```python
import torch

def _softmax(x, axis=-1):
    return torch.softmax(x, dim=axis)
def _gelu(x):
    return torch.nn.functional.gelu(x, approximate="tanh")
def _silu(x):
    return torch.nn.functional.silu(x)
def _sigmoid(x):
    return torch.sigmoid(x)
def _layernorm(x, axis=-1, eps=1e-5):
    m = x.mean(dim=axis, keepdim=True)
    v = x.var(dim=axis, keepdim=True, unbiased=False)
    return (x - m) / torch.sqrt(v + eps)
def _scatter_add(tgt, idx, src, axis=0):
    return tgt.clone().index_add_(axis, idx, src)
def _segment_sum(src, seg, n):
    out = torch.zeros((n,) + src.shape[1:], dtype=src.dtype)
    return out.index_add_(0, seg, src)
def _pad(x, pw):
    flat = tuple(v for pair in reversed(pw) for v in pair)
    return torch.nn.functional.pad(x, flat)

kernel_name = 'standalone__normalfloat_lut_af4__prompt'

def setup_inputs():

    _w = (lambda a: (lambda t: t.to(torch.bfloat16) if t.is_floating_point() else t)(torch.as_tensor(a)))
    B, S, D, F = 1, 2048, 1024, 3584
    G = -1 if -1 > 0 else D
    D = (D // G) * G
    ng = D // G
    nf4 = torch.tensor([
        -1.0, -0.6961928009986877, -0.5250730514526367, -0.39491748809814453,
        -0.28444138169288635, -0.18477343022823334, -0.09105003625154495, 0.0,
        0.07958029955625534, 0.16093020141124725, 0.24611230194568634,
        0.33791524171829224, 0.44070982933044434, 0.5626170039176941,
        0.7229568362236023, 1.0,
    ], dtype=float)
    qw = torch.randint(0, 16, (D, F)).to(torch.int64)
    return {
        "x": _w((lambda *s: torch.randn(*s, dtype=torch.bfloat16) * 0.05)(B, S, D)),
        "qw": _w(qw),
        "lut": _w(nf4),
        "scales": _w(torch.abs((lambda *s: torch.randn(*s, dtype=torch.bfloat16) * 0.05)(ng, F)).to(float) + 0.01),
    }

def reference(x, qw, lut, scales):
    B, S, D = x.shape
    ng, F = scales.shape
    G = D // ng
    deq = lut[qw]
    s = (lambda x, n, axis: torch.repeat_interleave(x, n, dim=axis))(scales, G, axis=0)
    w = (lambda x, dt: x.to(dt))(deq, x.dtype) * (lambda x, dt: x.to(dt))(s, x.dtype)
    return torch.einsum("bsd,df->bsf", x, w)
```

```asm
; @launch grid=(224,1,1) block=(512,1,1) lds=163840
.amdgcn_target "amdgcn-amd-amdhsa--gfx950"
.text
.globl standalone__normalfloat_lut_af4__prompt_kernel
.p2align 8
.type standalone__normalfloat_lut_af4__prompt_kernel,@function
standalone__normalfloat_lut_af4__prompt_kernel:
s_cmp_ge_u32 s2, 224
s_cbranch_scc1 L_END
s_load_dwordx4 s[4:7], s[0:1], 0
s_load_dwordx4 s[8:11], s[0:1], 16
s_load_dwordx2 s[12:13], s[0:1], 32
v_lshrrev_b32 v1, 6, v0
v_and_b32 v0, 63, v0
s_and_b32 s40, s2, 7
s_lshr_b32 s41, s2, 3
v_readfirstlane_b32 s36, v1
s_lshr_b32 s42, s40, 2
s_and_b32 s43, s40, 3
s_and_b32 s37, s41, 3
s_lshl2_add_u32 s37, s42, s37
s_lshr_b32 s38, s41, 2
s_mul_i32 s44, s43, 7
s_add_u32 s38, s38, s44
s_mov_b32 s22, 4194304
s_mov_b32 s23, 0x20000
s_mov_b32 s26, 14680064
s_mov_b32 s27, 0x20000
s_cmp_ge_u32 s36, 4
s_cbranch_scc1 L_PROD
v_lshrrev_b32 v2, 3, v0
v_lshlrev_b32 v2, 1, v2
v_and_b32 v3, 15, v0
v_bfe_u32 v4, v0, 4, 1
v_lshrrev_b32 v5, 5, v0
s_lshl_b32 s45, s38, 8
v_lshl_add_u32 v6, v3, 4, s45
v_lshl_add_u32 v7, v4, 3, v6
s_lshl_b32 s46, s36, 3
s_waitcnt lgkmcnt(0)
global_load_ushort v24, v2, s[8:9]
global_load_ushort v25, v2, s[8:9] offset:16
s_load_dwordx2 s[48:49], s[8:9], s46
global_load_dwordx2 v[18:19], v7, s[10:11]
s_mov_b32 s28, s12
s_mov_b32 s29, s13
s_mov_b32 s30, 14680064
s_mov_b32 s31, 0x20000
s_lshl_b32 s47, s37, 2
s_add_u32 s47, s47, s36
s_lshl_b32 s47, s47, 6
v_lshl_add_u32 v26, v5, 2, v4
v_add_u32 v26, s47, v26
v_mul_u32_u24 v26, 7168, v26
v_add_u32 v17, v26, v6
v_and_b32 v26, 31, v0
s_lshl_b32 s47, s36, 6
v_add_u32 v26, s47, v26
v_lshlrev_b32 v26, 7, v26
v_bfe_u32 v27, v0, 1, 3
v_xor_b32 v27, v27, v5
v_lshl_add_u32 v8, v27, 4, v26
v_xor_b32 v9, 32, v8
v_xor_b32 v10, 64, v8
v_xor_b32 v11, 96, v8
v_mov_b32 v12, v8
v_mov_b32 v13, v9
v_mov_b32 v14, v10
v_mov_b32 v15, v11
v_lshl_add_u32 v26, v3, 1, v4
v_lshlrev_b32 v26, 4, v26
v_lshl_add_u32 v26, v5, 11, v26
v_add_u32 v16, 98304, v26
v_mov_b32 v64, 0
v_mov_b32 v65, 0
v_mov_b32 v66, 0
v_mov_b32 v67, 0
s_nop 1
v_mfma_f32_32x32x16_bf16 v[128:143], v[64:67], v[64:67], 0
v_mfma_f32_32x32x16_bf16 v[144:159], v[64:67], v[64:67], 0
v_mfma_f32_32x32x16_bf16 v[160:175], v[64:67], v[64:67], 0
v_mfma_f32_32x32x16_bf16 v[176:191], v[64:67], v[64:67], 0
v_mfma_f32_32x32x16_bf16 v[192:207], v[64:67], v[64:67], 0
v_mfma_f32_32x32x16_bf16 v[208:223], v[64:67], v[64:67], 0
v_mfma_f32_32x32x16_bf16 v[224:239], v[64:67], v[64:67], 0
v_mfma_f32_32x32x16_bf16 v[240:255], v[64:67], v[64:67], 0
s_lshl_b32 s47, s36, 13
s_add_u32 s47, s47, 131072
v_lshl_add_u32 v27, v0, 4, s47
s_waitcnt vmcnt(1) lgkmcnt(0)
s_lshl_b32 s50, s48, 16
s_and_b32 s51, s48, 0xffff0000
s_lshl_b32 s52, s49, 16
s_and_b32 s53, s49, 0xffff0000
v_or_b32 v28, s50, v24
v_or_b32 v29, s50, v24
v_or_b32 v30, s50, v24
v_or_b32 v31, s50, v24
ds_write_b128 v27, v[28:31] offset:0
v_or_b32 v32, s50, v25
v_or_b32 v33, s50, v25
v_or_b32 v34, s50, v25
v_or_b32 v35, s50, v25
ds_write_b128 v27, v[32:35] offset:1024
v_or_b32 v36, s51, v24
v_or_b32 v37, s51, v24
v_or_b32 v38, s51, v24
v_or_b32 v39, s51, v24
ds_write_b128 v27, v[36:39] offset:2048
v_or_b32 v40, s51, v25
v_or_b32 v41, s51, v25
v_or_b32 v42, s51, v25
v_or_b32 v43, s51, v25
ds_write_b128 v27, v[40:43] offset:3072
v_or_b32 v44, s52, v24
v_or_b32 v45, s52, v24
v_or_b32 v46, s52, v24
v_or_b32 v47, s52, v24
ds_write_b128 v27, v[44:47] offset:4096
v_or_b32 v48, s52, v25
v_or_b32 v49, s52, v25
v_or_b32 v50, s52, v25
v_or_b32 v51, s52, v25
ds_write_b128 v27, v[48:51] offset:5120
v_or_b32 v52, s53, v24
v_or_b32 v53, s53, v24
v_or_b32 v54, s53, v24
v_or_b32 v55, s53, v24
ds_write_b128 v27, v[52:55] offset:6144
v_or_b32 v56, s53, v25
v_or_b32 v57, s53, v25
v_or_b32 v58, s53, v25
v_or_b32 v59, s53, v25
ds_write_b128 v27, v[56:59] offset:7168
s_waitcnt lgkmcnt(0)
s_barrier
s_mov_b32 s54, 0
s_mov_b32 s55, 0
s_barrier
ds_read_b128 v[64:67], v12
ds_read_b128 v[72:75], v16 offset:0
ds_read_b128 v[68:71], v12 offset:4096
ds_read_b128 v[76:79], v16 offset:512
ds_read_b128 v[80:83], v16 offset:1024
ds_read_b128 v[84:87], v16 offset:1536
s_branch L_CENTRY
L_CLOOP:
s_barrier
v_mfma_f32_32x32x16_bf16 v[128:143], v[88:91], v[96:99], v[128:143]
ds_read_b128 v[64:67], v12
ds_read_b128 v[72:75], v16 offset:0
v_mfma_f32_32x32x16_bf16 v[192:207], v[92:95], v[96:99], v[192:207]
ds_read_b128 v[68:71], v12 offset:4096
ds_read_b128 v[76:79], v16 offset:512
v_mfma_f32_32x32x16_bf16 v[144:159], v[88:91], v[100:103], v[144:159]
ds_read_b128 v[80:83], v16 offset:1024
ds_read_b128 v[84:87], v16 offset:1536
v_mfma_f32_32x32x16_bf16 v[208:223], v[92:95], v[100:103], v[208:223]
v_mfma_f32_32x32x16_bf16 v[160:175], v[88:91], v[104:107], v[160:175]
v_mfma_f32_32x32x16_bf16 v[224:239], v[92:95], v[104:107], v[224:239]
v_mfma_f32_32x32x16_bf16 v[176:191], v[88:91], v[108:111], v[176:191]
v_mfma_f32_32x32x16_bf16 v[240:255], v[92:95], v[108:111], v[240:255]
L_CENTRY:
s_waitcnt lgkmcnt(0)
v_mfma_f32_32x32x16_bf16 v[128:143], v[64:67], v[72:75], v[128:143]
ds_read_b128 v[88:91], v13
ds_read_b128 v[96:99], v16 offset:4096
v_mfma_f32_32x32x16_bf16 v[192:207], v[68:71], v[72:75], v[192:207]
ds_read_b128 v[92:95], v13 offset:4096
ds_read_b128 v[100:103], v16 offset:4608
v_mfma_f32_32x32x16_bf16 v[144:159], v[64:67], v[76:79], v[144:159]
ds_read_b128 v[104:107], v16 offset:5120
ds_read_b128 v[108:111], v16 offset:5632
v_mfma_f32_32x32x16_bf16 v[208:223], v[68:71], v[76:79], v[208:223]
v_mfma_f32_32x32x16_bf16 v[160:175], v[64:67], v[80:83], v[160:175]
v_mfma_f32_32x32x16_bf16 v[224:239], v[68:71], v[80:83], v[224:239]
v_mfma_f32_32x32x16_bf16 v[176:191], v[64:67], v[84:87], v[176:191]
v_mfma_f32_32x32x16_bf16 v[240:255], v[68:71], v[84:87], v[240:255]
s_waitcnt lgkmcnt(0)
v_mfma_f32_32x32x16_bf16 v[128:143], v[88:91], v[96:99], v[128:143]
ds_read_b128 v[64:67], v14
ds_read_b128 v[72:75], v16 offset:8192
v_mfma_f32_32x32x16_bf16 v[192:207], v[92:95], v[96:99], v[192:207]
ds_read_b128 v[68:71], v14 offset:4096
ds_read_b128 v[76:79], v16 offset:8704
v_mfma_f32_32x32x16_bf16 v[144:159], v[88:91], v[100:103], v[144:159]
ds_read_b128 v[80:83], v16 offset:9216
ds_read_b128 v[84:87], v16 offset:9728
v_mfma_f32_32x32x16_bf16 v[208:223], v[92:95], v[100:103], v[208:223]
v_mfma_f32_32x32x16_bf16 v[160:175], v[88:91], v[104:107], v[160:175]
v_mfma_f32_32x32x16_bf16 v[224:239], v[92:95], v[104:107], v[224:239]
v_mfma_f32_32x32x16_bf16 v[176:191], v[88:91], v[108:111], v[176:191]
v_mfma_f32_32x32x16_bf16 v[240:255], v[92:95], v[108:111], v[240:255]
s_waitcnt lgkmcnt(0)
v_mfma_f32_32x32x16_bf16 v[128:143], v[64:67], v[72:75], v[128:143]
ds_read_b128 v[88:91], v15
ds_read_b128 v[96:99], v16 offset:12288
v_mfma_f32_32x32x16_bf16 v[192:207], v[68:71], v[72:75], v[192:207]
ds_read_b128 v[92:95], v15 offset:4096
ds_read_b128 v[100:103], v16 offset:12800
v_mfma_f32_32x32x16_bf16 v[144:159], v[64:67], v[76:79], v[144:159]
ds_read_b128 v[104:107], v16 offset:13312
ds_read_b128 v[108:111], v16 offset:13824
v_mfma_f32_32x32x16_bf16 v[208:223], v[68:71], v[76:79], v[208:223]
s_add_u32 s55, s55, 32768
s_cmp_eq_u32 s55, 98304
s_cselect_b32 s55, 0, s55
v_mfma_f32_32x32x16_bf16 v[160:175], v[64:67], v[80:83], v[160:175]
v_add_u32 v12, s55, v8
v_add_u32 v13, s55, v9
v_add_u32 v14, s55, v10
v_mfma_f32_32x32x16_bf16 v[224:239], v[68:71], v[80:83], v[224:239]
v_add_u32 v15, s55, v11
v_xor_b32 v16, 16384, v16
s_add_u32 s54, s54, 1
v_mfma_f32_32x32x16_bf16 v[176:191], v[64:67], v[84:87], v[176:191]
v_mfma_f32_32x32x16_bf16 v[240:255], v[68:71], v[84:87], v[240:255]
s_waitcnt lgkmcnt(0)
s_cmp_lt_u32 s54, 16
s_cbranch_scc1 L_CLOOP
v_mfma_f32_32x32x16_bf16 v[128:143], v[88:91], v[96:99], v[128:143]
v_mfma_f32_32x32x16_bf16 v[192:207], v[92:95], v[96:99], v[192:207]
v_mfma_f32_32x32x16_bf16 v[144:159], v[88:91], v[100:103], v[144:159]
v_mfma_f32_32x32x16_bf16 v[208:223], v[92:95], v[100:103], v[208:223]
v_mfma_f32_32x32x16_bf16 v[160:175], v[88:91], v[104:107], v[160:175]
v_mfma_f32_32x32x16_bf16 v[224:239], v[92:95], v[104:107], v[224:239]
v_mfma_f32_32x32x16_bf16 v[176:191], v[88:91], v[108:111], v[176:191]
v_mfma_f32_32x32x16_bf16 v[240:255], v[92:95], v[108:111], v[240:255]
s_waitcnt vmcnt(0)
v_lshlrev_b32 v20, 16, v18
v_and_b32 v21, 0xffff0000, v18
v_lshlrev_b32 v22, 16, v19
v_and_b32 v23, 0xffff0000, v19
s_nop 7
s_nop 1
v_pk_mul_f32 v[128:129], v[128:129], v[20:21] op_sel:[0,0] op_sel_hi:[1,0]
v_pk_mul_f32 v[144:145], v[144:145], v[20:21] op_sel:[0,1] op_sel_hi:[1,1]
v_pk_mul_f32 v[160:161], v[160:161], v[22:23] op_sel:[0,0] op_sel_hi:[1,0]
v_pk_mul_f32 v[176:177], v[176:177], v[22:23] op_sel:[0,1] op_sel_hi:[1,1]
v_cvt_pk_bf16_f32 v64, v128, v144
v_cvt_pk_bf16_f32 v65, v160, v176
v_cvt_pk_bf16_f32 v66, v129, v145
v_cvt_pk_bf16_f32 v67, v161, v177
s_mov_b32 s56, 0
s_nop 0
v_permlane16_swap_b32 v64, v66
v_permlane16_swap_b32 v65, v67
buffer_store_dwordx4 v[64:67], v17, s[28:31], s56 offen nt
v_pk_mul_f32 v[130:131], v[130:131], v[20:21] op_sel:[0,0] op_sel_hi:[1,0]
v_pk_mul_f32 v[146:147], v[146:147], v[20:21] op_sel:[0,1] op_sel_hi:[1,1]
v_pk_mul_f32 v[162:163], v[162:163], v[22:23] op_sel:[0,0] op_sel_hi:[1,0]
v_pk_mul_f32 v[178:179], v[178:179], v[22:23] op_sel:[0,1] op_sel_hi:[1,1]
v_cvt_pk_bf16_f32 v68, v130, v146
v_cvt_pk_bf16_f32 v69, v162, v178
v_cvt_pk_bf16_f32 v70, v131, v147
v_cvt_pk_bf16_f32 v71, v163, v179
s_mov_b32 s56, 14336
s_nop 0
v_permlane16_swap_b32 v68, v70
v_permlane16_swap_b32 v69, v71
buffer_store_dwordx4 v[68:71], v17, s[28:31], s56 offen nt
v_pk_mul_f32 v[132:133], v[132:133], v[20:21] op_sel:[0,0] op_sel_hi:[1,0]
v_pk_mul_f32 v[148:149], v[148:149], v[20:21] op_sel:[0,1] op_sel_hi:[1,1]
v_pk_mul_f32 v[164:165], v[164:165], v[22:23] op_sel:[0,0] op_sel_hi:[1,0]
v_pk_mul_f32 v[180:181], v[180:181], v[22:23] op_sel:[0,1] op_sel_hi:[1,1]
v_cvt_pk_bf16_f32 v72, v132, v148
v_cvt_pk_bf16_f32 v73, v164, v180
v_cvt_pk_bf16_f32 v74, v133, v149
v_cvt_pk_bf16_f32 v75, v165, v181
s_mov_b32 s56, 57344
s_nop 0
v_permlane16_swap_b32 v72, v74
v_permlane16_swap_b32 v73, v75
buffer_store_dwordx4 v[72:75], v17, s[28:31], s56 offen nt
v_pk_mul_f32 v[134:135], v[134:135], v[20:21] op_sel:[0,0] op_sel_hi:[1,0]
v_pk_mul_f32 v[150:151], v[150:151], v[20:21] op_sel:[0,1] op_sel_hi:[1,1]
v_pk_mul_f32 v[166:167], v[166:167], v[22:23] op_sel:[0,0] op_sel_hi:[1,0]
v_pk_mul_f32 v[182:183], v[182:183], v[22:23] op_sel:[0,1] op_sel_hi:[1,1]
v_cvt_pk_bf16_f32 v76, v134, v150
v_cvt_pk_bf16_f32 v77, v166, v182
v_cvt_pk_bf16_f32 v78, v135, v151
v_cvt_pk_bf16_f32 v79, v167, v183
s_mov_b32 s56, 71680
s_nop 0
v_permlane16_swap_b32 v76, v78
v_permlane16_swap_b32 v77, v79
buffer_store_dwordx4 v[76:79], v17, s[28:31], s56 offen nt
v_pk_mul_f32 v[136:137], v[136:137], v[20:21] op_sel:[0,0] op_sel_hi:[1,0]
v_pk_mul_f32 v[152:153], v[152:153], v[20:21] op_sel:[0,1] op_sel_hi:[1,1]
v_pk_mul_f32 v[168:169], v[168:169], v[22:23] op_sel:[0,0] op_sel_hi:[1,0]
v_pk_mul_f32 v[184:185], v[184:185], v[22:23] op_sel:[0,1] op_sel_hi:[1,1]
v_cvt_pk_bf16_f32 v80, v136, v152
v_cvt_pk_bf16_f32 v81, v168, v184
v_cvt_pk_bf16_f32 v82, v137, v153
v_cvt_pk_bf16_f32 v83, v169, v185
s_mov_b32 s56, 114688
s_nop 0
v_permlane16_swap_b32 v80, v82
v_permlane16_swap_b32 v81, v83
buffer_store_dwordx4 v[80:83], v17, s[28:31], s56 offen nt
v_pk_mul_f32 v[138:139], v[138:139], v[20:21] op_sel:[0,0] op_sel_hi:[1,0]
v_pk_mul_f32 v[154:155], v[154:155], v[20:21] op_sel:[0,1] op_sel_hi:[1,1]
v_pk_mul_f32 v[170:171], v[170:171], v[22:23] op_sel:[0,0] op_sel_hi:[1,0]
v_pk_mul_f32 v[186:187], v[186:187], v[22:23] op_sel:[0,1] op_sel_hi:[1,1]
v_cvt_pk_bf16_f32 v84, v138, v154
v_cvt_pk_bf16_f32 v85, v170, v186
v_cvt_pk_bf16_f32 v86, v139, v155
v_cvt_pk_bf16_f32 v87, v171, v187
s_mov_b32 s56, 129024
s_nop 0
v_permlane16_swap_b32 v84, v86
v_permlane16_swap_b32 v85, v87
buffer_store_dwordx4 v[84:87], v17, s[28:31], s56 offen nt
v_pk_mul_f32 v[140:141], v[140:141], v[20:21] op_sel:[0,0] op_sel_hi:[1,0]
v_pk_mul_f32 v[156:157], v[156:157], v[20:21] op_sel:[0,1] op_sel_hi:[1,1]
v_pk_mul_f32 v[172:173], v[172:173], v[22:23] op_sel:[0,0] op_sel_hi:[1,0]
v_pk_mul_f32 v[188:189], v[188:189], v[22:23] op_sel:[0,1] op_sel_hi:[1,1]
v_cvt_pk_bf16_f32 v88, v140, v156
v_cvt_pk_bf16_f32 v89, v172, v188
v_cvt_pk_bf16_f32 v90, v141, v157
v_cvt_pk_bf16_f32 v91, v173, v189
s_mov_b32 s56, 172032
s_nop 0
v_permlane16_swap_b32 v88, v90
v_permlane16_swap_b32 v89, v91
buffer_store_dwordx4 v[88:91], v17, s[28:31], s56 offen nt
v_pk_mul_f32 v[142:143], v[142:143], v[20:21] op_sel:[0,0] op_sel_hi:[1,0]
v_pk_mul_f32 v[158:159], v[158:159], v[20:21] op_sel:[0,1] op_sel_hi:[1,1]
v_pk_mul_f32 v[174:175], v[174:175], v[22:23] op_sel:[0,0] op_sel_hi:[1,0]
v_pk_mul_f32 v[190:191], v[190:191], v[22:23] op_sel:[0,1] op_sel_hi:[1,1]
v_cvt_pk_bf16_f32 v92, v142, v158
v_cvt_pk_bf16_f32 v93, v174, v190
v_cvt_pk_bf16_f32 v94, v143, v159
v_cvt_pk_bf16_f32 v95, v175, v191
s_mov_b32 s56, 186368
s_nop 0
v_permlane16_swap_b32 v92, v94
v_permlane16_swap_b32 v93, v95
buffer_store_dwordx4 v[92:95], v17, s[28:31], s56 offen nt
v_pk_mul_f32 v[192:193], v[192:193], v[20:21] op_sel:[0,0] op_sel_hi:[1,0]
v_pk_mul_f32 v[208:209], v[208:209], v[20:21] op_sel:[0,1] op_sel_hi:[1,1]
v_pk_mul_f32 v[224:225], v[224:225], v[22:23] op_sel:[0,0] op_sel_hi:[1,0]
v_pk_mul_f32 v[240:241], v[240:241], v[22:23] op_sel:[0,1] op_sel_hi:[1,1]
v_cvt_pk_bf16_f32 v64, v192, v208
v_cvt_pk_bf16_f32 v65, v224, v240
v_cvt_pk_bf16_f32 v66, v193, v209
v_cvt_pk_bf16_f32 v67, v225, v241
s_mov_b32 s56, 229376
s_nop 0
v_permlane16_swap_b32 v64, v66
v_permlane16_swap_b32 v65, v67
buffer_store_dwordx4 v[64:67], v17, s[28:31], s56 offen nt
v_pk_mul_f32 v[194:195], v[194:195], v[20:21] op_sel:[0,0] op_sel_hi:[1,0]
v_pk_mul_f32 v[210:211], v[210:211], v[20:21] op_sel:[0,1] op_sel_hi:[1,1]
v_pk_mul_f32 v[226:227], v[226:227], v[22:23] op_sel:[0,0] op_sel_hi:[1,0]
v_pk_mul_f32 v[242:243], v[242:243], v[22:23] op_sel:[0,1] op_sel_hi:[1,1]
v_cvt_pk_bf16_f32 v68, v194, v210
v_cvt_pk_bf16_f32 v69, v226, v242
v_cvt_pk_bf16_f32 v70, v195, v211
v_cvt_pk_bf16_f32 v71, v227, v243
s_mov_b32 s56, 243712
s_nop 0
v_permlane16_swap_b32 v68, v70
v_permlane16_swap_b32 v69, v71
buffer_store_dwordx4 v[68:71], v17, s[28:31], s56 offen nt
v_pk_mul_f32 v[196:197], v[196:197], v[20:21] op_sel:[0,0] op_sel_hi:[1,0]
v_pk_mul_f32 v[212:213], v[212:213], v[20:21] op_sel:[0,1] op_sel_hi:[1,1]
v_pk_mul_f32 v[228:229], v[228:229], v[22:23] op_sel:[0,0] op_sel_hi:[1,0]
v_pk_mul_f32 v[244:245], v[244:245], v[22:23] op_sel:[0,1] op_sel_hi:[1,1]
v_cvt_pk_bf16_f32 v72, v196, v212
v_cvt_pk_bf16_f32 v73, v228, v244
v_cvt_pk_bf16_f32 v74, v197, v213
v_cvt_pk_bf16_f32 v75, v229, v245
s_mov_b32 s56, 286720
s_nop 0
v_permlane16_swap_b32 v72, v74
v_permlane16_swap_b32 v73, v75
buffer_store_dwordx4 v[72:75], v17, s[28:31], s56 offen nt
v_pk_mul_f32 v[198:199], v[198:199], v[20:21] op_sel:[0,0] op_sel_hi:[1,0]
v_pk_mul_f32 v[214:215], v[214:215], v[20:21] op_sel:[0,1] op_sel_hi:[1,1]
v_pk_mul_f32 v[230:231], v[230:231], v[22:23] op_sel:[0,0] op_sel_hi:[1,0]
v_pk_mul_f32 v[246:247], v[246:247], v[22:23] op_sel:[0,1] op_sel_hi:[1,1]
v_cvt_pk_bf16_f32 v76, v198, v214
v_cvt_pk_bf16_f32 v77, v230, v246
v_cvt_pk_bf16_f32 v78, v199, v215
v_cvt_pk_bf16_f32 v79, v231, v247
s_mov_b32 s56, 301056
s_nop 0
v_permlane16_swap_b32 v76, v78
v_permlane16_swap_b32 v77, v79
buffer_store_dwordx4 v[76:79], v17, s[28:31], s56 offen nt
v_pk_mul_f32 v[200:201], v[200:201], v[20:21] op_sel:[0,0] op_sel_hi:[1,0]
v_pk_mul_f32 v[216:217], v[216:217], v[20:21] op_sel:[0,1] op_sel_hi:[1,1]
v_pk_mul_f32 v[232:233], v[232:233], v[22:23] op_sel:[0,0] op_sel_hi:[1,0]
v_pk_mul_f32 v[248:249], v[248:249], v[22:23] op_sel:[0,1] op_sel_hi:[1,1]
v_cvt_pk_bf16_f32 v80, v200, v216
v_cvt_pk_bf16_f32 v81, v232, v248
v_cvt_pk_bf16_f32 v82, v201, v217
v_cvt_pk_bf16_f32 v83, v233, v249
s_mov_b32 s56, 344064
s_nop 0
v_permlane16_swap_b32 v80, v82
v_permlane16_swap_b32 v81, v83
buffer_store_dwordx4 v[80:83], v17, s[28:31], s56 offen nt
v_pk_mul_f32 v[202:203], v[202:203], v[20:21] op_sel:[0,0] op_sel_hi:[1,0]
v_pk_mul_f32 v[218:219], v[218:219], v[20:21] op_sel:[0,1] op_sel_hi:[1,1]
v_pk_mul_f32 v[234:235], v[234:235], v[22:23] op_sel:[0,0] op_sel_hi:[1,0]
v_pk_mul_f32 v[250:251], v[250:251], v[22:23] op_sel:[0,1] op_sel_hi:[1,1]
v_cvt_pk_bf16_f32 v84, v202, v218
v_cvt_pk_bf16_f32 v85, v234, v250
v_cvt_pk_bf16_f32 v86, v203, v219
v_cvt_pk_bf16_f32 v87, v235, v251
s_mov_b32 s56, 358400
s_nop 0
v_permlane16_swap_b32 v84, v86
v_permlane16_swap_b32 v85, v87
buffer_store_dwordx4 v[84:87], v17, s[28:31], s56 offen nt
v_pk_mul_f32 v[204:205], v[204:205], v[20:21] op_sel:[0,0] op_sel_hi:[1,0]
v_pk_mul_f32 v[220:221], v[220:221], v[20:21] op_sel:[0,1] op_sel_hi:[1,1]
v_pk_mul_f32 v[236:237], v[236:237], v[22:23] op_sel:[0,0] op_sel_hi:[1,0]
v_pk_mul_f32 v[252:253], v[252:253], v[22:23] op_sel:[0,1] op_sel_hi:[1,1]
v_cvt_pk_bf16_f32 v88, v204, v220
v_cvt_pk_bf16_f32 v89, v236, v252
v_cvt_pk_bf16_f32 v90, v205, v221
v_cvt_pk_bf16_f32 v91, v237, v253
s_mov_b32 s56, 401408
s_nop 0
v_permlane16_swap_b32 v88, v90
v_permlane16_swap_b32 v89, v91
buffer_store_dwordx4 v[88:91], v17, s[28:31], s56 offen nt
v_pk_mul_f32 v[206:207], v[206:207], v[20:21] op_sel:[0,0] op_sel_hi:[1,0]
v_pk_mul_f32 v[222:223], v[222:223], v[20:21] op_sel:[0,1] op_sel_hi:[1,1]
v_pk_mul_f32 v[238:239], v[238:239], v[22:23] op_sel:[0,0] op_sel_hi:[1,0]
v_pk_mul_f32 v[254:255], v[254:255], v[22:23] op_sel:[0,1] op_sel_hi:[1,1]
v_cvt_pk_bf16_f32 v92, v206, v222
v_cvt_pk_bf16_f32 v93, v238, v254
v_cvt_pk_bf16_f32 v94, v207, v223
v_cvt_pk_bf16_f32 v95, v239, v255
s_mov_b32 s56, 415744
s_nop 0
v_permlane16_swap_b32 v92, v94
v_permlane16_swap_b32 v93, v95
buffer_store_dwordx4 v[92:95], v17, s[28:31], s56 offen nt
s_endpgm
L_PROD:
s_sub_u32 s39, s36, 4
v_lshrrev_b32 v5, 5, v0
v_and_b32 v3, 31, v0
s_mul_i32 s45, s39, 229376
s_lshl_b32 s46, s38, 9
s_add_u32 s45, s45, s46
v_mul_u32_u24 v2, 114688, v5
v_lshl_add_u32 v2, v3, 4, v2
v_add_u32 v16, s45, v2
v_add_u32 v17, 14336, v16
v_add_u32 v18, 28672, v16
v_add_u32 v19, 43008, v16
v_add_u32 v20, 57344, v16
v_add_u32 v21, 71680, v16
v_add_u32 v22, 86016, v16
v_add_u32 v23, 100352, v16
s_mov_b32 s50, 0
s_mov_b32 s51, 0
s_waitcnt lgkmcnt(0)
s_mov_b32 s24, s6
s_mov_b32 s25, s7
s_mov_b32 s20, s4
s_mov_b32 s21, s5
buffer_load_dwordx4 v[32:35], v16, s[24:27], s50 offen
buffer_load_dwordx4 v[36:39], v17, s[24:27], s50 offen
buffer_load_dwordx4 v[40:43], v18, s[24:27], s50 offen
buffer_load_dwordx4 v[44:47], v19, s[24:27], s50 offen
buffer_load_dwordx4 v[48:51], v20, s[24:27], s50 offen
buffer_load_dwordx4 v[52:55], v21, s[24:27], s50 offen
buffer_load_dwordx4 v[56:59], v22, s[24:27], s50 offen
buffer_load_dwordx4 v[60:63], v23, s[24:27], s50 offen
s_lshl_b32 s45, s37, 2
s_add_u32 s45, s45, s39
s_lshl_b32 s45, s45, 17
v_lshrrev_b32 v2, 3, v0
v_lshl_add_u32 v2, v2, 11, s45
v_and_b32 v4, 7, v0
v_lshrrev_b32 v6, 4, v0
v_xor_b32 v4, v4, v6
v_lshl_add_u32 v2, v4, 4, v2
v_xor_b32 v4, 64, v2
v_add_u32 v8, 0, v2
v_add_u32 v9, 15360, v4
v_add_u32 v10, 30720, v2
v_add_u32 v11, 46080, v4
v_add_u32 v12, 65536, v2
v_add_u32 v13, 80896, v4
v_add_u32 v14, 96256, v2
v_add_u32 v15, 111616, v4
s_lshl_b32 s52, s39, 13
s_mov_b32 s53, s52
s_mov_b32 m0, s52
s_nop 0
buffer_load_dwordx4 v8, s[20:23], s51 offen offset:0 lds
buffer_load_dwordx4 v9, s[20:23], s51 offen offset:1024 lds
buffer_load_dwordx4 v10, s[20:23], s51 offen offset:2048 lds
buffer_load_dwordx4 v11, s[20:23], s51 offen offset:3072 lds
s_add_u32 m0, s52, 4096
s_nop 0
buffer_load_dwordx4 v12, s[20:23], s51 offen offset:0 lds
buffer_load_dwordx4 v13, s[20:23], s51 offen offset:1024 lds
buffer_load_dwordx4 v14, s[20:23], s51 offen offset:2048 lds
buffer_load_dwordx4 v15, s[20:23], s51 offen offset:3072 lds
s_add_u32 s50, s50, 917504
s_add_u32 s51, s51, 128
s_add_u32 s52, s52, 32768
s_cmp_ge_u32 s52, 98304
s_cselect_b32 s52, s53, s52
buffer_load_dwordx4 v[64:67], v16, s[24:27], s50 offen
buffer_load_dwordx4 v[68:71], v17, s[24:27], s50 offen
buffer_load_dwordx4 v[72:75], v18, s[24:27], s50 offen
buffer_load_dwordx4 v[76:79], v19, s[24:27], s50 offen
buffer_load_dwordx4 v[80:83], v20, s[24:27], s50 offen
buffer_load_dwordx4 v[84:87], v21, s[24:27], s50 offen
buffer_load_dwordx4 v[88:91], v22, s[24:27], s50 offen
buffer_load_dwordx4 v[92:95], v23, s[24:27], s50 offen
s_mov_b32 m0, s52
s_nop 0
buffer_load_dwordx4 v8, s[20:23], s51 offen offset:0 lds
buffer_load_dwordx4 v9, s[20:23], s51 offen offset:1024 lds
buffer_load_dwordx4 v10, s[20:23], s51 offen offset:2048 lds
buffer_load_dwordx4 v11, s[20:23], s51 offen offset:3072 lds
s_add_u32 m0, s52, 4096
s_nop 0
buffer_load_dwordx4 v12, s[20:23], s51 offen offset:0 lds
buffer_load_dwordx4 v13, s[20:23], s51 offen offset:1024 lds
buffer_load_dwordx4 v14, s[20:23], s51 offen offset:2048 lds
buffer_load_dwordx4 v15, s[20:23], s51 offen offset:3072 lds
s_add_u32 s50, s50, 917504
s_add_u32 s51, s51, 128
s_add_u32 s52, s52, 32768
s_cmp_ge_u32 s52, 98304
s_cselect_b32 s52, s53, s52
v_lshlrev_b32 v24, 2, v3
v_add_u32 v24, 131072, v24
s_lshl_b32 s45, s39, 12
s_add_u32 s45, s45, 98304
v_lshlrev_b32 v2, 4, v3
v_lshl_add_u32 v2, v5, 11, v2
v_add_u32 v25, s45, v2
s_barrier
s_waitcnt vmcnt(24)
v_lshl_or_b32 v96, v36, 4, v32
v_lshl_add_u32 v96, v96, 7, v24
ds_read_b32 v96, v96
v_lshl_or_b32 v97, v44, 4, v40
v_lshl_add_u32 v97, v97, 7, v24
ds_read_b32 v97, v97
v_lshl_or_b32 v98, v52, 4, v48
v_lshl_add_u32 v98, v98, 7, v24
ds_read_b32 v98, v98
v_lshl_or_b32 v99, v60, 4, v56
v_lshl_add_u32 v99, v99, 7, v24
ds_read_b32 v99, v99
v_lshl_or_b32 v100, v37, 4, v33
v_lshl_add_u32 v100, v100, 7, v24
ds_read_b32 v100, v100
v_lshl_or_b32 v101, v45, 4, v41
v_lshl_add_u32 v101, v101, 7, v24
ds_read_b32 v101, v101
v_lshl_or_b32 v102, v53, 4, v49
v_lshl_add_u32 v102, v102, 7, v24
ds_read_b32 v102, v102
v_lshl_or_b32 v103, v61, 4, v57
v_lshl_add_u32 v103, v103, 7, v24
ds_read_b32 v103, v103
s_waitcnt lgkmcnt(4)
ds_write_b128 v25, v[96:99] offset:0
v_lshl_or_b32 v104, v38, 4, v34
v_lshl_add_u32 v104, v104, 7, v24
ds_read_b32 v104, v104
v_lshl_or_b32 v105, v46, 4, v42
v_lshl_add_u32 v105, v105, 7, v24
ds_read_b32 v105, v105
v_lshl_or_b32 v106, v54, 4, v50
v_lshl_add_u32 v106, v106, 7, v24
ds_read_b32 v106, v106
v_lshl_or_b32 v107, v62, 4, v58
v_lshl_add_u32 v107, v107, 7, v24
ds_read_b32 v107, v107
s_waitcnt lgkmcnt(5)
ds_write_b128 v25, v[100:103] offset:512
v_lshl_or_b32 v108, v39, 4, v35
v_lshl_add_u32 v108, v108, 7, v24
ds_read_b32 v108, v108
v_lshl_or_b32 v109, v47, 4, v43
v_lshl_add_u32 v109, v109, 7, v24
ds_read_b32 v109, v109
v_lshl_or_b32 v110, v55, 4, v51
v_lshl_add_u32 v110, v110, 7, v24
ds_read_b32 v110, v110
v_lshl_or_b32 v111, v63, 4, v59
v_lshl_add_u32 v111, v111, 7, v24
ds_read_b32 v111, v111
s_waitcnt lgkmcnt(5)
ds_write_b128 v25, v[104:107] offset:1024
s_waitcnt lgkmcnt(1)
ds_write_b128 v25, v[108:111] offset:1536
v_xor_b32 v25, 16384, v25
s_mov_b32 s54, 0
s_waitcnt vmcnt(16) lgkmcnt(0)
L_PLOOP:
s_barrier
s_waitcnt vmcnt(8)
buffer_load_dwordx4 v[32:35], v16, s[24:27], s50 offen
v_lshl_or_b32 v96, v68, 4, v64
v_lshl_add_u32 v96, v96, 7, v24
ds_read_b32 v96, v96
v_lshl_or_b32 v97, v76, 4, v72
buffer_load_dwordx4 v[36:39], v17, s[24:27], s50 offen
v_lshl_add_u32 v97, v97, 7, v24
ds_read_b32 v97, v97
v_lshl_or_b32 v98, v84, 4, v80
v_lshl_add_u32 v98, v98, 7, v24
buffer_load_dwordx4 v[40:43], v18, s[24:27], s50 offen
ds_read_b32 v98, v98
v_lshl_or_b32 v99, v92, 4, v88
v_lshl_add_u32 v99, v99, 7, v24
ds_read_b32 v99, v99
buffer_load_dwordx4 v[44:47], v19, s[24:27], s50 offen
v_lshl_or_b32 v100, v69, 4, v65
v_lshl_add_u32 v100, v100, 7, v24
ds_read_b32 v100, v100
v_lshl_or_b32 v101, v77, 4, v73
buffer_load_dwordx4 v[48:51], v20, s[24:27], s50 offen
v_lshl_add_u32 v101, v101, 7, v24
ds_read_b32 v101, v101
v_lshl_or_b32 v102, v85, 4, v81
v_lshl_add_u32 v102, v102, 7, v24
buffer_load_dwordx4 v[52:55], v21, s[24:27], s50 offen
ds_read_b32 v102, v102
v_lshl_or_b32 v103, v93, 4, v89
v_lshl_add_u32 v103, v103, 7, v24
ds_read_b32 v103, v103
buffer_load_dwordx4 v[56:59], v22, s[24:27], s50 offen
s_waitcnt lgkmcnt(4)
ds_write_b128 v25, v[96:99] offset:0
v_lshl_or_b32 v104, v70, 4, v66
v_lshl_add_u32 v104, v104, 7, v24
ds_read_b32 v104, v104
buffer_load_dwordx4 v[60:63], v23, s[24:27], s50 offen
v_lshl_or_b32 v105, v78, 4, v74
v_lshl_add_u32 v105, v105, 7, v24
ds_read_b32 v105, v105
v_lshl_or_b32 v106, v86, 4, v82
s_mov_b32 m0, s52
s_nop 0
buffer_load_dwordx4 v8, s[20:23], s51 offen offset:0 lds
v_lshl_add_u32 v106, v106, 7, v24
ds_read_b32 v106, v106
v_lshl_or_b32 v107, v94, 4, v90
v_lshl_add_u32 v107, v107, 7, v24
buffer_load_dwordx4 v9, s[20:23], s51 offen offset:1024 lds
ds_read_b32 v107, v107
s_waitcnt lgkmcnt(5)
ds_write_b128 v25, v[100:103] offset:512
v_lshl_or_b32 v108, v71, 4, v67
v_lshl_add_u32 v108, v108, 7, v24
buffer_load_dwordx4 v10, s[20:23], s51 offen offset:2048 lds
ds_read_b32 v108, v108
v_lshl_or_b32 v109, v79, 4, v75
v_lshl_add_u32 v109, v109, 7, v24
ds_read_b32 v109, v109
buffer_load_dwordx4 v11, s[20:23], s51 offen offset:3072 lds
v_lshl_or_b32 v110, v87, 4, v83
v_lshl_add_u32 v110, v110, 7, v24
ds_read_b32 v110, v110
v_lshl_or_b32 v111, v95, 4, v91
s_add_u32 m0, s52, 4096
s_nop 0
buffer_load_dwordx4 v12, s[20:23], s51 offen offset:0 lds
v_lshl_add_u32 v111, v111, 7, v24
ds_read_b32 v111, v111
s_waitcnt lgkmcnt(5)
ds_write_b128 v25, v[104:107] offset:1024
s_waitcnt lgkmcnt(1)
ds_write_b128 v25, v[108:111] offset:1536
buffer_load_dwordx4 v13, s[20:23], s51 offen offset:1024 lds
v_xor_b32 v25, 16384, v25
buffer_load_dwordx4 v14, s[20:23], s51 offen offset:2048 lds
buffer_load_dwordx4 v15, s[20:23], s51 offen offset:3072 lds
s_add_u32 s50, s50, 917504
s_add_u32 s51, s51, 128
s_add_u32 s52, s52, 32768
s_cmp_ge_u32 s52, 98304
s_cselect_b32 s52, s53, s52
s_waitcnt vmcnt(16) lgkmcnt(0)
s_barrier
s_waitcnt vmcnt(8)
buffer_load_dwordx4 v[64:67], v16, s[24:27], s50 offen
v_lshl_or_b32 v96, v36, 4, v32
v_lshl_add_u32 v96, v96, 7, v24
ds_read_b32 v96, v96
v_lshl_or_b32 v97, v44, 4, v40
buffer_load_dwordx4 v[68:71], v17, s[24:27], s50 offen
v_lshl_add_u32 v97, v97, 7, v24
ds_read_b32 v97, v97
v_lshl_or_b32 v98, v52, 4, v48
v_lshl_add_u32 v98, v98, 7, v24
buffer_load_dwordx4 v[72:75], v18, s[24:27], s50 offen
ds_read_b32 v98, v98
v_lshl_or_b32 v99, v60, 4, v56
v_lshl_add_u32 v99, v99, 7, v24
ds_read_b32 v99, v99
buffer_load_dwordx4 v[76:79], v19, s[24:27], s50 offen
v_lshl_or_b32 v100, v37, 4, v33
v_lshl_add_u32 v100, v100, 7, v24
ds_read_b32 v100, v100
v_lshl_or_b32 v101, v45, 4, v41
buffer_load_dwordx4 v[80:83], v20, s[24:27], s50 offen
v_lshl_add_u32 v101, v101, 7, v24
ds_read_b32 v101, v101
v_lshl_or_b32 v102, v53, 4, v49
v_lshl_add_u32 v102, v102, 7, v24
buffer_load_dwordx4 v[84:87], v21, s[24:27], s50 offen
ds_read_b32 v102, v102
v_lshl_or_b32 v103, v61, 4, v57
v_lshl_add_u32 v103, v103, 7, v24
ds_read_b32 v103, v103
buffer_load_dwordx4 v[88:91], v22, s[24:27], s50 offen
s_waitcnt lgkmcnt(4)
ds_write_b128 v25, v[96:99] offset:0
v_lshl_or_b32 v104, v38, 4, v34
v_lshl_add_u32 v104, v104, 7, v24
ds_read_b32 v104, v104
buffer_load_dwordx4 v[92:95], v23, s[24:27], s50 offen
v_lshl_or_b32 v105, v46, 4, v42
v_lshl_add_u32 v105, v105, 7, v24
ds_read_b32 v105, v105
v_lshl_or_b32 v106, v54, 4, v50
s_mov_b32 m0, s52
s_nop 0
buffer_load_dwordx4 v8, s[20:23], s51 offen offset:0 lds
v_lshl_add_u32 v106, v106, 7, v24
ds_read_b32 v106, v106
v_lshl_or_b32 v107, v62, 4, v58
v_lshl_add_u32 v107, v107, 7, v24
buffer_load_dwordx4 v9, s[20:23], s51 offen offset:1024 lds
ds_read_b32 v107, v107
s_waitcnt lgkmcnt(5)
ds_write_b128 v25, v[100:103] offset:512
v_lshl_or_b32 v108, v39, 4, v35
v_lshl_add_u32 v108, v108, 7, v24
buffer_load_dwordx4 v10, s[20:23], s51 offen offset:2048 lds
ds_read_b32 v108, v108
v_lshl_or_b32 v109, v47, 4, v43
v_lshl_add_u32 v109, v109, 7, v24
ds_read_b32 v109, v109
buffer_load_dwordx4 v11, s[20:23], s51 offen offset:3072 lds
v_lshl_or_b32 v110, v55, 4, v51
v_lshl_add_u32 v110, v110, 7, v24
ds_read_b32 v110, v110
v_lshl_or_b32 v111, v63, 4, v59
s_add_u32 m0, s52, 4096
s_nop 0
buffer_load_dwordx4 v12, s[20:23], s51 offen offset:0 lds
v_lshl_add_u32 v111, v111, 7, v24
ds_read_b32 v111, v111
s_waitcnt lgkmcnt(5)
ds_write_b128 v25, v[104:107] offset:1024
s_waitcnt lgkmcnt(1)
ds_write_b128 v25, v[108:111] offset:1536
buffer_load_dwordx4 v13, s[20:23], s51 offen offset:1024 lds
v_xor_b32 v25, 16384, v25
buffer_load_dwordx4 v14, s[20:23], s51 offen offset:2048 lds
buffer_load_dwordx4 v15, s[20:23], s51 offen offset:3072 lds
s_add_u32 s50, s50, 917504
s_add_u32 s51, s51, 128
s_add_u32 s52, s52, 32768
s_cmp_ge_u32 s52, 98304
s_cselect_b32 s52, s53, s52
s_add_u32 s54, s54, 2
s_cmp_lt_u32 s54, 14
s_waitcnt vmcnt(16) lgkmcnt(0)
s_cbranch_scc1 L_PLOOP
s_barrier
s_waitcnt vmcnt(8)
v_lshl_or_b32 v96, v68, 4, v64
v_lshl_add_u32 v96, v96, 7, v24
ds_read_b32 v96, v96
v_lshl_or_b32 v97, v76, 4, v72
v_lshl_add_u32 v97, v97, 7, v24
ds_read_b32 v97, v97
v_lshl_or_b32 v98, v84, 4, v80
v_lshl_add_u32 v98, v98, 7, v24
ds_read_b32 v98, v98
v_lshl_or_b32 v99, v92, 4, v88
v_lshl_add_u32 v99, v99, 7, v24
ds_read_b32 v99, v99
v_lshl_or_b32 v100, v69, 4, v65
v_lshl_add_u32 v100, v100, 7, v24
ds_read_b32 v100, v100
v_lshl_or_b32 v101, v77, 4, v73
v_lshl_add_u32 v101, v101, 7, v24
ds_read_b32 v101, v101
v_lshl_or_b32 v102, v85, 4, v81
v_lshl_add_u32 v102, v102, 7, v24
ds_read_b32 v102, v102
v_lshl_or_b32 v103, v93, 4, v89
v_lshl_add_u32 v103, v103, 7, v24
ds_read_b32 v103, v103
s_waitcnt lgkmcnt(4)
ds_write_b128 v25, v[96:99] offset:0
v_lshl_or_b32 v104, v70, 4, v66
v_lshl_add_u32 v104, v104, 7, v24
ds_read_b32 v104, v104
v_lshl_or_b32 v105, v78, 4, v74
v_lshl_add_u32 v105, v105, 7, v24
ds_read_b32 v105, v105
v_lshl_or_b32 v106, v86, 4, v82
v_lshl_add_u32 v106, v106, 7, v24
ds_read_b32 v106, v106
v_lshl_or_b32 v107, v94, 4, v90
v_lshl_add_u32 v107, v107, 7, v24
ds_read_b32 v107, v107
s_waitcnt lgkmcnt(5)
ds_write_b128 v25, v[100:103] offset:512
v_lshl_or_b32 v108, v71, 4, v67
v_lshl_add_u32 v108, v108, 7, v24
ds_read_b32 v108, v108
v_lshl_or_b32 v109, v79, 4, v75
v_lshl_add_u32 v109, v109, 7, v24
ds_read_b32 v109, v109
v_lshl_or_b32 v110, v87, 4, v83
v_lshl_add_u32 v110, v110, 7, v24
ds_read_b32 v110, v110
v_lshl_or_b32 v111, v95, 4, v91
v_lshl_add_u32 v111, v111, 7, v24
ds_read_b32 v111, v111
s_waitcnt lgkmcnt(5)
ds_write_b128 v25, v[104:107] offset:1024
s_waitcnt lgkmcnt(1)
ds_write_b128 v25, v[108:111] offset:1536
v_xor_b32 v25, 16384, v25
s_waitcnt vmcnt(0) lgkmcnt(0)
s_barrier
s_endpgm
L_END:
s_endpgm
.section .rodata,"a"
.p2align 6
.amdhsa_kernel standalone__normalfloat_lut_af4__prompt_kernel
  .amdhsa_next_free_vgpr 256
  .amdhsa_next_free_sgpr 102
  .amdhsa_accum_offset 256
  .amdhsa_group_segment_fixed_size 0
  .amdhsa_kernarg_size 56
  .amdhsa_user_sgpr_count 2
  .amdhsa_user_sgpr_kernarg_segment_ptr 1
  .amdhsa_system_sgpr_workgroup_id_x 1
.end_amdhsa_kernel
```

```asm
; @launch grid=(256,1,1) block=(256,1,1) lds=131072
.amdgcn_target "amdgcn-amd-amdhsa--gfx950"
.text
.globl standalone__normalfloat_lut_af4__prompt_kernel
.p2align 8
.type standalone__normalfloat_lut_af4__prompt_kernel,@function
standalone__normalfloat_lut_af4__prompt_kernel:
s_cmp_ge_u32 s2, 256
s_cbranch_scc1 L_END
s_load_dwordx4 s[4:7], s[0:1], 0
s_load_dwordx4 s[8:11], s[0:1], 16
s_load_dwordx2 s[12:13], s[0:1], 32
v_lshrrev_b32 v1, 6, v0
v_and_b32 v0, 63, v0
s_and_b32 s40, s2, 7
s_lshr_b32 s41, s2, 3
v_readfirstlane_b32 s36, v1
s_sub_u32 s41, s41, 4
s_lshr_b32 s42, s40, 2
s_and_b32 s43, s40, 3
s_and_b32 s37, s41, 3
s_lshl2_add_u32 s37, s42, s37
s_lshr_b32 s38, s41, 2
s_mul_i32 s44, s43, 7
s_add_u32 s38, s38, s44
s_mov_b32 s22, 4194304
s_mov_b32 s23, 0x20000
s_mov_b32 s26, 14680064
s_mov_b32 s27, 0x20000
s_cmp_ge_u32 s41, 28
s_cbranch_scc1 L_HELPER
v_lshrrev_b32 v5, 5, v0
v_and_b32 v3, 31, v0
s_mul_i32 s45, s36, 229376
s_lshl_b32 s46, s38, 9
s_add_u32 s45, s45, s46
v_mul_u32_u24 v2, 114688, v5
v_lshl_add_u32 v2, v3, 4, v2
v_add_u32 v16, s45, v2
v_add_u32 v17, 14336, v16
v_add_u32 v18, 28672, v16
v_add_u32 v19, 43008, v16
v_add_u32 v20, 57344, v16
v_add_u32 v21, 71680, v16
v_add_u32 v22, 86016, v16
v_add_u32 v23, 100352, v16
v_lshrrev_b32 v6, 3, v0
v_lshlrev_b32 v2, 1, v6
s_lshl_b32 s46, s36, 3
s_mov_b32 s50, 0
s_mov_b32 s51, 0
s_waitcnt lgkmcnt(0)
s_mov_b32 s24, s6
s_mov_b32 s25, s7
s_mov_b32 s20, s4
s_mov_b32 s21, s5
global_load_ushort v116, v2, s[8:9]
global_load_ushort v117, v2, s[8:9] offset:16
s_load_dwordx2 s[48:49], s[8:9], s46
buffer_load_dwordx4 v[64:67], v16, s[24:27], s50 offen
buffer_load_dwordx4 v[68:71], v17, s[24:27], s50 offen
buffer_load_dwordx4 v[72:75], v18, s[24:27], s50 offen
buffer_load_dwordx4 v[76:79], v19, s[24:27], s50 offen
buffer_load_dwordx4 v[80:83], v20, s[24:27], s50 offen
buffer_load_dwordx4 v[84:87], v21, s[24:27], s50 offen
buffer_load_dwordx4 v[88:91], v22, s[24:27], s50 offen
buffer_load_dwordx4 v[92:95], v23, s[24:27], s50 offen
s_lshl_b32 s45, s37, 2
s_add_u32 s45, s45, s36
s_lshl_b32 s45, s45, 17
v_lshl_add_u32 v2, v6, 11, s45
v_and_b32 v4, 7, v0
v_lshrrev_b32 v6, 4, v0
v_xor_b32 v4, v4, v6
v_lshl_add_u32 v2, v4, 4, v2
v_xor_b32 v4, 64, v2
v_add_u32 v8, 0, v2
v_add_u32 v9, 15360, v4
v_add_u32 v10, 30720, v2
v_add_u32 v11, 46080, v4
v_add_u32 v12, 65536, v2
v_add_u32 v13, 80896, v4
v_add_u32 v14, 96256, v2
v_add_u32 v15, 111616, v4
s_lshl_b32 m0, s36, 13
s_add_u32 s50, s50, 917504
buffer_load_dwordx4 v8, s[20:23], s51 offen offset:0 lds
buffer_load_dwordx4 v9, s[20:23], s51 offen offset:1024 lds
buffer_load_dwordx4 v10, s[20:23], s51 offen offset:2048 lds
buffer_load_dwordx4 v11, s[20:23], s51 offen offset:3072 lds
s_xor_b32 m0, m0, 0x1000
s_nop 0
buffer_load_dwordx4 v12, s[20:23], s51 offen offset:0 lds
buffer_load_dwordx4 v13, s[20:23], s51 offen offset:1024 lds
buffer_load_dwordx4 v14, s[20:23], s51 offen offset:2048 lds
buffer_load_dwordx4 v15, s[20:23], s51 offen offset:3072 lds
buffer_load_dwordx4 v[32:35], v16, s[24:27], s50 offen
buffer_load_dwordx4 v[36:39], v17, s[24:27], s50 offen
buffer_load_dwordx4 v[40:43], v18, s[24:27], s50 offen
buffer_load_dwordx4 v[44:47], v19, s[24:27], s50 offen
buffer_load_dwordx4 v[48:51], v20, s[24:27], s50 offen
buffer_load_dwordx4 v[52:55], v21, s[24:27], s50 offen
buffer_load_dwordx4 v[56:59], v22, s[24:27], s50 offen
buffer_load_dwordx4 v[60:63], v23, s[24:27], s50 offen
s_xor_b32 m0, m0, 36864
s_add_u32 s51, s51, 128
buffer_load_dwordx4 v8, s[20:23], s51 offen offset:0 lds
buffer_load_dwordx4 v9, s[20:23], s51 offen offset:1024 lds
buffer_load_dwordx4 v10, s[20:23], s51 offen offset:2048 lds
buffer_load_dwordx4 v11, s[20:23], s51 offen offset:3072 lds
s_xor_b32 m0, m0, 0x1000
s_nop 0
buffer_load_dwordx4 v12, s[20:23], s51 offen offset:0 lds
buffer_load_dwordx4 v13, s[20:23], s51 offen offset:1024 lds
s_add_u32 s50, s50, 917504
v_lshlrev_b32 v29, 2, v3
v_add_u32 v29, 98304, v29
s_lshl_b32 s45, s36, 12
s_add_u32 s45, s45, 65536
v_xor_b32 v3, v3, v5
v_lshlrev_b32 v2, 4, v3
v_lshl_add_u32 v2, v5, 11, v2
v_add_u32 v30, s45, v2
v_and_b32 v3, 15, v0
v_and_b32 v4, 1, v6
s_lshl_b32 s45, s38, 8
v_lshl_add_u32 v118, v3, 4, s45
s_mov_b32 s28, s12
s_mov_b32 s29, s13
s_mov_b32 s30, 14680064
s_mov_b32 s31, 0x20000
s_lshl_b32 s47, s37, 2
s_add_u32 s47, s47, s36
s_lshl_b32 s47, s47, 6
v_lshl_add_u32 v2, v6, 2, s47
v_mul_u32_u24 v2, 7168, v2
v_add_u32 v28, v2, v118
s_lshl_b32 s47, s36, 6
v_add_u32 v2, s47, v3
v_lshlrev_b32 v2, 7, v2
v_bfe_u32 v119, v0, 1, 3
v_xor_b32 v119, v119, v6
v_lshl_add_u32 v24, v119, 4, v2
v_xor_b32 v25, 64, v24
v_lshl_add_u32 v2, v3, 1, v4
v_lshlrev_b32 v2, 4, v2
v_lshl_add_u32 v2, v6, 11, v2
v_add_u32 v26, 65536, v2
v_xor_b32 v27, 16, v26
s_lshl_b32 s47, s36, 13
s_add_u32 s47, s47, 98304
v_lshl_add_u32 v119, v0, 4, s47
s_waitcnt vmcnt(30) lgkmcnt(0)
s_lshl_b32 s56, s48, 16
s_and_b32 s57, s48, 0xffff0000
s_lshl_b32 s58, s49, 16
s_and_b32 s59, s49, 0xffff0000
v_or_b32 v128, s56, v116
v_or_b32 v129, s56, v116
v_or_b32 v130, s56, v116
v_or_b32 v131, s56, v116
v_or_b32 v132, s56, v117
v_or_b32 v133, s56, v117
v_or_b32 v134, s56, v117
v_or_b32 v135, s56, v117
v_or_b32 v136, s57, v116
v_or_b32 v137, s57, v116
v_or_b32 v138, s57, v116
v_or_b32 v139, s57, v116
v_or_b32 v140, s57, v117
v_or_b32 v141, s57, v117
v_or_b32 v142, s57, v117
v_or_b32 v143, s57, v117
v_or_b32 v144, s58, v116
v_or_b32 v145, s58, v116
v_or_b32 v146, s58, v116
v_or_b32 v147, s58, v116
v_or_b32 v148, s58, v117
v_or_b32 v149, s58, v117
v_or_b32 v150, s58, v117
v_or_b32 v151, s58, v117
v_or_b32 v152, s59, v116
v_or_b32 v153, s59, v116
v_or_b32 v154, s59, v116
v_or_b32 v155, s59, v116
v_or_b32 v156, s59, v117
v_or_b32 v157, s59, v117
v_or_b32 v158, s59, v117
v_or_b32 v159, s59, v117
ds_write_b128 v119, v[128:131] offset:0
ds_write_b128 v119, v[132:135] offset:1024
ds_write_b128 v119, v[136:139] offset:2048
ds_write_b128 v119, v[140:143] offset:3072
ds_write_b128 v119, v[144:147] offset:4096
ds_write_b128 v119, v[148:151] offset:5120
ds_write_b128 v119, v[152:155] offset:6144
ds_write_b128 v119, v[156:159] offset:7168
v_mov_b32 v96, 0
v_mov_b32 v97, 0
v_mov_b32 v98, 0
v_mov_b32 v99, 0
s_waitcnt lgkmcnt(0)
s_barrier
v_mfma_f32_32x32x16_bf16 v[128:143], v[96:99], v[96:99], 0
v_mfma_f32_32x32x16_bf16 v[144:159], v[96:99], v[96:99], 0
v_mfma_f32_32x32x16_bf16 v[160:175], v[96:99], v[96:99], 0
v_mfma_f32_32x32x16_bf16 v[176:191], v[96:99], v[96:99], 0
v_mfma_f32_32x32x16_bf16 v[192:207], v[96:99], v[96:99], 0
v_mfma_f32_32x32x16_bf16 v[208:223], v[96:99], v[96:99], 0
v_mfma_f32_32x32x16_bf16 v[224:239], v[96:99], v[96:99], 0
v_mfma_f32_32x32x16_bf16 v[240:255], v[96:99], v[96:99], 0
s_waitcnt vmcnt(28)
v_lshl_add_u64 v[120:121], v[68:69], 4, v[64:65]
v_lshl_add_u64 v[122:123], v[70:71], 4, v[66:67]
v_lshl_add_u32 v96, v120, 7, v29
v_lshl_add_u32 v100, v121, 7, v29
v_lshl_add_u32 v104, v122, 7, v29
v_lshl_add_u32 v108, v123, 7, v29
ds_read_b32 v96, v96
ds_read_b32 v100, v100
ds_read_b32 v104, v104
ds_read_b32 v108, v108
s_waitcnt vmcnt(26)
v_lshl_add_u64 v[124:125], v[76:77], 4, v[72:73]
v_lshl_add_u64 v[126:127], v[78:79], 4, v[74:75]
v_lshl_add_u32 v97, v124, 7, v29
v_lshl_add_u32 v101, v125, 7, v29
v_lshl_add_u32 v105, v126, 7, v29
v_lshl_add_u32 v109, v127, 7, v29
ds_read_b32 v97, v97
ds_read_b32 v101, v101
ds_read_b32 v105, v105
ds_read_b32 v109, v109
s_waitcnt vmcnt(24)
v_lshl_add_u64 v[120:121], v[84:85], 4, v[80:81]
v_lshl_add_u64 v[122:123], v[86:87], 4, v[82:83]
v_lshl_add_u32 v98, v120, 7, v29
v_lshl_add_u32 v102, v121, 7, v29
v_lshl_add_u32 v106, v122, 7, v29
v_lshl_add_u32 v110, v123, 7, v29
ds_read_b32 v98, v98
ds_read_b32 v102, v102
ds_read_b32 v106, v106
ds_read_b32 v110, v110
s_waitcnt vmcnt(22)
v_lshl_add_u64 v[124:125], v[92:93], 4, v[88:89]
v_lshl_add_u64 v[126:127], v[94:95], 4, v[90:91]
v_lshl_add_u32 v99, v124, 7, v29
v_lshl_add_u32 v103, v125, 7, v29
v_lshl_add_u32 v107, v126, 7, v29
v_lshl_add_u32 v111, v127, 7, v29
ds_read_b32 v99, v99
ds_read_b32 v103, v103
ds_read_b32 v107, v107
ds_read_b32 v111, v111
s_waitcnt lgkmcnt(0)
ds_write_b128 v30, v[96:99] offset:0
ds_write_b128 v30, v[100:103] offset:512
ds_write_b128 v30, v[104:107] offset:1024
ds_write_b128 v30, v[108:111] offset:1536
s_waitcnt vmcnt(12)
v_lshl_add_u64 v[120:121], v[36:37], 4, v[32:33]
v_lshl_add_u64 v[122:123], v[38:39], 4, v[34:35]
v_lshl_add_u32 v96, v120, 7, v29
v_lshl_add_u32 v100, v121, 7, v29
v_lshl_add_u32 v104, v122, 7, v29
v_lshl_add_u32 v108, v123, 7, v29
ds_read_b32 v96, v96
ds_read_b32 v100, v100
ds_read_b32 v104, v104
ds_read_b32 v108, v108
s_waitcnt vmcnt(14) lgkmcnt(4)
s_barrier
ds_read_b128 a[0:3], v24 offset:0
ds_read_b128 a[4:7], v24 offset:2048
s_waitcnt vmcnt(10)
ds_read_b128 a[8:11], v24 offset:4096
buffer_load_dwordx4 v14, s[20:23], s51 offen offset:2048 lds
ds_read_b128 a[12:15], v24 offset:6144
ds_read_b128 a[16:19], v26 offset:0
v_lshl_add_u64 v[124:125], v[44:45], 4, v[40:41]
ds_read_b128 a[20:23], v26 offset:512
v_lshl_add_u64 v[126:127], v[46:47], 4, v[42:43]
ds_read_b128 a[24:27], v26 offset:1024
v_lshl_add_u32 v97, v124, 7, v29
buffer_load_dwordx4 v15, s[20:23], s51 offen offset:3072 lds
ds_read_b128 a[28:31], v26 offset:1536
s_xor_b32 m0, m0, 36864
ds_read_b32 v97, v97
v_lshl_add_u32 v101, v125, 7, v29
s_add_u32 s51, s51, 128
ds_read_b128 a[32:35], v27 offset:0
v_lshl_add_u32 v105, v126, 7, v29
s_cmp_lt_u32 s51, 2048
ds_read_b32 v101, v101
v_lshl_add_u32 v109, v127, 7, v29
s_cselect_b32 s22, 4194304, 0
buffer_load_dwordx4 v[32:35], v16, s[24:27], s50 offen
ds_read_b128 a[36:39], v27 offset:512
s_waitcnt vmcnt(11)
ds_read_b32 v105, v105
ds_read_b128 a[40:43], v27 offset:1024
v_lshl_add_u64 v[120:121], v[52:53], 4, v[48:49]
ds_read_b32 v109, v109
v_lshl_add_u64 v[122:123], v[54:55], 4, v[50:51]
buffer_load_dwordx4 v[36:39], v17, s[24:27], s50 offen
ds_read_b128 a[44:47], v27 offset:1536
ds_read_b128 a[64:67], v26 offset:8192
v_lshl_add_u32 v98, v120, 7, v29
ds_read_b128 a[68:71], v26 offset:8704
v_lshl_add_u32 v102, v121, 7, v29
ds_read_b32 v98, v98
v_lshl_add_u32 v106, v122, 7, v29
buffer_load_dwordx4 v[40:43], v18, s[24:27], s50 offen
ds_read_b128 a[72:75], v26 offset:9216
ds_read_b32 v102, v102
v_lshl_add_u32 v110, v123, 7, v29
s_waitcnt vmcnt(11)
ds_read_b128 a[76:79], v26 offset:9728
ds_read_b32 v106, v106
v_lshl_add_u64 v[124:125], v[60:61], 4, v[56:57]
buffer_load_dwordx4 v[44:47], v19, s[24:27], s50 offen
ds_read_b128 a[80:83], v27 offset:8192
ds_read_b32 v110, v110
v_lshl_add_u64 v[126:127], v[62:63], 4, v[58:59]
ds_read_b128 a[84:87], v27 offset:8704
v_lshl_add_u32 v99, v124, 7, v29
v_lshl_add_u32 v103, v125, 7, v29
buffer_load_dwordx4 v[48:51], v20, s[24:27], s50 offen
ds_read_b32 v99, v99
ds_read_b128 a[88:91], v27 offset:9216
v_lshl_add_u32 v107, v126, 7, v29
ds_read_b32 v103, v103
v_lshl_add_u32 v111, v127, 7, v29
s_waitcnt lgkmcnt(13)
buffer_load_dwordx4 v[52:55], v21, s[24:27], s50 offen
ds_read_b32 v107, v107
s_branch L_ENTRY
.p2align 6
L_LOOP:
v_mfma_f32_16x16x32_bf16 v[128:131], a[48:51], a[64:67], v[128:131]
s_barrier
ds_read_b128 a[0:3], v24 offset:0
v_mfma_f32_16x16x32_bf16 v[160:163], a[52:55], a[64:67], v[160:163]
ds_read_b128 a[4:7], v24 offset:2048
v_mfma_f32_16x16x32_bf16 v[192:195], a[56:59], a[64:67], v[192:195]
s_waitcnt vmcnt(10)
ds_read_b128 a[8:11], v24 offset:4096
v_mfma_f32_16x16x32_bf16 v[224:227], a[60:63], a[64:67], v[224:227]
buffer_load_dwordx4 v14, s[20:23], s51 offen offset:2048 lds
ds_read_b128 a[12:15], v24 offset:6144
v_mfma_f32_16x16x32_bf16 v[228:231], a[60:63], a[68:71], v[228:231]
ds_read_b128 a[16:19], v26 offset:0
v_lshl_add_u64 v[124:125], v[44:45], 4, v[40:41]
v_mfma_f32_16x16x32_bf16 v[196:199], a[56:59], a[68:71], v[196:199]
ds_read_b128 a[20:23], v26 offset:512
v_lshl_add_u64 v[126:127], v[46:47], 4, v[42:43]
v_mfma_f32_16x16x32_bf16 v[164:167], a[52:55], a[68:71], v[164:167]
ds_read_b128 a[24:27], v26 offset:1024
v_lshl_add_u32 v97, v124, 7, v29
v_mfma_f32_16x16x32_bf16 v[132:135], a[48:51], a[68:71], v[132:135]
buffer_load_dwordx4 v15, s[20:23], s51 offen offset:3072 lds
ds_read_b128 a[28:31], v26 offset:1536
v_mfma_f32_16x16x32_bf16 v[136:139], a[48:51], a[72:75], v[136:139]
s_xor_b32 m0, m0, 36864
ds_read_b32 v97, v97
v_lshl_add_u32 v101, v125, 7, v29
v_mfma_f32_16x16x32_bf16 v[168:171], a[52:55], a[72:75], v[168:171]
s_add_u32 s51, s51, 128
ds_read_b128 a[32:35], v27 offset:0
v_lshl_add_u32 v105, v126, 7, v29
v_mfma_f32_16x16x32_bf16 v[200:203], a[56:59], a[72:75], v[200:203]
s_cmp_lt_u32 s51, 2048
ds_read_b32 v101, v101
v_lshl_add_u32 v109, v127, 7, v29
v_mfma_f32_16x16x32_bf16 v[232:235], a[60:63], a[72:75], v[232:235]
s_cselect_b32 s22, 4194304, 0
buffer_load_dwordx4 v[32:35], v16, s[24:27], s50 offen
ds_read_b128 a[36:39], v27 offset:512
v_mfma_f32_16x16x32_bf16 v[236:239], a[60:63], a[76:79], v[236:239]
s_waitcnt vmcnt(11)
ds_read_b32 v105, v105
v_mfma_f32_16x16x32_bf16 v[204:207], a[56:59], a[76:79], v[204:207]
ds_read_b128 a[40:43], v27 offset:1024
v_lshl_add_u64 v[120:121], v[52:53], 4, v[48:49]
v_mfma_f32_16x16x32_bf16 v[172:175], a[52:55], a[76:79], v[172:175]
ds_read_b32 v109, v109
v_lshl_add_u64 v[122:123], v[54:55], 4, v[50:51]
v_mfma_f32_16x16x32_bf16 v[140:143], a[48:51], a[76:79], v[140:143]
buffer_load_dwordx4 v[36:39], v17, s[24:27], s50 offen
ds_read_b128 a[44:47], v27 offset:1536
v_mfma_f32_16x16x32_bf16 v[144:147], a[48:51], a[80:83], v[144:147]
ds_read_b128 a[64:67], v26 offset:8192
v_lshl_add_u32 v98, v120, 7, v29
v_mfma_f32_16x16x32_bf16 v[176:179], a[52:55], a[80:83], v[176:179]
ds_read_b128 a[68:71], v26 offset:8704
v_lshl_add_u32 v102, v121, 7, v29
v_mfma_f32_16x16x32_bf16 v[208:211], a[56:59], a[80:83], v[208:211]
ds_read_b32 v98, v98
v_lshl_add_u32 v106, v122, 7, v29
v_mfma_f32_16x16x32_bf16 v[240:243], a[60:63], a[80:83], v[240:243]
buffer_load_dwordx4 v[40:43], v18, s[24:27], s50 offen
ds_read_b128 a[72:75], v26 offset:9216
v_mfma_f32_16x16x32_bf16 v[244:247], a[60:63], a[84:87], v[244:247]
ds_read_b32 v102, v102
v_lshl_add_u32 v110, v123, 7, v29
v_mfma_f32_16x16x32_bf16 v[212:215], a[56:59], a[84:87], v[212:215]
s_waitcnt vmcnt(11)
ds_read_b128 a[76:79], v26 offset:9728
v_mfma_f32_16x16x32_bf16 v[180:183], a[52:55], a[84:87], v[180:183]
ds_read_b32 v106, v106
v_lshl_add_u64 v[124:125], v[60:61], 4, v[56:57]
v_mfma_f32_16x16x32_bf16 v[148:151], a[48:51], a[84:87], v[148:151]
buffer_load_dwordx4 v[44:47], v19, s[24:27], s50 offen
ds_read_b128 a[80:83], v27 offset:8192
v_mfma_f32_16x16x32_bf16 v[152:155], a[48:51], a[88:91], v[152:155]
ds_read_b32 v110, v110
v_lshl_add_u64 v[126:127], v[62:63], 4, v[58:59]
v_mfma_f32_16x16x32_bf16 v[184:187], a[52:55], a[88:91], v[184:187]
ds_read_b128 a[84:87], v27 offset:8704
v_lshl_add_u32 v99, v124, 7, v29
v_mfma_f32_16x16x32_bf16 v[216:219], a[56:59], a[88:91], v[216:219]
v_lshl_add_u32 v103, v125, 7, v29
v_mfma_f32_16x16x32_bf16 v[248:251], a[60:63], a[88:91], v[248:251]
buffer_load_dwordx4 v[48:51], v20, s[24:27], s50 offen
ds_read_b32 v99, v99
v_mfma_f32_16x16x32_bf16 v[252:255], a[60:63], a[92:95], v[252:255]
ds_read_b128 a[88:91], v27 offset:9216
v_lshl_add_u32 v107, v126, 7, v29
v_mfma_f32_16x16x32_bf16 v[220:223], a[56:59], a[92:95], v[220:223]
ds_read_b32 v103, v103
v_lshl_add_u32 v111, v127, 7, v29
v_mfma_f32_16x16x32_bf16 v[188:191], a[52:55], a[92:95], v[188:191]
s_waitcnt lgkmcnt(13)
v_mfma_f32_16x16x32_bf16 v[156:159], a[48:51], a[92:95], v[156:159]
buffer_load_dwordx4 v[52:55], v21, s[24:27], s50 offen
ds_read_b32 v107, v107
L_ENTRY:
v_mfma_f32_16x16x32_bf16 v[128:131], a[0:3], a[16:19], v[128:131]
ds_read_b128 a[48:51], v25 offset:0
v_mfma_f32_16x16x32_bf16 v[160:163], a[4:7], a[16:19], v[160:163]
ds_read_b32 v111, v111
v_mfma_f32_16x16x32_bf16 v[192:195], a[8:11], a[16:19], v[192:195]
ds_read_b128 a[52:55], v25 offset:2048
v_mfma_f32_16x16x32_bf16 v[224:227], a[12:15], a[16:19], v[224:227]
buffer_load_dwordx4 v[56:59], v22, s[24:27], s50 offen
ds_read_b128 a[56:59], v25 offset:4096
v_mfma_f32_16x16x32_bf16 v[228:231], a[12:15], a[20:23], v[228:231]
ds_read_b128 a[60:63], v25 offset:6144
v_mfma_f32_16x16x32_bf16 v[196:199], a[8:11], a[20:23], v[196:199]
ds_read_b128 a[92:95], v27 offset:9728
v_mfma_f32_16x16x32_bf16 v[164:167], a[4:7], a[20:23], v[164:167]
v_mfma_f32_16x16x32_bf16 v[132:135], a[0:3], a[20:23], v[132:135]
buffer_load_dwordx4 v[60:63], v23, s[24:27], s50 offen
v_mfma_f32_16x16x32_bf16 v[136:139], a[0:3], a[24:27], v[136:139]
s_add_u32 s50, s50, 917504
v_mfma_f32_16x16x32_bf16 v[168:171], a[4:7], a[24:27], v[168:171]
s_waitcnt lgkmcnt(1)
v_mfma_f32_16x16x32_bf16 v[200:203], a[8:11], a[24:27], v[200:203]
ds_write_b128 v30, v[96:99] offset:16384
v_mfma_f32_16x16x32_bf16 v[232:235], a[12:15], a[24:27], v[232:235]
buffer_load_dwordx4 v8, s[20:23], s51 offen offset:0 lds
v_mfma_f32_16x16x32_bf16 v[236:239], a[12:15], a[28:31], v[236:239]
v_mfma_f32_16x16x32_bf16 v[204:207], a[8:11], a[28:31], v[204:207]
v_mfma_f32_16x16x32_bf16 v[172:175], a[4:7], a[28:31], v[172:175]
ds_write_b128 v30, v[100:103] offset:16896
v_mfma_f32_16x16x32_bf16 v[140:143], a[0:3], a[28:31], v[140:143]
buffer_load_dwordx4 v9, s[20:23], s51 offen offset:1024 lds
v_mfma_f32_16x16x32_bf16 v[144:147], a[0:3], a[32:35], v[144:147]
v_mfma_f32_16x16x32_bf16 v[176:179], a[4:7], a[32:35], v[176:179]
v_mfma_f32_16x16x32_bf16 v[208:211], a[8:11], a[32:35], v[208:211]
ds_write_b128 v30, v[104:107] offset:17408
v_mfma_f32_16x16x32_bf16 v[240:243], a[12:15], a[32:35], v[240:243]
s_waitcnt vmcnt(8)
buffer_load_dwordx4 v10, s[20:23], s51 offen offset:2048 lds
v_mfma_f32_16x16x32_bf16 v[244:247], a[12:15], a[36:39], v[244:247]
v_lshl_add_u64 v[120:121], v[36:37], 4, v[32:33]
v_lshl_add_u64 v[122:123], v[38:39], 4, v[34:35]
v_mfma_f32_16x16x32_bf16 v[212:215], a[8:11], a[36:39], v[212:215]
v_mfma_f32_16x16x32_bf16 v[180:183], a[4:7], a[36:39], v[180:183]
ds_write_b128 v30, v[108:111] offset:17920
v_mfma_f32_16x16x32_bf16 v[148:151], a[0:3], a[36:39], v[148:151]
buffer_load_dwordx4 v11, s[20:23], s51 offen offset:3072 lds
v_lshl_add_u32 v96, v120, 7, v29
v_mfma_f32_16x16x32_bf16 v[152:155], a[0:3], a[40:43], v[152:155]
s_xor_b32 m0, m0, 0x1000
v_lshl_add_u32 v100, v121, 7, v29
v_mfma_f32_16x16x32_bf16 v[184:187], a[4:7], a[40:43], v[184:187]
v_lshl_add_u32 v104, v122, 7, v29
v_mfma_f32_16x16x32_bf16 v[216:219], a[8:11], a[40:43], v[216:219]
v_lshl_add_u32 v108, v123, 7, v29
v_mfma_f32_16x16x32_bf16 v[248:251], a[12:15], a[40:43], v[248:251]
buffer_load_dwordx4 v12, s[20:23], s51 offen offset:0 lds
ds_read_b32 v96, v96
v_mfma_f32_16x16x32_bf16 v[252:255], a[12:15], a[44:47], v[252:255]
ds_read_b32 v100, v100
v_mfma_f32_16x16x32_bf16 v[220:223], a[8:11], a[44:47], v[220:223]
ds_read_b32 v104, v104
v_mfma_f32_16x16x32_bf16 v[188:191], a[4:7], a[44:47], v[188:191]
s_waitcnt vmcnt(13) lgkmcnt(3)
ds_read_b32 v108, v108
v_mfma_f32_16x16x32_bf16 v[156:159], a[0:3], a[44:47], v[156:159]
buffer_load_dwordx4 v13, s[20:23], s51 offen offset:1024 lds
v_mfma_f32_16x16x32_bf16 v[128:131], a[48:51], a[64:67], v[128:131]
s_barrier
ds_read_b128 a[0:3], v24 offset:32768
v_mfma_f32_16x16x32_bf16 v[160:163], a[52:55], a[64:67], v[160:163]
ds_read_b128 a[4:7], v24 offset:34816
v_mfma_f32_16x16x32_bf16 v[192:195], a[56:59], a[64:67], v[192:195]
s_waitcnt vmcnt(10)
ds_read_b128 a[8:11], v24 offset:36864
v_mfma_f32_16x16x32_bf16 v[224:227], a[60:63], a[64:67], v[224:227]
buffer_load_dwordx4 v14, s[20:23], s51 offen offset:2048 lds
ds_read_b128 a[12:15], v24 offset:38912
v_mfma_f32_16x16x32_bf16 v[228:231], a[60:63], a[68:71], v[228:231]
ds_read_b128 a[16:19], v26 offset:16384
v_lshl_add_u64 v[124:125], v[44:45], 4, v[40:41]
v_mfma_f32_16x16x32_bf16 v[196:199], a[56:59], a[68:71], v[196:199]
ds_read_b128 a[20:23], v26 offset:16896
v_lshl_add_u64 v[126:127], v[46:47], 4, v[42:43]
v_mfma_f32_16x16x32_bf16 v[164:167], a[52:55], a[68:71], v[164:167]
ds_read_b128 a[24:27], v26 offset:17408
v_lshl_add_u32 v97, v124, 7, v29
v_mfma_f32_16x16x32_bf16 v[132:135], a[48:51], a[68:71], v[132:135]
buffer_load_dwordx4 v15, s[20:23], s51 offen offset:3072 lds
ds_read_b128 a[28:31], v26 offset:17920
v_mfma_f32_16x16x32_bf16 v[136:139], a[48:51], a[72:75], v[136:139]
s_xor_b32 m0, m0, 36864
ds_read_b32 v97, v97
v_lshl_add_u32 v101, v125, 7, v29
v_mfma_f32_16x16x32_bf16 v[168:171], a[52:55], a[72:75], v[168:171]
s_add_u32 s51, s51, 128
ds_read_b128 a[32:35], v27 offset:16384
v_lshl_add_u32 v105, v126, 7, v29
v_mfma_f32_16x16x32_bf16 v[200:203], a[56:59], a[72:75], v[200:203]
ds_read_b32 v101, v101
v_lshl_add_u32 v109, v127, 7, v29
v_mfma_f32_16x16x32_bf16 v[232:235], a[60:63], a[72:75], v[232:235]
buffer_load_dwordx4 v[32:35], v16, s[24:27], s50 offen
ds_read_b128 a[36:39], v27 offset:16896
v_mfma_f32_16x16x32_bf16 v[236:239], a[60:63], a[76:79], v[236:239]
s_waitcnt vmcnt(11)
ds_read_b32 v105, v105
v_mfma_f32_16x16x32_bf16 v[204:207], a[56:59], a[76:79], v[204:207]
ds_read_b128 a[40:43], v27 offset:17408
v_lshl_add_u64 v[120:121], v[52:53], 4, v[48:49]
v_mfma_f32_16x16x32_bf16 v[172:175], a[52:55], a[76:79], v[172:175]
ds_read_b32 v109, v109
v_lshl_add_u64 v[122:123], v[54:55], 4, v[50:51]
v_mfma_f32_16x16x32_bf16 v[140:143], a[48:51], a[76:79], v[140:143]
buffer_load_dwordx4 v[36:39], v17, s[24:27], s50 offen
ds_read_b128 a[44:47], v27 offset:17920
v_mfma_f32_16x16x32_bf16 v[144:147], a[48:51], a[80:83], v[144:147]
ds_read_b128 a[64:67], v26 offset:24576
v_lshl_add_u32 v98, v120, 7, v29
v_mfma_f32_16x16x32_bf16 v[176:179], a[52:55], a[80:83], v[176:179]
ds_read_b128 a[68:71], v26 offset:25088
v_lshl_add_u32 v102, v121, 7, v29
v_mfma_f32_16x16x32_bf16 v[208:211], a[56:59], a[80:83], v[208:211]
ds_read_b32 v98, v98
v_lshl_add_u32 v106, v122, 7, v29
v_mfma_f32_16x16x32_bf16 v[240:243], a[60:63], a[80:83], v[240:243]
buffer_load_dwordx4 v[40:43], v18, s[24:27], s50 offen
ds_read_b128 a[72:75], v26 offset:25600
v_mfma_f32_16x16x32_bf16 v[244:247], a[60:63], a[84:87], v[244:247]
ds_read_b32 v102, v102
v_lshl_add_u32 v110, v123, 7, v29
v_mfma_f32_16x16x32_bf16 v[212:215], a[56:59], a[84:87], v[212:215]
s_waitcnt vmcnt(11)
ds_read_b128 a[76:79], v26 offset:26112
v_mfma_f32_16x16x32_bf16 v[180:183], a[52:55], a[84:87], v[180:183]
ds_read_b32 v106, v106
v_lshl_add_u64 v[124:125], v[60:61], 4, v[56:57]
v_mfma_f32_16x16x32_bf16 v[148:151], a[48:51], a[84:87], v[148:151]
buffer_load_dwordx4 v[44:47], v19, s[24:27], s50 offen
ds_read_b128 a[80:83], v27 offset:24576
v_mfma_f32_16x16x32_bf16 v[152:155], a[48:51], a[88:91], v[152:155]
ds_read_b32 v110, v110
v_lshl_add_u64 v[126:127], v[62:63], 4, v[58:59]
v_mfma_f32_16x16x32_bf16 v[184:187], a[52:55], a[88:91], v[184:187]
ds_read_b128 a[84:87], v27 offset:25088
v_lshl_add_u32 v99, v124, 7, v29
v_mfma_f32_16x16x32_bf16 v[216:219], a[56:59], a[88:91], v[216:219]
v_lshl_add_u32 v103, v125, 7, v29
v_mfma_f32_16x16x32_bf16 v[248:251], a[60:63], a[88:91], v[248:251]
buffer_load_dwordx4 v[48:51], v20, s[24:27], s50 offen
ds_read_b32 v99, v99
v_mfma_f32_16x16x32_bf16 v[252:255], a[60:63], a[92:95], v[252:255]
ds_read_b128 a[88:91], v27 offset:25600
v_lshl_add_u32 v107, v126, 7, v29
v_mfma_f32_16x16x32_bf16 v[220:223], a[56:59], a[92:95], v[220:223]
ds_read_b32 v103, v103
v_lshl_add_u32 v111, v127, 7, v29
v_mfma_f32_16x16x32_bf16 v[188:191], a[52:55], a[92:95], v[188:191]
s_waitcnt lgkmcnt(13)
v_mfma_f32_16x16x32_bf16 v[156:159], a[48:51], a[92:95], v[156:159]
buffer_load_dwordx4 v[52:55], v21, s[24:27], s50 offen
ds_read_b32 v107, v107
v_mfma_f32_16x16x32_bf16 v[128:131], a[0:3], a[16:19], v[128:131]
ds_read_b128 a[48:51], v25 offset:32768
v_mfma_f32_16x16x32_bf16 v[160:163], a[4:7], a[16:19], v[160:163]
ds_read_b32 v111, v111
v_mfma_f32_16x16x32_bf16 v[192:195], a[8:11], a[16:19], v[192:195]
ds_read_b128 a[52:55], v25 offset:34816
v_mfma_f32_16x16x32_bf16 v[224:227], a[12:15], a[16:19], v[224:227]
buffer_load_dwordx4 v[56:59], v22, s[24:27], s50 offen
ds_read_b128 a[56:59], v25 offset:36864
v_mfma_f32_16x16x32_bf16 v[228:231], a[12:15], a[20:23], v[228:231]
ds_read_b128 a[60:63], v25 offset:38912
v_mfma_f32_16x16x32_bf16 v[196:199], a[8:11], a[20:23], v[196:199]
ds_read_b128 a[92:95], v27 offset:26112
v_mfma_f32_16x16x32_bf16 v[164:167], a[4:7], a[20:23], v[164:167]
v_mfma_f32_16x16x32_bf16 v[132:135], a[0:3], a[20:23], v[132:135]
buffer_load_dwordx4 v[60:63], v23, s[24:27], s50 offen
v_mfma_f32_16x16x32_bf16 v[136:139], a[0:3], a[24:27], v[136:139]
s_add_u32 s50, s50, 917504
v_mfma_f32_16x16x32_bf16 v[168:171], a[4:7], a[24:27], v[168:171]
s_waitcnt lgkmcnt(1)
v_mfma_f32_16x16x32_bf16 v[200:203], a[8:11], a[24:27], v[200:203]
ds_write_b128 v30, v[96:99] offset:0
v_mfma_f32_16x16x32_bf16 v[232:235], a[12:15], a[24:27], v[232:235]
buffer_load_dwordx4 v8, s[20:23], s51 offen offset:0 lds
v_mfma_f32_16x16x32_bf16 v[236:239], a[12:15], a[28:31], v[236:239]
v_mfma_f32_16x16x32_bf16 v[204:207], a[8:11], a[28:31], v[204:207]
v_mfma_f32_16x16x32_bf16 v[172:175], a[4:7], a[28:31], v[172:175]
ds_write_b128 v30, v[100:103] offset:512
v_mfma_f32_16x16x32_bf16 v[140:143], a[0:3], a[28:31], v[140:143]
buffer_load_dwordx4 v9, s[20:23], s51 offen offset:1024 lds
v_mfma_f32_16x16x32_bf16 v[144:147], a[0:3], a[32:35], v[144:147]
v_mfma_f32_16x16x32_bf16 v[176:179], a[4:7], a[32:35], v[176:179]
v_mfma_f32_16x16x32_bf16 v[208:211], a[8:11], a[32:35], v[208:211]
ds_write_b128 v30, v[104:107] offset:1024
v_mfma_f32_16x16x32_bf16 v[240:243], a[12:15], a[32:35], v[240:243]
s_waitcnt vmcnt(8)
buffer_load_dwordx4 v10, s[20:23], s51 offen offset:2048 lds
v_mfma_f32_16x16x32_bf16 v[244:247], a[12:15], a[36:39], v[244:247]
v_lshl_add_u64 v[120:121], v[36:37], 4, v[32:33]
v_lshl_add_u64 v[122:123], v[38:39], 4, v[34:35]
v_mfma_f32_16x16x32_bf16 v[212:215], a[8:11], a[36:39], v[212:215]
v_mfma_f32_16x16x32_bf16 v[180:183], a[4:7], a[36:39], v[180:183]
ds_write_b128 v30, v[108:111] offset:1536
v_mfma_f32_16x16x32_bf16 v[148:151], a[0:3], a[36:39], v[148:151]
buffer_load_dwordx4 v11, s[20:23], s51 offen offset:3072 lds
v_lshl_add_u32 v96, v120, 7, v29
v_mfma_f32_16x16x32_bf16 v[152:155], a[0:3], a[40:43], v[152:155]
s_xor_b32 m0, m0, 0x1000
v_lshl_add_u32 v100, v121, 7, v29
v_mfma_f32_16x16x32_bf16 v[184:187], a[4:7], a[40:43], v[184:187]
s_cmp_lt_u32 s51, 2176
v_lshl_add_u32 v104, v122, 7, v29
v_mfma_f32_16x16x32_bf16 v[216:219], a[8:11], a[40:43], v[216:219]
v_lshl_add_u32 v108, v123, 7, v29
v_mfma_f32_16x16x32_bf16 v[248:251], a[12:15], a[40:43], v[248:251]
buffer_load_dwordx4 v12, s[20:23], s51 offen offset:0 lds
ds_read_b32 v96, v96
v_mfma_f32_16x16x32_bf16 v[252:255], a[12:15], a[44:47], v[252:255]
ds_read_b32 v100, v100
v_mfma_f32_16x16x32_bf16 v[220:223], a[8:11], a[44:47], v[220:223]
ds_read_b32 v104, v104
v_mfma_f32_16x16x32_bf16 v[188:191], a[4:7], a[44:47], v[188:191]
s_waitcnt vmcnt(13) lgkmcnt(3)
ds_read_b32 v108, v108
v_mfma_f32_16x16x32_bf16 v[156:159], a[0:3], a[44:47], v[156:159]
buffer_load_dwordx4 v13, s[20:23], s51 offen offset:1024 lds
s_cbranch_scc1 L_LOOP
global_load_dwordx4 v[112:115], v118, s[10:11]
v_mfma_f32_16x16x32_bf16 v[128:131], a[48:51], a[64:67], v[128:131]
v_mfma_f32_16x16x32_bf16 v[132:135], a[48:51], a[68:71], v[132:135]
v_mfma_f32_16x16x32_bf16 v[136:139], a[48:51], a[72:75], v[136:139]
v_mfma_f32_16x16x32_bf16 v[140:143], a[48:51], a[76:79], v[140:143]
v_mfma_f32_16x16x32_bf16 v[144:147], a[48:51], a[80:83], v[144:147]
v_mfma_f32_16x16x32_bf16 v[148:151], a[48:51], a[84:87], v[148:151]
v_mfma_f32_16x16x32_bf16 v[152:155], a[48:51], a[88:91], v[152:155]
v_mfma_f32_16x16x32_bf16 v[156:159], a[48:51], a[92:95], v[156:159]
v_mfma_f32_16x16x32_bf16 v[160:163], a[52:55], a[64:67], v[160:163]
v_mfma_f32_16x16x32_bf16 v[164:167], a[52:55], a[68:71], v[164:167]
v_mfma_f32_16x16x32_bf16 v[168:171], a[52:55], a[72:75], v[168:171]
v_mfma_f32_16x16x32_bf16 v[172:175], a[52:55], a[76:79], v[172:175]
v_mfma_f32_16x16x32_bf16 v[176:179], a[52:55], a[80:83], v[176:179]
v_mfma_f32_16x16x32_bf16 v[180:183], a[52:55], a[84:87], v[180:183]
v_mfma_f32_16x16x32_bf16 v[184:187], a[52:55], a[88:91], v[184:187]
v_mfma_f32_16x16x32_bf16 v[188:191], a[52:55], a[92:95], v[188:191]
v_mfma_f32_16x16x32_bf16 v[192:195], a[56:59], a[64:67], v[192:195]
v_mfma_f32_16x16x32_bf16 v[196:199], a[56:59], a[68:71], v[196:199]
v_mfma_f32_16x16x32_bf16 v[200:203], a[56:59], a[72:75], v[200:203]
v_mfma_f32_16x16x32_bf16 v[204:207], a[56:59], a[76:79], v[204:207]
v_mfma_f32_16x16x32_bf16 v[208:211], a[56:59], a[80:83], v[208:211]
v_mfma_f32_16x16x32_bf16 v[212:215], a[56:59], a[84:87], v[212:215]
v_mfma_f32_16x16x32_bf16 v[216:219], a[56:59], a[88:91], v[216:219]
v_mfma_f32_16x16x32_bf16 v[220:223], a[56:59], a[92:95], v[220:223]
v_mfma_f32_16x16x32_bf16 v[224:227], a[60:63], a[64:67], v[224:227]
v_mfma_f32_16x16x32_bf16 v[228:231], a[60:63], a[68:71], v[228:231]
v_mfma_f32_16x16x32_bf16 v[232:235], a[60:63], a[72:75], v[232:235]
v_mfma_f32_16x16x32_bf16 v[236:239], a[60:63], a[76:79], v[236:239]
v_mfma_f32_16x16x32_bf16 v[240:243], a[60:63], a[80:83], v[240:243]
v_mfma_f32_16x16x32_bf16 v[244:247], a[60:63], a[84:87], v[244:247]
v_mfma_f32_16x16x32_bf16 v[248:251], a[60:63], a[88:91], v[248:251]
v_mfma_f32_16x16x32_bf16 v[252:255], a[60:63], a[92:95], v[252:255]
s_waitcnt vmcnt(0) lgkmcnt(0)
v_lshlrev_b32 v32, 16, v112
v_and_b32 v33, 0xffff0000, v112
v_lshlrev_b32 v34, 16, v113
v_and_b32 v35, 0xffff0000, v113
v_lshlrev_b32 v36, 16, v114
v_and_b32 v37, 0xffff0000, v114
v_lshlrev_b32 v38, 16, v115
v_and_b32 v39, 0xffff0000, v115
v_pk_mul_f32 v[128:129], v[128:129], v[32:33] op_sel:[0,0] op_sel_hi:[1,0]
v_pk_mul_f32 v[132:133], v[132:133], v[32:33] op_sel:[0,1] op_sel_hi:[1,1]
v_pk_mul_f32 v[136:137], v[136:137], v[34:35] op_sel:[0,0] op_sel_hi:[1,0]
v_pk_mul_f32 v[140:141], v[140:141], v[34:35] op_sel:[0,1] op_sel_hi:[1,1]
v_pk_mul_f32 v[144:145], v[144:145], v[36:37] op_sel:[0,0] op_sel_hi:[1,0]
v_pk_mul_f32 v[148:149], v[148:149], v[36:37] op_sel:[0,1] op_sel_hi:[1,1]
v_pk_mul_f32 v[152:153], v[152:153], v[38:39] op_sel:[0,0] op_sel_hi:[1,0]
v_pk_mul_f32 v[156:157], v[156:157], v[38:39] op_sel:[0,1] op_sel_hi:[1,1]
v_cvt_pk_bf16_f32 v64, v128, v132
v_cvt_pk_bf16_f32 v65, v136, v140
v_cvt_pk_bf16_f32 v66, v144, v148
v_cvt_pk_bf16_f32 v67, v152, v156
s_mov_b32 s56, 0
buffer_store_dwordx4 v[64:67], v28, s[28:31], s56 offen nt
v_cvt_pk_bf16_f32 v68, v129, v133
v_cvt_pk_bf16_f32 v69, v137, v141
v_cvt_pk_bf16_f32 v70, v145, v149
v_cvt_pk_bf16_f32 v71, v153, v157
s_mov_b32 s56, 7168
buffer_store_dwordx4 v[68:71], v28, s[28:31], s56 offen nt
v_pk_mul_f32 v[130:131], v[130:131], v[32:33] op_sel:[0,0] op_sel_hi:[1,0]
v_pk_mul_f32 v[134:135], v[134:135], v[32:33] op_sel:[0,1] op_sel_hi:[1,1]
v_pk_mul_f32 v[138:139], v[138:139], v[34:35] op_sel:[0,0] op_sel_hi:[1,0]
v_pk_mul_f32 v[142:143], v[142:143], v[34:35] op_sel:[0,1] op_sel_hi:[1,1]
v_pk_mul_f32 v[146:147], v[146:147], v[36:37] op_sel:[0,0] op_sel_hi:[1,0]
v_pk_mul_f32 v[150:151], v[150:151], v[36:37] op_sel:[0,1] op_sel_hi:[1,1]
v_pk_mul_f32 v[154:155], v[154:155], v[38:39] op_sel:[0,0] op_sel_hi:[1,0]
v_pk_mul_f32 v[158:159], v[158:159], v[38:39] op_sel:[0,1] op_sel_hi:[1,1]
v_cvt_pk_bf16_f32 v72, v130, v134
v_cvt_pk_bf16_f32 v73, v138, v142
v_cvt_pk_bf16_f32 v74, v146, v150
v_cvt_pk_bf16_f32 v75, v154, v158
s_mov_b32 s56, 14336
buffer_store_dwordx4 v[72:75], v28, s[28:31], s56 offen nt
v_cvt_pk_bf16_f32 v76, v131, v135
v_cvt_pk_bf16_f32 v77, v139, v143
v_cvt_pk_bf16_f32 v78, v147, v151
v_cvt_pk_bf16_f32 v79, v155, v159
s_mov_b32 s56, 21504
buffer_store_dwordx4 v[76:79], v28, s[28:31], s56 offen nt
v_pk_mul_f32 v[160:161], v[160:161], v[32:33] op_sel:[0,0] op_sel_hi:[1,0]
v_pk_mul_f32 v[164:165], v[164:165], v[32:33] op_sel:[0,1] op_sel_hi:[1,1]
v_pk_mul_f32 v[168:169], v[168:169], v[34:35] op_sel:[0,0] op_sel_hi:[1,0]
v_pk_mul_f32 v[172:173], v[172:173], v[34:35] op_sel:[0,1] op_sel_hi:[1,1]
v_pk_mul_f32 v[176:177], v[176:177], v[36:37] op_sel:[0,0] op_sel_hi:[1,0]
v_pk_mul_f32 v[180:181], v[180:181], v[36:37] op_sel:[0,1] op_sel_hi:[1,1]
v_pk_mul_f32 v[184:185], v[184:185], v[38:39] op_sel:[0,0] op_sel_hi:[1,0]
v_pk_mul_f32 v[188:189], v[188:189], v[38:39] op_sel:[0,1] op_sel_hi:[1,1]
v_cvt_pk_bf16_f32 v80, v160, v164
v_cvt_pk_bf16_f32 v81, v168, v172
v_cvt_pk_bf16_f32 v82, v176, v180
v_cvt_pk_bf16_f32 v83, v184, v188
s_mov_b32 s56, 114688
buffer_store_dwordx4 v[80:83], v28, s[28:31], s56 offen nt
v_cvt_pk_bf16_f32 v84, v161, v165
v_cvt_pk_bf16_f32 v85, v169, v173
v_cvt_pk_bf16_f32 v86, v177, v181
v_cvt_pk_bf16_f32 v87, v185, v189
s_mov_b32 s56, 121856
buffer_store_dwordx4 v[84:87], v28, s[28:31], s56 offen nt
v_pk_mul_f32 v[162:163], v[162:163], v[32:33] op_sel:[0,0] op_sel_hi:[1,0]
v_pk_mul_f32 v[166:167], v[166:167], v[32:33] op_sel:[0,1] op_sel_hi:[1,1]
v_pk_mul_f32 v[170:171], v[170:171], v[34:35] op_sel:[0,0] op_sel_hi:[1,0]
v_pk_mul_f32 v[174:175], v[174:175], v[34:35] op_sel:[0,1] op_sel_hi:[1,1]
v_pk_mul_f32 v[178:179], v[178:179], v[36:37] op_sel:[0,0] op_sel_hi:[1,0]
v_pk_mul_f32 v[182:183], v[182:183], v[36:37] op_sel:[0,1] op_sel_hi:[1,1]
v_pk_mul_f32 v[186:187], v[186:187], v[38:39] op_sel:[0,0] op_sel_hi:[1,0]
v_pk_mul_f32 v[190:191], v[190:191], v[38:39] op_sel:[0,1] op_sel_hi:[1,1]
v_cvt_pk_bf16_f32 v88, v162, v166
v_cvt_pk_bf16_f32 v89, v170, v174
v_cvt_pk_bf16_f32 v90, v178, v182
v_cvt_pk_bf16_f32 v91, v186, v190
s_mov_b32 s56, 129024
buffer_store_dwordx4 v[88:91], v28, s[28:31], s56 offen nt
v_cvt_pk_bf16_f32 v92, v163, v167
v_cvt_pk_bf16_f32 v93, v171, v175
v_cvt_pk_bf16_f32 v94, v179, v183
v_cvt_pk_bf16_f32 v95, v187, v191
s_mov_b32 s56, 136192
buffer_store_dwordx4 v[92:95], v28, s[28:31], s56 offen nt
v_pk_mul_f32 v[192:193], v[192:193], v[32:33] op_sel:[0,0] op_sel_hi:[1,0]
v_pk_mul_f32 v[196:197], v[196:197], v[32:33] op_sel:[0,1] op_sel_hi:[1,1]
v_pk_mul_f32 v[200:201], v[200:201], v[34:35] op_sel:[0,0] op_sel_hi:[1,0]
v_pk_mul_f32 v[204:205], v[204:205], v[34:35] op_sel:[0,1] op_sel_hi:[1,1]
v_pk_mul_f32 v[208:209], v[208:209], v[36:37] op_sel:[0,0] op_sel_hi:[1,0]
v_pk_mul_f32 v[212:213], v[212:213], v[36:37] op_sel:[0,1] op_sel_hi:[1,1]
v_pk_mul_f32 v[216:217], v[216:217], v[38:39] op_sel:[0,0] op_sel_hi:[1,0]
v_pk_mul_f32 v[220:221], v[220:221], v[38:39] op_sel:[0,1] op_sel_hi:[1,1]
v_cvt_pk_bf16_f32 v64, v192, v196
v_cvt_pk_bf16_f32 v65, v200, v204
v_cvt_pk_bf16_f32 v66, v208, v212
v_cvt_pk_bf16_f32 v67, v216, v220
s_mov_b32 s56, 229376
buffer_store_dwordx4 v[64:67], v28, s[28:31], s56 offen nt
v_cvt_pk_bf16_f32 v68, v193, v197
v_cvt_pk_bf16_f32 v69, v201, v205
v_cvt_pk_bf16_f32 v70, v209, v213
v_cvt_pk_bf16_f32 v71, v217, v221
s_mov_b32 s56, 236544
buffer_store_dwordx4 v[68:71], v28, s[28:31], s56 offen nt
v_pk_mul_f32 v[194:195], v[194:195], v[32:33] op_sel:[0,0] op_sel_hi:[1,0]
v_pk_mul_f32 v[198:199], v[198:199], v[32:33] op_sel:[0,1] op_sel_hi:[1,1]
v_pk_mul_f32 v[202:203], v[202:203], v[34:35] op_sel:[0,0] op_sel_hi:[1,0]
v_pk_mul_f32 v[206:207], v[206:207], v[34:35] op_sel:[0,1] op_sel_hi:[1,1]
v_pk_mul_f32 v[210:211], v[210:211], v[36:37] op_sel:[0,0] op_sel_hi:[1,0]
v_pk_mul_f32 v[214:215], v[214:215], v[36:37] op_sel:[0,1] op_sel_hi:[1,1]
v_pk_mul_f32 v[218:219], v[218:219], v[38:39] op_sel:[0,0] op_sel_hi:[1,0]
v_pk_mul_f32 v[222:223], v[222:223], v[38:39] op_sel:[0,1] op_sel_hi:[1,1]
v_cvt_pk_bf16_f32 v72, v194, v198
v_cvt_pk_bf16_f32 v73, v202, v206
v_cvt_pk_bf16_f32 v74, v210, v214
v_cvt_pk_bf16_f32 v75, v218, v222
s_mov_b32 s56, 243712
buffer_store_dwordx4 v[72:75], v28, s[28:31], s56 offen nt
v_cvt_pk_bf16_f32 v76, v195, v199
v_cvt_pk_bf16_f32 v77, v203, v207
v_cvt_pk_bf16_f32 v78, v211, v215
v_cvt_pk_bf16_f32 v79, v219, v223
s_mov_b32 s56, 250880
buffer_store_dwordx4 v[76:79], v28, s[28:31], s56 offen nt
v_pk_mul_f32 v[224:225], v[224:225], v[32:33] op_sel:[0,0] op_sel_hi:[1,0]
v_pk_mul_f32 v[228:229], v[228:229], v[32:33] op_sel:[0,1] op_sel_hi:[1,1]
v_pk_mul_f32 v[232:233], v[232:233], v[34:35] op_sel:[0,0] op_sel_hi:[1,0]
v_pk_mul_f32 v[236:237], v[236:237], v[34:35] op_sel:[0,1] op_sel_hi:[1,1]
v_pk_mul_f32 v[240:241], v[240:241], v[36:37] op_sel:[0,0] op_sel_hi:[1,0]
v_pk_mul_f32 v[244:245], v[244:245], v[36:37] op_sel:[0,1] op_sel_hi:[1,1]
v_pk_mul_f32 v[248:249], v[248:249], v[38:39] op_sel:[0,0] op_sel_hi:[1,0]
v_pk_mul_f32 v[252:253], v[252:253], v[38:39] op_sel:[0,1] op_sel_hi:[1,1]
v_cvt_pk_bf16_f32 v80, v224, v228
v_cvt_pk_bf16_f32 v81, v232, v236
v_cvt_pk_bf16_f32 v82, v240, v244
v_cvt_pk_bf16_f32 v83, v248, v252
s_mov_b32 s56, 344064
buffer_store_dwordx4 v[80:83], v28, s[28:31], s56 offen nt
v_cvt_pk_bf16_f32 v84, v225, v229
v_cvt_pk_bf16_f32 v85, v233, v237
v_cvt_pk_bf16_f32 v86, v241, v245
v_cvt_pk_bf16_f32 v87, v249, v253
s_mov_b32 s56, 351232
buffer_store_dwordx4 v[84:87], v28, s[28:31], s56 offen nt
v_pk_mul_f32 v[226:227], v[226:227], v[32:33] op_sel:[0,0] op_sel_hi:[1,0]
v_pk_mul_f32 v[230:231], v[230:231], v[32:33] op_sel:[0,1] op_sel_hi:[1,1]
v_pk_mul_f32 v[234:235], v[234:235], v[34:35] op_sel:[0,0] op_sel_hi:[1,0]
v_pk_mul_f32 v[238:239], v[238:239], v[34:35] op_sel:[0,1] op_sel_hi:[1,1]
v_pk_mul_f32 v[242:243], v[242:243], v[36:37] op_sel:[0,0] op_sel_hi:[1,0]
v_pk_mul_f32 v[246:247], v[246:247], v[36:37] op_sel:[0,1] op_sel_hi:[1,1]
v_pk_mul_f32 v[250:251], v[250:251], v[38:39] op_sel:[0,0] op_sel_hi:[1,0]
v_pk_mul_f32 v[254:255], v[254:255], v[38:39] op_sel:[0,1] op_sel_hi:[1,1]
v_cvt_pk_bf16_f32 v88, v226, v230
v_cvt_pk_bf16_f32 v89, v234, v238
v_cvt_pk_bf16_f32 v90, v242, v246
v_cvt_pk_bf16_f32 v91, v250, v254
s_mov_b32 s56, 358400
buffer_store_dwordx4 v[88:91], v28, s[28:31], s56 offen nt
v_cvt_pk_bf16_f32 v92, v227, v231
v_cvt_pk_bf16_f32 v93, v235, v239
v_cvt_pk_bf16_f32 v94, v243, v247
v_cvt_pk_bf16_f32 v95, v251, v255
s_mov_b32 s56, 365568
buffer_store_dwordx4 v[92:95], v28, s[28:31], s56 offen nt
s_endpgm
L_HELPER:
s_add_u32 s41, s41, 4
s_lshl2_add_u32 s41, s41, s36
v_min_u32 v2, 55, v0
v_cmp_lt_u32 vcc, 27, v2
v_lshlrev_b32 v2, 7, v2
v_mov_b32 v3, 10752
v_cndmask_b32 v3, 0, v3, vcc
v_add_u32 v2, v2, v3
s_lshl_b32 s45, s42, 4
s_add_u32 s45, s45, s41
s_mul_i32 s45, s45, 28672
s_mul_i32 s46, s43, 3584
s_add_u32 s45, s45, s46
v_add_u32 v2, s45, v2
v_lshrrev_b32 v3, 2, v0
v_and_b32 v4, 3, v0
v_lshlrev_b32 v3, 11, v3
v_lshl_add_u32 v3, v4, 7, v3
s_lshl2_add_u32 s45, s42, s43
s_lshl4_add_u32 s45, s45, s41
s_lshl_b32 s45, s45, 15
v_add_u32 v3, s45, v3
s_waitcnt lgkmcnt(0)
s_mov_b32 s24, s6
s_mov_b32 s25, s7
s_mov_b32 s20, s4
s_mov_b32 s21, s5
buffer_load_dword v8, v3, s[20:23], 0 offen offset:0
s_mov_b32 s50, 917504
buffer_load_dword v9, v2, s[24:27], s50 offen
s_mov_b32 s50, 1835008
buffer_load_dword v10, v2, s[24:27], s50 offen
s_mov_b32 s50, 2752512
buffer_load_dword v11, v2, s[24:27], s50 offen
buffer_load_dword v12, v3, s[20:23], 0 offen offset:512
s_mov_b32 s50, 3670016
buffer_load_dword v13, v2, s[24:27], s50 offen
s_mov_b32 s50, 4587520
buffer_load_dword v14, v2, s[24:27], s50 offen
s_mov_b32 s50, 5505024
buffer_load_dword v15, v2, s[24:27], s50 offen
s_mov_b32 s50, 6422528
buffer_load_dword v16, v2, s[24:27], s50 offen
buffer_load_dword v17, v3, s[20:23], 0 offen offset:1024
s_mov_b32 s50, 7340032
buffer_load_dword v18, v2, s[24:27], s50 offen
s_mov_b32 s50, 8257536
buffer_load_dword v19, v2, s[24:27], s50 offen
s_mov_b32 s50, 9175040
buffer_load_dword v20, v2, s[24:27], s50 offen
s_mov_b32 s50, 10092544
buffer_load_dword v21, v2, s[24:27], s50 offen
buffer_load_dword v22, v3, s[20:23], 0 offen offset:1536
s_mov_b32 s50, 11010048
buffer_load_dword v23, v2, s[24:27], s50 offen
s_mov_b32 s50, 11927552
buffer_load_dword v24, v2, s[24:27], s50 offen
s_mov_b32 s50, 12845056
buffer_load_dword v25, v2, s[24:27], s50 offen
s_mov_b32 s50, 13762560
buffer_load_dword v26, v2, s[24:27], s50 offen
s_waitcnt vmcnt(0)
L_END:
s_endpgm
.section .rodata,"a"
.p2align 6
.amdhsa_kernel standalone__normalfloat_lut_af4__prompt_kernel
  .amdhsa_next_free_vgpr 352
  .amdhsa_next_free_sgpr 102
  .amdhsa_accum_offset 256
  .amdhsa_group_segment_fixed_size 0
  .amdhsa_kernarg_size 56
  .amdhsa_user_sgpr_count 2
  .amdhsa_user_sgpr_kernarg_segment_ptr 1
  .amdhsa_system_sgpr_workgroup_id_x 1
.end_amdhsa_kernel
```

```asm
; @launch grid=(256,1,1) block=(256,1,1) lds=131072
.amdgcn_target "amdgcn-amd-amdhsa--gfx950"
.text
.globl standalone__normalfloat_lut_af4__prompt_kernel
.p2align 8
.type standalone__normalfloat_lut_af4__prompt_kernel,@function
standalone__normalfloat_lut_af4__prompt_kernel:
s_load_dwordx4 s[4:7], s[0:1], 0
s_load_dwordx4 s[8:11], s[0:1], 24
s_getpc_b64 s[48:49]
L_PC0:
v_lshlrev_b32 v2, 7, v0
v_min_u32 v2, L_END-L_PC0, v2
global_load_dword v7, v2, s[48:49]
s_cmp_ge_u32 s2, 256
s_cbranch_scc1 L_END
v_lshrrev_b32 v1, 6, v0
v_lshrrev_b32 v5, 5, v0
v_and_b32 v3, 31, v0
v_readfirstlane_b32 s36, v1
s_and_b32 s43, s2, 3
s_lshr_b32 s41, s2, 3
s_mov_b32 s26, 14680064
s_mov_b32 s27, 0x20000
s_sub_u32 s41, s41, 4
s_cbranch_scc1 L_HELPER
s_lshr_b32 s38, s41, 2
s_mul_i32 s44, s43, 7
s_add_u32 s38, s38, s44
v_mul_u32_u24 v2, 114688, v5
s_lshl_b32 s50, s38, 9
v_lshl_add_u32 v16, v3, 4, v2
s_movk_i32 s47, 0x3800
v_add_u32 v17, s47, v16
v_add_u32 v18, s47, v17
v_add_u32 v19, s47, v18
v_add_u32 v20, s47, v19
v_add_u32 v21, s47, v20
v_add_u32 v22, s47, v21
v_add_u32 v23, s47, v22
s_waitcnt lgkmcnt(0)
s_mov_b64 s[24:25], s[6:7]
buffer_load_dwordx4 v[32:35], v16, s[24:27], s50 offen
buffer_load_dwordx4 v[36:39], v17, s[24:27], s50 offen
buffer_load_dwordx4 v[40:43], v18, s[24:27], s50 offen
buffer_load_dwordx4 v[44:47], v19, s[24:27], s50 offen
buffer_load_dwordx4 v[48:51], v20, s[24:27], s50 offen
buffer_load_dwordx4 v[52:55], v21, s[24:27], s50 offen
buffer_load_dwordx4 v[56:59], v22, s[24:27], s50 offen
buffer_load_dwordx4 v[60:63], v23, s[24:27], s50 offen
s_branch L_MAIN
L_HELPER:
s_add_u32 s41, s41, 4
s_lshl2_add_u32 s41, s41, s36
v_and_b32 v0, 63, v0
s_bfe_u32 s42, s2, 0x10002
s_mov_b32 s22, 4194304
s_mov_b32 s23, 0x20000
v_min_u32 v2, 55, v0
v_cmp_lt_u32 vcc, 27, v2
v_lshlrev_b32 v2, 7, v2
v_mov_b32 v3, 10752
v_cndmask_b32 v3, 0, v3, vcc
v_add_u32 v2, v2, v3
s_lshl_b32 s45, s42, 4
s_add_u32 s45, s45, s41
s_mul_i32 s45, s45, 28672
s_mul_i32 s46, s43, 3584
s_add_u32 s45, s45, s46
v_add_u32 v2, s45, v2
v_lshrrev_b32 v3, 2, v0
v_and_b32 v4, 3, v0
v_lshlrev_b32 v3, 11, v3
v_lshl_add_u32 v3, v4, 7, v3
s_lshl2_add_u32 s45, s42, s43
s_lshl4_add_u32 s45, s45, s41
s_lshl_b32 s45, s45, 15
v_add_u32 v3, s45, v3
s_mov_b32 s50, 917504
s_waitcnt lgkmcnt(0)
s_mov_b64 s[24:25], s[6:7]
s_mov_b64 s[20:21], s[4:5]
buffer_load_dword v8, v3, s[20:23], 0 offen
buffer_load_dword v9, v2, s[24:27], s50 offen
s_add_u32 s50, s50, 917504
buffer_load_dword v9, v2, s[24:27], s50 offen
s_add_u32 s50, s50, 917504
buffer_load_dword v9, v2, s[24:27], s50 offen
s_add_u32 s50, s50, 917504
L_HLOOP:
v_add_u32 v3, 512, v3
buffer_load_dword v8, v3, s[20:23], 0 offen
buffer_load_dword v9, v2, s[24:27], s50 offen
s_add_u32 s50, s50, 917504
buffer_load_dword v9, v2, s[24:27], s50 offen
s_add_u32 s50, s50, 917504
buffer_load_dword v9, v2, s[24:27], s50 offen
s_add_u32 s50, s50, 917504
buffer_load_dword v9, v2, s[24:27], s50 offen
s_add_u32 s50, s50, 917504
s_cmp_lt_u32 s50, 14680064
s_cbranch_scc1 L_HLOOP
s_waitcnt vmcnt(0)
s_endpgm
L_MAIN:
v_mov_b32 v2, 0x3da3bf80
s_lshl_b64 exec, exec, 8
v_mov_b32 v2, 0x3e25bf32
s_lshl_b64 exec, exec, 8
v_mov_b32 v2, 0x3e7cbf06
s_lshl_b64 exec, exec, 8
v_mov_b32 v2, 0x3eadbeca
s_lshl_b64 exec, exec, 8
v_mov_b32 v2, 0x3ee2be92
s_lshl_b64 exec, exec, 8
v_mov_b32 v2, 0x3f10be3d
s_lshl_b64 exec, exec, 8
v_mov_b32 v2, 0x3f39bdba
s_lshl_b64 exec, exec, 8
v_mov_b32 v2, 0x3f800000
s_mov_b64 exec, -1
s_and_b32 s45, s36, 1
s_mul_i32 s45, s45, 0x0202
s_lshr_b32 s46, s36, 1
s_mul_i32 s46, s46, 0x02020000
s_add_u32 s45, s45, s46
s_add_u32 s45, s45, 0x05040100
v_mov_b32 v4, s45
s_mov_b32 s44, 98304
v_lshl_add_u32 v31, v0, 4, s44
v_mov_b64 v[116:117], 0
v_mov_b64 v[118:119], 0
s_mov_b32 s45, 0xbf32bf80
v_perm_b32 v64, s45, v2, v4
v_mov_b32 v65, v64
v_mov_b64 v[66:67], v[64:65]
v_mfma_f32_32x32x16_bf16 v[128:143], v[116:119], v[116:119], 0
ds_write_b128 v31, v[64:67] offset:0
s_mov_b32 s45, 0xbecabf06
v_perm_b32 v68, s45, v2, v4
v_mov_b32 v69, v68
v_mov_b64 v[70:71], v[68:69]
v_lshl_add_u32 v29, v3, 2, s44
s_mov_b64 s[20:21], s[4:5]
s_mov_b32 s22, 4194304
v_mfma_f32_32x32x16_bf16 v[144:159], v[116:119], v[116:119], 0
ds_write_b128 v31, v[68:71] offset:4096
s_mov_b32 s45, 0xbe3dbe92
v_perm_b32 v72, s45, v2, v4
v_mov_b32 v73, v72
v_mov_b64 v[74:75], v[72:73]
s_mov_b32 s23, 0x20000
s_mov_b32 s51, 0
s_bfe_u32 s42, s2, 0x10002
v_mfma_f32_32x32x16_bf16 v[160:175], v[116:119], v[116:119], 0
ds_write_b128 v31, v[72:75] offset:8192
s_mov_b32 s45, 0xbdba
v_perm_b32 v76, s45, v2, v4
v_mov_b32 v77, v76
v_mov_b64 v[78:79], v[76:77]
s_and_b32 s37, s41, 3
s_lshl2_add_u32 s37, s42, s37
s_lshl2_add_u32 s37, s37, s36
v_mfma_f32_32x32x16_bf16 v[176:191], v[116:119], v[116:119], 0
ds_write_b128 v31, v[76:79] offset:12288
s_mov_b32 s45, 0x3e253da3
v_perm_b32 v80, s45, v2, v4
v_mov_b32 v81, v80
v_mov_b64 v[82:83], v[80:81]
v_and_b32 v120, 1, v5
v_xor_b32 v3, v3, v120
v_lshlrev_b32 v120, 4, v3
v_mfma_f32_32x32x16_bf16 v[192:207], v[116:119], v[116:119], 0
ds_write_b128 v31, v[80:83] offset:16384
s_mov_b32 s45, 0x3ead3e7c
v_perm_b32 v84, s45, v2, v4
v_mov_b32 v85, v84
v_mov_b64 v[86:87], v[84:85]
v_lshl_add_u32 v120, v5, 11, v120
v_add_u32 v30, 65536, v120
v_and_b32 v0, 63, v0
v_mfma_f32_32x32x16_bf16 v[208:223], v[116:119], v[116:119], 0
ds_write_b128 v31, v[84:87] offset:20480
s_mov_b32 s45, 0x3f103ee2
v_perm_b32 v88, s45, v2, v4
v_mov_b32 v89, v88
v_mov_b64 v[90:91], v[88:89]
s_lshl_b32 s46, s37, 17
v_lshrrev_b32 v6, 3, v0
v_lshl_add_u32 v120, v6, 11, s46
v_mfma_f32_32x32x16_bf16 v[224:239], v[116:119], v[116:119], 0
ds_write_b128 v31, v[88:91] offset:24576
s_mov_b32 s45, 0x3f803f39
v_perm_b32 v92, s45, v2, v4
v_mov_b32 v93, v92
v_mov_b64 v[94:95], v[92:93]
v_and_b32 v121, 7, v0
v_lshrrev_b32 v6, 4, v0
v_xor_b32 v121, v121, v6
v_mfma_f32_32x32x16_bf16 v[240:255], v[116:119], v[116:119], 0
ds_write_b128 v31, v[92:95] offset:28672
v_lshl_add_u32 v8, v121, 4, v120
v_xor_b32 v121, 64, v8
v_add_u32 v9, 15360, v121
v_add_u32 v10, 30720, v8
v_add_u32 v11, 46080, v121
v_add_u32 v12, 65536, v8
v_add_u32 v13, 80896, v121
v_add_u32 v14, 96256, v8
v_add_u32 v15, 111616, v121
s_lshl_b32 m0, s36, 13
v_and_b32 v3, 15, v0
s_lshl_b32 s46, s38, 8
v_lshl_add_u32 v122, v3, 4, s46
s_add_u32 s50, s50, 917504
buffer_load_dwordx4 v8, s[20:23], s51 offen offset:0 lds
buffer_load_dwordx4 v9, s[20:23], s51 offen offset:1024 lds
buffer_load_dwordx4 v10, s[20:23], s51 offen offset:2048 lds
buffer_load_dwordx4 v11, s[20:23], s51 offen offset:3072 lds
s_xor_b32 m0, m0, 0x1000
s_mov_b64 s[28:29], s[10:11]
s_mov_b32 s30, 14680064
s_mov_b32 s31, 0x20000
s_lshl_b32 s47, s37, 6
v_and_b32 v121, 1, v6
v_lshl_add_u32 v120, v6, 2, s47
v_mul_u32_u24 v120, 7168, v120
v_add_u32 v28, v120, v122
s_lshl_b32 s47, s36, 13
v_lshl_add_u32 v120, v3, 7, s47
v_bfe_u32 v5, v0, 1, 3
v_xor_b32 v5, v5, v6
v_lshl_add_u32 v24, v5, 4, v120
v_xor_b32 v25, 64, v24
v_lshl_add_u32 v120, v3, 1, v121
v_lshlrev_b32 v120, 4, v120
v_lshl_add_u32 v120, v6, 11, v120
v_add_u32 v26, 65536, v120
v_xor_b32 v27, 16, v26
s_waitcnt lgkmcnt(0)
s_barrier
s_waitcnt vmcnt(10)
v_lshl_add_u64 v[64:65], v[36:37], 4, v[32:33]
v_lshl_add_u64 v[66:67], v[38:39], 4, v[34:35]
v_lshl_add_u32 v96, v64, 7, v29
v_lshl_add_u32 v100, v65, 7, v29
v_lshl_add_u32 v104, v66, 7, v29
v_lshl_add_u32 v108, v67, 7, v29
ds_read_b32 v96, v96
ds_read_b32 v100, v100
ds_read_b32 v104, v104
ds_read_b32 v108, v108
buffer_load_dwordx4 v12, s[20:23], s51 offen offset:0 lds
buffer_load_dwordx4 v13, s[20:23], s51 offen offset:1024 lds
s_waitcnt vmcnt(10)
v_lshl_add_u64 v[68:69], v[44:45], 4, v[40:41]
v_lshl_add_u64 v[70:71], v[46:47], 4, v[42:43]
v_lshl_add_u32 v97, v68, 7, v29
v_lshl_add_u32 v101, v69, 7, v29
v_lshl_add_u32 v105, v70, 7, v29
v_lshl_add_u32 v109, v71, 7, v29
ds_read_b32 v97, v97
ds_read_b32 v101, v101
ds_read_b32 v105, v105
ds_read_b32 v109, v109
buffer_load_dwordx4 v14, s[20:23], s51 offen offset:2048 lds
buffer_load_dwordx4 v15, s[20:23], s51 offen offset:3072 lds
s_waitcnt vmcnt(10)
v_lshl_add_u64 v[72:73], v[52:53], 4, v[48:49]
v_lshl_add_u64 v[74:75], v[54:55], 4, v[50:51]
v_lshl_add_u32 v98, v72, 7, v29
v_lshl_add_u32 v102, v73, 7, v29
v_lshl_add_u32 v106, v74, 7, v29
v_lshl_add_u32 v110, v75, 7, v29
ds_read_b32 v98, v98
ds_read_b32 v102, v102
ds_read_b32 v106, v106
ds_read_b32 v110, v110
s_waitcnt vmcnt(8)
v_lshl_add_u64 v[76:77], v[60:61], 4, v[56:57]
v_lshl_add_u64 v[78:79], v[62:63], 4, v[58:59]
v_lshl_add_u32 v99, v76, 7, v29
v_lshl_add_u32 v103, v77, 7, v29
v_lshl_add_u32 v107, v78, 7, v29
v_lshl_add_u32 v111, v79, 7, v29
ds_read_b32 v99, v99
ds_read_b32 v103, v103
ds_read_b32 v107, v107
ds_read_b32 v111, v111
global_load_dwordx4 v[112:115], v122, s[8:9]
buffer_load_dwordx4 v[32:35], v16, s[24:27], s50 offen
buffer_load_dwordx4 v[36:39], v17, s[24:27], s50 offen
s_waitcnt lgkmcnt(0)
ds_write_b128 v30, v[96:99] offset:0
ds_write_b128 v30, v[100:103] offset:512
ds_write_b128 v30, v[104:107] offset:1024
ds_write_b128 v30, v[108:111] offset:1536
buffer_load_dwordx4 v[40:43], v18, s[24:27], s50 offen
buffer_load_dwordx4 v[44:47], v19, s[24:27], s50 offen
buffer_load_dwordx4 v[48:51], v20, s[24:27], s50 offen
buffer_load_dwordx4 v[52:55], v21, s[24:27], s50 offen
buffer_load_dwordx4 v[56:59], v22, s[24:27], s50 offen
buffer_load_dwordx4 v[60:63], v23, s[24:27], s50 offen
s_xor_b32 m0, m0, 36864
s_add_u32 s51, s51, 128
s_add_u32 s50, s50, 917504
buffer_load_dwordx4 v8, s[20:23], s51 offen offset:0 lds
buffer_load_dwordx4 v9, s[20:23], s51 offen offset:1024 lds
buffer_load_dwordx4 v10, s[20:23], s51 offen offset:2048 lds
buffer_load_dwordx4 v11, s[20:23], s51 offen offset:3072 lds
s_xor_b32 m0, m0, 0x1000
s_nop 0
s_waitcnt vmcnt(13)
ds_read_b128 a[0:3], v24 offset:0
buffer_load_dwordx4 v12, s[20:23], s51 offen offset:0 lds
ds_read_b128 a[4:7], v24 offset:2048
ds_read_b128 a[8:11], v24 offset:4096
ds_read_b128 a[12:15], v24 offset:6144
s_waitcnt lgkmcnt(4)
buffer_load_dwordx4 v13, s[20:23], s51 offen offset:1024 lds
s_barrier
ds_read_b128 a[16:19], v26 offset:0
ds_read_b128 a[20:23], v26 offset:512
ds_read_b128 a[24:27], v26 offset:1024
buffer_load_dwordx4 v14, s[20:23], s51 offen offset:2048 lds
ds_read_b128 a[28:31], v26 offset:1536
ds_read_b128 a[32:35], v27 offset:0
ds_read_b128 a[36:39], v27 offset:512
ds_read_b128 a[40:43], v27 offset:1024
s_waitcnt lgkmcnt(4)
buffer_load_dwordx4 v15, s[20:23], s51 offen offset:3072 lds
ds_read_b128 a[44:47], v27 offset:1536
s_branch L_ENTRY
.p2align 6
L_LOOP:
v_mfma_f32_16x16x32_bf16 v[152:155], a[48:51], a[88:91], v[152:155]
s_barrier
ds_read_b128 a[16:19], v26 offset:0
v_mfma_f32_16x16x32_bf16 v[184:187], a[52:55], a[88:91], v[184:187]
ds_read_b128 a[20:23], v26 offset:512
v_mfma_f32_16x16x32_bf16 v[216:219], a[56:59], a[88:91], v[216:219]
ds_read_b128 a[24:27], v26 offset:1024
v_mfma_f32_16x16x32_bf16 v[248:251], a[60:63], a[88:91], v[248:251]
buffer_load_dwordx4 v14, s[20:23], s51 offen offset:2048 lds
ds_read_b128 a[28:31], v26 offset:1536
v_mfma_f32_16x16x32_bf16 v[252:255], a[60:63], a[92:95], v[252:255]
ds_read_b128 a[32:35], v27 offset:0
v_mfma_f32_16x16x32_bf16 v[220:223], a[56:59], a[92:95], v[220:223]
ds_read_b128 a[36:39], v27 offset:512
v_mfma_f32_16x16x32_bf16 v[188:191], a[52:55], a[92:95], v[188:191]
ds_read_b128 a[40:43], v27 offset:1024
v_mfma_f32_16x16x32_bf16 v[156:159], a[48:51], a[92:95], v[156:159]
s_waitcnt lgkmcnt(4)
buffer_load_dwordx4 v15, s[20:23], s51 offen offset:3072 lds
ds_read_b128 a[44:47], v27 offset:1536
L_ENTRY:
v_mfma_f32_16x16x32_bf16 v[128:131], a[0:3], a[16:19], v[128:131]
s_waitcnt vmcnt(14)
ds_read_b128 a[64:67], v26 offset:8192
v_lshl_add_u64 v[64:65], v[36:37], 4, v[32:33]
v_mfma_f32_16x16x32_bf16 v[160:163], a[4:7], a[16:19], v[160:163]
s_xor_b32 m0, m0, 36864
ds_read_b128 a[48:51], v25 offset:0
v_lshl_add_u64 v[66:67], v[38:39], 4, v[34:35]
v_mfma_f32_16x16x32_bf16 v[192:195], a[8:11], a[16:19], v[192:195]
s_add_u32 s51, s51, 128
ds_read_b128 a[52:55], v25 offset:2048
v_lshl_add_u32 v96, v64, 7, v29
v_mfma_f32_16x16x32_bf16 v[224:227], a[12:15], a[16:19], v[224:227]
s_cmp_lt_u32 s51, 2048
buffer_load_dwordx4 v[32:35], v16, s[24:27], s50 offen
ds_read_b32 v96, v96
v_mfma_f32_16x16x32_bf16 v[228:231], a[12:15], a[20:23], v[228:231]
s_cselect_b32 s22, 4194304, 0
ds_read_b128 a[56:59], v25 offset:4096
v_lshl_add_u32 v100, v65, 7, v29
v_mfma_f32_16x16x32_bf16 v[196:199], a[8:11], a[20:23], v[196:199]
ds_read_b32 v100, v100
v_lshl_add_u32 v104, v66, 7, v29
v_mfma_f32_16x16x32_bf16 v[164:167], a[4:7], a[20:23], v[164:167]
ds_read_b32 v104, v104
v_lshl_add_u32 v108, v67, 7, v29
v_mfma_f32_16x16x32_bf16 v[132:135], a[0:3], a[20:23], v[132:135]
buffer_load_dwordx4 v[36:39], v17, s[24:27], s50 offen
ds_read_b32 v108, v108
v_mfma_f32_16x16x32_bf16 v[136:139], a[0:3], a[24:27], v[136:139]
s_waitcnt vmcnt(14)
ds_read_b128 a[60:63], v25 offset:6144
v_lshl_add_u64 v[68:69], v[44:45], 4, v[40:41]
v_mfma_f32_16x16x32_bf16 v[168:171], a[4:7], a[24:27], v[168:171]
ds_read_b128 a[68:71], v26 offset:8704
v_lshl_add_u64 v[70:71], v[46:47], 4, v[42:43]
v_mfma_f32_16x16x32_bf16 v[200:203], a[8:11], a[24:27], v[200:203]
ds_read_b128 a[72:75], v26 offset:9216
v_lshl_add_u32 v97, v68, 7, v29
v_mfma_f32_16x16x32_bf16 v[232:235], a[12:15], a[24:27], v[232:235]
s_waitcnt lgkmcnt(4)
buffer_load_dwordx4 v[40:43], v18, s[24:27], s50 offen
ds_read_b32 v97, v97
v_mfma_f32_16x16x32_bf16 v[236:239], a[12:15], a[28:31], v[236:239]
ds_read_b128 a[76:79], v26 offset:9728
v_lshl_add_u32 v101, v69, 7, v29
v_mfma_f32_16x16x32_bf16 v[204:207], a[8:11], a[28:31], v[204:207]
ds_read_b32 v101, v101
v_lshl_add_u32 v105, v70, 7, v29
v_mfma_f32_16x16x32_bf16 v[172:175], a[4:7], a[28:31], v[172:175]
ds_read_b32 v105, v105
v_lshl_add_u32 v109, v71, 7, v29
v_mfma_f32_16x16x32_bf16 v[140:143], a[0:3], a[28:31], v[140:143]
buffer_load_dwordx4 v[44:47], v19, s[24:27], s50 offen
ds_read_b32 v109, v109
v_mfma_f32_16x16x32_bf16 v[144:147], a[0:3], a[32:35], v[144:147]
s_waitcnt vmcnt(14)
ds_read_b128 a[80:83], v27 offset:8192
v_lshl_add_u64 v[72:73], v[52:53], 4, v[48:49]
v_mfma_f32_16x16x32_bf16 v[176:179], a[4:7], a[32:35], v[176:179]
ds_read_b128 a[84:87], v27 offset:8704
v_lshl_add_u64 v[74:75], v[54:55], 4, v[50:51]
v_mfma_f32_16x16x32_bf16 v[208:211], a[8:11], a[32:35], v[208:211]
ds_read_b128 a[88:91], v27 offset:9216
v_lshl_add_u32 v98, v72, 7, v29
v_mfma_f32_16x16x32_bf16 v[240:243], a[12:15], a[32:35], v[240:243]
buffer_load_dwordx4 v[48:51], v20, s[24:27], s50 offen
ds_read_b32 v98, v98
v_mfma_f32_16x16x32_bf16 v[244:247], a[12:15], a[36:39], v[244:247]
ds_read_b128 a[92:95], v27 offset:9728
v_lshl_add_u32 v102, v73, 7, v29
v_mfma_f32_16x16x32_bf16 v[212:215], a[8:11], a[36:39], v[212:215]
ds_read_b32 v102, v102
v_lshl_add_u32 v106, v74, 7, v29
v_mfma_f32_16x16x32_bf16 v[180:183], a[4:7], a[36:39], v[180:183]
ds_read_b32 v106, v106
v_lshl_add_u32 v110, v75, 7, v29
v_mfma_f32_16x16x32_bf16 v[148:151], a[0:3], a[36:39], v[148:151]
buffer_load_dwordx4 v[52:55], v21, s[24:27], s50 offen
ds_read_b32 v110, v110
v_mfma_f32_16x16x32_bf16 v[152:155], a[0:3], a[40:43], v[152:155]
s_waitcnt vmcnt(14)
v_lshl_add_u64 v[76:77], v[60:61], 4, v[56:57]
v_lshl_add_u64 v[78:79], v[62:63], 4, v[58:59]
v_mfma_f32_16x16x32_bf16 v[184:187], a[4:7], a[40:43], v[184:187]
v_lshl_add_u32 v99, v76, 7, v29
v_lshl_add_u32 v103, v77, 7, v29
v_mfma_f32_16x16x32_bf16 v[216:219], a[8:11], a[40:43], v[216:219]
ds_read_b32 v99, v99
v_lshl_add_u32 v107, v78, 7, v29
v_mfma_f32_16x16x32_bf16 v[248:251], a[12:15], a[40:43], v[248:251]
buffer_load_dwordx4 v[56:59], v22, s[24:27], s50 offen
ds_read_b32 v103, v103
v_mfma_f32_16x16x32_bf16 v[252:255], a[12:15], a[44:47], v[252:255]
ds_read_b32 v107, v107
v_lshl_add_u32 v111, v79, 7, v29
v_mfma_f32_16x16x32_bf16 v[220:223], a[8:11], a[44:47], v[220:223]
ds_read_b32 v111, v111
v_mfma_f32_16x16x32_bf16 v[188:191], a[4:7], a[44:47], v[188:191]
v_mfma_f32_16x16x32_bf16 v[156:159], a[0:3], a[44:47], v[156:159]
buffer_load_dwordx4 v[60:63], v23, s[24:27], s50 offen
v_mfma_f32_16x16x32_bf16 v[128:131], a[48:51], a[64:67], v[128:131]
s_add_u32 s50, s50, 917504
v_mfma_f32_16x16x32_bf16 v[160:163], a[52:55], a[64:67], v[160:163]
v_mfma_f32_16x16x32_bf16 v[192:195], a[56:59], a[64:67], v[192:195]
s_waitcnt lgkmcnt(0)
ds_write_b128 v30, v[96:99] offset:16384
v_mfma_f32_16x16x32_bf16 v[224:227], a[60:63], a[64:67], v[224:227]
buffer_load_dwordx4 v8, s[20:23], s51 offen offset:0 lds
v_mfma_f32_16x16x32_bf16 v[228:231], a[60:63], a[68:71], v[228:231]
v_mfma_f32_16x16x32_bf16 v[196:199], a[56:59], a[68:71], v[196:199]
v_mfma_f32_16x16x32_bf16 v[164:167], a[52:55], a[68:71], v[164:167]
ds_write_b128 v30, v[100:103] offset:16896
v_mfma_f32_16x16x32_bf16 v[132:135], a[48:51], a[68:71], v[132:135]
buffer_load_dwordx4 v9, s[20:23], s51 offen offset:1024 lds
v_mfma_f32_16x16x32_bf16 v[136:139], a[48:51], a[72:75], v[136:139]
v_mfma_f32_16x16x32_bf16 v[168:171], a[52:55], a[72:75], v[168:171]
v_mfma_f32_16x16x32_bf16 v[200:203], a[56:59], a[72:75], v[200:203]
ds_write_b128 v30, v[104:107] offset:17408
v_mfma_f32_16x16x32_bf16 v[232:235], a[60:63], a[72:75], v[232:235]
buffer_load_dwordx4 v10, s[20:23], s51 offen offset:2048 lds
v_mfma_f32_16x16x32_bf16 v[236:239], a[60:63], a[76:79], v[236:239]
v_mfma_f32_16x16x32_bf16 v[204:207], a[56:59], a[76:79], v[204:207]
v_mfma_f32_16x16x32_bf16 v[172:175], a[52:55], a[76:79], v[172:175]
ds_write_b128 v30, v[108:111] offset:17920
v_mfma_f32_16x16x32_bf16 v[140:143], a[48:51], a[76:79], v[140:143]
buffer_load_dwordx4 v11, s[20:23], s51 offen offset:3072 lds
v_mfma_f32_16x16x32_bf16 v[144:147], a[48:51], a[80:83], v[144:147]
s_xor_b32 m0, m0, 0x1000
v_mfma_f32_16x16x32_bf16 v[176:179], a[52:55], a[80:83], v[176:179]
v_mfma_f32_16x16x32_bf16 v[208:211], a[56:59], a[80:83], v[208:211]
s_waitcnt vmcnt(12)
ds_read_b128 a[0:3], v24 offset:32768
v_mfma_f32_16x16x32_bf16 v[240:243], a[60:63], a[80:83], v[240:243]
buffer_load_dwordx4 v12, s[20:23], s51 offen offset:0 lds
ds_read_b128 a[4:7], v24 offset:34816
v_mfma_f32_16x16x32_bf16 v[244:247], a[60:63], a[84:87], v[244:247]
ds_read_b128 a[8:11], v24 offset:36864
v_mfma_f32_16x16x32_bf16 v[212:215], a[56:59], a[84:87], v[212:215]
ds_read_b128 a[12:15], v24 offset:38912
v_mfma_f32_16x16x32_bf16 v[180:183], a[52:55], a[84:87], v[180:183]
s_waitcnt lgkmcnt(4)
v_mfma_f32_16x16x32_bf16 v[148:151], a[48:51], a[84:87], v[148:151]
buffer_load_dwordx4 v13, s[20:23], s51 offen offset:1024 lds
v_mfma_f32_16x16x32_bf16 v[152:155], a[48:51], a[88:91], v[152:155]
s_barrier
ds_read_b128 a[16:19], v26 offset:16384
v_mfma_f32_16x16x32_bf16 v[184:187], a[52:55], a[88:91], v[184:187]
ds_read_b128 a[20:23], v26 offset:16896
v_mfma_f32_16x16x32_bf16 v[216:219], a[56:59], a[88:91], v[216:219]
ds_read_b128 a[24:27], v26 offset:17408
v_mfma_f32_16x16x32_bf16 v[248:251], a[60:63], a[88:91], v[248:251]
buffer_load_dwordx4 v14, s[20:23], s51 offen offset:2048 lds
ds_read_b128 a[28:31], v26 offset:17920
v_mfma_f32_16x16x32_bf16 v[252:255], a[60:63], a[92:95], v[252:255]
ds_read_b128 a[32:35], v27 offset:16384
v_mfma_f32_16x16x32_bf16 v[220:223], a[56:59], a[92:95], v[220:223]
ds_read_b128 a[36:39], v27 offset:16896
v_mfma_f32_16x16x32_bf16 v[188:191], a[52:55], a[92:95], v[188:191]
ds_read_b128 a[40:43], v27 offset:17408
v_mfma_f32_16x16x32_bf16 v[156:159], a[48:51], a[92:95], v[156:159]
s_waitcnt lgkmcnt(4)
buffer_load_dwordx4 v15, s[20:23], s51 offen offset:3072 lds
ds_read_b128 a[44:47], v27 offset:17920
v_mfma_f32_16x16x32_bf16 v[128:131], a[0:3], a[16:19], v[128:131]
s_waitcnt vmcnt(14)
ds_read_b128 a[64:67], v26 offset:24576
v_lshl_add_u64 v[64:65], v[36:37], 4, v[32:33]
v_mfma_f32_16x16x32_bf16 v[160:163], a[4:7], a[16:19], v[160:163]
s_xor_b32 m0, m0, 36864
ds_read_b128 a[48:51], v25 offset:32768
v_lshl_add_u64 v[66:67], v[38:39], 4, v[34:35]
v_mfma_f32_16x16x32_bf16 v[192:195], a[8:11], a[16:19], v[192:195]
s_add_u32 s51, s51, 128
ds_read_b128 a[52:55], v25 offset:34816
v_lshl_add_u32 v96, v64, 7, v29
v_mfma_f32_16x16x32_bf16 v[224:227], a[12:15], a[16:19], v[224:227]
buffer_load_dwordx4 v[32:35], v16, s[24:27], s50 offen
ds_read_b32 v96, v96
v_mfma_f32_16x16x32_bf16 v[228:231], a[12:15], a[20:23], v[228:231]
ds_read_b128 a[56:59], v25 offset:36864
v_lshl_add_u32 v100, v65, 7, v29
v_mfma_f32_16x16x32_bf16 v[196:199], a[8:11], a[20:23], v[196:199]
ds_read_b32 v100, v100
v_lshl_add_u32 v104, v66, 7, v29
v_mfma_f32_16x16x32_bf16 v[164:167], a[4:7], a[20:23], v[164:167]
ds_read_b32 v104, v104
v_lshl_add_u32 v108, v67, 7, v29
v_mfma_f32_16x16x32_bf16 v[132:135], a[0:3], a[20:23], v[132:135]
buffer_load_dwordx4 v[36:39], v17, s[24:27], s50 offen
ds_read_b32 v108, v108
v_mfma_f32_16x16x32_bf16 v[136:139], a[0:3], a[24:27], v[136:139]
s_waitcnt vmcnt(14)
ds_read_b128 a[60:63], v25 offset:38912
v_lshl_add_u64 v[68:69], v[44:45], 4, v[40:41]
v_mfma_f32_16x16x32_bf16 v[168:171], a[4:7], a[24:27], v[168:171]
ds_read_b128 a[68:71], v26 offset:25088
v_lshl_add_u64 v[70:71], v[46:47], 4, v[42:43]
v_mfma_f32_16x16x32_bf16 v[200:203], a[8:11], a[24:27], v[200:203]
ds_read_b128 a[72:75], v26 offset:25600
v_lshl_add_u32 v97, v68, 7, v29
v_mfma_f32_16x16x32_bf16 v[232:235], a[12:15], a[24:27], v[232:235]
s_waitcnt lgkmcnt(4)
buffer_load_dwordx4 v[40:43], v18, s[24:27], s50 offen
ds_read_b32 v97, v97
v_mfma_f32_16x16x32_bf16 v[236:239], a[12:15], a[28:31], v[236:239]
ds_read_b128 a[76:79], v26 offset:26112
v_lshl_add_u32 v101, v69, 7, v29
v_mfma_f32_16x16x32_bf16 v[204:207], a[8:11], a[28:31], v[204:207]
ds_read_b32 v101, v101
v_lshl_add_u32 v105, v70, 7, v29
v_mfma_f32_16x16x32_bf16 v[172:175], a[4:7], a[28:31], v[172:175]
ds_read_b32 v105, v105
v_lshl_add_u32 v109, v71, 7, v29
v_mfma_f32_16x16x32_bf16 v[140:143], a[0:3], a[28:31], v[140:143]
buffer_load_dwordx4 v[44:47], v19, s[24:27], s50 offen
ds_read_b32 v109, v109
v_mfma_f32_16x16x32_bf16 v[144:147], a[0:3], a[32:35], v[144:147]
s_waitcnt vmcnt(14)
ds_read_b128 a[80:83], v27 offset:24576
v_lshl_add_u64 v[72:73], v[52:53], 4, v[48:49]
v_mfma_f32_16x16x32_bf16 v[176:179], a[4:7], a[32:35], v[176:179]
ds_read_b128 a[84:87], v27 offset:25088
v_lshl_add_u64 v[74:75], v[54:55], 4, v[50:51]
v_mfma_f32_16x16x32_bf16 v[208:211], a[8:11], a[32:35], v[208:211]
ds_read_b128 a[88:91], v27 offset:25600
v_lshl_add_u32 v98, v72, 7, v29
v_mfma_f32_16x16x32_bf16 v[240:243], a[12:15], a[32:35], v[240:243]
buffer_load_dwordx4 v[48:51], v20, s[24:27], s50 offen
ds_read_b32 v98, v98
v_mfma_f32_16x16x32_bf16 v[244:247], a[12:15], a[36:39], v[244:247]
ds_read_b128 a[92:95], v27 offset:26112
v_lshl_add_u32 v102, v73, 7, v29
v_mfma_f32_16x16x32_bf16 v[212:215], a[8:11], a[36:39], v[212:215]
ds_read_b32 v102, v102
v_lshl_add_u32 v106, v74, 7, v29
v_mfma_f32_16x16x32_bf16 v[180:183], a[4:7], a[36:39], v[180:183]
ds_read_b32 v106, v106
v_lshl_add_u32 v110, v75, 7, v29
v_mfma_f32_16x16x32_bf16 v[148:151], a[0:3], a[36:39], v[148:151]
buffer_load_dwordx4 v[52:55], v21, s[24:27], s50 offen
ds_read_b32 v110, v110
v_mfma_f32_16x16x32_bf16 v[152:155], a[0:3], a[40:43], v[152:155]
s_waitcnt vmcnt(14)
v_lshl_add_u64 v[76:77], v[60:61], 4, v[56:57]
v_lshl_add_u64 v[78:79], v[62:63], 4, v[58:59]
v_mfma_f32_16x16x32_bf16 v[184:187], a[4:7], a[40:43], v[184:187]
v_lshl_add_u32 v99, v76, 7, v29
v_lshl_add_u32 v103, v77, 7, v29
v_mfma_f32_16x16x32_bf16 v[216:219], a[8:11], a[40:43], v[216:219]
ds_read_b32 v99, v99
v_lshl_add_u32 v107, v78, 7, v29
v_mfma_f32_16x16x32_bf16 v[248:251], a[12:15], a[40:43], v[248:251]
buffer_load_dwordx4 v[56:59], v22, s[24:27], s50 offen
ds_read_b32 v103, v103
v_mfma_f32_16x16x32_bf16 v[252:255], a[12:15], a[44:47], v[252:255]
ds_read_b32 v107, v107
v_lshl_add_u32 v111, v79, 7, v29
v_mfma_f32_16x16x32_bf16 v[220:223], a[8:11], a[44:47], v[220:223]
ds_read_b32 v111, v111
v_mfma_f32_16x16x32_bf16 v[188:191], a[4:7], a[44:47], v[188:191]
v_mfma_f32_16x16x32_bf16 v[156:159], a[0:3], a[44:47], v[156:159]
buffer_load_dwordx4 v[60:63], v23, s[24:27], s50 offen
v_mfma_f32_16x16x32_bf16 v[128:131], a[48:51], a[64:67], v[128:131]
s_add_u32 s50, s50, 917504
v_mfma_f32_16x16x32_bf16 v[160:163], a[52:55], a[64:67], v[160:163]
v_mfma_f32_16x16x32_bf16 v[192:195], a[56:59], a[64:67], v[192:195]
s_waitcnt lgkmcnt(0)
ds_write_b128 v30, v[96:99] offset:0
v_mfma_f32_16x16x32_bf16 v[224:227], a[60:63], a[64:67], v[224:227]
buffer_load_dwordx4 v8, s[20:23], s51 offen offset:0 lds
v_mfma_f32_16x16x32_bf16 v[228:231], a[60:63], a[68:71], v[228:231]
v_mfma_f32_16x16x32_bf16 v[196:199], a[56:59], a[68:71], v[196:199]
v_mfma_f32_16x16x32_bf16 v[164:167], a[52:55], a[68:71], v[164:167]
ds_write_b128 v30, v[100:103] offset:512
v_mfma_f32_16x16x32_bf16 v[132:135], a[48:51], a[68:71], v[132:135]
buffer_load_dwordx4 v9, s[20:23], s51 offen offset:1024 lds
v_mfma_f32_16x16x32_bf16 v[136:139], a[48:51], a[72:75], v[136:139]
v_mfma_f32_16x16x32_bf16 v[168:171], a[52:55], a[72:75], v[168:171]
v_mfma_f32_16x16x32_bf16 v[200:203], a[56:59], a[72:75], v[200:203]
ds_write_b128 v30, v[104:107] offset:1024
v_mfma_f32_16x16x32_bf16 v[232:235], a[60:63], a[72:75], v[232:235]
buffer_load_dwordx4 v10, s[20:23], s51 offen offset:2048 lds
v_mfma_f32_16x16x32_bf16 v[236:239], a[60:63], a[76:79], v[236:239]
v_mfma_f32_16x16x32_bf16 v[204:207], a[56:59], a[76:79], v[204:207]
v_mfma_f32_16x16x32_bf16 v[172:175], a[52:55], a[76:79], v[172:175]
ds_write_b128 v30, v[108:111] offset:1536
v_mfma_f32_16x16x32_bf16 v[140:143], a[48:51], a[76:79], v[140:143]
buffer_load_dwordx4 v11, s[20:23], s51 offen offset:3072 lds
v_mfma_f32_16x16x32_bf16 v[144:147], a[48:51], a[80:83], v[144:147]
s_xor_b32 m0, m0, 0x1000
v_mfma_f32_16x16x32_bf16 v[176:179], a[52:55], a[80:83], v[176:179]
s_cmp_lt_u32 s51, 2176
v_mfma_f32_16x16x32_bf16 v[208:211], a[56:59], a[80:83], v[208:211]
s_waitcnt vmcnt(12)
ds_read_b128 a[0:3], v24 offset:0
v_mfma_f32_16x16x32_bf16 v[240:243], a[60:63], a[80:83], v[240:243]
buffer_load_dwordx4 v12, s[20:23], s51 offen offset:0 lds
ds_read_b128 a[4:7], v24 offset:2048
v_mfma_f32_16x16x32_bf16 v[244:247], a[60:63], a[84:87], v[244:247]
ds_read_b128 a[8:11], v24 offset:4096
v_mfma_f32_16x16x32_bf16 v[212:215], a[56:59], a[84:87], v[212:215]
ds_read_b128 a[12:15], v24 offset:6144
v_mfma_f32_16x16x32_bf16 v[180:183], a[52:55], a[84:87], v[180:183]
s_waitcnt lgkmcnt(4)
v_mfma_f32_16x16x32_bf16 v[148:151], a[48:51], a[84:87], v[148:151]
buffer_load_dwordx4 v13, s[20:23], s51 offen offset:1024 lds
s_cbranch_scc1 L_LOOP
v_mfma_f32_16x16x32_bf16 v[152:155], a[48:51], a[88:91], v[152:155]
v_lshlrev_b32 v80, 16, v112
v_and_b32 v81, 0xffff0000, v112
v_mfma_f32_16x16x32_bf16 v[184:187], a[52:55], a[88:91], v[184:187]
v_lshlrev_b32 v82, 16, v113
v_and_b32 v83, 0xffff0000, v113
v_mfma_f32_16x16x32_bf16 v[216:219], a[56:59], a[88:91], v[216:219]
v_lshlrev_b32 v84, 16, v114
v_and_b32 v85, 0xffff0000, v114
v_mfma_f32_16x16x32_bf16 v[248:251], a[60:63], a[88:91], v[248:251]
v_lshlrev_b32 v86, 16, v115
v_and_b32 v87, 0xffff0000, v115
v_mfma_f32_16x16x32_bf16 v[252:255], a[60:63], a[92:95], v[252:255]
v_mfma_f32_16x16x32_bf16 v[220:223], a[56:59], a[92:95], v[220:223]
v_mfma_f32_16x16x32_bf16 v[188:191], a[52:55], a[92:95], v[188:191]
v_mfma_f32_16x16x32_bf16 v[156:159], a[48:51], a[92:95], v[156:159]
s_waitcnt vmcnt(0) lgkmcnt(0)
s_nop 1
v_pk_mul_f32 v[128:129], v[128:129], v[80:81] op_sel:[0,0] op_sel_hi:[1,0]
v_pk_mul_f32 v[132:133], v[132:133], v[80:81] op_sel:[0,1] op_sel_hi:[1,1]
v_pk_mul_f32 v[136:137], v[136:137], v[82:83] op_sel:[0,0] op_sel_hi:[1,0]
v_pk_mul_f32 v[140:141], v[140:141], v[82:83] op_sel:[0,1] op_sel_hi:[1,1]
v_pk_mul_f32 v[144:145], v[144:145], v[84:85] op_sel:[0,0] op_sel_hi:[1,0]
v_pk_mul_f32 v[148:149], v[148:149], v[84:85] op_sel:[0,1] op_sel_hi:[1,1]
v_pk_mul_f32 v[152:153], v[152:153], v[86:87] op_sel:[0,0] op_sel_hi:[1,0]
v_pk_mul_f32 v[156:157], v[156:157], v[86:87] op_sel:[0,1] op_sel_hi:[1,1]
v_cvt_pk_bf16_f32 v32, v128, v132
v_cvt_pk_bf16_f32 v33, v136, v140
v_cvt_pk_bf16_f32 v34, v144, v148
v_cvt_pk_bf16_f32 v35, v152, v156
s_mov_b32 s56, 0
buffer_store_dwordx4 v[32:35], v28, s[28:31], s56 offen nt
v_cvt_pk_bf16_f32 v36, v129, v133
v_cvt_pk_bf16_f32 v37, v137, v141
v_cvt_pk_bf16_f32 v38, v145, v149
v_cvt_pk_bf16_f32 v39, v153, v157
s_mov_b32 s56, 7168
buffer_store_dwordx4 v[36:39], v28, s[28:31], s56 offen nt
v_pk_mul_f32 v[130:131], v[130:131], v[80:81] op_sel:[0,0] op_sel_hi:[1,0]
v_pk_mul_f32 v[134:135], v[134:135], v[80:81] op_sel:[0,1] op_sel_hi:[1,1]
v_pk_mul_f32 v[138:139], v[138:139], v[82:83] op_sel:[0,0] op_sel_hi:[1,0]
v_pk_mul_f32 v[142:143], v[142:143], v[82:83] op_sel:[0,1] op_sel_hi:[1,1]
v_pk_mul_f32 v[146:147], v[146:147], v[84:85] op_sel:[0,0] op_sel_hi:[1,0]
v_pk_mul_f32 v[150:151], v[150:151], v[84:85] op_sel:[0,1] op_sel_hi:[1,1]
v_pk_mul_f32 v[154:155], v[154:155], v[86:87] op_sel:[0,0] op_sel_hi:[1,0]
v_pk_mul_f32 v[158:159], v[158:159], v[86:87] op_sel:[0,1] op_sel_hi:[1,1]
v_cvt_pk_bf16_f32 v40, v130, v134
v_cvt_pk_bf16_f32 v41, v138, v142
v_cvt_pk_bf16_f32 v42, v146, v150
v_cvt_pk_bf16_f32 v43, v154, v158
s_mov_b32 s56, 14336
buffer_store_dwordx4 v[40:43], v28, s[28:31], s56 offen nt
v_cvt_pk_bf16_f32 v44, v131, v135
v_cvt_pk_bf16_f32 v45, v139, v143
v_cvt_pk_bf16_f32 v46, v147, v151
v_cvt_pk_bf16_f32 v47, v155, v159
s_mov_b32 s56, 21504
buffer_store_dwordx4 v[44:47], v28, s[28:31], s56 offen nt
v_pk_mul_f32 v[160:161], v[160:161], v[80:81] op_sel:[0,0] op_sel_hi:[1,0]
v_pk_mul_f32 v[164:165], v[164:165], v[80:81] op_sel:[0,1] op_sel_hi:[1,1]
v_pk_mul_f32 v[168:169], v[168:169], v[82:83] op_sel:[0,0] op_sel_hi:[1,0]
v_pk_mul_f32 v[172:173], v[172:173], v[82:83] op_sel:[0,1] op_sel_hi:[1,1]
v_pk_mul_f32 v[176:177], v[176:177], v[84:85] op_sel:[0,0] op_sel_hi:[1,0]
v_pk_mul_f32 v[180:181], v[180:181], v[84:85] op_sel:[0,1] op_sel_hi:[1,1]
v_pk_mul_f32 v[184:185], v[184:185], v[86:87] op_sel:[0,0] op_sel_hi:[1,0]
v_pk_mul_f32 v[188:189], v[188:189], v[86:87] op_sel:[0,1] op_sel_hi:[1,1]
v_cvt_pk_bf16_f32 v48, v160, v164
v_cvt_pk_bf16_f32 v49, v168, v172
v_cvt_pk_bf16_f32 v50, v176, v180
v_cvt_pk_bf16_f32 v51, v184, v188
s_mov_b32 s56, 114688
buffer_store_dwordx4 v[48:51], v28, s[28:31], s56 offen nt
v_cvt_pk_bf16_f32 v52, v161, v165
v_cvt_pk_bf16_f32 v53, v169, v173
v_cvt_pk_bf16_f32 v54, v177, v181
v_cvt_pk_bf16_f32 v55, v185, v189
s_mov_b32 s56, 121856
buffer_store_dwordx4 v[52:55], v28, s[28:31], s56 offen nt
v_pk_mul_f32 v[162:163], v[162:163], v[80:81] op_sel:[0,0] op_sel_hi:[1,0]
v_pk_mul_f32 v[166:167], v[166:167], v[80:81] op_sel:[0,1] op_sel_hi:[1,1]
v_pk_mul_f32 v[170:171], v[170:171], v[82:83] op_sel:[0,0] op_sel_hi:[1,0]
v_pk_mul_f32 v[174:175], v[174:175], v[82:83] op_sel:[0,1] op_sel_hi:[1,1]
v_pk_mul_f32 v[178:179], v[178:179], v[84:85] op_sel:[0,0] op_sel_hi:[1,0]
v_pk_mul_f32 v[182:183], v[182:183], v[84:85] op_sel:[0,1] op_sel_hi:[1,1]
v_pk_mul_f32 v[186:187], v[186:187], v[86:87] op_sel:[0,0] op_sel_hi:[1,0]
v_pk_mul_f32 v[190:191], v[190:191], v[86:87] op_sel:[0,1] op_sel_hi:[1,1]
v_cvt_pk_bf16_f32 v56, v162, v166
v_cvt_pk_bf16_f32 v57, v170, v174
v_cvt_pk_bf16_f32 v58, v178, v182
v_cvt_pk_bf16_f32 v59, v186, v190
s_mov_b32 s56, 129024
buffer_store_dwordx4 v[56:59], v28, s[28:31], s56 offen nt
v_cvt_pk_bf16_f32 v60, v163, v167
v_cvt_pk_bf16_f32 v61, v171, v175
v_cvt_pk_bf16_f32 v62, v179, v183
v_cvt_pk_bf16_f32 v63, v187, v191
s_mov_b32 s56, 136192
buffer_store_dwordx4 v[60:63], v28, s[28:31], s56 offen nt
v_pk_mul_f32 v[192:193], v[192:193], v[80:81] op_sel:[0,0] op_sel_hi:[1,0]
v_pk_mul_f32 v[196:197], v[196:197], v[80:81] op_sel:[0,1] op_sel_hi:[1,1]
v_pk_mul_f32 v[200:201], v[200:201], v[82:83] op_sel:[0,0] op_sel_hi:[1,0]
v_pk_mul_f32 v[204:205], v[204:205], v[82:83] op_sel:[0,1] op_sel_hi:[1,1]
v_pk_mul_f32 v[208:209], v[208:209], v[84:85] op_sel:[0,0] op_sel_hi:[1,0]
v_pk_mul_f32 v[212:213], v[212:213], v[84:85] op_sel:[0,1] op_sel_hi:[1,1]
v_pk_mul_f32 v[216:217], v[216:217], v[86:87] op_sel:[0,0] op_sel_hi:[1,0]
v_pk_mul_f32 v[220:221], v[220:221], v[86:87] op_sel:[0,1] op_sel_hi:[1,1]
v_cvt_pk_bf16_f32 v32, v192, v196
v_cvt_pk_bf16_f32 v33, v200, v204
v_cvt_pk_bf16_f32 v34, v208, v212
v_cvt_pk_bf16_f32 v35, v216, v220
s_mov_b32 s56, 229376
buffer_store_dwordx4 v[32:35], v28, s[28:31], s56 offen nt
v_cvt_pk_bf16_f32 v36, v193, v197
v_cvt_pk_bf16_f32 v37, v201, v205
v_cvt_pk_bf16_f32 v38, v209, v213
v_cvt_pk_bf16_f32 v39, v217, v221
s_mov_b32 s56, 236544
buffer_store_dwordx4 v[36:39], v28, s[28:31], s56 offen nt
v_pk_mul_f32 v[194:195], v[194:195], v[80:81] op_sel:[0,0] op_sel_hi:[1,0]
v_pk_mul_f32 v[198:199], v[198:199], v[80:81] op_sel:[0,1] op_sel_hi:[1,1]
v_pk_mul_f32 v[202:203], v[202:203], v[82:83] op_sel:[0,0] op_sel_hi:[1,0]
v_pk_mul_f32 v[206:207], v[206:207], v[82:83] op_sel:[0,1] op_sel_hi:[1,1]
v_pk_mul_f32 v[210:211], v[210:211], v[84:85] op_sel:[0,0] op_sel_hi:[1,0]
v_pk_mul_f32 v[214:215], v[214:215], v[84:85] op_sel:[0,1] op_sel_hi:[1,1]
v_pk_mul_f32 v[218:219], v[218:219], v[86:87] op_sel:[0,0] op_sel_hi:[1,0]
v_pk_mul_f32 v[222:223], v[222:223], v[86:87] op_sel:[0,1] op_sel_hi:[1,1]
v_cvt_pk_bf16_f32 v40, v194, v198
v_cvt_pk_bf16_f32 v41, v202, v206
v_cvt_pk_bf16_f32 v42, v210, v214
v_cvt_pk_bf16_f32 v43, v218, v222
s_mov_b32 s56, 243712
buffer_store_dwordx4 v[40:43], v28, s[28:31], s56 offen nt
v_cvt_pk_bf16_f32 v44, v195, v199
v_cvt_pk_bf16_f32 v45, v203, v207
v_cvt_pk_bf16_f32 v46, v211, v215
v_cvt_pk_bf16_f32 v47, v219, v223
s_mov_b32 s56, 250880
buffer_store_dwordx4 v[44:47], v28, s[28:31], s56 offen nt
v_pk_mul_f32 v[224:225], v[224:225], v[80:81] op_sel:[0,0] op_sel_hi:[1,0]
v_pk_mul_f32 v[228:229], v[228:229], v[80:81] op_sel:[0,1] op_sel_hi:[1,1]
v_pk_mul_f32 v[232:233], v[232:233], v[82:83] op_sel:[0,0] op_sel_hi:[1,0]
v_pk_mul_f32 v[236:237], v[236:237], v[82:83] op_sel:[0,1] op_sel_hi:[1,1]
v_pk_mul_f32 v[240:241], v[240:241], v[84:85] op_sel:[0,0] op_sel_hi:[1,0]
v_pk_mul_f32 v[244:245], v[244:245], v[84:85] op_sel:[0,1] op_sel_hi:[1,1]
v_pk_mul_f32 v[248:249], v[248:249], v[86:87] op_sel:[0,0] op_sel_hi:[1,0]
v_pk_mul_f32 v[252:253], v[252:253], v[86:87] op_sel:[0,1] op_sel_hi:[1,1]
v_cvt_pk_bf16_f32 v48, v224, v228
v_cvt_pk_bf16_f32 v49, v232, v236
v_cvt_pk_bf16_f32 v50, v240, v244
v_cvt_pk_bf16_f32 v51, v248, v252
s_mov_b32 s56, 344064
buffer_store_dwordx4 v[48:51], v28, s[28:31], s56 offen nt
v_cvt_pk_bf16_f32 v52, v225, v229
v_cvt_pk_bf16_f32 v53, v233, v237
v_cvt_pk_bf16_f32 v54, v241, v245
v_cvt_pk_bf16_f32 v55, v249, v253
s_mov_b32 s56, 351232
buffer_store_dwordx4 v[52:55], v28, s[28:31], s56 offen nt
v_pk_mul_f32 v[226:227], v[226:227], v[80:81] op_sel:[0,0] op_sel_hi:[1,0]
v_pk_mul_f32 v[230:231], v[230:231], v[80:81] op_sel:[0,1] op_sel_hi:[1,1]
v_pk_mul_f32 v[234:235], v[234:235], v[82:83] op_sel:[0,0] op_sel_hi:[1,0]
v_pk_mul_f32 v[238:239], v[238:239], v[82:83] op_sel:[0,1] op_sel_hi:[1,1]
v_pk_mul_f32 v[242:243], v[242:243], v[84:85] op_sel:[0,0] op_sel_hi:[1,0]
v_pk_mul_f32 v[246:247], v[246:247], v[84:85] op_sel:[0,1] op_sel_hi:[1,1]
v_pk_mul_f32 v[250:251], v[250:251], v[86:87] op_sel:[0,0] op_sel_hi:[1,0]
v_pk_mul_f32 v[254:255], v[254:255], v[86:87] op_sel:[0,1] op_sel_hi:[1,1]
v_cvt_pk_bf16_f32 v56, v226, v230
v_cvt_pk_bf16_f32 v57, v234, v238
v_cvt_pk_bf16_f32 v58, v242, v246
v_cvt_pk_bf16_f32 v59, v250, v254
s_mov_b32 s56, 358400
buffer_store_dwordx4 v[56:59], v28, s[28:31], s56 offen nt
v_cvt_pk_bf16_f32 v60, v227, v231
v_cvt_pk_bf16_f32 v61, v235, v239
v_cvt_pk_bf16_f32 v62, v243, v247
v_cvt_pk_bf16_f32 v63, v251, v255
s_mov_b32 s56, 365568
buffer_store_dwordx4 v[60:63], v28, s[28:31], s56 offen nt
L_END:
s_endpgm
.section .rodata,"a"
.p2align 6
.amdhsa_kernel standalone__normalfloat_lut_af4__prompt_kernel
  .amdhsa_next_free_vgpr 352
  .amdhsa_next_free_sgpr 102
  .amdhsa_accum_offset 256
  .amdhsa_group_segment_fixed_size 0
  .amdhsa_kernarg_size 56
  .amdhsa_user_sgpr_count 2
  .amdhsa_user_sgpr_kernarg_segment_ptr 1
  .amdhsa_system_sgpr_workgroup_id_x 1
.end_amdhsa_kernel
```

```asm
; @launch grid=(256,1,1) block=(256,1,1) lds=163840
.amdgcn_target "amdgcn-amd-amdhsa--gfx950"
.text
.globl standalone__normalfloat_lut_af4__prompt_kernel
.p2align 8
.type standalone__normalfloat_lut_af4__prompt_kernel,@function
standalone__normalfloat_lut_af4__prompt_kernel:
s_load_dwordx4 s[4:7], s[0:1], 0
s_load_dwordx4 s[12:15], s[0:1], 40
s_load_dwordx4 s[8:11], s[0:1], 24
s_memrealtime s[56:57]
s_cmp_ge_u32 s2, 256
s_cbranch_scc1 L_END
s_getpc_b64 s[48:49]
L_PC0:
v_bfi_b32 v2, 7, v0, s2
v_lshlrev_b32 v2, 7, v2
v_min_u32 v2, L_END-L_PC0, v2
global_load_dword v7, v2, s[48:49]
v_lshrrev_b32 v1, 6, v0
s_cmp_lt_u32 s2, 32
v_readfirstlane_b32 s36, v1
s_cbranch_scc1 L_PACK
s_and_b32 s40, s2, 7
s_lshr_b32 s41, s2, 3
s_sub_u32 s41, s41, 4
s_and_b32 s43, s40, 1
s_lshr_b32 s38, s41, 2
s_mul_i32 s43, s43, 7
s_add_u32 s38, s38, s43
s_lshl2_add_u32 s39, s38, s36
v_bfe_u32 v6, v0, 4, 2
v_and_b32 v3, 15, v0
v_mul_u32_u24 v2, 114688, v6
v_lshl_add_u32 v30, v3, 4, v2
s_lshl_b32 s47, s39, 8
s_mov_b32 s86, 444672
s_mov_b32 s87, 0x20000
s_mov_b32 s92, 14336
s_mov_b32 s93, 28672
s_mov_b32 s94, 43008
s_mov_b32 s95, 57344
s_mov_b32 s96, 71680
s_mov_b32 s97, 86016
s_mov_b32 s98, 100352
s_sub_u32 s44, s2, 32
s_mul_i32 s45, s44, 4682
s_lshr_b32 s45, s45, 16
s_mul_i32 s46, s45, 14
s_sub_u32 s44, s44, s46
s_lshl2_add_u32 s44, s44, s36
s_lshr_b32 s46, s45, 1
s_and_b32 s34, s45, 1
s_lshl3_add_u32 s46, s46, s34
s_mul_i32 s46, s46, 57344
s_lshl_b32 s34, s44, 8
s_add_u32 s46, s46, s34
s_add_u32 s46, s46, 458752
s_waitcnt lgkmcnt(0)
s_add_u32 s84, s6, s46
s_addc_u32 s85, s7, 0
buffer_load_dwordx4 v[96:99], v30, s[84:87], 0 offen
buffer_load_dwordx4 v[100:103], v30, s[84:87], s92 offen
buffer_load_dwordx4 v[104:107], v30, s[84:87], s93 offen
buffer_load_dwordx4 v[108:111], v30, s[84:87], s94 offen
s_branch L_MAIN
L_PACK:
v_lshlrev_b32 v16, 3, v0
s_cmp_eq_u32 s2, 0
s_cselect_b32 s34, 128, 0
s_mov_b32 s35, 0x20000
s_waitcnt lgkmcnt(0)
s_mov_b64 s[32:33], s[12:13]
v_mov_b64 v[4:5], s[56:57]
buffer_store_dwordx2 v[4:5], v16, s[32:35], 0 offen sc1
v_and_b32 v0, 63, v0
v_lshrrev_b32 v2, 4, v0
v_and_b32 v3, 15, v0
v_mul_u32_u24 v2, 114688, v2
v_lshl_add_u32 v8, v3, 4, v2
s_movk_i32 s47, 0x3800
v_add_u32 v9, s47, v8
v_add_u32 v10, s47, v9
v_add_u32 v11, s47, v10
v_add_u32 v12, s47, v11
v_add_u32 v13, s47, v12
v_add_u32 v14, s47, v13
v_add_u32 v15, s47, v14
s_mul_i32 s40, s2, 4682
s_lshr_b32 s40, s40, 16
s_mul_i32 s41, s40, 14
s_sub_u32 s41, s2, s41
s_add_u32 s40, s40, 9
s_mov_b32 s22, 14680064
s_mov_b32 s23, 0x20000
s_lshl2_add_u32 s42, s41, s36
s_mul_i32 s43, s40, 458752
s_lshl_b32 s44, s42, 8
s_add_u32 s43, s43, s44
s_lshl_b32 s44, s42, 5
s_add_u32 s44, s44, s40
s_lshl_b32 s50, s44, 11
s_cmp_lt_u32 s40, 32
s_cselect_b32 s50, s50, -1
s_add_u32 s41, s41, 4
s_add_u32 s40, s40, 2
s_cmp_ge_u32 s41, 14
s_cselect_b32 s48, 14, 0
s_addc_u32 s40, s40, 0
s_sub_u32 s41, s41, s48
s_mov_b64 s[20:21], s[6:7]
buffer_load_dwordx4 v[32:35], v8, s[20:23], s43 offen
buffer_load_dwordx4 v[36:39], v9, s[20:23], s43 offen
buffer_load_dwordx4 v[40:43], v10, s[20:23], s43 offen
buffer_load_dwordx4 v[44:47], v11, s[20:23], s43 offen
buffer_load_dwordx4 v[48:51], v12, s[20:23], s43 offen
buffer_load_dwordx4 v[52:55], v13, s[20:23], s43 offen
buffer_load_dwordx4 v[56:59], v14, s[20:23], s43 offen
buffer_load_dwordx4 v[60:63], v15, s[20:23], s43 offen
s_mov_b64 s[24:25], s[14:15]
s_mov_b32 s26, 3670016
s_mov_b32 s27, 0x20000
s_movk_i32 s34, 128
v_mov_b32 v16, 0
v_lshlrev_b32 v18, 4, v0
s_movk_i32 s46, 4096
s_lshl2_add_u32 s42, s41, s36
s_mul_i32 s43, s40, 458752
s_lshl_b32 s44, s42, 8
s_add_u32 s43, s43, s44
s_lshl_b32 s44, s42, 5
s_add_u32 s44, s44, s40
s_lshl_b32 s51, s44, 11
s_cmp_lt_u32 s40, 32
s_cselect_b32 s51, s51, -1
s_add_u32 s41, s41, 4
s_add_u32 s40, s40, 2
s_cmp_ge_u32 s41, 14
s_cselect_b32 s48, 14, 0
s_addc_u32 s40, s40, 0
s_sub_u32 s41, s41, s48
buffer_load_dwordx4 v[64:67], v8, s[20:23], s43 offen
buffer_load_dwordx4 v[68:71], v9, s[20:23], s43 offen
buffer_load_dwordx4 v[72:75], v10, s[20:23], s43 offen
buffer_load_dwordx4 v[76:79], v11, s[20:23], s43 offen
buffer_load_dwordx4 v[80:83], v12, s[20:23], s43 offen
buffer_load_dwordx4 v[84:87], v13, s[20:23], s43 offen
buffer_load_dwordx4 v[88:91], v14, s[20:23], s43 offen
buffer_load_dwordx4 v[92:95], v15, s[20:23], s43 offen
s_load_dwordx2 s[52:53], s[12:13], 0
s_waitcnt vmcnt(8)
v_lshl_add_u64 v[32:33], v[36:37], 4, v[32:33]
v_lshl_add_u64 v[34:35], v[38:39], 4, v[34:35]
v_lshl_add_u64 v[40:41], v[44:45], 4, v[40:41]
v_lshl_add_u64 v[42:43], v[46:47], 4, v[42:43]
v_lshl_or_b32 v32, v40, 8, v32
v_lshl_or_b32 v33, v41, 8, v33
v_lshl_or_b32 v34, v42, 8, v34
v_lshl_or_b32 v35, v43, 8, v35
v_lshl_or_b32 v20, v33, 16, v32
v_lshl_or_b32 v21, v35, 16, v34
v_lshl_add_u64 v[48:49], v[52:53], 4, v[48:49]
v_lshl_add_u64 v[50:51], v[54:55], 4, v[50:51]
v_lshl_add_u64 v[56:57], v[60:61], 4, v[56:57]
v_lshl_add_u64 v[58:59], v[62:63], 4, v[58:59]
v_lshl_or_b32 v48, v56, 8, v48
v_lshl_or_b32 v49, v57, 8, v49
v_lshl_or_b32 v50, v58, 8, v50
v_lshl_or_b32 v51, v59, 8, v51
v_lshl_or_b32 v24, v49, 16, v48
v_lshl_or_b32 v25, v51, 16, v50
s_waitcnt lgkmcnt(0)
v_mov_b64 v[22:23], s[52:53]
s_nop 0
L_PKN:
v_cmp_ne_u64 vcc, 0, v[22:23]
s_sub_u32 s46, s46, 1
s_cmp_gt_i32 s46, 0
s_cbranch_vccnz L_PKGO
s_cbranch_scc0 L_END
buffer_load_dwordx2 v[22:23], v16, s[32:35], 0 offen sc1
s_waitcnt vmcnt(0)
s_branch L_PKN
L_PKGO:
v_mov_b64 v[26:27], v[22:23]
L_PKLOOP:
buffer_store_dwordx4 v[20:23], v18, s[24:27], s50 offen offset:0 sc1
buffer_store_dwordx4 v[24:27], v18, s[24:27], s50 offen offset:1024 sc1
s_cmp_eq_u32 s51, -1
s_cbranch_scc1 L_PKEND
s_lshl2_add_u32 s42, s41, s36
s_mul_i32 s43, s40, 458752
s_lshl_b32 s44, s42, 8
s_add_u32 s43, s43, s44
s_lshl_b32 s44, s42, 5
s_add_u32 s44, s44, s40
s_lshl_b32 s50, s44, 11
s_cmp_lt_u32 s40, 32
s_cselect_b32 s50, s50, -1
s_add_u32 s41, s41, 4
s_add_u32 s40, s40, 2
s_cmp_ge_u32 s41, 14
s_cselect_b32 s48, 14, 0
s_addc_u32 s40, s40, 0
s_sub_u32 s41, s41, s48
buffer_load_dwordx4 v[32:35], v8, s[20:23], s43 offen
buffer_load_dwordx4 v[36:39], v9, s[20:23], s43 offen
buffer_load_dwordx4 v[40:43], v10, s[20:23], s43 offen
buffer_load_dwordx4 v[44:47], v11, s[20:23], s43 offen
buffer_load_dwordx4 v[48:51], v12, s[20:23], s43 offen
buffer_load_dwordx4 v[52:55], v13, s[20:23], s43 offen
buffer_load_dwordx4 v[56:59], v14, s[20:23], s43 offen
buffer_load_dwordx4 v[60:63], v15, s[20:23], s43 offen
s_waitcnt vmcnt(10)
v_lshl_add_u64 v[64:65], v[68:69], 4, v[64:65]
v_lshl_add_u64 v[66:67], v[70:71], 4, v[66:67]
v_lshl_add_u64 v[72:73], v[76:77], 4, v[72:73]
v_lshl_add_u64 v[74:75], v[78:79], 4, v[74:75]
v_lshl_or_b32 v64, v72, 8, v64
v_lshl_or_b32 v65, v73, 8, v65
v_lshl_or_b32 v66, v74, 8, v66
v_lshl_or_b32 v67, v75, 8, v67
v_lshl_or_b32 v20, v65, 16, v64
v_lshl_or_b32 v21, v67, 16, v66
v_lshl_add_u64 v[80:81], v[84:85], 4, v[80:81]
v_lshl_add_u64 v[82:83], v[86:87], 4, v[82:83]
v_lshl_add_u64 v[88:89], v[92:93], 4, v[88:89]
v_lshl_add_u64 v[90:91], v[94:95], 4, v[90:91]
v_lshl_or_b32 v80, v88, 8, v80
v_lshl_or_b32 v81, v89, 8, v81
v_lshl_or_b32 v82, v90, 8, v82
v_lshl_or_b32 v83, v91, 8, v83
v_lshl_or_b32 v24, v81, 16, v80
v_lshl_or_b32 v25, v83, 16, v82
buffer_store_dwordx4 v[20:23], v18, s[24:27], s51 offen offset:0 sc1
buffer_store_dwordx4 v[24:27], v18, s[24:27], s51 offen offset:1024 sc1
s_cmp_eq_u32 s50, -1
s_cbranch_scc1 L_PKEND
s_lshl2_add_u32 s42, s41, s36
s_mul_i32 s43, s40, 458752
s_lshl_b32 s44, s42, 8
s_add_u32 s43, s43, s44
s_lshl_b32 s44, s42, 5
s_add_u32 s44, s44, s40
s_lshl_b32 s51, s44, 11
s_cmp_lt_u32 s40, 32
s_cselect_b32 s51, s51, -1
s_add_u32 s41, s41, 4
s_add_u32 s40, s40, 2
s_cmp_ge_u32 s41, 14
s_cselect_b32 s48, 14, 0
s_addc_u32 s40, s40, 0
s_sub_u32 s41, s41, s48
buffer_load_dwordx4 v[64:67], v8, s[20:23], s43 offen
buffer_load_dwordx4 v[68:71], v9, s[20:23], s43 offen
buffer_load_dwordx4 v[72:75], v10, s[20:23], s43 offen
buffer_load_dwordx4 v[76:79], v11, s[20:23], s43 offen
buffer_load_dwordx4 v[80:83], v12, s[20:23], s43 offen
buffer_load_dwordx4 v[84:87], v13, s[20:23], s43 offen
buffer_load_dwordx4 v[88:91], v14, s[20:23], s43 offen
buffer_load_dwordx4 v[92:95], v15, s[20:23], s43 offen
s_waitcnt vmcnt(10)
v_lshl_add_u64 v[32:33], v[36:37], 4, v[32:33]
v_lshl_add_u64 v[34:35], v[38:39], 4, v[34:35]
v_lshl_add_u64 v[40:41], v[44:45], 4, v[40:41]
v_lshl_add_u64 v[42:43], v[46:47], 4, v[42:43]
v_lshl_or_b32 v32, v40, 8, v32
v_lshl_or_b32 v33, v41, 8, v33
v_lshl_or_b32 v34, v42, 8, v34
v_lshl_or_b32 v35, v43, 8, v35
v_lshl_or_b32 v20, v33, 16, v32
v_lshl_or_b32 v21, v35, 16, v34
v_lshl_add_u64 v[48:49], v[52:53], 4, v[48:49]
v_lshl_add_u64 v[50:51], v[54:55], 4, v[50:51]
v_lshl_add_u64 v[56:57], v[60:61], 4, v[56:57]
v_lshl_add_u64 v[58:59], v[62:63], 4, v[58:59]
v_lshl_or_b32 v48, v56, 8, v48
v_lshl_or_b32 v49, v57, 8, v49
v_lshl_or_b32 v50, v58, 8, v50
v_lshl_or_b32 v51, v59, 8, v51
v_lshl_or_b32 v24, v49, 16, v48
v_lshl_or_b32 v25, v51, 16, v50
s_branch L_PKLOOP
L_PKEND:
s_endpgm
L_MAIN:
s_lshr_b32 s42, s40, 1
s_and_b32 s37, s41, 3
s_lshl2_add_u32 s37, s42, s37
s_mov_b64 s[20:21], s[4:5]
s_mov_b32 s22, 4194304
s_mov_b32 s23, 0x20000
s_lshl_b32 s46, s37, 18
v_lshrrev_b32 v5, 3, v0
v_lshl_add_u32 v2, v5, 11, s46
v_lshrrev_b32 v4, 4, v0
v_xor_b32 v4, v4, v0
v_and_b32 v4, 7, v4
v_lshl_add_u32 v8, v4, 4, v2
v_add_u32 v9, 65536, v8
v_add_u32 v10, 131072, v8
v_add_u32 v11, 196608, v8
s_lshl_b32 s33, s36, 10
s_lshl_b32 s44, s44, 6
s_add_u32 s44, s44, s45
s_add_u32 s44, s44, 2
s_lshl_b32 s44, s44, 10
s_add_u32 s76, s14, s44
s_addc_u32 s77, s15, 0
s_min_u32 s78, s86, 1024
s_mov_b32 s79, 0x20000
s_add_u32 s84, s6, s47
s_addc_u32 s85, s7, 0
s_mov_b32 s86, 444672
s_add_u32 m0, s33, 65536
s_nop 0
buffer_load_dwordx4 v8, s[20:23], 0 offen offset:0 lds
s_add_u32 m0, s33, 69632
s_nop 0
buffer_load_dwordx4 v9, s[20:23], 0 offen offset:0 lds
s_add_u32 m0, s33, 73728
s_nop 0
buffer_load_dwordx4 v10, s[20:23], 0 offen offset:0 lds
s_add_u32 m0, s33, 77824
s_nop 0
buffer_load_dwordx4 v11, s[20:23], 0 offen offset:0 lds
v_mov_b32 v2, 0x3da3bf80
s_lshl_b64 exec, exec, 8
v_mov_b32 v2, 0x3e25bf32
s_lshl_b64 exec, exec, 8
v_mov_b32 v2, 0x3e7cbf06
s_lshl_b64 exec, exec, 8
v_mov_b32 v2, 0x3eadbeca
s_lshl_b64 exec, exec, 8
v_mov_b32 v2, 0x3ee2be92
s_lshl_b64 exec, exec, 8
v_mov_b32 v2, 0x3f10be3d
s_lshl_b64 exec, exec, 8
v_mov_b32 v2, 0x3f39bdba
s_lshl_b64 exec, exec, 8
v_mov_b32 v2, 0x3f800000
s_mov_b64 exec, -1
s_and_b32 s45, s36, 1
s_mul_i32 s45, s45, 0x0202
s_lshr_b32 s46, s36, 1
s_mul_i32 s46, s46, 0x02020000
s_add_u32 s45, s45, s46
s_add_u32 s45, s45, 0x05040100
v_mov_b32 v4, s45
v_lshlrev_b32 v5, 8, v5
v_and_b32 v31, 7, v0
v_lshl_add_u32 v31, v31, 4, v5
s_mov_b32 s45, 0xbf32bf80
v_perm_b32 v128, s45, v2, v4
v_mov_b32 v129, v128
v_mov_b64 v[130:131], v[128:129]
ds_write_b128 v31, v[128:131] offset:0
s_mov_b32 s45, 0xbecabf06
v_perm_b32 v132, s45, v2, v4
v_mov_b32 v133, v132
v_mov_b64 v[134:135], v[132:133]
v_and_b32 v5, 31, v0
v_lshlrev_b32 v19, 2, v5
v_and_b32 v0, 63, v0
s_lshl_b32 s46, s39, 7
ds_write_b128 v31, v[132:135] offset:8192
s_mov_b32 s45, 0xbe3dbe92
v_perm_b32 v136, s45, v2, v4
v_mov_b32 v137, v136
v_mov_b64 v[138:139], v[136:137]
v_lshl_add_u32 v28, v3, 3, s46
s_mul_i32 s47, s37, 917504
s_add_u32 s47, s47, s46
s_add_u32 s28, s10, s47
s_addc_u32 s29, s11, 0
ds_write_b128 v31, v[136:139] offset:16384
s_mov_b32 s45, 0xbdba
v_perm_b32 v140, s45, v2, v4
v_mov_b32 v141, v140
v_mov_b64 v[142:143], v[140:141]
s_mov_b32 s30, 86144
s_mov_b32 s31, 0x20000
v_mul_u32_u24 v29, 28672, v6
v_lshl_add_u32 v18, v3, 3, v29
ds_write_b128 v31, v[140:143] offset:24576
s_mov_b32 s45, 0x3e253da3
v_perm_b32 v144, s45, v2, v4
v_mov_b32 v145, v144
v_mov_b64 v[146:147], v[144:145]
v_lshlrev_b32 v29, 7, v3
v_bfe_u32 v5, v0, 1, 3
v_xor_b32 v5, v5, v6
v_lshl_add_u32 v29, v5, 4, v29
ds_write_b128 v31, v[144:147] offset:32768
s_mov_b32 s45, 0x3ead3e7c
v_perm_b32 v148, s45, v2, v4
v_mov_b32 v149, v148
v_mov_b64 v[150:151], v[148:149]
v_add_u32 v14, 65536, v29
v_xor_b32 v15, 64, v14
v_add_u32 v16, 0x10000, v14
v_add_u32 v17, 0x10000, v15
ds_write_b128 v31, v[148:151] offset:40960
s_mov_b32 s45, 0x3f103ee2
v_perm_b32 v152, s45, v2, v4
v_mov_b32 v153, v152
v_mov_b64 v[154:155], v[152:153]
s_mov_b32 s52, 0x0c0c0400
s_mov_b32 s53, 0x0c0c0500
s_mov_b32 s54, 0x0c0c0600
s_mov_b32 s55, 0x0c0c0700
ds_write_b128 v31, v[152:155] offset:49152
s_mov_b32 s45, 0x3f803f39
v_perm_b32 v156, s45, v2, v4
v_mov_b32 v157, v156
v_mov_b64 v[158:159], v[156:157]
v_lshlrev_b32 v13, 4, v0
v_add_u32 v12, 0, v13
s_lshl_b32 s47, s39, 16
s_add_u32 s24, s14, s47
s_addc_u32 s25, s15, 0
ds_write_b128 v31, v[156:159] offset:57344
s_mov_b32 s26, 65536
s_mov_b32 s27, 0x20000
s_mov_b64 s[80:81], s[12:13]
s_movk_i32 s82, 128
s_mov_b32 s83, 0x20000
s_movk_i32 s90, 4096
s_waitcnt lgkmcnt(0)
s_barrier
s_load_dwordx2 s[88:89], s[12:13], 0
s_waitcnt vmcnt(4)
v_lshl_add_u64 v[96:97], v[100:101], 4, v[96:97]
v_lshl_add_u64 v[98:99], v[102:103], 4, v[98:99]
v_lshl_add_u64 v[104:105], v[108:109], 4, v[104:105]
v_lshl_add_u64 v[106:107], v[110:111], 4, v[106:107]
v_lshl_or_b32 v96, v104, 8, v96
v_lshl_or_b32 v97, v105, 8, v97
v_lshl_or_b32 v98, v106, 8, v98
v_lshl_or_b32 v99, v107, 8, v99
v_lshl_or_b32 v112, v97, 16, v96
v_lshl_or_b32 v113, v99, 16, v98
s_waitcnt lgkmcnt(0)
s_cmp_eq_u64 s[88:89], 0
s_cbranch_scc1 L_NOTAG
L_TAGOK:
v_mov_b64 v[114:115], s[88:89]
buffer_store_dwordx4 v[112:115], v13, s[76:79], 0 offen sc1
buffer_load_dwordx4 v[64:67], v30, s[84:87], 0 offen
buffer_load_dwordx4 v[68:71], v30, s[84:87], s92 offen
buffer_load_dwordx4 v[72:75], v30, s[84:87], s93 offen
buffer_load_dwordx4 v[76:79], v30, s[84:87], s94 offen
buffer_load_dwordx4 v[80:83], v30, s[84:87], s95 offen
buffer_load_dwordx4 v[84:87], v30, s[84:87], s96 offen
buffer_load_dwordx4 v[88:91], v30, s[84:87], s97 offen
buffer_load_dwordx4 v[92:95], v30, s[84:87], s98 offen
s_waitcnt vmcnt(8)
buffer_load_dwordx4 v[32:35], v12, s[24:27], 0 offen offset:2048 sc1
buffer_load_dwordx4 v[36:39], v12, s[24:27], 0 offen offset:3072 sc1
v_add_u32 v12, 4096, v12
s_add_u32 m0, s33, 81792
s_waitcnt vmcnt(8)
buffer_load_dwordx4 v8, s[20:23], 0 offen offset:128 lds
v_lshl_add_u64 v[64:65], v[68:69], 4, v[64:65]
v_lshl_add_u64 v[66:67], v[70:71], 4, v[66:67]
v_lshl_add_u32 v64, v64, 8, v19
v_lshl_add_u32 v65, v65, 8, v19
v_lshl_add_u32 v66, v66, 8, v19
v_lshl_add_u32 v67, v67, 8, v19
ds_read_b32 a0, v64
ds_read_b32 a4, v65
ds_read_b32 a8, v66
ds_read_b32 a12, v67
s_waitcnt vmcnt(7)
v_lshl_add_u64 v[72:73], v[76:77], 4, v[72:73]
v_lshl_add_u64 v[74:75], v[78:79], 4, v[74:75]
v_lshl_add_u32 v72, v72, 8, v19
v_lshl_add_u32 v73, v73, 8, v19
v_lshl_add_u32 v74, v74, 8, v19
v_lshl_add_u32 v75, v75, 8, v19
ds_read_b32 a1, v72
ds_read_b32 a5, v73
ds_read_b32 a9, v74
ds_read_b32 a13, v75
s_waitcnt vmcnt(5)
buffer_load_dwordx4 v[40:43], v12, s[24:27], 0 offen offset:0 sc1
v_lshl_add_u64 v[80:81], v[84:85], 4, v[80:81]
v_lshl_add_u64 v[82:83], v[86:87], 4, v[82:83]
v_lshl_add_u32 v80, v80, 8, v19
v_lshl_add_u32 v81, v81, 8, v19
v_lshl_add_u32 v82, v82, 8, v19
v_lshl_add_u32 v83, v83, 8, v19
ds_read_b32 a2, v80
ds_read_b32 a6, v81
ds_read_b32 a10, v82
ds_read_b32 a14, v83
s_waitcnt vmcnt(4)
buffer_load_dwordx4 v[44:47], v12, s[24:27], 0 offen offset:1024 sc1
v_lshl_add_u64 v[88:89], v[92:93], 4, v[88:89]
v_lshl_add_u64 v[90:91], v[94:95], 4, v[90:91]
v_lshl_add_u32 v88, v88, 8, v19
v_lshl_add_u32 v89, v89, 8, v19
v_lshl_add_u32 v90, v90, 8, v19
v_lshl_add_u32 v91, v91, 8, v19
ds_read_b32 a3, v88
ds_read_b32 a7, v89
ds_read_b32 a11, v90
ds_read_b32 a15, v91
s_barrier
ds_read_b128 a[224:227], v14 offset:0
s_add_u32 m0, s33, 85888
ds_read_b128 a[228:231], v14 offset:2048
buffer_load_dwordx4 v9, s[20:23], 0 offen offset:128 lds
s_waitcnt vmcnt(4)
s_add_u32 m0, s33, 89984
v_cmp_ne_u64 s[50:51], s[88:89], v[34:35]
v_cmp_ne_u64 vcc, s[88:89], v[38:39]
s_waitcnt lgkmcnt(1)
v_mfma_f32_16x16x32_bf16 v[128:131], a[224:227], a[0:3], 0
s_or_b64 vcc, vcc, s[50:51]
ds_read_b128 a[232:235], v14 offset:4096
buffer_load_dwordx4 v10, s[20:23], 0 offen offset:128 lds
v_mfma_f32_16x16x32_bf16 v[132:135], a[224:227], a[4:7], 0
s_cbranch_scc1 L_SLOW1
L_BACK1:
v_mfma_f32_16x16x32_bf16 v[136:139], a[224:227], a[8:11], 0
s_add_u32 m0, s33, 94080
v_mfma_f32_16x16x32_bf16 v[140:143], a[224:227], a[12:15], 0
s_waitcnt lgkmcnt(1)
v_mfma_f32_16x16x32_bf16 v[144:147], a[228:231], a[0:3], 0
ds_read_b128 a[236:239], v14 offset:6144
buffer_load_dwordx4 v11, s[20:23], 0 offen offset:128 lds
v_mfma_f32_16x16x32_bf16 v[148:151], a[228:231], a[4:7], 0
v_perm_b32 v63, v32, v19, s52
v_mfma_f32_16x16x32_bf16 v[152:155], a[228:231], a[8:11], 0
ds_read_b32 a16, v63
v_perm_b32 v62, v32, v19, s53
v_mfma_f32_16x16x32_bf16 v[156:159], a[228:231], a[12:15], 0
s_waitcnt lgkmcnt(2)
ds_read_b32 a17, v62
v_mfma_f32_16x16x32_bf16 v[160:163], a[232:235], a[0:3], 0
ds_read_b128 a[240:243], v14 offset:8192
v_perm_b32 v61, v36, v19, s52
v_mfma_f32_16x16x32_bf16 v[164:167], a[232:235], a[4:7], 0
ds_read_b32 a18, v61
v_perm_b32 v60, v36, v19, s53
v_mfma_f32_16x16x32_bf16 v[168:171], a[232:235], a[8:11], 0
s_add_u32 m0, s33, 98048
ds_read_b32 a19, v60
v_perm_b32 v59, v32, v19, s54
v_mfma_f32_16x16x32_bf16 v[172:175], a[232:235], a[12:15], 0
s_waitcnt lgkmcnt(4)
ds_read_b32 a20, v59
v_perm_b32 v58, v32, v19, s55
v_mfma_f32_16x16x32_bf16 v[176:179], a[236:239], a[0:3], 0
ds_read_b128 a[244:247], v14 offset:10240
buffer_load_dwordx4 v8, s[20:23], 0 offen offset:256 lds
v_mfma_f32_16x16x32_bf16 v[180:183], a[236:239], a[4:7], 0
ds_read_b32 a21, v58
v_perm_b32 v57, v36, v19, s54
v_mfma_f32_16x16x32_bf16 v[184:187], a[236:239], a[8:11], 0
ds_read_b32 a22, v57
v_perm_b32 v56, v36, v19, s55
v_mfma_f32_16x16x32_bf16 v[188:191], a[236:239], a[12:15], 0
s_waitcnt lgkmcnt(4)
ds_read_b32 a23, v56
buffer_load_dwordx4 v[48:51], v12, s[24:27], 0 offen offset:2048 sc1
v_mfma_f32_16x16x32_bf16 v[192:195], a[240:243], a[0:3], 0
ds_read_b128 a[248:251], v14 offset:12288
v_perm_b32 v63, v33, v19, s52
v_mfma_f32_16x16x32_bf16 v[196:199], a[240:243], a[4:7], 0
ds_read_b32 a24, v63
v_perm_b32 v62, v33, v19, s53
v_mfma_f32_16x16x32_bf16 v[200:203], a[240:243], a[8:11], 0
ds_read_b32 a25, v62
v_perm_b32 v61, v37, v19, s52
v_mfma_f32_16x16x32_bf16 v[204:207], a[240:243], a[12:15], 0
s_waitcnt lgkmcnt(4)
ds_read_b32 a26, v61
buffer_load_dwordx4 v[52:55], v12, s[24:27], 0 offen offset:3072 sc1
v_mfma_f32_16x16x32_bf16 v[208:211], a[244:247], a[0:3], 0
ds_read_b128 a[252:255], v14 offset:14336
v_perm_b32 v60, v37, v19, s53
v_mfma_f32_16x16x32_bf16 v[212:215], a[244:247], a[4:7], 0
ds_read_b32 a27, v60
v_perm_b32 v59, v33, v19, s54
v_mfma_f32_16x16x32_bf16 v[216:219], a[244:247], a[8:11], 0
s_add_u32 m0, s33, 102144
ds_read_b32 a28, v59
v_perm_b32 v58, v33, v19, s55
v_mfma_f32_16x16x32_bf16 v[220:223], a[244:247], a[12:15], 0
s_waitcnt lgkmcnt(4)
ds_read_b32 a29, v58
v_perm_b32 v57, v37, v19, s54
v_mfma_f32_16x16x32_bf16 v[224:227], a[248:251], a[0:3], 0
ds_read_b128 a[224:227], v15 offset:0
buffer_load_dwordx4 v9, s[20:23], 0 offen offset:256 lds
v_mfma_f32_16x16x32_bf16 v[228:231], a[248:251], a[4:7], 0
ds_read_b32 a30, v57
v_perm_b32 v56, v37, v19, s55
v_mfma_f32_16x16x32_bf16 v[232:235], a[248:251], a[8:11], 0
ds_read_b32 a31, v56
v_add_u32 v12, 4096, v12
v_mfma_f32_16x16x32_bf16 v[236:239], a[248:251], a[12:15], 0
s_waitcnt lgkmcnt(4)
v_mfma_f32_16x16x32_bf16 v[240:243], a[252:255], a[0:3], 0
ds_read_b128 a[228:231], v15 offset:2048
v_mfma_f32_16x16x32_bf16 v[244:247], a[252:255], a[4:7], 0
v_mfma_f32_16x16x32_bf16 v[248:251], a[252:255], a[8:11], 0
s_waitcnt vmcnt(7)
v_cmp_ne_u64 s[50:51], s[88:89], v[42:43]
v_cmp_ne_u64 vcc, s[88:89], v[46:47]
v_mfma_f32_16x16x32_bf16 v[252:255], a[252:255], a[12:15], 0
s_waitcnt lgkmcnt(1)
buffer_load_dwordx4 v[96:99], v12, s[24:27], 0 offen offset:0 sc1
v_mfma_f32_16x16x32_bf16 v[128:131], a[224:227], a[16:19], v[128:131]
s_or_b64 vcc, vcc, s[50:51]
ds_read_b128 a[232:235], v15 offset:4096
buffer_load_dwordx4 v[100:103], v12, s[24:27], 0 offen offset:1024 sc1
v_mfma_f32_16x16x32_bf16 v[132:135], a[224:227], a[20:23], v[132:135]
s_cbranch_scc1 L_SLOW2
L_BACK2:
v_mfma_f32_16x16x32_bf16 v[136:139], a[224:227], a[24:27], v[136:139]
s_add_u32 m0, s33, 106240
global_load_dwordx2 v[20:21], v28, s[8:9]
v_mfma_f32_16x16x32_bf16 v[140:143], a[224:227], a[28:31], v[140:143]
s_waitcnt lgkmcnt(1)
v_mfma_f32_16x16x32_bf16 v[144:147], a[228:231], a[16:19], v[144:147]
ds_read_b128 a[236:239], v15 offset:6144
buffer_load_dwordx4 v10, s[20:23], 0 offen offset:256 lds
v_mfma_f32_16x16x32_bf16 v[148:151], a[228:231], a[20:23], v[148:151]
v_perm_b32 v63, v40, v19, s52
v_mfma_f32_16x16x32_bf16 v[152:155], a[228:231], a[24:27], v[152:155]
ds_read_b32 a32, v63
v_perm_b32 v62, v40, v19, s53
v_mfma_f32_16x16x32_bf16 v[156:159], a[228:231], a[28:31], v[156:159]
s_waitcnt lgkmcnt(2)
ds_read_b32 a33, v62
v_mfma_f32_16x16x32_bf16 v[160:163], a[232:235], a[16:19], v[160:163]
ds_read_b128 a[240:243], v15 offset:8192
v_perm_b32 v61, v44, v19, s52
v_mfma_f32_16x16x32_bf16 v[164:167], a[232:235], a[20:23], v[164:167]
ds_read_b32 a34, v61
v_perm_b32 v60, v44, v19, s53
v_mfma_f32_16x16x32_bf16 v[168:171], a[232:235], a[24:27], v[168:171]
ds_read_b32 a35, v60
v_perm_b32 v59, v40, v19, s54
v_mfma_f32_16x16x32_bf16 v[172:175], a[232:235], a[28:31], v[172:175]
s_waitcnt lgkmcnt(4)
ds_read_b32 a36, v59
v_mfma_f32_16x16x32_bf16 v[176:179], a[236:239], a[16:19], v[176:179]
ds_read_b128 a[244:247], v15 offset:10240
v_perm_b32 v58, v40, v19, s55
v_mfma_f32_16x16x32_bf16 v[180:183], a[236:239], a[20:23], v[180:183]
ds_read_b32 a37, v58
v_perm_b32 v57, v44, v19, s54
v_mfma_f32_16x16x32_bf16 v[184:187], a[236:239], a[24:27], v[184:187]
s_add_u32 m0, s33, 110336
ds_read_b32 a38, v57
v_perm_b32 v56, v44, v19, s55
v_mfma_f32_16x16x32_bf16 v[188:191], a[236:239], a[28:31], v[188:191]
s_waitcnt lgkmcnt(4)
ds_read_b32 a39, v56
v_perm_b32 v63, v41, v19, s52
v_mfma_f32_16x16x32_bf16 v[192:195], a[240:243], a[16:19], v[192:195]
ds_read_b128 a[248:251], v15 offset:12288
buffer_load_dwordx4 v11, s[20:23], 0 offen offset:256 lds
v_mfma_f32_16x16x32_bf16 v[196:199], a[240:243], a[20:23], v[196:199]
ds_read_b32 a40, v63
v_perm_b32 v62, v41, v19, s53
v_mfma_f32_16x16x32_bf16 v[200:203], a[240:243], a[24:27], v[200:203]
ds_read_b32 a41, v62
v_perm_b32 v61, v45, v19, s52
v_mfma_f32_16x16x32_bf16 v[204:207], a[240:243], a[28:31], v[204:207]
s_waitcnt lgkmcnt(4)
ds_read_b32 a42, v61
v_mfma_f32_16x16x32_bf16 v[208:211], a[244:247], a[16:19], v[208:211]
ds_read_b128 a[252:255], v15 offset:14336
v_perm_b32 v60, v45, v19, s53
v_mfma_f32_16x16x32_bf16 v[212:215], a[244:247], a[20:23], v[212:215]
ds_read_b32 a43, v60
v_perm_b32 v59, v41, v19, s54
v_mfma_f32_16x16x32_bf16 v[216:219], a[244:247], a[24:27], v[216:219]
ds_read_b32 a44, v59
v_perm_b32 v58, v41, v19, s55
v_mfma_f32_16x16x32_bf16 v[220:223], a[244:247], a[28:31], v[220:223]
s_waitcnt lgkmcnt(4)
ds_read_b32 a45, v58
v_mfma_f32_16x16x32_bf16 v[224:227], a[248:251], a[16:19], v[224:227]
s_waitcnt vmcnt(9)
s_barrier
ds_read_b128 a[224:227], v14 offset:16384
v_perm_b32 v57, v45, v19, s54
v_mfma_f32_16x16x32_bf16 v[228:231], a[248:251], a[20:23], v[228:231]
ds_read_b32 a46, v57
v_perm_b32 v56, v45, v19, s55
v_mfma_f32_16x16x32_bf16 v[232:235], a[248:251], a[24:27], v[232:235]
ds_read_b32 a47, v56
v_mfma_f32_16x16x32_bf16 v[236:239], a[248:251], a[28:31], v[236:239]
s_waitcnt lgkmcnt(4)
v_mfma_f32_16x16x32_bf16 v[240:243], a[252:255], a[16:19], v[240:243]
ds_read_b128 a[228:231], v14 offset:18432
v_mfma_f32_16x16x32_bf16 v[244:247], a[252:255], a[20:23], v[244:247]
v_mfma_f32_16x16x32_bf16 v[248:251], a[252:255], a[24:27], v[248:251]
v_mfma_f32_16x16x32_bf16 v[252:255], a[252:255], a[28:31], v[252:255]
s_waitcnt vmcnt(6) lgkmcnt(1)
v_cmp_ne_u64 s[50:51], s[88:89], v[50:51]
v_cmp_ne_u64 vcc, s[88:89], v[54:55]
v_mfma_f32_16x16x32_bf16 v[128:131], a[224:227], a[32:35], v[128:131]
ds_read_b128 a[232:235], v14 offset:20480
buffer_load_dwordx4 v[104:107], v12, s[24:27], 0 offen offset:2048 sc1
v_mfma_f32_16x16x32_bf16 v[132:135], a[224:227], a[36:39], v[132:135]
s_or_b64 vcc, vcc, s[50:51]
buffer_load_dwordx4 v[108:111], v12, s[24:27], 0 offen offset:3072 sc1
v_mfma_f32_16x16x32_bf16 v[136:139], a[224:227], a[40:43], v[136:139]
s_cbranch_scc1 L_SLOW3
L_BACK3:
v_mfma_f32_16x16x32_bf16 v[140:143], a[224:227], a[44:47], v[140:143]
s_waitcnt lgkmcnt(1)
v_add_u32 v12, 4096, v12
v_mfma_f32_16x16x32_bf16 v[144:147], a[228:231], a[32:35], v[144:147]
ds_read_b128 a[236:239], v14 offset:22528
v_mfma_f32_16x16x32_bf16 v[148:151], a[228:231], a[36:39], v[148:151]
v_perm_b32 v63, v48, v19, s52
v_mfma_f32_16x16x32_bf16 v[152:155], a[228:231], a[40:43], v[152:155]
ds_read_b32 a48, v63
v_perm_b32 v62, v48, v19, s53
v_mfma_f32_16x16x32_bf16 v[156:159], a[228:231], a[44:47], v[156:159]
s_waitcnt lgkmcnt(2)
ds_read_b32 a49, v62
v_mfma_f32_16x16x32_bf16 v[160:163], a[232:235], a[32:35], v[160:163]
ds_read_b128 a[240:243], v14 offset:24576
v_perm_b32 v61, v52, v19, s52
v_mfma_f32_16x16x32_bf16 v[164:167], a[232:235], a[36:39], v[164:167]
ds_read_b32 a50, v61
v_perm_b32 v60, v52, v19, s53
v_mfma_f32_16x16x32_bf16 v[168:171], a[232:235], a[40:43], v[168:171]
s_add_u32 m0, s33, 114304
ds_read_b32 a51, v60
v_perm_b32 v59, v48, v19, s54
v_mfma_f32_16x16x32_bf16 v[172:175], a[232:235], a[44:47], v[172:175]
s_waitcnt lgkmcnt(4)
ds_read_b32 a52, v59
v_perm_b32 v58, v48, v19, s55
v_mfma_f32_16x16x32_bf16 v[176:179], a[236:239], a[32:35], v[176:179]
ds_read_b128 a[244:247], v14 offset:26624
buffer_load_dwordx4 v8, s[20:23], 0 offen offset:384 lds
v_mfma_f32_16x16x32_bf16 v[180:183], a[236:239], a[36:39], v[180:183]
ds_read_b32 a53, v58
v_perm_b32 v57, v52, v19, s54
v_mfma_f32_16x16x32_bf16 v[184:187], a[236:239], a[40:43], v[184:187]
ds_read_b32 a54, v57
v_perm_b32 v56, v52, v19, s55
v_mfma_f32_16x16x32_bf16 v[188:191], a[236:239], a[44:47], v[188:191]
s_waitcnt lgkmcnt(4)
ds_read_b32 a55, v56
v_mfma_f32_16x16x32_bf16 v[192:195], a[240:243], a[32:35], v[192:195]
ds_read_b128 a[248:251], v14 offset:28672
v_perm_b32 v63, v49, v19, s52
v_mfma_f32_16x16x32_bf16 v[196:199], a[240:243], a[36:39], v[196:199]
ds_read_b32 a56, v63
v_perm_b32 v62, v49, v19, s53
v_mfma_f32_16x16x32_bf16 v[200:203], a[240:243], a[40:43], v[200:203]
ds_read_b32 a57, v62
v_perm_b32 v61, v53, v19, s52
v_mfma_f32_16x16x32_bf16 v[204:207], a[240:243], a[44:47], v[204:207]
s_waitcnt lgkmcnt(4)
ds_read_b32 a58, v61
v_mfma_f32_16x16x32_bf16 v[208:211], a[244:247], a[32:35], v[208:211]
ds_read_b128 a[252:255], v14 offset:30720
v_perm_b32 v60, v53, v19, s53
v_mfma_f32_16x16x32_bf16 v[212:215], a[244:247], a[36:39], v[212:215]
ds_read_b32 a59, v60
v_perm_b32 v59, v49, v19, s54
v_mfma_f32_16x16x32_bf16 v[216:219], a[244:247], a[40:43], v[216:219]
s_add_u32 m0, s33, 118400
ds_read_b32 a60, v59
v_perm_b32 v58, v49, v19, s55
v_mfma_f32_16x16x32_bf16 v[220:223], a[244:247], a[44:47], v[220:223]
s_waitcnt lgkmcnt(4)
ds_read_b32 a61, v58
v_perm_b32 v57, v53, v19, s54
v_mfma_f32_16x16x32_bf16 v[224:227], a[248:251], a[32:35], v[224:227]
ds_read_b128 a[224:227], v15 offset:16384
buffer_load_dwordx4 v9, s[20:23], 0 offen offset:384 lds
v_mfma_f32_16x16x32_bf16 v[228:231], a[248:251], a[36:39], v[228:231]
ds_read_b32 a62, v57
v_perm_b32 v56, v53, v19, s55
v_mfma_f32_16x16x32_bf16 v[232:235], a[248:251], a[40:43], v[232:235]
ds_read_b32 a63, v56
v_mfma_f32_16x16x32_bf16 v[236:239], a[248:251], a[44:47], v[236:239]
s_waitcnt lgkmcnt(4)
v_mfma_f32_16x16x32_bf16 v[240:243], a[252:255], a[32:35], v[240:243]
ds_read_b128 a[228:231], v15 offset:18432
v_mfma_f32_16x16x32_bf16 v[244:247], a[252:255], a[36:39], v[244:247]
v_mfma_f32_16x16x32_bf16 v[248:251], a[252:255], a[40:43], v[248:251]
s_waitcnt vmcnt(7)
v_cmp_ne_u64 s[50:51], s[88:89], v[98:99]
v_cmp_ne_u64 vcc, s[88:89], v[102:103]
v_mfma_f32_16x16x32_bf16 v[252:255], a[252:255], a[44:47], v[252:255]
s_waitcnt lgkmcnt(1)
buffer_load_dwordx4 v[112:115], v12, s[24:27], 0 offen offset:0 sc1
v_mfma_f32_16x16x32_bf16 v[128:131], a[224:227], a[48:51], v[128:131]
s_or_b64 vcc, vcc, s[50:51]
ds_read_b128 a[232:235], v15 offset:20480
buffer_load_dwordx4 v[116:119], v12, s[24:27], 0 offen offset:1024 sc1
v_mfma_f32_16x16x32_bf16 v[132:135], a[224:227], a[52:55], v[132:135]
s_cbranch_scc1 L_SLOW4
L_BACK4:
v_mfma_f32_16x16x32_bf16 v[136:139], a[224:227], a[56:59], v[136:139]
s_add_u32 m0, s33, 122496
v_mfma_f32_16x16x32_bf16 v[140:143], a[224:227], a[60:63], v[140:143]
s_waitcnt lgkmcnt(1)
v_mfma_f32_16x16x32_bf16 v[144:147], a[228:231], a[48:51], v[144:147]
ds_read_b128 a[236:239], v15 offset:22528
buffer_load_dwordx4 v10, s[20:23], 0 offen offset:384 lds
v_mfma_f32_16x16x32_bf16 v[148:151], a[228:231], a[52:55], v[148:151]
s_waitcnt vmcnt(9)
v_perm_b32 v63, v96, v19, s52
v_lshlrev_b32 v24, 16, v20
v_mfma_f32_16x16x32_bf16 v[152:155], a[228:231], a[56:59], v[152:155]
ds_read_b32 a64, v63
v_perm_b32 v62, v96, v19, s53
v_mfma_f32_16x16x32_bf16 v[156:159], a[228:231], a[60:63], v[156:159]
s_waitcnt lgkmcnt(2)
ds_read_b32 a65, v62
v_and_b32 v25, 0xffff0000, v20
v_mfma_f32_16x16x32_bf16 v[160:163], a[232:235], a[48:51], v[160:163]
ds_read_b128 a[240:243], v15 offset:24576
v_perm_b32 v61, v100, v19, s52
v_mfma_f32_16x16x32_bf16 v[164:167], a[232:235], a[52:55], v[164:167]
ds_read_b32 a66, v61
v_perm_b32 v60, v100, v19, s53
v_mfma_f32_16x16x32_bf16 v[168:171], a[232:235], a[56:59], v[168:171]
ds_read_b32 a67, v60
v_perm_b32 v59, v96, v19, s54
v_mfma_f32_16x16x32_bf16 v[172:175], a[232:235], a[60:63], v[172:175]
s_waitcnt lgkmcnt(4)
ds_read_b32 a68, v59
v_lshlrev_b32 v26, 16, v21
v_mfma_f32_16x16x32_bf16 v[176:179], a[236:239], a[48:51], v[176:179]
ds_read_b128 a[244:247], v15 offset:26624
v_perm_b32 v58, v96, v19, s55
v_mfma_f32_16x16x32_bf16 v[180:183], a[236:239], a[52:55], v[180:183]
ds_read_b32 a69, v58
v_perm_b32 v57, v100, v19, s54
v_mfma_f32_16x16x32_bf16 v[184:187], a[236:239], a[56:59], v[184:187]
s_add_u32 m0, s33, 126592
ds_read_b32 a70, v57
v_perm_b32 v56, v100, v19, s55
v_mfma_f32_16x16x32_bf16 v[188:191], a[236:239], a[60:63], v[188:191]
s_waitcnt lgkmcnt(4)
ds_read_b32 a71, v56
v_perm_b32 v63, v97, v19, s52
v_mfma_f32_16x16x32_bf16 v[192:195], a[240:243], a[48:51], v[192:195]
ds_read_b128 a[248:251], v15 offset:28672
buffer_load_dwordx4 v11, s[20:23], 0 offen offset:384 lds
v_mfma_f32_16x16x32_bf16 v[196:199], a[240:243], a[52:55], v[196:199]
ds_read_b32 a72, v63
v_perm_b32 v62, v97, v19, s53
v_mfma_f32_16x16x32_bf16 v[200:203], a[240:243], a[56:59], v[200:203]
ds_read_b32 a73, v62
v_perm_b32 v61, v101, v19, s52
v_mfma_f32_16x16x32_bf16 v[204:207], a[240:243], a[60:63], v[204:207]
s_waitcnt lgkmcnt(4)
ds_read_b32 a74, v61
v_and_b32 v27, 0xffff0000, v21
v_mfma_f32_16x16x32_bf16 v[208:211], a[244:247], a[48:51], v[208:211]
ds_read_b128 a[252:255], v15 offset:30720
v_perm_b32 v60, v101, v19, s53
v_mfma_f32_16x16x32_bf16 v[212:215], a[244:247], a[52:55], v[212:215]
ds_read_b32 a75, v60
v_perm_b32 v59, v97, v19, s54
v_mfma_f32_16x16x32_bf16 v[216:219], a[244:247], a[56:59], v[216:219]
ds_read_b32 a76, v59
v_perm_b32 v58, v97, v19, s55
v_mfma_f32_16x16x32_bf16 v[220:223], a[244:247], a[60:63], v[220:223]
s_waitcnt lgkmcnt(4)
ds_read_b32 a77, v58
v_mfma_f32_16x16x32_bf16 v[224:227], a[248:251], a[48:51], v[224:227]
s_waitcnt vmcnt(8)
s_barrier
ds_read_b128 a[224:227], v14 offset:32768
v_perm_b32 v57, v101, v19, s54
v_mfma_f32_16x16x32_bf16 v[228:231], a[248:251], a[52:55], v[228:231]
ds_read_b32 a78, v57
v_perm_b32 v56, v101, v19, s55
v_mfma_f32_16x16x32_bf16 v[232:235], a[248:251], a[56:59], v[232:235]
ds_read_b32 a79, v56
v_mfma_f32_16x16x32_bf16 v[236:239], a[248:251], a[60:63], v[236:239]
s_waitcnt lgkmcnt(4)
v_mfma_f32_16x16x32_bf16 v[240:243], a[252:255], a[48:51], v[240:243]
ds_read_b128 a[228:231], v14 offset:34816
v_mfma_f32_16x16x32_bf16 v[244:247], a[252:255], a[52:55], v[244:247]
v_mfma_f32_16x16x32_bf16 v[248:251], a[252:255], a[56:59], v[248:251]
s_add_u32 m0, s33, 130560
v_mfma_f32_16x16x32_bf16 v[252:255], a[252:255], a[60:63], v[252:255]
s_waitcnt vmcnt(6) lgkmcnt(1)
v_cmp_ne_u64 s[50:51], s[88:89], v[106:107]
v_cmp_ne_u64 vcc, s[88:89], v[110:111]
v_mfma_f32_16x16x32_bf16 v[128:131], a[224:227], a[64:67], v[128:131]
ds_read_b128 a[232:235], v14 offset:36864
buffer_load_dwordx4 v8, s[20:23], 0 offen offset:512 lds
v_mfma_f32_16x16x32_bf16 v[132:135], a[224:227], a[68:71], v[132:135]
s_or_b64 vcc, vcc, s[50:51]
buffer_load_dwordx4 v[32:35], v12, s[24:27], 0 offen offset:2048 sc1
v_mfma_f32_16x16x32_bf16 v[136:139], a[224:227], a[72:75], v[136:139]
s_cbranch_scc1 L_SLOW5
L_BACK5:
v_mfma_f32_16x16x32_bf16 v[140:143], a[224:227], a[76:79], v[140:143]
s_waitcnt lgkmcnt(1)
buffer_load_dwordx4 v[36:39], v12, s[24:27], 0 offen offset:3072 sc1
v_mfma_f32_16x16x32_bf16 v[144:147], a[228:231], a[64:67], v[144:147]
ds_read_b128 a[236:239], v14 offset:38912
v_add_u32 v12, 4096, v12
v_mfma_f32_16x16x32_bf16 v[148:151], a[228:231], a[68:71], v[148:151]
v_perm_b32 v63, v104, v19, s52
v_mfma_f32_16x16x32_bf16 v[152:155], a[228:231], a[72:75], v[152:155]
ds_read_b32 a80, v63
v_perm_b32 v62, v104, v19, s53
v_mfma_f32_16x16x32_bf16 v[156:159], a[228:231], a[76:79], v[156:159]
s_waitcnt lgkmcnt(2)
ds_read_b32 a81, v62
v_mfma_f32_16x16x32_bf16 v[160:163], a[232:235], a[64:67], v[160:163]
ds_read_b128 a[240:243], v14 offset:40960
v_perm_b32 v61, v108, v19, s52
v_mfma_f32_16x16x32_bf16 v[164:167], a[232:235], a[68:71], v[164:167]
ds_read_b32 a82, v61
v_perm_b32 v60, v108, v19, s53
v_mfma_f32_16x16x32_bf16 v[168:171], a[232:235], a[72:75], v[168:171]
s_add_u32 m0, s33, 134656
ds_read_b32 a83, v60
v_perm_b32 v59, v104, v19, s54
v_mfma_f32_16x16x32_bf16 v[172:175], a[232:235], a[76:79], v[172:175]
s_waitcnt lgkmcnt(4)
ds_read_b32 a84, v59
v_perm_b32 v58, v104, v19, s55
v_mfma_f32_16x16x32_bf16 v[176:179], a[236:239], a[64:67], v[176:179]
ds_read_b128 a[244:247], v14 offset:43008
buffer_load_dwordx4 v9, s[20:23], 0 offen offset:512 lds
v_mfma_f32_16x16x32_bf16 v[180:183], a[236:239], a[68:71], v[180:183]
ds_read_b32 a85, v58
v_perm_b32 v57, v108, v19, s54
v_mfma_f32_16x16x32_bf16 v[184:187], a[236:239], a[72:75], v[184:187]
ds_read_b32 a86, v57
v_perm_b32 v56, v108, v19, s55
v_mfma_f32_16x16x32_bf16 v[188:191], a[236:239], a[76:79], v[188:191]
s_waitcnt lgkmcnt(4)
ds_read_b32 a87, v56
v_mfma_f32_16x16x32_bf16 v[192:195], a[240:243], a[64:67], v[192:195]
ds_read_b128 a[248:251], v14 offset:45056
v_perm_b32 v63, v105, v19, s52
v_mfma_f32_16x16x32_bf16 v[196:199], a[240:243], a[68:71], v[196:199]
ds_read_b32 a88, v63
v_perm_b32 v62, v105, v19, s53
v_mfma_f32_16x16x32_bf16 v[200:203], a[240:243], a[72:75], v[200:203]
ds_read_b32 a89, v62
v_perm_b32 v61, v109, v19, s52
v_mfma_f32_16x16x32_bf16 v[204:207], a[240:243], a[76:79], v[204:207]
s_waitcnt lgkmcnt(4)
ds_read_b32 a90, v61
v_mfma_f32_16x16x32_bf16 v[208:211], a[244:247], a[64:67], v[208:211]
ds_read_b128 a[252:255], v14 offset:47104
v_perm_b32 v60, v109, v19, s53
v_mfma_f32_16x16x32_bf16 v[212:215], a[244:247], a[68:71], v[212:215]
ds_read_b32 a91, v60
v_perm_b32 v59, v105, v19, s54
v_mfma_f32_16x16x32_bf16 v[216:219], a[244:247], a[72:75], v[216:219]
s_add_u32 m0, s33, 138752
ds_read_b32 a92, v59
v_perm_b32 v58, v105, v19, s55
v_mfma_f32_16x16x32_bf16 v[220:223], a[244:247], a[76:79], v[220:223]
s_waitcnt lgkmcnt(4)
ds_read_b32 a93, v58
v_perm_b32 v57, v109, v19, s54
v_mfma_f32_16x16x32_bf16 v[224:227], a[248:251], a[64:67], v[224:227]
ds_read_b128 a[224:227], v15 offset:32768
buffer_load_dwordx4 v10, s[20:23], 0 offen offset:512 lds
v_mfma_f32_16x16x32_bf16 v[228:231], a[248:251], a[68:71], v[228:231]
ds_read_b32 a94, v57
v_perm_b32 v56, v109, v19, s55
v_mfma_f32_16x16x32_bf16 v[232:235], a[248:251], a[72:75], v[232:235]
ds_read_b32 a95, v56
v_mfma_f32_16x16x32_bf16 v[236:239], a[248:251], a[76:79], v[236:239]
s_waitcnt lgkmcnt(4)
v_mfma_f32_16x16x32_bf16 v[240:243], a[252:255], a[64:67], v[240:243]
ds_read_b128 a[228:231], v15 offset:34816
v_mfma_f32_16x16x32_bf16 v[244:247], a[252:255], a[68:71], v[244:247]
v_mfma_f32_16x16x32_bf16 v[248:251], a[252:255], a[72:75], v[248:251]
s_waitcnt vmcnt(7)
v_cmp_ne_u64 s[50:51], s[88:89], v[114:115]
v_cmp_ne_u64 vcc, s[88:89], v[118:119]
v_mfma_f32_16x16x32_bf16 v[252:255], a[252:255], a[76:79], v[252:255]
s_waitcnt lgkmcnt(1)
buffer_load_dwordx4 v[40:43], v12, s[24:27], 0 offen offset:0 sc1
v_mfma_f32_16x16x32_bf16 v[128:131], a[224:227], a[80:83], v[128:131]
s_or_b64 vcc, vcc, s[50:51]
ds_read_b128 a[232:235], v15 offset:36864
buffer_load_dwordx4 v[44:47], v12, s[24:27], 0 offen offset:1024 sc1
v_mfma_f32_16x16x32_bf16 v[132:135], a[224:227], a[84:87], v[132:135]
s_cbranch_scc1 L_SLOW6
L_BACK6:
v_mfma_f32_16x16x32_bf16 v[136:139], a[224:227], a[88:91], v[136:139]
s_add_u32 m0, s33, 142848
v_mfma_f32_16x16x32_bf16 v[140:143], a[224:227], a[92:95], v[140:143]
s_waitcnt lgkmcnt(1)
v_mfma_f32_16x16x32_bf16 v[144:147], a[228:231], a[80:83], v[144:147]
ds_read_b128 a[236:239], v15 offset:38912
buffer_load_dwordx4 v11, s[20:23], 0 offen offset:512 lds
v_mfma_f32_16x16x32_bf16 v[148:151], a[228:231], a[84:87], v[148:151]
v_perm_b32 v63, v112, v19, s52
v_mfma_f32_16x16x32_bf16 v[152:155], a[228:231], a[88:91], v[152:155]
ds_read_b32 a96, v63
v_perm_b32 v62, v112, v19, s53
v_mfma_f32_16x16x32_bf16 v[156:159], a[228:231], a[92:95], v[156:159]
s_waitcnt lgkmcnt(2)
ds_read_b32 a97, v62
v_mfma_f32_16x16x32_bf16 v[160:163], a[232:235], a[80:83], v[160:163]
ds_read_b128 a[240:243], v15 offset:40960
v_perm_b32 v61, v116, v19, s52
v_mfma_f32_16x16x32_bf16 v[164:167], a[232:235], a[84:87], v[164:167]
ds_read_b32 a98, v61
v_perm_b32 v60, v116, v19, s53
v_mfma_f32_16x16x32_bf16 v[168:171], a[232:235], a[88:91], v[168:171]
ds_read_b32 a99, v60
v_perm_b32 v59, v112, v19, s54
v_mfma_f32_16x16x32_bf16 v[172:175], a[232:235], a[92:95], v[172:175]
s_waitcnt lgkmcnt(4)
ds_read_b32 a100, v59
v_mfma_f32_16x16x32_bf16 v[176:179], a[236:239], a[80:83], v[176:179]
ds_read_b128 a[244:247], v15 offset:43008
v_perm_b32 v58, v112, v19, s55
v_mfma_f32_16x16x32_bf16 v[180:183], a[236:239], a[84:87], v[180:183]
ds_read_b32 a101, v58
v_perm_b32 v57, v116, v19, s54
v_mfma_f32_16x16x32_bf16 v[184:187], a[236:239], a[88:91], v[184:187]
s_add_u32 m0, s33, 146816
ds_read_b32 a102, v57
v_perm_b32 v56, v116, v19, s55
v_mfma_f32_16x16x32_bf16 v[188:191], a[236:239], a[92:95], v[188:191]
s_waitcnt lgkmcnt(4)
ds_read_b32 a103, v56
v_perm_b32 v63, v113, v19, s52
v_mfma_f32_16x16x32_bf16 v[192:195], a[240:243], a[80:83], v[192:195]
ds_read_b128 a[248:251], v15 offset:45056
buffer_load_dwordx4 v8, s[20:23], 0 offen offset:640 lds
v_mfma_f32_16x16x32_bf16 v[196:199], a[240:243], a[84:87], v[196:199]
ds_read_b32 a104, v63
v_perm_b32 v62, v113, v19, s53
v_mfma_f32_16x16x32_bf16 v[200:203], a[240:243], a[88:91], v[200:203]
ds_read_b32 a105, v62
v_perm_b32 v61, v117, v19, s52
v_mfma_f32_16x16x32_bf16 v[204:207], a[240:243], a[92:95], v[204:207]
s_waitcnt lgkmcnt(4)
ds_read_b32 a106, v61
v_mfma_f32_16x16x32_bf16 v[208:211], a[244:247], a[80:83], v[208:211]
ds_read_b128 a[252:255], v15 offset:47104
v_perm_b32 v60, v117, v19, s53
v_mfma_f32_16x16x32_bf16 v[212:215], a[244:247], a[84:87], v[212:215]
ds_read_b32 a107, v60
v_perm_b32 v59, v113, v19, s54
v_mfma_f32_16x16x32_bf16 v[216:219], a[244:247], a[88:91], v[216:219]
ds_read_b32 a108, v59
v_perm_b32 v58, v113, v19, s55
v_mfma_f32_16x16x32_bf16 v[220:223], a[244:247], a[92:95], v[220:223]
s_waitcnt lgkmcnt(4)
ds_read_b32 a109, v58
buffer_load_dwordx4 v[48:51], v12, s[24:27], 0 offen offset:2048 sc1
v_mfma_f32_16x16x32_bf16 v[224:227], a[248:251], a[80:83], v[224:227]
s_waitcnt vmcnt(10)
s_barrier
ds_read_b128 a[224:227], v14 offset:49152
v_perm_b32 v57, v117, v19, s54
v_mfma_f32_16x16x32_bf16 v[228:231], a[248:251], a[84:87], v[228:231]
ds_read_b32 a110, v57
v_perm_b32 v56, v117, v19, s55
v_mfma_f32_16x16x32_bf16 v[232:235], a[248:251], a[88:91], v[232:235]
ds_read_b32 a111, v56
buffer_load_dwordx4 v[52:55], v12, s[24:27], 0 offen offset:3072 sc1
v_mfma_f32_16x16x32_bf16 v[236:239], a[248:251], a[92:95], v[236:239]
s_waitcnt lgkmcnt(4)
v_add_u32 v12, 4096, v12
v_mfma_f32_16x16x32_bf16 v[240:243], a[252:255], a[80:83], v[240:243]
ds_read_b128 a[228:231], v14 offset:51200
v_mfma_f32_16x16x32_bf16 v[244:247], a[252:255], a[84:87], v[244:247]
v_mfma_f32_16x16x32_bf16 v[248:251], a[252:255], a[88:91], v[248:251]
v_mfma_f32_16x16x32_bf16 v[252:255], a[252:255], a[92:95], v[252:255]
s_waitcnt vmcnt(8) lgkmcnt(1)
v_cmp_ne_u64 s[50:51], s[88:89], v[34:35]
v_cmp_ne_u64 vcc, s[88:89], v[38:39]
v_mfma_f32_16x16x32_bf16 v[128:131], a[224:227], a[96:99], v[128:131]
ds_read_b128 a[232:235], v14 offset:53248
v_mfma_f32_16x16x32_bf16 v[132:135], a[224:227], a[100:103], v[132:135]
s_or_b64 vcc, vcc, s[50:51]
v_mfma_f32_16x16x32_bf16 v[136:139], a[224:227], a[104:107], v[136:139]
s_cbranch_scc1 L_SLOW7
L_BACK7:
v_mfma_f32_16x16x32_bf16 v[140:143], a[224:227], a[108:111], v[140:143]
s_waitcnt lgkmcnt(1)
v_mfma_f32_16x16x32_bf16 v[144:147], a[228:231], a[96:99], v[144:147]
ds_read_b128 a[236:239], v14 offset:55296
v_mfma_f32_16x16x32_bf16 v[148:151], a[228:231], a[100:103], v[148:151]
v_perm_b32 v63, v32, v19, s52
v_mfma_f32_16x16x32_bf16 v[152:155], a[228:231], a[104:107], v[152:155]
ds_read_b32 a112, v63
v_perm_b32 v62, v32, v19, s53
v_mfma_f32_16x16x32_bf16 v[156:159], a[228:231], a[108:111], v[156:159]
s_waitcnt lgkmcnt(2)
ds_read_b32 a113, v62
v_mfma_f32_16x16x32_bf16 v[160:163], a[232:235], a[96:99], v[160:163]
ds_read_b128 a[240:243], v14 offset:57344
v_perm_b32 v61, v36, v19, s52
v_mfma_f32_16x16x32_bf16 v[164:167], a[232:235], a[100:103], v[164:167]
ds_read_b32 a114, v61
v_perm_b32 v60, v36, v19, s53
v_mfma_f32_16x16x32_bf16 v[168:171], a[232:235], a[104:107], v[168:171]
s_add_u32 m0, s33, 150912
ds_read_b32 a115, v60
v_perm_b32 v59, v32, v19, s54
v_mfma_f32_16x16x32_bf16 v[172:175], a[232:235], a[108:111], v[172:175]
s_waitcnt lgkmcnt(4)
ds_read_b32 a116, v59
v_perm_b32 v58, v32, v19, s55
v_mfma_f32_16x16x32_bf16 v[176:179], a[236:239], a[96:99], v[176:179]
ds_read_b128 a[244:247], v14 offset:59392
buffer_load_dwordx4 v9, s[20:23], 0 offen offset:640 lds
v_mfma_f32_16x16x32_bf16 v[180:183], a[236:239], a[100:103], v[180:183]
ds_read_b32 a117, v58
v_perm_b32 v57, v36, v19, s54
v_mfma_f32_16x16x32_bf16 v[184:187], a[236:239], a[104:107], v[184:187]
ds_read_b32 a118, v57
v_perm_b32 v56, v36, v19, s55
v_mfma_f32_16x16x32_bf16 v[188:191], a[236:239], a[108:111], v[188:191]
s_waitcnt lgkmcnt(4)
ds_read_b32 a119, v56
v_mfma_f32_16x16x32_bf16 v[192:195], a[240:243], a[96:99], v[192:195]
ds_read_b128 a[248:251], v14 offset:61440
v_perm_b32 v63, v33, v19, s52
v_mfma_f32_16x16x32_bf16 v[196:199], a[240:243], a[100:103], v[196:199]
ds_read_b32 a120, v63
v_perm_b32 v62, v33, v19, s53
v_mfma_f32_16x16x32_bf16 v[200:203], a[240:243], a[104:107], v[200:203]
ds_read_b32 a121, v62
v_perm_b32 v61, v37, v19, s52
v_mfma_f32_16x16x32_bf16 v[204:207], a[240:243], a[108:111], v[204:207]
s_waitcnt lgkmcnt(4)
ds_read_b32 a122, v61
v_mfma_f32_16x16x32_bf16 v[208:211], a[244:247], a[96:99], v[208:211]
ds_read_b128 a[252:255], v14 offset:63488
v_perm_b32 v60, v37, v19, s53
v_mfma_f32_16x16x32_bf16 v[212:215], a[244:247], a[100:103], v[212:215]
ds_read_b32 a123, v60
v_perm_b32 v59, v33, v19, s54
v_mfma_f32_16x16x32_bf16 v[216:219], a[244:247], a[104:107], v[216:219]
s_add_u32 m0, s33, 155008
ds_read_b32 a124, v59
v_perm_b32 v58, v33, v19, s55
v_mfma_f32_16x16x32_bf16 v[220:223], a[244:247], a[108:111], v[220:223]
s_waitcnt lgkmcnt(4)
ds_read_b32 a125, v58
v_perm_b32 v57, v37, v19, s54
v_mfma_f32_16x16x32_bf16 v[224:227], a[248:251], a[96:99], v[224:227]
ds_read_b128 a[224:227], v15 offset:49152
buffer_load_dwordx4 v10, s[20:23], 0 offen offset:640 lds
v_mfma_f32_16x16x32_bf16 v[228:231], a[248:251], a[100:103], v[228:231]
ds_read_b32 a126, v57
v_perm_b32 v56, v37, v19, s55
v_mfma_f32_16x16x32_bf16 v[232:235], a[248:251], a[104:107], v[232:235]
ds_read_b32 a127, v56
buffer_load_dwordx4 v[96:99], v12, s[24:27], 0 offen offset:0 sc1
v_mfma_f32_16x16x32_bf16 v[236:239], a[248:251], a[108:111], v[236:239]
s_waitcnt lgkmcnt(4)
buffer_load_dwordx4 v[100:103], v12, s[24:27], 0 offen offset:1024 sc1
v_mfma_f32_16x16x32_bf16 v[240:243], a[252:255], a[96:99], v[240:243]
ds_read_b128 a[228:231], v15 offset:51200
v_mfma_f32_16x16x32_bf16 v[244:247], a[252:255], a[100:103], v[244:247]
v_mfma_f32_16x16x32_bf16 v[248:251], a[252:255], a[104:107], v[248:251]
s_waitcnt vmcnt(8)
v_cmp_ne_u64 s[50:51], s[88:89], v[42:43]
v_cmp_ne_u64 vcc, s[88:89], v[46:47]
v_mfma_f32_16x16x32_bf16 v[252:255], a[252:255], a[108:111], v[252:255]
s_waitcnt lgkmcnt(1)
v_mfma_f32_16x16x32_bf16 v[128:131], a[224:227], a[112:115], v[128:131]
s_or_b64 vcc, vcc, s[50:51]
ds_read_b128 a[232:235], v15 offset:53248
v_mfma_f32_16x16x32_bf16 v[132:135], a[224:227], a[116:119], v[132:135]
s_cbranch_scc1 L_SLOW8
L_BACK8:
v_mfma_f32_16x16x32_bf16 v[136:139], a[224:227], a[120:123], v[136:139]
s_add_u32 m0, s33, 158976
v_perm_b32 v63, v40, v19, s52
v_mfma_f32_16x16x32_bf16 v[140:143], a[224:227], a[124:127], v[140:143]
s_waitcnt lgkmcnt(1)
ds_read_b32 a128, v63
v_perm_b32 v62, v40, v19, s53
v_mfma_f32_16x16x32_bf16 v[144:147], a[228:231], a[112:115], v[144:147]
ds_read_b128 a[236:239], v15 offset:55296
buffer_load_dwordx4 v8, s[20:23], 0 offen offset:768 lds
v_mfma_f32_16x16x32_bf16 v[148:151], a[228:231], a[116:119], v[148:151]
ds_read_b32 a129, v62
v_perm_b32 v61, v44, v19, s52
v_mfma_f32_16x16x32_bf16 v[152:155], a[228:231], a[120:123], v[152:155]
ds_read_b32 a130, v61
v_perm_b32 v60, v44, v19, s53
v_mfma_f32_16x16x32_bf16 v[156:159], a[228:231], a[124:127], v[156:159]
s_waitcnt lgkmcnt(4)
ds_read_b32 a131, v60
v_mfma_f32_16x16x32_bf16 v[160:163], a[232:235], a[112:115], v[160:163]
ds_read_b128 a[240:243], v15 offset:57344
v_perm_b32 v59, v40, v19, s54
v_mfma_f32_16x16x32_bf16 v[164:167], a[232:235], a[116:119], v[164:167]
ds_read_b32 a132, v59
v_perm_b32 v58, v40, v19, s55
v_mfma_f32_16x16x32_bf16 v[168:171], a[232:235], a[120:123], v[168:171]
ds_read_b32 a133, v58
v_perm_b32 v57, v44, v19, s54
v_mfma_f32_16x16x32_bf16 v[172:175], a[232:235], a[124:127], v[172:175]
s_waitcnt lgkmcnt(4)
ds_read_b32 a134, v57
v_mfma_f32_16x16x32_bf16 v[176:179], a[236:239], a[112:115], v[176:179]
ds_read_b128 a[244:247], v15 offset:59392
v_perm_b32 v56, v44, v19, s55
v_mfma_f32_16x16x32_bf16 v[180:183], a[236:239], a[116:119], v[180:183]
ds_read_b32 a135, v56
v_perm_b32 v63, v41, v19, s52
v_mfma_f32_16x16x32_bf16 v[184:187], a[236:239], a[120:123], v[184:187]
s_add_u32 m0, s33, 64896
ds_read_b32 a136, v63
v_perm_b32 v62, v41, v19, s53
v_mfma_f32_16x16x32_bf16 v[188:191], a[236:239], a[124:127], v[188:191]
s_waitcnt lgkmcnt(4)
ds_read_b32 a137, v62
v_perm_b32 v61, v45, v19, s52
v_mfma_f32_16x16x32_bf16 v[192:195], a[240:243], a[112:115], v[192:195]
ds_read_b128 a[248:251], v15 offset:61440
buffer_load_dwordx4 v11, s[20:23], 0 offen offset:640 lds
v_mfma_f32_16x16x32_bf16 v[196:199], a[240:243], a[116:119], v[196:199]
ds_read_b32 a138, v61
v_perm_b32 v60, v45, v19, s53
v_mfma_f32_16x16x32_bf16 v[200:203], a[240:243], a[120:123], v[200:203]
ds_read_b32 a139, v60
v_perm_b32 v59, v41, v19, s54
v_mfma_f32_16x16x32_bf16 v[204:207], a[240:243], a[124:127], v[204:207]
s_waitcnt lgkmcnt(4)
ds_read_b32 a140, v59
buffer_load_dwordx4 v[104:107], v12, s[24:27], 0 offen offset:2048 sc1
v_mfma_f32_16x16x32_bf16 v[208:211], a[244:247], a[112:115], v[208:211]
ds_read_b128 a[252:255], v15 offset:63488
v_perm_b32 v58, v41, v19, s55
v_mfma_f32_16x16x32_bf16 v[212:215], a[244:247], a[116:119], v[212:215]
ds_read_b32 a141, v58
v_perm_b32 v57, v45, v19, s54
v_mfma_f32_16x16x32_bf16 v[216:219], a[244:247], a[120:123], v[216:219]
ds_read_b32 a142, v57
buffer_load_dwordx4 v[108:111], v12, s[24:27], 0 offen offset:3072 sc1
v_mfma_f32_16x16x32_bf16 v[220:223], a[244:247], a[124:127], v[220:223]
s_waitcnt vmcnt(8) lgkmcnt(4)
v_cmp_ne_u64 s[50:51], s[88:89], v[50:51]
v_cmp_ne_u64 vcc, s[88:89], v[54:55]
v_mfma_f32_16x16x32_bf16 v[224:227], a[248:251], a[112:115], v[224:227]
s_barrier
ds_read_b128 a[224:227], v16 offset:0
v_perm_b32 v56, v45, v19, s55
v_mfma_f32_16x16x32_bf16 v[228:231], a[248:251], a[116:119], v[228:231]
s_or_b64 vcc, vcc, s[50:51]
ds_read_b32 a143, v56
v_add_u32 v12, 4096, v12
v_mfma_f32_16x16x32_bf16 v[232:235], a[248:251], a[120:123], v[232:235]
s_cbranch_scc1 L_SLOW9
L_BACK9:
v_mfma_f32_16x16x32_bf16 v[236:239], a[248:251], a[124:127], v[236:239]
s_waitcnt lgkmcnt(2)
v_mfma_f32_16x16x32_bf16 v[240:243], a[252:255], a[112:115], v[240:243]
ds_read_b128 a[228:231], v16 offset:2048
v_mfma_f32_16x16x32_bf16 v[244:247], a[252:255], a[116:119], v[244:247]
v_perm_b32 v63, v48, v19, s52
v_mfma_f32_16x16x32_bf16 v[248:251], a[252:255], a[120:123], v[248:251]
ds_read_b32 a144, v63
v_perm_b32 v62, v48, v19, s53
v_mfma_f32_16x16x32_bf16 v[252:255], a[252:255], a[124:127], v[252:255]
s_waitcnt lgkmcnt(2)
ds_read_b32 a145, v62
v_mfma_f32_16x16x32_bf16 v[128:131], a[224:227], a[128:131], v[128:131]
ds_read_b128 a[232:235], v16 offset:4096
v_perm_b32 v61, v52, v19, s52
v_mfma_f32_16x16x32_bf16 v[132:135], a[224:227], a[132:135], v[132:135]
ds_read_b32 a146, v61
v_perm_b32 v60, v52, v19, s53
v_mfma_f32_16x16x32_bf16 v[136:139], a[224:227], a[136:139], v[136:139]
ds_read_b32 a147, v60
v_perm_b32 v59, v48, v19, s54
v_mfma_f32_16x16x32_bf16 v[140:143], a[224:227], a[140:143], v[140:143]
s_waitcnt lgkmcnt(4)
ds_read_b32 a148, v59
v_mfma_f32_16x16x32_bf16 v[144:147], a[228:231], a[128:131], v[144:147]
ds_read_b128 a[236:239], v16 offset:6144
v_perm_b32 v58, v48, v19, s55
v_mfma_f32_16x16x32_bf16 v[148:151], a[228:231], a[132:135], v[148:151]
ds_read_b32 a149, v58
v_perm_b32 v57, v52, v19, s54
v_mfma_f32_16x16x32_bf16 v[152:155], a[228:231], a[136:139], v[152:155]
ds_read_b32 a150, v57
v_perm_b32 v56, v52, v19, s55
v_mfma_f32_16x16x32_bf16 v[156:159], a[228:231], a[140:143], v[156:159]
s_waitcnt lgkmcnt(4)
ds_read_b32 a151, v56
buffer_load_dwordx4 v[112:115], v12, s[24:27], 0 offen offset:0 sc1
v_mfma_f32_16x16x32_bf16 v[160:163], a[232:235], a[128:131], v[160:163]
ds_read_b128 a[240:243], v16 offset:8192
v_perm_b32 v63, v49, v19, s52
v_mfma_f32_16x16x32_bf16 v[164:167], a[232:235], a[132:135], v[164:167]
ds_read_b32 a152, v63
v_perm_b32 v62, v49, v19, s53
v_mfma_f32_16x16x32_bf16 v[168:171], a[232:235], a[136:139], v[168:171]
s_add_u32 m0, s33, 68864
ds_read_b32 a153, v62
v_perm_b32 v61, v53, v19, s52
v_mfma_f32_16x16x32_bf16 v[172:175], a[232:235], a[140:143], v[172:175]
s_waitcnt lgkmcnt(4)
ds_read_b32 a154, v61
v_perm_b32 v60, v53, v19, s53
v_mfma_f32_16x16x32_bf16 v[176:179], a[236:239], a[128:131], v[176:179]
ds_read_b128 a[244:247], v16 offset:10240
buffer_load_dwordx4 v9, s[20:23], 0 offen offset:768 lds
v_mfma_f32_16x16x32_bf16 v[180:183], a[236:239], a[132:135], v[180:183]
ds_read_b32 a155, v60
v_perm_b32 v59, v49, v19, s54
v_mfma_f32_16x16x32_bf16 v[184:187], a[236:239], a[136:139], v[184:187]
ds_read_b32 a156, v59
v_perm_b32 v58, v49, v19, s55
v_mfma_f32_16x16x32_bf16 v[188:191], a[236:239], a[140:143], v[188:191]
s_waitcnt lgkmcnt(4)
ds_read_b32 a157, v58
buffer_load_dwordx4 v[116:119], v12, s[24:27], 0 offen offset:1024 sc1
v_mfma_f32_16x16x32_bf16 v[192:195], a[240:243], a[128:131], v[192:195]
ds_read_b128 a[248:251], v17 offset:0
v_perm_b32 v57, v53, v19, s54
v_mfma_f32_16x16x32_bf16 v[196:199], a[240:243], a[132:135], v[196:199]
ds_read_b32 a158, v57
v_perm_b32 v56, v53, v19, s55
v_mfma_f32_16x16x32_bf16 v[200:203], a[240:243], a[136:139], v[200:203]
ds_read_b32 a159, v56
v_mfma_f32_16x16x32_bf16 v[204:207], a[240:243], a[140:143], v[204:207]
s_waitcnt lgkmcnt(4)
v_mfma_f32_16x16x32_bf16 v[208:211], a[244:247], a[128:131], v[208:211]
ds_read_b128 a[252:255], v17 offset:2048
v_mfma_f32_16x16x32_bf16 v[212:215], a[244:247], a[132:135], v[212:215]
v_mfma_f32_16x16x32_bf16 v[216:219], a[244:247], a[136:139], v[216:219]
s_waitcnt vmcnt(7)
s_add_u32 m0, s33, 72960
v_cmp_ne_u64 s[50:51], s[88:89], v[98:99]
v_cmp_ne_u64 vcc, s[88:89], v[102:103]
v_mfma_f32_16x16x32_bf16 v[220:223], a[244:247], a[140:143], v[220:223]
s_waitcnt lgkmcnt(1)
v_mfma_f32_16x16x32_bf16 v[128:131], a[248:251], a[144:147], v[128:131]
s_or_b64 vcc, vcc, s[50:51]
ds_read_b128 a[224:227], v16 offset:12288
buffer_load_dwordx4 v10, s[20:23], 0 offen offset:768 lds
v_mfma_f32_16x16x32_bf16 v[132:135], a[248:251], a[148:151], v[132:135]
s_cbranch_scc1 L_SLOW10
L_BACK10:
v_mfma_f32_16x16x32_bf16 v[136:139], a[248:251], a[152:155], v[136:139]
v_perm_b32 v63, v96, v19, s52
v_mfma_f32_16x16x32_bf16 v[140:143], a[248:251], a[156:159], v[140:143]
s_waitcnt lgkmcnt(1)
ds_read_b32 a160, v63
v_mfma_f32_16x16x32_bf16 v[144:147], a[252:255], a[144:147], v[144:147]
ds_read_b128 a[228:231], v16 offset:14336
v_perm_b32 v62, v96, v19, s53
v_mfma_f32_16x16x32_bf16 v[148:151], a[252:255], a[148:151], v[148:151]
ds_read_b32 a161, v62
v_perm_b32 v61, v100, v19, s52
v_mfma_f32_16x16x32_bf16 v[152:155], a[252:255], a[152:155], v[152:155]
ds_read_b32 a162, v61
v_perm_b32 v60, v100, v19, s53
v_mfma_f32_16x16x32_bf16 v[156:159], a[252:255], a[156:159], v[156:159]
s_waitcnt lgkmcnt(4)
ds_read_b32 a163, v60
v_mfma_f32_16x16x32_bf16 v[224:227], a[224:227], a[128:131], v[224:227]
ds_read_b128 a[232:235], v17 offset:4096
v_perm_b32 v59, v96, v19, s54
v_mfma_f32_16x16x32_bf16 v[228:231], a[224:227], a[132:135], v[228:231]
ds_read_b32 a164, v59
v_perm_b32 v58, v96, v19, s55
v_mfma_f32_16x16x32_bf16 v[232:235], a[224:227], a[136:139], v[232:235]
s_add_u32 m0, s33, 76928
ds_read_b32 a165, v58
v_perm_b32 v57, v100, v19, s54
v_mfma_f32_16x16x32_bf16 v[236:239], a[224:227], a[140:143], v[236:239]
s_waitcnt lgkmcnt(4)
ds_read_b32 a166, v57
v_perm_b32 v56, v100, v19, s55
v_mfma_f32_16x16x32_bf16 v[240:243], a[228:231], a[128:131], v[240:243]
ds_read_b128 a[236:239], v17 offset:6144
buffer_load_dwordx4 v8, s[20:23], 0 offen offset:896 lds
v_mfma_f32_16x16x32_bf16 v[244:247], a[228:231], a[132:135], v[244:247]
ds_read_b32 a167, v56
v_perm_b32 v63, v97, v19, s52
v_mfma_f32_16x16x32_bf16 v[248:251], a[228:231], a[136:139], v[248:251]
ds_read_b32 a168, v63
v_perm_b32 v62, v97, v19, s53
v_mfma_f32_16x16x32_bf16 v[252:255], a[228:231], a[140:143], v[252:255]
s_waitcnt lgkmcnt(4)
ds_read_b32 a169, v62
buffer_load_dwordx4 v[32:35], v12, s[24:27], 0 offen offset:2048 sc1
v_mfma_f32_16x16x32_bf16 v[160:163], a[232:235], a[144:147], v[160:163]
ds_read_b128 a[240:243], v17 offset:8192
v_perm_b32 v61, v101, v19, s52
v_mfma_f32_16x16x32_bf16 v[164:167], a[232:235], a[148:151], v[164:167]
ds_read_b32 a170, v61
v_perm_b32 v60, v101, v19, s53
v_mfma_f32_16x16x32_bf16 v[168:171], a[232:235], a[152:155], v[168:171]
ds_read_b32 a171, v60
v_perm_b32 v59, v97, v19, s54
v_mfma_f32_16x16x32_bf16 v[172:175], a[232:235], a[156:159], v[172:175]
s_waitcnt lgkmcnt(4)
ds_read_b32 a172, v59
buffer_load_dwordx4 v[36:39], v12, s[24:27], 0 offen offset:3072 sc1
v_mfma_f32_16x16x32_bf16 v[176:179], a[236:239], a[144:147], v[176:179]
ds_read_b128 a[244:247], v17 offset:10240
v_perm_b32 v58, v97, v19, s55
v_mfma_f32_16x16x32_bf16 v[180:183], a[236:239], a[148:151], v[180:183]
ds_read_b32 a173, v58
v_perm_b32 v57, v101, v19, s54
v_mfma_f32_16x16x32_bf16 v[184:187], a[236:239], a[152:155], v[184:187]
s_waitcnt vmcnt(7)
s_add_u32 m0, s33, 81024
v_cmp_ne_u64 s[50:51], s[88:89], v[106:107]
v_cmp_ne_u64 vcc, s[88:89], v[110:111]
v_mfma_f32_16x16x32_bf16 v[188:191], a[236:239], a[156:159], v[188:191]
s_waitcnt lgkmcnt(3)
ds_read_b32 a174, v57
v_perm_b32 v56, v101, v19, s55
v_mfma_f32_16x16x32_bf16 v[192:195], a[240:243], a[144:147], v[192:195]
s_or_b64 vcc, vcc, s[50:51]
ds_read_b128 a[248:251], v16 offset:16384
buffer_load_dwordx4 v9, s[20:23], 0 offen offset:896 lds
v_mfma_f32_16x16x32_bf16 v[196:199], a[240:243], a[148:151], v[196:199]
s_cbranch_scc1 L_SLOW11
L_BACK11:
v_mfma_f32_16x16x32_bf16 v[200:203], a[240:243], a[152:155], v[200:203]
ds_read_b32 a175, v56
v_perm_b32 v63, v104, v19, s52
v_mfma_f32_16x16x32_bf16 v[204:207], a[240:243], a[156:159], v[204:207]
s_waitcnt lgkmcnt(3)
ds_read_b32 a176, v63
v_add_u32 v12, 4096, v12
v_mfma_f32_16x16x32_bf16 v[208:211], a[244:247], a[144:147], v[208:211]
ds_read_b128 a[252:255], v16 offset:18432
v_perm_b32 v62, v104, v19, s53
v_mfma_f32_16x16x32_bf16 v[212:215], a[244:247], a[148:151], v[212:215]
ds_read_b32 a177, v62
v_perm_b32 v61, v108, v19, s52
v_mfma_f32_16x16x32_bf16 v[216:219], a[244:247], a[152:155], v[216:219]
ds_read_b32 a178, v61
v_perm_b32 v60, v108, v19, s53
v_mfma_f32_16x16x32_bf16 v[220:223], a[244:247], a[156:159], v[220:223]
s_waitcnt lgkmcnt(4)
ds_read_b32 a179, v60
v_mfma_f32_16x16x32_bf16 v[128:131], a[248:251], a[160:163], v[128:131]
s_barrier
ds_read_b128 a[224:227], v16 offset:20480
v_perm_b32 v59, v104, v19, s54
v_mfma_f32_16x16x32_bf16 v[132:135], a[248:251], a[164:167], v[132:135]
ds_read_b32 a180, v59
v_perm_b32 v58, v104, v19, s55
v_mfma_f32_16x16x32_bf16 v[136:139], a[248:251], a[168:171], v[136:139]
ds_read_b32 a181, v58
v_perm_b32 v57, v108, v19, s54
v_mfma_f32_16x16x32_bf16 v[140:143], a[248:251], a[172:175], v[140:143]
s_waitcnt lgkmcnt(4)
ds_read_b32 a182, v57
v_mfma_f32_16x16x32_bf16 v[144:147], a[252:255], a[160:163], v[144:147]
ds_read_b128 a[228:231], v16 offset:22528
v_perm_b32 v56, v108, v19, s55
v_mfma_f32_16x16x32_bf16 v[148:151], a[252:255], a[164:167], v[148:151]
ds_read_b32 a183, v56
v_perm_b32 v63, v105, v19, s52
v_mfma_f32_16x16x32_bf16 v[152:155], a[252:255], a[168:171], v[152:155]
ds_read_b32 a184, v63
v_perm_b32 v62, v105, v19, s53
v_mfma_f32_16x16x32_bf16 v[156:159], a[252:255], a[172:175], v[156:159]
s_waitcnt lgkmcnt(4)
ds_read_b32 a185, v62
buffer_load_dwordx4 v[40:43], v12, s[24:27], 0 offen offset:0 sc1
v_mfma_f32_16x16x32_bf16 v[160:163], a[224:227], a[160:163], v[160:163]
ds_read_b128 a[232:235], v17 offset:12288
v_perm_b32 v61, v109, v19, s52
v_mfma_f32_16x16x32_bf16 v[164:167], a[224:227], a[164:167], v[164:167]
ds_read_b32 a186, v61
v_perm_b32 v60, v109, v19, s53
v_mfma_f32_16x16x32_bf16 v[168:171], a[224:227], a[168:171], v[168:171]
ds_read_b32 a187, v60
v_perm_b32 v59, v105, v19, s54
v_mfma_f32_16x16x32_bf16 v[172:175], a[224:227], a[172:175], v[172:175]
s_waitcnt lgkmcnt(4)
ds_read_b32 a188, v59
buffer_load_dwordx4 v[44:47], v12, s[24:27], 0 offen offset:1024 sc1
v_mfma_f32_16x16x32_bf16 v[176:179], a[228:231], a[160:163], v[176:179]
ds_read_b128 a[236:239], v17 offset:14336
v_perm_b32 v58, v105, v19, s55
v_mfma_f32_16x16x32_bf16 v[180:183], a[228:231], a[164:167], v[180:183]
ds_read_b32 a189, v58
v_perm_b32 v57, v109, v19, s54
v_mfma_f32_16x16x32_bf16 v[184:187], a[228:231], a[168:171], v[184:187]
s_waitcnt vmcnt(7)
v_cmp_ne_u64 s[50:51], s[88:89], v[114:115]
v_cmp_ne_u64 vcc, s[88:89], v[118:119]
v_mfma_f32_16x16x32_bf16 v[188:191], a[228:231], a[172:175], v[188:191]
s_waitcnt lgkmcnt(3)
ds_read_b32 a190, v57
v_mfma_f32_16x16x32_bf16 v[224:227], a[232:235], a[144:147], v[224:227]
s_or_b64 vcc, vcc, s[50:51]
ds_read_b128 a[240:243], v17 offset:16384
v_perm_b32 v56, v109, v19, s55
v_mfma_f32_16x16x32_bf16 v[228:231], a[232:235], a[148:151], v[228:231]
s_cbranch_scc1 L_SLOW12
L_BACK12:
v_mfma_f32_16x16x32_bf16 v[232:235], a[232:235], a[152:155], v[232:235]
s_add_u32 m0, s33, 85248
ds_read_b32 a191, v56
v_mfma_f32_16x16x32_bf16 v[236:239], a[232:235], a[156:159], v[236:239]
s_waitcnt lgkmcnt(3)
v_mfma_f32_16x16x32_bf16 v[240:243], a[236:239], a[144:147], v[240:243]
ds_read_b128 a[244:247], v17 offset:18432
buffer_load_dwordx4 v11, s[20:23], 0 offen offset:768 lds
v_mfma_f32_16x16x32_bf16 v[244:247], a[236:239], a[148:151], v[244:247]
v_perm_b32 v63, v112, v19, s52
v_mfma_f32_16x16x32_bf16 v[248:251], a[236:239], a[152:155], v[248:251]
ds_read_b32 a192, v63
v_perm_b32 v62, v112, v19, s53
v_mfma_f32_16x16x32_bf16 v[252:255], a[236:239], a[156:159], v[252:255]
s_waitcnt lgkmcnt(2)
ds_read_b32 a193, v62
v_mfma_f32_16x16x32_bf16 v[128:131], a[240:243], a[176:179], v[128:131]
ds_read_b128 a[248:251], v16 offset:24576
v_perm_b32 v61, v116, v19, s52
v_mfma_f32_16x16x32_bf16 v[132:135], a[240:243], a[180:183], v[132:135]
ds_read_b32 a194, v61
v_perm_b32 v60, v116, v19, s53
v_mfma_f32_16x16x32_bf16 v[136:139], a[240:243], a[184:187], v[136:139]
ds_read_b32 a195, v60
v_perm_b32 v59, v112, v19, s54
v_mfma_f32_16x16x32_bf16 v[140:143], a[240:243], a[188:191], v[140:143]
s_waitcnt lgkmcnt(4)
ds_read_b32 a196, v59
v_mfma_f32_16x16x32_bf16 v[144:147], a[244:247], a[176:179], v[144:147]
ds_read_b128 a[252:255], v16 offset:26624
v_perm_b32 v58, v112, v19, s55
v_mfma_f32_16x16x32_bf16 v[148:151], a[244:247], a[180:183], v[148:151]
ds_read_b32 a197, v58
v_perm_b32 v57, v116, v19, s54
v_mfma_f32_16x16x32_bf16 v[152:155], a[244:247], a[184:187], v[152:155]
s_add_u32 m0, s33, 89088
ds_read_b32 a198, v57
v_perm_b32 v56, v116, v19, s55
v_mfma_f32_16x16x32_bf16 v[156:159], a[244:247], a[188:191], v[156:159]
s_waitcnt lgkmcnt(4)
ds_read_b32 a199, v56
v_perm_b32 v63, v113, v19, s52
v_mfma_f32_16x16x32_bf16 v[192:195], a[248:251], a[160:163], v[192:195]
ds_read_b128 a[224:227], v17 offset:20480
buffer_load_dwordx4 v8, s[20:23], 0 offen offset:1024 lds
v_mfma_f32_16x16x32_bf16 v[196:199], a[248:251], a[164:167], v[196:199]
ds_read_b32 a200, v63
v_perm_b32 v62, v113, v19, s53
v_mfma_f32_16x16x32_bf16 v[200:203], a[248:251], a[168:171], v[200:203]
ds_read_b32 a201, v62
v_perm_b32 v61, v117, v19, s52
v_mfma_f32_16x16x32_bf16 v[204:207], a[248:251], a[172:175], v[204:207]
s_waitcnt lgkmcnt(4)
ds_read_b32 a202, v61
buffer_load_dwordx4 v[48:51], v12, s[24:27], 0 offen offset:2048 sc1
v_mfma_f32_16x16x32_bf16 v[208:211], a[252:255], a[160:163], v[208:211]
ds_read_b128 a[228:231], v17 offset:22528
v_perm_b32 v60, v117, v19, s53
v_mfma_f32_16x16x32_bf16 v[212:215], a[252:255], a[164:167], v[212:215]
ds_read_b32 a203, v60
v_perm_b32 v59, v113, v19, s54
v_mfma_f32_16x16x32_bf16 v[216:219], a[252:255], a[168:171], v[216:219]
ds_read_b32 a204, v59
v_perm_b32 v58, v113, v19, s55
v_mfma_f32_16x16x32_bf16 v[220:223], a[252:255], a[172:175], v[220:223]
s_waitcnt lgkmcnt(4)
ds_read_b32 a205, v58
buffer_load_dwordx4 v[52:55], v12, s[24:27], 0 offen offset:3072 sc1
v_mfma_f32_16x16x32_bf16 v[160:163], a[224:227], a[176:179], v[160:163]
ds_read_b128 a[232:235], v16 offset:28672
v_perm_b32 v57, v117, v19, s54
v_mfma_f32_16x16x32_bf16 v[164:167], a[224:227], a[180:183], v[164:167]
ds_read_b32 a206, v57
v_perm_b32 v56, v117, v19, s55
v_mfma_f32_16x16x32_bf16 v[168:171], a[224:227], a[184:187], v[168:171]
s_add_u32 m0, s33, 93312
ds_read_b32 a207, v56
v_add_u32 v12, 4096, v12
v_mfma_f32_16x16x32_bf16 v[172:175], a[224:227], a[188:191], v[172:175]
s_waitcnt lgkmcnt(4)
v_mfma_f32_16x16x32_bf16 v[176:179], a[228:231], a[176:179], v[176:179]
ds_read_b128 a[236:239], v16 offset:30720
buffer_load_dwordx4 v10, s[20:23], 0 offen offset:896 lds
v_mfma_f32_16x16x32_bf16 v[180:183], a[228:231], a[180:183], v[180:183]
v_mfma_f32_16x16x32_bf16 v[184:187], a[228:231], a[184:187], v[184:187]
s_waitcnt vmcnt(8)
v_cmp_ne_u64 s[50:51], s[88:89], v[34:35]
v_cmp_ne_u64 vcc, s[88:89], v[38:39]
v_mfma_f32_16x16x32_bf16 v[188:191], a[228:231], a[188:191], v[188:191]
s_waitcnt lgkmcnt(1)
v_mfma_f32_16x16x32_bf16 v[128:131], a[232:235], a[192:195], v[128:131]
s_or_b64 vcc, vcc, s[50:51]
ds_read_b128 a[240:243], v14 offset:0
v_mfma_f32_16x16x32_bf16 v[132:135], a[232:235], a[196:199], v[132:135]
s_cbranch_scc1 L_SLOW13
L_BACK13:
v_mfma_f32_16x16x32_bf16 v[136:139], a[232:235], a[200:203], v[136:139]
v_perm_b32 v63, v32, v19, s52
v_mfma_f32_16x16x32_bf16 v[140:143], a[232:235], a[204:207], v[140:143]
s_waitcnt lgkmcnt(1)
ds_read_b32 a208, v63
v_mfma_f32_16x16x32_bf16 v[144:147], a[236:239], a[192:195], v[144:147]
ds_read_b128 a[244:247], v14 offset:2048
v_perm_b32 v62, v32, v19, s53
v_mfma_f32_16x16x32_bf16 v[148:151], a[236:239], a[196:199], v[148:151]
ds_read_b32 a209, v62
v_perm_b32 v61, v36, v19, s52
v_mfma_f32_16x16x32_bf16 v[152:155], a[236:239], a[200:203], v[152:155]
s_add_u32 m0, s33, 97280
ds_read_b32 a210, v61
v_perm_b32 v60, v36, v19, s53
v_mfma_f32_16x16x32_bf16 v[156:159], a[236:239], a[204:207], v[156:159]
s_waitcnt lgkmcnt(4)
ds_read_b32 a211, v60
v_perm_b32 v59, v32, v19, s54
v_mfma_f32_16x16x32_bf16 v[224:227], a[240:243], a[160:163], v[224:227]
ds_read_b128 a[248:251], v17 offset:24576
buffer_load_dwordx4 v9, s[20:23], 0 offen offset:1024 lds
v_mfma_f32_16x16x32_bf16 v[228:231], a[240:243], a[164:167], v[228:231]
ds_read_b32 a212, v59
v_perm_b32 v58, v32, v19, s55
v_mfma_f32_16x16x32_bf16 v[232:235], a[240:243], a[168:171], v[232:235]
ds_read_b32 a213, v58
v_perm_b32 v57, v36, v19, s54
v_mfma_f32_16x16x32_bf16 v[236:239], a[240:243], a[172:175], v[236:239]
s_waitcnt lgkmcnt(4)
ds_read_b32 a214, v57
buffer_load_dwordx4 v[96:99], v12, s[24:27], 0 offen offset:0 sc1
v_mfma_f32_16x16x32_bf16 v[240:243], a[244:247], a[160:163], v[240:243]
ds_read_b128 a[252:255], v17 offset:26624
v_perm_b32 v56, v36, v19, s55
v_mfma_f32_16x16x32_bf16 v[244:247], a[244:247], a[164:167], v[244:247]
ds_read_b32 a215, v56
v_perm_b32 v63, v33, v19, s52
v_mfma_f32_16x16x32_bf16 v[248:251], a[244:247], a[168:171], v[248:251]
ds_read_b32 a216, v63
v_perm_b32 v62, v33, v19, s53
v_mfma_f32_16x16x32_bf16 v[252:255], a[244:247], a[172:175], v[252:255]
s_waitcnt lgkmcnt(4)
ds_read_b32 a217, v62
buffer_load_dwordx4 v[100:103], v12, s[24:27], 0 offen offset:1024 sc1
v_mfma_f32_16x16x32_bf16 v[192:195], a[248:251], a[176:179], v[192:195]
s_waitcnt vmcnt(10)
s_barrier
ds_read_b128 a[224:227], v14 offset:4096
v_perm_b32 v61, v37, v19, s52
v_mfma_f32_16x16x32_bf16 v[196:199], a[248:251], a[180:183], v[196:199]
ds_read_b32 a218, v61
v_perm_b32 v60, v37, v19, s53
v_mfma_f32_16x16x32_bf16 v[200:203], a[248:251], a[184:187], v[200:203]
ds_read_b32 a219, v60
v_perm_b32 v59, v33, v19, s54
v_mfma_f32_16x16x32_bf16 v[204:207], a[248:251], a[188:191], v[204:207]
s_waitcnt lgkmcnt(4)
ds_read_b32 a220, v59
v_mfma_f32_16x16x32_bf16 v[208:211], a[252:255], a[176:179], v[208:211]
ds_read_b128 a[228:231], v14 offset:6144
v_perm_b32 v58, v33, v19, s55
v_mfma_f32_16x16x32_bf16 v[212:215], a[252:255], a[180:183], v[212:215]
ds_read_b32 a221, v58
v_perm_b32 v57, v37, v19, s54
v_mfma_f32_16x16x32_bf16 v[216:219], a[252:255], a[184:187], v[216:219]
s_add_u32 m0, s33, 101248
ds_read_b32 a222, v57
v_perm_b32 v56, v37, v19, s55
v_mfma_f32_16x16x32_bf16 v[220:223], a[252:255], a[188:191], v[220:223]
s_waitcnt vmcnt(8) lgkmcnt(4)
v_cmp_ne_u64 s[50:51], s[88:89], v[42:43]
v_cmp_ne_u64 vcc, s[88:89], v[46:47]
v_mfma_f32_16x16x32_bf16 v[160:163], a[224:227], a[192:195], v[160:163]
ds_read_b128 a[232:235], v17 offset:28672
buffer_load_dwordx4 v8, s[20:23], 0 offen offset:1152 lds
v_mfma_f32_16x16x32_bf16 v[164:167], a[224:227], a[196:199], v[164:167]
s_or_b64 vcc, vcc, s[50:51]
ds_read_b32 a223, v56
v_mfma_f32_16x16x32_bf16 v[168:171], a[224:227], a[200:203], v[168:171]
s_cbranch_scc1 L_SLOW14
L_BACK14:
v_mfma_f32_16x16x32_bf16 v[172:175], a[224:227], a[204:207], v[172:175]
s_waitcnt lgkmcnt(2)
v_mfma_f32_16x16x32_bf16 v[176:179], a[228:231], a[192:195], v[176:179]
ds_read_b128 a[236:239], v17 offset:30720
v_mfma_f32_16x16x32_bf16 v[180:183], a[228:231], a[196:199], v[180:183]
v_perm_b32 v63, v40, v19, s52
v_mfma_f32_16x16x32_bf16 v[184:187], a[228:231], a[200:203], v[184:187]
ds_read_b32 a0, v63
v_perm_b32 v62, v40, v19, s53
v_mfma_f32_16x16x32_bf16 v[188:191], a[228:231], a[204:207], v[188:191]
s_waitcnt lgkmcnt(2)
ds_read_b32 a1, v62
v_mfma_f32_16x16x32_bf16 v[128:131], a[232:235], a[208:211], v[128:131]
ds_read_b128 a[240:243], v14 offset:8192
v_perm_b32 v61, v44, v19, s52
v_mfma_f32_16x16x32_bf16 v[132:135], a[232:235], a[212:215], v[132:135]
ds_read_b32 a2, v61
v_perm_b32 v60, v44, v19, s53
v_mfma_f32_16x16x32_bf16 v[136:139], a[232:235], a[216:219], v[136:139]
s_add_u32 m0, s33, 105600
ds_read_b32 a3, v60
v_perm_b32 v59, v40, v19, s54
v_mfma_f32_16x16x32_bf16 v[140:143], a[232:235], a[220:223], v[140:143]
s_waitcnt lgkmcnt(4)
ds_read_b32 a4, v59
v_perm_b32 v58, v40, v19, s55
v_mfma_f32_16x16x32_bf16 v[144:147], a[236:239], a[208:211], v[144:147]
ds_read_b128 a[244:247], v14 offset:10240
buffer_load_dwordx4 v11, s[20:23], 0 offen offset:896 lds
v_mfma_f32_16x16x32_bf16 v[148:151], a[236:239], a[212:215], v[148:151]
ds_read_b32 a5, v58
v_perm_b32 v57, v44, v19, s54
v_mfma_f32_16x16x32_bf16 v[152:155], a[236:239], a[216:219], v[152:155]
ds_read_b32 a6, v57
v_perm_b32 v56, v44, v19, s55
v_mfma_f32_16x16x32_bf16 v[156:159], a[236:239], a[220:223], v[156:159]
s_waitcnt lgkmcnt(4)
ds_read_b32 a7, v56
buffer_load_dwordx4 v[104:107], v12, s[24:27], 0 offen offset:2048 sc1
v_mfma_f32_16x16x32_bf16 v[192:195], a[240:243], a[192:195], v[192:195]
ds_read_b128 a[248:251], v15 offset:0
v_perm_b32 v63, v41, v19, s52
v_mfma_f32_16x16x32_bf16 v[196:199], a[240:243], a[196:199], v[196:199]
ds_read_b32 a8, v63
v_perm_b32 v62, v41, v19, s53
v_mfma_f32_16x16x32_bf16 v[200:203], a[240:243], a[200:203], v[200:203]
ds_read_b32 a9, v62
v_perm_b32 v61, v45, v19, s52
v_mfma_f32_16x16x32_bf16 v[204:207], a[240:243], a[204:207], v[204:207]
s_waitcnt lgkmcnt(4)
ds_read_b32 a10, v61
buffer_load_dwordx4 v[108:111], v12, s[24:27], 0 offen offset:3072 sc1
v_mfma_f32_16x16x32_bf16 v[208:211], a[244:247], a[192:195], v[208:211]
ds_read_b128 a[252:255], v15 offset:2048
v_perm_b32 v60, v45, v19, s53
v_mfma_f32_16x16x32_bf16 v[212:215], a[244:247], a[196:199], v[212:215]
ds_read_b32 a11, v60
v_perm_b32 v59, v41, v19, s54
v_mfma_f32_16x16x32_bf16 v[216:219], a[244:247], a[200:203], v[216:219]
s_add_u32 m0, s33, 109568
ds_read_b32 a12, v59
v_perm_b32 v58, v41, v19, s55
v_mfma_f32_16x16x32_bf16 v[220:223], a[244:247], a[204:207], v[220:223]
s_waitcnt vmcnt(8) lgkmcnt(4)
v_cmp_ne_u64 s[50:51], s[88:89], v[50:51]
v_cmp_ne_u64 vcc, s[88:89], v[54:55]
v_mfma_f32_16x16x32_bf16 v[224:227], a[248:251], a[176:179], v[224:227]
ds_read_b128 a[224:227], v15 offset:4096
buffer_load_dwordx4 v10, s[20:23], 0 offen offset:1024 lds
v_mfma_f32_16x16x32_bf16 v[228:231], a[248:251], a[180:183], v[228:231]
s_or_b64 vcc, vcc, s[50:51]
ds_read_b32 a13, v58
v_perm_b32 v57, v45, v19, s54
v_mfma_f32_16x16x32_bf16 v[232:235], a[248:251], a[184:187], v[232:235]
s_cbranch_scc1 L_SLOW15
L_BACK15:
v_mfma_f32_16x16x32_bf16 v[236:239], a[248:251], a[188:191], v[236:239]
s_waitcnt lgkmcnt(2)
ds_read_b32 a14, v57
v_add_u32 v12, 4096, v12
v_mfma_f32_16x16x32_bf16 v[240:243], a[252:255], a[176:179], v[240:243]
ds_read_b128 a[228:231], v15 offset:6144
v_perm_b32 v56, v45, v19, s55
v_mfma_f32_16x16x32_bf16 v[244:247], a[252:255], a[180:183], v[244:247]
ds_read_b32 a15, v56
v_perm_b32 v63, v48, v19, s52
v_mfma_f32_16x16x32_bf16 v[248:251], a[252:255], a[184:187], v[248:251]
ds_read_b32 a16, v63
v_perm_b32 v62, v48, v19, s53
v_mfma_f32_16x16x32_bf16 v[252:255], a[252:255], a[188:191], v[252:255]
s_waitcnt lgkmcnt(4)
ds_read_b32 a17, v62
v_mfma_f32_16x16x32_bf16 v[160:163], a[224:227], a[208:211], v[160:163]
ds_read_b128 a[232:235], v14 offset:12288
v_perm_b32 v61, v52, v19, s52
v_mfma_f32_16x16x32_bf16 v[164:167], a[224:227], a[212:215], v[164:167]
ds_read_b32 a18, v61
v_perm_b32 v60, v52, v19, s53
v_mfma_f32_16x16x32_bf16 v[168:171], a[224:227], a[216:219], v[168:171]
s_add_u32 m0, s33, 113536
ds_read_b32 a19, v60
v_perm_b32 v59, v48, v19, s54
v_mfma_f32_16x16x32_bf16 v[172:175], a[224:227], a[220:223], v[172:175]
s_waitcnt lgkmcnt(4)
ds_read_b32 a20, v59
v_perm_b32 v58, v48, v19, s55
v_mfma_f32_16x16x32_bf16 v[176:179], a[228:231], a[208:211], v[176:179]
ds_read_b128 a[236:239], v14 offset:14336
buffer_load_dwordx4 v9, s[20:23], 0 offen offset:1152 lds
v_mfma_f32_16x16x32_bf16 v[180:183], a[228:231], a[212:215], v[180:183]
ds_read_b32 a21, v58
v_perm_b32 v57, v52, v19, s54
v_mfma_f32_16x16x32_bf16 v[184:187], a[228:231], a[216:219], v[184:187]
ds_read_b32 a22, v57
v_perm_b32 v56, v52, v19, s55
v_mfma_f32_16x16x32_bf16 v[188:191], a[228:231], a[220:223], v[188:191]
s_waitcnt lgkmcnt(4)
ds_read_b32 a23, v56
buffer_load_dwordx4 v[112:115], v12, s[24:27], 0 offen offset:0 sc1
v_mfma_f32_16x16x32_bf16 v[128:131], a[232:235], a[0:3], v[128:131]
ds_read_b128 a[240:243], v14 offset:16384
v_perm_b32 v63, v49, v19, s52
v_mfma_f32_16x16x32_bf16 v[132:135], a[232:235], a[4:7], v[132:135]
ds_read_b32 a24, v63
v_perm_b32 v62, v49, v19, s53
v_mfma_f32_16x16x32_bf16 v[136:139], a[232:235], a[8:11], v[136:139]
ds_read_b32 a25, v62
v_perm_b32 v61, v53, v19, s52
v_mfma_f32_16x16x32_bf16 v[140:143], a[232:235], a[12:15], v[140:143]
s_waitcnt lgkmcnt(4)
ds_read_b32 a26, v61
buffer_load_dwordx4 v[116:119], v12, s[24:27], 0 offen offset:1024 sc1
v_mfma_f32_16x16x32_bf16 v[144:147], a[236:239], a[0:3], v[144:147]
ds_read_b128 a[244:247], v14 offset:18432
v_perm_b32 v60, v53, v19, s53
v_mfma_f32_16x16x32_bf16 v[148:151], a[236:239], a[4:7], v[148:151]
ds_read_b32 a27, v60
v_perm_b32 v59, v49, v19, s54
v_mfma_f32_16x16x32_bf16 v[152:155], a[236:239], a[8:11], v[152:155]
s_add_u32 m0, s33, 117504
ds_read_b32 a28, v59
v_perm_b32 v58, v49, v19, s55
v_mfma_f32_16x16x32_bf16 v[156:159], a[236:239], a[12:15], v[156:159]
s_waitcnt vmcnt(8) lgkmcnt(4)
v_cmp_ne_u64 s[50:51], s[88:89], v[98:99]
v_cmp_ne_u64 vcc, s[88:89], v[102:103]
v_mfma_f32_16x16x32_bf16 v[160:163], a[240:243], a[0:3], v[160:163]
ds_read_b128 a[248:251], v15 offset:8192
buffer_load_dwordx4 v8, s[20:23], 0 offen offset:1280 lds
v_mfma_f32_16x16x32_bf16 v[164:167], a[240:243], a[4:7], v[164:167]
s_or_b64 vcc, vcc, s[50:51]
ds_read_b32 a29, v58
v_perm_b32 v57, v53, v19, s54
v_mfma_f32_16x16x32_bf16 v[168:171], a[240:243], a[8:11], v[168:171]
s_cbranch_scc1 L_SLOW16
L_BACK16:
v_mfma_f32_16x16x32_bf16 v[172:175], a[240:243], a[12:15], v[172:175]
s_waitcnt lgkmcnt(2)
ds_read_b32 a30, v57
v_mfma_f32_16x16x32_bf16 v[176:179], a[244:247], a[0:3], v[176:179]
ds_read_b128 a[252:255], v15 offset:10240
v_perm_b32 v56, v53, v19, s55
v_mfma_f32_16x16x32_bf16 v[180:183], a[244:247], a[4:7], v[180:183]
ds_read_b32 a31, v56
v_perm_b32 v63, v96, v19, s52
v_mfma_f32_16x16x32_bf16 v[184:187], a[244:247], a[8:11], v[184:187]
ds_read_b32 a32, v63
v_perm_b32 v62, v96, v19, s53
v_mfma_f32_16x16x32_bf16 v[188:191], a[244:247], a[12:15], v[188:191]
s_waitcnt lgkmcnt(4)
ds_read_b32 a33, v62
v_mfma_f32_16x16x32_bf16 v[192:195], a[248:251], a[208:211], v[192:195]
s_barrier
ds_read_b128 a[224:227], v15 offset:12288
v_perm_b32 v61, v100, v19, s52
v_mfma_f32_16x16x32_bf16 v[196:199], a[248:251], a[212:215], v[196:199]
ds_read_b32 a34, v61
v_perm_b32 v60, v100, v19, s53
v_mfma_f32_16x16x32_bf16 v[200:203], a[248:251], a[216:219], v[200:203]
ds_read_b32 a35, v60
v_perm_b32 v59, v96, v19, s54
v_mfma_f32_16x16x32_bf16 v[204:207], a[248:251], a[220:223], v[204:207]
s_waitcnt lgkmcnt(4)
ds_read_b32 a36, v59
v_mfma_f32_16x16x32_bf16 v[208:211], a[252:255], a[208:211], v[208:211]
ds_read_b128 a[228:231], v15 offset:14336
v_perm_b32 v58, v96, v19, s55
v_mfma_f32_16x16x32_bf16 v[212:215], a[252:255], a[212:215], v[212:215]
ds_read_b32 a37, v58
v_perm_b32 v57, v100, v19, s54
v_mfma_f32_16x16x32_bf16 v[216:219], a[252:255], a[216:219], v[216:219]
ds_read_b32 a38, v57
v_perm_b32 v56, v100, v19, s55
v_mfma_f32_16x16x32_bf16 v[220:223], a[252:255], a[220:223], v[220:223]
s_waitcnt lgkmcnt(4)
ds_read_b32 a39, v56
buffer_load_dwordx4 v[32:35], v12, s[24:27], 0 offen offset:2048 sc1
v_mfma_f32_16x16x32_bf16 v[128:131], a[224:227], a[16:19], v[128:131]
ds_read_b128 a[232:235], v14 offset:20480
v_perm_b32 v63, v97, v19, s52
v_mfma_f32_16x16x32_bf16 v[132:135], a[224:227], a[20:23], v[132:135]
ds_read_b32 a40, v63
v_perm_b32 v62, v97, v19, s53
v_mfma_f32_16x16x32_bf16 v[136:139], a[224:227], a[24:27], v[136:139]
ds_read_b32 a41, v62
v_perm_b32 v61, v101, v19, s52
v_mfma_f32_16x16x32_bf16 v[140:143], a[224:227], a[28:31], v[140:143]
s_waitcnt lgkmcnt(4)
ds_read_b32 a42, v61
buffer_load_dwordx4 v[36:39], v12, s[24:27], 0 offen offset:3072 sc1
v_mfma_f32_16x16x32_bf16 v[144:147], a[228:231], a[16:19], v[144:147]
ds_read_b128 a[236:239], v14 offset:22528
v_perm_b32 v60, v101, v19, s53
v_mfma_f32_16x16x32_bf16 v[148:151], a[228:231], a[20:23], v[148:151]
ds_read_b32 a43, v60
v_perm_b32 v59, v97, v19, s54
v_mfma_f32_16x16x32_bf16 v[152:155], a[228:231], a[24:27], v[152:155]
ds_read_b32 a44, v59
v_perm_b32 v58, v97, v19, s55
v_mfma_f32_16x16x32_bf16 v[156:159], a[228:231], a[28:31], v[156:159]
s_waitcnt lgkmcnt(4)
ds_read_b32 a45, v58
v_add_u32 v12, 4096, v12
v_mfma_f32_16x16x32_bf16 v[224:227], a[232:235], a[192:195], v[224:227]
ds_read_b128 a[240:243], v14 offset:24576
v_perm_b32 v57, v101, v19, s54
v_mfma_f32_16x16x32_bf16 v[228:231], a[232:235], a[196:199], v[228:231]
ds_read_b32 a46, v57
v_perm_b32 v56, v101, v19, s55
v_mfma_f32_16x16x32_bf16 v[232:235], a[232:235], a[200:203], v[232:235]
s_add_u32 m0, s33, 121728
ds_read_b32 a47, v56
v_mfma_f32_16x16x32_bf16 v[236:239], a[232:235], a[204:207], v[236:239]
s_waitcnt lgkmcnt(4)
v_mfma_f32_16x16x32_bf16 v[240:243], a[236:239], a[192:195], v[240:243]
ds_read_b128 a[244:247], v14 offset:26624
buffer_load_dwordx4 v10, s[20:23], 0 offen offset:1152 lds
v_mfma_f32_16x16x32_bf16 v[244:247], a[236:239], a[196:199], v[244:247]
v_mfma_f32_16x16x32_bf16 v[248:251], a[236:239], a[200:203], v[248:251]
s_waitcnt vmcnt(8)
v_cmp_ne_u64 s[50:51], s[88:89], v[106:107]
v_cmp_ne_u64 vcc, s[88:89], v[110:111]
v_mfma_f32_16x16x32_bf16 v[252:255], a[236:239], a[204:207], v[252:255]
s_waitcnt lgkmcnt(1)
v_mfma_f32_16x16x32_bf16 v[128:131], a[240:243], a[32:35], v[128:131]
s_or_b64 vcc, vcc, s[50:51]
ds_read_b128 a[248:251], v15 offset:16384
v_mfma_f32_16x16x32_bf16 v[132:135], a[240:243], a[36:39], v[132:135]
s_cbranch_scc1 L_SLOW17
L_BACK17:
v_mfma_f32_16x16x32_bf16 v[136:139], a[240:243], a[40:43], v[136:139]
v_perm_b32 v63, v104, v19, s52
v_mfma_f32_16x16x32_bf16 v[140:143], a[240:243], a[44:47], v[140:143]
s_waitcnt lgkmcnt(1)
ds_read_b32 a48, v63
v_mfma_f32_16x16x32_bf16 v[144:147], a[244:247], a[32:35], v[144:147]
ds_read_b128 a[252:255], v15 offset:18432
v_perm_b32 v62, v104, v19, s53
v_mfma_f32_16x16x32_bf16 v[148:151], a[244:247], a[36:39], v[148:151]
ds_read_b32 a49, v62
v_perm_b32 v61, v108, v19, s52
v_mfma_f32_16x16x32_bf16 v[152:155], a[244:247], a[40:43], v[152:155]
s_add_u32 m0, s33, 125952
ds_read_b32 a50, v61
v_perm_b32 v60, v108, v19, s53
v_mfma_f32_16x16x32_bf16 v[156:159], a[244:247], a[44:47], v[156:159]
s_waitcnt lgkmcnt(4)
ds_read_b32 a51, v60
v_perm_b32 v59, v104, v19, s54
v_mfma_f32_16x16x32_bf16 v[160:163], a[248:251], a[16:19], v[160:163]
ds_read_b128 a[224:227], v14 offset:28672
buffer_load_dwordx4 v11, s[20:23], 0 offen offset:1024 lds
v_mfma_f32_16x16x32_bf16 v[164:167], a[248:251], a[20:23], v[164:167]
ds_read_b32 a52, v59
v_perm_b32 v58, v104, v19, s55
v_mfma_f32_16x16x32_bf16 v[168:171], a[248:251], a[24:27], v[168:171]
ds_read_b32 a53, v58
v_perm_b32 v57, v108, v19, s54
v_mfma_f32_16x16x32_bf16 v[172:175], a[248:251], a[28:31], v[172:175]
s_waitcnt lgkmcnt(4)
ds_read_b32 a54, v57
buffer_load_dwordx4 v[40:43], v12, s[24:27], 0 offen offset:0 sc1
v_mfma_f32_16x16x32_bf16 v[176:179], a[252:255], a[16:19], v[176:179]
ds_read_b128 a[228:231], v14 offset:30720
v_perm_b32 v56, v108, v19, s55
v_mfma_f32_16x16x32_bf16 v[180:183], a[252:255], a[20:23], v[180:183]
ds_read_b32 a55, v56
v_perm_b32 v63, v105, v19, s52
v_mfma_f32_16x16x32_bf16 v[184:187], a[252:255], a[24:27], v[184:187]
ds_read_b32 a56, v63
v_perm_b32 v62, v105, v19, s53
v_mfma_f32_16x16x32_bf16 v[188:191], a[252:255], a[28:31], v[188:191]
s_waitcnt lgkmcnt(4)
ds_read_b32 a57, v62
buffer_load_dwordx4 v[44:47], v12, s[24:27], 0 offen offset:1024 sc1
v_mfma_f32_16x16x32_bf16 v[192:195], a[224:227], a[0:3], v[192:195]
ds_read_b128 a[232:235], v15 offset:20480
v_perm_b32 v61, v109, v19, s52
v_mfma_f32_16x16x32_bf16 v[196:199], a[224:227], a[4:7], v[196:199]
ds_read_b32 a58, v61
v_perm_b32 v60, v109, v19, s53
v_mfma_f32_16x16x32_bf16 v[200:203], a[224:227], a[8:11], v[200:203]
s_add_u32 m0, s33, 129792
ds_read_b32 a59, v60
v_perm_b32 v59, v105, v19, s54
v_mfma_f32_16x16x32_bf16 v[204:207], a[224:227], a[12:15], v[204:207]
s_waitcnt lgkmcnt(4)
ds_read_b32 a60, v59
v_perm_b32 v58, v105, v19, s55
v_mfma_f32_16x16x32_bf16 v[208:211], a[228:231], a[0:3], v[208:211]
ds_read_b128 a[236:239], v15 offset:22528
buffer_load_dwordx4 v9, s[20:23], 0 offen offset:1280 lds
v_mfma_f32_16x16x32_bf16 v[212:215], a[228:231], a[4:7], v[212:215]
ds_read_b32 a61, v58
v_perm_b32 v57, v109, v19, s54
v_mfma_f32_16x16x32_bf16 v[216:219], a[228:231], a[8:11], v[216:219]
s_waitcnt vmcnt(8)
v_cmp_ne_u64 s[50:51], s[88:89], v[114:115]
v_cmp_ne_u64 vcc, s[88:89], v[118:119]
v_mfma_f32_16x16x32_bf16 v[220:223], a[228:231], a[12:15], v[220:223]
s_waitcnt lgkmcnt(3)
ds_read_b32 a62, v57
v_mfma_f32_16x16x32_bf16 v[224:227], a[232:235], a[208:211], v[224:227]
s_or_b64 vcc, vcc, s[50:51]
ds_read_b128 a[240:243], v15 offset:24576
v_perm_b32 v56, v109, v19, s55
v_mfma_f32_16x16x32_bf16 v[228:231], a[232:235], a[212:215], v[228:231]
s_cbranch_scc1 L_SLOW18
L_BACK18:
v_mfma_f32_16x16x32_bf16 v[232:235], a[232:235], a[216:219], v[232:235]
ds_read_b32 a63, v56
v_perm_b32 v63, v112, v19, s52
v_mfma_f32_16x16x32_bf16 v[236:239], a[232:235], a[220:223], v[236:239]
s_waitcnt lgkmcnt(3)
ds_read_b32 a64, v63
v_mfma_f32_16x16x32_bf16 v[240:243], a[236:239], a[208:211], v[240:243]
ds_read_b128 a[244:247], v15 offset:26624
v_perm_b32 v62, v112, v19, s53
v_mfma_f32_16x16x32_bf16 v[244:247], a[236:239], a[212:215], v[244:247]
ds_read_b32 a65, v62
v_perm_b32 v61, v116, v19, s52
v_mfma_f32_16x16x32_bf16 v[248:251], a[236:239], a[216:219], v[248:251]
s_add_u32 m0, s33, 133760
ds_read_b32 a66, v61
v_perm_b32 v60, v116, v19, s53
v_mfma_f32_16x16x32_bf16 v[252:255], a[236:239], a[220:223], v[252:255]
s_waitcnt lgkmcnt(4)
ds_read_b32 a67, v60
v_perm_b32 v59, v112, v19, s54
v_mfma_f32_16x16x32_bf16 v[128:131], a[240:243], a[48:51], v[128:131]
ds_read_b128 a[248:251], v14 offset:32768
buffer_load_dwordx4 v8, s[20:23], 0 offen offset:1408 lds
v_mfma_f32_16x16x32_bf16 v[132:135], a[240:243], a[52:55], v[132:135]
ds_read_b32 a68, v59
v_perm_b32 v58, v112, v19, s55
v_mfma_f32_16x16x32_bf16 v[136:139], a[240:243], a[56:59], v[136:139]
ds_read_b32 a69, v58
v_perm_b32 v57, v116, v19, s54
v_mfma_f32_16x16x32_bf16 v[140:143], a[240:243], a[60:63], v[140:143]
s_waitcnt lgkmcnt(4)
ds_read_b32 a70, v57
v_mfma_f32_16x16x32_bf16 v[144:147], a[244:247], a[48:51], v[144:147]
ds_read_b128 a[252:255], v14 offset:34816
v_perm_b32 v56, v116, v19, s55
v_mfma_f32_16x16x32_bf16 v[148:151], a[244:247], a[52:55], v[148:151]
ds_read_b32 a71, v56
v_perm_b32 v63, v113, v19, s52
v_mfma_f32_16x16x32_bf16 v[152:155], a[244:247], a[56:59], v[152:155]
ds_read_b32 a72, v63
v_perm_b32 v62, v113, v19, s53
v_mfma_f32_16x16x32_bf16 v[156:159], a[244:247], a[60:63], v[156:159]
s_waitcnt lgkmcnt(4)
ds_read_b32 a73, v62
buffer_load_dwordx4 v[48:51], v12, s[24:27], 0 offen offset:2048 sc1
v_mfma_f32_16x16x32_bf16 v[160:163], a[248:251], a[32:35], v[160:163]
s_waitcnt vmcnt(9)
s_barrier
ds_read_b128 a[224:227], v15 offset:28672
v_perm_b32 v61, v117, v19, s52
v_mfma_f32_16x16x32_bf16 v[164:167], a[248:251], a[36:39], v[164:167]
ds_read_b32 a74, v61
v_perm_b32 v60, v117, v19, s53
v_mfma_f32_16x16x32_bf16 v[168:171], a[248:251], a[40:43], v[168:171]
ds_read_b32 a75, v60
v_perm_b32 v59, v113, v19, s54
v_mfma_f32_16x16x32_bf16 v[172:175], a[248:251], a[44:47], v[172:175]
s_waitcnt lgkmcnt(4)
ds_read_b32 a76, v59
buffer_load_dwordx4 v[52:55], v12, s[24:27], 0 offen offset:3072 sc1
v_mfma_f32_16x16x32_bf16 v[176:179], a[252:255], a[32:35], v[176:179]
ds_read_b128 a[228:231], v15 offset:30720
v_perm_b32 v58, v113, v19, s55
v_mfma_f32_16x16x32_bf16 v[180:183], a[252:255], a[36:39], v[180:183]
ds_read_b32 a77, v58
v_perm_b32 v57, v117, v19, s54
v_mfma_f32_16x16x32_bf16 v[184:187], a[252:255], a[40:43], v[184:187]
ds_read_b32 a78, v57
v_add_u32 v12, 4096, v12
v_mfma_f32_16x16x32_bf16 v[188:191], a[252:255], a[44:47], v[188:191]
s_waitcnt vmcnt(8) lgkmcnt(4)
v_cmp_ne_u64 s[50:51], s[88:89], v[34:35]
v_cmp_ne_u64 vcc, s[88:89], v[38:39]
v_mfma_f32_16x16x32_bf16 v[192:195], a[224:227], a[16:19], v[192:195]
ds_read_b128 a[232:235], v14 offset:36864
v_perm_b32 v56, v117, v19, s55
v_mfma_f32_16x16x32_bf16 v[196:199], a[224:227], a[20:23], v[196:199]
s_or_b64 vcc, vcc, s[50:51]
ds_read_b32 a79, v56
v_mfma_f32_16x16x32_bf16 v[200:203], a[224:227], a[24:27], v[200:203]
s_cbranch_scc1 L_SLOW19
L_BACK19:
v_mfma_f32_16x16x32_bf16 v[204:207], a[224:227], a[28:31], v[204:207]
s_waitcnt lgkmcnt(2)
v_mfma_f32_16x16x32_bf16 v[208:211], a[228:231], a[16:19], v[208:211]
ds_read_b128 a[236:239], v14 offset:38912
v_mfma_f32_16x16x32_bf16 v[212:215], a[228:231], a[20:23], v[212:215]
v_perm_b32 v63, v32, v19, s52
v_mfma_f32_16x16x32_bf16 v[216:219], a[228:231], a[24:27], v[216:219]
ds_read_b32 a80, v63
v_perm_b32 v62, v32, v19, s53
v_mfma_f32_16x16x32_bf16 v[220:223], a[228:231], a[28:31], v[220:223]
s_waitcnt lgkmcnt(2)
ds_read_b32 a81, v62
v_mfma_f32_16x16x32_bf16 v[128:131], a[232:235], a[64:67], v[128:131]
ds_read_b128 a[240:243], v15 offset:32768
v_perm_b32 v61, v36, v19, s52
v_mfma_f32_16x16x32_bf16 v[132:135], a[232:235], a[68:71], v[132:135]
ds_read_b32 a82, v61
v_perm_b32 v60, v36, v19, s53
v_mfma_f32_16x16x32_bf16 v[136:139], a[232:235], a[72:75], v[136:139]
s_add_u32 m0, s33, 137856
ds_read_b32 a83, v60
v_perm_b32 v59, v32, v19, s54
v_mfma_f32_16x16x32_bf16 v[140:143], a[232:235], a[76:79], v[140:143]
s_waitcnt lgkmcnt(4)
ds_read_b32 a84, v59
v_perm_b32 v58, v32, v19, s55
v_mfma_f32_16x16x32_bf16 v[144:147], a[236:239], a[64:67], v[144:147]
ds_read_b128 a[244:247], v15 offset:34816
buffer_load_dwordx4 v9, s[20:23], 0 offen offset:1408 lds
v_mfma_f32_16x16x32_bf16 v[148:151], a[236:239], a[68:71], v[148:151]
ds_read_b32 a85, v58
v_perm_b32 v57, v36, v19, s54
v_mfma_f32_16x16x32_bf16 v[152:155], a[236:239], a[72:75], v[152:155]
ds_read_b32 a86, v57
v_perm_b32 v56, v36, v19, s55
v_mfma_f32_16x16x32_bf16 v[156:159], a[236:239], a[76:79], v[156:159]
s_waitcnt lgkmcnt(4)
ds_read_b32 a87, v56
v_mfma_f32_16x16x32_bf16 v[160:163], a[240:243], a[48:51], v[160:163]
ds_read_b128 a[248:251], v14 offset:40960
v_perm_b32 v63, v33, v19, s52
v_mfma_f32_16x16x32_bf16 v[164:167], a[240:243], a[52:55], v[164:167]
ds_read_b32 a88, v63
v_perm_b32 v62, v33, v19, s53
v_mfma_f32_16x16x32_bf16 v[168:171], a[240:243], a[56:59], v[168:171]
ds_read_b32 a89, v62
v_perm_b32 v61, v37, v19, s52
v_mfma_f32_16x16x32_bf16 v[172:175], a[240:243], a[60:63], v[172:175]
s_waitcnt lgkmcnt(4)
ds_read_b32 a90, v61
v_mfma_f32_16x16x32_bf16 v[176:179], a[244:247], a[48:51], v[176:179]
ds_read_b128 a[252:255], v14 offset:43008
v_perm_b32 v60, v37, v19, s53
v_mfma_f32_16x16x32_bf16 v[180:183], a[244:247], a[52:55], v[180:183]
ds_read_b32 a91, v60
v_perm_b32 v59, v33, v19, s54
v_mfma_f32_16x16x32_bf16 v[184:187], a[244:247], a[56:59], v[184:187]
s_add_u32 m0, s33, 142080
ds_read_b32 a92, v59
v_perm_b32 v58, v33, v19, s55
v_mfma_f32_16x16x32_bf16 v[188:191], a[244:247], a[60:63], v[188:191]
s_waitcnt vmcnt(5) lgkmcnt(4)
v_cmp_ne_u64 s[50:51], s[88:89], v[42:43]
v_cmp_ne_u64 vcc, s[88:89], v[46:47]
v_mfma_f32_16x16x32_bf16 v[224:227], a[248:251], a[0:3], v[224:227]
ds_read_b128 a[224:227], v14 offset:45056
buffer_load_dwordx4 v10, s[20:23], 0 offen offset:1280 lds
v_mfma_f32_16x16x32_bf16 v[228:231], a[248:251], a[4:7], v[228:231]
s_or_b64 vcc, vcc, s[50:51]
ds_read_b32 a93, v58
v_perm_b32 v57, v37, v19, s54
v_mfma_f32_16x16x32_bf16 v[232:235], a[248:251], a[8:11], v[232:235]
s_cbranch_scc1 L_SLOW20
L_BACK20:
v_mfma_f32_16x16x32_bf16 v[236:239], a[248:251], a[12:15], v[236:239]
s_waitcnt lgkmcnt(2)
ds_read_b32 a94, v57
buffer_load_dwordx4 v[96:99], v12, s[24:27], 0 offen offset:0 sc1
v_mfma_f32_16x16x32_bf16 v[240:243], a[252:255], a[0:3], v[240:243]
ds_read_b128 a[228:231], v14 offset:47104
v_perm_b32 v56, v37, v19, s55
v_mfma_f32_16x16x32_bf16 v[244:247], a[252:255], a[4:7], v[244:247]
ds_read_b32 a95, v56
v_perm_b32 v63, v40, v19, s52
v_mfma_f32_16x16x32_bf16 v[248:251], a[252:255], a[8:11], v[248:251]
ds_read_b32 a96, v63
v_perm_b32 v62, v40, v19, s53
v_mfma_f32_16x16x32_bf16 v[252:255], a[252:255], a[12:15], v[252:255]
s_waitcnt lgkmcnt(4)
ds_read_b32 a97, v62
buffer_load_dwordx4 v[100:103], v12, s[24:27], 0 offen offset:1024 sc1
v_mfma_f32_16x16x32_bf16 v[192:195], a[224:227], a[32:35], v[192:195]
ds_read_b128 a[232:235], v15 offset:36864
v_perm_b32 v61, v44, v19, s52
v_mfma_f32_16x16x32_bf16 v[196:199], a[224:227], a[36:39], v[196:199]
ds_read_b32 a98, v61
v_perm_b32 v60, v44, v19, s53
v_mfma_f32_16x16x32_bf16 v[200:203], a[224:227], a[40:43], v[200:203]
s_add_u32 m0, s33, 145920
ds_read_b32 a99, v60
v_perm_b32 v59, v40, v19, s54
v_mfma_f32_16x16x32_bf16 v[204:207], a[224:227], a[44:47], v[204:207]
s_waitcnt lgkmcnt(4)
ds_read_b32 a100, v59
v_perm_b32 v58, v40, v19, s55
v_mfma_f32_16x16x32_bf16 v[208:211], a[228:231], a[32:35], v[208:211]
ds_read_b128 a[236:239], v15 offset:38912
buffer_load_dwordx4 v8, s[20:23], 0 offen offset:1536 lds
v_mfma_f32_16x16x32_bf16 v[212:215], a[228:231], a[36:39], v[212:215]
ds_read_b32 a101, v58
v_perm_b32 v57, v44, v19, s54
v_mfma_f32_16x16x32_bf16 v[216:219], a[228:231], a[40:43], v[216:219]
ds_read_b32 a102, v57
v_perm_b32 v56, v44, v19, s55
v_mfma_f32_16x16x32_bf16 v[220:223], a[228:231], a[44:47], v[220:223]
s_waitcnt lgkmcnt(4)
ds_read_b32 a103, v56
v_mfma_f32_16x16x32_bf16 v[128:131], a[232:235], a[80:83], v[128:131]
ds_read_b128 a[240:243], v14 offset:49152
v_perm_b32 v63, v41, v19, s52
v_mfma_f32_16x16x32_bf16 v[132:135], a[232:235], a[84:87], v[132:135]
ds_read_b32 a104, v63
v_perm_b32 v62, v41, v19, s53
v_mfma_f32_16x16x32_bf16 v[136:139], a[232:235], a[88:91], v[136:139]
ds_read_b32 a105, v62
v_perm_b32 v61, v45, v19, s52
v_mfma_f32_16x16x32_bf16 v[140:143], a[232:235], a[92:95], v[140:143]
s_waitcnt lgkmcnt(4)
ds_read_b32 a106, v61
v_mfma_f32_16x16x32_bf16 v[144:147], a[236:239], a[80:83], v[144:147]
ds_read_b128 a[244:247], v14 offset:51200
v_perm_b32 v60, v45, v19, s53
v_mfma_f32_16x16x32_bf16 v[148:151], a[236:239], a[84:87], v[148:151]
ds_read_b32 a107, v60
v_perm_b32 v59, v41, v19, s54
v_mfma_f32_16x16x32_bf16 v[152:155], a[236:239], a[88:91], v[152:155]
s_add_u32 m0, s33, 150400
ds_read_b32 a108, v59
v_perm_b32 v58, v41, v19, s55
v_mfma_f32_16x16x32_bf16 v[156:159], a[236:239], a[92:95], v[156:159]
s_waitcnt lgkmcnt(4)
ds_read_b32 a109, v58
v_perm_b32 v57, v45, v19, s54
v_mfma_f32_16x16x32_bf16 v[160:163], a[240:243], a[64:67], v[160:163]
ds_read_b128 a[248:251], v14 offset:53248
buffer_load_dwordx4 v11, s[20:23], 0 offen offset:1152 lds
v_mfma_f32_16x16x32_bf16 v[164:167], a[240:243], a[68:71], v[164:167]
ds_read_b32 a110, v57
v_perm_b32 v56, v45, v19, s55
v_mfma_f32_16x16x32_bf16 v[168:171], a[240:243], a[72:75], v[168:171]
ds_read_b32 a111, v56
buffer_load_dwordx4 v[104:107], v12, s[24:27], 0 offen offset:2048 sc1
v_mfma_f32_16x16x32_bf16 v[172:175], a[240:243], a[76:79], v[172:175]
s_waitcnt lgkmcnt(4)
buffer_load_dwordx4 v[108:111], v12, s[24:27], 0 offen offset:3072 sc1
v_mfma_f32_16x16x32_bf16 v[176:179], a[244:247], a[64:67], v[176:179]
ds_read_b128 a[252:255], v14 offset:55296
v_add_u32 v12, 4096, v12
v_mfma_f32_16x16x32_bf16 v[180:183], a[244:247], a[68:71], v[180:183]
v_mfma_f32_16x16x32_bf16 v[184:187], a[244:247], a[72:75], v[184:187]
v_mfma_f32_16x16x32_bf16 v[188:191], a[244:247], a[76:79], v[188:191]
s_waitcnt vmcnt(8) lgkmcnt(1)
v_cmp_ne_u64 s[50:51], s[88:89], v[50:51]
v_cmp_ne_u64 vcc, s[88:89], v[54:55]
v_mfma_f32_16x16x32_bf16 v[128:131], a[248:251], a[96:99], v[128:131]
s_barrier
ds_read_b128 a[224:227], v15 offset:40960
v_mfma_f32_16x16x32_bf16 v[132:135], a[248:251], a[100:103], v[132:135]
s_or_b64 vcc, vcc, s[50:51]
v_mfma_f32_16x16x32_bf16 v[136:139], a[248:251], a[104:107], v[136:139]
s_cbranch_scc1 L_SLOW21
L_BACK21:
v_mfma_f32_16x16x32_bf16 v[140:143], a[248:251], a[108:111], v[140:143]
s_waitcnt lgkmcnt(1)
v_mfma_f32_16x16x32_bf16 v[144:147], a[252:255], a[96:99], v[144:147]
ds_read_b128 a[228:231], v15 offset:43008
v_mfma_f32_16x16x32_bf16 v[148:151], a[252:255], a[100:103], v[148:151]
v_perm_b32 v63, v48, v19, s52
v_mfma_f32_16x16x32_bf16 v[152:155], a[252:255], a[104:107], v[152:155]
ds_read_b32 a112, v63
v_perm_b32 v62, v48, v19, s53
v_mfma_f32_16x16x32_bf16 v[156:159], a[252:255], a[108:111], v[156:159]
s_waitcnt lgkmcnt(2)
ds_read_b32 a113, v62
v_mfma_f32_16x16x32_bf16 v[224:227], a[224:227], a[16:19], v[224:227]
ds_read_b128 a[232:235], v15 offset:45056
v_perm_b32 v61, v52, v19, s52
v_mfma_f32_16x16x32_bf16 v[228:231], a[224:227], a[20:23], v[228:231]
ds_read_b32 a114, v61
v_perm_b32 v60, v52, v19, s53
v_mfma_f32_16x16x32_bf16 v[232:235], a[224:227], a[24:27], v[232:235]
ds_read_b32 a115, v60
v_perm_b32 v59, v48, v19, s54
v_mfma_f32_16x16x32_bf16 v[236:239], a[224:227], a[28:31], v[236:239]
s_waitcnt lgkmcnt(4)
ds_read_b32 a116, v59
v_mfma_f32_16x16x32_bf16 v[240:243], a[228:231], a[16:19], v[240:243]
ds_read_b128 a[236:239], v15 offset:47104
v_perm_b32 v58, v48, v19, s55
v_mfma_f32_16x16x32_bf16 v[244:247], a[228:231], a[20:23], v[244:247]
ds_read_b32 a117, v58
v_perm_b32 v57, v52, v19, s54
v_mfma_f32_16x16x32_bf16 v[248:251], a[228:231], a[24:27], v[248:251]
ds_read_b32 a118, v57
v_perm_b32 v56, v52, v19, s55
v_mfma_f32_16x16x32_bf16 v[252:255], a[228:231], a[28:31], v[252:255]
s_waitcnt lgkmcnt(4)
ds_read_b32 a119, v56
buffer_load_dwordx4 v[112:115], v12, s[24:27], 0 offen offset:0 sc1
v_mfma_f32_16x16x32_bf16 v[192:195], a[232:235], a[48:51], v[192:195]
ds_read_b128 a[240:243], v15 offset:49152
v_perm_b32 v63, v49, v19, s52
v_mfma_f32_16x16x32_bf16 v[196:199], a[232:235], a[52:55], v[196:199]
ds_read_b32 a120, v63
v_perm_b32 v62, v49, v19, s53
v_mfma_f32_16x16x32_bf16 v[200:203], a[232:235], a[56:59], v[200:203]
ds_read_b32 a121, v62
v_perm_b32 v61, v53, v19, s52
v_mfma_f32_16x16x32_bf16 v[204:207], a[232:235], a[60:63], v[204:207]
s_waitcnt lgkmcnt(4)
ds_read_b32 a122, v61
buffer_load_dwordx4 v[116:119], v12, s[24:27], 0 offen offset:1024 sc1
v_mfma_f32_16x16x32_bf16 v[208:211], a[236:239], a[48:51], v[208:211]
ds_read_b128 a[244:247], v15 offset:51200
v_perm_b32 v60, v53, v19, s53
v_mfma_f32_16x16x32_bf16 v[212:215], a[236:239], a[52:55], v[212:215]
ds_read_b32 a123, v60
v_perm_b32 v59, v49, v19, s54
v_mfma_f32_16x16x32_bf16 v[216:219], a[236:239], a[56:59], v[216:219]
ds_read_b32 a124, v59
v_perm_b32 v58, v49, v19, s55
v_mfma_f32_16x16x32_bf16 v[220:223], a[236:239], a[60:63], v[220:223]
s_waitcnt lgkmcnt(4)
ds_read_b32 a125, v58
v_mfma_f32_16x16x32_bf16 v[160:163], a[240:243], a[80:83], v[160:163]
ds_read_b128 a[248:251], v15 offset:53248
v_perm_b32 v57, v53, v19, s54
v_mfma_f32_16x16x32_bf16 v[164:167], a[240:243], a[84:87], v[164:167]
ds_read_b32 a126, v57
v_perm_b32 v56, v53, v19, s55
v_mfma_f32_16x16x32_bf16 v[168:171], a[240:243], a[88:91], v[168:171]
ds_read_b32 a127, v56
v_mfma_f32_16x16x32_bf16 v[172:175], a[240:243], a[92:95], v[172:175]
s_waitcnt lgkmcnt(4)
v_mfma_f32_16x16x32_bf16 v[176:179], a[244:247], a[80:83], v[176:179]
ds_read_b128 a[252:255], v15 offset:55296
v_mfma_f32_16x16x32_bf16 v[180:183], a[244:247], a[84:87], v[180:183]
v_mfma_f32_16x16x32_bf16 v[184:187], a[244:247], a[88:91], v[184:187]
s_waitcnt vmcnt(6)
s_add_u32 m0, s33, 153984
v_cmp_ne_u64 s[50:51], s[88:89], v[98:99]
v_cmp_ne_u64 vcc, s[88:89], v[102:103]
v_mfma_f32_16x16x32_bf16 v[188:191], a[244:247], a[92:95], v[188:191]
s_waitcnt lgkmcnt(1)
v_mfma_f32_16x16x32_bf16 v[128:131], a[248:251], a[112:115], v[128:131]
s_or_b64 vcc, vcc, s[50:51]
ds_read_b128 a[224:227], v14 offset:57344
buffer_load_dwordx4 v8, s[20:23], 0 offen offset:1664 lds
v_mfma_f32_16x16x32_bf16 v[132:135], a[248:251], a[116:119], v[132:135]
s_cbranch_scc1 L_SLOW22
L_BACK22:
v_mfma_f32_16x16x32_bf16 v[136:139], a[248:251], a[120:123], v[136:139]
v_perm_b32 v63, v96, v19, s52
v_mfma_f32_16x16x32_bf16 v[140:143], a[248:251], a[124:127], v[140:143]
s_waitcnt lgkmcnt(1)
ds_read_b32 a128, v63
v_mfma_f32_16x16x32_bf16 v[144:147], a[252:255], a[112:115], v[144:147]
ds_read_b128 a[228:231], v14 offset:59392
v_perm_b32 v62, v96, v19, s53
v_mfma_f32_16x16x32_bf16 v[148:151], a[252:255], a[116:119], v[148:151]
ds_read_b32 a129, v62
v_perm_b32 v61, v100, v19, s52
v_mfma_f32_16x16x32_bf16 v[152:155], a[252:255], a[120:123], v[152:155]
ds_read_b32 a130, v61
v_perm_b32 v60, v100, v19, s53
v_mfma_f32_16x16x32_bf16 v[156:159], a[252:255], a[124:127], v[156:159]
s_waitcnt lgkmcnt(4)
ds_read_b32 a131, v60
buffer_load_dwordx4 v[32:35], v12, s[24:27], 0 offen offset:2048 sc1
v_mfma_f32_16x16x32_bf16 v[192:195], a[224:227], a[64:67], v[192:195]
ds_read_b128 a[232:235], v14 offset:61440
v_perm_b32 v59, v96, v19, s54
v_mfma_f32_16x16x32_bf16 v[196:199], a[224:227], a[68:71], v[196:199]
ds_read_b32 a132, v59
v_perm_b32 v58, v96, v19, s55
v_mfma_f32_16x16x32_bf16 v[200:203], a[224:227], a[72:75], v[200:203]
s_add_u32 m0, s33, 158208
ds_read_b32 a133, v58
v_perm_b32 v57, v100, v19, s54
v_mfma_f32_16x16x32_bf16 v[204:207], a[224:227], a[76:79], v[204:207]
s_waitcnt lgkmcnt(4)
ds_read_b32 a134, v57
v_perm_b32 v56, v100, v19, s55
v_mfma_f32_16x16x32_bf16 v[208:211], a[228:231], a[64:67], v[208:211]
ds_read_b128 a[236:239], v14 offset:63488
buffer_load_dwordx4 v9, s[20:23], 0 offen offset:1536 lds
v_mfma_f32_16x16x32_bf16 v[212:215], a[228:231], a[68:71], v[212:215]
ds_read_b32 a135, v56
v_perm_b32 v63, v97, v19, s52
v_mfma_f32_16x16x32_bf16 v[216:219], a[228:231], a[72:75], v[216:219]
ds_read_b32 a136, v63
v_perm_b32 v62, v97, v19, s53
v_mfma_f32_16x16x32_bf16 v[220:223], a[228:231], a[76:79], v[220:223]
s_waitcnt lgkmcnt(4)
ds_read_b32 a137, v62
buffer_load_dwordx4 v[36:39], v12, s[24:27], 0 offen offset:3072 sc1
v_mfma_f32_16x16x32_bf16 v[224:227], a[232:235], a[32:35], v[224:227]
ds_read_b128 a[240:243], v16 offset:0
v_perm_b32 v61, v101, v19, s52
v_mfma_f32_16x16x32_bf16 v[228:231], a[232:235], a[36:39], v[228:231]
ds_read_b32 a138, v61
v_perm_b32 v60, v101, v19, s53
v_mfma_f32_16x16x32_bf16 v[232:235], a[232:235], a[40:43], v[232:235]
ds_read_b32 a139, v60
v_perm_b32 v59, v97, v19, s54
v_mfma_f32_16x16x32_bf16 v[236:239], a[232:235], a[44:47], v[236:239]
s_waitcnt lgkmcnt(4)
ds_read_b32 a140, v59
v_add_u32 v12, 4096, v12
v_mfma_f32_16x16x32_bf16 v[240:243], a[236:239], a[32:35], v[240:243]
ds_read_b128 a[244:247], v16 offset:2048
v_perm_b32 v58, v97, v19, s55
v_mfma_f32_16x16x32_bf16 v[244:247], a[236:239], a[36:39], v[244:247]
ds_read_b32 a141, v58
v_perm_b32 v57, v101, v19, s54
v_mfma_f32_16x16x32_bf16 v[248:251], a[236:239], a[40:43], v[248:251]
s_waitcnt vmcnt(6)
s_add_u32 m0, s33, 64128
v_cmp_ne_u64 s[50:51], s[88:89], v[106:107]
v_cmp_ne_u64 vcc, s[88:89], v[110:111]
v_mfma_f32_16x16x32_bf16 v[252:255], a[236:239], a[44:47], v[252:255]
s_waitcnt lgkmcnt(3)
ds_read_b32 a142, v57
v_perm_b32 v56, v101, v19, s55
v_mfma_f32_16x16x32_bf16 v[160:163], a[240:243], a[96:99], v[160:163]
s_or_b64 vcc, vcc, s[50:51]
ds_read_b128 a[248:251], v16 offset:4096
buffer_load_dwordx4 v10, s[20:23], 0 offen offset:1408 lds
v_mfma_f32_16x16x32_bf16 v[164:167], a[240:243], a[100:103], v[164:167]
s_cbranch_scc1 L_SLOW23
L_BACK23:
v_mfma_f32_16x16x32_bf16 v[168:171], a[240:243], a[104:107], v[168:171]
ds_read_b32 a143, v56
v_perm_b32 v63, v104, v19, s52
v_mfma_f32_16x16x32_bf16 v[172:175], a[240:243], a[108:111], v[172:175]
s_waitcnt lgkmcnt(3)
ds_read_b32 a144, v63
v_mfma_f32_16x16x32_bf16 v[176:179], a[244:247], a[96:99], v[176:179]
ds_read_b128 a[252:255], v16 offset:6144
v_perm_b32 v62, v104, v19, s53
v_mfma_f32_16x16x32_bf16 v[180:183], a[244:247], a[100:103], v[180:183]
ds_read_b32 a145, v62
v_perm_b32 v61, v108, v19, s52
v_mfma_f32_16x16x32_bf16 v[184:187], a[244:247], a[104:107], v[184:187]
ds_read_b32 a146, v61
v_perm_b32 v60, v108, v19, s53
v_mfma_f32_16x16x32_bf16 v[188:191], a[244:247], a[108:111], v[188:191]
s_waitcnt lgkmcnt(4)
ds_read_b32 a147, v60
buffer_load_dwordx4 v[40:43], v12, s[24:27], 0 offen offset:0 sc1
v_mfma_f32_16x16x32_bf16 v[128:131], a[248:251], a[128:131], v[128:131]
s_barrier
ds_read_b128 a[224:227], v15 offset:57344
v_perm_b32 v59, v104, v19, s54
v_mfma_f32_16x16x32_bf16 v[132:135], a[248:251], a[132:135], v[132:135]
ds_read_b32 a148, v59
v_perm_b32 v58, v104, v19, s55
v_mfma_f32_16x16x32_bf16 v[136:139], a[248:251], a[136:139], v[136:139]
ds_read_b32 a149, v58
v_perm_b32 v57, v108, v19, s54
v_mfma_f32_16x16x32_bf16 v[140:143], a[248:251], a[140:143], v[140:143]
s_waitcnt lgkmcnt(4)
ds_read_b32 a150, v57
buffer_load_dwordx4 v[44:47], v12, s[24:27], 0 offen offset:1024 sc1
v_mfma_f32_16x16x32_bf16 v[144:147], a[252:255], a[128:131], v[144:147]
ds_read_b128 a[228:231], v15 offset:59392
v_perm_b32 v56, v108, v19, s55
v_mfma_f32_16x16x32_bf16 v[148:151], a[252:255], a[132:135], v[148:151]
ds_read_b32 a151, v56
v_perm_b32 v63, v105, v19, s52
v_mfma_f32_16x16x32_bf16 v[152:155], a[252:255], a[136:139], v[152:155]
ds_read_b32 a152, v63
v_perm_b32 v62, v105, v19, s53
v_mfma_f32_16x16x32_bf16 v[156:159], a[252:255], a[140:143], v[156:159]
s_waitcnt lgkmcnt(4)
ds_read_b32 a153, v62
v_mfma_f32_16x16x32_bf16 v[192:195], a[224:227], a[80:83], v[192:195]
ds_read_b128 a[232:235], v17 offset:0
v_perm_b32 v61, v109, v19, s52
v_mfma_f32_16x16x32_bf16 v[196:199], a[224:227], a[84:87], v[196:199]
ds_read_b32 a154, v61
v_perm_b32 v60, v109, v19, s53
v_mfma_f32_16x16x32_bf16 v[200:203], a[224:227], a[88:91], v[200:203]
s_add_u32 m0, s33, 68352
ds_read_b32 a155, v60
v_perm_b32 v59, v105, v19, s54
v_mfma_f32_16x16x32_bf16 v[204:207], a[224:227], a[92:95], v[204:207]
s_waitcnt lgkmcnt(4)
ds_read_b32 a156, v59
v_perm_b32 v58, v105, v19, s55
v_mfma_f32_16x16x32_bf16 v[208:211], a[228:231], a[80:83], v[208:211]
ds_read_b128 a[236:239], v17 offset:2048
buffer_load_dwordx4 v11, s[20:23], 0 offen offset:1280 lds
v_mfma_f32_16x16x32_bf16 v[212:215], a[228:231], a[84:87], v[212:215]
ds_read_b32 a157, v58
v_perm_b32 v57, v109, v19, s54
v_mfma_f32_16x16x32_bf16 v[216:219], a[228:231], a[88:91], v[216:219]
s_waitcnt vmcnt(8)
v_cmp_ne_u64 s[50:51], s[88:89], v[114:115]
v_cmp_ne_u64 vcc, s[88:89], v[118:119]
v_mfma_f32_16x16x32_bf16 v[220:223], a[228:231], a[92:95], v[220:223]
s_waitcnt lgkmcnt(3)
ds_read_b32 a158, v57
v_mfma_f32_16x16x32_bf16 v[160:163], a[232:235], a[112:115], v[160:163]
s_or_b64 vcc, vcc, s[50:51]
ds_read_b128 a[240:243], v17 offset:4096
v_perm_b32 v56, v109, v19, s55
v_mfma_f32_16x16x32_bf16 v[164:167], a[232:235], a[116:119], v[164:167]
s_cbranch_scc1 L_SLOW24
L_BACK24:
v_mfma_f32_16x16x32_bf16 v[168:171], a[232:235], a[120:123], v[168:171]
ds_read_b32 a159, v56
v_perm_b32 v63, v112, v19, s52
v_mfma_f32_16x16x32_bf16 v[172:175], a[232:235], a[124:127], v[172:175]
s_waitcnt lgkmcnt(3)
ds_read_b32 a160, v63
v_mfma_f32_16x16x32_bf16 v[176:179], a[236:239], a[112:115], v[176:179]
ds_read_b128 a[244:247], v17 offset:6144
v_perm_b32 v62, v112, v19, s53
v_mfma_f32_16x16x32_bf16 v[180:183], a[236:239], a[116:119], v[180:183]
ds_read_b32 a161, v62
v_perm_b32 v61, v116, v19, s52
v_mfma_f32_16x16x32_bf16 v[184:187], a[236:239], a[120:123], v[184:187]
s_add_u32 m0, s33, 71936
ds_read_b32 a162, v61
v_perm_b32 v60, v116, v19, s53
v_mfma_f32_16x16x32_bf16 v[188:191], a[236:239], a[124:127], v[188:191]
s_waitcnt lgkmcnt(4)
ds_read_b32 a163, v60
v_perm_b32 v59, v112, v19, s54
v_mfma_f32_16x16x32_bf16 v[128:131], a[240:243], a[144:147], v[128:131]
ds_read_b128 a[248:251], v15 offset:61440
buffer_load_dwordx4 v8, s[20:23], 0 offen offset:1792 lds
v_mfma_f32_16x16x32_bf16 v[132:135], a[240:243], a[148:151], v[132:135]
ds_read_b32 a164, v59
v_perm_b32 v58, v112, v19, s55
v_mfma_f32_16x16x32_bf16 v[136:139], a[240:243], a[152:155], v[136:139]
ds_read_b32 a165, v58
v_perm_b32 v57, v116, v19, s54
v_mfma_f32_16x16x32_bf16 v[140:143], a[240:243], a[156:159], v[140:143]
s_waitcnt lgkmcnt(4)
ds_read_b32 a166, v57
v_mfma_f32_16x16x32_bf16 v[144:147], a[244:247], a[144:147], v[144:147]
ds_read_b128 a[252:255], v15 offset:63488
v_perm_b32 v56, v116, v19, s55
v_mfma_f32_16x16x32_bf16 v[148:151], a[244:247], a[148:151], v[148:151]
ds_read_b32 a167, v56
v_perm_b32 v63, v113, v19, s52
v_mfma_f32_16x16x32_bf16 v[152:155], a[244:247], a[152:155], v[152:155]
ds_read_b32 a168, v63
v_perm_b32 v62, v113, v19, s53
v_mfma_f32_16x16x32_bf16 v[156:159], a[244:247], a[156:159], v[156:159]
s_waitcnt lgkmcnt(4)
ds_read_b32 a169, v62
buffer_load_dwordx4 v[48:51], v12, s[24:27], 0 offen offset:2048 sc1
v_mfma_f32_16x16x32_bf16 v[224:227], a[248:251], a[48:51], v[224:227]
ds_read_b128 a[224:227], v16 offset:8192
v_perm_b32 v61, v117, v19, s52
v_mfma_f32_16x16x32_bf16 v[228:231], a[248:251], a[52:55], v[228:231]
ds_read_b32 a170, v61
v_perm_b32 v60, v117, v19, s53
v_mfma_f32_16x16x32_bf16 v[232:235], a[248:251], a[56:59], v[232:235]
s_add_u32 m0, s33, 76160
ds_read_b32 a171, v60
v_perm_b32 v59, v113, v19, s54
v_mfma_f32_16x16x32_bf16 v[236:239], a[248:251], a[60:63], v[236:239]
s_waitcnt lgkmcnt(4)
ds_read_b32 a172, v59
v_perm_b32 v58, v113, v19, s55
v_mfma_f32_16x16x32_bf16 v[240:243], a[252:255], a[48:51], v[240:243]
ds_read_b128 a[228:231], v16 offset:10240
buffer_load_dwordx4 v9, s[20:23], 0 offen offset:1664 lds
v_mfma_f32_16x16x32_bf16 v[244:247], a[252:255], a[52:55], v[244:247]
ds_read_b32 a173, v58
v_perm_b32 v57, v117, v19, s54
v_mfma_f32_16x16x32_bf16 v[248:251], a[252:255], a[56:59], v[248:251]
s_waitcnt vmcnt(7)
v_cmp_ne_u64 s[50:51], s[88:89], v[34:35]
v_cmp_ne_u64 vcc, s[88:89], v[38:39]
v_mfma_f32_16x16x32_bf16 v[252:255], a[252:255], a[60:63], v[252:255]
s_waitcnt lgkmcnt(3)
ds_read_b32 a174, v57
buffer_load_dwordx4 v[52:55], v12, s[24:27], 0 offen offset:3072 sc1
v_mfma_f32_16x16x32_bf16 v[160:163], a[224:227], a[128:131], v[160:163]
s_or_b64 vcc, vcc, s[50:51]
ds_read_b128 a[232:235], v16 offset:12288
v_perm_b32 v56, v117, v19, s55
v_mfma_f32_16x16x32_bf16 v[164:167], a[224:227], a[132:135], v[164:167]
s_cbranch_scc1 L_SLOW25
L_BACK25:
v_mfma_f32_16x16x32_bf16 v[168:171], a[224:227], a[136:139], v[168:171]
ds_read_b32 a175, v56
v_perm_b32 v63, v32, v19, s52
v_mfma_f32_16x16x32_bf16 v[172:175], a[224:227], a[140:143], v[172:175]
s_waitcnt lgkmcnt(3)
ds_read_b32 a176, v63
v_add_u32 v12, 4096, v12
v_mfma_f32_16x16x32_bf16 v[176:179], a[228:231], a[128:131], v[176:179]
ds_read_b128 a[236:239], v16 offset:14336
v_perm_b32 v62, v32, v19, s53
v_mfma_f32_16x16x32_bf16 v[180:183], a[228:231], a[132:135], v[180:183]
ds_read_b32 a177, v62
v_perm_b32 v61, v36, v19, s52
v_mfma_f32_16x16x32_bf16 v[184:187], a[228:231], a[136:139], v[184:187]
s_add_u32 m0, s33, 80384
ds_read_b32 a178, v61
v_perm_b32 v60, v36, v19, s53
v_mfma_f32_16x16x32_bf16 v[188:191], a[228:231], a[140:143], v[188:191]
s_waitcnt lgkmcnt(4)
ds_read_b32 a179, v60
v_perm_b32 v59, v32, v19, s54
v_mfma_f32_16x16x32_bf16 v[192:195], a[232:235], a[96:99], v[192:195]
ds_read_b128 a[240:243], v16 offset:16384
buffer_load_dwordx4 v10, s[20:23], 0 offen offset:1536 lds
v_mfma_f32_16x16x32_bf16 v[196:199], a[232:235], a[100:103], v[196:199]
ds_read_b32 a180, v59
v_perm_b32 v58, v32, v19, s55
v_mfma_f32_16x16x32_bf16 v[200:203], a[232:235], a[104:107], v[200:203]
ds_read_b32 a181, v58
v_perm_b32 v57, v36, v19, s54
v_mfma_f32_16x16x32_bf16 v[204:207], a[232:235], a[108:111], v[204:207]
s_waitcnt lgkmcnt(4)
ds_read_b32 a182, v57
v_mfma_f32_16x16x32_bf16 v[208:211], a[236:239], a[96:99], v[208:211]
ds_read_b128 a[244:247], v16 offset:18432
v_perm_b32 v56, v36, v19, s55
v_mfma_f32_16x16x32_bf16 v[212:215], a[236:239], a[100:103], v[212:215]
ds_read_b32 a183, v56
v_perm_b32 v63, v33, v19, s52
v_mfma_f32_16x16x32_bf16 v[216:219], a[236:239], a[104:107], v[216:219]
ds_read_b32 a184, v63
v_perm_b32 v62, v33, v19, s53
v_mfma_f32_16x16x32_bf16 v[220:223], a[236:239], a[108:111], v[220:223]
s_waitcnt lgkmcnt(4)
ds_read_b32 a185, v62
buffer_load_dwordx4 v[96:99], v12, s[24:27], 0 offen offset:0 sc1
v_mfma_f32_16x16x32_bf16 v[128:131], a[240:243], a[160:163], v[128:131]
ds_read_b128 a[248:251], v16 offset:20480
v_perm_b32 v61, v37, v19, s52
v_mfma_f32_16x16x32_bf16 v[132:135], a[240:243], a[164:167], v[132:135]
ds_read_b32 a186, v61
v_perm_b32 v60, v37, v19, s53
v_mfma_f32_16x16x32_bf16 v[136:139], a[240:243], a[168:171], v[136:139]
s_add_u32 m0, s33, 84096
ds_read_b32 a187, v60
v_perm_b32 v59, v33, v19, s54
v_mfma_f32_16x16x32_bf16 v[140:143], a[240:243], a[172:175], v[140:143]
s_waitcnt lgkmcnt(4)
ds_read_b32 a188, v59
v_perm_b32 v58, v33, v19, s55
v_mfma_f32_16x16x32_bf16 v[144:147], a[244:247], a[160:163], v[144:147]
ds_read_b128 a[252:255], v16 offset:22528
buffer_load_dwordx4 v8, s[20:23], 0 offen offset:1920 lds
v_mfma_f32_16x16x32_bf16 v[148:151], a[244:247], a[164:167], v[148:151]
ds_read_b32 a189, v58
v_perm_b32 v57, v37, v19, s54
v_mfma_f32_16x16x32_bf16 v[152:155], a[244:247], a[168:171], v[152:155]
ds_read_b32 a190, v57
buffer_load_dwordx4 v[100:103], v12, s[24:27], 0 offen offset:1024 sc1
v_mfma_f32_16x16x32_bf16 v[156:159], a[244:247], a[172:175], v[156:159]
s_waitcnt vmcnt(9) lgkmcnt(4)
v_cmp_ne_u64 s[50:51], s[88:89], v[42:43]
v_cmp_ne_u64 vcc, s[88:89], v[46:47]
v_mfma_f32_16x16x32_bf16 v[224:227], a[248:251], a[64:67], v[224:227]
s_barrier
ds_read_b128 a[224:227], v17 offset:16384
v_perm_b32 v56, v37, v19, s55
v_mfma_f32_16x16x32_bf16 v[228:231], a[248:251], a[68:71], v[228:231]
s_or_b64 vcc, vcc, s[50:51]
ds_read_b32 a191, v56
v_mfma_f32_16x16x32_bf16 v[232:235], a[248:251], a[72:75], v[232:235]
s_cbranch_scc1 L_SLOW26
L_BACK26:
v_mfma_f32_16x16x32_bf16 v[236:239], a[248:251], a[76:79], v[236:239]
s_waitcnt lgkmcnt(2)
v_mfma_f32_16x16x32_bf16 v[240:243], a[252:255], a[64:67], v[240:243]
ds_read_b128 a[228:231], v17 offset:18432
v_mfma_f32_16x16x32_bf16 v[244:247], a[252:255], a[68:71], v[244:247]
v_perm_b32 v63, v40, v19, s52
v_mfma_f32_16x16x32_bf16 v[248:251], a[252:255], a[72:75], v[248:251]
s_add_u32 m0, s33, 88320
ds_read_b32 a192, v63
v_perm_b32 v62, v40, v19, s53
v_mfma_f32_16x16x32_bf16 v[252:255], a[252:255], a[76:79], v[252:255]
s_waitcnt lgkmcnt(2)
ds_read_b32 a193, v62
v_perm_b32 v61, v44, v19, s52
v_mfma_f32_16x16x32_bf16 v[128:131], a[224:227], a[176:179], v[128:131]
ds_read_b128 a[232:235], v17 offset:8192
buffer_load_dwordx4 v9, s[20:23], 0 offen offset:1792 lds
v_mfma_f32_16x16x32_bf16 v[132:135], a[224:227], a[180:183], v[132:135]
ds_read_b32 a194, v61
v_perm_b32 v60, v44, v19, s53
v_mfma_f32_16x16x32_bf16 v[136:139], a[224:227], a[184:187], v[136:139]
ds_read_b32 a195, v60
v_perm_b32 v59, v40, v19, s54
v_mfma_f32_16x16x32_bf16 v[140:143], a[224:227], a[188:191], v[140:143]
s_waitcnt lgkmcnt(4)
ds_read_b32 a196, v59
v_mfma_f32_16x16x32_bf16 v[144:147], a[228:231], a[176:179], v[144:147]
ds_read_b128 a[236:239], v17 offset:10240
v_perm_b32 v58, v40, v19, s55
v_mfma_f32_16x16x32_bf16 v[148:151], a[228:231], a[180:183], v[148:151]
ds_read_b32 a197, v58
v_perm_b32 v57, v44, v19, s54
v_mfma_f32_16x16x32_bf16 v[152:155], a[228:231], a[184:187], v[152:155]
ds_read_b32 a198, v57
v_perm_b32 v56, v44, v19, s55
v_mfma_f32_16x16x32_bf16 v[156:159], a[228:231], a[188:191], v[156:159]
s_waitcnt lgkmcnt(4)
ds_read_b32 a199, v56
buffer_load_dwordx4 v[104:107], v12, s[24:27], 0 offen offset:2048 sc1
v_mfma_f32_16x16x32_bf16 v[160:163], a[232:235], a[144:147], v[160:163]
ds_read_b128 a[240:243], v17 offset:12288
v_perm_b32 v63, v41, v19, s52
v_mfma_f32_16x16x32_bf16 v[164:167], a[232:235], a[148:151], v[164:167]
ds_read_b32 a200, v63
v_perm_b32 v62, v41, v19, s53
v_mfma_f32_16x16x32_bf16 v[168:171], a[232:235], a[152:155], v[168:171]
s_add_u32 m0, s33, 92800
ds_read_b32 a201, v62
v_perm_b32 v61, v45, v19, s52
v_mfma_f32_16x16x32_bf16 v[172:175], a[232:235], a[156:159], v[172:175]
s_waitcnt lgkmcnt(4)
ds_read_b32 a202, v61
v_perm_b32 v60, v45, v19, s53
v_mfma_f32_16x16x32_bf16 v[176:179], a[236:239], a[144:147], v[176:179]
ds_read_b128 a[244:247], v17 offset:14336
buffer_load_dwordx4 v11, s[20:23], 0 offen offset:1408 lds
v_mfma_f32_16x16x32_bf16 v[180:183], a[236:239], a[148:151], v[180:183]
ds_read_b32 a203, v60
v_perm_b32 v59, v41, v19, s54
v_mfma_f32_16x16x32_bf16 v[184:187], a[236:239], a[152:155], v[184:187]
ds_read_b32 a204, v59
v_perm_b32 v58, v41, v19, s55
v_mfma_f32_16x16x32_bf16 v[188:191], a[236:239], a[156:159], v[188:191]
s_waitcnt lgkmcnt(4)
ds_read_b32 a205, v58
buffer_load_dwordx4 v[108:111], v12, s[24:27], 0 offen offset:3072 sc1
v_mfma_f32_16x16x32_bf16 v[192:195], a[240:243], a[112:115], v[192:195]
ds_read_b128 a[248:251], v16 offset:24576
v_perm_b32 v57, v45, v19, s54
v_mfma_f32_16x16x32_bf16 v[196:199], a[240:243], a[116:119], v[196:199]
ds_read_b32 a206, v57
v_perm_b32 v56, v45, v19, s55
v_mfma_f32_16x16x32_bf16 v[200:203], a[240:243], a[120:123], v[200:203]
ds_read_b32 a207, v56
v_add_u32 v12, 4096, v12
v_mfma_f32_16x16x32_bf16 v[204:207], a[240:243], a[124:127], v[204:207]
s_waitcnt lgkmcnt(4)
v_mfma_f32_16x16x32_bf16 v[208:211], a[244:247], a[112:115], v[208:211]
ds_read_b128 a[252:255], v16 offset:26624
v_mfma_f32_16x16x32_bf16 v[212:215], a[244:247], a[116:119], v[212:215]
v_mfma_f32_16x16x32_bf16 v[216:219], a[244:247], a[120:123], v[216:219]
s_waitcnt vmcnt(8)
s_add_u32 m0, s33, 96640
v_cmp_ne_u64 s[50:51], s[88:89], v[50:51]
v_cmp_ne_u64 vcc, s[88:89], v[54:55]
v_mfma_f32_16x16x32_bf16 v[220:223], a[244:247], a[124:127], v[220:223]
s_waitcnt lgkmcnt(1)
v_mfma_f32_16x16x32_bf16 v[128:131], a[248:251], a[192:195], v[128:131]
s_or_b64 vcc, vcc, s[50:51]
ds_read_b128 a[224:227], v16 offset:28672
buffer_load_dwordx4 v10, s[20:23], 0 offen offset:1664 lds
v_mfma_f32_16x16x32_bf16 v[132:135], a[248:251], a[196:199], v[132:135]
s_cbranch_scc1 L_SLOW27
L_BACK27:
v_mfma_f32_16x16x32_bf16 v[136:139], a[248:251], a[200:203], v[136:139]
v_perm_b32 v63, v48, v19, s52
v_mfma_f32_16x16x32_bf16 v[140:143], a[248:251], a[204:207], v[140:143]
s_waitcnt lgkmcnt(1)
ds_read_b32 a208, v63
v_mfma_f32_16x16x32_bf16 v[144:147], a[252:255], a[192:195], v[144:147]
ds_read_b128 a[228:231], v16 offset:30720
v_perm_b32 v62, v48, v19, s53
v_mfma_f32_16x16x32_bf16 v[148:151], a[252:255], a[196:199], v[148:151]
ds_read_b32 a209, v62
v_perm_b32 v61, v52, v19, s52
v_mfma_f32_16x16x32_bf16 v[152:155], a[252:255], a[200:203], v[152:155]
ds_read_b32 a210, v61
v_perm_b32 v60, v52, v19, s53
v_mfma_f32_16x16x32_bf16 v[156:159], a[252:255], a[204:207], v[156:159]
s_waitcnt lgkmcnt(4)
ds_read_b32 a211, v60
v_mfma_f32_16x16x32_bf16 v[160:163], a[224:227], a[160:163], v[160:163]
ds_read_b128 a[232:235], v17 offset:20480
v_perm_b32 v59, v48, v19, s54
v_mfma_f32_16x16x32_bf16 v[164:167], a[224:227], a[164:167], v[164:167]
ds_read_b32 a212, v59
v_perm_b32 v58, v48, v19, s55
v_mfma_f32_16x16x32_bf16 v[168:171], a[224:227], a[168:171], v[168:171]
s_add_u32 m0, s33, 100480
ds_read_b32 a213, v58
v_perm_b32 v57, v52, v19, s54
v_mfma_f32_16x16x32_bf16 v[172:175], a[224:227], a[172:175], v[172:175]
s_waitcnt lgkmcnt(4)
ds_read_b32 a214, v57
v_perm_b32 v56, v52, v19, s55
v_mfma_f32_16x16x32_bf16 v[176:179], a[228:231], a[160:163], v[176:179]
ds_read_b128 a[236:239], v17 offset:22528
buffer_load_dwordx4 v9, s[20:23], 0 offen offset:1920 lds
v_mfma_f32_16x16x32_bf16 v[180:183], a[228:231], a[164:167], v[180:183]
ds_read_b32 a215, v56
v_perm_b32 v63, v49, v19, s52
v_mfma_f32_16x16x32_bf16 v[184:187], a[228:231], a[168:171], v[184:187]
ds_read_b32 a216, v63
v_perm_b32 v62, v49, v19, s53
v_mfma_f32_16x16x32_bf16 v[188:191], a[228:231], a[172:175], v[188:191]
s_waitcnt lgkmcnt(4)
ds_read_b32 a217, v62
buffer_load_dwordx4 v[112:115], v12, s[24:27], 0 offen offset:0 sc1
v_mfma_f32_16x16x32_bf16 v[224:227], a[232:235], a[80:83], v[224:227]
ds_read_b128 a[240:243], v14 offset:0
v_perm_b32 v61, v53, v19, s52
v_mfma_f32_16x16x32_bf16 v[228:231], a[232:235], a[84:87], v[228:231]
ds_read_b32 a218, v61
v_perm_b32 v60, v53, v19, s53
v_mfma_f32_16x16x32_bf16 v[232:235], a[232:235], a[88:91], v[232:235]
ds_read_b32 a219, v60
v_perm_b32 v59, v49, v19, s54
v_mfma_f32_16x16x32_bf16 v[236:239], a[232:235], a[92:95], v[236:239]
s_waitcnt lgkmcnt(4)
ds_read_b32 a220, v59
buffer_load_dwordx4 v[116:119], v12, s[24:27], 0 offen offset:1024 sc1
v_mfma_f32_16x16x32_bf16 v[240:243], a[236:239], a[80:83], v[240:243]
ds_read_b128 a[244:247], v14 offset:2048
v_perm_b32 v58, v49, v19, s55
v_mfma_f32_16x16x32_bf16 v[244:247], a[236:239], a[84:87], v[244:247]
ds_read_b32 a221, v58
v_perm_b32 v57, v53, v19, s54
v_mfma_f32_16x16x32_bf16 v[248:251], a[236:239], a[88:91], v[248:251]
s_add_u32 m0, s33, 104960
ds_read_b32 a222, v57
v_perm_b32 v56, v53, v19, s55
v_mfma_f32_16x16x32_bf16 v[252:255], a[236:239], a[92:95], v[252:255]
s_waitcnt vmcnt(8) lgkmcnt(4)
v_cmp_ne_u64 s[50:51], s[88:89], v[98:99]
v_cmp_ne_u64 vcc, s[88:89], v[102:103]
v_mfma_f32_16x16x32_bf16 v[192:195], a[240:243], a[128:131], v[192:195]
ds_read_b128 a[248:251], v17 offset:24576
buffer_load_dwordx4 v11, s[20:23], 0 offen offset:1536 lds
v_mfma_f32_16x16x32_bf16 v[196:199], a[240:243], a[132:135], v[196:199]
s_or_b64 vcc, vcc, s[50:51]
ds_read_b32 a223, v56
v_mfma_f32_16x16x32_bf16 v[200:203], a[240:243], a[136:139], v[200:203]
s_cbranch_scc1 L_SLOW28
L_BACK28:
v_mfma_f32_16x16x32_bf16 v[204:207], a[240:243], a[140:143], v[204:207]
s_waitcnt lgkmcnt(2)
v_mfma_f32_16x16x32_bf16 v[208:211], a[244:247], a[128:131], v[208:211]
ds_read_b128 a[252:255], v17 offset:26624
v_mfma_f32_16x16x32_bf16 v[212:215], a[244:247], a[132:135], v[212:215]
v_perm_b32 v63, v96, v19, s52
v_mfma_f32_16x16x32_bf16 v[216:219], a[244:247], a[136:139], v[216:219]
ds_read_b32 a0, v63
v_perm_b32 v62, v96, v19, s53
v_mfma_f32_16x16x32_bf16 v[220:223], a[244:247], a[140:143], v[220:223]
s_waitcnt lgkmcnt(2)
ds_read_b32 a1, v62
v_mfma_f32_16x16x32_bf16 v[128:131], a[248:251], a[208:211], v[128:131]
s_barrier
ds_read_b128 a[224:227], v17 offset:28672
v_perm_b32 v61, v100, v19, s52
v_mfma_f32_16x16x32_bf16 v[132:135], a[248:251], a[212:215], v[132:135]
ds_read_b32 a2, v61
v_perm_b32 v60, v100, v19, s53
v_mfma_f32_16x16x32_bf16 v[136:139], a[248:251], a[216:219], v[136:139]
s_add_u32 m0, s33, 108800
ds_read_b32 a3, v60
v_perm_b32 v59, v96, v19, s54
v_mfma_f32_16x16x32_bf16 v[140:143], a[248:251], a[220:223], v[140:143]
s_waitcnt lgkmcnt(4)
ds_read_b32 a4, v59
v_perm_b32 v58, v96, v19, s55
v_mfma_f32_16x16x32_bf16 v[144:147], a[252:255], a[208:211], v[144:147]
ds_read_b128 a[228:231], v17 offset:30720
buffer_load_dwordx4 v10, s[20:23], 0 offen offset:1792 lds
v_mfma_f32_16x16x32_bf16 v[148:151], a[252:255], a[212:215], v[148:151]
ds_read_b32 a5, v58
v_perm_b32 v57, v100, v19, s54
v_mfma_f32_16x16x32_bf16 v[152:155], a[252:255], a[216:219], v[152:155]
ds_read_b32 a6, v57
v_perm_b32 v56, v100, v19, s55
v_mfma_f32_16x16x32_bf16 v[156:159], a[252:255], a[220:223], v[156:159]
s_waitcnt lgkmcnt(4)
ds_read_b32 a7, v56
v_mfma_f32_16x16x32_bf16 v[160:163], a[224:227], a[176:179], v[160:163]
ds_read_b128 a[232:235], v15 offset:0
v_perm_b32 v63, v97, v19, s52
v_mfma_f32_16x16x32_bf16 v[164:167], a[224:227], a[180:183], v[164:167]
ds_read_b32 a8, v63
v_perm_b32 v62, v97, v19, s53
v_mfma_f32_16x16x32_bf16 v[168:171], a[224:227], a[184:187], v[168:171]
ds_read_b32 a9, v62
v_perm_b32 v61, v101, v19, s52
v_mfma_f32_16x16x32_bf16 v[172:175], a[224:227], a[188:191], v[172:175]
s_waitcnt lgkmcnt(4)
ds_read_b32 a10, v61
v_mfma_f32_16x16x32_bf16 v[176:179], a[228:231], a[176:179], v[176:179]
ds_read_b128 a[236:239], v15 offset:2048
v_perm_b32 v60, v101, v19, s53
v_mfma_f32_16x16x32_bf16 v[180:183], a[228:231], a[180:183], v[180:183]
ds_read_b32 a11, v60
v_perm_b32 v59, v97, v19, s54
v_mfma_f32_16x16x32_bf16 v[184:187], a[228:231], a[184:187], v[184:187]
s_add_u32 m0, s33, 112768
ds_read_b32 a12, v59
v_perm_b32 v58, v97, v19, s55
v_mfma_f32_16x16x32_bf16 v[188:191], a[228:231], a[188:191], v[188:191]
s_waitcnt vmcnt(6) lgkmcnt(4)
v_cmp_ne_u64 s[50:51], s[88:89], v[106:107]
v_cmp_ne_u64 vcc, s[88:89], v[110:111]
v_mfma_f32_16x16x32_bf16 v[192:195], a[232:235], a[144:147], v[192:195]
ds_read_b128 a[240:243], v14 offset:4096
buffer_load_dwordx4 v10, s[20:23], 0 offen offset:1920 lds
v_mfma_f32_16x16x32_bf16 v[196:199], a[232:235], a[148:151], v[196:199]
s_or_b64 vcc, vcc, s[50:51]
ds_read_b32 a13, v58
v_perm_b32 v57, v101, v19, s54
v_mfma_f32_16x16x32_bf16 v[200:203], a[232:235], a[152:155], v[200:203]
s_cbranch_scc1 L_SLOW29
L_BACK29:
v_mfma_f32_16x16x32_bf16 v[204:207], a[232:235], a[156:159], v[204:207]
s_waitcnt lgkmcnt(2)
ds_read_b32 a14, v57
buffer_load_dwordx4 v[32:35], v12, s[24:27], 0 offen offset:2048 sc1
v_mfma_f32_16x16x32_bf16 v[208:211], a[236:239], a[144:147], v[208:211]
ds_read_b128 a[244:247], v14 offset:6144
v_perm_b32 v56, v101, v19, s55
v_mfma_f32_16x16x32_bf16 v[212:215], a[236:239], a[148:151], v[212:215]
ds_read_b32 a15, v56
v_perm_b32 v63, v104, v19, s52
v_mfma_f32_16x16x32_bf16 v[216:219], a[236:239], a[152:155], v[216:219]
ds_read_b32 a16, v63
v_perm_b32 v62, v104, v19, s53
v_mfma_f32_16x16x32_bf16 v[220:223], a[236:239], a[156:159], v[220:223]
s_waitcnt lgkmcnt(4)
ds_read_b32 a17, v62
buffer_load_dwordx4 v[36:39], v12, s[24:27], 0 offen offset:3072 sc1
v_mfma_f32_16x16x32_bf16 v[224:227], a[240:243], a[96:99], v[224:227]
ds_read_b128 a[248:251], v14 offset:8192
v_perm_b32 v61, v108, v19, s52
v_mfma_f32_16x16x32_bf16 v[228:231], a[240:243], a[100:103], v[228:231]
ds_read_b32 a18, v61
v_perm_b32 v60, v108, v19, s53
v_mfma_f32_16x16x32_bf16 v[232:235], a[240:243], a[104:107], v[232:235]
s_add_u32 m0, s33, 117120
ds_read_b32 a19, v60
v_perm_b32 v59, v104, v19, s54
v_mfma_f32_16x16x32_bf16 v[236:239], a[240:243], a[108:111], v[236:239]
s_waitcnt lgkmcnt(4)
ds_read_b32 a20, v59
v_perm_b32 v58, v104, v19, s55
v_mfma_f32_16x16x32_bf16 v[240:243], a[244:247], a[96:99], v[240:243]
ds_read_b128 a[252:255], v14 offset:10240
buffer_load_dwordx4 v11, s[20:23], 0 offen offset:1664 lds
v_mfma_f32_16x16x32_bf16 v[244:247], a[244:247], a[100:103], v[244:247]
ds_read_b32 a21, v58
v_perm_b32 v57, v108, v19, s54
v_mfma_f32_16x16x32_bf16 v[248:251], a[244:247], a[104:107], v[248:251]
ds_read_b32 a22, v57
v_perm_b32 v56, v108, v19, s55
v_mfma_f32_16x16x32_bf16 v[252:255], a[244:247], a[108:111], v[252:255]
s_waitcnt lgkmcnt(4)
ds_read_b32 a23, v56
v_mfma_f32_16x16x32_bf16 v[128:131], a[248:251], a[0:3], v[128:131]
ds_read_b128 a[224:227], v14 offset:12288
v_perm_b32 v63, v105, v19, s52
v_mfma_f32_16x16x32_bf16 v[132:135], a[248:251], a[4:7], v[132:135]
ds_read_b32 a24, v63
v_perm_b32 v62, v105, v19, s53
v_mfma_f32_16x16x32_bf16 v[136:139], a[248:251], a[8:11], v[136:139]
ds_read_b32 a25, v62
v_perm_b32 v61, v109, v19, s52
v_mfma_f32_16x16x32_bf16 v[140:143], a[248:251], a[12:15], v[140:143]
s_waitcnt lgkmcnt(4)
ds_read_b32 a26, v61
v_mfma_f32_16x16x32_bf16 v[144:147], a[252:255], a[0:3], v[144:147]
ds_read_b128 a[228:231], v14 offset:14336
v_perm_b32 v60, v109, v19, s53
v_mfma_f32_16x16x32_bf16 v[148:151], a[252:255], a[4:7], v[148:151]
ds_read_b32 a27, v60
v_perm_b32 v59, v105, v19, s54
v_mfma_f32_16x16x32_bf16 v[152:155], a[252:255], a[8:11], v[152:155]
s_add_u32 m0, s33, 121088
ds_read_b32 a28, v59
v_perm_b32 v58, v105, v19, s55
v_mfma_f32_16x16x32_bf16 v[156:159], a[252:255], a[12:15], v[156:159]
s_waitcnt lgkmcnt(4)
ds_read_b32 a29, v58
v_perm_b32 v57, v109, v19, s54
v_mfma_f32_16x16x32_bf16 v[160:163], a[224:227], a[192:195], v[160:163]
ds_read_b128 a[232:235], v15 offset:8192
buffer_load_dwordx4 v11, s[20:23], 0 offen offset:1792 lds
v_mfma_f32_16x16x32_bf16 v[164:167], a[224:227], a[196:199], v[164:167]
ds_read_b32 a30, v57
v_perm_b32 v56, v109, v19, s55
v_mfma_f32_16x16x32_bf16 v[168:171], a[224:227], a[200:203], v[168:171]
ds_read_b32 a31, v56
v_mfma_f32_16x16x32_bf16 v[172:175], a[224:227], a[204:207], v[172:175]
s_waitcnt lgkmcnt(4)
v_mfma_f32_16x16x32_bf16 v[176:179], a[228:231], a[192:195], v[176:179]
ds_read_b128 a[236:239], v15 offset:10240
v_mfma_f32_16x16x32_bf16 v[180:183], a[228:231], a[196:199], v[180:183]
v_mfma_f32_16x16x32_bf16 v[184:187], a[228:231], a[200:203], v[184:187]
s_waitcnt vmcnt(7)
v_cmp_ne_u64 s[50:51], s[88:89], v[114:115]
v_cmp_ne_u64 vcc, s[88:89], v[118:119]
v_mfma_f32_16x16x32_bf16 v[188:191], a[228:231], a[204:207], v[188:191]
s_waitcnt lgkmcnt(1)
v_mfma_f32_16x16x32_bf16 v[128:131], a[232:235], a[16:19], v[128:131]
s_or_b64 vcc, vcc, s[50:51]
ds_read_b128 a[240:243], v14 offset:16384
v_mfma_f32_16x16x32_bf16 v[132:135], a[232:235], a[20:23], v[132:135]
s_cbranch_scc1 L_SLOW30
L_BACK30:
v_mfma_f32_16x16x32_bf16 v[136:139], a[232:235], a[24:27], v[136:139]
s_add_u32 m0, s33, 125056
v_mfma_f32_16x16x32_bf16 v[140:143], a[232:235], a[28:31], v[140:143]
s_waitcnt lgkmcnt(1)
v_mfma_f32_16x16x32_bf16 v[144:147], a[236:239], a[16:19], v[144:147]
ds_read_b128 a[244:247], v14 offset:18432
buffer_load_dwordx4 v11, s[20:23], 0 offen offset:1920 lds
v_mfma_f32_16x16x32_bf16 v[148:151], a[236:239], a[20:23], v[148:151]
v_perm_b32 v63, v112, v19, s52
v_mfma_f32_16x16x32_bf16 v[152:155], a[236:239], a[24:27], v[152:155]
ds_read_b32 a32, v63
v_perm_b32 v62, v112, v19, s53
v_mfma_f32_16x16x32_bf16 v[156:159], a[236:239], a[28:31], v[156:159]
s_waitcnt lgkmcnt(2)
ds_read_b32 a33, v62
v_mfma_f32_16x16x32_bf16 v[192:195], a[240:243], a[160:163], v[192:195]
ds_read_b128 a[248:251], v15 offset:4096
v_perm_b32 v61, v116, v19, s52
v_mfma_f32_16x16x32_bf16 v[196:199], a[240:243], a[164:167], v[196:199]
ds_read_b32 a34, v61
v_perm_b32 v60, v116, v19, s53
v_mfma_f32_16x16x32_bf16 v[200:203], a[240:243], a[168:171], v[200:203]
ds_read_b32 a35, v60
v_perm_b32 v59, v112, v19, s54
v_mfma_f32_16x16x32_bf16 v[204:207], a[240:243], a[172:175], v[204:207]
s_waitcnt lgkmcnt(4)
ds_read_b32 a36, v59
v_mfma_f32_16x16x32_bf16 v[208:211], a[244:247], a[160:163], v[208:211]
ds_read_b128 a[252:255], v15 offset:6144
v_perm_b32 v58, v112, v19, s55
v_mfma_f32_16x16x32_bf16 v[212:215], a[244:247], a[164:167], v[212:215]
ds_read_b32 a37, v58
v_perm_b32 v57, v116, v19, s54
v_mfma_f32_16x16x32_bf16 v[216:219], a[244:247], a[168:171], v[216:219]
ds_read_b32 a38, v57
v_perm_b32 v56, v116, v19, s55
v_mfma_f32_16x16x32_bf16 v[220:223], a[244:247], a[172:175], v[220:223]
s_waitcnt lgkmcnt(4)
ds_read_b32 a39, v56
v_mfma_f32_16x16x32_bf16 v[224:227], a[248:251], a[112:115], v[224:227]
s_barrier
ds_read_b128 a[224:227], v15 offset:12288
v_perm_b32 v63, v113, v19, s52
v_mfma_f32_16x16x32_bf16 v[228:231], a[248:251], a[116:119], v[228:231]
ds_read_b32 a40, v63
v_perm_b32 v62, v113, v19, s53
v_mfma_f32_16x16x32_bf16 v[232:235], a[248:251], a[120:123], v[232:235]
ds_read_b32 a41, v62
v_perm_b32 v61, v117, v19, s52
v_mfma_f32_16x16x32_bf16 v[236:239], a[248:251], a[124:127], v[236:239]
s_waitcnt lgkmcnt(4)
ds_read_b32 a42, v61
v_mfma_f32_16x16x32_bf16 v[240:243], a[252:255], a[112:115], v[240:243]
ds_read_b128 a[228:231], v15 offset:14336
v_perm_b32 v60, v117, v19, s53
v_mfma_f32_16x16x32_bf16 v[244:247], a[252:255], a[116:119], v[244:247]
ds_read_b32 a43, v60
v_perm_b32 v59, v113, v19, s54
v_mfma_f32_16x16x32_bf16 v[248:251], a[252:255], a[120:123], v[248:251]
ds_read_b32 a44, v59
v_perm_b32 v58, v113, v19, s55
v_mfma_f32_16x16x32_bf16 v[252:255], a[252:255], a[124:127], v[252:255]
s_waitcnt lgkmcnt(4)
ds_read_b32 a45, v58
v_mfma_f32_16x16x32_bf16 v[160:163], a[224:227], a[208:211], v[160:163]
ds_read_b128 a[232:235], v14 offset:20480
v_perm_b32 v57, v117, v19, s54
v_mfma_f32_16x16x32_bf16 v[164:167], a[224:227], a[212:215], v[164:167]
ds_read_b32 a46, v57
v_perm_b32 v56, v117, v19, s55
v_mfma_f32_16x16x32_bf16 v[168:171], a[224:227], a[216:219], v[168:171]
ds_read_b32 a47, v56
v_mfma_f32_16x16x32_bf16 v[172:175], a[224:227], a[220:223], v[172:175]
s_waitcnt lgkmcnt(4)
v_mfma_f32_16x16x32_bf16 v[176:179], a[228:231], a[208:211], v[176:179]
ds_read_b128 a[236:239], v14 offset:22528
v_mfma_f32_16x16x32_bf16 v[180:183], a[228:231], a[212:215], v[180:183]
v_mfma_f32_16x16x32_bf16 v[184:187], a[228:231], a[216:219], v[184:187]
v_mfma_f32_16x16x32_bf16 v[188:191], a[228:231], a[220:223], v[188:191]
s_waitcnt vmcnt(3) lgkmcnt(1)
v_cmp_ne_u64 s[50:51], s[88:89], v[34:35]
v_cmp_ne_u64 vcc, s[88:89], v[38:39]
v_mfma_f32_16x16x32_bf16 v[128:131], a[232:235], a[32:35], v[128:131]
ds_read_b128 a[240:243], v15 offset:16384
v_mfma_f32_16x16x32_bf16 v[132:135], a[232:235], a[36:39], v[132:135]
s_or_b64 vcc, vcc, s[50:51]
v_mfma_f32_16x16x32_bf16 v[136:139], a[232:235], a[40:43], v[136:139]
s_cbranch_scc1 L_SLOW31
L_BACK31:
v_mfma_f32_16x16x32_bf16 v[140:143], a[232:235], a[44:47], v[140:143]
s_waitcnt lgkmcnt(1)
v_mfma_f32_16x16x32_bf16 v[144:147], a[236:239], a[32:35], v[144:147]
ds_read_b128 a[244:247], v15 offset:18432
v_mfma_f32_16x16x32_bf16 v[148:151], a[236:239], a[36:39], v[148:151]
v_perm_b32 v63, v32, v19, s52
v_mfma_f32_16x16x32_bf16 v[152:155], a[236:239], a[40:43], v[152:155]
ds_read_b32 a48, v63
v_perm_b32 v62, v32, v19, s53
v_mfma_f32_16x16x32_bf16 v[156:159], a[236:239], a[44:47], v[156:159]
s_waitcnt lgkmcnt(2)
ds_read_b32 a49, v62
v_mfma_f32_16x16x32_bf16 v[192:195], a[240:243], a[176:179], v[192:195]
ds_read_b128 a[248:251], v14 offset:24576
v_perm_b32 v61, v36, v19, s52
v_mfma_f32_16x16x32_bf16 v[196:199], a[240:243], a[180:183], v[196:199]
ds_read_b32 a50, v61
v_perm_b32 v60, v36, v19, s53
v_mfma_f32_16x16x32_bf16 v[200:203], a[240:243], a[184:187], v[200:203]
ds_read_b32 a51, v60
v_perm_b32 v59, v32, v19, s54
v_mfma_f32_16x16x32_bf16 v[204:207], a[240:243], a[188:191], v[204:207]
s_waitcnt lgkmcnt(4)
ds_read_b32 a52, v59
v_mfma_f32_16x16x32_bf16 v[208:211], a[244:247], a[176:179], v[208:211]
ds_read_b128 a[252:255], v14 offset:26624
v_perm_b32 v58, v32, v19, s55
v_mfma_f32_16x16x32_bf16 v[212:215], a[244:247], a[180:183], v[212:215]
ds_read_b32 a53, v58
v_perm_b32 v57, v36, v19, s54
v_mfma_f32_16x16x32_bf16 v[216:219], a[244:247], a[184:187], v[216:219]
ds_read_b32 a54, v57
v_perm_b32 v56, v36, v19, s55
v_mfma_f32_16x16x32_bf16 v[220:223], a[244:247], a[188:191], v[220:223]
s_waitcnt lgkmcnt(4)
ds_read_b32 a55, v56
v_mfma_f32_16x16x32_bf16 v[160:163], a[248:251], a[0:3], v[160:163]
ds_read_b128 a[224:227], v14 offset:28672
v_perm_b32 v63, v33, v19, s52
v_mfma_f32_16x16x32_bf16 v[164:167], a[248:251], a[4:7], v[164:167]
ds_read_b32 a56, v63
v_perm_b32 v62, v33, v19, s53
v_mfma_f32_16x16x32_bf16 v[168:171], a[248:251], a[8:11], v[168:171]
ds_read_b32 a57, v62
v_perm_b32 v61, v37, v19, s52
v_mfma_f32_16x16x32_bf16 v[172:175], a[248:251], a[12:15], v[172:175]
s_waitcnt lgkmcnt(4)
ds_read_b32 a58, v61
v_mfma_f32_16x16x32_bf16 v[176:179], a[252:255], a[0:3], v[176:179]
ds_read_b128 a[228:231], v14 offset:30720
v_perm_b32 v60, v37, v19, s53
v_mfma_f32_16x16x32_bf16 v[180:183], a[252:255], a[4:7], v[180:183]
ds_read_b32 a59, v60
v_perm_b32 v59, v33, v19, s54
v_mfma_f32_16x16x32_bf16 v[184:187], a[252:255], a[8:11], v[184:187]
ds_read_b32 a60, v59
v_perm_b32 v58, v33, v19, s55
v_mfma_f32_16x16x32_bf16 v[188:191], a[252:255], a[12:15], v[188:191]
s_waitcnt lgkmcnt(4)
ds_read_b32 a61, v58
v_mfma_f32_16x16x32_bf16 v[224:227], a[224:227], a[128:131], v[224:227]
ds_read_b128 a[232:235], v15 offset:20480
v_perm_b32 v57, v37, v19, s54
v_mfma_f32_16x16x32_bf16 v[228:231], a[224:227], a[132:135], v[228:231]
ds_read_b32 a62, v57
v_perm_b32 v56, v37, v19, s55
v_mfma_f32_16x16x32_bf16 v[232:235], a[224:227], a[136:139], v[232:235]
ds_read_b32 a63, v56
v_mfma_f32_16x16x32_bf16 v[236:239], a[224:227], a[140:143], v[236:239]
s_waitcnt lgkmcnt(4)
v_mfma_f32_16x16x32_bf16 v[240:243], a[228:231], a[128:131], v[240:243]
ds_read_b128 a[236:239], v15 offset:22528
v_mfma_f32_16x16x32_bf16 v[244:247], a[228:231], a[132:135], v[244:247]
v_mfma_f32_16x16x32_bf16 v[248:251], a[228:231], a[136:139], v[248:251]
v_mfma_f32_16x16x32_bf16 v[252:255], a[228:231], a[140:143], v[252:255]
s_waitcnt lgkmcnt(1)
v_mfma_f32_16x16x32_bf16 v[128:131], a[232:235], a[48:51], v[128:131]
ds_read_b128 a[240:243], v14 offset:32768
v_mfma_f32_16x16x32_bf16 v[132:135], a[232:235], a[52:55], v[132:135]
v_mfma_f32_16x16x32_bf16 v[136:139], a[232:235], a[56:59], v[136:139]
v_mfma_f32_16x16x32_bf16 v[140:143], a[232:235], a[60:63], v[140:143]
s_waitcnt lgkmcnt(1)
v_mfma_f32_16x16x32_bf16 v[144:147], a[236:239], a[48:51], v[144:147]
ds_read_b128 a[244:247], v14 offset:34816
v_mfma_f32_16x16x32_bf16 v[148:151], a[236:239], a[52:55], v[148:151]
v_mfma_f32_16x16x32_bf16 v[152:155], a[236:239], a[56:59], v[152:155]
v_mfma_f32_16x16x32_bf16 v[156:159], a[236:239], a[60:63], v[156:159]
s_waitcnt lgkmcnt(1)
v_mfma_f32_16x16x32_bf16 v[192:195], a[240:243], a[192:195], v[192:195]
ds_read_b128 a[248:251], v15 offset:24576
v_mfma_f32_16x16x32_bf16 v[196:199], a[240:243], a[196:199], v[196:199]
v_mfma_f32_16x16x32_bf16 v[200:203], a[240:243], a[200:203], v[200:203]
v_mfma_f32_16x16x32_bf16 v[204:207], a[240:243], a[204:207], v[204:207]
s_waitcnt lgkmcnt(1)
v_mul_f32 v128, v128, v24
v_mul_f32 v132, v132, v25
v_mfma_f32_16x16x32_bf16 v[208:211], a[244:247], a[192:195], v[208:211]
s_waitcnt vmcnt(0)
s_barrier
ds_read_b128 a[252:255], v15 offset:26624
v_mul_f32 v136, v136, v26
v_mfma_f32_16x16x32_bf16 v[212:215], a[244:247], a[196:199], v[212:215]
v_mul_f32 v140, v140, v27
v_cvt_pk_bf16_f32 v120, v128, v132
v_mfma_f32_16x16x32_bf16 v[216:219], a[244:247], a[200:203], v[216:219]
v_cvt_pk_bf16_f32 v121, v136, v140
v_mfma_f32_16x16x32_bf16 v[220:223], a[244:247], a[204:207], v[220:223]
s_waitcnt lgkmcnt(1)
v_mfma_f32_16x16x32_bf16 v[160:163], a[248:251], a[16:19], v[160:163]
ds_read_b128 a[224:227], v15 offset:28672
v_mfma_f32_16x16x32_bf16 v[164:167], a[248:251], a[20:23], v[164:167]
buffer_store_dwordx2 v[120:121], v18, s[28:31], 0 offen nt
v_mul_f32 v129, v129, v24
v_mfma_f32_16x16x32_bf16 v[168:171], a[248:251], a[24:27], v[168:171]
s_add_u32 s28, s28, 7168
v_mul_f32 v133, v133, v25
v_mul_f32 v137, v137, v26
v_mfma_f32_16x16x32_bf16 v[172:175], a[248:251], a[28:31], v[172:175]
s_waitcnt lgkmcnt(1)
v_mul_f32 v141, v141, v27
v_cvt_pk_bf16_f32 v122, v129, v133
v_mfma_f32_16x16x32_bf16 v[176:179], a[252:255], a[16:19], v[176:179]
s_addc_u32 s29, s29, 0
ds_read_b128 a[228:231], v15 offset:30720
v_cvt_pk_bf16_f32 v123, v137, v141
v_mfma_f32_16x16x32_bf16 v[180:183], a[252:255], a[20:23], v[180:183]
buffer_store_dwordx2 v[122:123], v18, s[28:31], 0 offen nt
v_mul_f32 v130, v130, v24
v_mfma_f32_16x16x32_bf16 v[184:187], a[252:255], a[24:27], v[184:187]
s_add_u32 s28, s28, 7168
v_mul_f32 v134, v134, v25
v_mul_f32 v138, v138, v26
v_mfma_f32_16x16x32_bf16 v[188:191], a[252:255], a[28:31], v[188:191]
s_waitcnt lgkmcnt(1)
v_mul_f32 v142, v142, v27
v_cvt_pk_bf16_f32 v124, v130, v134
v_mfma_f32_16x16x32_bf16 v[224:227], a[224:227], a[144:147], v[224:227]
s_addc_u32 s29, s29, 0
ds_read_b128 a[232:235], v14 offset:36864
v_cvt_pk_bf16_f32 v125, v138, v142
v_mfma_f32_16x16x32_bf16 v[228:231], a[224:227], a[148:151], v[228:231]
buffer_store_dwordx2 v[124:125], v18, s[28:31], 0 offen nt
v_mul_f32 v131, v131, v24
v_mfma_f32_16x16x32_bf16 v[232:235], a[224:227], a[152:155], v[232:235]
s_add_u32 s28, s28, 7168
v_mul_f32 v135, v135, v25
v_mul_f32 v139, v139, v26
v_mfma_f32_16x16x32_bf16 v[236:239], a[224:227], a[156:159], v[236:239]
s_waitcnt lgkmcnt(1)
v_mul_f32 v143, v143, v27
v_cvt_pk_bf16_f32 v126, v131, v135
v_mfma_f32_16x16x32_bf16 v[240:243], a[228:231], a[144:147], v[240:243]
s_addc_u32 s29, s29, 0
ds_read_b128 a[236:239], v14 offset:38912
v_cvt_pk_bf16_f32 v127, v139, v143
v_mfma_f32_16x16x32_bf16 v[244:247], a[228:231], a[148:151], v[244:247]
buffer_store_dwordx2 v[126:127], v18, s[28:31], 0 offen nt
v_mul_f32 v144, v144, v24
v_mfma_f32_16x16x32_bf16 v[248:251], a[228:231], a[152:155], v[248:251]
s_add_u32 s28, s28, 93184
v_mul_f32 v148, v148, v25
v_mul_f32 v152, v152, v26
v_mfma_f32_16x16x32_bf16 v[252:255], a[228:231], a[156:159], v[252:255]
s_waitcnt lgkmcnt(1)
v_mul_f32 v156, v156, v27
v_cvt_pk_bf16_f32 v120, v144, v148
v_mfma_f32_16x16x32_bf16 v[160:163], a[232:235], a[32:35], v[160:163]
s_addc_u32 s29, s29, 0
ds_read_b128 a[240:243], v15 offset:32768
v_cvt_pk_bf16_f32 v121, v152, v156
v_mfma_f32_16x16x32_bf16 v[164:167], a[232:235], a[36:39], v[164:167]
buffer_store_dwordx2 v[120:121], v18, s[28:31], 0 offen nt
v_mul_f32 v145, v145, v24
v_mfma_f32_16x16x32_bf16 v[168:171], a[232:235], a[40:43], v[168:171]
s_add_u32 s28, s28, 7168
v_mul_f32 v149, v149, v25
v_mul_f32 v153, v153, v26
v_mfma_f32_16x16x32_bf16 v[172:175], a[232:235], a[44:47], v[172:175]
s_waitcnt lgkmcnt(1)
v_mul_f32 v157, v157, v27
v_cvt_pk_bf16_f32 v122, v145, v149
v_mfma_f32_16x16x32_bf16 v[176:179], a[236:239], a[32:35], v[176:179]
s_addc_u32 s29, s29, 0
ds_read_b128 a[244:247], v15 offset:34816
v_cvt_pk_bf16_f32 v123, v153, v157
v_mfma_f32_16x16x32_bf16 v[180:183], a[236:239], a[36:39], v[180:183]
buffer_store_dwordx2 v[122:123], v18, s[28:31], 0 offen nt
v_mul_f32 v146, v146, v24
v_mfma_f32_16x16x32_bf16 v[184:187], a[236:239], a[40:43], v[184:187]
s_add_u32 s28, s28, 7168
v_mul_f32 v150, v150, v25
v_mul_f32 v154, v154, v26
v_mfma_f32_16x16x32_bf16 v[188:191], a[236:239], a[44:47], v[188:191]
s_waitcnt lgkmcnt(1)
v_mul_f32 v158, v158, v27
v_cvt_pk_bf16_f32 v124, v146, v150
v_mfma_f32_16x16x32_bf16 v[192:195], a[240:243], a[208:211], v[192:195]
s_addc_u32 s29, s29, 0
ds_read_b128 a[248:251], v15 offset:36864
v_cvt_pk_bf16_f32 v125, v154, v158
v_mfma_f32_16x16x32_bf16 v[196:199], a[240:243], a[212:215], v[196:199]
buffer_store_dwordx2 v[124:125], v18, s[28:31], 0 offen nt
v_mul_f32 v147, v147, v24
v_mfma_f32_16x16x32_bf16 v[200:203], a[240:243], a[216:219], v[200:203]
s_add_u32 s28, s28, 7168
v_mul_f32 v151, v151, v25
v_mul_f32 v155, v155, v26
v_mfma_f32_16x16x32_bf16 v[204:207], a[240:243], a[220:223], v[204:207]
s_waitcnt lgkmcnt(1)
v_mul_f32 v159, v159, v27
v_cvt_pk_bf16_f32 v126, v147, v151
v_mfma_f32_16x16x32_bf16 v[208:211], a[244:247], a[208:211], v[208:211]
s_addc_u32 s29, s29, 0
ds_read_b128 a[252:255], v15 offset:38912
v_cvt_pk_bf16_f32 v127, v155, v159
v_mfma_f32_16x16x32_bf16 v[212:215], a[244:247], a[212:215], v[212:215]
buffer_store_dwordx2 v[126:127], v18, s[28:31], 0 offen nt
v_mfma_f32_16x16x32_bf16 v[216:219], a[244:247], a[216:219], v[216:219]
v_mfma_f32_16x16x32_bf16 v[220:223], a[244:247], a[220:223], v[220:223]
s_waitcnt lgkmcnt(1)
v_mfma_f32_16x16x32_bf16 v[160:163], a[248:251], a[48:51], v[160:163]
ds_read_b128 a[224:227], v14 offset:40960
v_mfma_f32_16x16x32_bf16 v[164:167], a[248:251], a[52:55], v[164:167]
v_mfma_f32_16x16x32_bf16 v[168:171], a[248:251], a[56:59], v[168:171]
v_mfma_f32_16x16x32_bf16 v[172:175], a[248:251], a[60:63], v[172:175]
s_waitcnt lgkmcnt(1)
v_mfma_f32_16x16x32_bf16 v[176:179], a[252:255], a[48:51], v[176:179]
ds_read_b128 a[228:231], v14 offset:43008
v_mfma_f32_16x16x32_bf16 v[180:183], a[252:255], a[52:55], v[180:183]
v_mfma_f32_16x16x32_bf16 v[184:187], a[252:255], a[56:59], v[184:187]
v_mfma_f32_16x16x32_bf16 v[188:191], a[252:255], a[60:63], v[188:191]
s_waitcnt lgkmcnt(1)
v_mfma_f32_16x16x32_bf16 v[224:227], a[224:227], a[160:163], v[224:227]
ds_read_b128 a[232:235], v14 offset:45056
v_mfma_f32_16x16x32_bf16 v[228:231], a[224:227], a[164:167], v[228:231]
v_mfma_f32_16x16x32_bf16 v[232:235], a[224:227], a[168:171], v[232:235]
v_mfma_f32_16x16x32_bf16 v[236:239], a[224:227], a[172:175], v[236:239]
s_waitcnt lgkmcnt(1)
v_mul_f32 v160, v160, v24
v_mul_f32 v164, v164, v25
v_mfma_f32_16x16x32_bf16 v[240:243], a[228:231], a[160:163], v[240:243]
s_add_u32 s28, s28, 93184
ds_read_b128 a[236:239], v14 offset:47104
v_mul_f32 v168, v168, v26
v_mfma_f32_16x16x32_bf16 v[244:247], a[228:231], a[164:167], v[244:247]
s_addc_u32 s29, s29, 0
v_mul_f32 v172, v172, v27
v_cvt_pk_bf16_f32 v120, v160, v164
v_mfma_f32_16x16x32_bf16 v[248:251], a[228:231], a[168:171], v[248:251]
v_cvt_pk_bf16_f32 v121, v168, v172
v_mfma_f32_16x16x32_bf16 v[252:255], a[228:231], a[172:175], v[252:255]
s_waitcnt lgkmcnt(1)
v_mfma_f32_16x16x32_bf16 v[192:195], a[232:235], a[0:3], v[192:195]
ds_read_b128 a[240:243], v15 offset:45056
v_mfma_f32_16x16x32_bf16 v[196:199], a[232:235], a[4:7], v[196:199]
buffer_store_dwordx2 v[120:121], v18, s[28:31], 0 offen nt
v_mul_f32 v161, v161, v24
v_mfma_f32_16x16x32_bf16 v[200:203], a[232:235], a[8:11], v[200:203]
s_add_u32 s28, s28, 7168
v_mul_f32 v165, v165, v25
v_mul_f32 v169, v169, v26
v_mfma_f32_16x16x32_bf16 v[204:207], a[232:235], a[12:15], v[204:207]
s_waitcnt lgkmcnt(1)
v_mul_f32 v173, v173, v27
v_cvt_pk_bf16_f32 v122, v161, v165
v_mfma_f32_16x16x32_bf16 v[208:211], a[236:239], a[0:3], v[208:211]
s_addc_u32 s29, s29, 0
ds_read_b128 a[244:247], v15 offset:47104
v_cvt_pk_bf16_f32 v123, v169, v173
v_mfma_f32_16x16x32_bf16 v[212:215], a[236:239], a[4:7], v[212:215]
buffer_store_dwordx2 v[122:123], v18, s[28:31], 0 offen nt
v_mul_f32 v162, v162, v24
v_mfma_f32_16x16x32_bf16 v[216:219], a[236:239], a[8:11], v[216:219]
s_add_u32 s28, s28, 7168
v_mul_f32 v166, v166, v25
v_mul_f32 v170, v170, v26
v_mfma_f32_16x16x32_bf16 v[220:223], a[236:239], a[12:15], v[220:223]
s_waitcnt lgkmcnt(1)
v_mul_f32 v174, v174, v27
v_cvt_pk_bf16_f32 v124, v162, v166
v_mfma_f32_16x16x32_bf16 v[192:195], a[240:243], a[16:19], v[192:195]
s_addc_u32 s29, s29, 0
ds_read_b128 a[248:251], v15 offset:40960
v_cvt_pk_bf16_f32 v125, v170, v174
v_mfma_f32_16x16x32_bf16 v[196:199], a[240:243], a[20:23], v[196:199]
buffer_store_dwordx2 v[124:125], v18, s[28:31], 0 offen nt
v_mul_f32 v163, v163, v24
v_mfma_f32_16x16x32_bf16 v[200:203], a[240:243], a[24:27], v[200:203]
s_add_u32 s28, s28, 7168
v_mul_f32 v167, v167, v25
v_mul_f32 v171, v171, v26
v_mfma_f32_16x16x32_bf16 v[204:207], a[240:243], a[28:31], v[204:207]
s_waitcnt lgkmcnt(1)
v_mul_f32 v175, v175, v27
v_cvt_pk_bf16_f32 v126, v163, v167
v_mfma_f32_16x16x32_bf16 v[208:211], a[244:247], a[16:19], v[208:211]
s_addc_u32 s29, s29, 0
ds_read_b128 a[252:255], v15 offset:43008
v_cvt_pk_bf16_f32 v127, v171, v175
v_mfma_f32_16x16x32_bf16 v[212:215], a[244:247], a[20:23], v[212:215]
buffer_store_dwordx2 v[126:127], v18, s[28:31], 0 offen nt
v_mul_f32 v176, v176, v24
v_mfma_f32_16x16x32_bf16 v[216:219], a[244:247], a[24:27], v[216:219]
s_add_u32 s28, s28, 93184
v_mul_f32 v180, v180, v25
v_mul_f32 v184, v184, v26
v_mfma_f32_16x16x32_bf16 v[220:223], a[244:247], a[28:31], v[220:223]
s_waitcnt lgkmcnt(1)
v_mul_f32 v188, v188, v27
v_cvt_pk_bf16_f32 v120, v176, v180
v_mfma_f32_16x16x32_bf16 v[224:227], a[248:251], a[176:179], v[224:227]
s_addc_u32 s29, s29, 0
ds_read_b128 a[224:227], v14 offset:49152
v_cvt_pk_bf16_f32 v121, v184, v188
v_mfma_f32_16x16x32_bf16 v[228:231], a[248:251], a[180:183], v[228:231]
buffer_store_dwordx2 v[120:121], v18, s[28:31], 0 offen nt
v_mul_f32 v177, v177, v24
v_mfma_f32_16x16x32_bf16 v[232:235], a[248:251], a[184:187], v[232:235]
s_add_u32 s28, s28, 7168
v_mul_f32 v181, v181, v25
v_mul_f32 v185, v185, v26
v_mfma_f32_16x16x32_bf16 v[236:239], a[248:251], a[188:191], v[236:239]
s_waitcnt lgkmcnt(1)
v_mul_f32 v189, v189, v27
v_cvt_pk_bf16_f32 v122, v177, v181
v_mfma_f32_16x16x32_bf16 v[240:243], a[252:255], a[176:179], v[240:243]
s_addc_u32 s29, s29, 0
ds_read_b128 a[228:231], v14 offset:51200
v_cvt_pk_bf16_f32 v123, v185, v189
v_mfma_f32_16x16x32_bf16 v[244:247], a[252:255], a[180:183], v[244:247]
buffer_store_dwordx2 v[122:123], v18, s[28:31], 0 offen nt
v_mul_f32 v178, v178, v24
v_mfma_f32_16x16x32_bf16 v[248:251], a[252:255], a[184:187], v[248:251]
s_add_u32 s28, s28, 7168
v_mul_f32 v182, v182, v25
v_mul_f32 v186, v186, v26
v_mfma_f32_16x16x32_bf16 v[252:255], a[252:255], a[188:191], v[252:255]
s_waitcnt lgkmcnt(1)
v_mul_f32 v190, v190, v27
v_cvt_pk_bf16_f32 v124, v178, v182
v_mfma_f32_16x16x32_bf16 v[192:195], a[224:227], a[32:35], v[192:195]
s_addc_u32 s29, s29, 0
ds_read_b128 a[232:235], v14 offset:53248
v_cvt_pk_bf16_f32 v125, v186, v190
v_mfma_f32_16x16x32_bf16 v[196:199], a[224:227], a[36:39], v[196:199]
buffer_store_dwordx2 v[124:125], v18, s[28:31], 0 offen nt
v_mul_f32 v179, v179, v24
v_mfma_f32_16x16x32_bf16 v[200:203], a[224:227], a[40:43], v[200:203]
s_add_u32 s28, s28, 7168
v_mul_f32 v183, v183, v25
v_mul_f32 v187, v187, v26
v_mfma_f32_16x16x32_bf16 v[204:207], a[224:227], a[44:47], v[204:207]
s_waitcnt lgkmcnt(1)
v_mul_f32 v191, v191, v27
v_cvt_pk_bf16_f32 v126, v179, v183
v_mfma_f32_16x16x32_bf16 v[208:211], a[228:231], a[32:35], v[208:211]
s_addc_u32 s29, s29, 0
ds_read_b128 a[236:239], v14 offset:55296
v_cvt_pk_bf16_f32 v127, v187, v191
v_mfma_f32_16x16x32_bf16 v[212:215], a[228:231], a[36:39], v[212:215]
buffer_store_dwordx2 v[126:127], v18, s[28:31], 0 offen nt
v_mfma_f32_16x16x32_bf16 v[216:219], a[228:231], a[40:43], v[216:219]
v_mfma_f32_16x16x32_bf16 v[220:223], a[228:231], a[44:47], v[220:223]
s_waitcnt lgkmcnt(1)
v_mfma_f32_16x16x32_bf16 v[224:227], a[232:235], a[192:195], v[224:227]
ds_read_b128 a[240:243], v15 offset:49152
v_mfma_f32_16x16x32_bf16 v[228:231], a[232:235], a[196:199], v[228:231]
v_mfma_f32_16x16x32_bf16 v[232:235], a[232:235], a[200:203], v[232:235]
v_mfma_f32_16x16x32_bf16 v[236:239], a[232:235], a[204:207], v[236:239]
s_waitcnt lgkmcnt(1)
v_mfma_f32_16x16x32_bf16 v[240:243], a[236:239], a[192:195], v[240:243]
ds_read_b128 a[244:247], v15 offset:51200
v_mfma_f32_16x16x32_bf16 v[244:247], a[236:239], a[196:199], v[244:247]
v_mfma_f32_16x16x32_bf16 v[248:251], a[236:239], a[200:203], v[248:251]
v_mfma_f32_16x16x32_bf16 v[252:255], a[236:239], a[204:207], v[252:255]
s_waitcnt lgkmcnt(1)
v_mfma_f32_16x16x32_bf16 v[192:195], a[240:243], a[48:51], v[192:195]
ds_read_b128 a[248:251], v15 offset:53248
v_mfma_f32_16x16x32_bf16 v[196:199], a[240:243], a[52:55], v[196:199]
v_mfma_f32_16x16x32_bf16 v[200:203], a[240:243], a[56:59], v[200:203]
v_mfma_f32_16x16x32_bf16 v[204:207], a[240:243], a[60:63], v[204:207]
s_waitcnt lgkmcnt(1)
v_mfma_f32_16x16x32_bf16 v[208:211], a[244:247], a[48:51], v[208:211]
ds_read_b128 a[252:255], v15 offset:55296
v_mfma_f32_16x16x32_bf16 v[212:215], a[244:247], a[52:55], v[212:215]
v_mfma_f32_16x16x32_bf16 v[216:219], a[244:247], a[56:59], v[216:219]
v_mfma_f32_16x16x32_bf16 v[220:223], a[244:247], a[60:63], v[220:223]
s_waitcnt lgkmcnt(1)
v_mfma_f32_16x16x32_bf16 v[224:227], a[248:251], a[208:211], v[224:227]
ds_read_b128 a[224:227], v14 offset:57344
v_mfma_f32_16x16x32_bf16 v[228:231], a[248:251], a[212:215], v[228:231]
v_mfma_f32_16x16x32_bf16 v[232:235], a[248:251], a[216:219], v[232:235]
v_mfma_f32_16x16x32_bf16 v[236:239], a[248:251], a[220:223], v[236:239]
s_waitcnt lgkmcnt(1)
v_mul_f32 v192, v192, v24
v_mul_f32 v196, v196, v25
v_mfma_f32_16x16x32_bf16 v[240:243], a[252:255], a[208:211], v[240:243]
s_add_u32 s28, s28, 93184
ds_read_b128 a[228:231], v14 offset:59392
v_mul_f32 v200, v200, v26
v_mfma_f32_16x16x32_bf16 v[244:247], a[252:255], a[212:215], v[244:247]
s_addc_u32 s29, s29, 0
v_mul_f32 v204, v204, v27
v_cvt_pk_bf16_f32 v120, v192, v196
v_mfma_f32_16x16x32_bf16 v[248:251], a[252:255], a[216:219], v[248:251]
v_cvt_pk_bf16_f32 v121, v200, v204
v_mfma_f32_16x16x32_bf16 v[252:255], a[252:255], a[220:223], v[252:255]
s_waitcnt lgkmcnt(1)
v_mfma_f32_16x16x32_bf16 v[224:227], a[224:227], a[0:3], v[224:227]
ds_read_b128 a[232:235], v15 offset:57344
v_mfma_f32_16x16x32_bf16 v[228:231], a[224:227], a[4:7], v[228:231]
buffer_store_dwordx2 v[120:121], v18, s[28:31], 0 offen nt
v_mul_f32 v193, v193, v24
v_mfma_f32_16x16x32_bf16 v[232:235], a[224:227], a[8:11], v[232:235]
s_add_u32 s28, s28, 7168
v_mul_f32 v197, v197, v25
v_mul_f32 v201, v201, v26
v_mfma_f32_16x16x32_bf16 v[236:239], a[224:227], a[12:15], v[236:239]
s_waitcnt lgkmcnt(1)
v_mul_f32 v205, v205, v27
v_cvt_pk_bf16_f32 v122, v193, v197
v_mfma_f32_16x16x32_bf16 v[240:243], a[228:231], a[0:3], v[240:243]
s_addc_u32 s29, s29, 0
ds_read_b128 a[236:239], v15 offset:59392
v_cvt_pk_bf16_f32 v123, v201, v205
v_mfma_f32_16x16x32_bf16 v[244:247], a[228:231], a[4:7], v[244:247]
buffer_store_dwordx2 v[122:123], v18, s[28:31], 0 offen nt
v_mul_f32 v194, v194, v24
v_mfma_f32_16x16x32_bf16 v[248:251], a[228:231], a[8:11], v[248:251]
s_add_u32 s28, s28, 7168
v_mul_f32 v198, v198, v25
v_mul_f32 v202, v202, v26
v_mfma_f32_16x16x32_bf16 v[252:255], a[228:231], a[12:15], v[252:255]
s_waitcnt lgkmcnt(1)
v_mul_f32 v206, v206, v27
v_cvt_pk_bf16_f32 v124, v194, v198
v_mfma_f32_16x16x32_bf16 v[224:227], a[232:235], a[16:19], v[224:227]
s_addc_u32 s29, s29, 0
ds_read_b128 a[240:243], v14 offset:61440
v_cvt_pk_bf16_f32 v125, v202, v206
v_mfma_f32_16x16x32_bf16 v[228:231], a[232:235], a[20:23], v[228:231]
buffer_store_dwordx2 v[124:125], v18, s[28:31], 0 offen nt
v_mul_f32 v195, v195, v24
v_mfma_f32_16x16x32_bf16 v[232:235], a[232:235], a[24:27], v[232:235]
s_add_u32 s28, s28, 7168
v_mul_f32 v199, v199, v25
v_mul_f32 v203, v203, v26
v_mfma_f32_16x16x32_bf16 v[236:239], a[232:235], a[28:31], v[236:239]
s_waitcnt lgkmcnt(1)
v_mul_f32 v207, v207, v27
v_cvt_pk_bf16_f32 v126, v195, v199
v_mfma_f32_16x16x32_bf16 v[240:243], a[236:239], a[16:19], v[240:243]
s_addc_u32 s29, s29, 0
ds_read_b128 a[244:247], v14 offset:63488
v_cvt_pk_bf16_f32 v127, v203, v207
v_mfma_f32_16x16x32_bf16 v[244:247], a[236:239], a[20:23], v[244:247]
buffer_store_dwordx2 v[126:127], v18, s[28:31], 0 offen nt
v_mul_f32 v208, v208, v24
v_mfma_f32_16x16x32_bf16 v[248:251], a[236:239], a[24:27], v[248:251]
s_add_u32 s28, s28, 93184
v_mul_f32 v212, v212, v25
v_mul_f32 v216, v216, v26
v_mfma_f32_16x16x32_bf16 v[252:255], a[236:239], a[28:31], v[252:255]
s_waitcnt lgkmcnt(1)
v_mul_f32 v220, v220, v27
v_cvt_pk_bf16_f32 v120, v208, v212
v_mfma_f32_16x16x32_bf16 v[224:227], a[240:243], a[32:35], v[224:227]
s_addc_u32 s29, s29, 0
ds_read_b128 a[248:251], v15 offset:61440
v_cvt_pk_bf16_f32 v121, v216, v220
v_mfma_f32_16x16x32_bf16 v[228:231], a[240:243], a[36:39], v[228:231]
buffer_store_dwordx2 v[120:121], v18, s[28:31], 0 offen nt
v_mul_f32 v209, v209, v24
v_mfma_f32_16x16x32_bf16 v[232:235], a[240:243], a[40:43], v[232:235]
s_add_u32 s28, s28, 7168
v_mul_f32 v213, v213, v25
v_mul_f32 v217, v217, v26
v_mfma_f32_16x16x32_bf16 v[236:239], a[240:243], a[44:47], v[236:239]
s_waitcnt lgkmcnt(1)
v_mul_f32 v221, v221, v27
v_cvt_pk_bf16_f32 v122, v209, v213
v_mfma_f32_16x16x32_bf16 v[240:243], a[244:247], a[32:35], v[240:243]
s_addc_u32 s29, s29, 0
ds_read_b128 a[252:255], v15 offset:63488
v_cvt_pk_bf16_f32 v123, v217, v221
v_mfma_f32_16x16x32_bf16 v[244:247], a[244:247], a[36:39], v[244:247]
buffer_store_dwordx2 v[122:123], v18, s[28:31], 0 offen nt
v_mfma_f32_16x16x32_bf16 v[248:251], a[244:247], a[40:43], v[248:251]
v_mfma_f32_16x16x32_bf16 v[252:255], a[244:247], a[44:47], v[252:255]
s_waitcnt lgkmcnt(1)
v_mfma_f32_16x16x32_bf16 v[224:227], a[248:251], a[48:51], v[224:227]
v_mfma_f32_16x16x32_bf16 v[228:231], a[248:251], a[52:55], v[228:231]
v_mfma_f32_16x16x32_bf16 v[232:235], a[248:251], a[56:59], v[232:235]
v_mfma_f32_16x16x32_bf16 v[236:239], a[248:251], a[60:63], v[236:239]
s_waitcnt lgkmcnt(0)
v_mfma_f32_16x16x32_bf16 v[240:243], a[252:255], a[48:51], v[240:243]
v_mfma_f32_16x16x32_bf16 v[244:247], a[252:255], a[52:55], v[244:247]
v_mfma_f32_16x16x32_bf16 v[248:251], a[252:255], a[56:59], v[248:251]
v_mfma_f32_16x16x32_bf16 v[252:255], a[252:255], a[60:63], v[252:255]
s_nop 7
v_pk_mul_f32 v[210:211], v[210:211], v[24:25] op_sel:[0,0] op_sel_hi:[1,0]
v_pk_mul_f32 v[214:215], v[214:215], v[24:25] op_sel:[0,1] op_sel_hi:[1,1]
v_pk_mul_f32 v[218:219], v[218:219], v[26:27] op_sel:[0,0] op_sel_hi:[1,0]
v_pk_mul_f32 v[222:223], v[222:223], v[26:27] op_sel:[0,1] op_sel_hi:[1,1]
v_cvt_pk_bf16_f32 v124, v210, v214
v_cvt_pk_bf16_f32 v125, v218, v222
s_add_u32 s28, s28, 7168
s_addc_u32 s29, s29, 0
buffer_store_dwordx2 v[124:125], v18, s[28:31], 0 offen nt
v_cvt_pk_bf16_f32 v126, v211, v215
v_cvt_pk_bf16_f32 v127, v219, v223
s_add_u32 s28, s28, 7168
s_addc_u32 s29, s29, 0
buffer_store_dwordx2 v[126:127], v18, s[28:31], 0 offen nt
v_pk_mul_f32 v[224:225], v[224:225], v[24:25] op_sel:[0,0] op_sel_hi:[1,0]
v_pk_mul_f32 v[228:229], v[228:229], v[24:25] op_sel:[0,1] op_sel_hi:[1,1]
v_pk_mul_f32 v[232:233], v[232:233], v[26:27] op_sel:[0,0] op_sel_hi:[1,0]
v_pk_mul_f32 v[236:237], v[236:237], v[26:27] op_sel:[0,1] op_sel_hi:[1,1]
v_cvt_pk_bf16_f32 v120, v224, v228
v_cvt_pk_bf16_f32 v121, v232, v236
s_add_u32 s28, s28, 93184
s_addc_u32 s29, s29, 0
buffer_store_dwordx2 v[120:121], v18, s[28:31], 0 offen nt
v_cvt_pk_bf16_f32 v122, v225, v229
v_cvt_pk_bf16_f32 v123, v233, v237
s_add_u32 s28, s28, 7168
s_addc_u32 s29, s29, 0
buffer_store_dwordx2 v[122:123], v18, s[28:31], 0 offen nt
v_pk_mul_f32 v[226:227], v[226:227], v[24:25] op_sel:[0,0] op_sel_hi:[1,0]
v_pk_mul_f32 v[230:231], v[230:231], v[24:25] op_sel:[0,1] op_sel_hi:[1,1]
v_pk_mul_f32 v[234:235], v[234:235], v[26:27] op_sel:[0,0] op_sel_hi:[1,0]
v_pk_mul_f32 v[238:239], v[238:239], v[26:27] op_sel:[0,1] op_sel_hi:[1,1]
v_cvt_pk_bf16_f32 v124, v226, v230
v_cvt_pk_bf16_f32 v125, v234, v238
s_add_u32 s28, s28, 7168
s_addc_u32 s29, s29, 0
buffer_store_dwordx2 v[124:125], v18, s[28:31], 0 offen nt
v_cvt_pk_bf16_f32 v126, v227, v231
v_cvt_pk_bf16_f32 v127, v235, v239
s_add_u32 s28, s28, 7168
s_addc_u32 s29, s29, 0
buffer_store_dwordx2 v[126:127], v18, s[28:31], 0 offen nt
v_pk_mul_f32 v[240:241], v[240:241], v[24:25] op_sel:[0,0] op_sel_hi:[1,0]
v_pk_mul_f32 v[244:245], v[244:245], v[24:25] op_sel:[0,1] op_sel_hi:[1,1]
v_pk_mul_f32 v[248:249], v[248:249], v[26:27] op_sel:[0,0] op_sel_hi:[1,0]
v_pk_mul_f32 v[252:253], v[252:253], v[26:27] op_sel:[0,1] op_sel_hi:[1,1]
v_cvt_pk_bf16_f32 v120, v240, v244
v_cvt_pk_bf16_f32 v121, v248, v252
s_add_u32 s28, s28, 93184
s_addc_u32 s29, s29, 0
buffer_store_dwordx2 v[120:121], v18, s[28:31], 0 offen nt
v_cvt_pk_bf16_f32 v122, v241, v245
v_cvt_pk_bf16_f32 v123, v249, v253
s_add_u32 s28, s28, 7168
s_addc_u32 s29, s29, 0
buffer_store_dwordx2 v[122:123], v18, s[28:31], 0 offen nt
v_pk_mul_f32 v[242:243], v[242:243], v[24:25] op_sel:[0,0] op_sel_hi:[1,0]
v_pk_mul_f32 v[246:247], v[246:247], v[24:25] op_sel:[0,1] op_sel_hi:[1,1]
v_pk_mul_f32 v[250:251], v[250:251], v[26:27] op_sel:[0,0] op_sel_hi:[1,0]
v_pk_mul_f32 v[254:255], v[254:255], v[26:27] op_sel:[0,1] op_sel_hi:[1,1]
v_cvt_pk_bf16_f32 v124, v242, v246
v_cvt_pk_bf16_f32 v125, v250, v254
s_add_u32 s28, s28, 7168
s_addc_u32 s29, s29, 0
buffer_store_dwordx2 v[124:125], v18, s[28:31], 0 offen nt
v_cvt_pk_bf16_f32 v126, v243, v247
v_cvt_pk_bf16_f32 v127, v251, v255
s_add_u32 s28, s28, 7168
s_addc_u32 s29, s29, 0
buffer_store_dwordx2 v[126:127], v18, s[28:31], 0 offen nt
s_endpgm
L_NOTAG:
buffer_load_dwordx2 v[22:23], off, s[80:83], 0 sc1
s_waitcnt vmcnt(0)
v_readfirstlane_b32 s88, v22
v_readfirstlane_b32 s89, v23
s_sub_u32 s90, s90, 1
s_nop 0
s_cmp_eq_u64 s[88:89], 0
s_cbranch_scc0 L_TAGOK
s_cmp_gt_i32 s90, 0
s_cbranch_scc1 L_NOTAG
s_mov_b32 s26, 0
s_mov_b32 s78, 0
s_mov_b64 s[88:89], 1
s_branch L_TAGOK
L_SLOW1:
s_movk_i32 s91, 1
s_call_b64 s[100:101], L_WAIT
v_mov_b64 v[32:33], v[120:121]
v_mov_b64 v[36:37], v[124:125]
s_branch L_BACK1
L_SLOW2:
s_movk_i32 s91, 2
s_call_b64 s[100:101], L_WAIT
v_mov_b64 v[40:41], v[120:121]
v_mov_b64 v[44:45], v[124:125]
s_branch L_BACK2
L_SLOW3:
s_movk_i32 s91, 3
s_call_b64 s[100:101], L_WAIT
v_mov_b64 v[48:49], v[120:121]
v_mov_b64 v[52:53], v[124:125]
s_branch L_BACK3
L_SLOW4:
s_movk_i32 s91, 4
s_call_b64 s[100:101], L_WAIT
v_mov_b64 v[96:97], v[120:121]
v_mov_b64 v[100:101], v[124:125]
s_branch L_BACK4
L_SLOW5:
s_movk_i32 s91, 5
s_call_b64 s[100:101], L_WAIT
v_mov_b64 v[104:105], v[120:121]
v_mov_b64 v[108:109], v[124:125]
s_branch L_BACK5
L_SLOW6:
s_movk_i32 s91, 6
s_call_b64 s[100:101], L_WAIT
v_mov_b64 v[112:113], v[120:121]
v_mov_b64 v[116:117], v[124:125]
s_branch L_BACK6
L_SLOW7:
s_movk_i32 s91, 7
s_call_b64 s[100:101], L_WAIT
v_mov_b64 v[32:33], v[120:121]
v_mov_b64 v[36:37], v[124:125]
s_branch L_BACK7
L_SLOW8:
s_movk_i32 s91, 8
s_call_b64 s[100:101], L_WAIT
v_mov_b64 v[40:41], v[120:121]
v_mov_b64 v[44:45], v[124:125]
s_branch L_BACK8
L_SLOW9:
s_movk_i32 s91, 9
s_call_b64 s[100:101], L_WAIT
v_mov_b64 v[48:49], v[120:121]
v_mov_b64 v[52:53], v[124:125]
s_branch L_BACK9
L_SLOW10:
s_movk_i32 s91, 10
s_call_b64 s[100:101], L_WAIT
v_mov_b64 v[96:97], v[120:121]
v_mov_b64 v[100:101], v[124:125]
s_branch L_BACK10
L_SLOW11:
s_movk_i32 s91, 11
s_call_b64 s[100:101], L_WAIT
v_mov_b64 v[104:105], v[120:121]
v_mov_b64 v[108:109], v[124:125]
s_branch L_BACK11
L_SLOW12:
s_movk_i32 s91, 12
s_call_b64 s[100:101], L_WAIT
v_mov_b64 v[112:113], v[120:121]
v_mov_b64 v[116:117], v[124:125]
s_branch L_BACK12
L_SLOW13:
s_movk_i32 s91, 13
s_call_b64 s[100:101], L_WAIT
v_mov_b64 v[32:33], v[120:121]
v_mov_b64 v[36:37], v[124:125]
s_branch L_BACK13
L_SLOW14:
s_movk_i32 s91, 14
s_call_b64 s[100:101], L_WAIT
v_mov_b64 v[40:41], v[120:121]
v_mov_b64 v[44:45], v[124:125]
s_branch L_BACK14
L_SLOW15:
s_movk_i32 s91, 15
s_call_b64 s[100:101], L_WAIT
v_mov_b64 v[48:49], v[120:121]
v_mov_b64 v[52:53], v[124:125]
s_branch L_BACK15
L_SLOW16:
s_movk_i32 s91, 16
s_call_b64 s[100:101], L_WAIT
v_mov_b64 v[96:97], v[120:121]
v_mov_b64 v[100:101], v[124:125]
s_branch L_BACK16
L_SLOW17:
s_movk_i32 s91, 17
s_call_b64 s[100:101], L_WAIT
v_mov_b64 v[104:105], v[120:121]
v_mov_b64 v[108:109], v[124:125]
s_branch L_BACK17
L_SLOW18:
s_movk_i32 s91, 18
s_call_b64 s[100:101], L_WAIT
v_mov_b64 v[112:113], v[120:121]
v_mov_b64 v[116:117], v[124:125]
s_branch L_BACK18
L_SLOW19:
s_movk_i32 s91, 19
s_call_b64 s[100:101], L_WAIT
v_mov_b64 v[32:33], v[120:121]
v_mov_b64 v[36:37], v[124:125]
s_branch L_BACK19
L_SLOW20:
s_movk_i32 s91, 20
s_call_b64 s[100:101], L_WAIT
v_mov_b64 v[40:41], v[120:121]
v_mov_b64 v[44:45], v[124:125]
s_branch L_BACK20
L_SLOW21:
s_movk_i32 s91, 21
s_call_b64 s[100:101], L_WAIT
v_mov_b64 v[48:49], v[120:121]
v_mov_b64 v[52:53], v[124:125]
s_branch L_BACK21
L_SLOW22:
s_movk_i32 s91, 22
s_call_b64 s[100:101], L_WAIT
v_mov_b64 v[96:97], v[120:121]
v_mov_b64 v[100:101], v[124:125]
s_branch L_BACK22
L_SLOW23:
s_movk_i32 s91, 23
s_call_b64 s[100:101], L_WAIT
v_mov_b64 v[104:105], v[120:121]
v_mov_b64 v[108:109], v[124:125]
s_branch L_BACK23
L_SLOW24:
s_movk_i32 s91, 24
s_call_b64 s[100:101], L_WAIT
v_mov_b64 v[112:113], v[120:121]
v_mov_b64 v[116:117], v[124:125]
s_branch L_BACK24
L_SLOW25:
s_movk_i32 s91, 25
s_call_b64 s[100:101], L_WAIT
v_mov_b64 v[32:33], v[120:121]
v_mov_b64 v[36:37], v[124:125]
s_branch L_BACK25
L_SLOW26:
s_movk_i32 s91, 26
s_call_b64 s[100:101], L_WAIT
v_mov_b64 v[40:41], v[120:121]
v_mov_b64 v[44:45], v[124:125]
s_branch L_BACK26
L_SLOW27:
s_movk_i32 s91, 27
s_call_b64 s[100:101], L_WAIT
v_mov_b64 v[48:49], v[120:121]
v_mov_b64 v[52:53], v[124:125]
s_branch L_BACK27
L_SLOW28:
s_movk_i32 s91, 28
s_call_b64 s[100:101], L_WAIT
v_mov_b64 v[96:97], v[120:121]
v_mov_b64 v[100:101], v[124:125]
s_branch L_BACK28
L_SLOW29:
s_movk_i32 s91, 29
s_call_b64 s[100:101], L_WAIT
v_mov_b64 v[104:105], v[120:121]
v_mov_b64 v[108:109], v[124:125]
s_branch L_BACK29
L_SLOW30:
s_movk_i32 s91, 30
s_call_b64 s[100:101], L_WAIT
v_mov_b64 v[112:113], v[120:121]
v_mov_b64 v[116:117], v[124:125]
s_branch L_BACK30
L_SLOW31:
s_movk_i32 s91, 31
s_call_b64 s[100:101], L_WAIT
v_mov_b64 v[32:33], v[120:121]
v_mov_b64 v[36:37], v[124:125]
s_branch L_BACK31
L_WAIT:
s_lshl_b32 s47, s91, 11
buffer_load_dwordx4 v[120:123], v13, s[24:27], s47 offen offset:0 sc1
buffer_load_dwordx4 v[124:127], v13, s[24:27], s47 offen offset:1024 sc1
s_waitcnt vmcnt(0)
v_cmp_ne_u64 s[50:51], s[88:89], v[122:123]
v_cmp_ne_u64 vcc, s[88:89], v[126:127]
s_sub_u32 s90, s90, 1
s_nop 0
s_or_b64 vcc, vcc, s[50:51]
s_cbranch_scc0 L_WRET
s_cmp_gt_i32 s90, 0
s_cbranch_scc1 L_WAIT
s_mul_i32 s47, s91, 458752
s_lshl_b32 s46, s39, 8
s_add_u32 s47, s47, s46
s_add_u32 s84, s6, s47
s_addc_u32 s85, s7, 0
buffer_load_dwordx4 v[64:67], v30, s[84:87], 0 offen
buffer_load_dwordx4 v[68:71], v30, s[84:87], s92 offen
buffer_load_dwordx4 v[72:75], v30, s[84:87], s93 offen
buffer_load_dwordx4 v[76:79], v30, s[84:87], s94 offen
buffer_load_dwordx4 v[80:83], v30, s[84:87], s95 offen
buffer_load_dwordx4 v[84:87], v30, s[84:87], s96 offen
buffer_load_dwordx4 v[88:91], v30, s[84:87], s97 offen
buffer_load_dwordx4 v[92:95], v30, s[84:87], s98 offen
s_waitcnt vmcnt(0)
v_lshl_add_u64 v[64:65], v[68:69], 4, v[64:65]
v_lshl_add_u64 v[66:67], v[70:71], 4, v[66:67]
v_lshl_add_u64 v[72:73], v[76:77], 4, v[72:73]
v_lshl_add_u64 v[74:75], v[78:79], 4, v[74:75]
v_lshl_or_b32 v64, v72, 8, v64
v_lshl_or_b32 v65, v73, 8, v65
v_lshl_or_b32 v66, v74, 8, v66
v_lshl_or_b32 v67, v75, 8, v67
v_lshl_or_b32 v120, v65, 16, v64
v_lshl_or_b32 v121, v67, 16, v66
v_lshl_add_u64 v[80:81], v[84:85], 4, v[80:81]
v_lshl_add_u64 v[82:83], v[86:87], 4, v[82:83]
v_lshl_add_u64 v[88:89], v[92:93], 4, v[88:89]
v_lshl_add_u64 v[90:91], v[94:95], 4, v[90:91]
v_lshl_or_b32 v80, v88, 8, v80
v_lshl_or_b32 v81, v89, 8, v81
v_lshl_or_b32 v82, v90, 8, v82
v_lshl_or_b32 v83, v91, 8, v83
v_lshl_or_b32 v124, v81, 16, v80
v_lshl_or_b32 v125, v83, 16, v82
L_WRET:
s_setpc_b64 s[100:101]
L_END:
s_endpgm
.section .rodata,"a"
.p2align 6
.amdhsa_kernel standalone__normalfloat_lut_af4__prompt_kernel
  .amdhsa_next_free_vgpr 512
  .amdhsa_next_free_sgpr 102
  .amdhsa_accum_offset 256
  .amdhsa_group_segment_fixed_size 0
  .amdhsa_kernarg_size 56
  .amdhsa_user_sgpr_count 2
  .amdhsa_user_sgpr_kernarg_segment_ptr 1
  .amdhsa_system_sgpr_workgroup_id_x 1
.end_amdhsa_kernel
```

```asm
; @launch grid=(256,1,1) block=(256,1,1) lds=163840
.amdgcn_target "amdgcn-amd-amdhsa--gfx950"
.text
.globl standalone__normalfloat_lut_af4__prompt_kernel
.p2align 12
.p2align 8
.type standalone__normalfloat_lut_af4__prompt_kernel,@function
standalone__normalfloat_lut_af4__prompt_kernel:
s_load_dwordx4 s[4:7], s[0:1], 0
s_load_dwordx4 s[12:15], s[0:1], 40
s_load_dwordx4 s[8:11], s[0:1], 24
s_memrealtime s[56:57]
s_cmp_ge_u32 s2, 256
s_cbranch_scc1 L_END
s_getpc_b64 s[48:49]
L_PC0:
v_bfi_b32 v2, 7, v0, s2
v_lshlrev_b32 v2, 7, v2
v_min_u32 v2, L_END-L_PC0, v2
global_load_dword v7, v2, s[48:49]
v_lshrrev_b32 v1, 6, v0
s_cmp_lt_u32 s2, 32
v_readfirstlane_b32 s36, v1
s_cbranch_scc1 L_PACK
s_bfe_u32 s34, s2, 0x20001
s_bfe_u32 s37, s2, 0x20003
s_lshl2_add_u32 s37, s34, s37
s_and_b32 s43, s2, 1
s_mul_i32 s43, s43, 7
s_lshr_b32 s38, s2, 5
s_add_u32 s38, s38, s43
s_lshl2_add_u32 s39, s38, s36
s_sub_u32 s39, s39, 4
v_bfe_u32 v6, v0, 4, 2
v_and_b32 v3, 15, v0
v_mul_u32_u24 v2, 114688, v6
v_lshl_add_u32 v30, v3, 4, v2
s_lshr_b32 s46, s37, 1
s_and_b32 s45, s37, 1
s_lshl3_add_u32 s46, s46, s45
s_mul_i32 s46, s46, 57344
s_lshl_b32 s47, s39, 8
s_add_u32 s46, s46, s47
s_mov_b32 s18, 387328
s_mov_b32 s19, 0x20000
s_mov_b32 s92, 14336
s_mov_b32 s93, 28672
s_mov_b32 s94, 43008
s_waitcnt lgkmcnt(0)
s_add_u32 s16, s6, s46
s_addc_u32 s17, s7, 0
buffer_load_dwordx4 v[104:107], v30, s[16:19], 0 offen
buffer_load_dwordx4 v[108:111], v30, s[16:19], s92 offen
buffer_load_dwordx4 v[112:115], v30, s[16:19], s93 offen
buffer_load_dwordx4 v[116:119], v30, s[16:19], s94 offen
s_branch L_MAIN
L_PACK:
v_lshlrev_b32 v16, 3, v0
s_cmp_lt_u32 s2, 2
s_cselect_b32 s34, 8, 0
s_mov_b32 s35, 0x20000
v_mov_b64 v[22:23], 0
s_waitcnt lgkmcnt(0)
s_mov_b64 s[32:33], s[12:13]
v_mov_b64 v[20:21], s[56:57]
buffer_atomic_cmpswap_x2 v[20:23], v16, s[32:35], 0 offen sc1
s_branch L_PACK1
L_MAIN:
s_mov_b64 s[20:21], s[4:5]
s_mov_b32 s22, 4194304
s_mov_b32 s23, 0x20000
s_lshl_b32 s46, s37, 18
v_lshrrev_b32 v5, 3, v0
v_lshl_add_u32 v2, v5, 11, s46
v_lshrrev_b32 v4, 4, v0
v_xor_b32 v4, v4, v0
v_and_b32 v4, 7, v4
v_lshl_add_u32 v8, v4, 4, v2
v_add_u32 v9, 65536, v8
v_add_u32 v10, 131072, v8
v_add_u32 v11, 196608, v8
s_lshl_b32 s33, s36, 10
s_lshl_b32 s40, s34, 7
s_xor_b32 s41, s40, 128
s_xor_b32 s42, s40, 256
s_xor_b32 s43, s40, 384
s_add_u32 m0, s33, 65536
s_nop 0
buffer_load_dwordx4 v8, s[20:23], s40 offen lds
s_add_u32 m0, s33, 69632
s_nop 0
buffer_load_dwordx4 v9, s[20:23], s40 offen lds
s_add_u32 m0, s33, 73728
s_nop 0
buffer_load_dwordx4 v10, s[20:23], s40 offen lds
s_add_u32 m0, s33, 77824
s_nop 0
buffer_load_dwordx4 v11, s[20:23], s40 offen lds
v_mov_b32 v2, 0x3da3bf80
s_lshl_b64 exec, exec, 8
v_mov_b32 v2, 0x3e25bf32
s_lshl_b64 exec, exec, 8
v_mov_b32 v2, 0x3e7cbf06
s_lshl_b64 exec, exec, 8
v_mov_b32 v2, 0x3eadbeca
s_lshl_b64 exec, exec, 8
v_mov_b32 v2, 0x3ee2be92
s_lshl_b64 exec, exec, 8
v_mov_b32 v2, 0x3f10be3d
s_lshl_b64 exec, exec, 8
v_mov_b32 v2, 0x3f39bdba
s_lshl_b64 exec, exec, 8
v_mov_b32 v2, 0x3f800000
s_mov_b64 exec, -1
s_and_b32 s45, s36, 1
s_mul_i32 s45, s45, 0x0202
s_lshr_b32 s46, s36, 1
s_mul_i32 s46, s46, 0x02020000
s_add_u32 s45, s45, s46
s_add_u32 s45, s45, 0x05040100
v_mov_b32 v4, s45
v_lshlrev_b32 v5, 8, v5
v_and_b32 v31, 7, v0
v_lshl_add_u32 v31, v31, 4, v5
s_mov_b32 s45, 0xbf32bf80
v_perm_b32 v128, s45, v2, v4
v_mov_b32 v129, v128
v_mov_b64 v[130:131], v[128:129]
ds_write_b128 v31, v[128:131] offset:0
s_mov_b32 s45, 0xbecabf06
v_perm_b32 v132, s45, v2, v4
v_mov_b32 v133, v132
v_mov_b64 v[134:135], v[132:133]
v_and_b32 v5, 31, v0
v_lshlrev_b32 v19, 2, v5
v_and_b32 v0, 63, v0
s_lshl_b32 s46, s39, 7
ds_write_b128 v31, v[132:135] offset:8192
s_mov_b32 s45, 0xbe3dbe92
v_perm_b32 v136, s45, v2, v4
v_mov_b32 v137, v136
v_mov_b64 v[138:139], v[136:137]
v_lshl_add_u32 v28, v3, 3, s46
s_mul_i32 s47, s37, 917504
s_add_u32 s47, s47, s46
s_add_u32 s28, s10, s47
s_addc_u32 s29, s11, 0
ds_write_b128 v31, v[136:139] offset:16384
s_mov_b32 s45, 0xbdba
v_perm_b32 v140, s45, v2, v4
v_mov_b32 v141, v140
v_mov_b64 v[142:143], v[140:141]
s_mov_b32 s30, 86144
s_mov_b32 s31, 0x20000
v_mul_u32_u24 v29, 28672, v6
v_lshl_add_u32 v18, v3, 3, v29
ds_write_b128 v31, v[140:143] offset:24576
s_mov_b32 s45, 0x3e253da3
v_perm_b32 v144, s45, v2, v4
v_mov_b32 v145, v144
v_mov_b64 v[146:147], v[144:145]
v_lshlrev_b32 v29, 7, v3
v_bfe_u32 v5, v0, 1, 3
v_xor_b32 v5, v5, v6
v_lshl_add_u32 v29, v5, 4, v29
s_load_dwordx2 s[88:89], s[12:13], 0
ds_write_b128 v31, v[144:147] offset:32768
s_mov_b32 s45, 0x3ead3e7c
v_perm_b32 v148, s45, v2, v4
v_mov_b32 v149, v148
v_mov_b64 v[150:151], v[148:149]
v_add_u32 v14, 65536, v29
v_xor_b32 v15, 64, v14
v_add_u32 v16, 0x10000, v14
v_add_u32 v17, 0x10000, v15
ds_write_b128 v31, v[148:151] offset:40960
s_mov_b32 s45, 0x3f103ee2
v_perm_b32 v152, s45, v2, v4
v_mov_b32 v153, v152
v_mov_b64 v[154:155], v[152:153]
s_mov_b32 s52, 0x0c0c0400
s_mov_b32 s53, 0x0c0c0500
s_mov_b32 s54, 0x0c0c0600
s_mov_b32 s55, 0x0c0c0700
ds_write_b128 v31, v[152:155] offset:49152
s_mov_b32 s45, 0x3f803f39
v_perm_b32 v156, s45, v2, v4
v_mov_b32 v157, v156
v_mov_b64 v[158:159], v[156:157]
v_lshlrev_b32 v13, 4, v0
v_lshl_add_u32 v12, s40, 5, v13
s_lshl_b32 s47, s39, 16
s_add_u32 s24, s14, s47
s_addc_u32 s25, s15, 0
ds_write_b128 v31, v[156:159] offset:57344
s_lshl_b32 s47, s37, 10
s_add_u32 s76, s24, s47
s_addc_u32 s77, s25, 0
s_movk_i32 s78, 1024
s_mov_b32 s79, 0x20000
s_add_u32 s16, s16, 7340032
s_addc_u32 s17, s17, 0
s_mov_b32 s26, 65536
s_mov_b32 s27, 0x20000
s_mov_b64 s[80:81], s[12:13]
s_movk_i32 s82, 128
s_mov_b32 s83, 0x20000
s_movk_i32 s90, 4096
s_add_u32 m0, s33, 81920
s_nop 0
buffer_load_dwordx4 v8, s[20:23], s41 offen lds
s_add_u32 m0, s33, 86016
s_nop 0
buffer_load_dwordx4 v9, s[20:23], s41 offen lds
s_add_u32 m0, s33, 90112
s_nop 0
buffer_load_dwordx4 v10, s[20:23], s41 offen lds
s_add_u32 m0, s33, 94208
s_nop 0
buffer_load_dwordx4 v11, s[20:23], s41 offen lds
s_waitcnt vmcnt(8)
v_lshl_add_u64 v[104:105], v[108:109], 4, v[104:105]
v_lshl_add_u64 v[106:107], v[110:111], 4, v[106:107]
v_lshl_add_u64 v[112:113], v[116:117], 4, v[112:113]
v_lshl_add_u64 v[114:115], v[118:119], 4, v[114:115]
v_lshl_or_b32 v104, v112, 8, v104
v_lshl_or_b32 v105, v113, 8, v105
v_lshl_or_b32 v106, v114, 8, v106
v_lshl_or_b32 v107, v115, 8, v107
v_lshl_or_b32 v108, v105, 16, v104
v_lshl_or_b32 v109, v107, 16, v106
s_waitcnt lgkmcnt(0)
s_cmp_eq_u64 s[88:89], 0
s_cbranch_scc1 L_NOTAG
L_TAGOK:
v_mov_b64 v[110:111], s[88:89]
buffer_store_dwordx4 v[108:111], v13, s[76:79], 0 offen sc1
s_add_u32 s76, s76, 32768
s_addc_u32 s77, s77, 0
s_waitcnt lgkmcnt(0)
s_barrier
s_mov_b64 vcc, -1
s_cmp_eq_u32 s36, 0
s_cbranch_scc1 L_PAD0
s_cmp_eq_u32 s36, 1
s_cbranch_scc1 L_PAD2
s_cmp_eq_u32 s36, 2
s_cbranch_scc1 L_PAD4
L_PADRET:
s_mov_b64 vcc, 0
s_branch L_STREAM
L_PACK1:
v_and_b32 v0, 63, v0
v_lshrrev_b32 v2, 4, v0
v_and_b32 v3, 15, v0
v_mul_u32_u24 v2, 114688, v2
v_lshl_add_u32 v8, v3, 4, v2
s_movk_i32 s47, 0x3800
v_add_u32 v9, s47, v8
v_add_u32 v10, s47, v9
v_add_u32 v11, s47, v10
v_add_u32 v12, s47, v11
v_add_u32 v13, s47, v12
v_add_u32 v14, s47, v13
v_add_u32 v15, s47, v14
s_mul_i32 s40, s2, 4682
s_lshr_b32 s40, s40, 16
s_mul_i32 s41, s40, 14
s_sub_u32 s41, s2, s41
s_add_u32 s40, s40, 8
s_mov_b32 s22, 14680064
s_mov_b32 s23, 0x20000
s_cmp_ge_u32 s40, 16
s_cselect_b32 s45, 8, 0
s_add_u32 s45, s45, s40
s_lshl2_add_u32 s42, s41, s36
s_mul_i32 s43, s45, 458752
s_lshl_b32 s44, s42, 8
s_add_u32 s43, s43, s44
s_lshl_b32 s44, s42, 5
s_add_u32 s44, s44, s45
s_lshl_b32 s50, s44, 11
s_cmp_lt_u32 s45, 32
s_cselect_b32 s50, s50, -1
s_cselect_b32 s22, 14680064, 0
s_add_u32 s41, s41, 4
s_add_u32 s40, s40, 2
s_cmp_ge_u32 s41, 14
s_cselect_b32 s48, 14, 0
s_addc_u32 s40, s40, 0
s_sub_u32 s41, s41, s48
s_mov_b64 s[20:21], s[6:7]
buffer_load_dwordx4 v[32:35], v8, s[20:23], s43 offen
buffer_load_dwordx4 v[36:39], v9, s[20:23], s43 offen
buffer_load_dwordx4 v[40:43], v10, s[20:23], s43 offen
buffer_load_dwordx4 v[44:47], v11, s[20:23], s43 offen
buffer_load_dwordx4 v[48:51], v12, s[20:23], s43 offen
buffer_load_dwordx4 v[52:55], v13, s[20:23], s43 offen
buffer_load_dwordx4 v[56:59], v14, s[20:23], s43 offen
buffer_load_dwordx4 v[60:63], v15, s[20:23], s43 offen
s_mov_b64 s[24:25], s[14:15]
s_mov_b32 s26, 3670016
s_mov_b32 s27, 0x20000
s_movk_i32 s34, 128
v_mov_b32 v16, 0
v_lshlrev_b32 v18, 4, v0
s_movk_i32 s46, 4096
s_cmp_ge_u32 s40, 16
s_cselect_b32 s45, 8, 0
s_add_u32 s45, s45, s40
s_lshl2_add_u32 s42, s41, s36
s_mul_i32 s43, s45, 458752
s_lshl_b32 s44, s42, 8
s_add_u32 s43, s43, s44
s_lshl_b32 s44, s42, 5
s_add_u32 s44, s44, s45
s_lshl_b32 s51, s44, 11
s_cmp_lt_u32 s45, 32
s_cselect_b32 s51, s51, -1
s_cselect_b32 s22, 14680064, 0
s_add_u32 s41, s41, 4
s_add_u32 s40, s40, 2
s_cmp_ge_u32 s41, 14
s_cselect_b32 s48, 14, 0
s_addc_u32 s40, s40, 0
s_sub_u32 s41, s41, s48
s_load_dwordx2 s[52:53], s[12:13], 0
buffer_load_dwordx4 v[64:67], v8, s[20:23], s43 offen
buffer_load_dwordx4 v[68:71], v9, s[20:23], s43 offen
buffer_load_dwordx4 v[72:75], v10, s[20:23], s43 offen
buffer_load_dwordx4 v[76:79], v11, s[20:23], s43 offen
buffer_load_dwordx4 v[80:83], v12, s[20:23], s43 offen
buffer_load_dwordx4 v[84:87], v13, s[20:23], s43 offen
buffer_load_dwordx4 v[88:91], v14, s[20:23], s43 offen
buffer_load_dwordx4 v[92:95], v15, s[20:23], s43 offen
s_waitcnt vmcnt(8)
v_lshl_add_u64 v[32:33], v[36:37], 4, v[32:33]
v_lshl_add_u64 v[34:35], v[38:39], 4, v[34:35]
v_lshl_add_u64 v[40:41], v[44:45], 4, v[40:41]
v_lshl_add_u64 v[42:43], v[46:47], 4, v[42:43]
v_lshl_or_b32 v32, v40, 8, v32
v_lshl_or_b32 v33, v41, 8, v33
v_lshl_or_b32 v34, v42, 8, v34
v_lshl_or_b32 v35, v43, 8, v35
v_lshl_or_b32 v20, v33, 16, v32
v_lshl_or_b32 v21, v35, 16, v34
v_lshl_add_u64 v[48:49], v[52:53], 4, v[48:49]
v_lshl_add_u64 v[50:51], v[54:55], 4, v[50:51]
v_lshl_add_u64 v[56:57], v[60:61], 4, v[56:57]
v_lshl_add_u64 v[58:59], v[62:63], 4, v[58:59]
v_lshl_or_b32 v48, v56, 8, v48
v_lshl_or_b32 v49, v57, 8, v49
v_lshl_or_b32 v50, v58, 8, v50
v_lshl_or_b32 v51, v59, 8, v51
v_lshl_or_b32 v24, v49, 16, v48
v_lshl_or_b32 v25, v51, 16, v50
s_waitcnt lgkmcnt(0)
v_mov_b64 v[22:23], s[52:53]
s_nop 0
L_PKN:
v_cmp_ne_u64 vcc, 0, v[22:23]
s_sub_u32 s46, s46, 1
s_cmp_gt_i32 s46, 0
s_cbranch_vccnz L_PKGO
s_cbranch_scc0 L_END
buffer_load_dwordx2 v[22:23], v16, s[32:35], 0 offen sc1
s_waitcnt vmcnt(0)
s_branch L_PKN
L_PKGO:
v_mov_b64 v[26:27], v[22:23]
L_PKLOOP:
buffer_store_dwordx4 v[20:23], v18, s[24:27], s50 offen offset:0 sc1
buffer_store_dwordx4 v[24:27], v18, s[24:27], s50 offen offset:1024 sc1
s_cmp_eq_u32 s51, -1
s_cbranch_scc1 L_PKEND
s_cmp_ge_u32 s40, 16
s_cselect_b32 s45, 8, 0
s_add_u32 s45, s45, s40
s_lshl2_add_u32 s42, s41, s36
s_mul_i32 s43, s45, 458752
s_lshl_b32 s44, s42, 8
s_add_u32 s43, s43, s44
s_lshl_b32 s44, s42, 5
s_add_u32 s44, s44, s45
s_lshl_b32 s50, s44, 11
s_cmp_lt_u32 s45, 32
s_cselect_b32 s50, s50, -1
s_cselect_b32 s22, 14680064, 0
s_add_u32 s41, s41, 4
s_add_u32 s40, s40, 2
s_cmp_ge_u32 s41, 14
s_cselect_b32 s48, 14, 0
s_addc_u32 s40, s40, 0
s_sub_u32 s41, s41, s48
buffer_load_dwordx4 v[32:35], v8, s[20:23], s43 offen
buffer_load_dwordx4 v[36:39], v9, s[20:23], s43 offen
buffer_load_dwordx4 v[40:43], v10, s[20:23], s43 offen
buffer_load_dwordx4 v[44:47], v11, s[20:23], s43 offen
buffer_load_dwordx4 v[48:51], v12, s[20:23], s43 offen
buffer_load_dwordx4 v[52:55], v13, s[20:23], s43 offen
buffer_load_dwordx4 v[56:59], v14, s[20:23], s43 offen
buffer_load_dwordx4 v[60:63], v15, s[20:23], s43 offen
s_waitcnt vmcnt(10)
v_lshl_add_u64 v[64:65], v[68:69], 4, v[64:65]
v_lshl_add_u64 v[66:67], v[70:71], 4, v[66:67]
v_lshl_add_u64 v[72:73], v[76:77], 4, v[72:73]
v_lshl_add_u64 v[74:75], v[78:79], 4, v[74:75]
v_lshl_or_b32 v64, v72, 8, v64
v_lshl_or_b32 v65, v73, 8, v65
v_lshl_or_b32 v66, v74, 8, v66
v_lshl_or_b32 v67, v75, 8, v67
v_lshl_or_b32 v20, v65, 16, v64
v_lshl_or_b32 v21, v67, 16, v66
v_lshl_add_u64 v[80:81], v[84:85], 4, v[80:81]
v_lshl_add_u64 v[82:83], v[86:87], 4, v[82:83]
v_lshl_add_u64 v[88:89], v[92:93], 4, v[88:89]
v_lshl_add_u64 v[90:91], v[94:95], 4, v[90:91]
v_lshl_or_b32 v80, v88, 8, v80
v_lshl_or_b32 v81, v89, 8, v81
v_lshl_or_b32 v82, v90, 8, v82
v_lshl_or_b32 v83, v91, 8, v83
v_lshl_or_b32 v24, v81, 16, v80
v_lshl_or_b32 v25, v83, 16, v82
buffer_store_dwordx4 v[20:23], v18, s[24:27], s51 offen offset:0 sc1
buffer_store_dwordx4 v[24:27], v18, s[24:27], s51 offen offset:1024 sc1
s_cmp_eq_u32 s50, -1
s_cbranch_scc1 L_PKEND
s_cmp_ge_u32 s40, 16
s_cselect_b32 s45, 8, 0
s_add_u32 s45, s45, s40
s_lshl2_add_u32 s42, s41, s36
s_mul_i32 s43, s45, 458752
s_lshl_b32 s44, s42, 8
s_add_u32 s43, s43, s44
s_lshl_b32 s44, s42, 5
s_add_u32 s44, s44, s45
s_lshl_b32 s51, s44, 11
s_cmp_lt_u32 s45, 32
s_cselect_b32 s51, s51, -1
s_cselect_b32 s22, 14680064, 0
s_add_u32 s41, s41, 4
s_add_u32 s40, s40, 2
s_cmp_ge_u32 s41, 14
s_cselect_b32 s48, 14, 0
s_addc_u32 s40, s40, 0
s_sub_u32 s41, s41, s48
buffer_load_dwordx4 v[64:67], v8, s[20:23], s43 offen
buffer_load_dwordx4 v[68:71], v9, s[20:23], s43 offen
buffer_load_dwordx4 v[72:75], v10, s[20:23], s43 offen
buffer_load_dwordx4 v[76:79], v11, s[20:23], s43 offen
buffer_load_dwordx4 v[80:83], v12, s[20:23], s43 offen
buffer_load_dwordx4 v[84:87], v13, s[20:23], s43 offen
buffer_load_dwordx4 v[88:91], v14, s[20:23], s43 offen
buffer_load_dwordx4 v[92:95], v15, s[20:23], s43 offen
s_waitcnt vmcnt(10)
v_lshl_add_u64 v[32:33], v[36:37], 4, v[32:33]
v_lshl_add_u64 v[34:35], v[38:39], 4, v[34:35]
v_lshl_add_u64 v[40:41], v[44:45], 4, v[40:41]
v_lshl_add_u64 v[42:43], v[46:47], 4, v[42:43]
v_lshl_or_b32 v32, v40, 8, v32
v_lshl_or_b32 v33, v41, 8, v33
v_lshl_or_b32 v34, v42, 8, v34
v_lshl_or_b32 v35, v43, 8, v35
v_lshl_or_b32 v20, v33, 16, v32
v_lshl_or_b32 v21, v35, 16, v34
v_lshl_add_u64 v[48:49], v[52:53], 4, v[48:49]
v_lshl_add_u64 v[50:51], v[54:55], 4, v[50:51]
v_lshl_add_u64 v[56:57], v[60:61], 4, v[56:57]
v_lshl_add_u64 v[58:59], v[62:63], 4, v[58:59]
v_lshl_or_b32 v48, v56, 8, v48
v_lshl_or_b32 v49, v57, 8, v49
v_lshl_or_b32 v50, v58, 8, v50
v_lshl_or_b32 v51, v59, 8, v51
v_lshl_or_b32 v24, v49, 16, v48
v_lshl_or_b32 v25, v51, 16, v50
s_branch L_PKLOOP
L_PKEND:
s_endpgm
.p2align 12
L_STREAM:
L_PAD0:
s_cbranch_vccnz L_PAD1
s_waitcnt vmcnt(0)
buffer_load_dwordx4 v[32:35], v12, s[24:27], 0 offen offset:0 sc1
buffer_load_dwordx4 v[36:39], v12, s[24:27], 0 offen offset:1024 sc1
buffer_load_dwordx4 v[40:43], v12, s[24:27], 0 offen offset:2048 sc1
buffer_load_dwordx4 v[44:47], v12, s[24:27], 0 offen offset:3072 sc1
v_lshl_add_u32 v12, s41, 5, v13
s_barrier
ds_read_b128 a[224:227], v14 offset:0
ds_read_b128 a[228:231], v14 offset:2048
s_waitcnt vmcnt(2)
v_cmp_ne_u64 s[50:51], s[88:89], v[34:35]
v_cmp_ne_u64 s[44:45], s[88:89], v[38:39]
s_or_b64 s[50:51], s[44:45], s[50:51]
s_cbranch_scc1 L_SLOW0
L_BACK0:
v_perm_b32 v64, v32, v19, s52
v_perm_b32 v65, v32, v19, s53
v_perm_b32 v66, v36, v19, s52
v_perm_b32 v67, v36, v19, s53
v_perm_b32 v68, v32, v19, s54
v_perm_b32 v69, v32, v19, s55
v_perm_b32 v70, v36, v19, s54
v_perm_b32 v71, v36, v19, s55
ds_read_b32 a0, v64
ds_read_b32 a1, v65
ds_read_b32 a2, v66
ds_read_b32 a3, v67
ds_read_b32 a4, v68
ds_read_b32 a5, v69
ds_read_b32 a6, v70
ds_read_b32 a7, v71
v_perm_b32 v72, v33, v19, s52
v_perm_b32 v73, v33, v19, s53
v_perm_b32 v74, v37, v19, s52
v_perm_b32 v75, v37, v19, s53
v_perm_b32 v76, v33, v19, s54
v_perm_b32 v77, v33, v19, s55
v_perm_b32 v78, v37, v19, s54
v_perm_b32 v79, v37, v19, s55
ds_read_b32 a8, v72
ds_read_b32 a9, v73
ds_read_b32 a10, v74
ds_read_b32 a11, v75
ds_read_b32 a12, v76
ds_read_b32 a13, v77
ds_read_b32 a14, v78
ds_read_b32 a15, v79
buffer_load_dwordx4 v[48:51], v12, s[24:27], 0 offen offset:0 sc1
s_waitcnt vmcnt(1) lgkmcnt(12)
v_cmp_ne_u64 s[50:51], s[88:89], v[42:43]
v_cmp_ne_u64 s[44:45], s[88:89], v[46:47]
v_mfma_f32_16x16x32_bf16 v[128:131], a[224:227], a[0:3], 0
s_waitcnt lgkmcnt(8)
ds_read_b128 a[232:235], v14 offset:4096
buffer_load_dwordx4 v[52:55], v12, s[24:27], 0 offen offset:1024 sc1
v_mfma_f32_16x16x32_bf16 v[132:135], a[224:227], a[4:7], 0
s_waitcnt lgkmcnt(5)
s_or_b64 s[50:51], s[44:45], s[50:51]
v_mfma_f32_16x16x32_bf16 v[136:139], a[224:227], a[8:11], 0
s_waitcnt lgkmcnt(1)
s_cbranch_scc1 L_SLOW1
L_BACK1:
v_mfma_f32_16x16x32_bf16 v[140:143], a[224:227], a[12:15], 0
buffer_load_dwordx4 v[96:99], v12, s[24:27], 0 offen offset:2048 sc1
v_mfma_f32_16x16x32_bf16 v[144:147], a[228:231], a[0:3], 0
ds_read_b128 a[236:239], v14 offset:6144
buffer_load_dwordx4 v[100:103], v12, s[24:27], 0 offen offset:3072 sc1
v_mfma_f32_16x16x32_bf16 v[148:151], a[228:231], a[4:7], 0
v_perm_b32 v63, v40, v19, s52
v_lshl_add_u32 v12, s42, 5, v13
v_mfma_f32_16x16x32_bf16 v[152:155], a[228:231], a[8:11], 0
s_add_u32 m0, s33, 98304
ds_read_b32 a16, v63
v_perm_b32 v62, v40, v19, s53
v_mfma_f32_16x16x32_bf16 v[156:159], a[228:231], a[12:15], 0
s_waitcnt lgkmcnt(2)
ds_read_b32 a17, v62
v_perm_b32 v61, v44, v19, s52
v_mfma_f32_16x16x32_bf16 v[160:163], a[232:235], a[0:3], 0
ds_read_b128 a[240:243], v14 offset:8192
buffer_load_dwordx4 v8, s[20:23], s42 offen lds
v_mfma_f32_16x16x32_bf16 v[164:167], a[232:235], a[4:7], 0
ds_read_b32 a18, v61
v_perm_b32 v60, v44, v19, s53
v_mfma_f32_16x16x32_bf16 v[168:171], a[232:235], a[8:11], 0
s_add_u32 m0, s33, 102400
ds_read_b32 a19, v60
v_perm_b32 v59, v40, v19, s54
v_mfma_f32_16x16x32_bf16 v[172:175], a[232:235], a[12:15], 0
s_waitcnt lgkmcnt(4)
ds_read_b32 a20, v59
v_perm_b32 v58, v40, v19, s55
v_mfma_f32_16x16x32_bf16 v[176:179], a[236:239], a[0:3], 0
ds_read_b128 a[244:247], v14 offset:10240
buffer_load_dwordx4 v9, s[20:23], s42 offen lds
v_mfma_f32_16x16x32_bf16 v[180:183], a[236:239], a[4:7], 0
ds_read_b32 a21, v58
v_perm_b32 v57, v44, v19, s54
v_mfma_f32_16x16x32_bf16 v[184:187], a[236:239], a[8:11], 0
s_add_u32 m0, s33, 106496
ds_read_b32 a22, v57
v_perm_b32 v56, v44, v19, s55
v_mfma_f32_16x16x32_bf16 v[188:191], a[236:239], a[12:15], 0
s_waitcnt lgkmcnt(4)
ds_read_b32 a23, v56
v_perm_b32 v63, v41, v19, s52
v_mfma_f32_16x16x32_bf16 v[192:195], a[240:243], a[0:3], 0
ds_read_b128 a[248:251], v14 offset:12288
buffer_load_dwordx4 v10, s[20:23], s42 offen lds
v_mfma_f32_16x16x32_bf16 v[196:199], a[240:243], a[4:7], 0
ds_read_b32 a24, v63
v_perm_b32 v62, v41, v19, s53
v_mfma_f32_16x16x32_bf16 v[200:203], a[240:243], a[8:11], 0
s_add_u32 m0, s33, 110592
ds_read_b32 a25, v62
v_perm_b32 v61, v45, v19, s52
v_mfma_f32_16x16x32_bf16 v[204:207], a[240:243], a[12:15], 0
s_waitcnt lgkmcnt(4)
ds_read_b32 a26, v61
v_perm_b32 v60, v45, v19, s53
v_mfma_f32_16x16x32_bf16 v[208:211], a[244:247], a[0:3], 0
ds_read_b128 a[252:255], v14 offset:14336
buffer_load_dwordx4 v11, s[20:23], s42 offen lds
v_mfma_f32_16x16x32_bf16 v[212:215], a[244:247], a[4:7], 0
ds_read_b32 a27, v60
v_perm_b32 v59, v41, v19, s54
v_mfma_f32_16x16x32_bf16 v[216:219], a[244:247], a[8:11], 0
ds_read_b32 a28, v59
v_perm_b32 v58, v41, v19, s55
v_mfma_f32_16x16x32_bf16 v[220:223], a[244:247], a[12:15], 0
s_waitcnt lgkmcnt(4)
ds_read_b32 a29, v58
v_mfma_f32_16x16x32_bf16 v[224:227], a[248:251], a[0:3], 0
ds_read_b128 a[224:227], v15 offset:0
v_perm_b32 v57, v45, v19, s54
v_mfma_f32_16x16x32_bf16 v[228:231], a[248:251], a[4:7], 0
ds_read_b32 a30, v57
v_perm_b32 v56, v45, v19, s55
v_mfma_f32_16x16x32_bf16 v[232:235], a[248:251], a[8:11], 0
ds_read_b32 a31, v56
buffer_load_dwordx4 v[80:83], v12, s[24:27], 0 offen offset:0 sc1
v_mfma_f32_16x16x32_bf16 v[236:239], a[248:251], a[12:15], 0
s_waitcnt lgkmcnt(4)
buffer_load_dwordx4 v[84:87], v12, s[24:27], 0 offen offset:1024 sc1
v_mfma_f32_16x16x32_bf16 v[240:243], a[252:255], a[0:3], 0
ds_read_b128 a[228:231], v15 offset:2048
v_mfma_f32_16x16x32_bf16 v[244:247], a[252:255], a[4:7], 0
buffer_load_dwordx4 v[88:91], v12, s[24:27], 0 offen offset:2048 sc1
v_mfma_f32_16x16x32_bf16 v[248:251], a[252:255], a[8:11], 0
buffer_load_dwordx4 v[92:95], v12, s[24:27], 0 offen offset:3072 sc1
v_lshl_add_u32 v12, s43, 5, v13
v_mfma_f32_16x16x32_bf16 v[252:255], a[252:255], a[12:15], 0
s_waitcnt vmcnt(10) lgkmcnt(1)
v_cmp_ne_u64 s[50:51], s[88:89], v[50:51]
v_cmp_ne_u64 s[44:45], s[88:89], v[54:55]
v_mfma_f32_16x16x32_bf16 v[128:131], a[224:227], a[16:19], v[128:131]
ds_read_b128 a[232:235], v15 offset:4096
global_load_dwordx2 v[20:21], v28, s[8:9]
v_mfma_f32_16x16x32_bf16 v[132:135], a[224:227], a[20:23], v[132:135]
s_or_b64 s[50:51], s[44:45], s[50:51]
v_mfma_f32_16x16x32_bf16 v[136:139], a[224:227], a[24:27], v[136:139]
s_cbranch_scc1 L_SLOW2
L_BACK2:
v_mfma_f32_16x16x32_bf16 v[140:143], a[224:227], a[28:31], v[140:143]
s_waitcnt lgkmcnt(1)
v_mfma_f32_16x16x32_bf16 v[144:147], a[228:231], a[16:19], v[144:147]
ds_read_b128 a[236:239], v15 offset:6144
v_mfma_f32_16x16x32_bf16 v[148:151], a[228:231], a[20:23], v[148:151]
v_perm_b32 v63, v48, v19, s52
v_mfma_f32_16x16x32_bf16 v[152:155], a[228:231], a[24:27], v[152:155]
ds_read_b32 a32, v63
v_perm_b32 v62, v48, v19, s53
v_mfma_f32_16x16x32_bf16 v[156:159], a[228:231], a[28:31], v[156:159]
s_waitcnt lgkmcnt(2)
ds_read_b32 a33, v62
v_mfma_f32_16x16x32_bf16 v[160:163], a[232:235], a[16:19], v[160:163]
ds_read_b128 a[240:243], v15 offset:8192
v_perm_b32 v61, v52, v19, s52
v_mfma_f32_16x16x32_bf16 v[164:167], a[232:235], a[20:23], v[164:167]
ds_read_b32 a34, v61
v_perm_b32 v60, v52, v19, s53
v_mfma_f32_16x16x32_bf16 v[168:171], a[232:235], a[24:27], v[168:171]
ds_read_b32 a35, v60
v_perm_b32 v59, v48, v19, s54
v_mfma_f32_16x16x32_bf16 v[172:175], a[232:235], a[28:31], v[172:175]
s_waitcnt lgkmcnt(4)
ds_read_b32 a36, v59
v_mfma_f32_16x16x32_bf16 v[176:179], a[236:239], a[16:19], v[176:179]
ds_read_b128 a[244:247], v15 offset:10240
v_perm_b32 v58, v48, v19, s55
v_mfma_f32_16x16x32_bf16 v[180:183], a[236:239], a[20:23], v[180:183]
ds_read_b32 a37, v58
v_perm_b32 v57, v52, v19, s54
v_mfma_f32_16x16x32_bf16 v[184:187], a[236:239], a[24:27], v[184:187]
s_add_u32 m0, s33, 114688
ds_read_b32 a38, v57
v_perm_b32 v56, v52, v19, s55
v_mfma_f32_16x16x32_bf16 v[188:191], a[236:239], a[28:31], v[188:191]
s_waitcnt lgkmcnt(4)
ds_read_b32 a39, v56
v_perm_b32 v63, v49, v19, s52
v_mfma_f32_16x16x32_bf16 v[192:195], a[240:243], a[16:19], v[192:195]
ds_read_b128 a[248:251], v15 offset:12288
buffer_load_dwordx4 v8, s[20:23], s43 offen lds
v_mfma_f32_16x16x32_bf16 v[196:199], a[240:243], a[20:23], v[196:199]
ds_read_b32 a40, v63
v_perm_b32 v62, v49, v19, s53
v_mfma_f32_16x16x32_bf16 v[200:203], a[240:243], a[24:27], v[200:203]
ds_read_b32 a41, v62
v_perm_b32 v61, v53, v19, s52
v_mfma_f32_16x16x32_bf16 v[204:207], a[240:243], a[28:31], v[204:207]
s_waitcnt lgkmcnt(4)
ds_read_b32 a42, v61
v_mfma_f32_16x16x32_bf16 v[208:211], a[244:247], a[16:19], v[208:211]
ds_read_b128 a[252:255], v15 offset:14336
v_perm_b32 v60, v53, v19, s53
v_mfma_f32_16x16x32_bf16 v[212:215], a[244:247], a[20:23], v[212:215]
ds_read_b32 a43, v60
v_perm_b32 v59, v49, v19, s54
v_mfma_f32_16x16x32_bf16 v[216:219], a[244:247], a[24:27], v[216:219]
ds_read_b32 a44, v59
v_perm_b32 v58, v49, v19, s55
v_mfma_f32_16x16x32_bf16 v[220:223], a[244:247], a[28:31], v[220:223]
s_waitcnt lgkmcnt(4)
ds_read_b32 a45, v58
buffer_load_dwordx4 v[32:35], v12, s[24:27], 0 offen offset:0 sc1
v_mfma_f32_16x16x32_bf16 v[224:227], a[248:251], a[16:19], v[224:227]
s_barrier
ds_read_b128 a[224:227], v14 offset:16384
v_perm_b32 v57, v53, v19, s54
v_mfma_f32_16x16x32_bf16 v[228:231], a[248:251], a[20:23], v[228:231]
ds_read_b32 a46, v57
v_perm_b32 v56, v53, v19, s55
v_mfma_f32_16x16x32_bf16 v[232:235], a[248:251], a[24:27], v[232:235]
s_add_u32 m0, s33, 118784
ds_read_b32 a47, v56
buffer_load_dwordx4 v[36:39], v12, s[24:27], 0 offen offset:1024 sc1
v_mfma_f32_16x16x32_bf16 v[236:239], a[248:251], a[28:31], v[236:239]
s_waitcnt lgkmcnt(4)
v_mfma_f32_16x16x32_bf16 v[240:243], a[252:255], a[16:19], v[240:243]
ds_read_b128 a[228:231], v14 offset:18432
buffer_load_dwordx4 v9, s[20:23], s43 offen lds
v_mfma_f32_16x16x32_bf16 v[244:247], a[252:255], a[20:23], v[244:247]
buffer_load_dwordx4 v[104:107], v30, s[16:19], 0 offen
v_mfma_f32_16x16x32_bf16 v[248:251], a[252:255], a[24:27], v[248:251]
s_waitcnt vmcnt(14)
v_cmp_ne_u64 s[50:51], s[88:89], v[98:99]
v_cmp_ne_u64 s[44:45], s[88:89], v[102:103]
v_mfma_f32_16x16x32_bf16 v[252:255], a[252:255], a[28:31], v[252:255]
s_waitcnt lgkmcnt(1)
v_mfma_f32_16x16x32_bf16 v[128:131], a[224:227], a[32:35], v[128:131]
s_or_b64 s[50:51], s[44:45], s[50:51]
ds_read_b128 a[232:235], v14 offset:20480
v_mfma_f32_16x16x32_bf16 v[132:135], a[224:227], a[36:39], v[132:135]
s_cbranch_scc1 L_SLOW3
L_BACK3:
v_mfma_f32_16x16x32_bf16 v[136:139], a[224:227], a[40:43], v[136:139]
v_perm_b32 v63, v96, v19, s52
v_mfma_f32_16x16x32_bf16 v[140:143], a[224:227], a[44:47], v[140:143]
s_waitcnt lgkmcnt(1)
ds_read_b32 a48, v63
v_mfma_f32_16x16x32_bf16 v[144:147], a[228:231], a[32:35], v[144:147]
ds_read_b128 a[236:239], v14 offset:22528
v_perm_b32 v62, v96, v19, s53
v_mfma_f32_16x16x32_bf16 v[148:151], a[228:231], a[36:39], v[148:151]
ds_read_b32 a49, v62
v_perm_b32 v61, v100, v19, s52
v_mfma_f32_16x16x32_bf16 v[152:155], a[228:231], a[40:43], v[152:155]
s_add_u32 m0, s33, 122880
ds_read_b32 a50, v61
v_perm_b32 v60, v100, v19, s53
v_mfma_f32_16x16x32_bf16 v[156:159], a[228:231], a[44:47], v[156:159]
s_waitcnt lgkmcnt(4)
ds_read_b32 a51, v60
v_perm_b32 v59, v96, v19, s54
v_mfma_f32_16x16x32_bf16 v[160:163], a[232:235], a[32:35], v[160:163]
ds_read_b128 a[240:243], v14 offset:24576
buffer_load_dwordx4 v10, s[20:23], s43 offen lds
v_mfma_f32_16x16x32_bf16 v[164:167], a[232:235], a[36:39], v[164:167]
buffer_load_dwordx4 v[108:111], v30, s[16:19], s92 offen
v_mfma_f32_16x16x32_bf16 v[168:171], a[232:235], a[40:43], v[168:171]
ds_read_b32 a52, v59
v_perm_b32 v58, v96, v19, s55
v_mfma_f32_16x16x32_bf16 v[172:175], a[232:235], a[44:47], v[172:175]
s_waitcnt lgkmcnt(3)
ds_read_b32 a53, v58
v_mfma_f32_16x16x32_bf16 v[176:179], a[236:239], a[32:35], v[176:179]
ds_read_b128 a[244:247], v14 offset:26624
v_perm_b32 v57, v100, v19, s54
v_mfma_f32_16x16x32_bf16 v[180:183], a[236:239], a[36:39], v[180:183]
ds_read_b32 a54, v57
v_perm_b32 v56, v100, v19, s55
v_mfma_f32_16x16x32_bf16 v[184:187], a[236:239], a[40:43], v[184:187]
ds_read_b32 a55, v56
v_perm_b32 v63, v97, v19, s52
v_mfma_f32_16x16x32_bf16 v[188:191], a[236:239], a[44:47], v[188:191]
s_waitcnt lgkmcnt(4)
ds_read_b32 a56, v63
buffer_load_dwordx4 v[40:43], v12, s[24:27], 0 offen offset:2048 sc1
v_mfma_f32_16x16x32_bf16 v[192:195], a[240:243], a[32:35], v[192:195]
ds_read_b128 a[248:251], v14 offset:28672
v_perm_b32 v62, v97, v19, s53
v_mfma_f32_16x16x32_bf16 v[196:199], a[240:243], a[36:39], v[196:199]
ds_read_b32 a57, v62
v_perm_b32 v61, v101, v19, s52
v_mfma_f32_16x16x32_bf16 v[200:203], a[240:243], a[40:43], v[200:203]
s_add_u32 m0, s33, 126976
ds_read_b32 a58, v61
v_perm_b32 v60, v101, v19, s53
v_mfma_f32_16x16x32_bf16 v[204:207], a[240:243], a[44:47], v[204:207]
s_waitcnt lgkmcnt(4)
ds_read_b32 a59, v60
v_perm_b32 v59, v97, v19, s54
v_mfma_f32_16x16x32_bf16 v[208:211], a[244:247], a[32:35], v[208:211]
ds_read_b128 a[252:255], v14 offset:30720
buffer_load_dwordx4 v11, s[20:23], s43 offen lds
v_mfma_f32_16x16x32_bf16 v[212:215], a[244:247], a[36:39], v[212:215]
buffer_load_dwordx4 v[112:115], v30, s[16:19], s93 offen
v_mfma_f32_16x16x32_bf16 v[216:219], a[244:247], a[40:43], v[216:219]
ds_read_b32 a60, v59
v_perm_b32 v58, v97, v19, s55
v_mfma_f32_16x16x32_bf16 v[220:223], a[244:247], a[44:47], v[220:223]
s_waitcnt lgkmcnt(3)
ds_read_b32 a61, v58
buffer_load_dwordx4 v[44:47], v12, s[24:27], 0 offen offset:3072 sc1
v_mfma_f32_16x16x32_bf16 v[224:227], a[248:251], a[32:35], v[224:227]
ds_read_b128 a[224:227], v15 offset:16384
v_perm_b32 v57, v101, v19, s54
v_mfma_f32_16x16x32_bf16 v[228:231], a[248:251], a[36:39], v[228:231]
ds_read_b32 a62, v57
v_perm_b32 v56, v101, v19, s55
v_mfma_f32_16x16x32_bf16 v[232:235], a[248:251], a[40:43], v[232:235]
ds_read_b32 a63, v56
v_add_u32 v12, 16384, v13
v_mfma_f32_16x16x32_bf16 v[236:239], a[248:251], a[44:47], v[236:239]
s_waitcnt lgkmcnt(4)
v_mfma_f32_16x16x32_bf16 v[240:243], a[252:255], a[32:35], v[240:243]
ds_read_b128 a[228:231], v15 offset:18432
v_mfma_f32_16x16x32_bf16 v[244:247], a[252:255], a[36:39], v[244:247]
v_mfma_f32_16x16x32_bf16 v[248:251], a[252:255], a[40:43], v[248:251]
s_waitcnt vmcnt(14)
v_cmp_ne_u64 s[50:51], s[88:89], v[82:83]
v_cmp_ne_u64 s[44:45], s[88:89], v[86:87]
v_mfma_f32_16x16x32_bf16 v[252:255], a[252:255], a[44:47], v[252:255]
s_waitcnt lgkmcnt(1)
v_mfma_f32_16x16x32_bf16 v[128:131], a[224:227], a[48:51], v[128:131]
s_or_b64 s[50:51], s[44:45], s[50:51]
ds_read_b128 a[232:235], v15 offset:20480
v_mfma_f32_16x16x32_bf16 v[132:135], a[224:227], a[52:55], v[132:135]
buffer_load_dwordx4 v[116:119], v30, s[16:19], s94 offen
v_mfma_f32_16x16x32_bf16 v[136:139], a[224:227], a[56:59], v[136:139]
s_cbranch_scc1 L_SLOW4
L_BACK4:
v_mfma_f32_16x16x32_bf16 v[140:143], a[224:227], a[60:63], v[140:143]
s_waitcnt lgkmcnt(1)
v_mfma_f32_16x16x32_bf16 v[144:147], a[228:231], a[48:51], v[144:147]
s_waitcnt vmcnt(12)
ds_read_b128 a[236:239], v15 offset:22528
v_lshlrev_b32 v24, 16, v20
v_mfma_f32_16x16x32_bf16 v[148:151], a[228:231], a[52:55], v[148:151]
v_perm_b32 v63, v80, v19, s52
v_and_b32 v25, 0xffff0000, v20
v_mfma_f32_16x16x32_bf16 v[152:155], a[228:231], a[56:59], v[152:155]
ds_read_b32 a64, v63
v_perm_b32 v62, v80, v19, s53
v_mfma_f32_16x16x32_bf16 v[156:159], a[228:231], a[60:63], v[156:159]
s_waitcnt lgkmcnt(2)
ds_read_b32 a65, v62
v_lshlrev_b32 v26, 16, v21
v_mfma_f32_16x16x32_bf16 v[160:163], a[232:235], a[48:51], v[160:163]
ds_read_b128 a[240:243], v15 offset:24576
v_perm_b32 v61, v84, v19, s52
v_mfma_f32_16x16x32_bf16 v[164:167], a[232:235], a[52:55], v[164:167]
ds_read_b32 a66, v61
v_perm_b32 v60, v84, v19, s53
v_mfma_f32_16x16x32_bf16 v[168:171], a[232:235], a[56:59], v[168:171]
ds_read_b32 a67, v60
v_perm_b32 v59, v80, v19, s54
v_mfma_f32_16x16x32_bf16 v[172:175], a[232:235], a[60:63], v[172:175]
s_waitcnt lgkmcnt(4)
ds_read_b32 a68, v59
v_and_b32 v27, 0xffff0000, v21
v_mfma_f32_16x16x32_bf16 v[176:179], a[236:239], a[48:51], v[176:179]
ds_read_b128 a[244:247], v15 offset:26624
v_perm_b32 v58, v80, v19, s55
v_mfma_f32_16x16x32_bf16 v[180:183], a[236:239], a[52:55], v[180:183]
ds_read_b32 a69, v58
v_perm_b32 v57, v84, v19, s54
v_mfma_f32_16x16x32_bf16 v[184:187], a[236:239], a[56:59], v[184:187]
s_add_u32 m0, s33, 130560
ds_read_b32 a70, v57
v_perm_b32 v56, v84, v19, s55
v_mfma_f32_16x16x32_bf16 v[188:191], a[236:239], a[60:63], v[188:191]
s_waitcnt lgkmcnt(4)
ds_read_b32 a71, v56
v_perm_b32 v63, v81, v19, s52
v_mfma_f32_16x16x32_bf16 v[192:195], a[240:243], a[48:51], v[192:195]
ds_read_b128 a[248:251], v15 offset:28672
buffer_load_dwordx4 v8, s[20:23], 0 offen offset:512 lds
v_mfma_f32_16x16x32_bf16 v[196:199], a[240:243], a[52:55], v[196:199]
ds_read_b32 a72, v63
v_perm_b32 v62, v81, v19, s53
v_mfma_f32_16x16x32_bf16 v[200:203], a[240:243], a[56:59], v[200:203]
ds_read_b32 a73, v62
v_perm_b32 v61, v85, v19, s52
v_mfma_f32_16x16x32_bf16 v[204:207], a[240:243], a[60:63], v[204:207]
s_waitcnt lgkmcnt(4)
ds_read_b32 a74, v61
v_mfma_f32_16x16x32_bf16 v[208:211], a[244:247], a[48:51], v[208:211]
ds_read_b128 a[252:255], v15 offset:30720
v_perm_b32 v60, v85, v19, s53
v_mfma_f32_16x16x32_bf16 v[212:215], a[244:247], a[52:55], v[212:215]
ds_read_b32 a75, v60
v_perm_b32 v59, v81, v19, s54
v_mfma_f32_16x16x32_bf16 v[216:219], a[244:247], a[56:59], v[216:219]
ds_read_b32 a76, v59
v_perm_b32 v58, v81, v19, s55
v_mfma_f32_16x16x32_bf16 v[220:223], a[244:247], a[60:63], v[220:223]
s_waitcnt lgkmcnt(4)
ds_read_b32 a77, v58
v_mfma_f32_16x16x32_bf16 v[224:227], a[248:251], a[48:51], v[224:227]
s_barrier
ds_read_b128 a[224:227], v14 offset:32768
v_perm_b32 v57, v85, v19, s54
v_mfma_f32_16x16x32_bf16 v[228:231], a[248:251], a[52:55], v[228:231]
ds_read_b32 a78, v57
v_perm_b32 v56, v85, v19, s55
v_mfma_f32_16x16x32_bf16 v[232:235], a[248:251], a[56:59], v[232:235]
s_add_u32 m0, s33, 134656
ds_read_b32 a79, v56
v_mfma_f32_16x16x32_bf16 v[236:239], a[248:251], a[60:63], v[236:239]
s_waitcnt lgkmcnt(4)
buffer_load_dwordx4 v[48:51], v12, s[24:27], 0 offen offset:0 sc1
v_mfma_f32_16x16x32_bf16 v[240:243], a[252:255], a[48:51], v[240:243]
ds_read_b128 a[228:231], v14 offset:34816
buffer_load_dwordx4 v9, s[20:23], 0 offen offset:512 lds
v_mfma_f32_16x16x32_bf16 v[244:247], a[252:255], a[52:55], v[244:247]
buffer_load_dwordx4 v[52:55], v12, s[24:27], 0 offen offset:1024 sc1
v_mfma_f32_16x16x32_bf16 v[248:251], a[252:255], a[56:59], v[248:251]
v_mfma_f32_16x16x32_bf16 v[252:255], a[252:255], a[60:63], v[252:255]
s_waitcnt lgkmcnt(1)
v_cmp_ne_u64 s[50:51], s[88:89], v[90:91]
v_cmp_ne_u64 s[44:45], s[88:89], v[94:95]
v_mfma_f32_16x16x32_bf16 v[128:131], a[224:227], a[64:67], v[128:131]
ds_read_b128 a[232:235], v14 offset:36864
v_mfma_f32_16x16x32_bf16 v[132:135], a[224:227], a[68:71], v[132:135]
s_or_b64 s[50:51], s[44:45], s[50:51]
v_mfma_f32_16x16x32_bf16 v[136:139], a[224:227], a[72:75], v[136:139]
s_cbranch_scc1 L_SLOW5
L_BACK5:
v_mfma_f32_16x16x32_bf16 v[140:143], a[224:227], a[76:79], v[140:143]
s_waitcnt lgkmcnt(1)
v_mfma_f32_16x16x32_bf16 v[144:147], a[228:231], a[64:67], v[144:147]
ds_read_b128 a[236:239], v14 offset:38912
v_mfma_f32_16x16x32_bf16 v[148:151], a[228:231], a[68:71], v[148:151]
v_perm_b32 v63, v88, v19, s52
v_mfma_f32_16x16x32_bf16 v[152:155], a[228:231], a[72:75], v[152:155]
s_add_u32 m0, s33, 138752
ds_read_b32 a80, v63
v_perm_b32 v62, v88, v19, s53
v_mfma_f32_16x16x32_bf16 v[156:159], a[228:231], a[76:79], v[156:159]
s_waitcnt lgkmcnt(2)
ds_read_b32 a81, v62
v_perm_b32 v61, v92, v19, s52
v_mfma_f32_16x16x32_bf16 v[160:163], a[232:235], a[64:67], v[160:163]
ds_read_b128 a[240:243], v14 offset:40960
buffer_load_dwordx4 v10, s[20:23], 0 offen offset:512 lds
v_mfma_f32_16x16x32_bf16 v[164:167], a[232:235], a[68:71], v[164:167]
ds_read_b32 a82, v61
v_perm_b32 v60, v92, v19, s53
v_mfma_f32_16x16x32_bf16 v[168:171], a[232:235], a[72:75], v[168:171]
ds_read_b32 a83, v60
v_perm_b32 v59, v88, v19, s54
v_mfma_f32_16x16x32_bf16 v[172:175], a[232:235], a[76:79], v[172:175]
s_waitcnt lgkmcnt(4)
ds_read_b32 a84, v59
v_mfma_f32_16x16x32_bf16 v[176:179], a[236:239], a[64:67], v[176:179]
ds_read_b128 a[244:247], v14 offset:43008
v_perm_b32 v58, v88, v19, s55
v_mfma_f32_16x16x32_bf16 v[180:183], a[236:239], a[68:71], v[180:183]
ds_read_b32 a85, v58
v_perm_b32 v57, v92, v19, s54
v_mfma_f32_16x16x32_bf16 v[184:187], a[236:239], a[72:75], v[184:187]
ds_read_b32 a86, v57
v_perm_b32 v56, v92, v19, s55
v_mfma_f32_16x16x32_bf16 v[188:191], a[236:239], a[76:79], v[188:191]
s_waitcnt lgkmcnt(4)
ds_read_b32 a87, v56
v_mfma_f32_16x16x32_bf16 v[192:195], a[240:243], a[64:67], v[192:195]
ds_read_b128 a[248:251], v14 offset:45056
v_perm_b32 v63, v89, v19, s52
v_mfma_f32_16x16x32_bf16 v[196:199], a[240:243], a[68:71], v[196:199]
ds_read_b32 a88, v63
v_perm_b32 v62, v89, v19, s53
v_mfma_f32_16x16x32_bf16 v[200:203], a[240:243], a[72:75], v[200:203]
s_add_u32 m0, s33, 142848
ds_read_b32 a89, v62
v_perm_b32 v61, v93, v19, s52
v_mfma_f32_16x16x32_bf16 v[204:207], a[240:243], a[76:79], v[204:207]
s_waitcnt lgkmcnt(4)
ds_read_b32 a90, v61
v_perm_b32 v60, v93, v19, s53
v_mfma_f32_16x16x32_bf16 v[208:211], a[244:247], a[64:67], v[208:211]
ds_read_b128 a[252:255], v14 offset:47104
buffer_load_dwordx4 v11, s[20:23], 0 offen offset:512 lds
v_mfma_f32_16x16x32_bf16 v[212:215], a[244:247], a[68:71], v[212:215]
ds_read_b32 a91, v60
v_perm_b32 v59, v89, v19, s54
v_mfma_f32_16x16x32_bf16 v[216:219], a[244:247], a[72:75], v[216:219]
ds_read_b32 a92, v59
v_perm_b32 v58, v89, v19, s55
v_mfma_f32_16x16x32_bf16 v[220:223], a[244:247], a[76:79], v[220:223]
s_waitcnt lgkmcnt(4)
ds_read_b32 a93, v58
v_mfma_f32_16x16x32_bf16 v[224:227], a[248:251], a[64:67], v[224:227]
ds_read_b128 a[224:227], v15 offset:32768
v_perm_b32 v57, v93, v19, s54
v_mfma_f32_16x16x32_bf16 v[228:231], a[248:251], a[68:71], v[228:231]
ds_read_b32 a94, v57
v_perm_b32 v56, v93, v19, s55
v_mfma_f32_16x16x32_bf16 v[232:235], a[248:251], a[72:75], v[232:235]
ds_read_b32 a95, v56
v_mfma_f32_16x16x32_bf16 v[236:239], a[248:251], a[76:79], v[236:239]
s_waitcnt vmcnt(15) lgkmcnt(4)
v_cmp_ne_u64 s[50:51], s[88:89], v[34:35]
v_cmp_ne_u64 s[44:45], s[88:89], v[38:39]
v_mfma_f32_16x16x32_bf16 v[240:243], a[252:255], a[64:67], v[240:243]
ds_read_b128 a[228:231], v15 offset:34816
buffer_load_dwordx4 v[96:99], v12, s[24:27], 0 offen offset:2048 sc1
v_mfma_f32_16x16x32_bf16 v[244:247], a[252:255], a[68:71], v[244:247]
s_or_b64 s[50:51], s[44:45], s[50:51]
buffer_load_dwordx4 v[100:103], v12, s[24:27], 0 offen offset:3072 sc1
v_mfma_f32_16x16x32_bf16 v[248:251], a[252:255], a[72:75], v[248:251]
s_cbranch_scc1 L_SLOW6
L_BACK6:
v_mfma_f32_16x16x32_bf16 v[252:255], a[252:255], a[76:79], v[252:255]
s_waitcnt lgkmcnt(1)
v_add_u32 v12, 20480, v13
v_mfma_f32_16x16x32_bf16 v[128:131], a[224:227], a[80:83], v[128:131]
ds_read_b128 a[232:235], v15 offset:36864
v_mfma_f32_16x16x32_bf16 v[132:135], a[224:227], a[84:87], v[132:135]
v_perm_b32 v63, v32, v19, s52
v_mfma_f32_16x16x32_bf16 v[136:139], a[224:227], a[88:91], v[136:139]
ds_read_b32 a96, v63
v_perm_b32 v62, v32, v19, s53
v_mfma_f32_16x16x32_bf16 v[140:143], a[224:227], a[92:95], v[140:143]
s_waitcnt lgkmcnt(2)
ds_read_b32 a97, v62
v_mfma_f32_16x16x32_bf16 v[144:147], a[228:231], a[80:83], v[144:147]
ds_read_b128 a[236:239], v15 offset:38912
v_perm_b32 v61, v36, v19, s52
v_mfma_f32_16x16x32_bf16 v[148:151], a[228:231], a[84:87], v[148:151]
ds_read_b32 a98, v61
v_perm_b32 v60, v36, v19, s53
v_mfma_f32_16x16x32_bf16 v[152:155], a[228:231], a[88:91], v[152:155]
L_PAD1:
s_cbranch_vccnz L_PADRET
ds_read_b32 a99, v60
v_perm_b32 v59, v32, v19, s54
v_mfma_f32_16x16x32_bf16 v[156:159], a[228:231], a[92:95], v[156:159]
s_waitcnt lgkmcnt(4)
ds_read_b32 a100, v59
v_mfma_f32_16x16x32_bf16 v[160:163], a[232:235], a[80:83], v[160:163]
ds_read_b128 a[240:243], v15 offset:40960
v_perm_b32 v58, v32, v19, s55
v_mfma_f32_16x16x32_bf16 v[164:167], a[232:235], a[84:87], v[164:167]
ds_read_b32 a101, v58
v_perm_b32 v57, v36, v19, s54
v_mfma_f32_16x16x32_bf16 v[168:171], a[232:235], a[88:91], v[168:171]
ds_read_b32 a102, v57
v_perm_b32 v56, v36, v19, s55
v_mfma_f32_16x16x32_bf16 v[172:175], a[232:235], a[92:95], v[172:175]
s_waitcnt lgkmcnt(4)
ds_read_b32 a103, v56
v_mfma_f32_16x16x32_bf16 v[176:179], a[236:239], a[80:83], v[176:179]
ds_read_b128 a[244:247], v15 offset:43008
v_perm_b32 v63, v33, v19, s52
v_mfma_f32_16x16x32_bf16 v[180:183], a[236:239], a[84:87], v[180:183]
ds_read_b32 a104, v63
v_perm_b32 v62, v33, v19, s53
v_mfma_f32_16x16x32_bf16 v[184:187], a[236:239], a[88:91], v[184:187]
s_add_u32 m0, s33, 146816
ds_read_b32 a105, v62
v_perm_b32 v61, v37, v19, s52
v_mfma_f32_16x16x32_bf16 v[188:191], a[236:239], a[92:95], v[188:191]
s_waitcnt lgkmcnt(4)
ds_read_b32 a106, v61
v_perm_b32 v60, v37, v19, s53
v_mfma_f32_16x16x32_bf16 v[192:195], a[240:243], a[80:83], v[192:195]
ds_read_b128 a[248:251], v15 offset:45056
buffer_load_dwordx4 v8, s[20:23], 0 offen offset:640 lds
v_mfma_f32_16x16x32_bf16 v[196:199], a[240:243], a[84:87], v[196:199]
ds_read_b32 a107, v60
v_perm_b32 v59, v33, v19, s54
v_mfma_f32_16x16x32_bf16 v[200:203], a[240:243], a[88:91], v[200:203]
ds_read_b32 a108, v59
v_mfma_f32_16x16x32_bf16 v[204:207], a[240:243], a[92:95], v[204:207]
s_waitcnt vmcnt(10) lgkmcnt(4)
v_cmp_ne_u64 s[50:51], s[88:89], v[42:43]
v_cmp_ne_u64 s[44:45], s[88:89], v[46:47]
v_mfma_f32_16x16x32_bf16 v[208:211], a[244:247], a[80:83], v[208:211]
ds_read_b128 a[252:255], v15 offset:47104
v_perm_b32 v58, v33, v19, s55
v_mfma_f32_16x16x32_bf16 v[212:215], a[244:247], a[84:87], v[212:215]
s_or_b64 s[50:51], s[44:45], s[50:51]
ds_read_b32 a109, v58
v_perm_b32 v57, v37, v19, s54
v_mfma_f32_16x16x32_bf16 v[216:219], a[244:247], a[88:91], v[216:219]
s_cbranch_scc1 L_SLOW7
L_BACK7:
v_mfma_f32_16x16x32_bf16 v[220:223], a[244:247], a[92:95], v[220:223]
s_waitcnt lgkmcnt(2)
ds_read_b32 a110, v57
v_mfma_f32_16x16x32_bf16 v[224:227], a[248:251], a[80:83], v[224:227]
s_barrier
ds_read_b128 a[224:227], v14 offset:49152
v_perm_b32 v56, v37, v19, s55
v_mfma_f32_16x16x32_bf16 v[228:231], a[248:251], a[84:87], v[228:231]
ds_read_b32 a111, v56
v_perm_b32 v63, v40, v19, s52
v_mfma_f32_16x16x32_bf16 v[232:235], a[248:251], a[88:91], v[232:235]
s_add_u32 m0, s33, 150912
ds_read_b32 a112, v63
buffer_load_dwordx4 v[80:83], v12, s[24:27], 0 offen offset:0 sc1
v_mfma_f32_16x16x32_bf16 v[236:239], a[248:251], a[92:95], v[236:239]
s_waitcnt vmcnt(10) lgkmcnt(4)
v_perm_b32 v62, v40, v19, s53
v_lshl_add_u64 v[104:105], v[108:109], 4, v[104:105]
v_mfma_f32_16x16x32_bf16 v[240:243], a[252:255], a[80:83], v[240:243]
ds_read_b128 a[228:231], v14 offset:51200
buffer_load_dwordx4 v9, s[20:23], 0 offen offset:640 lds
v_mfma_f32_16x16x32_bf16 v[244:247], a[252:255], a[84:87], v[244:247]
ds_read_b32 a113, v62
buffer_load_dwordx4 v[84:87], v12, s[24:27], 0 offen offset:1024 sc1
v_mfma_f32_16x16x32_bf16 v[248:251], a[252:255], a[88:91], v[248:251]
v_perm_b32 v61, v44, v19, s52
v_lshl_add_u64 v[106:107], v[110:111], 4, v[106:107]
v_mfma_f32_16x16x32_bf16 v[252:255], a[252:255], a[92:95], v[252:255]
s_waitcnt lgkmcnt(2)
ds_read_b32 a114, v61
v_mfma_f32_16x16x32_bf16 v[128:131], a[224:227], a[96:99], v[128:131]
ds_read_b128 a[232:235], v14 offset:53248
v_mfma_f32_16x16x32_bf16 v[132:135], a[224:227], a[100:103], v[132:135]
v_perm_b32 v60, v44, v19, s53
v_lshl_add_u64 v[112:113], v[116:117], 4, v[112:113]
v_mfma_f32_16x16x32_bf16 v[136:139], a[224:227], a[104:107], v[136:139]
ds_read_b32 a115, v60
v_perm_b32 v59, v40, v19, s54
v_mfma_f32_16x16x32_bf16 v[140:143], a[224:227], a[108:111], v[140:143]
s_waitcnt lgkmcnt(3)
ds_read_b32 a116, v59
v_perm_b32 v58, v40, v19, s55
v_mfma_f32_16x16x32_bf16 v[144:147], a[228:231], a[96:99], v[144:147]
ds_read_b128 a[236:239], v14 offset:55296
v_lshl_add_u64 v[114:115], v[118:119], 4, v[114:115]
v_mfma_f32_16x16x32_bf16 v[148:151], a[228:231], a[100:103], v[148:151]
ds_read_b32 a117, v58
v_perm_b32 v57, v44, v19, s54
v_mfma_f32_16x16x32_bf16 v[152:155], a[228:231], a[104:107], v[152:155]
s_add_u32 m0, s33, 155008
ds_read_b32 a118, v57
v_mfma_f32_16x16x32_bf16 v[156:159], a[228:231], a[108:111], v[156:159]
s_waitcnt lgkmcnt(4)
v_perm_b32 v56, v44, v19, s55
v_lshl_or_b32 v104, v112, 8, v104
v_mfma_f32_16x16x32_bf16 v[160:163], a[232:235], a[96:99], v[160:163]
ds_read_b128 a[240:243], v14 offset:57344
buffer_load_dwordx4 v10, s[20:23], 0 offen offset:640 lds
v_mfma_f32_16x16x32_bf16 v[164:167], a[232:235], a[100:103], v[164:167]
ds_read_b32 a119, v56
v_mfma_f32_16x16x32_bf16 v[168:171], a[232:235], a[104:107], v[168:171]
v_perm_b32 v63, v41, v19, s52
v_lshl_or_b32 v105, v113, 8, v105
v_mfma_f32_16x16x32_bf16 v[172:175], a[232:235], a[108:111], v[172:175]
s_waitcnt lgkmcnt(2)
ds_read_b32 a120, v63
v_mfma_f32_16x16x32_bf16 v[176:179], a[236:239], a[96:99], v[176:179]
ds_read_b128 a[244:247], v14 offset:59392
v_mfma_f32_16x16x32_bf16 v[180:183], a[236:239], a[100:103], v[180:183]
v_perm_b32 v62, v41, v19, s53
v_lshl_or_b32 v106, v114, 8, v106
v_mfma_f32_16x16x32_bf16 v[184:187], a[236:239], a[104:107], v[184:187]
ds_read_b32 a121, v62
v_perm_b32 v61, v45, v19, s52
v_mfma_f32_16x16x32_bf16 v[188:191], a[236:239], a[108:111], v[188:191]
s_waitcnt lgkmcnt(3)
ds_read_b32 a122, v61
v_perm_b32 v60, v45, v19, s53
v_mfma_f32_16x16x32_bf16 v[192:195], a[240:243], a[96:99], v[192:195]
ds_read_b128 a[248:251], v14 offset:61440
v_lshl_or_b32 v107, v115, 8, v107
v_mfma_f32_16x16x32_bf16 v[196:199], a[240:243], a[100:103], v[196:199]
ds_read_b32 a123, v60
v_perm_b32 v59, v41, v19, s54
v_mfma_f32_16x16x32_bf16 v[200:203], a[240:243], a[104:107], v[200:203]
s_add_u32 m0, s33, 159104
ds_read_b32 a124, v59
v_mfma_f32_16x16x32_bf16 v[204:207], a[240:243], a[108:111], v[204:207]
s_waitcnt lgkmcnt(4)
v_perm_b32 v58, v41, v19, s55
v_lshl_or_b32 v108, v105, 16, v104
v_mfma_f32_16x16x32_bf16 v[208:211], a[244:247], a[96:99], v[208:211]
ds_read_b128 a[252:255], v14 offset:63488
buffer_load_dwordx4 v11, s[20:23], 0 offen offset:640 lds
v_mfma_f32_16x16x32_bf16 v[212:215], a[244:247], a[100:103], v[212:215]
ds_read_b32 a125, v58
v_mfma_f32_16x16x32_bf16 v[216:219], a[244:247], a[104:107], v[216:219]
v_perm_b32 v57, v45, v19, s54
v_lshl_or_b32 v109, v107, 16, v106
v_mfma_f32_16x16x32_bf16 v[220:223], a[244:247], a[108:111], v[220:223]
s_waitcnt lgkmcnt(2)
ds_read_b32 a126, v57
v_mfma_f32_16x16x32_bf16 v[224:227], a[248:251], a[96:99], v[224:227]
ds_read_b128 a[224:227], v15 offset:49152
v_mfma_f32_16x16x32_bf16 v[228:231], a[248:251], a[100:103], v[228:231]
v_perm_b32 v56, v45, v19, s55
v_mov_b64 v[110:111], s[88:89]
v_mfma_f32_16x16x32_bf16 v[232:235], a[248:251], a[104:107], v[232:235]
ds_read_b32 a127, v56
v_mfma_f32_16x16x32_bf16 v[236:239], a[248:251], a[108:111], v[236:239]
s_waitcnt lgkmcnt(3)
buffer_load_dwordx4 v[88:91], v12, s[24:27], 0 offen offset:2048 sc1
v_mfma_f32_16x16x32_bf16 v[240:243], a[252:255], a[96:99], v[240:243]
ds_read_b128 a[228:231], v15 offset:51200
buffer_load_dwordx4 v[92:95], v12, s[24:27], 0 offen offset:3072 sc1
v_mfma_f32_16x16x32_bf16 v[244:247], a[252:255], a[100:103], v[244:247]
buffer_store_dwordx4 v[108:111], v13, s[76:79], 0 offen sc1
v_mfma_f32_16x16x32_bf16 v[248:251], a[252:255], a[104:107], v[248:251]
v_add_u32 v12, 24576, v13
v_mfma_f32_16x16x32_bf16 v[252:255], a[252:255], a[108:111], v[252:255]
s_waitcnt vmcnt(13) lgkmcnt(1)
v_cmp_ne_u64 s[50:51], s[88:89], v[50:51]
v_cmp_ne_u64 s[44:45], s[88:89], v[54:55]
v_mfma_f32_16x16x32_bf16 v[128:131], a[224:227], a[112:115], v[128:131]
ds_read_b128 a[232:235], v15 offset:53248
v_mfma_f32_16x16x32_bf16 v[132:135], a[224:227], a[116:119], v[132:135]
s_or_b64 s[50:51], s[44:45], s[50:51]
v_mfma_f32_16x16x32_bf16 v[136:139], a[224:227], a[120:123], v[136:139]
s_cbranch_scc1 L_SLOW8
L_BACK8:
v_mfma_f32_16x16x32_bf16 v[140:143], a[224:227], a[124:127], v[140:143]
s_waitcnt lgkmcnt(1)
v_mfma_f32_16x16x32_bf16 v[144:147], a[228:231], a[112:115], v[144:147]
ds_read_b128 a[236:239], v15 offset:55296
v_mfma_f32_16x16x32_bf16 v[148:151], a[228:231], a[116:119], v[148:151]
v_perm_b32 v63, v48, v19, s52
v_mfma_f32_16x16x32_bf16 v[152:155], a[228:231], a[120:123], v[152:155]
ds_read_b32 a128, v63
v_perm_b32 v62, v48, v19, s53
v_mfma_f32_16x16x32_bf16 v[156:159], a[228:231], a[124:127], v[156:159]
s_waitcnt lgkmcnt(2)
ds_read_b32 a129, v62
v_mfma_f32_16x16x32_bf16 v[160:163], a[232:235], a[112:115], v[160:163]
ds_read_b128 a[240:243], v15 offset:57344
v_perm_b32 v61, v52, v19, s52
v_mfma_f32_16x16x32_bf16 v[164:167], a[232:235], a[116:119], v[164:167]
ds_read_b32 a130, v61
v_perm_b32 v60, v52, v19, s53
v_mfma_f32_16x16x32_bf16 v[168:171], a[232:235], a[120:123], v[168:171]
ds_read_b32 a131, v60
v_perm_b32 v59, v48, v19, s54
v_mfma_f32_16x16x32_bf16 v[172:175], a[232:235], a[124:127], v[172:175]
s_waitcnt lgkmcnt(4)
ds_read_b32 a132, v59
v_mfma_f32_16x16x32_bf16 v[176:179], a[236:239], a[112:115], v[176:179]
ds_read_b128 a[244:247], v15 offset:59392
v_perm_b32 v58, v48, v19, s55
v_mfma_f32_16x16x32_bf16 v[180:183], a[236:239], a[116:119], v[180:183]
ds_read_b32 a133, v58
v_perm_b32 v57, v52, v19, s54
v_mfma_f32_16x16x32_bf16 v[184:187], a[236:239], a[120:123], v[184:187]
s_add_u32 m0, s33, 64768
ds_read_b32 a134, v57
v_perm_b32 v56, v52, v19, s55
v_mfma_f32_16x16x32_bf16 v[188:191], a[236:239], a[124:127], v[188:191]
s_waitcnt lgkmcnt(4)
ds_read_b32 a135, v56
v_perm_b32 v63, v49, v19, s52
v_mfma_f32_16x16x32_bf16 v[192:195], a[240:243], a[112:115], v[192:195]
ds_read_b128 a[248:251], v15 offset:61440
buffer_load_dwordx4 v8, s[20:23], 0 offen offset:768 lds
v_mfma_f32_16x16x32_bf16 v[196:199], a[240:243], a[116:119], v[196:199]
ds_read_b32 a136, v63
v_perm_b32 v62, v49, v19, s53
v_mfma_f32_16x16x32_bf16 v[200:203], a[240:243], a[120:123], v[200:203]
ds_read_b32 a137, v62
v_perm_b32 v61, v53, v19, s52
v_mfma_f32_16x16x32_bf16 v[204:207], a[240:243], a[124:127], v[204:207]
s_waitcnt lgkmcnt(4)
ds_read_b32 a138, v61
v_mfma_f32_16x16x32_bf16 v[208:211], a[244:247], a[112:115], v[208:211]
ds_read_b128 a[252:255], v15 offset:63488
v_perm_b32 v60, v53, v19, s53
v_mfma_f32_16x16x32_bf16 v[212:215], a[244:247], a[116:119], v[212:215]
ds_read_b32 a139, v60
v_perm_b32 v59, v49, v19, s54
v_mfma_f32_16x16x32_bf16 v[216:219], a[244:247], a[120:123], v[216:219]
ds_read_b32 a140, v59
v_perm_b32 v58, v49, v19, s55
v_mfma_f32_16x16x32_bf16 v[220:223], a[244:247], a[124:127], v[220:223]
s_waitcnt lgkmcnt(4)
ds_read_b32 a141, v58
v_mfma_f32_16x16x32_bf16 v[224:227], a[248:251], a[112:115], v[224:227]
s_waitcnt vmcnt(12)
s_barrier
ds_read_b128 a[224:227], v16 offset:0
v_perm_b32 v57, v53, v19, s54
v_mfma_f32_16x16x32_bf16 v[228:231], a[248:251], a[116:119], v[228:231]
ds_read_b32 a142, v57
v_perm_b32 v56, v53, v19, s55
v_mfma_f32_16x16x32_bf16 v[232:235], a[248:251], a[120:123], v[232:235]
s_add_u32 m0, s33, 68864
ds_read_b32 a143, v56
v_mfma_f32_16x16x32_bf16 v[236:239], a[248:251], a[124:127], v[236:239]
s_waitcnt lgkmcnt(4)
buffer_load_dwordx4 v[32:35], v12, s[24:27], 0 offen offset:0 sc1
v_mfma_f32_16x16x32_bf16 v[240:243], a[252:255], a[112:115], v[240:243]
ds_read_b128 a[228:231], v16 offset:2048
buffer_load_dwordx4 v9, s[20:23], 0 offen offset:768 lds
v_mfma_f32_16x16x32_bf16 v[244:247], a[252:255], a[116:119], v[244:247]
buffer_load_dwordx4 v[36:39], v12, s[24:27], 0 offen offset:1024 sc1
v_mfma_f32_16x16x32_bf16 v[248:251], a[252:255], a[120:123], v[248:251]
v_mfma_f32_16x16x32_bf16 v[252:255], a[252:255], a[124:127], v[252:255]
s_waitcnt vmcnt(13) lgkmcnt(1)
v_cmp_ne_u64 s[50:51], s[88:89], v[98:99]
v_cmp_ne_u64 s[44:45], s[88:89], v[102:103]
v_mfma_f32_16x16x32_bf16 v[128:131], a[224:227], a[128:131], v[128:131]
ds_read_b128 a[232:235], v16 offset:4096
v_mfma_f32_16x16x32_bf16 v[132:135], a[224:227], a[132:135], v[132:135]
s_or_b64 s[50:51], s[44:45], s[50:51]
v_mfma_f32_16x16x32_bf16 v[136:139], a[224:227], a[136:139], v[136:139]
s_cbranch_scc1 L_SLOW9
L_BACK9:
v_mfma_f32_16x16x32_bf16 v[140:143], a[224:227], a[140:143], v[140:143]
s_waitcnt lgkmcnt(1)
v_mfma_f32_16x16x32_bf16 v[144:147], a[228:231], a[128:131], v[144:147]
ds_read_b128 a[236:239], v16 offset:6144
v_mfma_f32_16x16x32_bf16 v[148:151], a[228:231], a[132:135], v[148:151]
v_perm_b32 v63, v96, v19, s52
v_mfma_f32_16x16x32_bf16 v[152:155], a[228:231], a[136:139], v[152:155]
s_add_u32 m0, s33, 72960
ds_read_b32 a144, v63
v_perm_b32 v62, v96, v19, s53
v_mfma_f32_16x16x32_bf16 v[156:159], a[228:231], a[140:143], v[156:159]
s_waitcnt lgkmcnt(2)
ds_read_b32 a145, v62
v_perm_b32 v61, v100, v19, s52
v_mfma_f32_16x16x32_bf16 v[160:163], a[232:235], a[128:131], v[160:163]
ds_read_b128 a[240:243], v16 offset:8192
buffer_load_dwordx4 v10, s[20:23], 0 offen offset:768 lds
v_mfma_f32_16x16x32_bf16 v[164:167], a[232:235], a[132:135], v[164:167]
ds_read_b32 a146, v61
v_perm_b32 v60, v100, v19, s53
v_mfma_f32_16x16x32_bf16 v[168:171], a[232:235], a[136:139], v[168:171]
ds_read_b32 a147, v60
v_perm_b32 v59, v96, v19, s54
v_mfma_f32_16x16x32_bf16 v[172:175], a[232:235], a[140:143], v[172:175]
s_waitcnt lgkmcnt(4)
ds_read_b32 a148, v59
v_mfma_f32_16x16x32_bf16 v[176:179], a[236:239], a[128:131], v[176:179]
ds_read_b128 a[244:247], v16 offset:10240
v_perm_b32 v58, v96, v19, s55
v_mfma_f32_16x16x32_bf16 v[180:183], a[236:239], a[132:135], v[180:183]
ds_read_b32 a149, v58
v_perm_b32 v57, v100, v19, s54
v_mfma_f32_16x16x32_bf16 v[184:187], a[236:239], a[136:139], v[184:187]
ds_read_b32 a150, v57
v_perm_b32 v56, v100, v19, s55
v_mfma_f32_16x16x32_bf16 v[188:191], a[236:239], a[140:143], v[188:191]
s_waitcnt lgkmcnt(4)
ds_read_b32 a151, v56
v_mfma_f32_16x16x32_bf16 v[192:195], a[240:243], a[128:131], v[192:195]
ds_read_b128 a[248:251], v16 offset:12288
v_perm_b32 v63, v97, v19, s52
v_mfma_f32_16x16x32_bf16 v[196:199], a[240:243], a[132:135], v[196:199]
ds_read_b32 a152, v63
v_perm_b32 v62, v97, v19, s53
v_mfma_f32_16x16x32_bf16 v[200:203], a[240:243], a[136:139], v[200:203]
s_add_u32 m0, s33, 77056
ds_read_b32 a153, v62
v_perm_b32 v61, v101, v19, s52
v_mfma_f32_16x16x32_bf16 v[204:207], a[240:243], a[140:143], v[204:207]
s_waitcnt lgkmcnt(4)
ds_read_b32 a154, v61
v_perm_b32 v60, v101, v19, s53
v_mfma_f32_16x16x32_bf16 v[208:211], a[244:247], a[128:131], v[208:211]
ds_read_b128 a[252:255], v16 offset:14336
buffer_load_dwordx4 v11, s[20:23], 0 offen offset:768 lds
v_mfma_f32_16x16x32_bf16 v[212:215], a[244:247], a[132:135], v[212:215]
ds_read_b32 a155, v60
v_perm_b32 v59, v97, v19, s54
v_mfma_f32_16x16x32_bf16 v[216:219], a[244:247], a[136:139], v[216:219]
ds_read_b32 a156, v59
v_perm_b32 v58, v97, v19, s55
v_mfma_f32_16x16x32_bf16 v[220:223], a[244:247], a[140:143], v[220:223]
s_waitcnt lgkmcnt(4)
ds_read_b32 a157, v58
v_mfma_f32_16x16x32_bf16 v[224:227], a[248:251], a[128:131], v[224:227]
ds_read_b128 a[224:227], v17 offset:0
v_perm_b32 v57, v101, v19, s54
v_mfma_f32_16x16x32_bf16 v[228:231], a[248:251], a[132:135], v[228:231]
ds_read_b32 a158, v57
v_perm_b32 v56, v101, v19, s55
v_mfma_f32_16x16x32_bf16 v[232:235], a[248:251], a[136:139], v[232:235]
ds_read_b32 a159, v56
v_mfma_f32_16x16x32_bf16 v[236:239], a[248:251], a[140:143], v[236:239]
s_waitcnt lgkmcnt(4)
buffer_load_dwordx4 v[40:43], v12, s[24:27], 0 offen offset:2048 sc1
v_mfma_f32_16x16x32_bf16 v[240:243], a[252:255], a[128:131], v[240:243]
ds_read_b128 a[228:231], v17 offset:2048
buffer_load_dwordx4 v[44:47], v12, s[24:27], 0 offen offset:3072 sc1
v_mfma_f32_16x16x32_bf16 v[244:247], a[252:255], a[132:135], v[244:247]
v_add_u32 v12, 28672, v13
v_mfma_f32_16x16x32_bf16 v[248:251], a[252:255], a[136:139], v[248:251]
s_waitcnt vmcnt(13)
v_cmp_ne_u64 s[50:51], s[88:89], v[82:83]
v_cmp_ne_u64 s[44:45], s[88:89], v[86:87]
v_mfma_f32_16x16x32_bf16 v[252:255], a[252:255], a[140:143], v[252:255]
s_waitcnt lgkmcnt(1)
v_mfma_f32_16x16x32_bf16 v[128:131], a[224:227], a[144:147], v[128:131]
s_or_b64 s[50:51], s[44:45], s[50:51]
ds_read_b128 a[232:235], v17 offset:4096
v_mfma_f32_16x16x32_bf16 v[132:135], a[224:227], a[148:151], v[132:135]
s_cbranch_scc1 L_SLOW10
L_BACK10:
v_mfma_f32_16x16x32_bf16 v[136:139], a[224:227], a[152:155], v[136:139]
s_add_u32 m0, s33, 81024
v_mfma_f32_16x16x32_bf16 v[140:143], a[224:227], a[156:159], v[140:143]
s_waitcnt lgkmcnt(1)
v_mfma_f32_16x16x32_bf16 v[144:147], a[228:231], a[144:147], v[144:147]
ds_read_b128 a[236:239], v17 offset:6144
buffer_load_dwordx4 v8, s[20:23], 0 offen offset:896 lds
v_mfma_f32_16x16x32_bf16 v[148:151], a[228:231], a[148:151], v[148:151]
v_perm_b32 v63, v80, v19, s52
v_mfma_f32_16x16x32_bf16 v[152:155], a[228:231], a[152:155], v[152:155]
ds_read_b32 a160, v63
v_perm_b32 v62, v80, v19, s53
v_mfma_f32_16x16x32_bf16 v[156:159], a[228:231], a[156:159], v[156:159]
s_waitcnt lgkmcnt(2)
ds_read_b32 a161, v62
v_mfma_f32_16x16x32_bf16 v[160:163], a[232:235], a[144:147], v[160:163]
ds_read_b128 a[240:243], v17 offset:8192
v_perm_b32 v61, v84, v19, s52
v_mfma_f32_16x16x32_bf16 v[164:167], a[232:235], a[148:151], v[164:167]
ds_read_b32 a162, v61
v_perm_b32 v60, v84, v19, s53
v_mfma_f32_16x16x32_bf16 v[168:171], a[232:235], a[152:155], v[168:171]
ds_read_b32 a163, v60
v_perm_b32 v59, v80, v19, s54
v_mfma_f32_16x16x32_bf16 v[172:175], a[232:235], a[156:159], v[172:175]
s_waitcnt lgkmcnt(4)
ds_read_b32 a164, v59
v_mfma_f32_16x16x32_bf16 v[176:179], a[236:239], a[144:147], v[176:179]
ds_read_b128 a[244:247], v17 offset:10240
v_perm_b32 v58, v80, v19, s55
v_mfma_f32_16x16x32_bf16 v[180:183], a[236:239], a[148:151], v[180:183]
ds_read_b32 a165, v58
v_perm_b32 v57, v84, v19, s54
v_mfma_f32_16x16x32_bf16 v[184:187], a[236:239], a[152:155], v[184:187]
s_add_u32 m0, s33, 85120
ds_read_b32 a166, v57
v_perm_b32 v56, v84, v19, s55
v_mfma_f32_16x16x32_bf16 v[188:191], a[236:239], a[156:159], v[188:191]
s_waitcnt lgkmcnt(4)
ds_read_b32 a167, v56
v_perm_b32 v63, v81, v19, s52
v_mfma_f32_16x16x32_bf16 v[192:195], a[240:243], a[144:147], v[192:195]
ds_read_b128 a[248:251], v17 offset:12288
buffer_load_dwordx4 v9, s[20:23], 0 offen offset:896 lds
v_mfma_f32_16x16x32_bf16 v[196:199], a[240:243], a[148:151], v[196:199]
ds_read_b32 a168, v63
v_perm_b32 v62, v81, v19, s53
v_mfma_f32_16x16x32_bf16 v[200:203], a[240:243], a[152:155], v[200:203]
ds_read_b32 a169, v62
v_perm_b32 v61, v85, v19, s52
v_mfma_f32_16x16x32_bf16 v[204:207], a[240:243], a[156:159], v[204:207]
s_waitcnt lgkmcnt(4)
ds_read_b32 a170, v61
v_mfma_f32_16x16x32_bf16 v[208:211], a[244:247], a[144:147], v[208:211]
ds_read_b128 a[252:255], v17 offset:14336
v_perm_b32 v60, v85, v19, s53
v_mfma_f32_16x16x32_bf16 v[212:215], a[244:247], a[148:151], v[212:215]
ds_read_b32 a171, v60
v_perm_b32 v59, v81, v19, s54
v_mfma_f32_16x16x32_bf16 v[216:219], a[244:247], a[152:155], v[216:219]
ds_read_b32 a172, v59
v_perm_b32 v58, v81, v19, s55
v_mfma_f32_16x16x32_bf16 v[220:223], a[244:247], a[156:159], v[220:223]
s_waitcnt lgkmcnt(4)
ds_read_b32 a173, v58
v_mfma_f32_16x16x32_bf16 v[224:227], a[248:251], a[144:147], v[224:227]
s_waitcnt vmcnt(13)
s_barrier
ds_read_b128 a[224:227], v16 offset:16384
v_perm_b32 v57, v85, v19, s54
v_mfma_f32_16x16x32_bf16 v[228:231], a[248:251], a[148:151], v[228:231]
ds_read_b32 a174, v57
v_perm_b32 v56, v85, v19, s55
v_mfma_f32_16x16x32_bf16 v[232:235], a[248:251], a[152:155], v[232:235]
s_add_u32 m0, s33, 89216
ds_read_b32 a175, v56
buffer_load_dwordx4 v[48:51], v12, s[24:27], 0 offen offset:0 sc1
v_mfma_f32_16x16x32_bf16 v[236:239], a[248:251], a[156:159], v[236:239]
s_waitcnt lgkmcnt(4)
buffer_load_dwordx4 v[52:55], v12, s[24:27], 0 offen offset:1024 sc1
v_mfma_f32_16x16x32_bf16 v[240:243], a[252:255], a[144:147], v[240:243]
ds_read_b128 a[228:231], v16 offset:18432
buffer_load_dwordx4 v10, s[20:23], 0 offen offset:896 lds
v_mfma_f32_16x16x32_bf16 v[244:247], a[252:255], a[148:151], v[244:247]
v_mfma_f32_16x16x32_bf16 v[248:251], a[252:255], a[152:155], v[248:251]
v_mfma_f32_16x16x32_bf16 v[252:255], a[252:255], a[156:159], v[252:255]
s_waitcnt vmcnt(14) lgkmcnt(1)
v_cmp_ne_u64 s[50:51], s[88:89], v[90:91]
v_cmp_ne_u64 s[44:45], s[88:89], v[94:95]
v_mfma_f32_16x16x32_bf16 v[128:131], a[224:227], a[160:163], v[128:131]
ds_read_b128 a[232:235], v16 offset:20480
v_mfma_f32_16x16x32_bf16 v[132:135], a[224:227], a[164:167], v[132:135]
s_or_b64 s[50:51], s[44:45], s[50:51]
v_mfma_f32_16x16x32_bf16 v[136:139], a[224:227], a[168:171], v[136:139]
s_cbranch_scc1 L_SLOW11
L_BACK11:
v_mfma_f32_16x16x32_bf16 v[140:143], a[224:227], a[172:175], v[140:143]
s_waitcnt lgkmcnt(1)
v_mfma_f32_16x16x32_bf16 v[144:147], a[228:231], a[160:163], v[144:147]
ds_read_b128 a[236:239], v16 offset:22528
v_mfma_f32_16x16x32_bf16 v[148:151], a[228:231], a[164:167], v[148:151]
v_perm_b32 v63, v88, v19, s52
v_mfma_f32_16x16x32_bf16 v[152:155], a[228:231], a[168:171], v[152:155]
s_add_u32 m0, s33, 93312
ds_read_b32 a176, v63
v_perm_b32 v62, v88, v19, s53
v_mfma_f32_16x16x32_bf16 v[156:159], a[228:231], a[172:175], v[156:159]
s_waitcnt lgkmcnt(2)
ds_read_b32 a177, v62
v_perm_b32 v61, v92, v19, s52
v_mfma_f32_16x16x32_bf16 v[160:163], a[232:235], a[160:163], v[160:163]
ds_read_b128 a[240:243], v16 offset:24576
buffer_load_dwordx4 v11, s[20:23], 0 offen offset:896 lds
v_mfma_f32_16x16x32_bf16 v[164:167], a[232:235], a[164:167], v[164:167]
ds_read_b32 a178, v61
v_perm_b32 v60, v92, v19, s53
v_mfma_f32_16x16x32_bf16 v[168:171], a[232:235], a[168:171], v[168:171]
ds_read_b32 a179, v60
v_perm_b32 v59, v88, v19, s54
v_mfma_f32_16x16x32_bf16 v[172:175], a[232:235], a[172:175], v[172:175]
s_waitcnt lgkmcnt(4)
ds_read_b32 a180, v59
v_mfma_f32_16x16x32_bf16 v[176:179], a[236:239], a[160:163], v[176:179]
ds_read_b128 a[244:247], v16 offset:26624
v_perm_b32 v58, v88, v19, s55
v_mfma_f32_16x16x32_bf16 v[180:183], a[236:239], a[164:167], v[180:183]
ds_read_b32 a181, v58
v_perm_b32 v57, v92, v19, s54
v_mfma_f32_16x16x32_bf16 v[184:187], a[236:239], a[168:171], v[184:187]
ds_read_b32 a182, v57
v_perm_b32 v56, v92, v19, s55
v_mfma_f32_16x16x32_bf16 v[188:191], a[236:239], a[172:175], v[188:191]
s_waitcnt lgkmcnt(4)
ds_read_b32 a183, v56
buffer_load_dwordx4 v[96:99], v12, s[24:27], 0 offen offset:2048 sc1
v_mfma_f32_16x16x32_bf16 v[192:195], a[240:243], a[160:163], v[192:195]
ds_read_b128 a[248:251], v16 offset:28672
v_perm_b32 v63, v89, v19, s52
v_mfma_f32_16x16x32_bf16 v[196:199], a[240:243], a[164:167], v[196:199]
ds_read_b32 a184, v63
v_perm_b32 v62, v89, v19, s53
v_mfma_f32_16x16x32_bf16 v[200:203], a[240:243], a[168:171], v[200:203]
s_add_u32 m0, s33, 97280
ds_read_b32 a185, v62
v_perm_b32 v61, v93, v19, s52
v_mfma_f32_16x16x32_bf16 v[204:207], a[240:243], a[172:175], v[204:207]
s_waitcnt lgkmcnt(4)
ds_read_b32 a186, v61
v_perm_b32 v60, v93, v19, s53
v_mfma_f32_16x16x32_bf16 v[208:211], a[244:247], a[160:163], v[208:211]
ds_read_b128 a[252:255], v16 offset:30720
buffer_load_dwordx4 v8, s[20:23], 0 offen offset:1024 lds
v_mfma_f32_16x16x32_bf16 v[212:215], a[244:247], a[164:167], v[212:215]
ds_read_b32 a187, v60
v_perm_b32 v59, v89, v19, s54
v_mfma_f32_16x16x32_bf16 v[216:219], a[244:247], a[168:171], v[216:219]
ds_read_b32 a188, v59
v_perm_b32 v58, v89, v19, s55
v_mfma_f32_16x16x32_bf16 v[220:223], a[244:247], a[172:175], v[220:223]
s_waitcnt lgkmcnt(4)
ds_read_b32 a189, v58
buffer_load_dwordx4 v[100:103], v12, s[24:27], 0 offen offset:3072 sc1
v_mfma_f32_16x16x32_bf16 v[224:227], a[248:251], a[160:163], v[224:227]
ds_read_b128 a[224:227], v17 offset:16384
v_perm_b32 v57, v93, v19, s54
v_mfma_f32_16x16x32_bf16 v[228:231], a[248:251], a[164:167], v[228:231]
ds_read_b32 a190, v57
v_perm_b32 v56, v93, v19, s55
v_mfma_f32_16x16x32_bf16 v[232:235], a[248:251], a[168:171], v[232:235]
ds_read_b32 a191, v56
v_add_u32 v12, 32768, v13
v_mfma_f32_16x16x32_bf16 v[236:239], a[248:251], a[172:175], v[236:239]
s_waitcnt lgkmcnt(4)
v_mfma_f32_16x16x32_bf16 v[240:243], a[252:255], a[160:163], v[240:243]
ds_read_b128 a[228:231], v17 offset:18432
v_mfma_f32_16x16x32_bf16 v[244:247], a[252:255], a[164:167], v[244:247]
v_mfma_f32_16x16x32_bf16 v[248:251], a[252:255], a[168:171], v[248:251]
v_mfma_f32_16x16x32_bf16 v[252:255], a[252:255], a[172:175], v[252:255]
L_PAD2:
s_cbranch_vccnz L_PAD3
s_waitcnt vmcnt(13) lgkmcnt(1)
v_cmp_ne_u64 s[50:51], s[88:89], v[34:35]
v_cmp_ne_u64 s[44:45], s[88:89], v[38:39]
v_mfma_f32_16x16x32_bf16 v[128:131], a[224:227], a[176:179], v[128:131]
ds_read_b128 a[232:235], v17 offset:20480
v_mfma_f32_16x16x32_bf16 v[132:135], a[224:227], a[180:183], v[132:135]
s_or_b64 s[50:51], s[44:45], s[50:51]
v_mfma_f32_16x16x32_bf16 v[136:139], a[224:227], a[184:187], v[136:139]
s_cbranch_scc1 L_SLOW12
L_BACK12:
v_mfma_f32_16x16x32_bf16 v[140:143], a[224:227], a[188:191], v[140:143]
s_waitcnt lgkmcnt(1)
v_mfma_f32_16x16x32_bf16 v[144:147], a[228:231], a[176:179], v[144:147]
ds_read_b128 a[236:239], v17 offset:22528
v_mfma_f32_16x16x32_bf16 v[148:151], a[228:231], a[180:183], v[148:151]
v_perm_b32 v63, v32, v19, s52
v_mfma_f32_16x16x32_bf16 v[152:155], a[228:231], a[184:187], v[152:155]
ds_read_b32 a192, v63
v_perm_b32 v62, v32, v19, s53
v_mfma_f32_16x16x32_bf16 v[156:159], a[228:231], a[188:191], v[156:159]
s_waitcnt lgkmcnt(2)
ds_read_b32 a193, v62
v_mfma_f32_16x16x32_bf16 v[160:163], a[232:235], a[176:179], v[160:163]
ds_read_b128 a[240:243], v17 offset:24576
v_perm_b32 v61, v36, v19, s52
v_mfma_f32_16x16x32_bf16 v[164:167], a[232:235], a[180:183], v[164:167]
ds_read_b32 a194, v61
v_perm_b32 v60, v36, v19, s53
v_mfma_f32_16x16x32_bf16 v[168:171], a[232:235], a[184:187], v[168:171]
ds_read_b32 a195, v60
v_perm_b32 v59, v32, v19, s54
v_mfma_f32_16x16x32_bf16 v[172:175], a[232:235], a[188:191], v[172:175]
s_waitcnt lgkmcnt(4)
ds_read_b32 a196, v59
buffer_load_dwordx4 v[80:83], v12, s[24:27], 0 offen offset:0 sc1
v_mfma_f32_16x16x32_bf16 v[176:179], a[236:239], a[176:179], v[176:179]
ds_read_b128 a[244:247], v17 offset:26624
v_perm_b32 v58, v32, v19, s55
v_mfma_f32_16x16x32_bf16 v[180:183], a[236:239], a[180:183], v[180:183]
ds_read_b32 a197, v58
v_perm_b32 v57, v36, v19, s54
v_mfma_f32_16x16x32_bf16 v[184:187], a[236:239], a[184:187], v[184:187]
s_add_u32 m0, s33, 101376
ds_read_b32 a198, v57
v_perm_b32 v56, v36, v19, s55
v_mfma_f32_16x16x32_bf16 v[188:191], a[236:239], a[188:191], v[188:191]
s_waitcnt lgkmcnt(4)
ds_read_b32 a199, v56
v_perm_b32 v63, v33, v19, s52
v_mfma_f32_16x16x32_bf16 v[192:195], a[240:243], a[176:179], v[192:195]
ds_read_b128 a[248:251], v17 offset:28672
buffer_load_dwordx4 v9, s[20:23], 0 offen offset:1024 lds
v_mfma_f32_16x16x32_bf16 v[196:199], a[240:243], a[180:183], v[196:199]
ds_read_b32 a200, v63
v_perm_b32 v62, v33, v19, s53
v_mfma_f32_16x16x32_bf16 v[200:203], a[240:243], a[184:187], v[200:203]
ds_read_b32 a201, v62
v_perm_b32 v61, v37, v19, s52
v_mfma_f32_16x16x32_bf16 v[204:207], a[240:243], a[188:191], v[204:207]
s_waitcnt lgkmcnt(4)
ds_read_b32 a202, v61
buffer_load_dwordx4 v[84:87], v12, s[24:27], 0 offen offset:1024 sc1
v_mfma_f32_16x16x32_bf16 v[208:211], a[244:247], a[176:179], v[208:211]
ds_read_b128 a[252:255], v17 offset:30720
v_perm_b32 v60, v37, v19, s53
v_mfma_f32_16x16x32_bf16 v[212:215], a[244:247], a[180:183], v[212:215]
ds_read_b32 a203, v60
v_perm_b32 v59, v33, v19, s54
v_mfma_f32_16x16x32_bf16 v[216:219], a[244:247], a[184:187], v[216:219]
ds_read_b32 a204, v59
v_perm_b32 v58, v33, v19, s55
v_mfma_f32_16x16x32_bf16 v[220:223], a[244:247], a[188:191], v[220:223]
s_waitcnt lgkmcnt(4)
ds_read_b32 a205, v58
v_mfma_f32_16x16x32_bf16 v[224:227], a[248:251], a[176:179], v[224:227]
s_waitcnt vmcnt(14)
s_barrier
ds_read_b128 a[224:227], v14 offset:0
v_perm_b32 v57, v37, v19, s54
v_mfma_f32_16x16x32_bf16 v[228:231], a[248:251], a[180:183], v[228:231]
ds_read_b32 a206, v57
v_perm_b32 v56, v37, v19, s55
v_mfma_f32_16x16x32_bf16 v[232:235], a[248:251], a[184:187], v[232:235]
s_add_u32 m0, s33, 105472
ds_read_b32 a207, v56
v_mfma_f32_16x16x32_bf16 v[236:239], a[248:251], a[188:191], v[236:239]
s_waitcnt lgkmcnt(4)
v_mfma_f32_16x16x32_bf16 v[240:243], a[252:255], a[176:179], v[240:243]
ds_read_b128 a[228:231], v14 offset:2048
buffer_load_dwordx4 v10, s[20:23], 0 offen offset:1024 lds
v_mfma_f32_16x16x32_bf16 v[244:247], a[252:255], a[180:183], v[244:247]
v_mfma_f32_16x16x32_bf16 v[248:251], a[252:255], a[184:187], v[248:251]
v_mfma_f32_16x16x32_bf16 v[252:255], a[252:255], a[188:191], v[252:255]
s_waitcnt vmcnt(13) lgkmcnt(1)
v_cmp_ne_u64 s[50:51], s[88:89], v[42:43]
v_cmp_ne_u64 s[44:45], s[88:89], v[46:47]
v_mfma_f32_16x16x32_bf16 v[128:131], a[224:227], a[192:195], v[128:131]
ds_read_b128 a[232:235], v14 offset:4096
v_mfma_f32_16x16x32_bf16 v[132:135], a[224:227], a[196:199], v[132:135]
s_or_b64 s[50:51], s[44:45], s[50:51]
v_mfma_f32_16x16x32_bf16 v[136:139], a[224:227], a[200:203], v[136:139]
s_cbranch_scc1 L_SLOW13
L_BACK13:
v_mfma_f32_16x16x32_bf16 v[140:143], a[224:227], a[204:207], v[140:143]
s_waitcnt lgkmcnt(1)
buffer_load_dwordx4 v[88:91], v12, s[24:27], 0 offen offset:2048 sc1
v_mfma_f32_16x16x32_bf16 v[144:147], a[228:231], a[192:195], v[144:147]
ds_read_b128 a[236:239], v14 offset:6144
buffer_load_dwordx4 v[92:95], v12, s[24:27], 0 offen offset:3072 sc1
v_mfma_f32_16x16x32_bf16 v[148:151], a[228:231], a[196:199], v[148:151]
v_perm_b32 v63, v40, v19, s52
v_add_u32 v12, 36864, v13
v_mfma_f32_16x16x32_bf16 v[152:155], a[228:231], a[200:203], v[152:155]
s_add_u32 m0, s33, 109440
ds_read_b32 a208, v63
v_perm_b32 v62, v40, v19, s53
v_mfma_f32_16x16x32_bf16 v[156:159], a[228:231], a[204:207], v[156:159]
s_waitcnt lgkmcnt(2)
ds_read_b32 a209, v62
v_perm_b32 v61, v44, v19, s52
v_mfma_f32_16x16x32_bf16 v[160:163], a[232:235], a[192:195], v[160:163]
ds_read_b128 a[240:243], v14 offset:8192
buffer_load_dwordx4 v8, s[20:23], 0 offen offset:1152 lds
v_mfma_f32_16x16x32_bf16 v[164:167], a[232:235], a[196:199], v[164:167]
ds_read_b32 a210, v61
v_perm_b32 v60, v44, v19, s53
v_mfma_f32_16x16x32_bf16 v[168:171], a[232:235], a[200:203], v[168:171]
ds_read_b32 a211, v60
v_perm_b32 v59, v40, v19, s54
v_mfma_f32_16x16x32_bf16 v[172:175], a[232:235], a[204:207], v[172:175]
s_waitcnt lgkmcnt(4)
ds_read_b32 a212, v59
v_mfma_f32_16x16x32_bf16 v[176:179], a[236:239], a[192:195], v[176:179]
ds_read_b128 a[244:247], v14 offset:10240
v_perm_b32 v58, v40, v19, s55
v_mfma_f32_16x16x32_bf16 v[180:183], a[236:239], a[196:199], v[180:183]
ds_read_b32 a213, v58
v_perm_b32 v57, v44, v19, s54
v_mfma_f32_16x16x32_bf16 v[184:187], a[236:239], a[200:203], v[184:187]
ds_read_b32 a214, v57
v_perm_b32 v56, v44, v19, s55
v_mfma_f32_16x16x32_bf16 v[188:191], a[236:239], a[204:207], v[188:191]
s_waitcnt lgkmcnt(4)
ds_read_b32 a215, v56
v_mfma_f32_16x16x32_bf16 v[192:195], a[240:243], a[192:195], v[192:195]
ds_read_b128 a[248:251], v14 offset:12288
v_perm_b32 v63, v41, v19, s52
v_mfma_f32_16x16x32_bf16 v[196:199], a[240:243], a[196:199], v[196:199]
ds_read_b32 a216, v63
v_perm_b32 v62, v41, v19, s53
v_mfma_f32_16x16x32_bf16 v[200:203], a[240:243], a[200:203], v[200:203]
s_add_u32 m0, s33, 113536
ds_read_b32 a217, v62
v_perm_b32 v61, v45, v19, s52
v_mfma_f32_16x16x32_bf16 v[204:207], a[240:243], a[204:207], v[204:207]
s_waitcnt lgkmcnt(4)
ds_read_b32 a218, v61
v_perm_b32 v60, v45, v19, s53
v_mfma_f32_16x16x32_bf16 v[208:211], a[244:247], a[192:195], v[208:211]
ds_read_b128 a[252:255], v14 offset:14336
buffer_load_dwordx4 v9, s[20:23], 0 offen offset:1152 lds
v_mfma_f32_16x16x32_bf16 v[212:215], a[244:247], a[196:199], v[212:215]
ds_read_b32 a219, v60
v_perm_b32 v59, v41, v19, s54
v_mfma_f32_16x16x32_bf16 v[216:219], a[244:247], a[200:203], v[216:219]
ds_read_b32 a220, v59
v_perm_b32 v58, v41, v19, s55
v_mfma_f32_16x16x32_bf16 v[220:223], a[244:247], a[204:207], v[220:223]
s_waitcnt lgkmcnt(4)
ds_read_b32 a221, v58
v_mfma_f32_16x16x32_bf16 v[224:227], a[248:251], a[192:195], v[224:227]
ds_read_b128 a[224:227], v15 offset:0
v_perm_b32 v57, v45, v19, s54
v_mfma_f32_16x16x32_bf16 v[228:231], a[248:251], a[196:199], v[228:231]
ds_read_b32 a222, v57
v_perm_b32 v56, v45, v19, s55
v_mfma_f32_16x16x32_bf16 v[232:235], a[248:251], a[200:203], v[232:235]
ds_read_b32 a223, v56
v_mfma_f32_16x16x32_bf16 v[236:239], a[248:251], a[204:207], v[236:239]
s_waitcnt lgkmcnt(4)
buffer_load_dwordx4 v[32:35], v12, s[24:27], 0 offen offset:0 sc1
v_mfma_f32_16x16x32_bf16 v[240:243], a[252:255], a[192:195], v[240:243]
ds_read_b128 a[228:231], v15 offset:2048
buffer_load_dwordx4 v[36:39], v12, s[24:27], 0 offen offset:1024 sc1
v_mfma_f32_16x16x32_bf16 v[244:247], a[252:255], a[196:199], v[244:247]
v_mfma_f32_16x16x32_bf16 v[248:251], a[252:255], a[200:203], v[248:251]
s_waitcnt vmcnt(15)
v_cmp_ne_u64 s[50:51], s[88:89], v[50:51]
v_cmp_ne_u64 s[44:45], s[88:89], v[54:55]
v_mfma_f32_16x16x32_bf16 v[252:255], a[252:255], a[204:207], v[252:255]
s_waitcnt lgkmcnt(1)
v_mfma_f32_16x16x32_bf16 v[128:131], a[224:227], a[208:211], v[128:131]
s_or_b64 s[50:51], s[44:45], s[50:51]
ds_read_b128 a[232:235], v15 offset:4096
v_mfma_f32_16x16x32_bf16 v[132:135], a[224:227], a[212:215], v[132:135]
s_cbranch_scc1 L_SLOW14
L_BACK14:
v_mfma_f32_16x16x32_bf16 v[136:139], a[224:227], a[216:219], v[136:139]
v_perm_b32 v63, v48, v19, s52
v_mfma_f32_16x16x32_bf16 v[140:143], a[224:227], a[220:223], v[140:143]
s_waitcnt lgkmcnt(1)
ds_read_b32 a0, v63
v_mfma_f32_16x16x32_bf16 v[144:147], a[228:231], a[208:211], v[144:147]
ds_read_b128 a[236:239], v15 offset:6144
v_perm_b32 v62, v48, v19, s53
v_mfma_f32_16x16x32_bf16 v[148:151], a[228:231], a[212:215], v[148:151]
ds_read_b32 a1, v62
v_perm_b32 v61, v52, v19, s52
v_mfma_f32_16x16x32_bf16 v[152:155], a[228:231], a[216:219], v[152:155]
ds_read_b32 a2, v61
v_perm_b32 v60, v52, v19, s53
v_mfma_f32_16x16x32_bf16 v[156:159], a[228:231], a[220:223], v[156:159]
s_waitcnt lgkmcnt(4)
ds_read_b32 a3, v60
v_mfma_f32_16x16x32_bf16 v[160:163], a[232:235], a[208:211], v[160:163]
ds_read_b128 a[240:243], v15 offset:8192
v_perm_b32 v59, v48, v19, s54
v_mfma_f32_16x16x32_bf16 v[164:167], a[232:235], a[212:215], v[164:167]
ds_read_b32 a4, v59
v_perm_b32 v58, v48, v19, s55
v_mfma_f32_16x16x32_bf16 v[168:171], a[232:235], a[216:219], v[168:171]
ds_read_b32 a5, v58
v_perm_b32 v57, v52, v19, s54
v_mfma_f32_16x16x32_bf16 v[172:175], a[232:235], a[220:223], v[172:175]
s_waitcnt lgkmcnt(4)
ds_read_b32 a6, v57
v_mfma_f32_16x16x32_bf16 v[176:179], a[236:239], a[208:211], v[176:179]
ds_read_b128 a[244:247], v15 offset:10240
v_perm_b32 v56, v52, v19, s55
v_mfma_f32_16x16x32_bf16 v[180:183], a[236:239], a[212:215], v[180:183]
ds_read_b32 a7, v56
v_perm_b32 v63, v49, v19, s52
v_mfma_f32_16x16x32_bf16 v[184:187], a[236:239], a[216:219], v[184:187]
s_add_u32 m0, s33, 117760
ds_read_b32 a8, v63
v_perm_b32 v62, v49, v19, s53
v_mfma_f32_16x16x32_bf16 v[188:191], a[236:239], a[220:223], v[188:191]
s_waitcnt lgkmcnt(4)
ds_read_b32 a9, v62
v_perm_b32 v61, v53, v19, s52
v_mfma_f32_16x16x32_bf16 v[192:195], a[240:243], a[208:211], v[192:195]
ds_read_b128 a[248:251], v15 offset:12288
buffer_load_dwordx4 v11, s[20:23], 0 offen offset:1024 lds
v_mfma_f32_16x16x32_bf16 v[196:199], a[240:243], a[212:215], v[196:199]
ds_read_b32 a10, v61
v_perm_b32 v60, v53, v19, s53
v_mfma_f32_16x16x32_bf16 v[200:203], a[240:243], a[216:219], v[200:203]
ds_read_b32 a11, v60
v_mfma_f32_16x16x32_bf16 v[204:207], a[240:243], a[220:223], v[204:207]
s_waitcnt vmcnt(11) lgkmcnt(4)
v_perm_b32 v59, v49, v19, s54
v_cmp_ne_u64 s[50:51], s[88:89], v[98:99]
v_mfma_f32_16x16x32_bf16 v[208:211], a[244:247], a[208:211], v[208:211]
ds_read_b128 a[252:255], v15 offset:14336
v_cmp_ne_u64 s[44:45], s[88:89], v[102:103]
v_mfma_f32_16x16x32_bf16 v[212:215], a[244:247], a[212:215], v[212:215]
ds_read_b32 a12, v59
v_perm_b32 v58, v49, v19, s55
v_mfma_f32_16x16x32_bf16 v[216:219], a[244:247], a[216:219], v[216:219]
s_or_b64 s[50:51], s[44:45], s[50:51]
ds_read_b32 a13, v58
v_perm_b32 v57, v53, v19, s54
v_mfma_f32_16x16x32_bf16 v[220:223], a[244:247], a[220:223], v[220:223]
s_waitcnt lgkmcnt(3)
ds_read_b32 a14, v57
buffer_load_dwordx4 v[40:43], v12, s[24:27], 0 offen offset:2048 sc1
v_mfma_f32_16x16x32_bf16 v[224:227], a[248:251], a[208:211], v[224:227]
s_barrier
ds_read_b128 a[224:227], v14 offset:16384
v_perm_b32 v56, v53, v19, s55
v_mfma_f32_16x16x32_bf16 v[228:231], a[248:251], a[212:215], v[228:231]
s_cbranch_scc1 L_SLOW15
L_BACK15:
v_mfma_f32_16x16x32_bf16 v[232:235], a[248:251], a[216:219], v[232:235]
s_add_u32 m0, s33, 121600
ds_read_b32 a15, v56
v_perm_b32 v63, v96, v19, s52
v_mfma_f32_16x16x32_bf16 v[236:239], a[248:251], a[220:223], v[236:239]
s_waitcnt lgkmcnt(3)
ds_read_b32 a16, v63
v_perm_b32 v62, v96, v19, s53
v_mfma_f32_16x16x32_bf16 v[240:243], a[252:255], a[208:211], v[240:243]
ds_read_b128 a[228:231], v14 offset:18432
buffer_load_dwordx4 v8, s[20:23], 0 offen offset:1280 lds
v_mfma_f32_16x16x32_bf16 v[244:247], a[252:255], a[212:215], v[244:247]
ds_read_b32 a17, v62
v_perm_b32 v61, v100, v19, s52
v_mfma_f32_16x16x32_bf16 v[248:251], a[252:255], a[216:219], v[248:251]
ds_read_b32 a18, v61
v_perm_b32 v60, v100, v19, s53
v_mfma_f32_16x16x32_bf16 v[252:255], a[252:255], a[220:223], v[252:255]
s_waitcnt lgkmcnt(4)
ds_read_b32 a19, v60
buffer_load_dwordx4 v[44:47], v12, s[24:27], 0 offen offset:3072 sc1
v_mfma_f32_16x16x32_bf16 v[128:131], a[224:227], a[0:3], v[128:131]
ds_read_b128 a[232:235], v14 offset:20480
v_perm_b32 v59, v96, v19, s54
v_mfma_f32_16x16x32_bf16 v[132:135], a[224:227], a[4:7], v[132:135]
ds_read_b32 a20, v59
v_perm_b32 v58, v96, v19, s55
v_mfma_f32_16x16x32_bf16 v[136:139], a[224:227], a[8:11], v[136:139]
ds_read_b32 a21, v58
v_perm_b32 v57, v100, v19, s54
v_mfma_f32_16x16x32_bf16 v[140:143], a[224:227], a[12:15], v[140:143]
s_waitcnt lgkmcnt(4)
ds_read_b32 a22, v57
v_add_u32 v12, 40960, v13
v_mfma_f32_16x16x32_bf16 v[144:147], a[228:231], a[0:3], v[144:147]
ds_read_b128 a[236:239], v14 offset:22528
v_perm_b32 v56, v100, v19, s55
v_mfma_f32_16x16x32_bf16 v[148:151], a[228:231], a[4:7], v[148:151]
ds_read_b32 a23, v56
v_perm_b32 v63, v97, v19, s52
v_mfma_f32_16x16x32_bf16 v[152:155], a[228:231], a[8:11], v[152:155]
s_add_u32 m0, s33, 125824
ds_read_b32 a24, v63
v_perm_b32 v62, v97, v19, s53
v_mfma_f32_16x16x32_bf16 v[156:159], a[228:231], a[12:15], v[156:159]
s_waitcnt lgkmcnt(4)
ds_read_b32 a25, v62
v_perm_b32 v61, v101, v19, s52
v_mfma_f32_16x16x32_bf16 v[160:163], a[232:235], a[0:3], v[160:163]
ds_read_b128 a[240:243], v14 offset:24576
buffer_load_dwordx4 v10, s[20:23], 0 offen offset:1152 lds
v_mfma_f32_16x16x32_bf16 v[164:167], a[232:235], a[4:7], v[164:167]
ds_read_b32 a26, v61
v_perm_b32 v60, v101, v19, s53
v_mfma_f32_16x16x32_bf16 v[168:171], a[232:235], a[8:11], v[168:171]
ds_read_b32 a27, v60
v_perm_b32 v59, v97, v19, s54
v_mfma_f32_16x16x32_bf16 v[172:175], a[232:235], a[12:15], v[172:175]
s_waitcnt lgkmcnt(4)
ds_read_b32 a28, v59
buffer_load_dwordx4 v[48:51], v12, s[24:27], 0 offen offset:0 sc1
v_mfma_f32_16x16x32_bf16 v[176:179], a[236:239], a[0:3], v[176:179]
ds_read_b128 a[244:247], v14 offset:26624
v_perm_b32 v58, v97, v19, s55
v_mfma_f32_16x16x32_bf16 v[180:183], a[236:239], a[4:7], v[180:183]
ds_read_b32 a29, v58
v_perm_b32 v57, v101, v19, s54
v_mfma_f32_16x16x32_bf16 v[184:187], a[236:239], a[8:11], v[184:187]
s_waitcnt vmcnt(13)
v_cmp_ne_u64 s[50:51], s[88:89], v[82:83]
v_cmp_ne_u64 s[44:45], s[88:89], v[86:87]
v_mfma_f32_16x16x32_bf16 v[188:191], a[236:239], a[12:15], v[188:191]
s_waitcnt lgkmcnt(3)
ds_read_b32 a30, v57
buffer_load_dwordx4 v[52:55], v12, s[24:27], 0 offen offset:1024 sc1
v_mfma_f32_16x16x32_bf16 v[192:195], a[240:243], a[0:3], v[192:195]
s_or_b64 s[50:51], s[44:45], s[50:51]
ds_read_b128 a[248:251], v15 offset:16384
v_perm_b32 v56, v101, v19, s55
v_mfma_f32_16x16x32_bf16 v[196:199], a[240:243], a[4:7], v[196:199]
s_cbranch_scc1 L_SLOW16
L_BACK16:
v_mfma_f32_16x16x32_bf16 v[200:203], a[240:243], a[8:11], v[200:203]
s_add_u32 m0, s33, 129792
ds_read_b32 a31, v56
v_perm_b32 v63, v80, v19, s52
v_mfma_f32_16x16x32_bf16 v[204:207], a[240:243], a[12:15], v[204:207]
s_waitcnt lgkmcnt(3)
ds_read_b32 a32, v63
v_perm_b32 v62, v80, v19, s53
v_mfma_f32_16x16x32_bf16 v[208:211], a[244:247], a[0:3], v[208:211]
ds_read_b128 a[252:255], v15 offset:18432
buffer_load_dwordx4 v9, s[20:23], 0 offen offset:1280 lds
v_mfma_f32_16x16x32_bf16 v[212:215], a[244:247], a[4:7], v[212:215]
ds_read_b32 a33, v62
v_perm_b32 v61, v84, v19, s52
v_mfma_f32_16x16x32_bf16 v[216:219], a[244:247], a[8:11], v[216:219]
ds_read_b32 a34, v61
v_perm_b32 v60, v84, v19, s53
v_mfma_f32_16x16x32_bf16 v[220:223], a[244:247], a[12:15], v[220:223]
s_waitcnt lgkmcnt(4)
ds_read_b32 a35, v60
v_mfma_f32_16x16x32_bf16 v[128:131], a[248:251], a[16:19], v[128:131]
ds_read_b128 a[224:227], v15 offset:20480
v_perm_b32 v59, v80, v19, s54
v_mfma_f32_16x16x32_bf16 v[132:135], a[248:251], a[20:23], v[132:135]
ds_read_b32 a36, v59
v_perm_b32 v58, v80, v19, s55
v_mfma_f32_16x16x32_bf16 v[136:139], a[248:251], a[24:27], v[136:139]
ds_read_b32 a37, v58
v_perm_b32 v57, v84, v19, s54
v_mfma_f32_16x16x32_bf16 v[140:143], a[248:251], a[28:31], v[140:143]
s_waitcnt lgkmcnt(4)
ds_read_b32 a38, v57
v_mfma_f32_16x16x32_bf16 v[144:147], a[252:255], a[16:19], v[144:147]
ds_read_b128 a[228:231], v15 offset:22528
v_perm_b32 v56, v84, v19, s55
v_mfma_f32_16x16x32_bf16 v[148:151], a[252:255], a[20:23], v[148:151]
ds_read_b32 a39, v56
v_perm_b32 v63, v81, v19, s52
v_mfma_f32_16x16x32_bf16 v[152:155], a[252:255], a[24:27], v[152:155]
ds_read_b32 a40, v63
v_perm_b32 v62, v81, v19, s53
v_mfma_f32_16x16x32_bf16 v[156:159], a[252:255], a[28:31], v[156:159]
s_waitcnt lgkmcnt(4)
ds_read_b32 a41, v62
v_mfma_f32_16x16x32_bf16 v[160:163], a[224:227], a[16:19], v[160:163]
ds_read_b128 a[232:235], v14 offset:28672
v_perm_b32 v61, v85, v19, s52
v_mfma_f32_16x16x32_bf16 v[164:167], a[224:227], a[20:23], v[164:167]
ds_read_b32 a42, v61
v_perm_b32 v60, v85, v19, s53
v_mfma_f32_16x16x32_bf16 v[168:171], a[224:227], a[24:27], v[168:171]
s_add_u32 m0, s33, 133760
ds_read_b32 a43, v60
v_perm_b32 v59, v81, v19, s54
v_mfma_f32_16x16x32_bf16 v[172:175], a[224:227], a[28:31], v[172:175]
s_waitcnt lgkmcnt(4)
ds_read_b32 a44, v59
v_perm_b32 v58, v81, v19, s55
v_mfma_f32_16x16x32_bf16 v[176:179], a[228:231], a[16:19], v[176:179]
ds_read_b128 a[236:239], v14 offset:30720
buffer_load_dwordx4 v8, s[20:23], 0 offen offset:1408 lds
v_mfma_f32_16x16x32_bf16 v[180:183], a[228:231], a[20:23], v[180:183]
ds_read_b32 a45, v58
v_perm_b32 v57, v85, v19, s54
v_mfma_f32_16x16x32_bf16 v[184:187], a[228:231], a[24:27], v[184:187]
s_waitcnt vmcnt(13)
v_cmp_ne_u64 s[50:51], s[88:89], v[90:91]
v_cmp_ne_u64 s[44:45], s[88:89], v[94:95]
v_mfma_f32_16x16x32_bf16 v[188:191], a[228:231], a[28:31], v[188:191]
s_waitcnt lgkmcnt(3)
ds_read_b32 a46, v57
v_mfma_f32_16x16x32_bf16 v[224:227], a[232:235], a[0:3], v[224:227]
s_or_b64 s[50:51], s[44:45], s[50:51]
ds_read_b128 a[240:243], v14 offset:32768
v_perm_b32 v56, v85, v19, s55
v_mfma_f32_16x16x32_bf16 v[228:231], a[232:235], a[4:7], v[228:231]
s_cbranch_scc1 L_SLOW17
L_BACK17:
v_mfma_f32_16x16x32_bf16 v[232:235], a[232:235], a[8:11], v[232:235]
ds_read_b32 a47, v56
v_perm_b32 v63, v88, v19, s52
v_mfma_f32_16x16x32_bf16 v[236:239], a[232:235], a[12:15], v[236:239]
s_waitcnt lgkmcnt(3)
ds_read_b32 a48, v63
buffer_load_dwordx4 v[96:99], v12, s[24:27], 0 offen offset:2048 sc1
v_mfma_f32_16x16x32_bf16 v[240:243], a[236:239], a[0:3], v[240:243]
ds_read_b128 a[244:247], v14 offset:34816
v_perm_b32 v62, v88, v19, s53
v_mfma_f32_16x16x32_bf16 v[244:247], a[236:239], a[4:7], v[244:247]
ds_read_b32 a49, v62
v_perm_b32 v61, v92, v19, s52
v_mfma_f32_16x16x32_bf16 v[248:251], a[236:239], a[8:11], v[248:251]
s_add_u32 m0, s33, 138112
ds_read_b32 a50, v61
v_perm_b32 v60, v92, v19, s53
v_mfma_f32_16x16x32_bf16 v[252:255], a[236:239], a[12:15], v[252:255]
s_waitcnt lgkmcnt(4)
ds_read_b32 a51, v60
v_perm_b32 v59, v88, v19, s54
v_mfma_f32_16x16x32_bf16 v[128:131], a[240:243], a[32:35], v[128:131]
ds_read_b128 a[248:251], v15 offset:24576
buffer_load_dwordx4 v11, s[20:23], 0 offen offset:1152 lds
v_mfma_f32_16x16x32_bf16 v[132:135], a[240:243], a[36:39], v[132:135]
ds_read_b32 a52, v59
v_perm_b32 v58, v88, v19, s55
v_mfma_f32_16x16x32_bf16 v[136:139], a[240:243], a[40:43], v[136:139]
ds_read_b32 a53, v58
v_perm_b32 v57, v92, v19, s54
v_mfma_f32_16x16x32_bf16 v[140:143], a[240:243], a[44:47], v[140:143]
s_waitcnt lgkmcnt(4)
ds_read_b32 a54, v57
buffer_load_dwordx4 v[100:103], v12, s[24:27], 0 offen offset:3072 sc1
v_mfma_f32_16x16x32_bf16 v[144:147], a[244:247], a[32:35], v[144:147]
ds_read_b128 a[252:255], v15 offset:26624
v_perm_b32 v56, v92, v19, s55
v_mfma_f32_16x16x32_bf16 v[148:151], a[244:247], a[36:39], v[148:151]
ds_read_b32 a55, v56
v_perm_b32 v63, v89, v19, s52
v_mfma_f32_16x16x32_bf16 v[152:155], a[244:247], a[40:43], v[152:155]
ds_read_b32 a56, v63
v_perm_b32 v62, v89, v19, s53
v_mfma_f32_16x16x32_bf16 v[156:159], a[244:247], a[44:47], v[156:159]
s_waitcnt lgkmcnt(4)
ds_read_b32 a57, v62
v_add_u32 v12, 45056, v13
v_mfma_f32_16x16x32_bf16 v[192:195], a[248:251], a[16:19], v[192:195]
s_waitcnt vmcnt(14)
s_barrier
ds_read_b128 a[224:227], v14 offset:36864
v_perm_b32 v61, v93, v19, s52
v_mfma_f32_16x16x32_bf16 v[196:199], a[248:251], a[20:23], v[196:199]
ds_read_b32 a58, v61
v_perm_b32 v60, v93, v19, s53
v_mfma_f32_16x16x32_bf16 v[200:203], a[248:251], a[24:27], v[200:203]
s_add_u32 m0, s33, 142080
ds_read_b32 a59, v60
v_perm_b32 v59, v89, v19, s54
v_mfma_f32_16x16x32_bf16 v[204:207], a[248:251], a[28:31], v[204:207]
s_waitcnt lgkmcnt(4)
ds_read_b32 a60, v59
v_perm_b32 v58, v89, v19, s55
v_mfma_f32_16x16x32_bf16 v[208:211], a[252:255], a[16:19], v[208:211]
ds_read_b128 a[228:231], v14 offset:38912
buffer_load_dwordx4 v10, s[20:23], 0 offen offset:1280 lds
v_mfma_f32_16x16x32_bf16 v[212:215], a[252:255], a[20:23], v[212:215]
ds_read_b32 a61, v58
v_perm_b32 v57, v93, v19, s54
v_mfma_f32_16x16x32_bf16 v[216:219], a[252:255], a[24:27], v[216:219]
ds_read_b32 a62, v57
v_mfma_f32_16x16x32_bf16 v[220:223], a[252:255], a[28:31], v[220:223]
s_waitcnt vmcnt(13) lgkmcnt(4)
v_cmp_ne_u64 s[50:51], s[88:89], v[34:35]
v_cmp_ne_u64 s[44:45], s[88:89], v[38:39]
v_mfma_f32_16x16x32_bf16 v[160:163], a[224:227], a[32:35], v[160:163]
ds_read_b128 a[232:235], v15 offset:32768
v_perm_b32 v56, v93, v19, s55
v_mfma_f32_16x16x32_bf16 v[164:167], a[224:227], a[36:39], v[164:167]
s_or_b64 s[50:51], s[44:45], s[50:51]
ds_read_b32 a63, v56
v_mfma_f32_16x16x32_bf16 v[168:171], a[224:227], a[40:43], v[168:171]
s_cbranch_scc1 L_SLOW18
L_BACK18:
v_mfma_f32_16x16x32_bf16 v[172:175], a[224:227], a[44:47], v[172:175]
s_waitcnt lgkmcnt(2)
buffer_load_dwordx4 v[80:83], v12, s[24:27], 0 offen offset:0 sc1
v_mfma_f32_16x16x32_bf16 v[176:179], a[228:231], a[32:35], v[176:179]
ds_read_b128 a[236:239], v15 offset:34816
buffer_load_dwordx4 v[84:87], v12, s[24:27], 0 offen offset:1024 sc1
v_mfma_f32_16x16x32_bf16 v[180:183], a[228:231], a[36:39], v[180:183]
v_perm_b32 v63, v32, v19, s52
v_mfma_f32_16x16x32_bf16 v[184:187], a[228:231], a[40:43], v[184:187]
s_add_u32 m0, s33, 146048
ds_read_b32 a64, v63
v_perm_b32 v62, v32, v19, s53
v_mfma_f32_16x16x32_bf16 v[188:191], a[228:231], a[44:47], v[188:191]
s_waitcnt lgkmcnt(2)
ds_read_b32 a65, v62
v_perm_b32 v61, v36, v19, s52
v_mfma_f32_16x16x32_bf16 v[128:131], a[232:235], a[48:51], v[128:131]
ds_read_b128 a[240:243], v15 offset:28672
buffer_load_dwordx4 v9, s[20:23], 0 offen offset:1408 lds
v_mfma_f32_16x16x32_bf16 v[132:135], a[232:235], a[52:55], v[132:135]
ds_read_b32 a66, v61
v_perm_b32 v60, v36, v19, s53
v_mfma_f32_16x16x32_bf16 v[136:139], a[232:235], a[56:59], v[136:139]
ds_read_b32 a67, v60
v_perm_b32 v59, v32, v19, s54
v_mfma_f32_16x16x32_bf16 v[140:143], a[232:235], a[60:63], v[140:143]
s_waitcnt lgkmcnt(4)
ds_read_b32 a68, v59
v_mfma_f32_16x16x32_bf16 v[144:147], a[236:239], a[48:51], v[144:147]
ds_read_b128 a[244:247], v15 offset:30720
v_perm_b32 v58, v32, v19, s55
v_mfma_f32_16x16x32_bf16 v[148:151], a[236:239], a[52:55], v[148:151]
ds_read_b32 a69, v58
v_perm_b32 v57, v36, v19, s54
v_mfma_f32_16x16x32_bf16 v[152:155], a[236:239], a[56:59], v[152:155]
L_PAD3:
s_cbranch_vccnz L_PADRET
ds_read_b32 a70, v57
v_perm_b32 v56, v36, v19, s55
v_mfma_f32_16x16x32_bf16 v[156:159], a[236:239], a[60:63], v[156:159]
s_waitcnt lgkmcnt(4)
ds_read_b32 a71, v56
v_mfma_f32_16x16x32_bf16 v[224:227], a[240:243], a[16:19], v[224:227]
ds_read_b128 a[248:251], v14 offset:40960
v_perm_b32 v63, v33, v19, s52
v_mfma_f32_16x16x32_bf16 v[228:231], a[240:243], a[20:23], v[228:231]
ds_read_b32 a72, v63
v_perm_b32 v62, v33, v19, s53
v_mfma_f32_16x16x32_bf16 v[232:235], a[240:243], a[24:27], v[232:235]
s_add_u32 m0, s33, 150016
ds_read_b32 a73, v62
v_perm_b32 v61, v37, v19, s52
v_mfma_f32_16x16x32_bf16 v[236:239], a[240:243], a[28:31], v[236:239]
s_waitcnt lgkmcnt(4)
ds_read_b32 a74, v61
v_perm_b32 v60, v37, v19, s53
v_mfma_f32_16x16x32_bf16 v[240:243], a[244:247], a[16:19], v[240:243]
ds_read_b128 a[252:255], v14 offset:43008
buffer_load_dwordx4 v8, s[20:23], 0 offen offset:1536 lds
v_mfma_f32_16x16x32_bf16 v[244:247], a[244:247], a[20:23], v[244:247]
ds_read_b32 a75, v60
v_perm_b32 v59, v33, v19, s54
v_mfma_f32_16x16x32_bf16 v[248:251], a[244:247], a[24:27], v[248:251]
ds_read_b32 a76, v59
v_mfma_f32_16x16x32_bf16 v[252:255], a[244:247], a[28:31], v[252:255]
s_waitcnt vmcnt(13) lgkmcnt(4)
v_cmp_ne_u64 s[50:51], s[88:89], v[42:43]
v_cmp_ne_u64 s[44:45], s[88:89], v[46:47]
v_mfma_f32_16x16x32_bf16 v[192:195], a[248:251], a[32:35], v[192:195]
ds_read_b128 a[224:227], v15 offset:36864
v_perm_b32 v58, v33, v19, s55
v_mfma_f32_16x16x32_bf16 v[196:199], a[248:251], a[36:39], v[196:199]
s_or_b64 s[50:51], s[44:45], s[50:51]
ds_read_b32 a77, v58
v_perm_b32 v57, v37, v19, s54
v_mfma_f32_16x16x32_bf16 v[200:203], a[248:251], a[40:43], v[200:203]
s_cbranch_scc1 L_SLOW19
L_BACK19:
v_mfma_f32_16x16x32_bf16 v[204:207], a[248:251], a[44:47], v[204:207]
s_waitcnt lgkmcnt(2)
ds_read_b32 a78, v57
buffer_load_dwordx4 v[88:91], v12, s[24:27], 0 offen offset:2048 sc1
v_mfma_f32_16x16x32_bf16 v[208:211], a[252:255], a[32:35], v[208:211]
ds_read_b128 a[228:231], v15 offset:38912
v_perm_b32 v56, v37, v19, s55
v_mfma_f32_16x16x32_bf16 v[212:215], a[252:255], a[36:39], v[212:215]
ds_read_b32 a79, v56
v_perm_b32 v63, v40, v19, s52
v_mfma_f32_16x16x32_bf16 v[216:219], a[252:255], a[40:43], v[216:219]
ds_read_b32 a80, v63
v_perm_b32 v62, v40, v19, s53
v_mfma_f32_16x16x32_bf16 v[220:223], a[252:255], a[44:47], v[220:223]
s_waitcnt lgkmcnt(4)
ds_read_b32 a81, v62
buffer_load_dwordx4 v[92:95], v12, s[24:27], 0 offen offset:3072 sc1
v_mfma_f32_16x16x32_bf16 v[160:163], a[224:227], a[48:51], v[160:163]
ds_read_b128 a[232:235], v14 offset:45056
v_perm_b32 v61, v44, v19, s52
v_mfma_f32_16x16x32_bf16 v[164:167], a[224:227], a[52:55], v[164:167]
ds_read_b32 a82, v61
v_perm_b32 v60, v44, v19, s53
v_mfma_f32_16x16x32_bf16 v[168:171], a[224:227], a[56:59], v[168:171]
ds_read_b32 a83, v60
v_perm_b32 v59, v40, v19, s54
v_mfma_f32_16x16x32_bf16 v[172:175], a[224:227], a[60:63], v[172:175]
s_waitcnt lgkmcnt(4)
ds_read_b32 a84, v59
v_add_u32 v12, 49152, v13
v_mfma_f32_16x16x32_bf16 v[176:179], a[228:231], a[48:51], v[176:179]
ds_read_b128 a[236:239], v14 offset:47104
v_perm_b32 v58, v40, v19, s55
v_mfma_f32_16x16x32_bf16 v[180:183], a[228:231], a[52:55], v[180:183]
ds_read_b32 a85, v58
v_perm_b32 v57, v44, v19, s54
v_mfma_f32_16x16x32_bf16 v[184:187], a[228:231], a[56:59], v[184:187]
ds_read_b32 a86, v57
v_perm_b32 v56, v44, v19, s55
v_mfma_f32_16x16x32_bf16 v[188:191], a[228:231], a[60:63], v[188:191]
s_waitcnt lgkmcnt(4)
ds_read_b32 a87, v56
v_mfma_f32_16x16x32_bf16 v[128:131], a[232:235], a[64:67], v[128:131]
ds_read_b128 a[240:243], v15 offset:40960
v_perm_b32 v63, v41, v19, s52
v_mfma_f32_16x16x32_bf16 v[132:135], a[232:235], a[68:71], v[132:135]
ds_read_b32 a88, v63
v_perm_b32 v62, v41, v19, s53
v_mfma_f32_16x16x32_bf16 v[136:139], a[232:235], a[72:75], v[136:139]
ds_read_b32 a89, v62
v_perm_b32 v61, v45, v19, s52
v_mfma_f32_16x16x32_bf16 v[140:143], a[232:235], a[76:79], v[140:143]
s_waitcnt lgkmcnt(4)
ds_read_b32 a90, v61
v_mfma_f32_16x16x32_bf16 v[144:147], a[236:239], a[64:67], v[144:147]
ds_read_b128 a[244:247], v15 offset:43008
v_perm_b32 v60, v45, v19, s53
v_mfma_f32_16x16x32_bf16 v[148:151], a[236:239], a[68:71], v[148:151]
ds_read_b32 a91, v60
v_perm_b32 v59, v41, v19, s54
v_mfma_f32_16x16x32_bf16 v[152:155], a[236:239], a[72:75], v[152:155]
s_add_u32 m0, s33, 154240
ds_read_b32 a92, v59
v_perm_b32 v58, v41, v19, s55
v_mfma_f32_16x16x32_bf16 v[156:159], a[236:239], a[76:79], v[156:159]
s_waitcnt vmcnt(12) lgkmcnt(4)
v_cmp_ne_u64 s[50:51], s[88:89], v[50:51]
v_cmp_ne_u64 s[44:45], s[88:89], v[54:55]
v_mfma_f32_16x16x32_bf16 v[192:195], a[240:243], a[48:51], v[192:195]
ds_read_b128 a[248:251], v14 offset:49152
buffer_load_dwordx4 v10, s[20:23], 0 offen offset:1408 lds
v_mfma_f32_16x16x32_bf16 v[196:199], a[240:243], a[52:55], v[196:199]
s_or_b64 s[50:51], s[44:45], s[50:51]
ds_read_b32 a93, v58
v_perm_b32 v57, v45, v19, s54
v_mfma_f32_16x16x32_bf16 v[200:203], a[240:243], a[56:59], v[200:203]
s_cbranch_scc1 L_SLOW20
L_BACK20:
v_mfma_f32_16x16x32_bf16 v[204:207], a[240:243], a[60:63], v[204:207]
s_waitcnt lgkmcnt(2)
ds_read_b32 a94, v57
buffer_load_dwordx4 v[32:35], v12, s[24:27], 0 offen offset:0 sc1
v_mfma_f32_16x16x32_bf16 v[208:211], a[244:247], a[48:51], v[208:211]
ds_read_b128 a[252:255], v14 offset:51200
v_perm_b32 v56, v45, v19, s55
v_mfma_f32_16x16x32_bf16 v[212:215], a[244:247], a[52:55], v[212:215]
ds_read_b32 a95, v56
v_perm_b32 v63, v48, v19, s52
v_mfma_f32_16x16x32_bf16 v[216:219], a[244:247], a[56:59], v[216:219]
ds_read_b32 a96, v63
v_perm_b32 v62, v48, v19, s53
v_mfma_f32_16x16x32_bf16 v[220:223], a[244:247], a[60:63], v[220:223]
s_waitcnt lgkmcnt(4)
ds_read_b32 a97, v62
buffer_load_dwordx4 v[36:39], v12, s[24:27], 0 offen offset:1024 sc1
v_mfma_f32_16x16x32_bf16 v[160:163], a[248:251], a[64:67], v[160:163]
s_waitcnt vmcnt(14)
s_barrier
ds_read_b128 a[224:227], v14 offset:53248
v_perm_b32 v61, v52, v19, s52
v_mfma_f32_16x16x32_bf16 v[164:167], a[248:251], a[68:71], v[164:167]
ds_read_b32 a98, v61
v_perm_b32 v60, v52, v19, s53
v_mfma_f32_16x16x32_bf16 v[168:171], a[248:251], a[72:75], v[168:171]
s_add_u32 m0, s33, 158208
ds_read_b32 a99, v60
v_perm_b32 v59, v48, v19, s54
v_mfma_f32_16x16x32_bf16 v[172:175], a[248:251], a[76:79], v[172:175]
s_waitcnt lgkmcnt(4)
ds_read_b32 a100, v59
v_perm_b32 v58, v48, v19, s55
v_mfma_f32_16x16x32_bf16 v[176:179], a[252:255], a[64:67], v[176:179]
ds_read_b128 a[228:231], v14 offset:55296
buffer_load_dwordx4 v9, s[20:23], 0 offen offset:1536 lds
v_mfma_f32_16x16x32_bf16 v[180:183], a[252:255], a[68:71], v[180:183]
ds_read_b32 a101, v58
v_perm_b32 v57, v52, v19, s54
v_mfma_f32_16x16x32_bf16 v[184:187], a[252:255], a[72:75], v[184:187]
ds_read_b32 a102, v57
v_perm_b32 v56, v52, v19, s55
v_mfma_f32_16x16x32_bf16 v[188:191], a[252:255], a[76:79], v[188:191]
s_waitcnt lgkmcnt(4)
ds_read_b32 a103, v56
v_mfma_f32_16x16x32_bf16 v[224:227], a[224:227], a[32:35], v[224:227]
ds_read_b128 a[232:235], v15 offset:45056
v_perm_b32 v63, v49, v19, s52
v_mfma_f32_16x16x32_bf16 v[228:231], a[224:227], a[36:39], v[228:231]
ds_read_b32 a104, v63
v_perm_b32 v62, v49, v19, s53
v_mfma_f32_16x16x32_bf16 v[232:235], a[224:227], a[40:43], v[232:235]
ds_read_b32 a105, v62
v_perm_b32 v61, v53, v19, s52
v_mfma_f32_16x16x32_bf16 v[236:239], a[224:227], a[44:47], v[236:239]
s_waitcnt lgkmcnt(4)
ds_read_b32 a106, v61
v_mfma_f32_16x16x32_bf16 v[240:243], a[228:231], a[32:35], v[240:243]
ds_read_b128 a[236:239], v15 offset:47104
v_perm_b32 v60, v53, v19, s53
v_mfma_f32_16x16x32_bf16 v[244:247], a[228:231], a[36:39], v[244:247]
ds_read_b32 a107, v60
v_perm_b32 v59, v49, v19, s54
v_mfma_f32_16x16x32_bf16 v[248:251], a[228:231], a[40:43], v[248:251]
s_add_u32 m0, s33, 64256
ds_read_b32 a108, v59
v_perm_b32 v58, v49, v19, s55
v_mfma_f32_16x16x32_bf16 v[252:255], a[228:231], a[44:47], v[252:255]
s_waitcnt lgkmcnt(4)
ds_read_b32 a109, v58
v_perm_b32 v57, v53, v19, s54
v_mfma_f32_16x16x32_bf16 v[128:131], a[232:235], a[80:83], v[128:131]
ds_read_b128 a[240:243], v14 offset:57344
buffer_load_dwordx4 v11, s[20:23], 0 offen offset:1280 lds
v_mfma_f32_16x16x32_bf16 v[132:135], a[232:235], a[84:87], v[132:135]
ds_read_b32 a110, v57
v_perm_b32 v56, v53, v19, s55
v_mfma_f32_16x16x32_bf16 v[136:139], a[232:235], a[88:91], v[136:139]
ds_read_b32 a111, v56
v_mfma_f32_16x16x32_bf16 v[140:143], a[232:235], a[92:95], v[140:143]
s_waitcnt lgkmcnt(4)
buffer_load_dwordx4 v[40:43], v12, s[24:27], 0 offen offset:2048 sc1
v_mfma_f32_16x16x32_bf16 v[144:147], a[236:239], a[80:83], v[144:147]
ds_read_b128 a[244:247], v14 offset:59392
buffer_load_dwordx4 v[44:47], v12, s[24:27], 0 offen offset:3072 sc1
v_mfma_f32_16x16x32_bf16 v[148:151], a[236:239], a[84:87], v[148:151]
v_add_u32 v12, 53248, v13
v_mfma_f32_16x16x32_bf16 v[152:155], a[236:239], a[88:91], v[152:155]
s_waitcnt vmcnt(14)
v_cmp_ne_u64 s[50:51], s[88:89], v[98:99]
v_cmp_ne_u64 s[44:45], s[88:89], v[102:103]
v_mfma_f32_16x16x32_bf16 v[156:159], a[236:239], a[92:95], v[156:159]
s_waitcnt lgkmcnt(1)
v_mfma_f32_16x16x32_bf16 v[128:131], a[240:243], a[96:99], v[128:131]
s_or_b64 s[50:51], s[44:45], s[50:51]
ds_read_b128 a[248:251], v15 offset:49152
v_mfma_f32_16x16x32_bf16 v[132:135], a[240:243], a[100:103], v[132:135]
s_cbranch_scc1 L_SLOW21
L_BACK21:
v_mfma_f32_16x16x32_bf16 v[136:139], a[240:243], a[104:107], v[136:139]
s_add_u32 m0, s33, 67968
v_perm_b32 v63, v96, v19, s52
v_mfma_f32_16x16x32_bf16 v[140:143], a[240:243], a[108:111], v[140:143]
s_waitcnt lgkmcnt(1)
ds_read_b32 a112, v63
v_perm_b32 v62, v96, v19, s53
v_mfma_f32_16x16x32_bf16 v[144:147], a[244:247], a[96:99], v[144:147]
ds_read_b128 a[252:255], v15 offset:51200
buffer_load_dwordx4 v8, s[20:23], 0 offen offset:1664 lds
v_mfma_f32_16x16x32_bf16 v[148:151], a[244:247], a[100:103], v[148:151]
ds_read_b32 a113, v62
v_perm_b32 v61, v100, v19, s52
v_mfma_f32_16x16x32_bf16 v[152:155], a[244:247], a[104:107], v[152:155]
ds_read_b32 a114, v61
v_perm_b32 v60, v100, v19, s53
v_mfma_f32_16x16x32_bf16 v[156:159], a[244:247], a[108:111], v[156:159]
s_waitcnt lgkmcnt(4)
ds_read_b32 a115, v60
v_mfma_f32_16x16x32_bf16 v[160:163], a[248:251], a[80:83], v[160:163]
ds_read_b128 a[224:227], v14 offset:61440
v_perm_b32 v59, v96, v19, s54
v_mfma_f32_16x16x32_bf16 v[164:167], a[248:251], a[84:87], v[164:167]
ds_read_b32 a116, v59
v_perm_b32 v58, v96, v19, s55
v_mfma_f32_16x16x32_bf16 v[168:171], a[248:251], a[88:91], v[168:171]
ds_read_b32 a117, v58
v_perm_b32 v57, v100, v19, s54
v_mfma_f32_16x16x32_bf16 v[172:175], a[248:251], a[92:95], v[172:175]
s_waitcnt lgkmcnt(4)
ds_read_b32 a118, v57
v_mfma_f32_16x16x32_bf16 v[176:179], a[252:255], a[80:83], v[176:179]
ds_read_b128 a[228:231], v14 offset:63488
v_perm_b32 v56, v100, v19, s55
v_mfma_f32_16x16x32_bf16 v[180:183], a[252:255], a[84:87], v[180:183]
ds_read_b32 a119, v56
v_perm_b32 v63, v97, v19, s52
v_mfma_f32_16x16x32_bf16 v[184:187], a[252:255], a[88:91], v[184:187]
ds_read_b32 a120, v63
v_perm_b32 v62, v97, v19, s53
v_mfma_f32_16x16x32_bf16 v[188:191], a[252:255], a[92:95], v[188:191]
s_waitcnt lgkmcnt(4)
ds_read_b32 a121, v62
v_mfma_f32_16x16x32_bf16 v[192:195], a[224:227], a[64:67], v[192:195]
ds_read_b128 a[232:235], v15 offset:53248
v_perm_b32 v61, v101, v19, s52
v_mfma_f32_16x16x32_bf16 v[196:199], a[224:227], a[68:71], v[196:199]
ds_read_b32 a122, v61
v_perm_b32 v60, v101, v19, s53
v_mfma_f32_16x16x32_bf16 v[200:203], a[224:227], a[72:75], v[200:203]
ds_read_b32 a123, v60
v_perm_b32 v59, v97, v19, s54
v_mfma_f32_16x16x32_bf16 v[204:207], a[224:227], a[76:79], v[204:207]
s_waitcnt lgkmcnt(4)
ds_read_b32 a124, v59
buffer_load_dwordx4 v[48:51], v12, s[24:27], 0 offen offset:0 sc1
v_mfma_f32_16x16x32_bf16 v[208:211], a[228:231], a[64:67], v[208:211]
ds_read_b128 a[236:239], v15 offset:55296
v_perm_b32 v58, v97, v19, s55
v_mfma_f32_16x16x32_bf16 v[212:215], a[228:231], a[68:71], v[212:215]
ds_read_b32 a125, v58
v_perm_b32 v57, v101, v19, s54
v_mfma_f32_16x16x32_bf16 v[216:219], a[228:231], a[72:75], v[216:219]
s_waitcnt vmcnt(13)
v_cmp_ne_u64 s[50:51], s[88:89], v[82:83]
v_cmp_ne_u64 s[44:45], s[88:89], v[86:87]
v_mfma_f32_16x16x32_bf16 v[220:223], a[228:231], a[76:79], v[220:223]
s_waitcnt lgkmcnt(3)
ds_read_b32 a126, v57
buffer_load_dwordx4 v[52:55], v12, s[24:27], 0 offen offset:1024 sc1
v_mfma_f32_16x16x32_bf16 v[224:227], a[232:235], a[48:51], v[224:227]
s_or_b64 s[50:51], s[44:45], s[50:51]
ds_read_b128 a[240:243], v15 offset:57344
v_perm_b32 v56, v101, v19, s55
v_mfma_f32_16x16x32_bf16 v[228:231], a[232:235], a[52:55], v[228:231]
s_cbranch_scc1 L_SLOW22
L_BACK22:
v_mfma_f32_16x16x32_bf16 v[232:235], a[232:235], a[56:59], v[232:235]
ds_read_b32 a127, v56
v_perm_b32 v63, v80, v19, s52
v_mfma_f32_16x16x32_bf16 v[236:239], a[232:235], a[60:63], v[236:239]
s_waitcnt lgkmcnt(3)
ds_read_b32 a128, v63
v_mfma_f32_16x16x32_bf16 v[240:243], a[236:239], a[48:51], v[240:243]
ds_read_b128 a[244:247], v15 offset:59392
v_perm_b32 v62, v80, v19, s53
v_mfma_f32_16x16x32_bf16 v[244:247], a[236:239], a[52:55], v[244:247]
ds_read_b32 a129, v62
v_perm_b32 v61, v84, v19, s52
v_mfma_f32_16x16x32_bf16 v[248:251], a[236:239], a[56:59], v[248:251]
ds_read_b32 a130, v61
v_perm_b32 v60, v84, v19, s53
v_mfma_f32_16x16x32_bf16 v[252:255], a[236:239], a[60:63], v[252:255]
s_waitcnt lgkmcnt(4)
ds_read_b32 a131, v60
v_mfma_f32_16x16x32_bf16 v[128:131], a[240:243], a[112:115], v[128:131]
ds_read_b128 a[248:251], v16 offset:0
v_perm_b32 v59, v80, v19, s54
v_mfma_f32_16x16x32_bf16 v[132:135], a[240:243], a[116:119], v[132:135]
ds_read_b32 a132, v59
v_perm_b32 v58, v80, v19, s55
v_mfma_f32_16x16x32_bf16 v[136:139], a[240:243], a[120:123], v[136:139]
s_add_u32 m0, s33, 71936
ds_read_b32 a133, v58
v_perm_b32 v57, v84, v19, s54
v_mfma_f32_16x16x32_bf16 v[140:143], a[240:243], a[124:127], v[140:143]
s_waitcnt lgkmcnt(4)
ds_read_b32 a134, v57
v_perm_b32 v56, v84, v19, s55
v_mfma_f32_16x16x32_bf16 v[144:147], a[244:247], a[112:115], v[144:147]
ds_read_b128 a[252:255], v16 offset:2048
buffer_load_dwordx4 v8, s[20:23], 0 offen offset:1792 lds
v_mfma_f32_16x16x32_bf16 v[148:151], a[244:247], a[116:119], v[148:151]
ds_read_b32 a135, v56
v_perm_b32 v63, v81, v19, s52
v_mfma_f32_16x16x32_bf16 v[152:155], a[244:247], a[120:123], v[152:155]
ds_read_b32 a136, v63
v_perm_b32 v62, v81, v19, s53
v_mfma_f32_16x16x32_bf16 v[156:159], a[244:247], a[124:127], v[156:159]
s_waitcnt lgkmcnt(4)
ds_read_b32 a137, v62
v_mfma_f32_16x16x32_bf16 v[160:163], a[248:251], a[96:99], v[160:163]
s_waitcnt vmcnt(13)
s_barrier
ds_read_b128 a[224:227], v15 offset:61440
v_perm_b32 v61, v85, v19, s52
v_mfma_f32_16x16x32_bf16 v[164:167], a[248:251], a[100:103], v[164:167]
ds_read_b32 a138, v61
v_perm_b32 v60, v85, v19, s53
v_mfma_f32_16x16x32_bf16 v[168:171], a[248:251], a[104:107], v[168:171]
ds_read_b32 a139, v60
v_perm_b32 v59, v81, v19, s54
v_mfma_f32_16x16x32_bf16 v[172:175], a[248:251], a[108:111], v[172:175]
s_waitcnt lgkmcnt(4)
ds_read_b32 a140, v59
buffer_load_dwordx4 v[96:99], v12, s[24:27], 0 offen offset:2048 sc1
v_mfma_f32_16x16x32_bf16 v[176:179], a[252:255], a[96:99], v[176:179]
ds_read_b128 a[228:231], v15 offset:63488
v_perm_b32 v58, v81, v19, s55
v_mfma_f32_16x16x32_bf16 v[180:183], a[252:255], a[100:103], v[180:183]
ds_read_b32 a141, v58
v_perm_b32 v57, v85, v19, s54
v_mfma_f32_16x16x32_bf16 v[184:187], a[252:255], a[104:107], v[184:187]
s_waitcnt vmcnt(12)
s_add_u32 m0, s33, 76160
v_cmp_ne_u64 s[50:51], s[88:89], v[90:91]
v_cmp_ne_u64 s[44:45], s[88:89], v[94:95]
v_mfma_f32_16x16x32_bf16 v[188:191], a[252:255], a[108:111], v[188:191]
s_waitcnt lgkmcnt(3)
ds_read_b32 a142, v57
v_perm_b32 v56, v85, v19, s55
v_mfma_f32_16x16x32_bf16 v[192:195], a[224:227], a[80:83], v[192:195]
s_or_b64 s[50:51], s[44:45], s[50:51]
ds_read_b128 a[232:235], v16 offset:4096
buffer_load_dwordx4 v9, s[20:23], 0 offen offset:1664 lds
v_mfma_f32_16x16x32_bf16 v[196:199], a[224:227], a[84:87], v[196:199]
s_cbranch_scc1 L_SLOW23
L_BACK23:
v_mfma_f32_16x16x32_bf16 v[200:203], a[224:227], a[88:91], v[200:203]
ds_read_b32 a143, v56
v_perm_b32 v63, v88, v19, s52
v_mfma_f32_16x16x32_bf16 v[204:207], a[224:227], a[92:95], v[204:207]
s_waitcnt lgkmcnt(3)
ds_read_b32 a144, v63
buffer_load_dwordx4 v[100:103], v12, s[24:27], 0 offen offset:3072 sc1
v_mfma_f32_16x16x32_bf16 v[208:211], a[228:231], a[80:83], v[208:211]
ds_read_b128 a[236:239], v16 offset:6144
v_perm_b32 v62, v88, v19, s53
v_mfma_f32_16x16x32_bf16 v[212:215], a[228:231], a[84:87], v[212:215]
ds_read_b32 a145, v62
v_perm_b32 v61, v92, v19, s52
v_mfma_f32_16x16x32_bf16 v[216:219], a[228:231], a[88:91], v[216:219]
ds_read_b32 a146, v61
v_perm_b32 v60, v92, v19, s53
v_mfma_f32_16x16x32_bf16 v[220:223], a[228:231], a[92:95], v[220:223]
s_waitcnt lgkmcnt(4)
ds_read_b32 a147, v60
v_add_u32 v12, 57344, v13
v_mfma_f32_16x16x32_bf16 v[128:131], a[232:235], a[128:131], v[128:131]
ds_read_b128 a[240:243], v17 offset:0
v_perm_b32 v59, v88, v19, s54
v_mfma_f32_16x16x32_bf16 v[132:135], a[232:235], a[132:135], v[132:135]
ds_read_b32 a148, v59
v_perm_b32 v58, v88, v19, s55
v_mfma_f32_16x16x32_bf16 v[136:139], a[232:235], a[136:139], v[136:139]
s_add_u32 m0, s33, 80384
ds_read_b32 a149, v58
v_perm_b32 v57, v92, v19, s54
v_mfma_f32_16x16x32_bf16 v[140:143], a[232:235], a[140:143], v[140:143]
s_waitcnt lgkmcnt(4)
ds_read_b32 a150, v57
v_perm_b32 v56, v92, v19, s55
v_mfma_f32_16x16x32_bf16 v[144:147], a[236:239], a[128:131], v[144:147]
ds_read_b128 a[244:247], v17 offset:2048
buffer_load_dwordx4 v10, s[20:23], 0 offen offset:1536 lds
v_mfma_f32_16x16x32_bf16 v[148:151], a[236:239], a[132:135], v[148:151]
ds_read_b32 a151, v56
v_perm_b32 v63, v89, v19, s52
v_mfma_f32_16x16x32_bf16 v[152:155], a[236:239], a[136:139], v[152:155]
ds_read_b32 a152, v63
v_perm_b32 v62, v89, v19, s53
v_mfma_f32_16x16x32_bf16 v[156:159], a[236:239], a[140:143], v[156:159]
s_waitcnt lgkmcnt(4)
ds_read_b32 a153, v62
v_mfma_f32_16x16x32_bf16 v[160:163], a[240:243], a[112:115], v[160:163]
ds_read_b128 a[248:251], v16 offset:8192
v_perm_b32 v61, v93, v19, s52
v_mfma_f32_16x16x32_bf16 v[164:167], a[240:243], a[116:119], v[164:167]
ds_read_b32 a154, v61
v_perm_b32 v60, v93, v19, s53
v_mfma_f32_16x16x32_bf16 v[168:171], a[240:243], a[120:123], v[168:171]
ds_read_b32 a155, v60
v_perm_b32 v59, v89, v19, s54
v_mfma_f32_16x16x32_bf16 v[172:175], a[240:243], a[124:127], v[172:175]
s_waitcnt lgkmcnt(4)
ds_read_b32 a156, v59
v_mfma_f32_16x16x32_bf16 v[176:179], a[244:247], a[112:115], v[176:179]
ds_read_b128 a[252:255], v16 offset:10240
v_perm_b32 v58, v89, v19, s55
v_mfma_f32_16x16x32_bf16 v[180:183], a[244:247], a[116:119], v[180:183]
ds_read_b32 a157, v58
v_perm_b32 v57, v93, v19, s54
v_mfma_f32_16x16x32_bf16 v[184:187], a[244:247], a[120:123], v[184:187]
s_waitcnt vmcnt(12)
s_add_u32 m0, s33, 84608
v_cmp_ne_u64 s[50:51], s[88:89], v[34:35]
v_cmp_ne_u64 s[44:45], s[88:89], v[38:39]
v_mfma_f32_16x16x32_bf16 v[188:191], a[244:247], a[124:127], v[188:191]
s_waitcnt lgkmcnt(3)
ds_read_b32 a158, v57
v_perm_b32 v56, v93, v19, s55
v_mfma_f32_16x16x32_bf16 v[224:227], a[248:251], a[64:67], v[224:227]
s_or_b64 s[50:51], s[44:45], s[50:51]
ds_read_b128 a[224:227], v16 offset:12288
buffer_load_dwordx4 v11, s[20:23], 0 offen offset:1408 lds
v_mfma_f32_16x16x32_bf16 v[228:231], a[248:251], a[68:71], v[228:231]
s_cbranch_scc1 L_SLOW24
L_BACK24:
v_mfma_f32_16x16x32_bf16 v[232:235], a[248:251], a[72:75], v[232:235]
ds_read_b32 a159, v56
v_perm_b32 v63, v32, v19, s52
v_mfma_f32_16x16x32_bf16 v[236:239], a[248:251], a[76:79], v[236:239]
s_waitcnt lgkmcnt(3)
ds_read_b32 a160, v63
buffer_load_dwordx4 v[80:83], v12, s[24:27], 0 offen offset:0 sc1
v_mfma_f32_16x16x32_bf16 v[240:243], a[252:255], a[64:67], v[240:243]
ds_read_b128 a[228:231], v16 offset:14336
v_perm_b32 v62, v32, v19, s53
v_mfma_f32_16x16x32_bf16 v[244:247], a[252:255], a[68:71], v[244:247]
ds_read_b32 a161, v62
v_perm_b32 v61, v36, v19, s52
v_mfma_f32_16x16x32_bf16 v[248:251], a[252:255], a[72:75], v[248:251]
ds_read_b32 a162, v61
v_perm_b32 v60, v36, v19, s53
v_mfma_f32_16x16x32_bf16 v[252:255], a[252:255], a[76:79], v[252:255]
s_waitcnt lgkmcnt(4)
ds_read_b32 a163, v60
buffer_load_dwordx4 v[84:87], v12, s[24:27], 0 offen offset:1024 sc1
v_mfma_f32_16x16x32_bf16 v[192:195], a[224:227], a[96:99], v[192:195]
ds_read_b128 a[232:235], v17 offset:4096
v_perm_b32 v59, v32, v19, s54
v_mfma_f32_16x16x32_bf16 v[196:199], a[224:227], a[100:103], v[196:199]
ds_read_b32 a164, v59
v_perm_b32 v58, v32, v19, s55
v_mfma_f32_16x16x32_bf16 v[200:203], a[224:227], a[104:107], v[200:203]
s_add_u32 m0, s33, 88192
ds_read_b32 a165, v58
v_perm_b32 v57, v36, v19, s54
v_mfma_f32_16x16x32_bf16 v[204:207], a[224:227], a[108:111], v[204:207]
s_waitcnt lgkmcnt(4)
ds_read_b32 a166, v57
v_perm_b32 v56, v36, v19, s55
v_mfma_f32_16x16x32_bf16 v[208:211], a[228:231], a[96:99], v[208:211]
ds_read_b128 a[236:239], v17 offset:6144
buffer_load_dwordx4 v8, s[20:23], 0 offen offset:1920 lds
v_mfma_f32_16x16x32_bf16 v[212:215], a[228:231], a[100:103], v[212:215]
ds_read_b32 a167, v56
v_perm_b32 v63, v33, v19, s52
v_mfma_f32_16x16x32_bf16 v[216:219], a[228:231], a[104:107], v[216:219]
ds_read_b32 a168, v63
v_perm_b32 v62, v33, v19, s53
v_mfma_f32_16x16x32_bf16 v[220:223], a[228:231], a[108:111], v[220:223]
s_waitcnt lgkmcnt(4)
ds_read_b32 a169, v62
v_mfma_f32_16x16x32_bf16 v[128:131], a[232:235], a[144:147], v[128:131]
ds_read_b128 a[240:243], v16 offset:16384
v_perm_b32 v61, v37, v19, s52
v_mfma_f32_16x16x32_bf16 v[132:135], a[232:235], a[148:151], v[132:135]
ds_read_b32 a170, v61
v_perm_b32 v60, v37, v19, s53
v_mfma_f32_16x16x32_bf16 v[136:139], a[232:235], a[152:155], v[136:139]
ds_read_b32 a171, v60
v_perm_b32 v59, v33, v19, s54
v_mfma_f32_16x16x32_bf16 v[140:143], a[232:235], a[156:159], v[140:143]
s_waitcnt lgkmcnt(4)
ds_read_b32 a172, v59
v_mfma_f32_16x16x32_bf16 v[144:147], a[236:239], a[144:147], v[144:147]
ds_read_b128 a[244:247], v16 offset:18432
v_perm_b32 v58, v33, v19, s55
v_mfma_f32_16x16x32_bf16 v[148:151], a[236:239], a[148:151], v[148:151]
ds_read_b32 a173, v58
v_perm_b32 v57, v37, v19, s54
v_mfma_f32_16x16x32_bf16 v[152:155], a[236:239], a[152:155], v[152:155]
s_add_u32 m0, s33, 92416
ds_read_b32 a174, v57
v_perm_b32 v56, v37, v19, s55
v_mfma_f32_16x16x32_bf16 v[156:159], a[236:239], a[156:159], v[156:159]
s_waitcnt vmcnt(12) lgkmcnt(4)
v_cmp_ne_u64 s[50:51], s[88:89], v[42:43]
v_cmp_ne_u64 s[44:45], s[88:89], v[46:47]
v_mfma_f32_16x16x32_bf16 v[160:163], a[240:243], a[128:131], v[160:163]
ds_read_b128 a[248:251], v16 offset:20480
buffer_load_dwordx4 v9, s[20:23], 0 offen offset:1792 lds
v_mfma_f32_16x16x32_bf16 v[164:167], a[240:243], a[132:135], v[164:167]
s_or_b64 s[50:51], s[44:45], s[50:51]
ds_read_b32 a175, v56
v_mfma_f32_16x16x32_bf16 v[168:171], a[240:243], a[136:139], v[168:171]
s_cbranch_scc1 L_SLOW25
L_BACK25:
v_mfma_f32_16x16x32_bf16 v[172:175], a[240:243], a[140:143], v[172:175]
s_waitcnt lgkmcnt(2)
buffer_load_dwordx4 v[88:91], v12, s[24:27], 0 offen offset:2048 sc1
v_mfma_f32_16x16x32_bf16 v[176:179], a[244:247], a[128:131], v[176:179]
ds_read_b128 a[252:255], v16 offset:22528
buffer_load_dwordx4 v[92:95], v12, s[24:27], 0 offen offset:3072 sc1
v_mfma_f32_16x16x32_bf16 v[180:183], a[244:247], a[132:135], v[180:183]
v_perm_b32 v63, v40, v19, s52
v_add_u32 v12, 61440, v13
v_mfma_f32_16x16x32_bf16 v[184:187], a[244:247], a[136:139], v[184:187]
ds_read_b32 a176, v63
v_perm_b32 v62, v40, v19, s53
v_mfma_f32_16x16x32_bf16 v[188:191], a[244:247], a[140:143], v[188:191]
L_PAD4:
s_cbranch_vccnz L_PAD5
s_waitcnt lgkmcnt(2)
ds_read_b32 a177, v62
v_mfma_f32_16x16x32_bf16 v[128:131], a[248:251], a[160:163], v[128:131]
s_waitcnt vmcnt(14)
s_barrier
ds_read_b128 a[224:227], v17 offset:8192
v_perm_b32 v61, v44, v19, s52
v_mfma_f32_16x16x32_bf16 v[132:135], a[248:251], a[164:167], v[132:135]
ds_read_b32 a178, v61
v_perm_b32 v60, v44, v19, s53
v_mfma_f32_16x16x32_bf16 v[136:139], a[248:251], a[168:171], v[136:139]
s_add_u32 m0, s33, 96640
ds_read_b32 a179, v60
v_perm_b32 v59, v40, v19, s54
v_mfma_f32_16x16x32_bf16 v[140:143], a[248:251], a[172:175], v[140:143]
s_waitcnt lgkmcnt(4)
ds_read_b32 a180, v59
v_perm_b32 v58, v40, v19, s55
v_mfma_f32_16x16x32_bf16 v[144:147], a[252:255], a[160:163], v[144:147]
ds_read_b128 a[228:231], v17 offset:10240
buffer_load_dwordx4 v10, s[20:23], 0 offen offset:1664 lds
v_mfma_f32_16x16x32_bf16 v[148:151], a[252:255], a[164:167], v[148:151]
ds_read_b32 a181, v58
v_perm_b32 v57, v44, v19, s54
v_mfma_f32_16x16x32_bf16 v[152:155], a[252:255], a[168:171], v[152:155]
ds_read_b32 a182, v57
v_perm_b32 v56, v44, v19, s55
v_mfma_f32_16x16x32_bf16 v[156:159], a[252:255], a[172:175], v[156:159]
s_waitcnt lgkmcnt(4)
ds_read_b32 a183, v56
v_mfma_f32_16x16x32_bf16 v[224:227], a[224:227], a[80:83], v[224:227]
ds_read_b128 a[232:235], v17 offset:12288
v_perm_b32 v63, v41, v19, s52
v_mfma_f32_16x16x32_bf16 v[228:231], a[224:227], a[84:87], v[228:231]
ds_read_b32 a184, v63
v_perm_b32 v62, v41, v19, s53
v_mfma_f32_16x16x32_bf16 v[232:235], a[224:227], a[88:91], v[232:235]
ds_read_b32 a185, v62
v_perm_b32 v61, v45, v19, s52
v_mfma_f32_16x16x32_bf16 v[236:239], a[224:227], a[92:95], v[236:239]
s_waitcnt lgkmcnt(4)
ds_read_b32 a186, v61
v_mfma_f32_16x16x32_bf16 v[240:243], a[228:231], a[80:83], v[240:243]
ds_read_b128 a[236:239], v17 offset:14336
v_perm_b32 v60, v45, v19, s53
v_mfma_f32_16x16x32_bf16 v[244:247], a[228:231], a[84:87], v[244:247]
ds_read_b32 a187, v60
v_perm_b32 v59, v41, v19, s54
v_mfma_f32_16x16x32_bf16 v[248:251], a[228:231], a[88:91], v[248:251]
s_add_u32 m0, s33, 100480
ds_read_b32 a188, v59
v_perm_b32 v58, v41, v19, s55
v_mfma_f32_16x16x32_bf16 v[252:255], a[228:231], a[92:95], v[252:255]
s_waitcnt vmcnt(13) lgkmcnt(4)
v_cmp_ne_u64 s[50:51], s[88:89], v[50:51]
v_cmp_ne_u64 s[44:45], s[88:89], v[54:55]
v_mfma_f32_16x16x32_bf16 v[192:195], a[232:235], a[112:115], v[192:195]
ds_read_b128 a[240:243], v17 offset:16384
buffer_load_dwordx4 v9, s[20:23], 0 offen offset:1920 lds
v_mfma_f32_16x16x32_bf16 v[196:199], a[232:235], a[116:119], v[196:199]
s_or_b64 s[50:51], s[44:45], s[50:51]
ds_read_b32 a189, v58
v_perm_b32 v57, v45, v19, s54
v_mfma_f32_16x16x32_bf16 v[200:203], a[232:235], a[120:123], v[200:203]
s_cbranch_scc1 L_SLOW26
L_BACK26:
v_mfma_f32_16x16x32_bf16 v[204:207], a[232:235], a[124:127], v[204:207]
s_waitcnt lgkmcnt(2)
ds_read_b32 a190, v57
buffer_load_dwordx4 v[32:35], v12, s[24:27], 0 offen offset:0 sc1
v_mfma_f32_16x16x32_bf16 v[208:211], a[236:239], a[112:115], v[208:211]
ds_read_b128 a[244:247], v17 offset:18432
v_perm_b32 v56, v45, v19, s55
v_mfma_f32_16x16x32_bf16 v[212:215], a[236:239], a[116:119], v[212:215]
ds_read_b32 a191, v56
v_perm_b32 v63, v48, v19, s52
v_mfma_f32_16x16x32_bf16 v[216:219], a[236:239], a[120:123], v[216:219]
ds_read_b32 a192, v63
v_perm_b32 v62, v48, v19, s53
v_mfma_f32_16x16x32_bf16 v[220:223], a[236:239], a[124:127], v[220:223]
s_waitcnt lgkmcnt(4)
ds_read_b32 a193, v62
buffer_load_dwordx4 v[36:39], v12, s[24:27], 0 offen offset:1024 sc1
v_mfma_f32_16x16x32_bf16 v[160:163], a[240:243], a[144:147], v[160:163]
ds_read_b128 a[248:251], v17 offset:20480
v_perm_b32 v61, v52, v19, s52
v_mfma_f32_16x16x32_bf16 v[164:167], a[240:243], a[148:151], v[164:167]
ds_read_b32 a194, v61
v_perm_b32 v60, v52, v19, s53
v_mfma_f32_16x16x32_bf16 v[168:171], a[240:243], a[152:155], v[168:171]
s_add_u32 m0, s33, 104960
ds_read_b32 a195, v60
v_perm_b32 v59, v48, v19, s54
v_mfma_f32_16x16x32_bf16 v[172:175], a[240:243], a[156:159], v[172:175]
s_waitcnt lgkmcnt(4)
ds_read_b32 a196, v59
v_perm_b32 v58, v48, v19, s55
v_mfma_f32_16x16x32_bf16 v[176:179], a[244:247], a[144:147], v[176:179]
ds_read_b128 a[252:255], v17 offset:22528
buffer_load_dwordx4 v11, s[20:23], 0 offen offset:1536 lds
v_mfma_f32_16x16x32_bf16 v[180:183], a[244:247], a[148:151], v[180:183]
ds_read_b32 a197, v58
v_perm_b32 v57, v52, v19, s54
v_mfma_f32_16x16x32_bf16 v[184:187], a[244:247], a[152:155], v[184:187]
ds_read_b32 a198, v57
v_perm_b32 v56, v52, v19, s55
v_mfma_f32_16x16x32_bf16 v[188:191], a[244:247], a[156:159], v[188:191]
s_waitcnt lgkmcnt(4)
ds_read_b32 a199, v56
v_mfma_f32_16x16x32_bf16 v[128:131], a[248:251], a[176:179], v[128:131]
ds_read_b128 a[224:227], v16 offset:24576
v_perm_b32 v63, v49, v19, s52
v_mfma_f32_16x16x32_bf16 v[132:135], a[248:251], a[180:183], v[132:135]
ds_read_b32 a200, v63
v_perm_b32 v62, v49, v19, s53
v_mfma_f32_16x16x32_bf16 v[136:139], a[248:251], a[184:187], v[136:139]
ds_read_b32 a201, v62
v_perm_b32 v61, v53, v19, s52
v_mfma_f32_16x16x32_bf16 v[140:143], a[248:251], a[188:191], v[140:143]
s_waitcnt lgkmcnt(4)
ds_read_b32 a202, v61
v_mfma_f32_16x16x32_bf16 v[144:147], a[252:255], a[176:179], v[144:147]
ds_read_b128 a[228:231], v16 offset:26624
v_perm_b32 v60, v53, v19, s53
v_mfma_f32_16x16x32_bf16 v[148:151], a[252:255], a[180:183], v[148:151]
ds_read_b32 a203, v60
v_perm_b32 v59, v49, v19, s54
v_mfma_f32_16x16x32_bf16 v[152:155], a[252:255], a[184:187], v[152:155]
s_add_u32 m0, s33, 108800
ds_read_b32 a204, v59
v_perm_b32 v58, v49, v19, s55
v_mfma_f32_16x16x32_bf16 v[156:159], a[252:255], a[188:191], v[156:159]
s_waitcnt vmcnt(13) lgkmcnt(4)
v_cmp_ne_u64 s[50:51], s[88:89], v[98:99]
v_cmp_ne_u64 s[44:45], s[88:89], v[102:103]
v_mfma_f32_16x16x32_bf16 v[192:195], a[224:227], a[128:131], v[192:195]
ds_read_b128 a[232:235], v16 offset:28672
buffer_load_dwordx4 v10, s[20:23], 0 offen offset:1792 lds
v_mfma_f32_16x16x32_bf16 v[196:199], a[224:227], a[132:135], v[196:199]
s_or_b64 s[50:51], s[44:45], s[50:51]
ds_read_b32 a205, v58
v_perm_b32 v57, v53, v19, s54
v_mfma_f32_16x16x32_bf16 v[200:203], a[224:227], a[136:139], v[200:203]
s_cbranch_scc1 L_SLOW27
L_BACK27:
v_mfma_f32_16x16x32_bf16 v[204:207], a[224:227], a[140:143], v[204:207]
s_waitcnt lgkmcnt(2)
ds_read_b32 a206, v57
buffer_load_dwordx4 v[40:43], v12, s[24:27], 0 offen offset:2048 sc1
v_mfma_f32_16x16x32_bf16 v[208:211], a[228:231], a[128:131], v[208:211]
ds_read_b128 a[236:239], v16 offset:30720
v_perm_b32 v56, v53, v19, s55
v_mfma_f32_16x16x32_bf16 v[212:215], a[228:231], a[132:135], v[212:215]
ds_read_b32 a207, v56
v_perm_b32 v63, v96, v19, s52
v_mfma_f32_16x16x32_bf16 v[216:219], a[228:231], a[136:139], v[216:219]
ds_read_b32 a208, v63
v_perm_b32 v62, v96, v19, s53
v_mfma_f32_16x16x32_bf16 v[220:223], a[228:231], a[140:143], v[220:223]
s_waitcnt lgkmcnt(4)
ds_read_b32 a209, v62
buffer_load_dwordx4 v[44:47], v12, s[24:27], 0 offen offset:3072 sc1
v_mfma_f32_16x16x32_bf16 v[160:163], a[232:235], a[160:163], v[160:163]
ds_read_b128 a[240:243], v14 offset:0
v_perm_b32 v61, v100, v19, s52
v_mfma_f32_16x16x32_bf16 v[164:167], a[232:235], a[164:167], v[164:167]
ds_read_b32 a210, v61
v_perm_b32 v60, v100, v19, s53
v_mfma_f32_16x16x32_bf16 v[168:171], a[232:235], a[168:171], v[168:171]
s_add_u32 m0, s33, 113024
ds_read_b32 a211, v60
v_perm_b32 v59, v96, v19, s54
v_mfma_f32_16x16x32_bf16 v[172:175], a[232:235], a[172:175], v[172:175]
s_waitcnt lgkmcnt(4)
ds_read_b32 a212, v59
v_perm_b32 v58, v96, v19, s55
v_mfma_f32_16x16x32_bf16 v[176:179], a[236:239], a[160:163], v[176:179]
ds_read_b128 a[244:247], v14 offset:2048
buffer_load_dwordx4 v11, s[20:23], 0 offen offset:1664 lds
v_mfma_f32_16x16x32_bf16 v[180:183], a[236:239], a[164:167], v[180:183]
ds_read_b32 a213, v58
v_perm_b32 v57, v100, v19, s54
v_mfma_f32_16x16x32_bf16 v[184:187], a[236:239], a[168:171], v[184:187]
ds_read_b32 a214, v57
v_perm_b32 v56, v100, v19, s55
v_mfma_f32_16x16x32_bf16 v[188:191], a[236:239], a[172:175], v[188:191]
s_waitcnt lgkmcnt(4)
ds_read_b32 a215, v56
v_mfma_f32_16x16x32_bf16 v[224:227], a[240:243], a[96:99], v[224:227]
ds_read_b128 a[248:251], v14 offset:4096
v_perm_b32 v63, v97, v19, s52
v_mfma_f32_16x16x32_bf16 v[228:231], a[240:243], a[100:103], v[228:231]
ds_read_b32 a216, v63
v_perm_b32 v62, v97, v19, s53
v_mfma_f32_16x16x32_bf16 v[232:235], a[240:243], a[104:107], v[232:235]
s_add_u32 m0, s33, 116864
ds_read_b32 a217, v62
v_perm_b32 v61, v101, v19, s52
v_mfma_f32_16x16x32_bf16 v[236:239], a[240:243], a[108:111], v[236:239]
s_waitcnt lgkmcnt(4)
ds_read_b32 a218, v61
v_perm_b32 v60, v101, v19, s53
v_mfma_f32_16x16x32_bf16 v[240:243], a[244:247], a[96:99], v[240:243]
ds_read_b128 a[252:255], v14 offset:6144
buffer_load_dwordx4 v10, s[20:23], 0 offen offset:1920 lds
v_mfma_f32_16x16x32_bf16 v[244:247], a[244:247], a[100:103], v[244:247]
ds_read_b32 a219, v60
v_perm_b32 v59, v97, v19, s54
v_mfma_f32_16x16x32_bf16 v[248:251], a[244:247], a[104:107], v[248:251]
ds_read_b32 a220, v59
v_perm_b32 v58, v97, v19, s55
v_mfma_f32_16x16x32_bf16 v[252:255], a[244:247], a[108:111], v[252:255]
s_waitcnt lgkmcnt(4)
ds_read_b32 a221, v58
v_mfma_f32_16x16x32_bf16 v[128:131], a[248:251], a[192:195], v[128:131]
s_waitcnt vmcnt(17)
s_barrier
ds_read_b128 a[224:227], v15 offset:4096
v_perm_b32 v57, v101, v19, s54
v_mfma_f32_16x16x32_bf16 v[132:135], a[248:251], a[196:199], v[132:135]
ds_read_b32 a222, v57
v_perm_b32 v56, v101, v19, s55
v_mfma_f32_16x16x32_bf16 v[136:139], a[248:251], a[200:203], v[136:139]
ds_read_b32 a223, v56
v_mfma_f32_16x16x32_bf16 v[140:143], a[248:251], a[204:207], v[140:143]
s_waitcnt lgkmcnt(4)
v_mfma_f32_16x16x32_bf16 v[144:147], a[252:255], a[192:195], v[144:147]
ds_read_b128 a[228:231], v15 offset:6144
v_mfma_f32_16x16x32_bf16 v[148:151], a[252:255], a[196:199], v[148:151]
v_mfma_f32_16x16x32_bf16 v[152:155], a[252:255], a[200:203], v[152:155]
s_waitcnt vmcnt(14)
v_cmp_ne_u64 s[50:51], s[88:89], v[82:83]
v_cmp_ne_u64 s[44:45], s[88:89], v[86:87]
v_mfma_f32_16x16x32_bf16 v[156:159], a[252:255], a[204:207], v[156:159]
s_waitcnt lgkmcnt(1)
v_mfma_f32_16x16x32_bf16 v[128:131], a[224:227], a[208:211], v[128:131]
s_or_b64 s[50:51], s[44:45], s[50:51]
ds_read_b128 a[232:235], v17 offset:28672
v_mfma_f32_16x16x32_bf16 v[132:135], a[224:227], a[212:215], v[132:135]
s_cbranch_scc1 L_SLOW28
L_BACK28:
v_mfma_f32_16x16x32_bf16 v[136:139], a[224:227], a[216:219], v[136:139]
s_add_u32 m0, s33, 121088
v_perm_b32 v63, v80, v19, s52
v_mfma_f32_16x16x32_bf16 v[140:143], a[224:227], a[220:223], v[140:143]
s_waitcnt lgkmcnt(1)
ds_read_b32 a0, v63
v_perm_b32 v62, v80, v19, s53
v_mfma_f32_16x16x32_bf16 v[144:147], a[228:231], a[208:211], v[144:147]
ds_read_b128 a[236:239], v17 offset:30720
buffer_load_dwordx4 v11, s[20:23], 0 offen offset:1792 lds
v_mfma_f32_16x16x32_bf16 v[148:151], a[228:231], a[212:215], v[148:151]
ds_read_b32 a1, v62
v_perm_b32 v61, v84, v19, s52
v_mfma_f32_16x16x32_bf16 v[152:155], a[228:231], a[216:219], v[152:155]
ds_read_b32 a2, v61
v_perm_b32 v60, v84, v19, s53
v_mfma_f32_16x16x32_bf16 v[156:159], a[228:231], a[220:223], v[156:159]
s_waitcnt lgkmcnt(4)
ds_read_b32 a3, v60
v_mfma_f32_16x16x32_bf16 v[160:163], a[232:235], a[176:179], v[160:163]
ds_read_b128 a[240:243], v17 offset:24576
v_perm_b32 v59, v80, v19, s54
v_mfma_f32_16x16x32_bf16 v[164:167], a[232:235], a[180:183], v[164:167]
ds_read_b32 a4, v59
v_perm_b32 v58, v80, v19, s55
v_mfma_f32_16x16x32_bf16 v[168:171], a[232:235], a[184:187], v[168:171]
ds_read_b32 a5, v58
v_perm_b32 v57, v84, v19, s54
v_mfma_f32_16x16x32_bf16 v[172:175], a[232:235], a[188:191], v[172:175]
s_waitcnt lgkmcnt(4)
ds_read_b32 a6, v57
v_mfma_f32_16x16x32_bf16 v[176:179], a[236:239], a[176:179], v[176:179]
ds_read_b128 a[244:247], v17 offset:26624
v_perm_b32 v56, v84, v19, s55
v_mfma_f32_16x16x32_bf16 v[180:183], a[236:239], a[180:183], v[180:183]
ds_read_b32 a7, v56
v_perm_b32 v63, v81, v19, s52
v_mfma_f32_16x16x32_bf16 v[184:187], a[236:239], a[184:187], v[184:187]
s_add_u32 m0, s33, 125056
ds_read_b32 a8, v63
v_perm_b32 v62, v81, v19, s53
v_mfma_f32_16x16x32_bf16 v[188:191], a[236:239], a[188:191], v[188:191]
s_waitcnt lgkmcnt(4)
ds_read_b32 a9, v62
v_perm_b32 v61, v85, v19, s52
v_mfma_f32_16x16x32_bf16 v[192:195], a[240:243], a[144:147], v[192:195]
ds_read_b128 a[248:251], v15 offset:0
buffer_load_dwordx4 v11, s[20:23], 0 offen offset:1920 lds
v_mfma_f32_16x16x32_bf16 v[196:199], a[240:243], a[148:151], v[196:199]
ds_read_b32 a10, v61
v_perm_b32 v60, v85, v19, s53
v_mfma_f32_16x16x32_bf16 v[200:203], a[240:243], a[152:155], v[200:203]
ds_read_b32 a11, v60
v_perm_b32 v59, v81, v19, s54
v_mfma_f32_16x16x32_bf16 v[204:207], a[240:243], a[156:159], v[204:207]
s_waitcnt lgkmcnt(4)
ds_read_b32 a12, v59
v_mfma_f32_16x16x32_bf16 v[208:211], a[244:247], a[144:147], v[208:211]
ds_read_b128 a[252:255], v15 offset:2048
v_perm_b32 v58, v81, v19, s55
v_mfma_f32_16x16x32_bf16 v[212:215], a[244:247], a[148:151], v[212:215]
ds_read_b32 a13, v58
v_perm_b32 v57, v85, v19, s54
v_mfma_f32_16x16x32_bf16 v[216:219], a[244:247], a[152:155], v[216:219]
s_waitcnt vmcnt(12)
v_cmp_ne_u64 s[50:51], s[88:89], v[90:91]
v_cmp_ne_u64 s[44:45], s[88:89], v[94:95]
v_mfma_f32_16x16x32_bf16 v[220:223], a[244:247], a[156:159], v[220:223]
s_waitcnt lgkmcnt(3)
ds_read_b32 a14, v57
v_mfma_f32_16x16x32_bf16 v[224:227], a[248:251], a[112:115], v[224:227]
s_or_b64 s[50:51], s[44:45], s[50:51]
ds_read_b128 a[224:227], v14 offset:8192
v_perm_b32 v56, v85, v19, s55
v_mfma_f32_16x16x32_bf16 v[228:231], a[248:251], a[116:119], v[228:231]
s_cbranch_scc1 L_SLOW29
L_BACK29:
v_mfma_f32_16x16x32_bf16 v[232:235], a[248:251], a[120:123], v[232:235]
ds_read_b32 a15, v56
v_perm_b32 v63, v88, v19, s52
v_mfma_f32_16x16x32_bf16 v[236:239], a[248:251], a[124:127], v[236:239]
s_waitcnt lgkmcnt(3)
ds_read_b32 a16, v63
v_mfma_f32_16x16x32_bf16 v[240:243], a[252:255], a[112:115], v[240:243]
ds_read_b128 a[228:231], v14 offset:10240
v_perm_b32 v62, v88, v19, s53
v_mfma_f32_16x16x32_bf16 v[244:247], a[252:255], a[116:119], v[244:247]
ds_read_b32 a17, v62
v_perm_b32 v61, v92, v19, s52
v_mfma_f32_16x16x32_bf16 v[248:251], a[252:255], a[120:123], v[248:251]
ds_read_b32 a18, v61
v_perm_b32 v60, v92, v19, s53
v_mfma_f32_16x16x32_bf16 v[252:255], a[252:255], a[124:127], v[252:255]
s_waitcnt lgkmcnt(4)
ds_read_b32 a19, v60
v_mfma_f32_16x16x32_bf16 v[128:131], a[224:227], a[0:3], v[128:131]
ds_read_b128 a[232:235], v14 offset:12288
v_perm_b32 v59, v88, v19, s54
v_mfma_f32_16x16x32_bf16 v[132:135], a[224:227], a[4:7], v[132:135]
ds_read_b32 a20, v59
v_perm_b32 v58, v88, v19, s55
v_mfma_f32_16x16x32_bf16 v[136:139], a[224:227], a[8:11], v[136:139]
ds_read_b32 a21, v58
v_perm_b32 v57, v92, v19, s54
v_mfma_f32_16x16x32_bf16 v[140:143], a[224:227], a[12:15], v[140:143]
s_waitcnt lgkmcnt(4)
ds_read_b32 a22, v57
v_mfma_f32_16x16x32_bf16 v[144:147], a[228:231], a[0:3], v[144:147]
ds_read_b128 a[236:239], v14 offset:14336
v_perm_b32 v56, v92, v19, s55
v_mfma_f32_16x16x32_bf16 v[148:151], a[228:231], a[4:7], v[148:151]
ds_read_b32 a23, v56
v_perm_b32 v63, v89, v19, s52
v_mfma_f32_16x16x32_bf16 v[152:155], a[228:231], a[8:11], v[152:155]
ds_read_b32 a24, v63
v_perm_b32 v62, v89, v19, s53
v_mfma_f32_16x16x32_bf16 v[156:159], a[228:231], a[12:15], v[156:159]
s_waitcnt lgkmcnt(4)
ds_read_b32 a25, v62
v_mfma_f32_16x16x32_bf16 v[160:163], a[232:235], a[192:195], v[160:163]
ds_read_b128 a[240:243], v14 offset:16384
v_perm_b32 v61, v93, v19, s52
v_mfma_f32_16x16x32_bf16 v[164:167], a[232:235], a[196:199], v[164:167]
ds_read_b32 a26, v61
v_perm_b32 v60, v93, v19, s53
v_mfma_f32_16x16x32_bf16 v[168:171], a[232:235], a[200:203], v[168:171]
ds_read_b32 a27, v60
v_perm_b32 v59, v89, v19, s54
v_mfma_f32_16x16x32_bf16 v[172:175], a[232:235], a[204:207], v[172:175]
s_waitcnt lgkmcnt(4)
ds_read_b32 a28, v59
v_mfma_f32_16x16x32_bf16 v[176:179], a[236:239], a[192:195], v[176:179]
ds_read_b128 a[244:247], v14 offset:18432
v_perm_b32 v58, v89, v19, s55
v_mfma_f32_16x16x32_bf16 v[180:183], a[236:239], a[196:199], v[180:183]
ds_read_b32 a29, v58
v_perm_b32 v57, v93, v19, s54
v_mfma_f32_16x16x32_bf16 v[184:187], a[236:239], a[200:203], v[184:187]
ds_read_b32 a30, v57
v_mfma_f32_16x16x32_bf16 v[188:191], a[236:239], a[204:207], v[188:191]
s_waitcnt vmcnt(8) lgkmcnt(4)
v_cmp_ne_u64 s[50:51], s[88:89], v[34:35]
v_cmp_ne_u64 s[44:45], s[88:89], v[38:39]
v_mfma_f32_16x16x32_bf16 v[192:195], a[240:243], a[160:163], v[192:195]
ds_read_b128 a[248:251], v15 offset:8192
v_perm_b32 v56, v93, v19, s55
v_mfma_f32_16x16x32_bf16 v[196:199], a[240:243], a[164:167], v[196:199]
s_or_b64 s[50:51], s[44:45], s[50:51]
ds_read_b32 a31, v56
v_mfma_f32_16x16x32_bf16 v[200:203], a[240:243], a[168:171], v[200:203]
s_cbranch_scc1 L_SLOW30
L_BACK30:
v_mfma_f32_16x16x32_bf16 v[204:207], a[240:243], a[172:175], v[204:207]
s_waitcnt lgkmcnt(2)
v_mfma_f32_16x16x32_bf16 v[208:211], a[244:247], a[160:163], v[208:211]
ds_read_b128 a[252:255], v15 offset:10240
v_mfma_f32_16x16x32_bf16 v[212:215], a[244:247], a[164:167], v[212:215]
v_perm_b32 v63, v32, v19, s52
v_mfma_f32_16x16x32_bf16 v[216:219], a[244:247], a[168:171], v[216:219]
ds_read_b32 a32, v63
v_perm_b32 v62, v32, v19, s53
v_mfma_f32_16x16x32_bf16 v[220:223], a[244:247], a[172:175], v[220:223]
s_waitcnt lgkmcnt(2)
ds_read_b32 a33, v62
v_mfma_f32_16x16x32_bf16 v[128:131], a[248:251], a[16:19], v[128:131]
s_barrier
ds_read_b128 a[224:227], v15 offset:12288
v_perm_b32 v61, v36, v19, s52
v_mfma_f32_16x16x32_bf16 v[132:135], a[248:251], a[20:23], v[132:135]
ds_read_b32 a34, v61
v_perm_b32 v60, v36, v19, s53
v_mfma_f32_16x16x32_bf16 v[136:139], a[248:251], a[24:27], v[136:139]
ds_read_b32 a35, v60
v_perm_b32 v59, v32, v19, s54
v_mfma_f32_16x16x32_bf16 v[140:143], a[248:251], a[28:31], v[140:143]
s_waitcnt lgkmcnt(4)
ds_read_b32 a36, v59
v_mfma_f32_16x16x32_bf16 v[144:147], a[252:255], a[16:19], v[144:147]
ds_read_b128 a[228:231], v15 offset:14336
v_perm_b32 v58, v32, v19, s55
v_mfma_f32_16x16x32_bf16 v[148:151], a[252:255], a[20:23], v[148:151]
ds_read_b32 a37, v58
v_perm_b32 v57, v36, v19, s54
v_mfma_f32_16x16x32_bf16 v[152:155], a[252:255], a[24:27], v[152:155]
ds_read_b32 a38, v57
v_perm_b32 v56, v36, v19, s55
v_mfma_f32_16x16x32_bf16 v[156:159], a[252:255], a[28:31], v[156:159]
s_waitcnt lgkmcnt(4)
ds_read_b32 a39, v56
v_mfma_f32_16x16x32_bf16 v[160:163], a[224:227], a[208:211], v[160:163]
ds_read_b128 a[232:235], v14 offset:20480
v_perm_b32 v63, v33, v19, s52
v_mfma_f32_16x16x32_bf16 v[164:167], a[224:227], a[212:215], v[164:167]
ds_read_b32 a40, v63
v_perm_b32 v62, v33, v19, s53
v_mfma_f32_16x16x32_bf16 v[168:171], a[224:227], a[216:219], v[168:171]
ds_read_b32 a41, v62
v_perm_b32 v61, v37, v19, s52
v_mfma_f32_16x16x32_bf16 v[172:175], a[224:227], a[220:223], v[172:175]
s_waitcnt lgkmcnt(4)
ds_read_b32 a42, v61
v_mfma_f32_16x16x32_bf16 v[176:179], a[228:231], a[208:211], v[176:179]
ds_read_b128 a[236:239], v14 offset:22528
v_perm_b32 v60, v37, v19, s53
v_mfma_f32_16x16x32_bf16 v[180:183], a[228:231], a[212:215], v[180:183]
ds_read_b32 a43, v60
v_perm_b32 v59, v33, v19, s54
v_mfma_f32_16x16x32_bf16 v[184:187], a[228:231], a[216:219], v[184:187]
ds_read_b32 a44, v59
v_mfma_f32_16x16x32_bf16 v[188:191], a[228:231], a[220:223], v[188:191]
s_waitcnt vmcnt(4) lgkmcnt(4)
v_cmp_ne_u64 s[50:51], s[88:89], v[42:43]
v_cmp_ne_u64 s[44:45], s[88:89], v[46:47]
v_mfma_f32_16x16x32_bf16 v[224:227], a[232:235], a[128:131], v[224:227]
ds_read_b128 a[240:243], v15 offset:16384
v_perm_b32 v58, v33, v19, s55
v_mfma_f32_16x16x32_bf16 v[228:231], a[232:235], a[132:135], v[228:231]
s_or_b64 s[50:51], s[44:45], s[50:51]
ds_read_b32 a45, v58
v_perm_b32 v57, v37, v19, s54
v_mfma_f32_16x16x32_bf16 v[232:235], a[232:235], a[136:139], v[232:235]
s_cbranch_scc1 L_SLOW31
L_BACK31:
v_mfma_f32_16x16x32_bf16 v[236:239], a[232:235], a[140:143], v[236:239]
s_waitcnt lgkmcnt(2)
ds_read_b32 a46, v57
v_mfma_f32_16x16x32_bf16 v[240:243], a[236:239], a[128:131], v[240:243]
ds_read_b128 a[244:247], v15 offset:18432
v_perm_b32 v56, v37, v19, s55
v_mfma_f32_16x16x32_bf16 v[244:247], a[236:239], a[132:135], v[244:247]
ds_read_b32 a47, v56
v_perm_b32 v63, v40, v19, s52
v_mfma_f32_16x16x32_bf16 v[248:251], a[236:239], a[136:139], v[248:251]
ds_read_b32 a48, v63
v_perm_b32 v62, v40, v19, s53
v_mfma_f32_16x16x32_bf16 v[252:255], a[236:239], a[140:143], v[252:255]
s_waitcnt lgkmcnt(4)
ds_read_b32 a49, v62
v_mfma_f32_16x16x32_bf16 v[192:195], a[240:243], a[176:179], v[192:195]
ds_read_b128 a[248:251], v14 offset:24576
v_perm_b32 v61, v44, v19, s52
v_mfma_f32_16x16x32_bf16 v[196:199], a[240:243], a[180:183], v[196:199]
ds_read_b32 a50, v61
v_perm_b32 v60, v44, v19, s53
v_mfma_f32_16x16x32_bf16 v[200:203], a[240:243], a[184:187], v[200:203]
ds_read_b32 a51, v60
v_perm_b32 v59, v40, v19, s54
v_mfma_f32_16x16x32_bf16 v[204:207], a[240:243], a[188:191], v[204:207]
s_waitcnt lgkmcnt(4)
ds_read_b32 a52, v59
v_mfma_f32_16x16x32_bf16 v[208:211], a[244:247], a[176:179], v[208:211]
ds_read_b128 a[252:255], v14 offset:26624
v_perm_b32 v58, v40, v19, s55
v_mfma_f32_16x16x32_bf16 v[212:215], a[244:247], a[180:183], v[212:215]
ds_read_b32 a53, v58
v_perm_b32 v57, v44, v19, s54
v_mfma_f32_16x16x32_bf16 v[216:219], a[244:247], a[184:187], v[216:219]
ds_read_b32 a54, v57
v_perm_b32 v56, v44, v19, s55
v_mfma_f32_16x16x32_bf16 v[220:223], a[244:247], a[188:191], v[220:223]
s_waitcnt lgkmcnt(4)
ds_read_b32 a55, v56
v_mfma_f32_16x16x32_bf16 v[128:131], a[248:251], a[32:35], v[128:131]
ds_read_b128 a[224:227], v14 offset:28672
v_perm_b32 v63, v41, v19, s52
v_mfma_f32_16x16x32_bf16 v[132:135], a[248:251], a[36:39], v[132:135]
ds_read_b32 a56, v63
v_perm_b32 v62, v41, v19, s53
v_mfma_f32_16x16x32_bf16 v[136:139], a[248:251], a[40:43], v[136:139]
ds_read_b32 a57, v62
v_perm_b32 v61, v45, v19, s52
v_mfma_f32_16x16x32_bf16 v[140:143], a[248:251], a[44:47], v[140:143]
s_waitcnt lgkmcnt(4)
ds_read_b32 a58, v61
v_mfma_f32_16x16x32_bf16 v[144:147], a[252:255], a[32:35], v[144:147]
ds_read_b128 a[228:231], v14 offset:30720
v_perm_b32 v60, v45, v19, s53
v_mfma_f32_16x16x32_bf16 v[148:151], a[252:255], a[36:39], v[148:151]
ds_read_b32 a59, v60
v_perm_b32 v59, v41, v19, s54
v_mfma_f32_16x16x32_bf16 v[152:155], a[252:255], a[40:43], v[152:155]
ds_read_b32 a60, v59
v_perm_b32 v58, v41, v19, s55
v_mfma_f32_16x16x32_bf16 v[156:159], a[252:255], a[44:47], v[156:159]
s_waitcnt lgkmcnt(4)
ds_read_b32 a61, v58
v_mfma_f32_16x16x32_bf16 v[160:163], a[224:227], a[0:3], v[160:163]
ds_read_b128 a[232:235], v15 offset:24576
v_perm_b32 v57, v45, v19, s54
v_mfma_f32_16x16x32_bf16 v[164:167], a[224:227], a[4:7], v[164:167]
ds_read_b32 a62, v57
v_perm_b32 v56, v45, v19, s55
v_mfma_f32_16x16x32_bf16 v[168:171], a[224:227], a[8:11], v[168:171]
ds_read_b32 a63, v56
v_mfma_f32_16x16x32_bf16 v[172:175], a[224:227], a[12:15], v[172:175]
s_waitcnt lgkmcnt(4)
v_mfma_f32_16x16x32_bf16 v[176:179], a[228:231], a[0:3], v[176:179]
ds_read_b128 a[236:239], v15 offset:26624
v_mfma_f32_16x16x32_bf16 v[180:183], a[228:231], a[4:7], v[180:183]
v_mfma_f32_16x16x32_bf16 v[184:187], a[228:231], a[8:11], v[184:187]
v_mfma_f32_16x16x32_bf16 v[188:191], a[228:231], a[12:15], v[188:191]
s_waitcnt lgkmcnt(1)
v_mfma_f32_16x16x32_bf16 v[128:131], a[232:235], a[48:51], v[128:131]
ds_read_b128 a[240:243], v15 offset:20480
v_mfma_f32_16x16x32_bf16 v[132:135], a[232:235], a[52:55], v[132:135]
v_mfma_f32_16x16x32_bf16 v[136:139], a[232:235], a[56:59], v[136:139]
v_mfma_f32_16x16x32_bf16 v[140:143], a[232:235], a[60:63], v[140:143]
s_waitcnt lgkmcnt(1)
v_mfma_f32_16x16x32_bf16 v[144:147], a[236:239], a[48:51], v[144:147]
L_PAD5:
s_cbranch_vccnz L_PADRET
ds_read_b128 a[244:247], v15 offset:22528
v_mfma_f32_16x16x32_bf16 v[148:151], a[236:239], a[52:55], v[148:151]
v_mfma_f32_16x16x32_bf16 v[152:155], a[236:239], a[56:59], v[152:155]
v_mfma_f32_16x16x32_bf16 v[156:159], a[236:239], a[60:63], v[156:159]
s_waitcnt lgkmcnt(1)
v_mfma_f32_16x16x32_bf16 v[224:227], a[240:243], a[144:147], v[224:227]
ds_read_b128 a[248:251], v14 offset:32768
v_mfma_f32_16x16x32_bf16 v[228:231], a[240:243], a[148:151], v[228:231]
v_mfma_f32_16x16x32_bf16 v[232:235], a[240:243], a[152:155], v[232:235]
v_mfma_f32_16x16x32_bf16 v[236:239], a[240:243], a[156:159], v[236:239]
s_waitcnt lgkmcnt(1)
v_mul_f32 v128, v128, v24
v_mul_f32 v132, v132, v25
v_mfma_f32_16x16x32_bf16 v[240:243], a[244:247], a[144:147], v[240:243]
s_waitcnt vmcnt(0)
s_barrier
ds_read_b128 a[252:255], v14 offset:34816
v_mul_f32 v136, v136, v26
v_mfma_f32_16x16x32_bf16 v[244:247], a[244:247], a[148:151], v[244:247]
v_mul_f32 v140, v140, v27
v_cvt_pk_bf16_f32 v120, v128, v132
v_mfma_f32_16x16x32_bf16 v[248:251], a[244:247], a[152:155], v[248:251]
v_cvt_pk_bf16_f32 v121, v136, v140
v_mfma_f32_16x16x32_bf16 v[252:255], a[244:247], a[156:159], v[252:255]
s_waitcnt lgkmcnt(1)
v_mfma_f32_16x16x32_bf16 v[192:195], a[248:251], a[192:195], v[192:195]
ds_read_b128 a[224:227], v15 offset:28672
v_mfma_f32_16x16x32_bf16 v[196:199], a[248:251], a[196:199], v[196:199]
buffer_store_dwordx2 v[120:121], v18, s[28:31], 0 offen nt
v_mul_f32 v129, v129, v24
v_mfma_f32_16x16x32_bf16 v[200:203], a[248:251], a[200:203], v[200:203]
s_add_u32 s28, s28, 7168
v_mul_f32 v133, v133, v25
v_mul_f32 v137, v137, v26
v_mfma_f32_16x16x32_bf16 v[204:207], a[248:251], a[204:207], v[204:207]
s_waitcnt lgkmcnt(1)
v_mul_f32 v141, v141, v27
v_cvt_pk_bf16_f32 v122, v129, v133
v_mfma_f32_16x16x32_bf16 v[208:211], a[252:255], a[192:195], v[208:211]
s_addc_u32 s29, s29, 0
ds_read_b128 a[228:231], v15 offset:30720
v_cvt_pk_bf16_f32 v123, v137, v141
v_mfma_f32_16x16x32_bf16 v[212:215], a[252:255], a[196:199], v[212:215]
buffer_store_dwordx2 v[122:123], v18, s[28:31], 0 offen nt
v_mul_f32 v130, v130, v24
v_mfma_f32_16x16x32_bf16 v[216:219], a[252:255], a[200:203], v[216:219]
s_add_u32 s28, s28, 7168
v_mul_f32 v134, v134, v25
v_mul_f32 v138, v138, v26
v_mfma_f32_16x16x32_bf16 v[220:223], a[252:255], a[204:207], v[220:223]
s_waitcnt lgkmcnt(1)
v_mul_f32 v142, v142, v27
v_cvt_pk_bf16_f32 v124, v130, v134
v_mfma_f32_16x16x32_bf16 v[160:163], a[224:227], a[16:19], v[160:163]
s_addc_u32 s29, s29, 0
ds_read_b128 a[232:235], v15 offset:32768
v_cvt_pk_bf16_f32 v125, v138, v142
v_mfma_f32_16x16x32_bf16 v[164:167], a[224:227], a[20:23], v[164:167]
buffer_store_dwordx2 v[124:125], v18, s[28:31], 0 offen nt
v_mul_f32 v131, v131, v24
v_mfma_f32_16x16x32_bf16 v[168:171], a[224:227], a[24:27], v[168:171]
s_add_u32 s28, s28, 7168
v_mul_f32 v135, v135, v25
v_mul_f32 v139, v139, v26
v_mfma_f32_16x16x32_bf16 v[172:175], a[224:227], a[28:31], v[172:175]
s_waitcnt lgkmcnt(1)
v_mul_f32 v143, v143, v27
v_cvt_pk_bf16_f32 v126, v131, v135
v_mfma_f32_16x16x32_bf16 v[176:179], a[228:231], a[16:19], v[176:179]
s_addc_u32 s29, s29, 0
ds_read_b128 a[236:239], v15 offset:34816
v_cvt_pk_bf16_f32 v127, v139, v143
v_mfma_f32_16x16x32_bf16 v[180:183], a[228:231], a[20:23], v[180:183]
buffer_store_dwordx2 v[126:127], v18, s[28:31], 0 offen nt
v_mul_f32 v144, v144, v24
v_mfma_f32_16x16x32_bf16 v[184:187], a[228:231], a[24:27], v[184:187]
s_add_u32 s28, s28, 93184
v_mul_f32 v148, v148, v25
v_mul_f32 v152, v152, v26
v_mfma_f32_16x16x32_bf16 v[188:191], a[228:231], a[28:31], v[188:191]
s_waitcnt lgkmcnt(1)
v_mul_f32 v156, v156, v27
v_cvt_pk_bf16_f32 v120, v144, v148
v_mfma_f32_16x16x32_bf16 v[192:195], a[232:235], a[208:211], v[192:195]
s_addc_u32 s29, s29, 0
ds_read_b128 a[240:243], v14 offset:36864
v_cvt_pk_bf16_f32 v121, v152, v156
v_mfma_f32_16x16x32_bf16 v[196:199], a[232:235], a[212:215], v[196:199]
buffer_store_dwordx2 v[120:121], v18, s[28:31], 0 offen nt
v_mul_f32 v145, v145, v24
v_mfma_f32_16x16x32_bf16 v[200:203], a[232:235], a[216:219], v[200:203]
s_add_u32 s28, s28, 7168
v_mul_f32 v149, v149, v25
v_mul_f32 v153, v153, v26
v_mfma_f32_16x16x32_bf16 v[204:207], a[232:235], a[220:223], v[204:207]
s_waitcnt lgkmcnt(1)
v_mul_f32 v157, v157, v27
v_cvt_pk_bf16_f32 v122, v145, v149
v_mfma_f32_16x16x32_bf16 v[208:211], a[236:239], a[208:211], v[208:211]
s_addc_u32 s29, s29, 0
ds_read_b128 a[244:247], v14 offset:38912
v_cvt_pk_bf16_f32 v123, v153, v157
v_mfma_f32_16x16x32_bf16 v[212:215], a[236:239], a[212:215], v[212:215]
buffer_store_dwordx2 v[122:123], v18, s[28:31], 0 offen nt
v_mul_f32 v146, v146, v24
v_mfma_f32_16x16x32_bf16 v[216:219], a[236:239], a[216:219], v[216:219]
s_add_u32 s28, s28, 7168
v_mul_f32 v150, v150, v25
v_mul_f32 v154, v154, v26
v_mfma_f32_16x16x32_bf16 v[220:223], a[236:239], a[220:223], v[220:223]
s_waitcnt lgkmcnt(1)
v_mul_f32 v158, v158, v27
v_cvt_pk_bf16_f32 v124, v146, v150
v_mfma_f32_16x16x32_bf16 v[160:163], a[240:243], a[32:35], v[160:163]
s_addc_u32 s29, s29, 0
ds_read_b128 a[248:251], v14 offset:40960
v_cvt_pk_bf16_f32 v125, v154, v158
v_mfma_f32_16x16x32_bf16 v[164:167], a[240:243], a[36:39], v[164:167]
buffer_store_dwordx2 v[124:125], v18, s[28:31], 0 offen nt
v_mul_f32 v147, v147, v24
v_mfma_f32_16x16x32_bf16 v[168:171], a[240:243], a[40:43], v[168:171]
s_add_u32 s28, s28, 7168
v_mul_f32 v151, v151, v25
v_mul_f32 v155, v155, v26
v_mfma_f32_16x16x32_bf16 v[172:175], a[240:243], a[44:47], v[172:175]
s_waitcnt lgkmcnt(1)
v_mul_f32 v159, v159, v27
v_cvt_pk_bf16_f32 v126, v147, v151
v_mfma_f32_16x16x32_bf16 v[176:179], a[244:247], a[32:35], v[176:179]
s_addc_u32 s29, s29, 0
ds_read_b128 a[252:255], v14 offset:43008
v_cvt_pk_bf16_f32 v127, v155, v159
v_mfma_f32_16x16x32_bf16 v[180:183], a[244:247], a[36:39], v[180:183]
buffer_store_dwordx2 v[126:127], v18, s[28:31], 0 offen nt
v_mfma_f32_16x16x32_bf16 v[184:187], a[244:247], a[40:43], v[184:187]
v_mfma_f32_16x16x32_bf16 v[188:191], a[244:247], a[44:47], v[188:191]
s_waitcnt lgkmcnt(1)
v_mfma_f32_16x16x32_bf16 v[224:227], a[248:251], a[160:163], v[224:227]
ds_read_b128 a[224:227], v14 offset:45056
v_mfma_f32_16x16x32_bf16 v[228:231], a[248:251], a[164:167], v[228:231]
v_mfma_f32_16x16x32_bf16 v[232:235], a[248:251], a[168:171], v[232:235]
v_mfma_f32_16x16x32_bf16 v[236:239], a[248:251], a[172:175], v[236:239]
s_waitcnt lgkmcnt(1)
v_mfma_f32_16x16x32_bf16 v[240:243], a[252:255], a[160:163], v[240:243]
ds_read_b128 a[228:231], v14 offset:47104
v_mfma_f32_16x16x32_bf16 v[244:247], a[252:255], a[164:167], v[244:247]
v_mfma_f32_16x16x32_bf16 v[248:251], a[252:255], a[168:171], v[248:251]
v_mfma_f32_16x16x32_bf16 v[252:255], a[252:255], a[172:175], v[252:255]
s_waitcnt lgkmcnt(1)
v_mfma_f32_16x16x32_bf16 v[192:195], a[224:227], a[0:3], v[192:195]
ds_read_b128 a[232:235], v15 offset:36864
v_mfma_f32_16x16x32_bf16 v[196:199], a[224:227], a[4:7], v[196:199]
v_mfma_f32_16x16x32_bf16 v[200:203], a[224:227], a[8:11], v[200:203]
v_mfma_f32_16x16x32_bf16 v[204:207], a[224:227], a[12:15], v[204:207]
s_waitcnt lgkmcnt(1)
v_mfma_f32_16x16x32_bf16 v[208:211], a[228:231], a[0:3], v[208:211]
ds_read_b128 a[236:239], v15 offset:38912
v_mfma_f32_16x16x32_bf16 v[212:215], a[228:231], a[4:7], v[212:215]
v_mfma_f32_16x16x32_bf16 v[216:219], a[228:231], a[8:11], v[216:219]
v_mfma_f32_16x16x32_bf16 v[220:223], a[228:231], a[12:15], v[220:223]
s_waitcnt lgkmcnt(1)
v_mfma_f32_16x16x32_bf16 v[160:163], a[232:235], a[48:51], v[160:163]
ds_read_b128 a[240:243], v15 offset:40960
v_mfma_f32_16x16x32_bf16 v[164:167], a[232:235], a[52:55], v[164:167]
v_mfma_f32_16x16x32_bf16 v[168:171], a[232:235], a[56:59], v[168:171]
v_mfma_f32_16x16x32_bf16 v[172:175], a[232:235], a[60:63], v[172:175]
s_waitcnt lgkmcnt(1)
v_mfma_f32_16x16x32_bf16 v[176:179], a[236:239], a[48:51], v[176:179]
ds_read_b128 a[244:247], v15 offset:43008
v_mfma_f32_16x16x32_bf16 v[180:183], a[236:239], a[52:55], v[180:183]
v_mfma_f32_16x16x32_bf16 v[184:187], a[236:239], a[56:59], v[184:187]
v_mfma_f32_16x16x32_bf16 v[188:191], a[236:239], a[60:63], v[188:191]
s_waitcnt lgkmcnt(1)
v_mfma_f32_16x16x32_bf16 v[224:227], a[240:243], a[176:179], v[224:227]
ds_read_b128 a[248:251], v15 offset:45056
v_mfma_f32_16x16x32_bf16 v[228:231], a[240:243], a[180:183], v[228:231]
v_mfma_f32_16x16x32_bf16 v[232:235], a[240:243], a[184:187], v[232:235]
v_mfma_f32_16x16x32_bf16 v[236:239], a[240:243], a[188:191], v[236:239]
s_waitcnt lgkmcnt(1)
v_mul_f32 v160, v160, v24
v_mul_f32 v164, v164, v25
v_mfma_f32_16x16x32_bf16 v[240:243], a[244:247], a[176:179], v[240:243]
s_add_u32 s28, s28, 93184
ds_read_b128 a[252:255], v15 offset:47104
v_mul_f32 v168, v168, v26
v_mfma_f32_16x16x32_bf16 v[244:247], a[244:247], a[180:183], v[244:247]
s_addc_u32 s29, s29, 0
v_mul_f32 v172, v172, v27
v_cvt_pk_bf16_f32 v120, v160, v164
v_mfma_f32_16x16x32_bf16 v[248:251], a[244:247], a[184:187], v[248:251]
v_cvt_pk_bf16_f32 v121, v168, v172
v_mfma_f32_16x16x32_bf16 v[252:255], a[244:247], a[188:191], v[252:255]
s_waitcnt lgkmcnt(1)
v_mfma_f32_16x16x32_bf16 v[192:195], a[248:251], a[16:19], v[192:195]
ds_read_b128 a[224:227], v14 offset:49152
v_mfma_f32_16x16x32_bf16 v[196:199], a[248:251], a[20:23], v[196:199]
buffer_store_dwordx2 v[120:121], v18, s[28:31], 0 offen nt
v_mul_f32 v161, v161, v24
v_mfma_f32_16x16x32_bf16 v[200:203], a[248:251], a[24:27], v[200:203]
s_add_u32 s28, s28, 7168
v_mul_f32 v165, v165, v25
v_mul_f32 v169, v169, v26
v_mfma_f32_16x16x32_bf16 v[204:207], a[248:251], a[28:31], v[204:207]
s_waitcnt lgkmcnt(1)
v_mul_f32 v173, v173, v27
v_cvt_pk_bf16_f32 v122, v161, v165
v_mfma_f32_16x16x32_bf16 v[208:211], a[252:255], a[16:19], v[208:211]
s_addc_u32 s29, s29, 0
ds_read_b128 a[228:231], v14 offset:51200
v_cvt_pk_bf16_f32 v123, v169, v173
v_mfma_f32_16x16x32_bf16 v[212:215], a[252:255], a[20:23], v[212:215]
buffer_store_dwordx2 v[122:123], v18, s[28:31], 0 offen nt
v_mul_f32 v162, v162, v24
v_mfma_f32_16x16x32_bf16 v[216:219], a[252:255], a[24:27], v[216:219]
s_add_u32 s28, s28, 7168
v_mul_f32 v166, v166, v25
v_mul_f32 v170, v170, v26
v_mfma_f32_16x16x32_bf16 v[220:223], a[252:255], a[28:31], v[220:223]
s_waitcnt lgkmcnt(1)
v_mul_f32 v174, v174, v27
v_cvt_pk_bf16_f32 v124, v162, v166
v_mfma_f32_16x16x32_bf16 v[224:227], a[224:227], a[192:195], v[224:227]
s_addc_u32 s29, s29, 0
ds_read_b128 a[232:235], v14 offset:53248
v_cvt_pk_bf16_f32 v125, v170, v174
v_mfma_f32_16x16x32_bf16 v[228:231], a[224:227], a[196:199], v[228:231]
buffer_store_dwordx2 v[124:125], v18, s[28:31], 0 offen nt
v_mul_f32 v163, v163, v24
v_mfma_f32_16x16x32_bf16 v[232:235], a[224:227], a[200:203], v[232:235]
s_add_u32 s28, s28, 7168
v_mul_f32 v167, v167, v25
v_mul_f32 v171, v171, v26
v_mfma_f32_16x16x32_bf16 v[236:239], a[224:227], a[204:207], v[236:239]
s_waitcnt lgkmcnt(1)
v_mul_f32 v175, v175, v27
v_cvt_pk_bf16_f32 v126, v163, v167
v_mfma_f32_16x16x32_bf16 v[240:243], a[228:231], a[192:195], v[240:243]
s_addc_u32 s29, s29, 0
ds_read_b128 a[236:239], v14 offset:55296
v_cvt_pk_bf16_f32 v127, v171, v175
v_mfma_f32_16x16x32_bf16 v[244:247], a[228:231], a[196:199], v[244:247]
buffer_store_dwordx2 v[126:127], v18, s[28:31], 0 offen nt
v_mul_f32 v176, v176, v24
v_mfma_f32_16x16x32_bf16 v[248:251], a[228:231], a[200:203], v[248:251]
s_add_u32 s28, s28, 93184
v_mul_f32 v180, v180, v25
v_mul_f32 v184, v184, v26
v_mfma_f32_16x16x32_bf16 v[252:255], a[228:231], a[204:207], v[252:255]
s_waitcnt lgkmcnt(1)
v_mul_f32 v188, v188, v27
v_cvt_pk_bf16_f32 v120, v176, v180
v_mfma_f32_16x16x32_bf16 v[192:195], a[232:235], a[32:35], v[192:195]
s_addc_u32 s29, s29, 0
ds_read_b128 a[240:243], v15 offset:53248
v_cvt_pk_bf16_f32 v121, v184, v188
v_mfma_f32_16x16x32_bf16 v[196:199], a[232:235], a[36:39], v[196:199]
buffer_store_dwordx2 v[120:121], v18, s[28:31], 0 offen nt
v_mul_f32 v177, v177, v24
v_mfma_f32_16x16x32_bf16 v[200:203], a[232:235], a[40:43], v[200:203]
s_add_u32 s28, s28, 7168
v_mul_f32 v181, v181, v25
v_mul_f32 v185, v185, v26
v_mfma_f32_16x16x32_bf16 v[204:207], a[232:235], a[44:47], v[204:207]
s_waitcnt lgkmcnt(1)
v_mul_f32 v189, v189, v27
v_cvt_pk_bf16_f32 v122, v177, v181
v_mfma_f32_16x16x32_bf16 v[208:211], a[236:239], a[32:35], v[208:211]
s_addc_u32 s29, s29, 0
ds_read_b128 a[244:247], v15 offset:55296
v_cvt_pk_bf16_f32 v123, v185, v189
v_mfma_f32_16x16x32_bf16 v[212:215], a[236:239], a[36:39], v[212:215]
buffer_store_dwordx2 v[122:123], v18, s[28:31], 0 offen nt
v_mul_f32 v178, v178, v24
v_mfma_f32_16x16x32_bf16 v[216:219], a[236:239], a[40:43], v[216:219]
s_add_u32 s28, s28, 7168
v_mul_f32 v182, v182, v25
v_mul_f32 v186, v186, v26
v_mfma_f32_16x16x32_bf16 v[220:223], a[236:239], a[44:47], v[220:223]
s_waitcnt lgkmcnt(1)
v_mul_f32 v190, v190, v27
v_cvt_pk_bf16_f32 v124, v178, v182
v_mfma_f32_16x16x32_bf16 v[192:195], a[240:243], a[48:51], v[192:195]
s_addc_u32 s29, s29, 0
ds_read_b128 a[248:251], v15 offset:49152
v_cvt_pk_bf16_f32 v125, v186, v190
v_mfma_f32_16x16x32_bf16 v[196:199], a[240:243], a[52:55], v[196:199]
buffer_store_dwordx2 v[124:125], v18, s[28:31], 0 offen nt
v_mul_f32 v179, v179, v24
v_mfma_f32_16x16x32_bf16 v[200:203], a[240:243], a[56:59], v[200:203]
s_add_u32 s28, s28, 7168
v_mul_f32 v183, v183, v25
v_mul_f32 v187, v187, v26
v_mfma_f32_16x16x32_bf16 v[204:207], a[240:243], a[60:63], v[204:207]
s_waitcnt lgkmcnt(1)
v_mul_f32 v191, v191, v27
v_cvt_pk_bf16_f32 v126, v179, v183
v_mfma_f32_16x16x32_bf16 v[208:211], a[244:247], a[48:51], v[208:211]
s_addc_u32 s29, s29, 0
ds_read_b128 a[252:255], v15 offset:51200
v_cvt_pk_bf16_f32 v127, v187, v191
v_mfma_f32_16x16x32_bf16 v[212:215], a[244:247], a[52:55], v[212:215]
buffer_store_dwordx2 v[126:127], v18, s[28:31], 0 offen nt
v_mfma_f32_16x16x32_bf16 v[216:219], a[244:247], a[56:59], v[216:219]
v_mfma_f32_16x16x32_bf16 v[220:223], a[244:247], a[60:63], v[220:223]
s_waitcnt lgkmcnt(1)
v_mfma_f32_16x16x32_bf16 v[224:227], a[248:251], a[208:211], v[224:227]
ds_read_b128 a[224:227], v14 offset:57344
v_mfma_f32_16x16x32_bf16 v[228:231], a[248:251], a[212:215], v[228:231]
v_mfma_f32_16x16x32_bf16 v[232:235], a[248:251], a[216:219], v[232:235]
v_mfma_f32_16x16x32_bf16 v[236:239], a[248:251], a[220:223], v[236:239]
s_waitcnt lgkmcnt(1)
v_mul_f32 v192, v192, v24
v_mul_f32 v196, v196, v25
v_mfma_f32_16x16x32_bf16 v[240:243], a[252:255], a[208:211], v[240:243]
s_add_u32 s28, s28, 93184
ds_read_b128 a[228:231], v14 offset:59392
v_mul_f32 v200, v200, v26
v_mfma_f32_16x16x32_bf16 v[244:247], a[252:255], a[212:215], v[244:247]
s_addc_u32 s29, s29, 0
v_mul_f32 v204, v204, v27
v_cvt_pk_bf16_f32 v120, v192, v196
v_mfma_f32_16x16x32_bf16 v[248:251], a[252:255], a[216:219], v[248:251]
v_cvt_pk_bf16_f32 v121, v200, v204
v_mfma_f32_16x16x32_bf16 v[252:255], a[252:255], a[220:223], v[252:255]
s_waitcnt lgkmcnt(1)
v_mfma_f32_16x16x32_bf16 v[224:227], a[224:227], a[0:3], v[224:227]
ds_read_b128 a[232:235], v15 offset:57344
v_mfma_f32_16x16x32_bf16 v[228:231], a[224:227], a[4:7], v[228:231]
buffer_store_dwordx2 v[120:121], v18, s[28:31], 0 offen nt
v_mul_f32 v193, v193, v24
v_mfma_f32_16x16x32_bf16 v[232:235], a[224:227], a[8:11], v[232:235]
s_add_u32 s28, s28, 7168
v_mul_f32 v197, v197, v25
v_mul_f32 v201, v201, v26
v_mfma_f32_16x16x32_bf16 v[236:239], a[224:227], a[12:15], v[236:239]
s_waitcnt lgkmcnt(1)
v_mul_f32 v205, v205, v27
v_cvt_pk_bf16_f32 v122, v193, v197
v_mfma_f32_16x16x32_bf16 v[240:243], a[228:231], a[0:3], v[240:243]
s_addc_u32 s29, s29, 0
ds_read_b128 a[236:239], v15 offset:59392
v_cvt_pk_bf16_f32 v123, v201, v205
v_mfma_f32_16x16x32_bf16 v[244:247], a[228:231], a[4:7], v[244:247]
buffer_store_dwordx2 v[122:123], v18, s[28:31], 0 offen nt
v_mul_f32 v194, v194, v24
v_mfma_f32_16x16x32_bf16 v[248:251], a[228:231], a[8:11], v[248:251]
s_add_u32 s28, s28, 7168
v_mul_f32 v198, v198, v25
v_mul_f32 v202, v202, v26
v_mfma_f32_16x16x32_bf16 v[252:255], a[228:231], a[12:15], v[252:255]
s_waitcnt lgkmcnt(1)
v_mul_f32 v206, v206, v27
v_cvt_pk_bf16_f32 v124, v194, v198
v_mfma_f32_16x16x32_bf16 v[224:227], a[232:235], a[16:19], v[224:227]
s_addc_u32 s29, s29, 0
ds_read_b128 a[240:243], v14 offset:61440
v_cvt_pk_bf16_f32 v125, v202, v206
v_mfma_f32_16x16x32_bf16 v[228:231], a[232:235], a[20:23], v[228:231]
buffer_store_dwordx2 v[124:125], v18, s[28:31], 0 offen nt
v_mul_f32 v195, v195, v24
v_mfma_f32_16x16x32_bf16 v[232:235], a[232:235], a[24:27], v[232:235]
s_add_u32 s28, s28, 7168
v_mul_f32 v199, v199, v25
v_mul_f32 v203, v203, v26
v_mfma_f32_16x16x32_bf16 v[236:239], a[232:235], a[28:31], v[236:239]
s_waitcnt lgkmcnt(1)
v_mul_f32 v207, v207, v27
v_cvt_pk_bf16_f32 v126, v195, v199
v_mfma_f32_16x16x32_bf16 v[240:243], a[236:239], a[16:19], v[240:243]
s_addc_u32 s29, s29, 0
ds_read_b128 a[244:247], v14 offset:63488
v_cvt_pk_bf16_f32 v127, v203, v207
v_mfma_f32_16x16x32_bf16 v[244:247], a[236:239], a[20:23], v[244:247]
buffer_store_dwordx2 v[126:127], v18, s[28:31], 0 offen nt
v_mul_f32 v208, v208, v24
v_mfma_f32_16x16x32_bf16 v[248:251], a[236:239], a[24:27], v[248:251]
s_add_u32 s28, s28, 93184
v_mul_f32 v212, v212, v25
v_mul_f32 v216, v216, v26
v_mfma_f32_16x16x32_bf16 v[252:255], a[236:239], a[28:31], v[252:255]
s_waitcnt lgkmcnt(1)
v_mul_f32 v220, v220, v27
v_cvt_pk_bf16_f32 v120, v208, v212
v_mfma_f32_16x16x32_bf16 v[224:227], a[240:243], a[32:35], v[224:227]
s_addc_u32 s29, s29, 0
ds_read_b128 a[248:251], v15 offset:61440
v_cvt_pk_bf16_f32 v121, v216, v220
v_mfma_f32_16x16x32_bf16 v[228:231], a[240:243], a[36:39], v[228:231]
buffer_store_dwordx2 v[120:121], v18, s[28:31], 0 offen nt
v_mul_f32 v209, v209, v24
v_mfma_f32_16x16x32_bf16 v[232:235], a[240:243], a[40:43], v[232:235]
s_add_u32 s28, s28, 7168
v_mul_f32 v213, v213, v25
v_mul_f32 v217, v217, v26
v_mfma_f32_16x16x32_bf16 v[236:239], a[240:243], a[44:47], v[236:239]
s_waitcnt lgkmcnt(1)
v_mul_f32 v221, v221, v27
v_cvt_pk_bf16_f32 v122, v209, v213
v_mfma_f32_16x16x32_bf16 v[240:243], a[244:247], a[32:35], v[240:243]
s_addc_u32 s29, s29, 0
ds_read_b128 a[252:255], v15 offset:63488
v_cvt_pk_bf16_f32 v123, v217, v221
v_mfma_f32_16x16x32_bf16 v[244:247], a[244:247], a[36:39], v[244:247]
buffer_store_dwordx2 v[122:123], v18, s[28:31], 0 offen nt
v_mfma_f32_16x16x32_bf16 v[248:251], a[244:247], a[40:43], v[248:251]
v_mfma_f32_16x16x32_bf16 v[252:255], a[244:247], a[44:47], v[252:255]
s_waitcnt lgkmcnt(1)
v_mfma_f32_16x16x32_bf16 v[224:227], a[248:251], a[48:51], v[224:227]
v_mfma_f32_16x16x32_bf16 v[228:231], a[248:251], a[52:55], v[228:231]
v_mfma_f32_16x16x32_bf16 v[232:235], a[248:251], a[56:59], v[232:235]
v_mfma_f32_16x16x32_bf16 v[236:239], a[248:251], a[60:63], v[236:239]
s_waitcnt lgkmcnt(0)
v_mfma_f32_16x16x32_bf16 v[240:243], a[252:255], a[48:51], v[240:243]
v_mfma_f32_16x16x32_bf16 v[244:247], a[252:255], a[52:55], v[244:247]
v_mfma_f32_16x16x32_bf16 v[248:251], a[252:255], a[56:59], v[248:251]
v_mfma_f32_16x16x32_bf16 v[252:255], a[252:255], a[60:63], v[252:255]
s_nop 7
v_pk_mul_f32 v[210:211], v[210:211], v[24:25] op_sel:[0,0] op_sel_hi:[1,0]
v_pk_mul_f32 v[214:215], v[214:215], v[24:25] op_sel:[0,1] op_sel_hi:[1,1]
v_pk_mul_f32 v[218:219], v[218:219], v[26:27] op_sel:[0,0] op_sel_hi:[1,0]
v_pk_mul_f32 v[222:223], v[222:223], v[26:27] op_sel:[0,1] op_sel_hi:[1,1]
v_cvt_pk_bf16_f32 v124, v210, v214
v_cvt_pk_bf16_f32 v125, v218, v222
s_add_u32 s28, s28, 7168
s_addc_u32 s29, s29, 0
buffer_store_dwordx2 v[124:125], v18, s[28:31], 0 offen nt
v_cvt_pk_bf16_f32 v126, v211, v215
v_cvt_pk_bf16_f32 v127, v219, v223
s_add_u32 s28, s28, 7168
s_addc_u32 s29, s29, 0
buffer_store_dwordx2 v[126:127], v18, s[28:31], 0 offen nt
v_pk_mul_f32 v[224:225], v[224:225], v[24:25] op_sel:[0,0] op_sel_hi:[1,0]
v_pk_mul_f32 v[228:229], v[228:229], v[24:25] op_sel:[0,1] op_sel_hi:[1,1]
v_pk_mul_f32 v[232:233], v[232:233], v[26:27] op_sel:[0,0] op_sel_hi:[1,0]
v_pk_mul_f32 v[236:237], v[236:237], v[26:27] op_sel:[0,1] op_sel_hi:[1,1]
v_cvt_pk_bf16_f32 v120, v224, v228
v_cvt_pk_bf16_f32 v121, v232, v236
s_add_u32 s28, s28, 93184
s_addc_u32 s29, s29, 0
buffer_store_dwordx2 v[120:121], v18, s[28:31], 0 offen nt
v_cvt_pk_bf16_f32 v122, v225, v229
v_cvt_pk_bf16_f32 v123, v233, v237
s_add_u32 s28, s28, 7168
s_addc_u32 s29, s29, 0
buffer_store_dwordx2 v[122:123], v18, s[28:31], 0 offen nt
v_pk_mul_f32 v[226:227], v[226:227], v[24:25] op_sel:[0,0] op_sel_hi:[1,0]
v_pk_mul_f32 v[230:231], v[230:231], v[24:25] op_sel:[0,1] op_sel_hi:[1,1]
v_pk_mul_f32 v[234:235], v[234:235], v[26:27] op_sel:[0,0] op_sel_hi:[1,0]
v_pk_mul_f32 v[238:239], v[238:239], v[26:27] op_sel:[0,1] op_sel_hi:[1,1]
v_cvt_pk_bf16_f32 v124, v226, v230
v_cvt_pk_bf16_f32 v125, v234, v238
s_add_u32 s28, s28, 7168
s_addc_u32 s29, s29, 0
buffer_store_dwordx2 v[124:125], v18, s[28:31], 0 offen nt
v_cvt_pk_bf16_f32 v126, v227, v231
v_cvt_pk_bf16_f32 v127, v235, v239
s_add_u32 s28, s28, 7168
s_addc_u32 s29, s29, 0
buffer_store_dwordx2 v[126:127], v18, s[28:31], 0 offen nt
v_pk_mul_f32 v[240:241], v[240:241], v[24:25] op_sel:[0,0] op_sel_hi:[1,0]
v_pk_mul_f32 v[244:245], v[244:245], v[24:25] op_sel:[0,1] op_sel_hi:[1,1]
v_pk_mul_f32 v[248:249], v[248:249], v[26:27] op_sel:[0,0] op_sel_hi:[1,0]
v_pk_mul_f32 v[252:253], v[252:253], v[26:27] op_sel:[0,1] op_sel_hi:[1,1]
v_cvt_pk_bf16_f32 v120, v240, v244
v_cvt_pk_bf16_f32 v121, v248, v252
s_add_u32 s28, s28, 93184
s_addc_u32 s29, s29, 0
buffer_store_dwordx2 v[120:121], v18, s[28:31], 0 offen nt
v_cvt_pk_bf16_f32 v122, v241, v245
v_cvt_pk_bf16_f32 v123, v249, v253
s_add_u32 s28, s28, 7168
s_addc_u32 s29, s29, 0
buffer_store_dwordx2 v[122:123], v18, s[28:31], 0 offen nt
v_pk_mul_f32 v[242:243], v[242:243], v[24:25] op_sel:[0,0] op_sel_hi:[1,0]
v_pk_mul_f32 v[246:247], v[246:247], v[24:25] op_sel:[0,1] op_sel_hi:[1,1]
v_pk_mul_f32 v[250:251], v[250:251], v[26:27] op_sel:[0,0] op_sel_hi:[1,0]
v_pk_mul_f32 v[254:255], v[254:255], v[26:27] op_sel:[0,1] op_sel_hi:[1,1]
v_cvt_pk_bf16_f32 v124, v242, v246
v_cvt_pk_bf16_f32 v125, v250, v254
s_add_u32 s28, s28, 7168
s_addc_u32 s29, s29, 0
buffer_store_dwordx2 v[124:125], v18, s[28:31], 0 offen nt
v_cvt_pk_bf16_f32 v126, v243, v247
v_cvt_pk_bf16_f32 v127, v251, v255
s_add_u32 s28, s28, 7168
s_addc_u32 s29, s29, 0
buffer_store_dwordx2 v[126:127], v18, s[28:31], 0 offen nt
s_endpgm
L_NOTAG:
buffer_load_dwordx2 v[22:23], off, s[80:83], 0 sc1
s_waitcnt vmcnt(0)
v_readfirstlane_b32 s88, v22
v_readfirstlane_b32 s89, v23
s_sub_u32 s90, s90, 1
s_nop 0
s_cmp_eq_u64 s[88:89], 0
s_cbranch_scc0 L_TAGOK
s_cmp_gt_i32 s90, 0
s_cbranch_scc1 L_NOTAG
s_mov_b32 s26, 0
s_mov_b32 s78, 0
s_mov_b64 s[88:89], 1
s_branch L_TAGOK
L_SLOW0:
s_lshr_b32 s91, s40, 6
s_add_u32 s91, s91, 0
s_call_b64 s[100:101], L_WAIT
v_mov_b64 v[32:33], v[120:121]
v_mov_b64 v[36:37], v[124:125]
s_branch L_BACK0
L_SLOW1:
s_lshr_b32 s91, s40, 6
s_add_u32 s91, s91, 1
s_call_b64 s[100:101], L_WAIT
v_mov_b64 v[40:41], v[120:121]
v_mov_b64 v[44:45], v[124:125]
s_branch L_BACK1
L_SLOW2:
s_lshr_b32 s91, s41, 6
s_add_u32 s91, s91, 0
s_call_b64 s[100:101], L_WAIT
v_mov_b64 v[48:49], v[120:121]
v_mov_b64 v[52:53], v[124:125]
s_branch L_BACK2
L_SLOW3:
s_lshr_b32 s91, s41, 6
s_add_u32 s91, s91, 1
s_call_b64 s[100:101], L_WAIT
v_mov_b64 v[96:97], v[120:121]
v_mov_b64 v[100:101], v[124:125]
s_branch L_BACK3
L_SLOW4:
s_lshr_b32 s91, s42, 6
s_add_u32 s91, s91, 0
s_call_b64 s[100:101], L_WAIT
v_mov_b64 v[80:81], v[120:121]
v_mov_b64 v[84:85], v[124:125]
s_branch L_BACK4
L_SLOW5:
s_lshr_b32 s91, s42, 6
s_add_u32 s91, s91, 1
s_call_b64 s[100:101], L_WAIT
v_mov_b64 v[88:89], v[120:121]
v_mov_b64 v[92:93], v[124:125]
s_branch L_BACK5
L_SLOW6:
s_lshr_b32 s91, s43, 6
s_add_u32 s91, s91, 0
s_call_b64 s[100:101], L_WAIT
v_mov_b64 v[32:33], v[120:121]
v_mov_b64 v[36:37], v[124:125]
s_branch L_BACK6
L_SLOW7:
s_lshr_b32 s91, s43, 6
s_add_u32 s91, s91, 1
s_call_b64 s[100:101], L_WAIT
v_mov_b64 v[40:41], v[120:121]
v_mov_b64 v[44:45], v[124:125]
s_branch L_BACK7
L_SLOW8:
s_movk_i32 s91, 8
s_call_b64 s[100:101], L_WAIT
v_mov_b64 v[48:49], v[120:121]
v_mov_b64 v[52:53], v[124:125]
s_branch L_BACK8
L_SLOW9:
s_movk_i32 s91, 9
s_call_b64 s[100:101], L_WAIT
v_mov_b64 v[96:97], v[120:121]
v_mov_b64 v[100:101], v[124:125]
s_branch L_BACK9
L_SLOW10:
s_movk_i32 s91, 10
s_call_b64 s[100:101], L_WAIT
v_mov_b64 v[80:81], v[120:121]
v_mov_b64 v[84:85], v[124:125]
s_branch L_BACK10
L_SLOW11:
s_movk_i32 s91, 11
s_call_b64 s[100:101], L_WAIT
v_mov_b64 v[88:89], v[120:121]
v_mov_b64 v[92:93], v[124:125]
s_branch L_BACK11
L_SLOW12:
s_movk_i32 s91, 12
s_call_b64 s[100:101], L_WAIT
v_mov_b64 v[32:33], v[120:121]
v_mov_b64 v[36:37], v[124:125]
s_branch L_BACK12
L_SLOW13:
s_movk_i32 s91, 13
s_call_b64 s[100:101], L_WAIT
v_mov_b64 v[40:41], v[120:121]
v_mov_b64 v[44:45], v[124:125]
s_branch L_BACK13
L_SLOW14:
s_movk_i32 s91, 14
s_call_b64 s[100:101], L_WAIT
v_mov_b64 v[48:49], v[120:121]
v_mov_b64 v[52:53], v[124:125]
s_branch L_BACK14
L_SLOW15:
s_movk_i32 s91, 15
s_call_b64 s[100:101], L_WAIT
v_mov_b64 v[96:97], v[120:121]
v_mov_b64 v[100:101], v[124:125]
s_branch L_BACK15
L_SLOW16:
s_movk_i32 s91, 16
s_call_b64 s[100:101], L_WAIT
v_mov_b64 v[80:81], v[120:121]
v_mov_b64 v[84:85], v[124:125]
s_branch L_BACK16
L_SLOW17:
s_movk_i32 s91, 17
s_call_b64 s[100:101], L_WAIT
v_mov_b64 v[88:89], v[120:121]
v_mov_b64 v[92:93], v[124:125]
s_branch L_BACK17
L_SLOW18:
s_movk_i32 s91, 18
s_call_b64 s[100:101], L_WAIT
v_mov_b64 v[32:33], v[120:121]
v_mov_b64 v[36:37], v[124:125]
s_branch L_BACK18
L_SLOW19:
s_movk_i32 s91, 19
s_call_b64 s[100:101], L_WAIT
v_mov_b64 v[40:41], v[120:121]
v_mov_b64 v[44:45], v[124:125]
s_branch L_BACK19
L_SLOW20:
s_movk_i32 s91, 20
s_call_b64 s[100:101], L_WAIT
v_mov_b64 v[48:49], v[120:121]
v_mov_b64 v[52:53], v[124:125]
s_branch L_BACK20
L_SLOW21:
s_movk_i32 s91, 21
s_call_b64 s[100:101], L_WAIT
v_mov_b64 v[96:97], v[120:121]
v_mov_b64 v[100:101], v[124:125]
s_branch L_BACK21
L_SLOW22:
s_movk_i32 s91, 22
s_call_b64 s[100:101], L_WAIT
v_mov_b64 v[80:81], v[120:121]
v_mov_b64 v[84:85], v[124:125]
s_branch L_BACK22
L_SLOW23:
s_movk_i32 s91, 23
s_call_b64 s[100:101], L_WAIT
v_mov_b64 v[88:89], v[120:121]
v_mov_b64 v[92:93], v[124:125]
s_branch L_BACK23
L_SLOW24:
s_movk_i32 s91, 24
s_call_b64 s[100:101], L_WAIT
v_mov_b64 v[32:33], v[120:121]
v_mov_b64 v[36:37], v[124:125]
s_branch L_BACK24
L_SLOW25:
s_movk_i32 s91, 25
s_call_b64 s[100:101], L_WAIT
v_mov_b64 v[40:41], v[120:121]
v_mov_b64 v[44:45], v[124:125]
s_branch L_BACK25
L_SLOW26:
s_movk_i32 s91, 26
s_call_b64 s[100:101], L_WAIT
v_mov_b64 v[48:49], v[120:121]
v_mov_b64 v[52:53], v[124:125]
s_branch L_BACK26
L_SLOW27:
s_movk_i32 s91, 27
s_call_b64 s[100:101], L_WAIT
v_mov_b64 v[96:97], v[120:121]
v_mov_b64 v[100:101], v[124:125]
s_branch L_BACK27
L_SLOW28:
s_movk_i32 s91, 28
s_call_b64 s[100:101], L_WAIT
v_mov_b64 v[80:81], v[120:121]
v_mov_b64 v[84:85], v[124:125]
s_branch L_BACK28
L_SLOW29:
s_movk_i32 s91, 29
s_call_b64 s[100:101], L_WAIT
v_mov_b64 v[88:89], v[120:121]
v_mov_b64 v[92:93], v[124:125]
s_branch L_BACK29
L_SLOW30:
s_movk_i32 s91, 30
s_call_b64 s[100:101], L_WAIT
v_mov_b64 v[32:33], v[120:121]
v_mov_b64 v[36:37], v[124:125]
s_branch L_BACK30
L_SLOW31:
s_movk_i32 s91, 31
s_call_b64 s[100:101], L_WAIT
v_mov_b64 v[40:41], v[120:121]
v_mov_b64 v[44:45], v[124:125]
s_branch L_BACK31
L_WAIT:
s_lshl_b32 s47, s91, 11
buffer_load_dwordx4 v[120:123], v13, s[24:27], s47 offen offset:0 sc1
buffer_load_dwordx4 v[124:127], v13, s[24:27], s47 offen offset:1024 sc1
s_waitcnt vmcnt(0)
v_cmp_ne_u64 s[50:51], s[88:89], v[122:123]
v_cmp_ne_u64 s[44:45], s[88:89], v[126:127]
s_sub_u32 s90, s90, 1
s_nop 0
s_or_b64 s[50:51], s[44:45], s[50:51]
s_cbranch_scc0 L_WRET
s_cmp_gt_i32 s90, 0
s_cbranch_scc1 L_WAIT
s_mul_i32 s47, s91, 458752
s_lshl_b32 s46, s39, 8
s_add_u32 s47, s47, s46
s_add_u32 s84, s6, s47
s_addc_u32 s85, s7, 0
s_mov_b32 s86, 387328
s_mov_b32 s87, 0x20000
buffer_load_dwordx4 v[64:67], v30, s[84:87], 0 offen
buffer_load_dwordx4 v[68:71], v30, s[84:87], s92 offen
buffer_load_dwordx4 v[72:75], v30, s[84:87], s93 offen
buffer_load_dwordx4 v[76:79], v30, s[84:87], s94 offen
s_waitcnt vmcnt(0)
v_lshl_add_u64 v[64:65], v[68:69], 4, v[64:65]
v_lshl_add_u64 v[66:67], v[70:71], 4, v[66:67]
v_lshl_add_u64 v[72:73], v[76:77], 4, v[72:73]
v_lshl_add_u64 v[74:75], v[78:79], 4, v[74:75]
v_lshl_or_b32 v64, v72, 8, v64
v_lshl_or_b32 v65, v73, 8, v65
v_lshl_or_b32 v66, v74, 8, v66
v_lshl_or_b32 v67, v75, 8, v67
v_lshl_or_b32 v120, v65, 16, v64
v_lshl_or_b32 v121, v67, 16, v66
s_add_u32 s84, s84, 57344
s_addc_u32 s85, s85, 0
buffer_load_dwordx4 v[64:67], v30, s[84:87], 0 offen
buffer_load_dwordx4 v[68:71], v30, s[84:87], s92 offen
buffer_load_dwordx4 v[72:75], v30, s[84:87], s93 offen
buffer_load_dwordx4 v[76:79], v30, s[84:87], s94 offen
s_waitcnt vmcnt(0)
v_lshl_add_u64 v[64:65], v[68:69], 4, v[64:65]
v_lshl_add_u64 v[66:67], v[70:71], 4, v[66:67]
v_lshl_add_u64 v[72:73], v[76:77], 4, v[72:73]
v_lshl_add_u64 v[74:75], v[78:79], 4, v[74:75]
v_lshl_or_b32 v64, v72, 8, v64
v_lshl_or_b32 v65, v73, 8, v65
v_lshl_or_b32 v66, v74, 8, v66
v_lshl_or_b32 v67, v75, 8, v67
v_lshl_or_b32 v124, v65, 16, v64
v_lshl_or_b32 v125, v67, 16, v66
L_WRET:
s_setpc_b64 s[100:101]
L_END:
s_endpgm
.section .rodata,"a"
.p2align 6
.amdhsa_kernel standalone__normalfloat_lut_af4__prompt_kernel
  .amdhsa_next_free_vgpr 512
  .amdhsa_next_free_sgpr 102
  .amdhsa_accum_offset 256
  .amdhsa_group_segment_fixed_size 0
  .amdhsa_kernarg_size 56
  .amdhsa_user_sgpr_count 2
  .amdhsa_user_sgpr_kernarg_segment_ptr 1
  .amdhsa_system_sgpr_workgroup_id_x 1
.end_amdhsa_kernel
```

```asm
; @launch grid=(256,1,1) block=(256,1,1) lds=163840
.amdgcn_target "amdgcn-amd-amdhsa--gfx950"
.text
.globl standalone__normalfloat_lut_af4__prompt_kernel
.p2align 12
.p2align 8
.type standalone__normalfloat_lut_af4__prompt_kernel,@function
standalone__normalfloat_lut_af4__prompt_kernel:
s_load_dwordx4 s[4:7], s[0:1], 0
s_load_dwordx4 s[12:15], s[0:1], 40
s_load_dwordx4 s[8:11], s[0:1], 24
s_memrealtime s[56:57]
s_cmp_ge_u32 s2, 256
s_cbranch_scc1 L_END
s_getpc_b64 s[48:49]
L_PC0:
v_bfi_b32 v2, 7, v0, s2
v_lshlrev_b32 v2, 7, v2
v_min_u32 v2, L_END-L_PC0, v2
global_load_dword v7, v2, s[48:49]
v_lshrrev_b32 v1, 6, v0
s_cmp_lt_u32 s2, 32
v_readfirstlane_b32 s36, v1
s_cbranch_scc1 L_PACK
s_bfe_u32 s34, s2, 0x20001
s_bfe_u32 s37, s2, 0x20003
s_lshl2_add_u32 s37, s34, s37
s_and_b32 s43, s2, 1
s_mul_i32 s43, s43, 7
s_lshr_b32 s38, s2, 5
s_add_u32 s38, s38, s43
s_lshl2_add_u32 s39, s38, s36
s_sub_u32 s39, s39, 4
v_bfe_u32 v6, v0, 4, 2
v_and_b32 v3, 15, v0
v_mul_u32_u24 v2, 114688, v6
v_lshl_add_u32 v30, v3, 4, v2
s_lshr_b32 s46, s37, 1
s_and_b32 s45, s37, 1
s_lshl3_add_u32 s46, s46, s45
s_mul_i32 s46, s46, 57344
s_lshl_b32 s47, s39, 8
s_add_u32 s46, s46, s47
s_mov_b32 s18, 387328
s_mov_b32 s19, 0x20000
s_mov_b32 s92, 14336
s_mov_b32 s93, 28672
s_mov_b32 s94, 43008
s_waitcnt lgkmcnt(0)
s_add_u32 s16, s6, s46
s_addc_u32 s17, s7, 0
buffer_load_dwordx4 v[104:107], v30, s[16:19], 0 offen
buffer_load_dwordx4 v[108:111], v30, s[16:19], s92 offen
buffer_load_dwordx4 v[112:115], v30, s[16:19], s93 offen
buffer_load_dwordx4 v[116:119], v30, s[16:19], s94 offen
s_branch L_MAIN
L_PACK:
v_lshrrev_b32 v2, 2, v0
v_and_b32 v3, 3, v0
s_lshl_b32 s45, s2, 17
v_lshl_add_u32 v2, v2, 11, s45
v_lshl_add_u32 v17, v3, 7, v2
s_mov_b32 s30, 4194304
s_mov_b32 s31, 0x20000
v_lshlrev_b32 v16, 3, v0
s_cmp_lt_u32 s2, 2
s_cselect_b32 s34, 8, 0
s_mov_b32 s35, 0x20000
v_mov_b64 v[22:23], 0
s_waitcnt lgkmcnt(0)
s_mov_b64 s[32:33], s[12:13]
v_mov_b64 v[20:21], s[56:57]
buffer_atomic_cmpswap_x2 v[20:23], v16, s[32:35], 0 offen sc1
s_mov_b64 s[28:29], s[4:5]
buffer_load_dword v19, v17, s[28:31], 0 offen offset:0
s_branch L_PACK1
L_MAIN:
s_mov_b64 s[20:21], s[4:5]
s_mov_b32 s22, 4194304
s_mov_b32 s23, 0x20000
s_lshl_b32 s46, s37, 18
v_lshrrev_b32 v5, 3, v0
v_lshl_add_u32 v2, v5, 11, s46
v_lshrrev_b32 v4, 4, v0
v_xor_b32 v4, v4, v0
v_and_b32 v4, 7, v4
v_lshl_add_u32 v8, v4, 4, v2
v_add_u32 v9, 65536, v8
v_add_u32 v10, 131072, v8
v_add_u32 v11, 196608, v8
s_lshl_b32 s33, s36, 10
s_lshl_b32 s40, s34, 7
s_xor_b32 s41, s40, 128
s_xor_b32 s42, s40, 256
s_xor_b32 s43, s40, 384
s_add_u32 m0, s33, 65536
s_nop 0
buffer_load_dwordx4 v8, s[20:23], s40 offen lds
s_add_u32 m0, s33, 69632
s_nop 0
buffer_load_dwordx4 v9, s[20:23], s40 offen lds
s_add_u32 m0, s33, 73728
s_nop 0
buffer_load_dwordx4 v10, s[20:23], s40 offen lds
s_add_u32 m0, s33, 77824
s_nop 0
buffer_load_dwordx4 v11, s[20:23], s40 offen lds
v_mov_b32 v2, 0x3da3bf80
s_lshl_b64 exec, exec, 8
v_mov_b32 v2, 0x3e25bf32
s_lshl_b64 exec, exec, 8
v_mov_b32 v2, 0x3e7cbf06
s_lshl_b64 exec, exec, 8
v_mov_b32 v2, 0x3eadbeca
s_lshl_b64 exec, exec, 8
v_mov_b32 v2, 0x3ee2be92
s_lshl_b64 exec, exec, 8
v_mov_b32 v2, 0x3f10be3d
s_lshl_b64 exec, exec, 8
v_mov_b32 v2, 0x3f39bdba
s_lshl_b64 exec, exec, 8
v_mov_b32 v2, 0x3f800000
s_mov_b64 exec, -1
s_and_b32 s45, s36, 1
s_mul_i32 s45, s45, 0x0202
s_lshr_b32 s46, s36, 1
s_mul_i32 s46, s46, 0x02020000
s_add_u32 s45, s45, s46
s_add_u32 s45, s45, 0x05040100
v_mov_b32 v4, s45
v_lshlrev_b32 v5, 8, v5
v_and_b32 v31, 7, v0
v_lshl_add_u32 v31, v31, 4, v5
s_mov_b32 s45, 0xbf32bf80
v_perm_b32 v128, s45, v2, v4
v_mov_b32 v129, v128
v_mov_b64 v[130:131], v[128:129]
ds_write_b128 v31, v[128:131] offset:0
s_mov_b32 s45, 0xbecabf06
v_perm_b32 v132, s45, v2, v4
v_mov_b32 v133, v132
v_mov_b64 v[134:135], v[132:133]
v_and_b32 v5, 31, v0
v_lshlrev_b32 v19, 2, v5
v_and_b32 v0, 63, v0
s_lshl_b32 s46, s39, 7
ds_write_b128 v31, v[132:135] offset:8192
s_mov_b32 s45, 0xbe3dbe92
v_perm_b32 v136, s45, v2, v4
v_mov_b32 v137, v136
v_mov_b64 v[138:139], v[136:137]
v_lshl_add_u32 v28, v3, 3, s46
s_mul_i32 s47, s37, 917504
s_add_u32 s47, s47, s46
s_add_u32 s28, s10, s47
s_addc_u32 s29, s11, 0
ds_write_b128 v31, v[136:139] offset:16384
s_mov_b32 s45, 0xbdba
v_perm_b32 v140, s45, v2, v4
v_mov_b32 v141, v140
v_mov_b64 v[142:143], v[140:141]
s_mov_b32 s30, 86144
s_mov_b32 s31, 0x20000
v_mul_u32_u24 v29, 28672, v6
v_lshl_add_u32 v18, v3, 3, v29
ds_write_b128 v31, v[140:143] offset:24576
s_mov_b32 s45, 0x3e253da3
v_perm_b32 v144, s45, v2, v4
v_mov_b32 v145, v144
v_mov_b64 v[146:147], v[144:145]
v_lshlrev_b32 v29, 7, v3
v_bfe_u32 v5, v0, 1, 3
v_xor_b32 v5, v5, v6
v_lshl_add_u32 v29, v5, 4, v29
s_load_dwordx2 s[88:89], s[12:13], 0
ds_write_b128 v31, v[144:147] offset:32768
s_mov_b32 s45, 0x3ead3e7c
v_perm_b32 v148, s45, v2, v4
v_mov_b32 v149, v148
v_mov_b64 v[150:151], v[148:149]
v_add_u32 v14, 65536, v29
v_xor_b32 v15, 64, v14
v_add_u32 v16, 0x10000, v14
v_add_u32 v17, 0x10000, v15
ds_write_b128 v31, v[148:151] offset:40960
s_mov_b32 s45, 0x3f103ee2
v_perm_b32 v152, s45, v2, v4
v_mov_b32 v153, v152
v_mov_b64 v[154:155], v[152:153]
s_mov_b32 s52, 0x0c0c0400
s_mov_b32 s53, 0x0c0c0500
s_mov_b32 s54, 0x0c0c0600
s_mov_b32 s55, 0x0c0c0700
ds_write_b128 v31, v[152:155] offset:49152
s_mov_b32 s45, 0x3f803f39
v_perm_b32 v156, s45, v2, v4
v_mov_b32 v157, v156
v_mov_b64 v[158:159], v[156:157]
v_lshlrev_b32 v13, 4, v0
v_lshl_add_u32 v12, s40, 5, v13
s_lshl_b32 s47, s39, 16
s_add_u32 s24, s14, s47
s_addc_u32 s25, s15, 0
ds_write_b128 v31, v[156:159] offset:57344
s_lshl_b32 s47, s37, 10
s_add_u32 s76, s24, s47
s_addc_u32 s77, s25, 0
s_movk_i32 s78, 1024
s_mov_b32 s79, 0x20000
s_add_u32 s16, s16, 5505024
s_addc_u32 s17, s17, 0
s_mov_b32 s26, 65536
s_mov_b32 s27, 0x20000
s_mov_b64 s[80:81], s[12:13]
s_movk_i32 s82, 128
s_mov_b32 s83, 0x20000
s_movk_i32 s90, 4096
s_add_u32 m0, s33, 81920
s_nop 0
buffer_load_dwordx4 v8, s[20:23], s41 offen lds
s_add_u32 m0, s33, 86016
s_nop 0
buffer_load_dwordx4 v9, s[20:23], s41 offen lds
s_add_u32 m0, s33, 90112
s_nop 0
buffer_load_dwordx4 v10, s[20:23], s41 offen lds
s_add_u32 m0, s33, 94208
s_nop 0
buffer_load_dwordx4 v11, s[20:23], s41 offen lds
s_waitcnt vmcnt(8)
v_lshl_add_u64 v[104:105], v[108:109], 4, v[104:105]
v_lshl_add_u64 v[106:107], v[110:111], 4, v[106:107]
v_lshl_add_u64 v[112:113], v[116:117], 4, v[112:113]
v_lshl_add_u64 v[114:115], v[118:119], 4, v[114:115]
v_lshl_or_b32 v104, v112, 8, v104
v_lshl_or_b32 v105, v113, 8, v105
v_lshl_or_b32 v106, v114, 8, v106
v_lshl_or_b32 v107, v115, 8, v107
v_lshl_or_b32 v108, v105, 16, v104
v_lshl_or_b32 v109, v107, 16, v106
s_waitcnt lgkmcnt(0)
s_cmp_eq_u64 s[88:89], 0
s_cbranch_scc1 L_NOTAG
L_TAGOK:
v_mov_b64 v[110:111], s[88:89]
buffer_store_dwordx4 v[108:111], v13, s[76:79], 0 offen sc1
s_add_u32 s76, s76, 24576
s_addc_u32 s77, s77, 0
s_waitcnt lgkmcnt(0)
s_barrier
s_mov_b64 vcc, -1
s_cmp_eq_u32 s36, 0
s_cbranch_scc1 L_PAD0
s_cmp_eq_u32 s36, 1
s_cbranch_scc1 L_PAD2
s_cmp_eq_u32 s36, 2
s_cbranch_scc1 L_PAD4
L_PADRET:
s_mov_b64 vcc, 0
s_branch L_STREAM
L_PACK1:
v_and_b32 v0, 63, v0
v_lshrrev_b32 v2, 4, v0
v_and_b32 v3, 15, v0
v_mul_u32_u24 v2, 114688, v2
v_lshl_add_u32 v8, v3, 4, v2
s_movk_i32 s47, 0x3800
v_add_u32 v9, s47, v8
v_add_u32 v10, s47, v9
v_add_u32 v11, s47, v10
v_add_u32 v12, s47, v11
v_add_u32 v13, s47, v12
v_add_u32 v14, s47, v13
v_add_u32 v15, s47, v14
s_mul_i32 s40, s2, 4682
s_lshr_b32 s40, s40, 16
s_mul_i32 s41, s40, 14
s_sub_u32 s41, s2, s41
s_add_u32 s40, s40, 8
s_mov_b32 s22, 14680064
s_mov_b32 s23, 0x20000
s_mov_b64 s[20:21], s[6:7]
s_cmp_ge_u32 s40, 12
s_cselect_b32 s45, 8, 0
s_add_u32 s45, s45, s40
s_lshl2_add_u32 s42, s41, s36
s_mul_i32 s43, s45, 458752
s_lshl_b32 s44, s42, 8
s_add_u32 s43, s43, s44
s_lshl_b32 s44, s42, 5
s_add_u32 s44, s44, s45
s_lshl_b32 s52, s44, 11
s_cmp_lt_u32 s45, 32
s_cselect_b32 s52, s52, 0x1000000
s_cselect_b32 s22, 14680064, 0
s_add_u32 s41, s41, 4
s_add_u32 s40, s40, 2
s_cmp_ge_u32 s41, 14
s_cselect_b32 s48, 14, 0
s_addc_u32 s40, s40, 0
s_sub_u32 s41, s41, s48
s_load_dwordx2 s[50:51], s[12:13], 0
buffer_load_dwordx4 v[32:35], v8, s[20:23], s43 offen
buffer_load_dwordx4 v[36:39], v9, s[20:23], s43 offen
buffer_load_dwordx4 v[40:43], v10, s[20:23], s43 offen
buffer_load_dwordx4 v[44:47], v11, s[20:23], s43 offen
buffer_load_dwordx4 v[48:51], v12, s[20:23], s43 offen
buffer_load_dwordx4 v[52:55], v13, s[20:23], s43 offen
buffer_load_dwordx4 v[56:59], v14, s[20:23], s43 offen
buffer_load_dwordx4 v[60:63], v15, s[20:23], s43 offen
s_mov_b64 s[24:25], s[14:15]
s_mov_b32 s26, 3670016
s_mov_b32 s27, 0x20000
s_movk_i32 s34, 128
v_mov_b32 v16, 0
v_lshlrev_b32 v18, 4, v0
s_movk_i32 s46, 4096
s_waitcnt vmcnt(4) lgkmcnt(0)
v_mov_b64 v[22:23], s[50:51]
s_nop 0
L_PKN:
v_cmp_ne_u64 vcc, 0, v[22:23]
s_sub_u32 s46, s46, 1
s_cmp_gt_i32 s46, 0
s_cbranch_vccnz L_PKGO
s_cbranch_scc0 L_END
buffer_load_dwordx2 v[22:23], v16, s[32:35], 0 offen sc1
s_waitcnt vmcnt(0)
s_branch L_PKN
L_PKGO:
s_call_b64 s[100:101], L_PK0
buffer_store_dwordx4 v[20:23], v18, s[24:27], s52 offen offset:0 sc1
s_waitcnt lgkmcnt(0)
s_call_b64 s[100:101], L_UNIT
s_mov_b32 s53, s49
buffer_load_dwordx4 v[64:67], v8, s[20:23], s43 offen
buffer_load_dwordx4 v[68:71], v9, s[20:23], s43 offen
buffer_load_dwordx4 v[72:75], v10, s[20:23], s43 offen
buffer_load_dwordx4 v[76:79], v11, s[20:23], s43 offen
s_waitcnt vmcnt(5)
s_call_b64 s[100:101], L_PK1
buffer_store_dwordx4 v[20:23], v18, s[24:27], s52 offen offset:1024 sc1
buffer_load_dwordx4 v[80:83], v12, s[20:23], s43 offen
buffer_load_dwordx4 v[84:87], v13, s[20:23], s43 offen
buffer_load_dwordx4 v[88:91], v14, s[20:23], s43 offen
buffer_load_dwordx4 v[92:95], v15, s[20:23], s43 offen
s_waitcnt vmcnt(5)
s_call_b64 s[100:101], L_PK2
buffer_store_dwordx4 v[20:23], v18, s[24:27], s53 offen offset:0 sc1
s_call_b64 s[100:101], L_UNIT
s_mov_b32 s54, s49
buffer_load_dwordx4 v[32:35], v8, s[20:23], s43 offen
buffer_load_dwordx4 v[36:39], v9, s[20:23], s43 offen
buffer_load_dwordx4 v[40:43], v10, s[20:23], s43 offen
buffer_load_dwordx4 v[44:47], v11, s[20:23], s43 offen
s_waitcnt vmcnt(5)
s_call_b64 s[100:101], L_PK3
buffer_store_dwordx4 v[20:23], v18, s[24:27], s53 offen offset:1024 sc1
buffer_load_dwordx4 v[48:51], v12, s[20:23], s43 offen
buffer_load_dwordx4 v[52:55], v13, s[20:23], s43 offen
buffer_load_dwordx4 v[56:59], v14, s[20:23], s43 offen
buffer_load_dwordx4 v[60:63], v15, s[20:23], s43 offen
s_waitcnt vmcnt(5)
s_call_b64 s[100:101], L_PK0
buffer_store_dwordx4 v[20:23], v18, s[24:27], s54 offen offset:0 sc1
s_call_b64 s[100:101], L_UNIT
s_mov_b32 s55, s49
buffer_load_dwordx4 v[64:67], v8, s[20:23], s43 offen
buffer_load_dwordx4 v[68:71], v9, s[20:23], s43 offen
buffer_load_dwordx4 v[72:75], v10, s[20:23], s43 offen
buffer_load_dwordx4 v[76:79], v11, s[20:23], s43 offen
s_waitcnt vmcnt(5)
s_call_b64 s[100:101], L_PK1
buffer_store_dwordx4 v[20:23], v18, s[24:27], s54 offen offset:1024 sc1
buffer_load_dwordx4 v[80:83], v12, s[20:23], s43 offen
buffer_load_dwordx4 v[84:87], v13, s[20:23], s43 offen
buffer_load_dwordx4 v[88:91], v14, s[20:23], s43 offen
buffer_load_dwordx4 v[92:95], v15, s[20:23], s43 offen
s_waitcnt vmcnt(5)
s_call_b64 s[100:101], L_PK2
buffer_store_dwordx4 v[20:23], v18, s[24:27], s55 offen offset:0 sc1
s_call_b64 s[100:101], L_UNIT
s_mov_b32 s52, s49
buffer_load_dwordx4 v[32:35], v8, s[20:23], s43 offen
buffer_load_dwordx4 v[36:39], v9, s[20:23], s43 offen
buffer_load_dwordx4 v[40:43], v10, s[20:23], s43 offen
buffer_load_dwordx4 v[44:47], v11, s[20:23], s43 offen
s_waitcnt vmcnt(5)
s_call_b64 s[100:101], L_PK3
buffer_store_dwordx4 v[20:23], v18, s[24:27], s55 offen offset:1024 sc1
buffer_load_dwordx4 v[48:51], v12, s[20:23], s43 offen
buffer_load_dwordx4 v[52:55], v13, s[20:23], s43 offen
buffer_load_dwordx4 v[56:59], v14, s[20:23], s43 offen
buffer_load_dwordx4 v[60:63], v15, s[20:23], s43 offen
s_waitcnt vmcnt(5)
s_call_b64 s[100:101], L_PK0
buffer_store_dwordx4 v[20:23], v18, s[24:27], s52 offen offset:0 sc1
s_call_b64 s[100:101], L_UNIT
s_mov_b32 s53, s49
buffer_load_dwordx4 v[64:67], v8, s[20:23], s43 offen
buffer_load_dwordx4 v[68:71], v9, s[20:23], s43 offen
buffer_load_dwordx4 v[72:75], v10, s[20:23], s43 offen
buffer_load_dwordx4 v[76:79], v11, s[20:23], s43 offen
s_waitcnt vmcnt(5)
s_call_b64 s[100:101], L_PK1
buffer_store_dwordx4 v[20:23], v18, s[24:27], s52 offen offset:1024 sc1
buffer_load_dwordx4 v[80:83], v12, s[20:23], s43 offen
buffer_load_dwordx4 v[84:87], v13, s[20:23], s43 offen
buffer_load_dwordx4 v[88:91], v14, s[20:23], s43 offen
buffer_load_dwordx4 v[92:95], v15, s[20:23], s43 offen
s_waitcnt vmcnt(5)
s_call_b64 s[100:101], L_PK2
buffer_store_dwordx4 v[20:23], v18, s[24:27], s53 offen offset:0 sc1
s_call_b64 s[100:101], L_UNIT
s_mov_b32 s54, s49
buffer_load_dwordx4 v[32:35], v8, s[20:23], s43 offen
buffer_load_dwordx4 v[36:39], v9, s[20:23], s43 offen
buffer_load_dwordx4 v[40:43], v10, s[20:23], s43 offen
buffer_load_dwordx4 v[44:47], v11, s[20:23], s43 offen
s_waitcnt vmcnt(5)
s_call_b64 s[100:101], L_PK3
buffer_store_dwordx4 v[20:23], v18, s[24:27], s53 offen offset:1024 sc1
buffer_load_dwordx4 v[48:51], v12, s[20:23], s43 offen
buffer_load_dwordx4 v[52:55], v13, s[20:23], s43 offen
buffer_load_dwordx4 v[56:59], v14, s[20:23], s43 offen
buffer_load_dwordx4 v[60:63], v15, s[20:23], s43 offen
s_waitcnt vmcnt(5)
s_call_b64 s[100:101], L_PK0
buffer_store_dwordx4 v[20:23], v18, s[24:27], s54 offen offset:0 sc1
s_waitcnt vmcnt(1)
s_call_b64 s[100:101], L_PK1
buffer_store_dwordx4 v[20:23], v18, s[24:27], s54 offen offset:1024 sc1
s_endpgm
L_UNIT:
s_cmp_ge_u32 s40, 12
s_cselect_b32 s45, 8, 0
s_add_u32 s45, s45, s40
s_lshl2_add_u32 s42, s41, s36
s_mul_i32 s43, s45, 458752
s_lshl_b32 s44, s42, 8
s_add_u32 s43, s43, s44
s_lshl_b32 s44, s42, 5
s_add_u32 s44, s44, s45
s_lshl_b32 s49, s44, 11
s_cmp_lt_u32 s45, 32
s_cselect_b32 s49, s49, 0x1000000
s_cselect_b32 s22, 14680064, 0
s_add_u32 s41, s41, 4
s_add_u32 s40, s40, 2
s_cmp_ge_u32 s41, 14
s_cselect_b32 s48, 14, 0
s_addc_u32 s40, s40, 0
s_sub_u32 s41, s41, s48
s_setpc_b64 s[100:101]
L_PK0:
v_lshl_add_u64 v[32:33], v[36:37], 4, v[32:33]
v_lshl_add_u64 v[34:35], v[38:39], 4, v[34:35]
v_lshl_add_u64 v[40:41], v[44:45], 4, v[40:41]
v_lshl_add_u64 v[42:43], v[46:47], 4, v[42:43]
v_lshl_or_b32 v32, v40, 8, v32
v_lshl_or_b32 v33, v41, 8, v33
v_lshl_or_b32 v34, v42, 8, v34
v_lshl_or_b32 v35, v43, 8, v35
v_lshl_or_b32 v20, v33, 16, v32
v_lshl_or_b32 v21, v35, 16, v34
s_setpc_b64 s[100:101]
L_PK1:
v_lshl_add_u64 v[48:49], v[52:53], 4, v[48:49]
v_lshl_add_u64 v[50:51], v[54:55], 4, v[50:51]
v_lshl_add_u64 v[56:57], v[60:61], 4, v[56:57]
v_lshl_add_u64 v[58:59], v[62:63], 4, v[58:59]
v_lshl_or_b32 v48, v56, 8, v48
v_lshl_or_b32 v49, v57, 8, v49
v_lshl_or_b32 v50, v58, 8, v50
v_lshl_or_b32 v51, v59, 8, v51
v_lshl_or_b32 v20, v49, 16, v48
v_lshl_or_b32 v21, v51, 16, v50
s_setpc_b64 s[100:101]
L_PK2:
v_lshl_add_u64 v[64:65], v[68:69], 4, v[64:65]
v_lshl_add_u64 v[66:67], v[70:71], 4, v[66:67]
v_lshl_add_u64 v[72:73], v[76:77], 4, v[72:73]
v_lshl_add_u64 v[74:75], v[78:79], 4, v[74:75]
v_lshl_or_b32 v64, v72, 8, v64
v_lshl_or_b32 v65, v73, 8, v65
v_lshl_or_b32 v66, v74, 8, v66
v_lshl_or_b32 v67, v75, 8, v67
v_lshl_or_b32 v20, v65, 16, v64
v_lshl_or_b32 v21, v67, 16, v66
s_setpc_b64 s[100:101]
L_PK3:
v_lshl_add_u64 v[80:81], v[84:85], 4, v[80:81]
v_lshl_add_u64 v[82:83], v[86:87], 4, v[82:83]
v_lshl_add_u64 v[88:89], v[92:93], 4, v[88:89]
v_lshl_add_u64 v[90:91], v[94:95], 4, v[90:91]
v_lshl_or_b32 v80, v88, 8, v80
v_lshl_or_b32 v81, v89, 8, v81
v_lshl_or_b32 v82, v90, 8, v82
v_lshl_or_b32 v83, v91, 8, v83
v_lshl_or_b32 v20, v81, 16, v80
v_lshl_or_b32 v21, v83, 16, v82
s_setpc_b64 s[100:101]
.p2align 12
L_STREAM:
L_PAD0:
s_cbranch_vccnz L_PAD1
s_waitcnt vmcnt(0)
buffer_load_dwordx4 v[32:35], v12, s[24:27], 0 offen offset:0 sc1
buffer_load_dwordx4 v[36:39], v12, s[24:27], 0 offen offset:1024 sc1
buffer_load_dwordx4 v[40:43], v12, s[24:27], 0 offen offset:2048 sc1
buffer_load_dwordx4 v[44:47], v12, s[24:27], 0 offen offset:3072 sc1
v_lshl_add_u32 v12, s41, 5, v13
s_barrier
ds_read_b128 a[224:227], v14 offset:0
ds_read_b128 a[228:231], v14 offset:2048
s_waitcnt vmcnt(2)
v_cmp_ne_u64 s[50:51], s[88:89], v[34:35]
v_cmp_ne_u64 s[44:45], s[88:89], v[38:39]
s_or_b64 s[50:51], s[44:45], s[50:51]
s_cbranch_scc1 L_SLOW0
L_BACK0:
v_perm_b32 v64, v32, v19, s52
v_perm_b32 v65, v32, v19, s53
v_perm_b32 v66, v36, v19, s52
v_perm_b32 v67, v36, v19, s53
v_perm_b32 v68, v32, v19, s54
v_perm_b32 v69, v32, v19, s55
v_perm_b32 v70, v36, v19, s54
v_perm_b32 v71, v36, v19, s55
ds_read_b32 a0, v64
ds_read_b32 a1, v65
ds_read_b32 a2, v66
ds_read_b32 a3, v67
ds_read_b32 a4, v68
ds_read_b32 a5, v69
ds_read_b32 a6, v70
ds_read_b32 a7, v71
v_perm_b32 v72, v33, v19, s52
v_perm_b32 v73, v33, v19, s53
v_perm_b32 v74, v37, v19, s52
v_perm_b32 v75, v37, v19, s53
v_perm_b32 v76, v33, v19, s54
v_perm_b32 v77, v33, v19, s55
v_perm_b32 v78, v37, v19, s54
v_perm_b32 v79, v37, v19, s55
ds_read_b32 a8, v72
ds_read_b32 a9, v73
ds_read_b32 a10, v74
ds_read_b32 a11, v75
ds_read_b32 a12, v76
ds_read_b32 a13, v77
ds_read_b32 a14, v78
ds_read_b32 a15, v79
buffer_load_dwordx4 v[48:51], v12, s[24:27], 0 offen offset:0 sc1
s_waitcnt vmcnt(1) lgkmcnt(12)
v_cmp_ne_u64 s[50:51], s[88:89], v[42:43]
v_cmp_ne_u64 s[44:45], s[88:89], v[46:47]
v_mfma_f32_16x16x32_bf16 v[128:131], a[224:227], a[0:3], 0
s_waitcnt lgkmcnt(8)
ds_read_b128 a[232:235], v14 offset:4096
buffer_load_dwordx4 v[52:55], v12, s[24:27], 0 offen offset:1024 sc1
v_mfma_f32_16x16x32_bf16 v[132:135], a[224:227], a[4:7], 0
s_waitcnt lgkmcnt(5)
s_or_b64 s[50:51], s[44:45], s[50:51]
v_mfma_f32_16x16x32_bf16 v[136:139], a[224:227], a[8:11], 0
s_waitcnt lgkmcnt(1)
s_cbranch_scc1 L_SLOW1
L_BACK1:
v_mfma_f32_16x16x32_bf16 v[140:143], a[224:227], a[12:15], 0
buffer_load_dwordx4 v[96:99], v12, s[24:27], 0 offen offset:2048 sc1
v_mfma_f32_16x16x32_bf16 v[144:147], a[228:231], a[0:3], 0
ds_read_b128 a[236:239], v14 offset:6144
buffer_load_dwordx4 v[100:103], v12, s[24:27], 0 offen offset:3072 sc1
v_mfma_f32_16x16x32_bf16 v[148:151], a[228:231], a[4:7], 0
v_perm_b32 v63, v40, v19, s52
v_lshl_add_u32 v12, s42, 5, v13
v_mfma_f32_16x16x32_bf16 v[152:155], a[228:231], a[8:11], 0
s_add_u32 m0, s33, 98304
ds_read_b32 a16, v63
v_perm_b32 v62, v40, v19, s53
v_mfma_f32_16x16x32_bf16 v[156:159], a[228:231], a[12:15], 0
s_waitcnt lgkmcnt(2)
ds_read_b32 a17, v62
v_perm_b32 v61, v44, v19, s52
v_mfma_f32_16x16x32_bf16 v[160:163], a[232:235], a[0:3], 0
ds_read_b128 a[240:243], v14 offset:8192
buffer_load_dwordx4 v8, s[20:23], s42 offen lds
v_mfma_f32_16x16x32_bf16 v[164:167], a[232:235], a[4:7], 0
ds_read_b32 a18, v61
v_perm_b32 v60, v44, v19, s53
v_mfma_f32_16x16x32_bf16 v[168:171], a[232:235], a[8:11], 0
s_add_u32 m0, s33, 102400
ds_read_b32 a19, v60
v_perm_b32 v59, v40, v19, s54
v_mfma_f32_16x16x32_bf16 v[172:175], a[232:235], a[12:15], 0
s_waitcnt lgkmcnt(4)
ds_read_b32 a20, v59
v_perm_b32 v58, v40, v19, s55
v_mfma_f32_16x16x32_bf16 v[176:179], a[236:239], a[0:3], 0
ds_read_b128 a[244:247], v14 offset:10240
buffer_load_dwordx4 v9, s[20:23], s42 offen lds
v_mfma_f32_16x16x32_bf16 v[180:183], a[236:239], a[4:7], 0
ds_read_b32 a21, v58
v_perm_b32 v57, v44, v19, s54
v_mfma_f32_16x16x32_bf16 v[184:187], a[236:239], a[8:11], 0
s_add_u32 m0, s33, 106496
ds_read_b32 a22, v57
v_perm_b32 v56, v44, v19, s55
v_mfma_f32_16x16x32_bf16 v[188:191], a[236:239], a[12:15], 0
s_waitcnt lgkmcnt(4)
ds_read_b32 a23, v56
v_perm_b32 v63, v41, v19, s52
v_mfma_f32_16x16x32_bf16 v[192:195], a[240:243], a[0:3], 0
ds_read_b128 a[248:251], v14 offset:12288
buffer_load_dwordx4 v10, s[20:23], s42 offen lds
v_mfma_f32_16x16x32_bf16 v[196:199], a[240:243], a[4:7], 0
ds_read_b32 a24, v63
v_perm_b32 v62, v41, v19, s53
v_mfma_f32_16x16x32_bf16 v[200:203], a[240:243], a[8:11], 0
s_add_u32 m0, s33, 110592
ds_read_b32 a25, v62
v_perm_b32 v61, v45, v19, s52
v_mfma_f32_16x16x32_bf16 v[204:207], a[240:243], a[12:15], 0
s_waitcnt lgkmcnt(4)
ds_read_b32 a26, v61
v_perm_b32 v60, v45, v19, s53
v_mfma_f32_16x16x32_bf16 v[208:211], a[244:247], a[0:3], 0
ds_read_b128 a[252:255], v14 offset:14336
buffer_load_dwordx4 v11, s[20:23], s42 offen lds
v_mfma_f32_16x16x32_bf16 v[212:215], a[244:247], a[4:7], 0
ds_read_b32 a27, v60
v_perm_b32 v59, v41, v19, s54
v_mfma_f32_16x16x32_bf16 v[216:219], a[244:247], a[8:11], 0
ds_read_b32 a28, v59
v_perm_b32 v58, v41, v19, s55
v_mfma_f32_16x16x32_bf16 v[220:223], a[244:247], a[12:15], 0
s_waitcnt lgkmcnt(4)
ds_read_b32 a29, v58
v_mfma_f32_16x16x32_bf16 v[224:227], a[248:251], a[0:3], 0
ds_read_b128 a[224:227], v15 offset:0
v_perm_b32 v57, v45, v19, s54
v_mfma_f32_16x16x32_bf16 v[228:231], a[248:251], a[4:7], 0
ds_read_b32 a30, v57
v_perm_b32 v56, v45, v19, s55
v_mfma_f32_16x16x32_bf16 v[232:235], a[248:251], a[8:11], 0
ds_read_b32 a31, v56
buffer_load_dwordx4 v[80:83], v12, s[24:27], 0 offen offset:0 sc1
v_mfma_f32_16x16x32_bf16 v[236:239], a[248:251], a[12:15], 0
s_waitcnt lgkmcnt(4)
buffer_load_dwordx4 v[84:87], v12, s[24:27], 0 offen offset:1024 sc1
v_mfma_f32_16x16x32_bf16 v[240:243], a[252:255], a[0:3], 0
ds_read_b128 a[228:231], v15 offset:2048
v_mfma_f32_16x16x32_bf16 v[244:247], a[252:255], a[4:7], 0
v_mfma_f32_16x16x32_bf16 v[248:251], a[252:255], a[8:11], 0
s_waitcnt vmcnt(8)
v_cmp_ne_u64 s[50:51], s[88:89], v[50:51]
v_cmp_ne_u64 s[44:45], s[88:89], v[54:55]
v_mfma_f32_16x16x32_bf16 v[252:255], a[252:255], a[12:15], 0
s_waitcnt lgkmcnt(1)
global_load_dwordx2 v[20:21], v28, s[8:9]
v_mfma_f32_16x16x32_bf16 v[128:131], a[224:227], a[16:19], v[128:131]
s_or_b64 s[50:51], s[44:45], s[50:51]
ds_read_b128 a[232:235], v15 offset:4096
v_mfma_f32_16x16x32_bf16 v[132:135], a[224:227], a[20:23], v[132:135]
s_cbranch_scc1 L_SLOW2
L_BACK2:
v_mfma_f32_16x16x32_bf16 v[136:139], a[224:227], a[24:27], v[136:139]
v_perm_b32 v63, v48, v19, s52
v_mfma_f32_16x16x32_bf16 v[140:143], a[224:227], a[28:31], v[140:143]
s_waitcnt lgkmcnt(1)
ds_read_b32 a32, v63
v_mfma_f32_16x16x32_bf16 v[144:147], a[228:231], a[16:19], v[144:147]
ds_read_b128 a[236:239], v15 offset:6144
v_perm_b32 v62, v48, v19, s53
v_mfma_f32_16x16x32_bf16 v[148:151], a[228:231], a[20:23], v[148:151]
ds_read_b32 a33, v62
v_perm_b32 v61, v52, v19, s52
v_mfma_f32_16x16x32_bf16 v[152:155], a[228:231], a[24:27], v[152:155]
ds_read_b32 a34, v61
v_perm_b32 v60, v52, v19, s53
v_mfma_f32_16x16x32_bf16 v[156:159], a[228:231], a[28:31], v[156:159]
s_waitcnt lgkmcnt(4)
ds_read_b32 a35, v60
v_mfma_f32_16x16x32_bf16 v[160:163], a[232:235], a[16:19], v[160:163]
ds_read_b128 a[240:243], v15 offset:8192
v_perm_b32 v59, v48, v19, s54
v_mfma_f32_16x16x32_bf16 v[164:167], a[232:235], a[20:23], v[164:167]
ds_read_b32 a36, v59
v_perm_b32 v58, v48, v19, s55
v_mfma_f32_16x16x32_bf16 v[168:171], a[232:235], a[24:27], v[168:171]
ds_read_b32 a37, v58
v_perm_b32 v57, v52, v19, s54
v_mfma_f32_16x16x32_bf16 v[172:175], a[232:235], a[28:31], v[172:175]
s_waitcnt lgkmcnt(4)
ds_read_b32 a38, v57
buffer_load_dwordx4 v[88:91], v12, s[24:27], 0 offen offset:2048 sc1
v_mfma_f32_16x16x32_bf16 v[176:179], a[236:239], a[16:19], v[176:179]
ds_read_b128 a[244:247], v15 offset:10240
v_perm_b32 v56, v52, v19, s55
v_mfma_f32_16x16x32_bf16 v[180:183], a[236:239], a[20:23], v[180:183]
buffer_load_dwordx4 v[104:107], v30, s[16:19], 0 offen
v_mfma_f32_16x16x32_bf16 v[184:187], a[236:239], a[24:27], v[184:187]
ds_read_b32 a39, v56
v_perm_b32 v63, v49, v19, s52
v_mfma_f32_16x16x32_bf16 v[188:191], a[236:239], a[28:31], v[188:191]
s_waitcnt lgkmcnt(3)
ds_read_b32 a40, v63
buffer_load_dwordx4 v[92:95], v12, s[24:27], 0 offen offset:3072 sc1
v_mfma_f32_16x16x32_bf16 v[192:195], a[240:243], a[16:19], v[192:195]
ds_read_b128 a[248:251], v15 offset:12288
v_perm_b32 v62, v49, v19, s53
v_mfma_f32_16x16x32_bf16 v[196:199], a[240:243], a[20:23], v[196:199]
ds_read_b32 a41, v62
v_perm_b32 v61, v53, v19, s52
v_mfma_f32_16x16x32_bf16 v[200:203], a[240:243], a[24:27], v[200:203]
s_add_u32 m0, s33, 114688
ds_read_b32 a42, v61
v_perm_b32 v60, v53, v19, s53
v_mfma_f32_16x16x32_bf16 v[204:207], a[240:243], a[28:31], v[204:207]
s_waitcnt lgkmcnt(4)
ds_read_b32 a43, v60
v_perm_b32 v59, v49, v19, s54
v_mfma_f32_16x16x32_bf16 v[208:211], a[244:247], a[16:19], v[208:211]
ds_read_b128 a[252:255], v15 offset:14336
buffer_load_dwordx4 v8, s[20:23], s43 offen lds
v_mfma_f32_16x16x32_bf16 v[212:215], a[244:247], a[20:23], v[212:215]
buffer_load_dwordx4 v[108:111], v30, s[16:19], s92 offen
v_mfma_f32_16x16x32_bf16 v[216:219], a[244:247], a[24:27], v[216:219]
ds_read_b32 a44, v59
v_perm_b32 v58, v49, v19, s55
v_mfma_f32_16x16x32_bf16 v[220:223], a[244:247], a[28:31], v[220:223]
s_waitcnt lgkmcnt(3)
ds_read_b32 a45, v58
v_lshl_add_u32 v12, s43, 5, v13
v_mfma_f32_16x16x32_bf16 v[224:227], a[248:251], a[16:19], v[224:227]
s_barrier
ds_read_b128 a[224:227], v14 offset:16384
v_perm_b32 v57, v53, v19, s54
v_mfma_f32_16x16x32_bf16 v[228:231], a[248:251], a[20:23], v[228:231]
ds_read_b32 a46, v57
v_perm_b32 v56, v53, v19, s55
v_mfma_f32_16x16x32_bf16 v[232:235], a[248:251], a[24:27], v[232:235]
ds_read_b32 a47, v56
v_mfma_f32_16x16x32_bf16 v[236:239], a[248:251], a[28:31], v[236:239]
s_waitcnt lgkmcnt(4)
v_mfma_f32_16x16x32_bf16 v[240:243], a[252:255], a[16:19], v[240:243]
ds_read_b128 a[228:231], v14 offset:18432
v_mfma_f32_16x16x32_bf16 v[244:247], a[252:255], a[20:23], v[244:247]
buffer_load_dwordx4 v[112:115], v30, s[16:19], s93 offen
v_mfma_f32_16x16x32_bf16 v[248:251], a[252:255], a[24:27], v[248:251]
s_waitcnt vmcnt(13)
v_cmp_ne_u64 s[50:51], s[88:89], v[98:99]
v_cmp_ne_u64 s[44:45], s[88:89], v[102:103]
v_mfma_f32_16x16x32_bf16 v[252:255], a[252:255], a[28:31], v[252:255]
s_waitcnt lgkmcnt(1)
v_mfma_f32_16x16x32_bf16 v[128:131], a[224:227], a[32:35], v[128:131]
s_or_b64 s[50:51], s[44:45], s[50:51]
ds_read_b128 a[232:235], v14 offset:20480
v_mfma_f32_16x16x32_bf16 v[132:135], a[224:227], a[36:39], v[132:135]
s_cbranch_scc1 L_SLOW3
L_BACK3:
v_mfma_f32_16x16x32_bf16 v[136:139], a[224:227], a[40:43], v[136:139]
s_add_u32 m0, s33, 118784
v_mfma_f32_16x16x32_bf16 v[140:143], a[224:227], a[44:47], v[140:143]
s_waitcnt lgkmcnt(1)
v_perm_b32 v63, v96, v19, s52
v_mfma_f32_16x16x32_bf16 v[144:147], a[228:231], a[32:35], v[144:147]
ds_read_b128 a[236:239], v14 offset:22528
buffer_load_dwordx4 v9, s[20:23], s43 offen lds
v_mfma_f32_16x16x32_bf16 v[148:151], a[228:231], a[36:39], v[148:151]
buffer_load_dwordx4 v[116:119], v30, s[16:19], s94 offen
v_mfma_f32_16x16x32_bf16 v[152:155], a[228:231], a[40:43], v[152:155]
ds_read_b32 a48, v63
v_perm_b32 v62, v96, v19, s53
v_mfma_f32_16x16x32_bf16 v[156:159], a[228:231], a[44:47], v[156:159]
s_waitcnt lgkmcnt(2)
ds_read_b32 a49, v62
buffer_load_dwordx4 v[32:35], v12, s[24:27], 0 offen offset:0 sc1
v_mfma_f32_16x16x32_bf16 v[160:163], a[232:235], a[32:35], v[160:163]
ds_read_b128 a[240:243], v14 offset:24576
v_perm_b32 v61, v100, v19, s52
v_mfma_f32_16x16x32_bf16 v[164:167], a[232:235], a[36:39], v[164:167]
ds_read_b32 a50, v61
v_perm_b32 v60, v100, v19, s53
v_mfma_f32_16x16x32_bf16 v[168:171], a[232:235], a[40:43], v[168:171]
ds_read_b32 a51, v60
v_perm_b32 v59, v96, v19, s54
v_mfma_f32_16x16x32_bf16 v[172:175], a[232:235], a[44:47], v[172:175]
s_waitcnt lgkmcnt(4)
ds_read_b32 a52, v59
buffer_load_dwordx4 v[36:39], v12, s[24:27], 0 offen offset:1024 sc1
v_mfma_f32_16x16x32_bf16 v[176:179], a[236:239], a[32:35], v[176:179]
ds_read_b128 a[244:247], v14 offset:26624
v_perm_b32 v58, v96, v19, s55
v_mfma_f32_16x16x32_bf16 v[180:183], a[236:239], a[36:39], v[180:183]
ds_read_b32 a53, v58
v_perm_b32 v57, v100, v19, s54
v_mfma_f32_16x16x32_bf16 v[184:187], a[236:239], a[40:43], v[184:187]
s_add_u32 m0, s33, 122880
ds_read_b32 a54, v57
v_perm_b32 v56, v100, v19, s55
v_mfma_f32_16x16x32_bf16 v[188:191], a[236:239], a[44:47], v[188:191]
s_waitcnt lgkmcnt(4)
ds_read_b32 a55, v56
v_perm_b32 v63, v97, v19, s52
v_mfma_f32_16x16x32_bf16 v[192:195], a[240:243], a[32:35], v[192:195]
ds_read_b128 a[248:251], v14 offset:28672
buffer_load_dwordx4 v10, s[20:23], s43 offen lds
v_mfma_f32_16x16x32_bf16 v[196:199], a[240:243], a[36:39], v[196:199]
ds_read_b32 a56, v63
v_perm_b32 v62, v97, v19, s53
v_mfma_f32_16x16x32_bf16 v[200:203], a[240:243], a[40:43], v[200:203]
ds_read_b32 a57, v62
v_perm_b32 v61, v101, v19, s52
v_mfma_f32_16x16x32_bf16 v[204:207], a[240:243], a[44:47], v[204:207]
s_waitcnt lgkmcnt(4)
ds_read_b32 a58, v61
v_mfma_f32_16x16x32_bf16 v[208:211], a[244:247], a[32:35], v[208:211]
ds_read_b128 a[252:255], v14 offset:30720
v_perm_b32 v60, v101, v19, s53
v_mfma_f32_16x16x32_bf16 v[212:215], a[244:247], a[36:39], v[212:215]
ds_read_b32 a59, v60
v_perm_b32 v59, v97, v19, s54
v_mfma_f32_16x16x32_bf16 v[216:219], a[244:247], a[40:43], v[216:219]
ds_read_b32 a60, v59
v_perm_b32 v58, v97, v19, s55
v_mfma_f32_16x16x32_bf16 v[220:223], a[244:247], a[44:47], v[220:223]
s_waitcnt lgkmcnt(4)
ds_read_b32 a61, v58
v_mfma_f32_16x16x32_bf16 v[224:227], a[248:251], a[32:35], v[224:227]
ds_read_b128 a[224:227], v15 offset:16384
v_perm_b32 v57, v101, v19, s54
v_mfma_f32_16x16x32_bf16 v[228:231], a[248:251], a[36:39], v[228:231]
ds_read_b32 a62, v57
v_perm_b32 v56, v101, v19, s55
v_mfma_f32_16x16x32_bf16 v[232:235], a[248:251], a[40:43], v[232:235]
s_add_u32 m0, s33, 126976
ds_read_b32 a63, v56
v_mfma_f32_16x16x32_bf16 v[236:239], a[248:251], a[44:47], v[236:239]
s_waitcnt lgkmcnt(4)
v_mfma_f32_16x16x32_bf16 v[240:243], a[252:255], a[32:35], v[240:243]
ds_read_b128 a[228:231], v15 offset:18432
buffer_load_dwordx4 v11, s[20:23], s43 offen lds
v_mfma_f32_16x16x32_bf16 v[244:247], a[252:255], a[36:39], v[244:247]
v_mfma_f32_16x16x32_bf16 v[248:251], a[252:255], a[40:43], v[248:251]
v_mfma_f32_16x16x32_bf16 v[252:255], a[252:255], a[44:47], v[252:255]
s_waitcnt vmcnt(13) lgkmcnt(1)
v_cmp_ne_u64 s[50:51], s[88:89], v[82:83]
v_cmp_ne_u64 s[44:45], s[88:89], v[86:87]
v_mfma_f32_16x16x32_bf16 v[128:131], a[224:227], a[48:51], v[128:131]
ds_read_b128 a[232:235], v15 offset:20480
v_mfma_f32_16x16x32_bf16 v[132:135], a[224:227], a[52:55], v[132:135]
s_or_b64 s[50:51], s[44:45], s[50:51]
v_mfma_f32_16x16x32_bf16 v[136:139], a[224:227], a[56:59], v[136:139]
s_cbranch_scc1 L_SLOW4
L_BACK4:
v_mfma_f32_16x16x32_bf16 v[140:143], a[224:227], a[60:63], v[140:143]
s_waitcnt lgkmcnt(1)
v_mfma_f32_16x16x32_bf16 v[144:147], a[228:231], a[48:51], v[144:147]
s_waitcnt vmcnt(12)
ds_read_b128 a[236:239], v15 offset:22528
v_lshlrev_b32 v24, 16, v20
v_mfma_f32_16x16x32_bf16 v[148:151], a[228:231], a[52:55], v[148:151]
v_perm_b32 v63, v80, v19, s52
v_and_b32 v25, 0xffff0000, v20
v_mfma_f32_16x16x32_bf16 v[152:155], a[228:231], a[56:59], v[152:155]
ds_read_b32 a64, v63
v_perm_b32 v62, v80, v19, s53
v_mfma_f32_16x16x32_bf16 v[156:159], a[228:231], a[60:63], v[156:159]
s_waitcnt lgkmcnt(2)
ds_read_b32 a65, v62
v_lshlrev_b32 v26, 16, v21
v_mfma_f32_16x16x32_bf16 v[160:163], a[232:235], a[48:51], v[160:163]
ds_read_b128 a[240:243], v15 offset:24576
v_perm_b32 v61, v84, v19, s52
v_mfma_f32_16x16x32_bf16 v[164:167], a[232:235], a[52:55], v[164:167]
ds_read_b32 a66, v61
v_perm_b32 v60, v84, v19, s53
v_mfma_f32_16x16x32_bf16 v[168:171], a[232:235], a[56:59], v[168:171]
ds_read_b32 a67, v60
v_perm_b32 v59, v80, v19, s54
v_mfma_f32_16x16x32_bf16 v[172:175], a[232:235], a[60:63], v[172:175]
s_waitcnt lgkmcnt(4)
ds_read_b32 a68, v59
buffer_load_dwordx4 v[40:43], v12, s[24:27], 0 offen offset:2048 sc1
v_mfma_f32_16x16x32_bf16 v[176:179], a[236:239], a[48:51], v[176:179]
ds_read_b128 a[244:247], v15 offset:26624
v_perm_b32 v58, v80, v19, s55
v_mfma_f32_16x16x32_bf16 v[180:183], a[236:239], a[52:55], v[180:183]
ds_read_b32 a69, v58
v_perm_b32 v57, v84, v19, s54
v_mfma_f32_16x16x32_bf16 v[184:187], a[236:239], a[56:59], v[184:187]
ds_read_b32 a70, v57
v_perm_b32 v56, v84, v19, s55
v_mfma_f32_16x16x32_bf16 v[188:191], a[236:239], a[60:63], v[188:191]
s_waitcnt lgkmcnt(4)
ds_read_b32 a71, v56
buffer_load_dwordx4 v[44:47], v12, s[24:27], 0 offen offset:3072 sc1
v_mfma_f32_16x16x32_bf16 v[192:195], a[240:243], a[48:51], v[192:195]
ds_read_b128 a[248:251], v15 offset:28672
v_perm_b32 v63, v81, v19, s52
v_mfma_f32_16x16x32_bf16 v[196:199], a[240:243], a[52:55], v[196:199]
ds_read_b32 a72, v63
v_perm_b32 v62, v81, v19, s53
v_mfma_f32_16x16x32_bf16 v[200:203], a[240:243], a[56:59], v[200:203]
s_add_u32 m0, s33, 130560
ds_read_b32 a73, v62
v_perm_b32 v61, v85, v19, s52
v_mfma_f32_16x16x32_bf16 v[204:207], a[240:243], a[60:63], v[204:207]
s_waitcnt lgkmcnt(4)
ds_read_b32 a74, v61
v_perm_b32 v60, v85, v19, s53
v_mfma_f32_16x16x32_bf16 v[208:211], a[244:247], a[48:51], v[208:211]
ds_read_b128 a[252:255], v15 offset:30720
buffer_load_dwordx4 v8, s[20:23], 0 offen offset:512 lds
v_mfma_f32_16x16x32_bf16 v[212:215], a[244:247], a[52:55], v[212:215]
ds_read_b32 a75, v60
v_perm_b32 v59, v81, v19, s54
v_mfma_f32_16x16x32_bf16 v[216:219], a[244:247], a[56:59], v[216:219]
ds_read_b32 a76, v59
v_perm_b32 v58, v81, v19, s55
v_mfma_f32_16x16x32_bf16 v[220:223], a[244:247], a[60:63], v[220:223]
s_waitcnt lgkmcnt(4)
ds_read_b32 a77, v58
v_add_u32 v12, 16384, v13
v_mfma_f32_16x16x32_bf16 v[224:227], a[248:251], a[48:51], v[224:227]
s_barrier
ds_read_b128 a[224:227], v14 offset:32768
v_perm_b32 v57, v85, v19, s54
v_mfma_f32_16x16x32_bf16 v[228:231], a[248:251], a[52:55], v[228:231]
ds_read_b32 a78, v57
v_perm_b32 v56, v85, v19, s55
v_mfma_f32_16x16x32_bf16 v[232:235], a[248:251], a[56:59], v[232:235]
ds_read_b32 a79, v56
v_and_b32 v27, 0xffff0000, v21
v_mfma_f32_16x16x32_bf16 v[236:239], a[248:251], a[60:63], v[236:239]
s_waitcnt lgkmcnt(4)
v_mfma_f32_16x16x32_bf16 v[240:243], a[252:255], a[48:51], v[240:243]
ds_read_b128 a[228:231], v14 offset:34816
v_mfma_f32_16x16x32_bf16 v[244:247], a[252:255], a[52:55], v[244:247]
v_mfma_f32_16x16x32_bf16 v[248:251], a[252:255], a[56:59], v[248:251]
s_waitcnt vmcnt(12)
v_cmp_ne_u64 s[50:51], s[88:89], v[90:91]
v_cmp_ne_u64 s[44:45], s[88:89], v[94:95]
v_mfma_f32_16x16x32_bf16 v[252:255], a[252:255], a[60:63], v[252:255]
s_waitcnt lgkmcnt(1)
v_mfma_f32_16x16x32_bf16 v[128:131], a[224:227], a[64:67], v[128:131]
s_or_b64 s[50:51], s[44:45], s[50:51]
ds_read_b128 a[232:235], v14 offset:36864
v_mfma_f32_16x16x32_bf16 v[132:135], a[224:227], a[68:71], v[132:135]
s_cbranch_scc1 L_SLOW5
L_BACK5:
v_mfma_f32_16x16x32_bf16 v[136:139], a[224:227], a[72:75], v[136:139]
s_add_u32 m0, s33, 134656
v_perm_b32 v63, v88, v19, s52
v_mfma_f32_16x16x32_bf16 v[140:143], a[224:227], a[76:79], v[140:143]
s_waitcnt lgkmcnt(1)
ds_read_b32 a80, v63
v_perm_b32 v62, v88, v19, s53
v_mfma_f32_16x16x32_bf16 v[144:147], a[228:231], a[64:67], v[144:147]
ds_read_b128 a[236:239], v14 offset:38912
buffer_load_dwordx4 v9, s[20:23], 0 offen offset:512 lds
v_mfma_f32_16x16x32_bf16 v[148:151], a[228:231], a[68:71], v[148:151]
ds_read_b32 a81, v62
v_perm_b32 v61, v92, v19, s52
v_mfma_f32_16x16x32_bf16 v[152:155], a[228:231], a[72:75], v[152:155]
ds_read_b32 a82, v61
v_perm_b32 v60, v92, v19, s53
v_mfma_f32_16x16x32_bf16 v[156:159], a[228:231], a[76:79], v[156:159]
s_waitcnt lgkmcnt(4)
ds_read_b32 a83, v60
v_mfma_f32_16x16x32_bf16 v[160:163], a[232:235], a[64:67], v[160:163]
ds_read_b128 a[240:243], v14 offset:40960
v_perm_b32 v59, v88, v19, s54
v_mfma_f32_16x16x32_bf16 v[164:167], a[232:235], a[68:71], v[164:167]
ds_read_b32 a84, v59
v_perm_b32 v58, v88, v19, s55
v_mfma_f32_16x16x32_bf16 v[168:171], a[232:235], a[72:75], v[168:171]
ds_read_b32 a85, v58
v_perm_b32 v57, v92, v19, s54
v_mfma_f32_16x16x32_bf16 v[172:175], a[232:235], a[76:79], v[172:175]
s_waitcnt lgkmcnt(4)
ds_read_b32 a86, v57
buffer_load_dwordx4 v[48:51], v12, s[24:27], 0 offen offset:0 sc1
v_mfma_f32_16x16x32_bf16 v[176:179], a[236:239], a[64:67], v[176:179]
ds_read_b128 a[244:247], v14 offset:43008
v_perm_b32 v56, v92, v19, s55
v_mfma_f32_16x16x32_bf16 v[180:183], a[236:239], a[68:71], v[180:183]
ds_read_b32 a87, v56
v_perm_b32 v63, v89, v19, s52
v_mfma_f32_16x16x32_bf16 v[184:187], a[236:239], a[72:75], v[184:187]
s_add_u32 m0, s33, 138752
ds_read_b32 a88, v63
v_perm_b32 v62, v89, v19, s53
v_mfma_f32_16x16x32_bf16 v[188:191], a[236:239], a[76:79], v[188:191]
s_waitcnt lgkmcnt(4)
ds_read_b32 a89, v62
v_perm_b32 v61, v93, v19, s52
v_mfma_f32_16x16x32_bf16 v[192:195], a[240:243], a[64:67], v[192:195]
ds_read_b128 a[248:251], v14 offset:45056
buffer_load_dwordx4 v10, s[20:23], 0 offen offset:512 lds
v_mfma_f32_16x16x32_bf16 v[196:199], a[240:243], a[68:71], v[196:199]
ds_read_b32 a90, v61
v_perm_b32 v60, v93, v19, s53
v_mfma_f32_16x16x32_bf16 v[200:203], a[240:243], a[72:75], v[200:203]
ds_read_b32 a91, v60
v_perm_b32 v59, v89, v19, s54
v_mfma_f32_16x16x32_bf16 v[204:207], a[240:243], a[76:79], v[204:207]
s_waitcnt lgkmcnt(4)
ds_read_b32 a92, v59
buffer_load_dwordx4 v[52:55], v12, s[24:27], 0 offen offset:1024 sc1
v_mfma_f32_16x16x32_bf16 v[208:211], a[244:247], a[64:67], v[208:211]
ds_read_b128 a[252:255], v14 offset:47104
v_mfma_f32_16x16x32_bf16 v[212:215], a[244:247], a[68:71], v[212:215]
s_waitcnt vmcnt(11)
v_perm_b32 v58, v89, v19, s55
v_lshl_add_u64 v[104:105], v[108:109], 4, v[104:105]
v_mfma_f32_16x16x32_bf16 v[216:219], a[244:247], a[72:75], v[216:219]
ds_read_b32 a93, v58
v_perm_b32 v57, v93, v19, s54
v_mfma_f32_16x16x32_bf16 v[220:223], a[244:247], a[76:79], v[220:223]
s_waitcnt lgkmcnt(3)
ds_read_b32 a94, v57
v_perm_b32 v56, v93, v19, s55
v_mfma_f32_16x16x32_bf16 v[224:227], a[248:251], a[64:67], v[224:227]
ds_read_b128 a[224:227], v15 offset:32768
v_lshl_add_u64 v[106:107], v[110:111], 4, v[106:107]
v_mfma_f32_16x16x32_bf16 v[228:231], a[248:251], a[68:71], v[228:231]
ds_read_b32 a95, v56
v_mfma_f32_16x16x32_bf16 v[232:235], a[248:251], a[72:75], v[232:235]
s_waitcnt vmcnt(9)
s_add_u32 m0, s33, 142848
v_cmp_ne_u64 s[50:51], s[88:89], v[34:35]
v_cmp_ne_u64 s[44:45], s[88:89], v[38:39]
v_mfma_f32_16x16x32_bf16 v[236:239], a[248:251], a[76:79], v[236:239]
s_waitcnt lgkmcnt(3)
v_lshl_add_u64 v[112:113], v[116:117], 4, v[112:113]
v_mfma_f32_16x16x32_bf16 v[240:243], a[252:255], a[64:67], v[240:243]
s_or_b64 s[50:51], s[44:45], s[50:51]
ds_read_b128 a[228:231], v15 offset:34816
buffer_load_dwordx4 v11, s[20:23], 0 offen offset:512 lds
v_mfma_f32_16x16x32_bf16 v[244:247], a[252:255], a[68:71], v[244:247]
s_cbranch_scc1 L_SLOW6
L_BACK6:
v_mfma_f32_16x16x32_bf16 v[248:251], a[252:255], a[72:75], v[248:251]
v_perm_b32 v63, v32, v19, s52
v_lshl_add_u64 v[114:115], v[118:119], 4, v[114:115]
v_mfma_f32_16x16x32_bf16 v[252:255], a[252:255], a[76:79], v[252:255]
s_waitcnt lgkmcnt(1)
ds_read_b32 a96, v63
v_mfma_f32_16x16x32_bf16 v[128:131], a[224:227], a[80:83], v[128:131]
ds_read_b128 a[232:235], v15 offset:36864
v_mfma_f32_16x16x32_bf16 v[132:135], a[224:227], a[84:87], v[132:135]
v_perm_b32 v62, v32, v19, s53
v_lshl_or_b32 v104, v112, 8, v104
v_mfma_f32_16x16x32_bf16 v[136:139], a[224:227], a[88:91], v[136:139]
ds_read_b32 a97, v62
v_perm_b32 v61, v36, v19, s52
v_mfma_f32_16x16x32_bf16 v[140:143], a[224:227], a[92:95], v[140:143]
s_waitcnt lgkmcnt(3)
ds_read_b32 a98, v61
v_perm_b32 v60, v36, v19, s53
v_mfma_f32_16x16x32_bf16 v[144:147], a[228:231], a[80:83], v[144:147]
L_PAD1:
s_cbranch_vccnz L_PADRET
ds_read_b128 a[236:239], v15 offset:38912
v_lshl_or_b32 v105, v113, 8, v105
v_mfma_f32_16x16x32_bf16 v[148:151], a[228:231], a[84:87], v[148:151]
ds_read_b32 a99, v60
v_perm_b32 v59, v32, v19, s54
v_mfma_f32_16x16x32_bf16 v[152:155], a[228:231], a[88:91], v[152:155]
ds_read_b32 a100, v59
v_perm_b32 v58, v32, v19, s55
v_mfma_f32_16x16x32_bf16 v[156:159], a[228:231], a[92:95], v[156:159]
s_waitcnt lgkmcnt(4)
ds_read_b32 a101, v58
v_lshl_or_b32 v106, v114, 8, v106
v_mfma_f32_16x16x32_bf16 v[160:163], a[232:235], a[80:83], v[160:163]
ds_read_b128 a[240:243], v15 offset:40960
v_perm_b32 v57, v36, v19, s54
v_mfma_f32_16x16x32_bf16 v[164:167], a[232:235], a[84:87], v[164:167]
ds_read_b32 a102, v57
v_mfma_f32_16x16x32_bf16 v[168:171], a[232:235], a[88:91], v[168:171]
v_perm_b32 v56, v36, v19, s55
v_lshl_or_b32 v107, v115, 8, v107
v_mfma_f32_16x16x32_bf16 v[172:175], a[232:235], a[92:95], v[172:175]
s_waitcnt lgkmcnt(3)
ds_read_b32 a103, v56
buffer_load_dwordx4 v[96:99], v12, s[24:27], 0 offen offset:2048 sc1
v_mfma_f32_16x16x32_bf16 v[176:179], a[236:239], a[80:83], v[176:179]
ds_read_b128 a[244:247], v15 offset:43008
buffer_load_dwordx4 v[100:103], v12, s[24:27], 0 offen offset:3072 sc1
v_mfma_f32_16x16x32_bf16 v[180:183], a[236:239], a[84:87], v[180:183]
v_perm_b32 v63, v33, v19, s52
v_lshl_or_b32 v108, v105, 16, v104
v_mfma_f32_16x16x32_bf16 v[184:187], a[236:239], a[88:91], v[184:187]
ds_read_b32 a104, v63
v_perm_b32 v62, v33, v19, s53
v_mfma_f32_16x16x32_bf16 v[188:191], a[236:239], a[92:95], v[188:191]
s_waitcnt lgkmcnt(3)
ds_read_b32 a105, v62
v_perm_b32 v61, v37, v19, s52
v_mfma_f32_16x16x32_bf16 v[192:195], a[240:243], a[80:83], v[192:195]
ds_read_b128 a[248:251], v15 offset:45056
v_lshl_or_b32 v109, v107, 16, v106
v_mfma_f32_16x16x32_bf16 v[196:199], a[240:243], a[84:87], v[196:199]
ds_read_b32 a106, v61
v_perm_b32 v60, v37, v19, s53
v_mfma_f32_16x16x32_bf16 v[200:203], a[240:243], a[88:91], v[200:203]
s_add_u32 m0, s33, 146816
ds_read_b32 a107, v60
v_add_u32 v12, 20480, v13
v_mfma_f32_16x16x32_bf16 v[204:207], a[240:243], a[92:95], v[204:207]
s_waitcnt lgkmcnt(4)
v_perm_b32 v59, v33, v19, s54
v_mov_b64 v[110:111], s[88:89]
v_mfma_f32_16x16x32_bf16 v[208:211], a[244:247], a[80:83], v[208:211]
ds_read_b128 a[252:255], v15 offset:47104
buffer_load_dwordx4 v8, s[20:23], 0 offen offset:640 lds
v_mfma_f32_16x16x32_bf16 v[212:215], a[244:247], a[84:87], v[212:215]
ds_read_b32 a108, v59
v_perm_b32 v58, v33, v19, s55
v_mfma_f32_16x16x32_bf16 v[216:219], a[244:247], a[88:91], v[216:219]
ds_read_b32 a109, v58
v_perm_b32 v57, v37, v19, s54
v_mfma_f32_16x16x32_bf16 v[220:223], a[244:247], a[92:95], v[220:223]
s_waitcnt lgkmcnt(3)
ds_read_b32 a110, v57
v_mfma_f32_16x16x32_bf16 v[224:227], a[248:251], a[80:83], v[224:227]
s_waitcnt vmcnt(11)
s_barrier
ds_read_b128 a[224:227], v14 offset:49152
v_perm_b32 v56, v37, v19, s55
v_mfma_f32_16x16x32_bf16 v[228:231], a[248:251], a[84:87], v[228:231]
buffer_store_dwordx4 v[108:111], v13, s[76:79], 0 offen sc1
v_mfma_f32_16x16x32_bf16 v[232:235], a[248:251], a[88:91], v[232:235]
ds_read_b32 a111, v56
v_mfma_f32_16x16x32_bf16 v[236:239], a[248:251], a[92:95], v[236:239]
s_waitcnt lgkmcnt(3)
v_mfma_f32_16x16x32_bf16 v[240:243], a[252:255], a[80:83], v[240:243]
ds_read_b128 a[228:231], v14 offset:51200
v_mfma_f32_16x16x32_bf16 v[244:247], a[252:255], a[84:87], v[244:247]
v_mfma_f32_16x16x32_bf16 v[248:251], a[252:255], a[88:91], v[248:251]
s_waitcnt vmcnt(10)
v_cmp_ne_u64 s[50:51], s[88:89], v[42:43]
v_cmp_ne_u64 s[44:45], s[88:89], v[46:47]
v_mfma_f32_16x16x32_bf16 v[252:255], a[252:255], a[92:95], v[252:255]
s_waitcnt lgkmcnt(1)
v_mfma_f32_16x16x32_bf16 v[128:131], a[224:227], a[96:99], v[128:131]
s_or_b64 s[50:51], s[44:45], s[50:51]
ds_read_b128 a[232:235], v14 offset:53248
v_mfma_f32_16x16x32_bf16 v[132:135], a[224:227], a[100:103], v[132:135]
s_cbranch_scc1 L_SLOW7
L_BACK7:
v_mfma_f32_16x16x32_bf16 v[136:139], a[224:227], a[104:107], v[136:139]
s_add_u32 m0, s33, 150912
v_mfma_f32_16x16x32_bf16 v[140:143], a[224:227], a[108:111], v[140:143]
s_waitcnt lgkmcnt(1)
v_mfma_f32_16x16x32_bf16 v[144:147], a[228:231], a[96:99], v[144:147]
ds_read_b128 a[236:239], v14 offset:55296
buffer_load_dwordx4 v9, s[20:23], 0 offen offset:640 lds
v_mfma_f32_16x16x32_bf16 v[148:151], a[228:231], a[100:103], v[148:151]
v_perm_b32 v63, v40, v19, s52
v_mfma_f32_16x16x32_bf16 v[152:155], a[228:231], a[104:107], v[152:155]
ds_read_b32 a112, v63
v_perm_b32 v62, v40, v19, s53
v_mfma_f32_16x16x32_bf16 v[156:159], a[228:231], a[108:111], v[156:159]
s_waitcnt lgkmcnt(2)
ds_read_b32 a113, v62
v_mfma_f32_16x16x32_bf16 v[160:163], a[232:235], a[96:99], v[160:163]
ds_read_b128 a[240:243], v14 offset:57344
v_perm_b32 v61, v44, v19, s52
v_mfma_f32_16x16x32_bf16 v[164:167], a[232:235], a[100:103], v[164:167]
ds_read_b32 a114, v61
v_perm_b32 v60, v44, v19, s53
v_mfma_f32_16x16x32_bf16 v[168:171], a[232:235], a[104:107], v[168:171]
ds_read_b32 a115, v60
v_perm_b32 v59, v40, v19, s54
v_mfma_f32_16x16x32_bf16 v[172:175], a[232:235], a[108:111], v[172:175]
s_waitcnt lgkmcnt(4)
ds_read_b32 a116, v59
buffer_load_dwordx4 v[80:83], v12, s[24:27], 0 offen offset:0 sc1
v_mfma_f32_16x16x32_bf16 v[176:179], a[236:239], a[96:99], v[176:179]
ds_read_b128 a[244:247], v14 offset:59392
v_perm_b32 v58, v40, v19, s55
v_mfma_f32_16x16x32_bf16 v[180:183], a[236:239], a[100:103], v[180:183]
ds_read_b32 a117, v58
v_perm_b32 v57, v44, v19, s54
v_mfma_f32_16x16x32_bf16 v[184:187], a[236:239], a[104:107], v[184:187]
s_add_u32 m0, s33, 155008
ds_read_b32 a118, v57
v_perm_b32 v56, v44, v19, s55
v_mfma_f32_16x16x32_bf16 v[188:191], a[236:239], a[108:111], v[188:191]
s_waitcnt lgkmcnt(4)
ds_read_b32 a119, v56
v_perm_b32 v63, v41, v19, s52
v_mfma_f32_16x16x32_bf16 v[192:195], a[240:243], a[96:99], v[192:195]
ds_read_b128 a[248:251], v14 offset:61440
buffer_load_dwordx4 v10, s[20:23], 0 offen offset:640 lds
v_mfma_f32_16x16x32_bf16 v[196:199], a[240:243], a[100:103], v[196:199]
ds_read_b32 a120, v63
v_perm_b32 v62, v41, v19, s53
v_mfma_f32_16x16x32_bf16 v[200:203], a[240:243], a[104:107], v[200:203]
ds_read_b32 a121, v62
v_perm_b32 v61, v45, v19, s52
v_mfma_f32_16x16x32_bf16 v[204:207], a[240:243], a[108:111], v[204:207]
s_waitcnt lgkmcnt(4)
ds_read_b32 a122, v61
buffer_load_dwordx4 v[84:87], v12, s[24:27], 0 offen offset:1024 sc1
v_mfma_f32_16x16x32_bf16 v[208:211], a[244:247], a[96:99], v[208:211]
ds_read_b128 a[252:255], v14 offset:63488
v_perm_b32 v60, v45, v19, s53
v_mfma_f32_16x16x32_bf16 v[212:215], a[244:247], a[100:103], v[212:215]
ds_read_b32 a123, v60
v_perm_b32 v59, v41, v19, s54
v_mfma_f32_16x16x32_bf16 v[216:219], a[244:247], a[104:107], v[216:219]
ds_read_b32 a124, v59
v_perm_b32 v58, v41, v19, s55
v_mfma_f32_16x16x32_bf16 v[220:223], a[244:247], a[108:111], v[220:223]
s_waitcnt lgkmcnt(4)
ds_read_b32 a125, v58
v_mfma_f32_16x16x32_bf16 v[224:227], a[248:251], a[96:99], v[224:227]
ds_read_b128 a[224:227], v15 offset:49152
v_perm_b32 v57, v45, v19, s54
v_mfma_f32_16x16x32_bf16 v[228:231], a[248:251], a[100:103], v[228:231]
ds_read_b32 a126, v57
v_perm_b32 v56, v45, v19, s55
v_mfma_f32_16x16x32_bf16 v[232:235], a[248:251], a[104:107], v[232:235]
s_add_u32 m0, s33, 159104
ds_read_b32 a127, v56
v_mfma_f32_16x16x32_bf16 v[236:239], a[248:251], a[108:111], v[236:239]
s_waitcnt lgkmcnt(4)
v_mfma_f32_16x16x32_bf16 v[240:243], a[252:255], a[96:99], v[240:243]
ds_read_b128 a[228:231], v15 offset:51200
buffer_load_dwordx4 v11, s[20:23], 0 offen offset:640 lds
v_mfma_f32_16x16x32_bf16 v[244:247], a[252:255], a[100:103], v[244:247]
v_mfma_f32_16x16x32_bf16 v[248:251], a[252:255], a[104:107], v[248:251]
v_mfma_f32_16x16x32_bf16 v[252:255], a[252:255], a[108:111], v[252:255]
s_waitcnt vmcnt(10) lgkmcnt(1)
v_cmp_ne_u64 s[50:51], s[88:89], v[50:51]
v_cmp_ne_u64 s[44:45], s[88:89], v[54:55]
v_mfma_f32_16x16x32_bf16 v[128:131], a[224:227], a[112:115], v[128:131]
ds_read_b128 a[232:235], v15 offset:53248
v_mfma_f32_16x16x32_bf16 v[132:135], a[224:227], a[116:119], v[132:135]
s_or_b64 s[50:51], s[44:45], s[50:51]
v_mfma_f32_16x16x32_bf16 v[136:139], a[224:227], a[120:123], v[136:139]
s_cbranch_scc1 L_SLOW8
L_BACK8:
v_mfma_f32_16x16x32_bf16 v[140:143], a[224:227], a[124:127], v[140:143]
s_waitcnt lgkmcnt(1)
v_mfma_f32_16x16x32_bf16 v[144:147], a[228:231], a[112:115], v[144:147]
ds_read_b128 a[236:239], v15 offset:55296
v_mfma_f32_16x16x32_bf16 v[148:151], a[228:231], a[116:119], v[148:151]
v_perm_b32 v63, v48, v19, s52
v_mfma_f32_16x16x32_bf16 v[152:155], a[228:231], a[120:123], v[152:155]
ds_read_b32 a128, v63
v_perm_b32 v62, v48, v19, s53
v_mfma_f32_16x16x32_bf16 v[156:159], a[228:231], a[124:127], v[156:159]
s_waitcnt lgkmcnt(2)
ds_read_b32 a129, v62
v_mfma_f32_16x16x32_bf16 v[160:163], a[232:235], a[112:115], v[160:163]
ds_read_b128 a[240:243], v15 offset:57344
v_perm_b32 v61, v52, v19, s52
v_mfma_f32_16x16x32_bf16 v[164:167], a[232:235], a[116:119], v[164:167]
ds_read_b32 a130, v61
v_perm_b32 v60, v52, v19, s53
v_mfma_f32_16x16x32_bf16 v[168:171], a[232:235], a[120:123], v[168:171]
ds_read_b32 a131, v60
v_perm_b32 v59, v48, v19, s54
v_mfma_f32_16x16x32_bf16 v[172:175], a[232:235], a[124:127], v[172:175]
s_waitcnt lgkmcnt(4)
ds_read_b32 a132, v59
buffer_load_dwordx4 v[88:91], v12, s[24:27], 0 offen offset:2048 sc1
v_mfma_f32_16x16x32_bf16 v[176:179], a[236:239], a[112:115], v[176:179]
ds_read_b128 a[244:247], v15 offset:59392
v_perm_b32 v58, v48, v19, s55
v_mfma_f32_16x16x32_bf16 v[180:183], a[236:239], a[116:119], v[180:183]
ds_read_b32 a133, v58
v_perm_b32 v57, v52, v19, s54
v_mfma_f32_16x16x32_bf16 v[184:187], a[236:239], a[120:123], v[184:187]
ds_read_b32 a134, v57
v_perm_b32 v56, v52, v19, s55
v_mfma_f32_16x16x32_bf16 v[188:191], a[236:239], a[124:127], v[188:191]
s_waitcnt lgkmcnt(4)
ds_read_b32 a135, v56
buffer_load_dwordx4 v[92:95], v12, s[24:27], 0 offen offset:3072 sc1
v_mfma_f32_16x16x32_bf16 v[192:195], a[240:243], a[112:115], v[192:195]
ds_read_b128 a[248:251], v15 offset:61440
v_perm_b32 v63, v49, v19, s52
v_mfma_f32_16x16x32_bf16 v[196:199], a[240:243], a[116:119], v[196:199]
ds_read_b32 a136, v63
v_perm_b32 v62, v49, v19, s53
v_mfma_f32_16x16x32_bf16 v[200:203], a[240:243], a[120:123], v[200:203]
s_add_u32 m0, s33, 64768
ds_read_b32 a137, v62
v_perm_b32 v61, v53, v19, s52
v_mfma_f32_16x16x32_bf16 v[204:207], a[240:243], a[124:127], v[204:207]
s_waitcnt lgkmcnt(4)
ds_read_b32 a138, v61
v_perm_b32 v60, v53, v19, s53
v_mfma_f32_16x16x32_bf16 v[208:211], a[244:247], a[112:115], v[208:211]
ds_read_b128 a[252:255], v15 offset:63488
buffer_load_dwordx4 v8, s[20:23], 0 offen offset:768 lds
v_mfma_f32_16x16x32_bf16 v[212:215], a[244:247], a[116:119], v[212:215]
ds_read_b32 a139, v60
v_perm_b32 v59, v49, v19, s54
v_mfma_f32_16x16x32_bf16 v[216:219], a[244:247], a[120:123], v[216:219]
ds_read_b32 a140, v59
v_perm_b32 v58, v49, v19, s55
v_mfma_f32_16x16x32_bf16 v[220:223], a[244:247], a[124:127], v[220:223]
s_waitcnt lgkmcnt(4)
ds_read_b32 a141, v58
v_add_u32 v12, 24576, v13
v_mfma_f32_16x16x32_bf16 v[224:227], a[248:251], a[112:115], v[224:227]
s_waitcnt vmcnt(12)
s_barrier
ds_read_b128 a[224:227], v16 offset:0
v_perm_b32 v57, v53, v19, s54
v_mfma_f32_16x16x32_bf16 v[228:231], a[248:251], a[116:119], v[228:231]
ds_read_b32 a142, v57
v_perm_b32 v56, v53, v19, s55
v_mfma_f32_16x16x32_bf16 v[232:235], a[248:251], a[120:123], v[232:235]
ds_read_b32 a143, v56
v_mfma_f32_16x16x32_bf16 v[236:239], a[248:251], a[124:127], v[236:239]
s_waitcnt lgkmcnt(4)
v_mfma_f32_16x16x32_bf16 v[240:243], a[252:255], a[112:115], v[240:243]
ds_read_b128 a[228:231], v16 offset:2048
v_mfma_f32_16x16x32_bf16 v[244:247], a[252:255], a[116:119], v[244:247]
v_mfma_f32_16x16x32_bf16 v[248:251], a[252:255], a[120:123], v[248:251]
s_waitcnt vmcnt(10)
v_cmp_ne_u64 s[50:51], s[88:89], v[98:99]
v_cmp_ne_u64 s[44:45], s[88:89], v[102:103]
v_mfma_f32_16x16x32_bf16 v[252:255], a[252:255], a[124:127], v[252:255]
s_waitcnt lgkmcnt(1)
v_mfma_f32_16x16x32_bf16 v[128:131], a[224:227], a[128:131], v[128:131]
s_or_b64 s[50:51], s[44:45], s[50:51]
ds_read_b128 a[232:235], v16 offset:4096
v_mfma_f32_16x16x32_bf16 v[132:135], a[224:227], a[132:135], v[132:135]
s_cbranch_scc1 L_SLOW9
L_BACK9:
v_mfma_f32_16x16x32_bf16 v[136:139], a[224:227], a[136:139], v[136:139]
s_add_u32 m0, s33, 68864
v_mfma_f32_16x16x32_bf16 v[140:143], a[224:227], a[140:143], v[140:143]
s_waitcnt lgkmcnt(1)
v_mfma_f32_16x16x32_bf16 v[144:147], a[228:231], a[128:131], v[144:147]
ds_read_b128 a[236:239], v16 offset:6144
buffer_load_dwordx4 v9, s[20:23], 0 offen offset:768 lds
v_mfma_f32_16x16x32_bf16 v[148:151], a[228:231], a[132:135], v[148:151]
v_perm_b32 v63, v96, v19, s52
v_mfma_f32_16x16x32_bf16 v[152:155], a[228:231], a[136:139], v[152:155]
ds_read_b32 a144, v63
v_perm_b32 v62, v96, v19, s53
v_mfma_f32_16x16x32_bf16 v[156:159], a[228:231], a[140:143], v[156:159]
s_waitcnt lgkmcnt(2)
ds_read_b32 a145, v62
v_mfma_f32_16x16x32_bf16 v[160:163], a[232:235], a[128:131], v[160:163]
ds_read_b128 a[240:243], v16 offset:8192
v_perm_b32 v61, v100, v19, s52
v_mfma_f32_16x16x32_bf16 v[164:167], a[232:235], a[132:135], v[164:167]
ds_read_b32 a146, v61
v_perm_b32 v60, v100, v19, s53
v_mfma_f32_16x16x32_bf16 v[168:171], a[232:235], a[136:139], v[168:171]
ds_read_b32 a147, v60
v_perm_b32 v59, v96, v19, s54
v_mfma_f32_16x16x32_bf16 v[172:175], a[232:235], a[140:143], v[172:175]
s_waitcnt lgkmcnt(4)
ds_read_b32 a148, v59
buffer_load_dwordx4 v[32:35], v12, s[24:27], 0 offen offset:0 sc1
v_mfma_f32_16x16x32_bf16 v[176:179], a[236:239], a[128:131], v[176:179]
ds_read_b128 a[244:247], v16 offset:10240
v_perm_b32 v58, v96, v19, s55
v_mfma_f32_16x16x32_bf16 v[180:183], a[236:239], a[132:135], v[180:183]
ds_read_b32 a149, v58
v_perm_b32 v57, v100, v19, s54
v_mfma_f32_16x16x32_bf16 v[184:187], a[236:239], a[136:139], v[184:187]
s_add_u32 m0, s33, 72960
ds_read_b32 a150, v57
v_perm_b32 v56, v100, v19, s55
v_mfma_f32_16x16x32_bf16 v[188:191], a[236:239], a[140:143], v[188:191]
s_waitcnt lgkmcnt(4)
ds_read_b32 a151, v56
v_perm_b32 v63, v97, v19, s52
v_mfma_f32_16x16x32_bf16 v[192:195], a[240:243], a[128:131], v[192:195]
ds_read_b128 a[248:251], v16 offset:12288
buffer_load_dwordx4 v10, s[20:23], 0 offen offset:768 lds
v_mfma_f32_16x16x32_bf16 v[196:199], a[240:243], a[132:135], v[196:199]
ds_read_b32 a152, v63
v_perm_b32 v62, v97, v19, s53
v_mfma_f32_16x16x32_bf16 v[200:203], a[240:243], a[136:139], v[200:203]
ds_read_b32 a153, v62
v_perm_b32 v61, v101, v19, s52
v_mfma_f32_16x16x32_bf16 v[204:207], a[240:243], a[140:143], v[204:207]
s_waitcnt lgkmcnt(4)
ds_read_b32 a154, v61
buffer_load_dwordx4 v[36:39], v12, s[24:27], 0 offen offset:1024 sc1
v_mfma_f32_16x16x32_bf16 v[208:211], a[244:247], a[128:131], v[208:211]
ds_read_b128 a[252:255], v16 offset:14336
v_perm_b32 v60, v101, v19, s53
v_mfma_f32_16x16x32_bf16 v[212:215], a[244:247], a[132:135], v[212:215]
ds_read_b32 a155, v60
v_perm_b32 v59, v97, v19, s54
v_mfma_f32_16x16x32_bf16 v[216:219], a[244:247], a[136:139], v[216:219]
ds_read_b32 a156, v59
v_perm_b32 v58, v97, v19, s55
v_mfma_f32_16x16x32_bf16 v[220:223], a[244:247], a[140:143], v[220:223]
s_waitcnt lgkmcnt(4)
ds_read_b32 a157, v58
v_mfma_f32_16x16x32_bf16 v[224:227], a[248:251], a[128:131], v[224:227]
ds_read_b128 a[224:227], v17 offset:0
v_perm_b32 v57, v101, v19, s54
v_mfma_f32_16x16x32_bf16 v[228:231], a[248:251], a[132:135], v[228:231]
ds_read_b32 a158, v57
v_perm_b32 v56, v101, v19, s55
v_mfma_f32_16x16x32_bf16 v[232:235], a[248:251], a[136:139], v[232:235]
s_add_u32 m0, s33, 77056
ds_read_b32 a159, v56
v_mfma_f32_16x16x32_bf16 v[236:239], a[248:251], a[140:143], v[236:239]
s_waitcnt lgkmcnt(4)
v_mfma_f32_16x16x32_bf16 v[240:243], a[252:255], a[128:131], v[240:243]
ds_read_b128 a[228:231], v17 offset:2048
buffer_load_dwordx4 v11, s[20:23], 0 offen offset:768 lds
v_mfma_f32_16x16x32_bf16 v[244:247], a[252:255], a[132:135], v[244:247]
v_mfma_f32_16x16x32_bf16 v[248:251], a[252:255], a[136:139], v[248:251]
v_mfma_f32_16x16x32_bf16 v[252:255], a[252:255], a[140:143], v[252:255]
s_waitcnt vmcnt(9) lgkmcnt(1)
v_cmp_ne_u64 s[50:51], s[88:89], v[82:83]
v_cmp_ne_u64 s[44:45], s[88:89], v[86:87]
v_mfma_f32_16x16x32_bf16 v[128:131], a[224:227], a[144:147], v[128:131]
ds_read_b128 a[232:235], v17 offset:4096
v_mfma_f32_16x16x32_bf16 v[132:135], a[224:227], a[148:151], v[132:135]
s_or_b64 s[50:51], s[44:45], s[50:51]
v_mfma_f32_16x16x32_bf16 v[136:139], a[224:227], a[152:155], v[136:139]
s_cbranch_scc1 L_SLOW10
L_BACK10:
v_mfma_f32_16x16x32_bf16 v[140:143], a[224:227], a[156:159], v[140:143]
s_waitcnt lgkmcnt(1)
v_mfma_f32_16x16x32_bf16 v[144:147], a[228:231], a[144:147], v[144:147]
ds_read_b128 a[236:239], v17 offset:6144
v_mfma_f32_16x16x32_bf16 v[148:151], a[228:231], a[148:151], v[148:151]
v_perm_b32 v63, v80, v19, s52
v_mfma_f32_16x16x32_bf16 v[152:155], a[228:231], a[152:155], v[152:155]
ds_read_b32 a160, v63
v_perm_b32 v62, v80, v19, s53
v_mfma_f32_16x16x32_bf16 v[156:159], a[228:231], a[156:159], v[156:159]
s_waitcnt lgkmcnt(2)
ds_read_b32 a161, v62
v_mfma_f32_16x16x32_bf16 v[160:163], a[232:235], a[144:147], v[160:163]
ds_read_b128 a[240:243], v17 offset:8192
v_perm_b32 v61, v84, v19, s52
v_mfma_f32_16x16x32_bf16 v[164:167], a[232:235], a[148:151], v[164:167]
ds_read_b32 a162, v61
v_perm_b32 v60, v84, v19, s53
v_mfma_f32_16x16x32_bf16 v[168:171], a[232:235], a[152:155], v[168:171]
s_add_u32 m0, s33, 81024
ds_read_b32 a163, v60
v_perm_b32 v59, v80, v19, s54
v_mfma_f32_16x16x32_bf16 v[172:175], a[232:235], a[156:159], v[172:175]
s_waitcnt lgkmcnt(4)
ds_read_b32 a164, v59
v_perm_b32 v58, v80, v19, s55
v_mfma_f32_16x16x32_bf16 v[176:179], a[236:239], a[144:147], v[176:179]
ds_read_b128 a[244:247], v17 offset:10240
buffer_load_dwordx4 v8, s[20:23], 0 offen offset:896 lds
v_mfma_f32_16x16x32_bf16 v[180:183], a[236:239], a[148:151], v[180:183]
ds_read_b32 a165, v58
v_perm_b32 v57, v84, v19, s54
v_mfma_f32_16x16x32_bf16 v[184:187], a[236:239], a[152:155], v[184:187]
ds_read_b32 a166, v57
v_perm_b32 v56, v84, v19, s55
v_mfma_f32_16x16x32_bf16 v[188:191], a[236:239], a[156:159], v[188:191]
s_waitcnt lgkmcnt(4)
ds_read_b32 a167, v56
buffer_load_dwordx4 v[40:43], v12, s[24:27], 0 offen offset:2048 sc1
v_mfma_f32_16x16x32_bf16 v[192:195], a[240:243], a[144:147], v[192:195]
ds_read_b128 a[248:251], v17 offset:12288
v_perm_b32 v63, v81, v19, s52
v_mfma_f32_16x16x32_bf16 v[196:199], a[240:243], a[148:151], v[196:199]
ds_read_b32 a168, v63
v_perm_b32 v62, v81, v19, s53
v_mfma_f32_16x16x32_bf16 v[200:203], a[240:243], a[152:155], v[200:203]
s_add_u32 m0, s33, 85120
ds_read_b32 a169, v62
v_perm_b32 v61, v85, v19, s52
v_mfma_f32_16x16x32_bf16 v[204:207], a[240:243], a[156:159], v[204:207]
s_waitcnt lgkmcnt(4)
ds_read_b32 a170, v61
v_perm_b32 v60, v85, v19, s53
v_mfma_f32_16x16x32_bf16 v[208:211], a[244:247], a[144:147], v[208:211]
ds_read_b128 a[252:255], v17 offset:14336
buffer_load_dwordx4 v9, s[20:23], 0 offen offset:896 lds
v_mfma_f32_16x16x32_bf16 v[212:215], a[244:247], a[148:151], v[212:215]
ds_read_b32 a171, v60
v_perm_b32 v59, v81, v19, s54
v_mfma_f32_16x16x32_bf16 v[216:219], a[244:247], a[152:155], v[216:219]
ds_read_b32 a172, v59
v_perm_b32 v58, v81, v19, s55
v_mfma_f32_16x16x32_bf16 v[220:223], a[244:247], a[156:159], v[220:223]
s_waitcnt lgkmcnt(4)
ds_read_b32 a173, v58
buffer_load_dwordx4 v[44:47], v12, s[24:27], 0 offen offset:3072 sc1
v_mfma_f32_16x16x32_bf16 v[224:227], a[248:251], a[144:147], v[224:227]
s_waitcnt vmcnt(12)
s_barrier
ds_read_b128 a[224:227], v16 offset:16384
v_perm_b32 v57, v85, v19, s54
v_mfma_f32_16x16x32_bf16 v[228:231], a[248:251], a[148:151], v[228:231]
ds_read_b32 a174, v57
v_perm_b32 v56, v85, v19, s55
v_mfma_f32_16x16x32_bf16 v[232:235], a[248:251], a[152:155], v[232:235]
ds_read_b32 a175, v56
v_add_u32 v12, 28672, v13
v_mfma_f32_16x16x32_bf16 v[236:239], a[248:251], a[156:159], v[236:239]
s_waitcnt lgkmcnt(4)
v_mfma_f32_16x16x32_bf16 v[240:243], a[252:255], a[144:147], v[240:243]
ds_read_b128 a[228:231], v16 offset:18432
v_mfma_f32_16x16x32_bf16 v[244:247], a[252:255], a[148:151], v[244:247]
v_mfma_f32_16x16x32_bf16 v[248:251], a[252:255], a[152:155], v[248:251]
s_waitcnt vmcnt(10)
v_cmp_ne_u64 s[50:51], s[88:89], v[90:91]
v_cmp_ne_u64 s[44:45], s[88:89], v[94:95]
v_mfma_f32_16x16x32_bf16 v[252:255], a[252:255], a[156:159], v[252:255]
s_waitcnt lgkmcnt(1)
v_mfma_f32_16x16x32_bf16 v[128:131], a[224:227], a[160:163], v[128:131]
s_or_b64 s[50:51], s[44:45], s[50:51]
ds_read_b128 a[232:235], v16 offset:20480
v_mfma_f32_16x16x32_bf16 v[132:135], a[224:227], a[164:167], v[132:135]
s_cbranch_scc1 L_SLOW11
L_BACK11:
v_mfma_f32_16x16x32_bf16 v[136:139], a[224:227], a[168:171], v[136:139]
s_add_u32 m0, s33, 89216
v_mfma_f32_16x16x32_bf16 v[140:143], a[224:227], a[172:175], v[140:143]
s_waitcnt lgkmcnt(1)
v_mfma_f32_16x16x32_bf16 v[144:147], a[228:231], a[160:163], v[144:147]
ds_read_b128 a[236:239], v16 offset:22528
buffer_load_dwordx4 v10, s[20:23], 0 offen offset:896 lds
v_mfma_f32_16x16x32_bf16 v[148:151], a[228:231], a[164:167], v[148:151]
v_perm_b32 v63, v88, v19, s52
v_mfma_f32_16x16x32_bf16 v[152:155], a[228:231], a[168:171], v[152:155]
ds_read_b32 a176, v63
v_perm_b32 v62, v88, v19, s53
v_mfma_f32_16x16x32_bf16 v[156:159], a[228:231], a[172:175], v[156:159]
s_waitcnt lgkmcnt(2)
ds_read_b32 a177, v62
v_mfma_f32_16x16x32_bf16 v[160:163], a[232:235], a[160:163], v[160:163]
ds_read_b128 a[240:243], v16 offset:24576
v_perm_b32 v61, v92, v19, s52
v_mfma_f32_16x16x32_bf16 v[164:167], a[232:235], a[164:167], v[164:167]
ds_read_b32 a178, v61
v_perm_b32 v60, v92, v19, s53
v_mfma_f32_16x16x32_bf16 v[168:171], a[232:235], a[168:171], v[168:171]
ds_read_b32 a179, v60
v_perm_b32 v59, v88, v19, s54
v_mfma_f32_16x16x32_bf16 v[172:175], a[232:235], a[172:175], v[172:175]
s_waitcnt lgkmcnt(4)
ds_read_b32 a180, v59
buffer_load_dwordx4 v[48:51], v12, s[24:27], 0 offen offset:0 sc1
v_mfma_f32_16x16x32_bf16 v[176:179], a[236:239], a[160:163], v[176:179]
ds_read_b128 a[244:247], v16 offset:26624
v_perm_b32 v58, v88, v19, s55
v_mfma_f32_16x16x32_bf16 v[180:183], a[236:239], a[164:167], v[180:183]
ds_read_b32 a181, v58
v_perm_b32 v57, v92, v19, s54
v_mfma_f32_16x16x32_bf16 v[184:187], a[236:239], a[168:171], v[184:187]
s_add_u32 m0, s33, 93312
ds_read_b32 a182, v57
v_perm_b32 v56, v92, v19, s55
v_mfma_f32_16x16x32_bf16 v[188:191], a[236:239], a[172:175], v[188:191]
s_waitcnt lgkmcnt(4)
ds_read_b32 a183, v56
v_perm_b32 v63, v89, v19, s52
v_mfma_f32_16x16x32_bf16 v[192:195], a[240:243], a[160:163], v[192:195]
ds_read_b128 a[248:251], v16 offset:28672
buffer_load_dwordx4 v11, s[20:23], 0 offen offset:896 lds
v_mfma_f32_16x16x32_bf16 v[196:199], a[240:243], a[164:167], v[196:199]
ds_read_b32 a184, v63
v_perm_b32 v62, v89, v19, s53
v_mfma_f32_16x16x32_bf16 v[200:203], a[240:243], a[168:171], v[200:203]
ds_read_b32 a185, v62
v_perm_b32 v61, v93, v19, s52
v_mfma_f32_16x16x32_bf16 v[204:207], a[240:243], a[172:175], v[204:207]
s_waitcnt lgkmcnt(4)
ds_read_b32 a186, v61
buffer_load_dwordx4 v[52:55], v12, s[24:27], 0 offen offset:1024 sc1
v_mfma_f32_16x16x32_bf16 v[208:211], a[244:247], a[160:163], v[208:211]
ds_read_b128 a[252:255], v16 offset:30720
v_perm_b32 v60, v93, v19, s53
v_mfma_f32_16x16x32_bf16 v[212:215], a[244:247], a[164:167], v[212:215]
ds_read_b32 a187, v60
v_perm_b32 v59, v89, v19, s54
v_mfma_f32_16x16x32_bf16 v[216:219], a[244:247], a[168:171], v[216:219]
ds_read_b32 a188, v59
v_perm_b32 v58, v89, v19, s55
v_mfma_f32_16x16x32_bf16 v[220:223], a[244:247], a[172:175], v[220:223]
s_waitcnt lgkmcnt(4)
ds_read_b32 a189, v58
v_mfma_f32_16x16x32_bf16 v[224:227], a[248:251], a[160:163], v[224:227]
ds_read_b128 a[224:227], v17 offset:16384
v_perm_b32 v57, v93, v19, s54
v_mfma_f32_16x16x32_bf16 v[228:231], a[248:251], a[164:167], v[228:231]
ds_read_b32 a190, v57
v_perm_b32 v56, v93, v19, s55
v_mfma_f32_16x16x32_bf16 v[232:235], a[248:251], a[168:171], v[232:235]
s_add_u32 m0, s33, 97280
ds_read_b32 a191, v56
v_mfma_f32_16x16x32_bf16 v[236:239], a[248:251], a[172:175], v[236:239]
s_waitcnt lgkmcnt(4)
v_mfma_f32_16x16x32_bf16 v[240:243], a[252:255], a[160:163], v[240:243]
ds_read_b128 a[228:231], v17 offset:18432
buffer_load_dwordx4 v8, s[20:23], 0 offen offset:1024 lds
v_mfma_f32_16x16x32_bf16 v[244:247], a[252:255], a[164:167], v[244:247]
v_mfma_f32_16x16x32_bf16 v[248:251], a[252:255], a[168:171], v[248:251]
v_mfma_f32_16x16x32_bf16 v[252:255], a[252:255], a[172:175], v[252:255]
L_PAD2:
s_cbranch_vccnz L_PAD3
s_waitcnt vmcnt(10) lgkmcnt(1)
v_cmp_ne_u64 s[50:51], s[88:89], v[34:35]
v_cmp_ne_u64 s[44:45], s[88:89], v[38:39]
v_mfma_f32_16x16x32_bf16 v[128:131], a[224:227], a[176:179], v[128:131]
ds_read_b128 a[232:235], v17 offset:20480
buffer_load_dwordx4 v[96:99], v12, s[24:27], 0 offen offset:2048 sc1
v_mfma_f32_16x16x32_bf16 v[132:135], a[224:227], a[180:183], v[132:135]
s_or_b64 s[50:51], s[44:45], s[50:51]
buffer_load_dwordx4 v[100:103], v12, s[24:27], 0 offen offset:3072 sc1
v_mfma_f32_16x16x32_bf16 v[136:139], a[224:227], a[184:187], v[136:139]
s_cbranch_scc1 L_SLOW12
L_BACK12:
v_mfma_f32_16x16x32_bf16 v[140:143], a[224:227], a[188:191], v[140:143]
s_waitcnt lgkmcnt(1)
v_add_u32 v12, 32768, v13
v_mfma_f32_16x16x32_bf16 v[144:147], a[228:231], a[176:179], v[144:147]
ds_read_b128 a[236:239], v17 offset:22528
v_mfma_f32_16x16x32_bf16 v[148:151], a[228:231], a[180:183], v[148:151]
v_perm_b32 v63, v32, v19, s52
v_mfma_f32_16x16x32_bf16 v[152:155], a[228:231], a[184:187], v[152:155]
ds_read_b32 a192, v63
v_perm_b32 v62, v32, v19, s53
v_mfma_f32_16x16x32_bf16 v[156:159], a[228:231], a[188:191], v[156:159]
s_waitcnt lgkmcnt(2)
ds_read_b32 a193, v62
v_mfma_f32_16x16x32_bf16 v[160:163], a[232:235], a[176:179], v[160:163]
ds_read_b128 a[240:243], v17 offset:24576
v_perm_b32 v61, v36, v19, s52
v_mfma_f32_16x16x32_bf16 v[164:167], a[232:235], a[180:183], v[164:167]
ds_read_b32 a194, v61
v_perm_b32 v60, v36, v19, s53
v_mfma_f32_16x16x32_bf16 v[168:171], a[232:235], a[184:187], v[168:171]
ds_read_b32 a195, v60
v_perm_b32 v59, v32, v19, s54
v_mfma_f32_16x16x32_bf16 v[172:175], a[232:235], a[188:191], v[172:175]
s_waitcnt lgkmcnt(4)
ds_read_b32 a196, v59
v_mfma_f32_16x16x32_bf16 v[176:179], a[236:239], a[176:179], v[176:179]
ds_read_b128 a[244:247], v17 offset:26624
v_perm_b32 v58, v32, v19, s55
v_mfma_f32_16x16x32_bf16 v[180:183], a[236:239], a[180:183], v[180:183]
ds_read_b32 a197, v58
v_perm_b32 v57, v36, v19, s54
v_mfma_f32_16x16x32_bf16 v[184:187], a[236:239], a[184:187], v[184:187]
ds_read_b32 a198, v57
v_perm_b32 v56, v36, v19, s55
v_mfma_f32_16x16x32_bf16 v[188:191], a[236:239], a[188:191], v[188:191]
s_waitcnt lgkmcnt(4)
ds_read_b32 a199, v56
v_mfma_f32_16x16x32_bf16 v[192:195], a[240:243], a[176:179], v[192:195]
ds_read_b128 a[248:251], v17 offset:28672
v_perm_b32 v63, v33, v19, s52
v_mfma_f32_16x16x32_bf16 v[196:199], a[240:243], a[180:183], v[196:199]
ds_read_b32 a200, v63
v_perm_b32 v62, v33, v19, s53
v_mfma_f32_16x16x32_bf16 v[200:203], a[240:243], a[184:187], v[200:203]
s_add_u32 m0, s33, 101376
ds_read_b32 a201, v62
v_perm_b32 v61, v37, v19, s52
v_mfma_f32_16x16x32_bf16 v[204:207], a[240:243], a[188:191], v[204:207]
s_waitcnt lgkmcnt(4)
ds_read_b32 a202, v61
v_perm_b32 v60, v37, v19, s53
v_mfma_f32_16x16x32_bf16 v[208:211], a[244:247], a[176:179], v[208:211]
ds_read_b128 a[252:255], v17 offset:30720
buffer_load_dwordx4 v9, s[20:23], 0 offen offset:1024 lds
v_mfma_f32_16x16x32_bf16 v[212:215], a[244:247], a[180:183], v[212:215]
ds_read_b32 a203, v60
v_perm_b32 v59, v33, v19, s54
v_mfma_f32_16x16x32_bf16 v[216:219], a[244:247], a[184:187], v[216:219]
ds_read_b32 a204, v59
v_perm_b32 v58, v33, v19, s55
v_mfma_f32_16x16x32_bf16 v[220:223], a[244:247], a[188:191], v[220:223]
s_waitcnt lgkmcnt(4)
ds_read_b32 a205, v58
v_mfma_f32_16x16x32_bf16 v[224:227], a[248:251], a[176:179], v[224:227]
s_waitcnt vmcnt(12)
s_barrier
ds_read_b128 a[224:227], v14 offset:0
v_perm_b32 v57, v37, v19, s54
v_mfma_f32_16x16x32_bf16 v[228:231], a[248:251], a[180:183], v[228:231]
ds_read_b32 a206, v57
v_perm_b32 v56, v37, v19, s55
v_mfma_f32_16x16x32_bf16 v[232:235], a[248:251], a[184:187], v[232:235]
ds_read_b32 a207, v56
buffer_load_dwordx4 v[80:83], v12, s[24:27], 0 offen offset:0 sc1
v_mfma_f32_16x16x32_bf16 v[236:239], a[248:251], a[188:191], v[236:239]
s_waitcnt lgkmcnt(4)
buffer_load_dwordx4 v[84:87], v12, s[24:27], 0 offen offset:1024 sc1
v_mfma_f32_16x16x32_bf16 v[240:243], a[252:255], a[176:179], v[240:243]
ds_read_b128 a[228:231], v14 offset:2048
v_mfma_f32_16x16x32_bf16 v[244:247], a[252:255], a[180:183], v[244:247]
v_mfma_f32_16x16x32_bf16 v[248:251], a[252:255], a[184:187], v[248:251]
s_waitcnt vmcnt(10)
v_cmp_ne_u64 s[50:51], s[88:89], v[42:43]
v_cmp_ne_u64 s[44:45], s[88:89], v[46:47]
v_mfma_f32_16x16x32_bf16 v[252:255], a[252:255], a[188:191], v[252:255]
s_waitcnt lgkmcnt(1)
v_mfma_f32_16x16x32_bf16 v[128:131], a[224:227], a[192:195], v[128:131]
s_or_b64 s[50:51], s[44:45], s[50:51]
ds_read_b128 a[232:235], v14 offset:4096
v_mfma_f32_16x16x32_bf16 v[132:135], a[224:227], a[196:199], v[132:135]
s_cbranch_scc1 L_SLOW13
L_BACK13:
v_mfma_f32_16x16x32_bf16 v[136:139], a[224:227], a[200:203], v[136:139]
s_add_u32 m0, s33, 105472
v_mfma_f32_16x16x32_bf16 v[140:143], a[224:227], a[204:207], v[140:143]
s_waitcnt lgkmcnt(1)
v_mfma_f32_16x16x32_bf16 v[144:147], a[228:231], a[192:195], v[144:147]
ds_read_b128 a[236:239], v14 offset:6144
buffer_load_dwordx4 v10, s[20:23], 0 offen offset:1024 lds
v_mfma_f32_16x16x32_bf16 v[148:151], a[228:231], a[196:199], v[148:151]
v_perm_b32 v63, v40, v19, s52
v_mfma_f32_16x16x32_bf16 v[152:155], a[228:231], a[200:203], v[152:155]
ds_read_b32 a208, v63
v_perm_b32 v62, v40, v19, s53
v_mfma_f32_16x16x32_bf16 v[156:159], a[228:231], a[204:207], v[156:159]
s_waitcnt lgkmcnt(2)
ds_read_b32 a209, v62
v_mfma_f32_16x16x32_bf16 v[160:163], a[232:235], a[192:195], v[160:163]
ds_read_b128 a[240:243], v14 offset:8192
v_perm_b32 v61, v44, v19, s52
v_mfma_f32_16x16x32_bf16 v[164:167], a[232:235], a[196:199], v[164:167]
ds_read_b32 a210, v61
v_perm_b32 v60, v44, v19, s53
v_mfma_f32_16x16x32_bf16 v[168:171], a[232:235], a[200:203], v[168:171]
ds_read_b32 a211, v60
v_perm_b32 v59, v40, v19, s54
v_mfma_f32_16x16x32_bf16 v[172:175], a[232:235], a[204:207], v[172:175]
s_waitcnt lgkmcnt(4)
ds_read_b32 a212, v59
v_mfma_f32_16x16x32_bf16 v[176:179], a[236:239], a[192:195], v[176:179]
ds_read_b128 a[244:247], v14 offset:10240
v_perm_b32 v58, v40, v19, s55
v_mfma_f32_16x16x32_bf16 v[180:183], a[236:239], a[196:199], v[180:183]
ds_read_b32 a213, v58
v_perm_b32 v57, v44, v19, s54
v_mfma_f32_16x16x32_bf16 v[184:187], a[236:239], a[200:203], v[184:187]
s_add_u32 m0, s33, 109440
ds_read_b32 a214, v57
v_perm_b32 v56, v44, v19, s55
v_mfma_f32_16x16x32_bf16 v[188:191], a[236:239], a[204:207], v[188:191]
s_waitcnt lgkmcnt(4)
ds_read_b32 a215, v56
v_perm_b32 v63, v41, v19, s52
v_mfma_f32_16x16x32_bf16 v[192:195], a[240:243], a[192:195], v[192:195]
ds_read_b128 a[248:251], v14 offset:12288
buffer_load_dwordx4 v8, s[20:23], 0 offen offset:1152 lds
v_mfma_f32_16x16x32_bf16 v[196:199], a[240:243], a[196:199], v[196:199]
ds_read_b32 a216, v63
v_perm_b32 v62, v41, v19, s53
v_mfma_f32_16x16x32_bf16 v[200:203], a[240:243], a[200:203], v[200:203]
ds_read_b32 a217, v62
v_perm_b32 v61, v45, v19, s52
v_mfma_f32_16x16x32_bf16 v[204:207], a[240:243], a[204:207], v[204:207]
s_waitcnt lgkmcnt(4)
ds_read_b32 a218, v61
buffer_load_dwordx4 v[88:91], v12, s[24:27], 0 offen offset:2048 sc1
v_mfma_f32_16x16x32_bf16 v[208:211], a[244:247], a[192:195], v[208:211]
ds_read_b128 a[252:255], v14 offset:14336
v_perm_b32 v60, v45, v19, s53
v_mfma_f32_16x16x32_bf16 v[212:215], a[244:247], a[196:199], v[212:215]
ds_read_b32 a219, v60
v_perm_b32 v59, v41, v19, s54
v_mfma_f32_16x16x32_bf16 v[216:219], a[244:247], a[200:203], v[216:219]
ds_read_b32 a220, v59
v_perm_b32 v58, v41, v19, s55
v_mfma_f32_16x16x32_bf16 v[220:223], a[244:247], a[204:207], v[220:223]
s_waitcnt lgkmcnt(4)
ds_read_b32 a221, v58
buffer_load_dwordx4 v[92:95], v12, s[24:27], 0 offen offset:3072 sc1
v_mfma_f32_16x16x32_bf16 v[224:227], a[248:251], a[192:195], v[224:227]
ds_read_b128 a[224:227], v15 offset:0
v_perm_b32 v57, v45, v19, s54
v_mfma_f32_16x16x32_bf16 v[228:231], a[248:251], a[196:199], v[228:231]
ds_read_b32 a222, v57
v_perm_b32 v56, v45, v19, s55
v_mfma_f32_16x16x32_bf16 v[232:235], a[248:251], a[200:203], v[232:235]
s_add_u32 m0, s33, 113664
ds_read_b32 a223, v56
v_add_u32 v12, 36864, v13
v_mfma_f32_16x16x32_bf16 v[236:239], a[248:251], a[204:207], v[236:239]
s_waitcnt lgkmcnt(4)
v_mfma_f32_16x16x32_bf16 v[240:243], a[252:255], a[192:195], v[240:243]
ds_read_b128 a[228:231], v15 offset:2048
buffer_load_dwordx4 v11, s[20:23], 0 offen offset:1024 lds
v_mfma_f32_16x16x32_bf16 v[244:247], a[252:255], a[196:199], v[244:247]
v_mfma_f32_16x16x32_bf16 v[248:251], a[252:255], a[200:203], v[248:251]
s_waitcnt vmcnt(11)
v_cmp_ne_u64 s[50:51], s[88:89], v[50:51]
v_cmp_ne_u64 s[44:45], s[88:89], v[54:55]
v_mfma_f32_16x16x32_bf16 v[252:255], a[252:255], a[204:207], v[252:255]
s_waitcnt lgkmcnt(1)
v_mfma_f32_16x16x32_bf16 v[128:131], a[224:227], a[208:211], v[128:131]
s_or_b64 s[50:51], s[44:45], s[50:51]
ds_read_b128 a[232:235], v15 offset:4096
v_mfma_f32_16x16x32_bf16 v[132:135], a[224:227], a[212:215], v[132:135]
s_cbranch_scc1 L_SLOW14
L_BACK14:
v_mfma_f32_16x16x32_bf16 v[136:139], a[224:227], a[216:219], v[136:139]
v_perm_b32 v63, v48, v19, s52
v_mfma_f32_16x16x32_bf16 v[140:143], a[224:227], a[220:223], v[140:143]
s_waitcnt lgkmcnt(1)
ds_read_b32 a0, v63
v_mfma_f32_16x16x32_bf16 v[144:147], a[228:231], a[208:211], v[144:147]
ds_read_b128 a[236:239], v15 offset:6144
v_perm_b32 v62, v48, v19, s53
v_mfma_f32_16x16x32_bf16 v[148:151], a[228:231], a[212:215], v[148:151]
ds_read_b32 a1, v62
v_perm_b32 v61, v52, v19, s52
v_mfma_f32_16x16x32_bf16 v[152:155], a[228:231], a[216:219], v[152:155]
ds_read_b32 a2, v61
v_perm_b32 v60, v52, v19, s53
v_mfma_f32_16x16x32_bf16 v[156:159], a[228:231], a[220:223], v[156:159]
s_waitcnt lgkmcnt(4)
ds_read_b32 a3, v60
v_mfma_f32_16x16x32_bf16 v[160:163], a[232:235], a[208:211], v[160:163]
ds_read_b128 a[240:243], v15 offset:8192
v_perm_b32 v59, v48, v19, s54
v_mfma_f32_16x16x32_bf16 v[164:167], a[232:235], a[212:215], v[164:167]
ds_read_b32 a4, v59
v_perm_b32 v58, v48, v19, s55
v_mfma_f32_16x16x32_bf16 v[168:171], a[232:235], a[216:219], v[168:171]
ds_read_b32 a5, v58
v_perm_b32 v57, v52, v19, s54
v_mfma_f32_16x16x32_bf16 v[172:175], a[232:235], a[220:223], v[172:175]
s_waitcnt lgkmcnt(4)
ds_read_b32 a6, v57
buffer_load_dwordx4 v[32:35], v12, s[24:27], 0 offen offset:0 sc1
v_mfma_f32_16x16x32_bf16 v[176:179], a[236:239], a[208:211], v[176:179]
ds_read_b128 a[244:247], v15 offset:10240
v_perm_b32 v56, v52, v19, s55
v_mfma_f32_16x16x32_bf16 v[180:183], a[236:239], a[212:215], v[180:183]
ds_read_b32 a7, v56
v_perm_b32 v63, v49, v19, s52
v_mfma_f32_16x16x32_bf16 v[184:187], a[236:239], a[216:219], v[184:187]
ds_read_b32 a8, v63
v_perm_b32 v62, v49, v19, s53
v_mfma_f32_16x16x32_bf16 v[188:191], a[236:239], a[220:223], v[188:191]
s_waitcnt lgkmcnt(4)
ds_read_b32 a9, v62
buffer_load_dwordx4 v[36:39], v12, s[24:27], 0 offen offset:1024 sc1
v_mfma_f32_16x16x32_bf16 v[192:195], a[240:243], a[208:211], v[192:195]
ds_read_b128 a[248:251], v15 offset:12288
v_perm_b32 v61, v53, v19, s52
v_mfma_f32_16x16x32_bf16 v[196:199], a[240:243], a[212:215], v[196:199]
ds_read_b32 a10, v61
v_perm_b32 v60, v53, v19, s53
v_mfma_f32_16x16x32_bf16 v[200:203], a[240:243], a[216:219], v[200:203]
s_add_u32 m0, s33, 117632
ds_read_b32 a11, v60
v_perm_b32 v59, v49, v19, s54
v_mfma_f32_16x16x32_bf16 v[204:207], a[240:243], a[220:223], v[204:207]
s_waitcnt vmcnt(10) lgkmcnt(4)
v_cmp_ne_u64 s[50:51], s[88:89], v[98:99]
v_cmp_ne_u64 s[44:45], s[88:89], v[102:103]
v_mfma_f32_16x16x32_bf16 v[208:211], a[244:247], a[208:211], v[208:211]
ds_read_b128 a[252:255], v15 offset:14336
buffer_load_dwordx4 v9, s[20:23], 0 offen offset:1152 lds
v_mfma_f32_16x16x32_bf16 v[212:215], a[244:247], a[212:215], v[212:215]
ds_read_b32 a12, v59
v_perm_b32 v58, v49, v19, s55
v_mfma_f32_16x16x32_bf16 v[216:219], a[244:247], a[216:219], v[216:219]
s_or_b64 s[50:51], s[44:45], s[50:51]
ds_read_b32 a13, v58
v_perm_b32 v57, v53, v19, s54
v_mfma_f32_16x16x32_bf16 v[220:223], a[244:247], a[220:223], v[220:223]
s_waitcnt lgkmcnt(3)
ds_read_b32 a14, v57
v_mfma_f32_16x16x32_bf16 v[224:227], a[248:251], a[208:211], v[224:227]
s_barrier
ds_read_b128 a[224:227], v14 offset:16384
v_perm_b32 v56, v53, v19, s55
v_mfma_f32_16x16x32_bf16 v[228:231], a[248:251], a[212:215], v[228:231]
s_cbranch_scc1 L_SLOW15
L_BACK15:
v_mfma_f32_16x16x32_bf16 v[232:235], a[248:251], a[216:219], v[232:235]
ds_read_b32 a15, v56
v_perm_b32 v63, v96, v19, s52
v_mfma_f32_16x16x32_bf16 v[236:239], a[248:251], a[220:223], v[236:239]
s_waitcnt lgkmcnt(3)
ds_read_b32 a16, v63
v_mfma_f32_16x16x32_bf16 v[240:243], a[252:255], a[208:211], v[240:243]
ds_read_b128 a[228:231], v14 offset:18432
v_perm_b32 v62, v96, v19, s53
v_mfma_f32_16x16x32_bf16 v[244:247], a[252:255], a[212:215], v[244:247]
ds_read_b32 a17, v62
v_perm_b32 v61, v100, v19, s52
v_mfma_f32_16x16x32_bf16 v[248:251], a[252:255], a[216:219], v[248:251]
ds_read_b32 a18, v61
v_perm_b32 v60, v100, v19, s53
v_mfma_f32_16x16x32_bf16 v[252:255], a[252:255], a[220:223], v[252:255]
s_waitcnt lgkmcnt(4)
ds_read_b32 a19, v60
v_mfma_f32_16x16x32_bf16 v[128:131], a[224:227], a[0:3], v[128:131]
ds_read_b128 a[232:235], v14 offset:20480
v_perm_b32 v59, v96, v19, s54
v_mfma_f32_16x16x32_bf16 v[132:135], a[224:227], a[4:7], v[132:135]
ds_read_b32 a20, v59
v_perm_b32 v58, v96, v19, s55
v_mfma_f32_16x16x32_bf16 v[136:139], a[224:227], a[8:11], v[136:139]
s_add_u32 m0, s33, 121600
ds_read_b32 a21, v58
v_perm_b32 v57, v100, v19, s54
v_mfma_f32_16x16x32_bf16 v[140:143], a[224:227], a[12:15], v[140:143]
s_waitcnt lgkmcnt(4)
ds_read_b32 a22, v57
v_perm_b32 v56, v100, v19, s55
v_mfma_f32_16x16x32_bf16 v[144:147], a[228:231], a[0:3], v[144:147]
ds_read_b128 a[236:239], v14 offset:22528
buffer_load_dwordx4 v8, s[20:23], 0 offen offset:1280 lds
v_mfma_f32_16x16x32_bf16 v[148:151], a[228:231], a[4:7], v[148:151]
ds_read_b32 a23, v56
v_perm_b32 v63, v97, v19, s52
v_mfma_f32_16x16x32_bf16 v[152:155], a[228:231], a[8:11], v[152:155]
ds_read_b32 a24, v63
v_perm_b32 v62, v97, v19, s53
v_mfma_f32_16x16x32_bf16 v[156:159], a[228:231], a[12:15], v[156:159]
s_waitcnt lgkmcnt(4)
ds_read_b32 a25, v62
buffer_load_dwordx4 v[40:43], v12, s[24:27], 0 offen offset:2048 sc1
v_mfma_f32_16x16x32_bf16 v[160:163], a[232:235], a[0:3], v[160:163]
ds_read_b128 a[240:243], v14 offset:24576
v_perm_b32 v61, v101, v19, s52
v_mfma_f32_16x16x32_bf16 v[164:167], a[232:235], a[4:7], v[164:167]
ds_read_b32 a26, v61
v_perm_b32 v60, v101, v19, s53
v_mfma_f32_16x16x32_bf16 v[168:171], a[232:235], a[8:11], v[168:171]
ds_read_b32 a27, v60
v_perm_b32 v59, v97, v19, s54
v_mfma_f32_16x16x32_bf16 v[172:175], a[232:235], a[12:15], v[172:175]
s_waitcnt lgkmcnt(4)
ds_read_b32 a28, v59
buffer_load_dwordx4 v[44:47], v12, s[24:27], 0 offen offset:3072 sc1
v_mfma_f32_16x16x32_bf16 v[176:179], a[236:239], a[0:3], v[176:179]
ds_read_b128 a[244:247], v14 offset:26624
v_perm_b32 v58, v97, v19, s55
v_mfma_f32_16x16x32_bf16 v[180:183], a[236:239], a[4:7], v[180:183]
ds_read_b32 a29, v58
v_perm_b32 v57, v101, v19, s54
v_mfma_f32_16x16x32_bf16 v[184:187], a[236:239], a[8:11], v[184:187]
s_waitcnt vmcnt(11)
s_add_u32 m0, s33, 125824
v_cmp_ne_u64 s[50:51], s[88:89], v[82:83]
v_cmp_ne_u64 s[44:45], s[88:89], v[86:87]
v_mfma_f32_16x16x32_bf16 v[188:191], a[236:239], a[12:15], v[188:191]
s_waitcnt lgkmcnt(3)
ds_read_b32 a30, v57
v_perm_b32 v56, v101, v19, s55
v_mfma_f32_16x16x32_bf16 v[192:195], a[240:243], a[0:3], v[192:195]
s_or_b64 s[50:51], s[44:45], s[50:51]
ds_read_b128 a[248:251], v14 offset:28672
buffer_load_dwordx4 v10, s[20:23], 0 offen offset:1152 lds
v_mfma_f32_16x16x32_bf16 v[196:199], a[240:243], a[4:7], v[196:199]
s_cbranch_scc1 L_SLOW16
L_BACK16:
v_mfma_f32_16x16x32_bf16 v[200:203], a[240:243], a[8:11], v[200:203]
ds_read_b32 a31, v56
v_perm_b32 v63, v80, v19, s52
v_mfma_f32_16x16x32_bf16 v[204:207], a[240:243], a[12:15], v[204:207]
s_waitcnt lgkmcnt(3)
ds_read_b32 a32, v63
v_add_u32 v12, 40960, v13
v_mfma_f32_16x16x32_bf16 v[208:211], a[244:247], a[0:3], v[208:211]
ds_read_b128 a[252:255], v14 offset:30720
v_perm_b32 v62, v80, v19, s53
v_mfma_f32_16x16x32_bf16 v[212:215], a[244:247], a[4:7], v[212:215]
ds_read_b32 a33, v62
v_perm_b32 v61, v84, v19, s52
v_mfma_f32_16x16x32_bf16 v[216:219], a[244:247], a[8:11], v[216:219]
ds_read_b32 a34, v61
v_perm_b32 v60, v84, v19, s53
v_mfma_f32_16x16x32_bf16 v[220:223], a[244:247], a[12:15], v[220:223]
s_waitcnt lgkmcnt(4)
ds_read_b32 a35, v60
v_mfma_f32_16x16x32_bf16 v[224:227], a[248:251], a[0:3], v[224:227]
ds_read_b128 a[224:227], v15 offset:16384
v_perm_b32 v59, v80, v19, s54
v_mfma_f32_16x16x32_bf16 v[228:231], a[248:251], a[4:7], v[228:231]
ds_read_b32 a36, v59
v_perm_b32 v58, v80, v19, s55
v_mfma_f32_16x16x32_bf16 v[232:235], a[248:251], a[8:11], v[232:235]
s_add_u32 m0, s33, 129792
ds_read_b32 a37, v58
v_perm_b32 v57, v84, v19, s54
v_mfma_f32_16x16x32_bf16 v[236:239], a[248:251], a[12:15], v[236:239]
s_waitcnt lgkmcnt(4)
ds_read_b32 a38, v57
v_perm_b32 v56, v84, v19, s55
v_mfma_f32_16x16x32_bf16 v[240:243], a[252:255], a[0:3], v[240:243]
ds_read_b128 a[228:231], v15 offset:18432
buffer_load_dwordx4 v9, s[20:23], 0 offen offset:1280 lds
v_mfma_f32_16x16x32_bf16 v[244:247], a[252:255], a[4:7], v[244:247]
ds_read_b32 a39, v56
v_perm_b32 v63, v81, v19, s52
v_mfma_f32_16x16x32_bf16 v[248:251], a[252:255], a[8:11], v[248:251]
ds_read_b32 a40, v63
v_perm_b32 v62, v81, v19, s53
v_mfma_f32_16x16x32_bf16 v[252:255], a[252:255], a[12:15], v[252:255]
s_waitcnt lgkmcnt(4)
ds_read_b32 a41, v62
buffer_load_dwordx4 v[48:51], v12, s[24:27], 0 offen offset:0 sc1
v_mfma_f32_16x16x32_bf16 v[128:131], a[224:227], a[16:19], v[128:131]
ds_read_b128 a[232:235], v15 offset:20480
v_perm_b32 v61, v85, v19, s52
v_mfma_f32_16x16x32_bf16 v[132:135], a[224:227], a[20:23], v[132:135]
ds_read_b32 a42, v61
v_perm_b32 v60, v85, v19, s53
v_mfma_f32_16x16x32_bf16 v[136:139], a[224:227], a[24:27], v[136:139]
ds_read_b32 a43, v60
v_perm_b32 v59, v81, v19, s54
v_mfma_f32_16x16x32_bf16 v[140:143], a[224:227], a[28:31], v[140:143]
s_waitcnt lgkmcnt(4)
ds_read_b32 a44, v59
buffer_load_dwordx4 v[52:55], v12, s[24:27], 0 offen offset:1024 sc1
v_mfma_f32_16x16x32_bf16 v[144:147], a[228:231], a[16:19], v[144:147]
ds_read_b128 a[236:239], v15 offset:22528
v_perm_b32 v58, v81, v19, s55
v_mfma_f32_16x16x32_bf16 v[148:151], a[228:231], a[20:23], v[148:151]
ds_read_b32 a45, v58
v_perm_b32 v57, v85, v19, s54
v_mfma_f32_16x16x32_bf16 v[152:155], a[228:231], a[24:27], v[152:155]
s_waitcnt vmcnt(11)
v_cmp_ne_u64 s[50:51], s[88:89], v[90:91]
v_cmp_ne_u64 s[44:45], s[88:89], v[94:95]
v_mfma_f32_16x16x32_bf16 v[156:159], a[228:231], a[28:31], v[156:159]
s_waitcnt lgkmcnt(3)
ds_read_b32 a46, v57
v_mfma_f32_16x16x32_bf16 v[160:163], a[232:235], a[16:19], v[160:163]
s_or_b64 s[50:51], s[44:45], s[50:51]
ds_read_b128 a[240:243], v15 offset:24576
v_perm_b32 v56, v85, v19, s55
v_mfma_f32_16x16x32_bf16 v[164:167], a[232:235], a[20:23], v[164:167]
s_cbranch_scc1 L_SLOW17
L_BACK17:
v_mfma_f32_16x16x32_bf16 v[168:171], a[232:235], a[24:27], v[168:171]
s_add_u32 m0, s33, 133760
ds_read_b32 a47, v56
v_perm_b32 v63, v88, v19, s52
v_mfma_f32_16x16x32_bf16 v[172:175], a[232:235], a[28:31], v[172:175]
s_waitcnt lgkmcnt(3)
ds_read_b32 a48, v63
v_perm_b32 v62, v88, v19, s53
v_mfma_f32_16x16x32_bf16 v[176:179], a[236:239], a[16:19], v[176:179]
ds_read_b128 a[244:247], v15 offset:26624
buffer_load_dwordx4 v8, s[20:23], 0 offen offset:1408 lds
v_mfma_f32_16x16x32_bf16 v[180:183], a[236:239], a[20:23], v[180:183]
ds_read_b32 a49, v62
v_perm_b32 v61, v92, v19, s52
v_mfma_f32_16x16x32_bf16 v[184:187], a[236:239], a[24:27], v[184:187]
ds_read_b32 a50, v61
v_perm_b32 v60, v92, v19, s53
v_mfma_f32_16x16x32_bf16 v[188:191], a[236:239], a[28:31], v[188:191]
s_waitcnt lgkmcnt(4)
ds_read_b32 a51, v60
v_mfma_f32_16x16x32_bf16 v[192:195], a[240:243], a[16:19], v[192:195]
ds_read_b128 a[248:251], v14 offset:32768
v_perm_b32 v59, v88, v19, s54
v_mfma_f32_16x16x32_bf16 v[196:199], a[240:243], a[20:23], v[196:199]
ds_read_b32 a52, v59
v_perm_b32 v58, v88, v19, s55
v_mfma_f32_16x16x32_bf16 v[200:203], a[240:243], a[24:27], v[200:203]
s_add_u32 m0, s33, 137984
ds_read_b32 a53, v58
v_perm_b32 v57, v92, v19, s54
v_mfma_f32_16x16x32_bf16 v[204:207], a[240:243], a[28:31], v[204:207]
s_waitcnt lgkmcnt(4)
ds_read_b32 a54, v57
v_perm_b32 v56, v92, v19, s55
v_mfma_f32_16x16x32_bf16 v[208:211], a[244:247], a[16:19], v[208:211]
ds_read_b128 a[252:255], v14 offset:34816
buffer_load_dwordx4 v10, s[20:23], 0 offen offset:1280 lds
v_mfma_f32_16x16x32_bf16 v[212:215], a[244:247], a[20:23], v[212:215]
ds_read_b32 a55, v56
v_perm_b32 v63, v89, v19, s52
v_mfma_f32_16x16x32_bf16 v[216:219], a[244:247], a[24:27], v[216:219]
ds_read_b32 a56, v63
v_perm_b32 v62, v89, v19, s53
v_mfma_f32_16x16x32_bf16 v[220:223], a[244:247], a[28:31], v[220:223]
s_waitcnt lgkmcnt(4)
ds_read_b32 a57, v62
buffer_load_dwordx4 v[96:99], v12, s[24:27], 0 offen offset:2048 sc1
v_mfma_f32_16x16x32_bf16 v[128:131], a[248:251], a[32:35], v[128:131]
s_waitcnt vmcnt(13)
s_barrier
ds_read_b128 a[224:227], v15 offset:28672
v_perm_b32 v61, v93, v19, s52
v_mfma_f32_16x16x32_bf16 v[132:135], a[248:251], a[36:39], v[132:135]
ds_read_b32 a58, v61
v_perm_b32 v60, v93, v19, s53
v_mfma_f32_16x16x32_bf16 v[136:139], a[248:251], a[40:43], v[136:139]
ds_read_b32 a59, v60
v_perm_b32 v59, v89, v19, s54
v_mfma_f32_16x16x32_bf16 v[140:143], a[248:251], a[44:47], v[140:143]
s_waitcnt lgkmcnt(4)
ds_read_b32 a60, v59
buffer_load_dwordx4 v[100:103], v12, s[24:27], 0 offen offset:3072 sc1
v_mfma_f32_16x16x32_bf16 v[144:147], a[252:255], a[32:35], v[144:147]
ds_read_b128 a[228:231], v15 offset:30720
v_perm_b32 v58, v89, v19, s55
v_mfma_f32_16x16x32_bf16 v[148:151], a[252:255], a[36:39], v[148:151]
ds_read_b32 a61, v58
v_perm_b32 v57, v93, v19, s54
v_mfma_f32_16x16x32_bf16 v[152:155], a[252:255], a[40:43], v[152:155]
s_waitcnt vmcnt(12)
v_cmp_ne_u64 s[50:51], s[88:89], v[34:35]
v_cmp_ne_u64 s[44:45], s[88:89], v[38:39]
v_mfma_f32_16x16x32_bf16 v[156:159], a[252:255], a[44:47], v[156:159]
s_waitcnt lgkmcnt(3)
ds_read_b32 a62, v57
v_add_u32 v12, 45056, v13
v_mfma_f32_16x16x32_bf16 v[224:227], a[224:227], a[16:19], v[224:227]
s_or_b64 s[50:51], s[44:45], s[50:51]
ds_read_b128 a[232:235], v14 offset:36864
v_perm_b32 v56, v93, v19, s55
v_mfma_f32_16x16x32_bf16 v[228:231], a[224:227], a[20:23], v[228:231]
s_cbranch_scc1 L_SLOW18
L_BACK18:
v_mfma_f32_16x16x32_bf16 v[232:235], a[224:227], a[24:27], v[232:235]
s_add_u32 m0, s33, 142208
ds_read_b32 a63, v56
v_perm_b32 v63, v32, v19, s52
v_mfma_f32_16x16x32_bf16 v[236:239], a[224:227], a[28:31], v[236:239]
s_waitcnt lgkmcnt(3)
ds_read_b32 a64, v63
v_perm_b32 v62, v32, v19, s53
v_mfma_f32_16x16x32_bf16 v[240:243], a[228:231], a[16:19], v[240:243]
ds_read_b128 a[236:239], v14 offset:38912
buffer_load_dwordx4 v11, s[20:23], 0 offen offset:1152 lds
v_mfma_f32_16x16x32_bf16 v[244:247], a[228:231], a[20:23], v[244:247]
ds_read_b32 a65, v62
v_perm_b32 v61, v36, v19, s52
v_mfma_f32_16x16x32_bf16 v[248:251], a[228:231], a[24:27], v[248:251]
ds_read_b32 a66, v61
v_perm_b32 v60, v36, v19, s53
v_mfma_f32_16x16x32_bf16 v[252:255], a[228:231], a[28:31], v[252:255]
s_waitcnt lgkmcnt(4)
ds_read_b32 a67, v60
v_mfma_f32_16x16x32_bf16 v[160:163], a[232:235], a[32:35], v[160:163]
ds_read_b128 a[240:243], v15 offset:32768
v_perm_b32 v59, v32, v19, s54
v_mfma_f32_16x16x32_bf16 v[164:167], a[232:235], a[36:39], v[164:167]
ds_read_b32 a68, v59
v_perm_b32 v58, v32, v19, s55
v_mfma_f32_16x16x32_bf16 v[168:171], a[232:235], a[40:43], v[168:171]
ds_read_b32 a69, v58
v_perm_b32 v57, v36, v19, s54
v_mfma_f32_16x16x32_bf16 v[172:175], a[232:235], a[44:47], v[172:175]
s_waitcnt lgkmcnt(4)
ds_read_b32 a70, v57
buffer_load_dwordx4 v[80:83], v12, s[24:27], 0 offen offset:0 sc1
v_mfma_f32_16x16x32_bf16 v[176:179], a[236:239], a[32:35], v[176:179]
L_PAD3:
s_cbranch_vccnz L_PADRET
ds_read_b128 a[244:247], v15 offset:34816
v_perm_b32 v56, v36, v19, s55
v_mfma_f32_16x16x32_bf16 v[180:183], a[236:239], a[36:39], v[180:183]
ds_read_b32 a71, v56
v_perm_b32 v63, v33, v19, s52
v_mfma_f32_16x16x32_bf16 v[184:187], a[236:239], a[40:43], v[184:187]
s_add_u32 m0, s33, 146048
ds_read_b32 a72, v63
v_perm_b32 v62, v33, v19, s53
v_mfma_f32_16x16x32_bf16 v[188:191], a[236:239], a[44:47], v[188:191]
s_waitcnt lgkmcnt(4)
ds_read_b32 a73, v62
v_perm_b32 v61, v37, v19, s52
v_mfma_f32_16x16x32_bf16 v[128:131], a[240:243], a[48:51], v[128:131]
ds_read_b128 a[248:251], v14 offset:40960
buffer_load_dwordx4 v9, s[20:23], 0 offen offset:1408 lds
v_mfma_f32_16x16x32_bf16 v[132:135], a[240:243], a[52:55], v[132:135]
ds_read_b32 a74, v61
v_perm_b32 v60, v37, v19, s53
v_mfma_f32_16x16x32_bf16 v[136:139], a[240:243], a[56:59], v[136:139]
ds_read_b32 a75, v60
v_perm_b32 v59, v33, v19, s54
v_mfma_f32_16x16x32_bf16 v[140:143], a[240:243], a[60:63], v[140:143]
s_waitcnt lgkmcnt(4)
ds_read_b32 a76, v59
buffer_load_dwordx4 v[84:87], v12, s[24:27], 0 offen offset:1024 sc1
v_mfma_f32_16x16x32_bf16 v[144:147], a[244:247], a[48:51], v[144:147]
ds_read_b128 a[252:255], v14 offset:43008
v_perm_b32 v58, v33, v19, s55
v_mfma_f32_16x16x32_bf16 v[148:151], a[244:247], a[52:55], v[148:151]
ds_read_b32 a77, v58
v_perm_b32 v57, v37, v19, s54
v_mfma_f32_16x16x32_bf16 v[152:155], a[244:247], a[56:59], v[152:155]
s_waitcnt vmcnt(12)
v_cmp_ne_u64 s[50:51], s[88:89], v[42:43]
v_cmp_ne_u64 s[44:45], s[88:89], v[46:47]
v_mfma_f32_16x16x32_bf16 v[156:159], a[244:247], a[60:63], v[156:159]
s_waitcnt lgkmcnt(3)
ds_read_b32 a78, v57
v_mfma_f32_16x16x32_bf16 v[192:195], a[248:251], a[32:35], v[192:195]
s_or_b64 s[50:51], s[44:45], s[50:51]
ds_read_b128 a[224:227], v15 offset:36864
v_perm_b32 v56, v37, v19, s55
v_mfma_f32_16x16x32_bf16 v[196:199], a[248:251], a[36:39], v[196:199]
s_cbranch_scc1 L_SLOW19
L_BACK19:
v_mfma_f32_16x16x32_bf16 v[200:203], a[248:251], a[40:43], v[200:203]
s_add_u32 m0, s33, 150016
ds_read_b32 a79, v56
v_perm_b32 v63, v40, v19, s52
v_mfma_f32_16x16x32_bf16 v[204:207], a[248:251], a[44:47], v[204:207]
s_waitcnt lgkmcnt(3)
ds_read_b32 a80, v63
v_perm_b32 v62, v40, v19, s53
v_mfma_f32_16x16x32_bf16 v[208:211], a[252:255], a[32:35], v[208:211]
ds_read_b128 a[228:231], v15 offset:38912
buffer_load_dwordx4 v8, s[20:23], 0 offen offset:1536 lds
v_mfma_f32_16x16x32_bf16 v[212:215], a[252:255], a[36:39], v[212:215]
ds_read_b32 a81, v62
v_perm_b32 v61, v44, v19, s52
v_mfma_f32_16x16x32_bf16 v[216:219], a[252:255], a[40:43], v[216:219]
ds_read_b32 a82, v61
v_perm_b32 v60, v44, v19, s53
v_mfma_f32_16x16x32_bf16 v[220:223], a[252:255], a[44:47], v[220:223]
s_waitcnt lgkmcnt(4)
ds_read_b32 a83, v60
buffer_load_dwordx4 v[88:91], v12, s[24:27], 0 offen offset:2048 sc1
v_mfma_f32_16x16x32_bf16 v[160:163], a[224:227], a[48:51], v[160:163]
ds_read_b128 a[232:235], v14 offset:45056
v_perm_b32 v59, v40, v19, s54
v_mfma_f32_16x16x32_bf16 v[164:167], a[224:227], a[52:55], v[164:167]
ds_read_b32 a84, v59
v_perm_b32 v58, v40, v19, s55
v_mfma_f32_16x16x32_bf16 v[168:171], a[224:227], a[56:59], v[168:171]
ds_read_b32 a85, v58
v_perm_b32 v57, v44, v19, s54
v_mfma_f32_16x16x32_bf16 v[172:175], a[224:227], a[60:63], v[172:175]
s_waitcnt lgkmcnt(4)
ds_read_b32 a86, v57
buffer_load_dwordx4 v[92:95], v12, s[24:27], 0 offen offset:3072 sc1
v_mfma_f32_16x16x32_bf16 v[176:179], a[228:231], a[48:51], v[176:179]
ds_read_b128 a[236:239], v14 offset:47104
v_perm_b32 v56, v44, v19, s55
v_mfma_f32_16x16x32_bf16 v[180:183], a[228:231], a[52:55], v[180:183]
ds_read_b32 a87, v56
v_perm_b32 v63, v41, v19, s52
v_mfma_f32_16x16x32_bf16 v[184:187], a[228:231], a[56:59], v[184:187]
ds_read_b32 a88, v63
v_perm_b32 v62, v41, v19, s53
v_mfma_f32_16x16x32_bf16 v[188:191], a[228:231], a[60:63], v[188:191]
s_waitcnt lgkmcnt(4)
ds_read_b32 a89, v62
v_add_u32 v12, 49152, v13
v_mfma_f32_16x16x32_bf16 v[128:131], a[232:235], a[64:67], v[128:131]
ds_read_b128 a[240:243], v15 offset:40960
v_perm_b32 v61, v45, v19, s52
v_mfma_f32_16x16x32_bf16 v[132:135], a[232:235], a[68:71], v[132:135]
ds_read_b32 a90, v61
v_perm_b32 v60, v45, v19, s53
v_mfma_f32_16x16x32_bf16 v[136:139], a[232:235], a[72:75], v[136:139]
ds_read_b32 a91, v60
v_perm_b32 v59, v41, v19, s54
v_mfma_f32_16x16x32_bf16 v[140:143], a[232:235], a[76:79], v[140:143]
s_waitcnt lgkmcnt(4)
ds_read_b32 a92, v59
v_mfma_f32_16x16x32_bf16 v[144:147], a[236:239], a[64:67], v[144:147]
ds_read_b128 a[244:247], v15 offset:43008
v_perm_b32 v58, v41, v19, s55
v_mfma_f32_16x16x32_bf16 v[148:151], a[236:239], a[68:71], v[148:151]
ds_read_b32 a93, v58
v_perm_b32 v57, v45, v19, s54
v_mfma_f32_16x16x32_bf16 v[152:155], a[236:239], a[72:75], v[152:155]
s_waitcnt vmcnt(11)
v_cmp_ne_u64 s[50:51], s[88:89], v[50:51]
v_cmp_ne_u64 s[44:45], s[88:89], v[54:55]
v_mfma_f32_16x16x32_bf16 v[156:159], a[236:239], a[76:79], v[156:159]
s_waitcnt lgkmcnt(3)
ds_read_b32 a94, v57
v_mfma_f32_16x16x32_bf16 v[192:195], a[240:243], a[48:51], v[192:195]
s_or_b64 s[50:51], s[44:45], s[50:51]
ds_read_b128 a[248:251], v14 offset:49152
v_perm_b32 v56, v45, v19, s55
v_mfma_f32_16x16x32_bf16 v[196:199], a[240:243], a[52:55], v[196:199]
s_cbranch_scc1 L_SLOW20
L_BACK20:
v_mfma_f32_16x16x32_bf16 v[200:203], a[240:243], a[56:59], v[200:203]
ds_read_b32 a95, v56
v_perm_b32 v63, v48, v19, s52
v_mfma_f32_16x16x32_bf16 v[204:207], a[240:243], a[60:63], v[204:207]
s_waitcnt lgkmcnt(3)
ds_read_b32 a96, v63
v_mfma_f32_16x16x32_bf16 v[208:211], a[244:247], a[48:51], v[208:211]
ds_read_b128 a[252:255], v14 offset:51200
v_perm_b32 v62, v48, v19, s53
v_mfma_f32_16x16x32_bf16 v[212:215], a[244:247], a[52:55], v[212:215]
ds_read_b32 a97, v62
v_perm_b32 v61, v52, v19, s52
v_mfma_f32_16x16x32_bf16 v[216:219], a[244:247], a[56:59], v[216:219]
ds_read_b32 a98, v61
v_perm_b32 v60, v52, v19, s53
v_mfma_f32_16x16x32_bf16 v[220:223], a[244:247], a[60:63], v[220:223]
s_waitcnt lgkmcnt(4)
ds_read_b32 a99, v60
v_mfma_f32_16x16x32_bf16 v[224:227], a[248:251], a[32:35], v[224:227]
s_barrier
ds_read_b128 a[224:227], v14 offset:53248
v_perm_b32 v59, v48, v19, s54
v_mfma_f32_16x16x32_bf16 v[228:231], a[248:251], a[36:39], v[228:231]
ds_read_b32 a100, v59
v_perm_b32 v58, v48, v19, s55
v_mfma_f32_16x16x32_bf16 v[232:235], a[248:251], a[40:43], v[232:235]
ds_read_b32 a101, v58
v_perm_b32 v57, v52, v19, s54
v_mfma_f32_16x16x32_bf16 v[236:239], a[248:251], a[44:47], v[236:239]
s_waitcnt lgkmcnt(4)
ds_read_b32 a102, v57
buffer_load_dwordx4 v[32:35], v12, s[24:27], 0 offen offset:0 sc1
v_mfma_f32_16x16x32_bf16 v[240:243], a[252:255], a[32:35], v[240:243]
ds_read_b128 a[228:231], v14 offset:55296
v_perm_b32 v56, v52, v19, s55
v_mfma_f32_16x16x32_bf16 v[244:247], a[252:255], a[36:39], v[244:247]
ds_read_b32 a103, v56
v_perm_b32 v63, v49, v19, s52
v_mfma_f32_16x16x32_bf16 v[248:251], a[252:255], a[40:43], v[248:251]
ds_read_b32 a104, v63
v_perm_b32 v62, v49, v19, s53
v_mfma_f32_16x16x32_bf16 v[252:255], a[252:255], a[44:47], v[252:255]
s_waitcnt lgkmcnt(4)
ds_read_b32 a105, v62
buffer_load_dwordx4 v[36:39], v12, s[24:27], 0 offen offset:1024 sc1
v_mfma_f32_16x16x32_bf16 v[160:163], a[224:227], a[64:67], v[160:163]
ds_read_b128 a[232:235], v15 offset:45056
v_perm_b32 v61, v53, v19, s52
v_mfma_f32_16x16x32_bf16 v[164:167], a[224:227], a[68:71], v[164:167]
ds_read_b32 a106, v61
v_perm_b32 v60, v53, v19, s53
v_mfma_f32_16x16x32_bf16 v[168:171], a[224:227], a[72:75], v[168:171]
s_add_u32 m0, s33, 154112
ds_read_b32 a107, v60
v_perm_b32 v59, v49, v19, s54
v_mfma_f32_16x16x32_bf16 v[172:175], a[224:227], a[76:79], v[172:175]
s_waitcnt lgkmcnt(4)
ds_read_b32 a108, v59
v_perm_b32 v58, v49, v19, s55
v_mfma_f32_16x16x32_bf16 v[176:179], a[228:231], a[64:67], v[176:179]
ds_read_b128 a[236:239], v15 offset:47104
buffer_load_dwordx4 v9, s[20:23], 0 offen offset:1536 lds
v_mfma_f32_16x16x32_bf16 v[180:183], a[228:231], a[68:71], v[180:183]
ds_read_b32 a109, v58
v_perm_b32 v57, v53, v19, s54
v_mfma_f32_16x16x32_bf16 v[184:187], a[228:231], a[72:75], v[184:187]
s_waitcnt vmcnt(10)
v_cmp_ne_u64 s[50:51], s[88:89], v[98:99]
v_cmp_ne_u64 s[44:45], s[88:89], v[102:103]
v_mfma_f32_16x16x32_bf16 v[188:191], a[228:231], a[76:79], v[188:191]
s_waitcnt lgkmcnt(3)
ds_read_b32 a110, v57
v_mfma_f32_16x16x32_bf16 v[128:131], a[232:235], a[80:83], v[128:131]
s_or_b64 s[50:51], s[44:45], s[50:51]
ds_read_b128 a[240:243], v15 offset:53248
v_perm_b32 v56, v53, v19, s55
v_mfma_f32_16x16x32_bf16 v[132:135], a[232:235], a[84:87], v[132:135]
s_cbranch_scc1 L_SLOW21
L_BACK21:
v_mfma_f32_16x16x32_bf16 v[136:139], a[232:235], a[88:91], v[136:139]
ds_read_b32 a111, v56
v_perm_b32 v63, v96, v19, s52
v_mfma_f32_16x16x32_bf16 v[140:143], a[232:235], a[92:95], v[140:143]
s_waitcnt lgkmcnt(3)
ds_read_b32 a112, v63
v_mfma_f32_16x16x32_bf16 v[144:147], a[236:239], a[80:83], v[144:147]
ds_read_b128 a[244:247], v15 offset:55296
v_perm_b32 v62, v96, v19, s53
v_mfma_f32_16x16x32_bf16 v[148:151], a[236:239], a[84:87], v[148:151]
ds_read_b32 a113, v62
v_perm_b32 v61, v100, v19, s52
v_mfma_f32_16x16x32_bf16 v[152:155], a[236:239], a[88:91], v[152:155]
s_add_u32 m0, s33, 158080
ds_read_b32 a114, v61
v_perm_b32 v60, v100, v19, s53
v_mfma_f32_16x16x32_bf16 v[156:159], a[236:239], a[92:95], v[156:159]
s_waitcnt lgkmcnt(4)
ds_read_b32 a115, v60
v_perm_b32 v59, v96, v19, s54
v_mfma_f32_16x16x32_bf16 v[160:163], a[240:243], a[80:83], v[160:163]
ds_read_b128 a[248:251], v14 offset:57344
buffer_load_dwordx4 v8, s[20:23], 0 offen offset:1664 lds
v_mfma_f32_16x16x32_bf16 v[164:167], a[240:243], a[84:87], v[164:167]
ds_read_b32 a116, v59
v_perm_b32 v58, v96, v19, s55
v_mfma_f32_16x16x32_bf16 v[168:171], a[240:243], a[88:91], v[168:171]
ds_read_b32 a117, v58
v_perm_b32 v57, v100, v19, s54
v_mfma_f32_16x16x32_bf16 v[172:175], a[240:243], a[92:95], v[172:175]
s_waitcnt lgkmcnt(4)
ds_read_b32 a118, v57
buffer_load_dwordx4 v[40:43], v12, s[24:27], 0 offen offset:2048 sc1
v_mfma_f32_16x16x32_bf16 v[176:179], a[244:247], a[80:83], v[176:179]
ds_read_b128 a[252:255], v14 offset:59392
v_perm_b32 v56, v100, v19, s55
v_mfma_f32_16x16x32_bf16 v[180:183], a[244:247], a[84:87], v[180:183]
ds_read_b32 a119, v56
v_perm_b32 v63, v97, v19, s52
v_mfma_f32_16x16x32_bf16 v[184:187], a[244:247], a[88:91], v[184:187]
ds_read_b32 a120, v63
v_perm_b32 v62, v97, v19, s53
v_mfma_f32_16x16x32_bf16 v[188:191], a[244:247], a[92:95], v[188:191]
s_waitcnt lgkmcnt(4)
ds_read_b32 a121, v62
buffer_load_dwordx4 v[44:47], v12, s[24:27], 0 offen offset:3072 sc1
v_mfma_f32_16x16x32_bf16 v[128:131], a[248:251], a[96:99], v[128:131]
ds_read_b128 a[224:227], v14 offset:61440
v_perm_b32 v61, v101, v19, s52
v_mfma_f32_16x16x32_bf16 v[132:135], a[248:251], a[100:103], v[132:135]
ds_read_b32 a122, v61
v_perm_b32 v60, v101, v19, s53
v_mfma_f32_16x16x32_bf16 v[136:139], a[248:251], a[104:107], v[136:139]
s_add_u32 m0, s33, 64128
ds_read_b32 a123, v60
v_perm_b32 v59, v97, v19, s54
v_mfma_f32_16x16x32_bf16 v[140:143], a[248:251], a[108:111], v[140:143]
s_waitcnt lgkmcnt(4)
ds_read_b32 a124, v59
v_perm_b32 v58, v97, v19, s55
v_mfma_f32_16x16x32_bf16 v[144:147], a[252:255], a[96:99], v[144:147]
ds_read_b128 a[228:231], v14 offset:63488
buffer_load_dwordx4 v10, s[20:23], 0 offen offset:1408 lds
v_mfma_f32_16x16x32_bf16 v[148:151], a[252:255], a[100:103], v[148:151]
ds_read_b32 a125, v58
v_perm_b32 v57, v101, v19, s54
v_mfma_f32_16x16x32_bf16 v[152:155], a[252:255], a[104:107], v[152:155]
s_waitcnt vmcnt(10)
v_cmp_ne_u64 s[50:51], s[88:89], v[82:83]
v_cmp_ne_u64 s[44:45], s[88:89], v[86:87]
v_mfma_f32_16x16x32_bf16 v[156:159], a[252:255], a[108:111], v[156:159]
s_waitcnt lgkmcnt(3)
ds_read_b32 a126, v57
v_add_u32 v12, 53248, v13
v_mfma_f32_16x16x32_bf16 v[192:195], a[224:227], a[64:67], v[192:195]
s_or_b64 s[50:51], s[44:45], s[50:51]
ds_read_b128 a[232:235], v15 offset:49152
v_perm_b32 v56, v101, v19, s55
v_mfma_f32_16x16x32_bf16 v[196:199], a[224:227], a[68:71], v[196:199]
s_cbranch_scc1 L_SLOW22
L_BACK22:
v_mfma_f32_16x16x32_bf16 v[200:203], a[224:227], a[72:75], v[200:203]
ds_read_b32 a127, v56
v_perm_b32 v63, v80, v19, s52
v_mfma_f32_16x16x32_bf16 v[204:207], a[224:227], a[76:79], v[204:207]
s_waitcnt lgkmcnt(3)
ds_read_b32 a128, v63
v_mfma_f32_16x16x32_bf16 v[208:211], a[228:231], a[64:67], v[208:211]
ds_read_b128 a[236:239], v15 offset:51200
v_perm_b32 v62, v80, v19, s53
v_mfma_f32_16x16x32_bf16 v[212:215], a[228:231], a[68:71], v[212:215]
ds_read_b32 a129, v62
v_perm_b32 v61, v84, v19, s52
v_mfma_f32_16x16x32_bf16 v[216:219], a[228:231], a[72:75], v[216:219]
s_add_u32 m0, s33, 68352
ds_read_b32 a130, v61
v_perm_b32 v60, v84, v19, s53
v_mfma_f32_16x16x32_bf16 v[220:223], a[228:231], a[76:79], v[220:223]
s_waitcnt lgkmcnt(4)
ds_read_b32 a131, v60
v_perm_b32 v59, v80, v19, s54
v_mfma_f32_16x16x32_bf16 v[224:227], a[232:235], a[48:51], v[224:227]
ds_read_b128 a[240:243], v15 offset:57344
buffer_load_dwordx4 v11, s[20:23], 0 offen offset:1280 lds
v_mfma_f32_16x16x32_bf16 v[228:231], a[232:235], a[52:55], v[228:231]
ds_read_b32 a132, v59
v_perm_b32 v58, v80, v19, s55
v_mfma_f32_16x16x32_bf16 v[232:235], a[232:235], a[56:59], v[232:235]
ds_read_b32 a133, v58
v_perm_b32 v57, v84, v19, s54
v_mfma_f32_16x16x32_bf16 v[236:239], a[232:235], a[60:63], v[236:239]
s_waitcnt lgkmcnt(4)
ds_read_b32 a134, v57
buffer_load_dwordx4 v[48:51], v12, s[24:27], 0 offen offset:0 sc1
v_mfma_f32_16x16x32_bf16 v[240:243], a[236:239], a[48:51], v[240:243]
ds_read_b128 a[244:247], v15 offset:59392
v_perm_b32 v56, v84, v19, s55
v_mfma_f32_16x16x32_bf16 v[244:247], a[236:239], a[52:55], v[244:247]
ds_read_b32 a135, v56
v_perm_b32 v63, v81, v19, s52
v_mfma_f32_16x16x32_bf16 v[248:251], a[236:239], a[56:59], v[248:251]
ds_read_b32 a136, v63
v_perm_b32 v62, v81, v19, s53
v_mfma_f32_16x16x32_bf16 v[252:255], a[236:239], a[60:63], v[252:255]
s_waitcnt lgkmcnt(4)
ds_read_b32 a137, v62
buffer_load_dwordx4 v[52:55], v12, s[24:27], 0 offen offset:1024 sc1
v_mfma_f32_16x16x32_bf16 v[128:131], a[240:243], a[112:115], v[128:131]
ds_read_b128 a[248:251], v16 offset:0
v_perm_b32 v61, v85, v19, s52
v_mfma_f32_16x16x32_bf16 v[132:135], a[240:243], a[116:119], v[132:135]
ds_read_b32 a138, v61
v_perm_b32 v60, v85, v19, s53
v_mfma_f32_16x16x32_bf16 v[136:139], a[240:243], a[120:123], v[136:139]
s_add_u32 m0, s33, 71936
ds_read_b32 a139, v60
v_perm_b32 v59, v81, v19, s54
v_mfma_f32_16x16x32_bf16 v[140:143], a[240:243], a[124:127], v[140:143]
s_waitcnt vmcnt(10) lgkmcnt(4)
v_cmp_ne_u64 s[50:51], s[88:89], v[90:91]
v_cmp_ne_u64 s[44:45], s[88:89], v[94:95]
v_mfma_f32_16x16x32_bf16 v[144:147], a[244:247], a[112:115], v[144:147]
ds_read_b128 a[252:255], v16 offset:2048
buffer_load_dwordx4 v8, s[20:23], 0 offen offset:1792 lds
v_mfma_f32_16x16x32_bf16 v[148:151], a[244:247], a[116:119], v[148:151]
ds_read_b32 a140, v59
v_perm_b32 v58, v81, v19, s55
v_mfma_f32_16x16x32_bf16 v[152:155], a[244:247], a[120:123], v[152:155]
s_or_b64 s[50:51], s[44:45], s[50:51]
ds_read_b32 a141, v58
v_perm_b32 v57, v85, v19, s54
v_mfma_f32_16x16x32_bf16 v[156:159], a[244:247], a[124:127], v[156:159]
s_waitcnt lgkmcnt(3)
ds_read_b32 a142, v57
v_mfma_f32_16x16x32_bf16 v[160:163], a[248:251], a[96:99], v[160:163]
s_barrier
ds_read_b128 a[224:227], v15 offset:61440
v_perm_b32 v56, v85, v19, s55
v_mfma_f32_16x16x32_bf16 v[164:167], a[248:251], a[100:103], v[164:167]
s_cbranch_scc1 L_SLOW23
L_BACK23:
v_mfma_f32_16x16x32_bf16 v[168:171], a[248:251], a[104:107], v[168:171]
ds_read_b32 a143, v56
v_perm_b32 v63, v88, v19, s52
v_mfma_f32_16x16x32_bf16 v[172:175], a[248:251], a[108:111], v[172:175]
s_waitcnt lgkmcnt(3)
ds_read_b32 a144, v63
v_mfma_f32_16x16x32_bf16 v[176:179], a[252:255], a[96:99], v[176:179]
ds_read_b128 a[228:231], v15 offset:63488
v_perm_b32 v62, v88, v19, s53
v_mfma_f32_16x16x32_bf16 v[180:183], a[252:255], a[100:103], v[180:183]
ds_read_b32 a145, v62
v_perm_b32 v61, v92, v19, s52
v_mfma_f32_16x16x32_bf16 v[184:187], a[252:255], a[104:107], v[184:187]
s_add_u32 m0, s33, 76160
ds_read_b32 a146, v61
v_perm_b32 v60, v92, v19, s53
v_mfma_f32_16x16x32_bf16 v[188:191], a[252:255], a[108:111], v[188:191]
s_waitcnt lgkmcnt(4)
ds_read_b32 a147, v60
v_perm_b32 v59, v88, v19, s54
v_mfma_f32_16x16x32_bf16 v[192:195], a[224:227], a[80:83], v[192:195]
ds_read_b128 a[232:235], v16 offset:4096
buffer_load_dwordx4 v9, s[20:23], 0 offen offset:1664 lds
v_mfma_f32_16x16x32_bf16 v[196:199], a[224:227], a[84:87], v[196:199]
ds_read_b32 a148, v59
v_perm_b32 v58, v88, v19, s55
v_mfma_f32_16x16x32_bf16 v[200:203], a[224:227], a[88:91], v[200:203]
ds_read_b32 a149, v58
v_perm_b32 v57, v92, v19, s54
v_mfma_f32_16x16x32_bf16 v[204:207], a[224:227], a[92:95], v[204:207]
s_waitcnt lgkmcnt(4)
ds_read_b32 a150, v57
buffer_load_dwordx4 v[96:99], v12, s[24:27], 0 offen offset:2048 sc1
v_mfma_f32_16x16x32_bf16 v[208:211], a[228:231], a[80:83], v[208:211]
ds_read_b128 a[236:239], v16 offset:6144
v_perm_b32 v56, v92, v19, s55
v_mfma_f32_16x16x32_bf16 v[212:215], a[228:231], a[84:87], v[212:215]
ds_read_b32 a151, v56
v_perm_b32 v63, v89, v19, s52
v_mfma_f32_16x16x32_bf16 v[216:219], a[228:231], a[88:91], v[216:219]
ds_read_b32 a152, v63
v_perm_b32 v62, v89, v19, s53
v_mfma_f32_16x16x32_bf16 v[220:223], a[228:231], a[92:95], v[220:223]
s_waitcnt lgkmcnt(4)
ds_read_b32 a153, v62
buffer_load_dwordx4 v[100:103], v12, s[24:27], 0 offen offset:3072 sc1
v_mfma_f32_16x16x32_bf16 v[128:131], a[232:235], a[128:131], v[128:131]
ds_read_b128 a[240:243], v17 offset:0
v_perm_b32 v61, v93, v19, s52
v_mfma_f32_16x16x32_bf16 v[132:135], a[232:235], a[132:135], v[132:135]
ds_read_b32 a154, v61
v_perm_b32 v60, v93, v19, s53
v_mfma_f32_16x16x32_bf16 v[136:139], a[232:235], a[136:139], v[136:139]
s_add_u32 m0, s33, 80384
ds_read_b32 a155, v60
v_perm_b32 v59, v89, v19, s54
v_mfma_f32_16x16x32_bf16 v[140:143], a[232:235], a[140:143], v[140:143]
s_waitcnt lgkmcnt(4)
ds_read_b32 a156, v59
v_perm_b32 v58, v89, v19, s55
v_mfma_f32_16x16x32_bf16 v[144:147], a[236:239], a[128:131], v[144:147]
ds_read_b128 a[244:247], v17 offset:2048
buffer_load_dwordx4 v10, s[20:23], 0 offen offset:1536 lds
v_mfma_f32_16x16x32_bf16 v[148:151], a[236:239], a[132:135], v[148:151]
ds_read_b32 a157, v58
v_perm_b32 v57, v93, v19, s54
v_mfma_f32_16x16x32_bf16 v[152:155], a[236:239], a[136:139], v[152:155]
s_waitcnt vmcnt(13)
v_cmp_ne_u64 s[50:51], s[88:89], v[34:35]
v_cmp_ne_u64 s[44:45], s[88:89], v[38:39]
v_mfma_f32_16x16x32_bf16 v[156:159], a[236:239], a[140:143], v[156:159]
s_waitcnt lgkmcnt(3)
ds_read_b32 a158, v57
v_add_u32 v12, 57344, v13
v_mfma_f32_16x16x32_bf16 v[160:163], a[240:243], a[112:115], v[160:163]
s_or_b64 s[50:51], s[44:45], s[50:51]
ds_read_b128 a[248:251], v17 offset:4096
v_perm_b32 v56, v93, v19, s55
v_mfma_f32_16x16x32_bf16 v[164:167], a[240:243], a[116:119], v[164:167]
s_cbranch_scc1 L_SLOW24
L_BACK24:
v_mfma_f32_16x16x32_bf16 v[168:171], a[240:243], a[120:123], v[168:171]
ds_read_b32 a159, v56
v_perm_b32 v63, v32, v19, s52
v_mfma_f32_16x16x32_bf16 v[172:175], a[240:243], a[124:127], v[172:175]
s_waitcnt lgkmcnt(3)
ds_read_b32 a160, v63
v_mfma_f32_16x16x32_bf16 v[176:179], a[244:247], a[112:115], v[176:179]
ds_read_b128 a[252:255], v17 offset:6144
v_perm_b32 v62, v32, v19, s53
v_mfma_f32_16x16x32_bf16 v[180:183], a[244:247], a[116:119], v[180:183]
ds_read_b32 a161, v62
v_perm_b32 v61, v36, v19, s52
v_mfma_f32_16x16x32_bf16 v[184:187], a[244:247], a[120:123], v[184:187]
s_add_u32 m0, s33, 84096
ds_read_b32 a162, v61
v_perm_b32 v60, v36, v19, s53
v_mfma_f32_16x16x32_bf16 v[188:191], a[244:247], a[124:127], v[188:191]
s_waitcnt lgkmcnt(4)
ds_read_b32 a163, v60
v_perm_b32 v59, v32, v19, s54
v_mfma_f32_16x16x32_bf16 v[128:131], a[248:251], a[144:147], v[128:131]
ds_read_b128 a[224:227], v16 offset:8192
buffer_load_dwordx4 v8, s[20:23], 0 offen offset:1920 lds
v_mfma_f32_16x16x32_bf16 v[132:135], a[248:251], a[148:151], v[132:135]
ds_read_b32 a164, v59
v_perm_b32 v58, v32, v19, s55
v_mfma_f32_16x16x32_bf16 v[136:139], a[248:251], a[152:155], v[136:139]
ds_read_b32 a165, v58
v_perm_b32 v57, v36, v19, s54
v_mfma_f32_16x16x32_bf16 v[140:143], a[248:251], a[156:159], v[140:143]
s_waitcnt lgkmcnt(4)
ds_read_b32 a166, v57
buffer_load_dwordx4 v[80:83], v12, s[24:27], 0 offen offset:0 sc1
v_mfma_f32_16x16x32_bf16 v[144:147], a[252:255], a[144:147], v[144:147]
ds_read_b128 a[228:231], v16 offset:10240
v_perm_b32 v56, v36, v19, s55
v_mfma_f32_16x16x32_bf16 v[148:151], a[252:255], a[148:151], v[148:151]
ds_read_b32 a167, v56
v_perm_b32 v63, v33, v19, s52
v_mfma_f32_16x16x32_bf16 v[152:155], a[252:255], a[152:155], v[152:155]
ds_read_b32 a168, v63
v_perm_b32 v62, v33, v19, s53
v_mfma_f32_16x16x32_bf16 v[156:159], a[252:255], a[156:159], v[156:159]
s_waitcnt lgkmcnt(4)
ds_read_b32 a169, v62
buffer_load_dwordx4 v[84:87], v12, s[24:27], 0 offen offset:1024 sc1
v_mfma_f32_16x16x32_bf16 v[192:195], a[224:227], a[96:99], v[192:195]
ds_read_b128 a[232:235], v16 offset:12288
v_perm_b32 v61, v37, v19, s52
v_mfma_f32_16x16x32_bf16 v[196:199], a[224:227], a[100:103], v[196:199]
ds_read_b32 a170, v61
v_perm_b32 v60, v37, v19, s53
v_mfma_f32_16x16x32_bf16 v[200:203], a[224:227], a[104:107], v[200:203]
s_add_u32 m0, s33, 88320
ds_read_b32 a171, v60
v_perm_b32 v59, v33, v19, s54
v_mfma_f32_16x16x32_bf16 v[204:207], a[224:227], a[108:111], v[204:207]
s_waitcnt lgkmcnt(4)
ds_read_b32 a172, v59
v_perm_b32 v58, v33, v19, s55
v_mfma_f32_16x16x32_bf16 v[208:211], a[228:231], a[96:99], v[208:211]
ds_read_b128 a[236:239], v16 offset:14336
buffer_load_dwordx4 v9, s[20:23], 0 offen offset:1792 lds
v_mfma_f32_16x16x32_bf16 v[212:215], a[228:231], a[100:103], v[212:215]
ds_read_b32 a173, v58
v_perm_b32 v57, v37, v19, s54
v_mfma_f32_16x16x32_bf16 v[216:219], a[228:231], a[104:107], v[216:219]
s_waitcnt vmcnt(13)
v_cmp_ne_u64 s[50:51], s[88:89], v[42:43]
v_cmp_ne_u64 s[44:45], s[88:89], v[46:47]
v_mfma_f32_16x16x32_bf16 v[220:223], a[228:231], a[108:111], v[220:223]
s_waitcnt lgkmcnt(3)
ds_read_b32 a174, v57
v_mfma_f32_16x16x32_bf16 v[224:227], a[232:235], a[64:67], v[224:227]
s_or_b64 s[50:51], s[44:45], s[50:51]
ds_read_b128 a[240:243], v16 offset:16384
v_perm_b32 v56, v37, v19, s55
v_mfma_f32_16x16x32_bf16 v[228:231], a[232:235], a[68:71], v[228:231]
s_cbranch_scc1 L_SLOW25
L_BACK25:
v_mfma_f32_16x16x32_bf16 v[232:235], a[232:235], a[72:75], v[232:235]
ds_read_b32 a175, v56
v_perm_b32 v63, v40, v19, s52
v_mfma_f32_16x16x32_bf16 v[236:239], a[232:235], a[76:79], v[236:239]
s_waitcnt lgkmcnt(3)
ds_read_b32 a176, v63
v_mfma_f32_16x16x32_bf16 v[240:243], a[236:239], a[64:67], v[240:243]
ds_read_b128 a[244:247], v16 offset:18432
v_perm_b32 v62, v40, v19, s53
v_mfma_f32_16x16x32_bf16 v[244:247], a[236:239], a[68:71], v[244:247]
ds_read_b32 a177, v62
v_perm_b32 v61, v44, v19, s52
v_mfma_f32_16x16x32_bf16 v[248:251], a[236:239], a[72:75], v[248:251]
s_add_u32 m0, s33, 92544
ds_read_b32 a178, v61
v_perm_b32 v60, v44, v19, s53
v_mfma_f32_16x16x32_bf16 v[252:255], a[236:239], a[76:79], v[252:255]
s_waitcnt lgkmcnt(4)
ds_read_b32 a179, v60
v_perm_b32 v59, v40, v19, s54
v_mfma_f32_16x16x32_bf16 v[160:163], a[240:243], a[128:131], v[160:163]
ds_read_b128 a[248:251], v16 offset:20480
buffer_load_dwordx4 v10, s[20:23], 0 offen offset:1664 lds
v_mfma_f32_16x16x32_bf16 v[164:167], a[240:243], a[132:135], v[164:167]
L_PAD4:
s_cbranch_vccnz L_PAD5
ds_read_b32 a180, v59
v_perm_b32 v58, v40, v19, s55
v_mfma_f32_16x16x32_bf16 v[168:171], a[240:243], a[136:139], v[168:171]
ds_read_b32 a181, v58
v_perm_b32 v57, v44, v19, s54
v_mfma_f32_16x16x32_bf16 v[172:175], a[240:243], a[140:143], v[172:175]
s_waitcnt lgkmcnt(4)
ds_read_b32 a182, v57
buffer_load_dwordx4 v[88:91], v12, s[24:27], 0 offen offset:2048 sc1
v_mfma_f32_16x16x32_bf16 v[176:179], a[244:247], a[128:131], v[176:179]
ds_read_b128 a[252:255], v16 offset:22528
v_perm_b32 v56, v44, v19, s55
v_mfma_f32_16x16x32_bf16 v[180:183], a[244:247], a[132:135], v[180:183]
ds_read_b32 a183, v56
v_perm_b32 v63, v41, v19, s52
v_mfma_f32_16x16x32_bf16 v[184:187], a[244:247], a[136:139], v[184:187]
ds_read_b32 a184, v63
v_perm_b32 v62, v41, v19, s53
v_mfma_f32_16x16x32_bf16 v[188:191], a[244:247], a[140:143], v[188:191]
s_waitcnt lgkmcnt(4)
ds_read_b32 a185, v62
buffer_load_dwordx4 v[92:95], v12, s[24:27], 0 offen offset:3072 sc1
v_mfma_f32_16x16x32_bf16 v[128:131], a[248:251], a[160:163], v[128:131]
s_waitcnt vmcnt(15)
s_barrier
ds_read_b128 a[224:227], v17 offset:16384
v_perm_b32 v61, v45, v19, s52
v_mfma_f32_16x16x32_bf16 v[132:135], a[248:251], a[164:167], v[132:135]
ds_read_b32 a186, v61
v_perm_b32 v60, v45, v19, s53
v_mfma_f32_16x16x32_bf16 v[136:139], a[248:251], a[168:171], v[136:139]
s_add_u32 m0, s33, 96896
ds_read_b32 a187, v60
v_perm_b32 v59, v41, v19, s54
v_mfma_f32_16x16x32_bf16 v[140:143], a[248:251], a[172:175], v[140:143]
s_waitcnt lgkmcnt(4)
ds_read_b32 a188, v59
v_perm_b32 v58, v41, v19, s55
v_mfma_f32_16x16x32_bf16 v[144:147], a[252:255], a[160:163], v[144:147]
ds_read_b128 a[228:231], v17 offset:18432
buffer_load_dwordx4 v11, s[20:23], 0 offen offset:1408 lds
v_mfma_f32_16x16x32_bf16 v[148:151], a[252:255], a[164:167], v[148:151]
ds_read_b32 a189, v58
v_perm_b32 v57, v45, v19, s54
v_mfma_f32_16x16x32_bf16 v[152:155], a[252:255], a[168:171], v[152:155]
s_waitcnt vmcnt(13)
v_cmp_ne_u64 s[50:51], s[88:89], v[50:51]
v_cmp_ne_u64 s[44:45], s[88:89], v[54:55]
v_mfma_f32_16x16x32_bf16 v[156:159], a[252:255], a[172:175], v[156:159]
s_waitcnt lgkmcnt(3)
ds_read_b32 a190, v57
v_add_u32 v12, 61440, v13
v_mfma_f32_16x16x32_bf16 v[160:163], a[224:227], a[144:147], v[160:163]
s_or_b64 s[50:51], s[44:45], s[50:51]
ds_read_b128 a[232:235], v17 offset:8192
v_perm_b32 v56, v45, v19, s55
v_mfma_f32_16x16x32_bf16 v[164:167], a[224:227], a[148:151], v[164:167]
s_cbranch_scc1 L_SLOW26
L_BACK26:
v_mfma_f32_16x16x32_bf16 v[168:171], a[224:227], a[152:155], v[168:171]
ds_read_b32 a191, v56
v_perm_b32 v63, v48, v19, s52
v_mfma_f32_16x16x32_bf16 v[172:175], a[224:227], a[156:159], v[172:175]
s_waitcnt lgkmcnt(3)
ds_read_b32 a192, v63
v_mfma_f32_16x16x32_bf16 v[176:179], a[228:231], a[144:147], v[176:179]
ds_read_b128 a[236:239], v17 offset:10240
v_perm_b32 v62, v48, v19, s53
v_mfma_f32_16x16x32_bf16 v[180:183], a[228:231], a[148:151], v[180:183]
ds_read_b32 a193, v62
v_perm_b32 v61, v52, v19, s52
v_mfma_f32_16x16x32_bf16 v[184:187], a[228:231], a[152:155], v[184:187]
s_add_u32 m0, s33, 100480
ds_read_b32 a194, v61
v_perm_b32 v60, v52, v19, s53
v_mfma_f32_16x16x32_bf16 v[188:191], a[228:231], a[156:159], v[188:191]
s_waitcnt lgkmcnt(4)
ds_read_b32 a195, v60
v_perm_b32 v59, v48, v19, s54
v_mfma_f32_16x16x32_bf16 v[192:195], a[232:235], a[112:115], v[192:195]
ds_read_b128 a[240:243], v17 offset:20480
buffer_load_dwordx4 v9, s[20:23], 0 offen offset:1920 lds
v_mfma_f32_16x16x32_bf16 v[196:199], a[232:235], a[116:119], v[196:199]
ds_read_b32 a196, v59
v_perm_b32 v58, v48, v19, s55
v_mfma_f32_16x16x32_bf16 v[200:203], a[232:235], a[120:123], v[200:203]
ds_read_b32 a197, v58
v_perm_b32 v57, v52, v19, s54
v_mfma_f32_16x16x32_bf16 v[204:207], a[232:235], a[124:127], v[204:207]
s_waitcnt lgkmcnt(4)
ds_read_b32 a198, v57
buffer_load_dwordx4 v[32:35], v12, s[24:27], 0 offen offset:0 sc1
v_mfma_f32_16x16x32_bf16 v[208:211], a[236:239], a[112:115], v[208:211]
ds_read_b128 a[244:247], v17 offset:22528
v_perm_b32 v56, v52, v19, s55
v_mfma_f32_16x16x32_bf16 v[212:215], a[236:239], a[116:119], v[212:215]
ds_read_b32 a199, v56
v_perm_b32 v63, v49, v19, s52
v_mfma_f32_16x16x32_bf16 v[216:219], a[236:239], a[120:123], v[216:219]
ds_read_b32 a200, v63
v_perm_b32 v62, v49, v19, s53
v_mfma_f32_16x16x32_bf16 v[220:223], a[236:239], a[124:127], v[220:223]
s_waitcnt lgkmcnt(4)
ds_read_b32 a201, v62
buffer_load_dwordx4 v[36:39], v12, s[24:27], 0 offen offset:1024 sc1
v_mfma_f32_16x16x32_bf16 v[128:131], a[240:243], a[176:179], v[128:131]
ds_read_b128 a[248:251], v17 offset:12288
v_perm_b32 v61, v53, v19, s52
v_mfma_f32_16x16x32_bf16 v[132:135], a[240:243], a[180:183], v[132:135]
ds_read_b32 a202, v61
v_perm_b32 v60, v53, v19, s53
v_mfma_f32_16x16x32_bf16 v[136:139], a[240:243], a[184:187], v[136:139]
s_add_u32 m0, s33, 104704
ds_read_b32 a203, v60
v_perm_b32 v59, v49, v19, s54
v_mfma_f32_16x16x32_bf16 v[140:143], a[240:243], a[188:191], v[140:143]
s_waitcnt lgkmcnt(4)
ds_read_b32 a204, v59
v_perm_b32 v58, v49, v19, s55
v_mfma_f32_16x16x32_bf16 v[144:147], a[244:247], a[176:179], v[144:147]
ds_read_b128 a[252:255], v17 offset:14336
buffer_load_dwordx4 v10, s[20:23], 0 offen offset:1792 lds
v_mfma_f32_16x16x32_bf16 v[148:151], a[244:247], a[180:183], v[148:151]
ds_read_b32 a205, v58
v_perm_b32 v57, v53, v19, s54
v_mfma_f32_16x16x32_bf16 v[152:155], a[244:247], a[184:187], v[152:155]
s_waitcnt vmcnt(13)
v_cmp_ne_u64 s[50:51], s[88:89], v[98:99]
v_cmp_ne_u64 s[44:45], s[88:89], v[102:103]
v_mfma_f32_16x16x32_bf16 v[156:159], a[244:247], a[188:191], v[156:159]
s_waitcnt lgkmcnt(3)
ds_read_b32 a206, v57
v_mfma_f32_16x16x32_bf16 v[224:227], a[248:251], a[80:83], v[224:227]
s_or_b64 s[50:51], s[44:45], s[50:51]
ds_read_b128 a[224:227], v16 offset:24576
v_perm_b32 v56, v53, v19, s55
v_mfma_f32_16x16x32_bf16 v[228:231], a[248:251], a[84:87], v[228:231]
s_cbranch_scc1 L_SLOW27
L_BACK27:
v_mfma_f32_16x16x32_bf16 v[232:235], a[248:251], a[88:91], v[232:235]
ds_read_b32 a207, v56
v_perm_b32 v63, v96, v19, s52
v_mfma_f32_16x16x32_bf16 v[236:239], a[248:251], a[92:95], v[236:239]
s_waitcnt lgkmcnt(3)
ds_read_b32 a208, v63
v_mfma_f32_16x16x32_bf16 v[240:243], a[252:255], a[80:83], v[240:243]
ds_read_b128 a[228:231], v16 offset:26624
v_perm_b32 v62, v96, v19, s53
v_mfma_f32_16x16x32_bf16 v[244:247], a[252:255], a[84:87], v[244:247]
ds_read_b32 a209, v62
v_perm_b32 v61, v100, v19, s52
v_mfma_f32_16x16x32_bf16 v[248:251], a[252:255], a[88:91], v[248:251]
s_add_u32 m0, s33, 109056
ds_read_b32 a210, v61
v_perm_b32 v60, v100, v19, s53
v_mfma_f32_16x16x32_bf16 v[252:255], a[252:255], a[92:95], v[252:255]
s_waitcnt lgkmcnt(4)
ds_read_b32 a211, v60
v_perm_b32 v59, v96, v19, s54
v_mfma_f32_16x16x32_bf16 v[160:163], a[224:227], a[160:163], v[160:163]
ds_read_b128 a[232:235], v16 offset:28672
buffer_load_dwordx4 v11, s[20:23], 0 offen offset:1536 lds
v_mfma_f32_16x16x32_bf16 v[164:167], a[224:227], a[164:167], v[164:167]
ds_read_b32 a212, v59
v_perm_b32 v58, v96, v19, s55
v_mfma_f32_16x16x32_bf16 v[168:171], a[224:227], a[168:171], v[168:171]
ds_read_b32 a213, v58
v_perm_b32 v57, v100, v19, s54
v_mfma_f32_16x16x32_bf16 v[172:175], a[224:227], a[172:175], v[172:175]
s_waitcnt lgkmcnt(4)
ds_read_b32 a214, v57
v_mfma_f32_16x16x32_bf16 v[176:179], a[228:231], a[160:163], v[176:179]
ds_read_b128 a[236:239], v16 offset:30720
v_perm_b32 v56, v100, v19, s55
v_mfma_f32_16x16x32_bf16 v[180:183], a[228:231], a[164:167], v[180:183]
ds_read_b32 a215, v56
v_perm_b32 v63, v97, v19, s52
v_mfma_f32_16x16x32_bf16 v[184:187], a[228:231], a[168:171], v[184:187]
ds_read_b32 a216, v63
v_perm_b32 v62, v97, v19, s53
v_mfma_f32_16x16x32_bf16 v[188:191], a[228:231], a[172:175], v[188:191]
s_waitcnt lgkmcnt(4)
ds_read_b32 a217, v62
v_mfma_f32_16x16x32_bf16 v[128:131], a[232:235], a[192:195], v[128:131]
ds_read_b128 a[240:243], v14 offset:0
v_perm_b32 v61, v101, v19, s52
v_mfma_f32_16x16x32_bf16 v[132:135], a[232:235], a[196:199], v[132:135]
ds_read_b32 a218, v61
v_perm_b32 v60, v101, v19, s53
v_mfma_f32_16x16x32_bf16 v[136:139], a[232:235], a[200:203], v[136:139]
s_add_u32 m0, s33, 112768
ds_read_b32 a219, v60
v_perm_b32 v59, v97, v19, s54
v_mfma_f32_16x16x32_bf16 v[140:143], a[232:235], a[204:207], v[140:143]
s_waitcnt lgkmcnt(4)
ds_read_b32 a220, v59
v_perm_b32 v58, v97, v19, s55
v_mfma_f32_16x16x32_bf16 v[144:147], a[236:239], a[192:195], v[144:147]
ds_read_b128 a[244:247], v14 offset:2048
buffer_load_dwordx4 v10, s[20:23], 0 offen offset:1920 lds
v_mfma_f32_16x16x32_bf16 v[148:151], a[236:239], a[196:199], v[148:151]
ds_read_b32 a221, v58
v_perm_b32 v57, v101, v19, s54
v_mfma_f32_16x16x32_bf16 v[152:155], a[236:239], a[200:203], v[152:155]
s_waitcnt vmcnt(11)
v_cmp_ne_u64 s[50:51], s[88:89], v[82:83]
v_cmp_ne_u64 s[44:45], s[88:89], v[86:87]
v_mfma_f32_16x16x32_bf16 v[156:159], a[236:239], a[204:207], v[156:159]
s_waitcnt lgkmcnt(3)
ds_read_b32 a222, v57
buffer_load_dwordx4 v[40:43], v12, s[24:27], 0 offen offset:2048 sc1
v_mfma_f32_16x16x32_bf16 v[192:195], a[240:243], a[128:131], v[192:195]
s_or_b64 s[50:51], s[44:45], s[50:51]
ds_read_b128 a[248:251], v17 offset:24576
v_perm_b32 v56, v101, v19, s55
v_mfma_f32_16x16x32_bf16 v[196:199], a[240:243], a[132:135], v[196:199]
s_cbranch_scc1 L_SLOW28
L_BACK28:
v_mfma_f32_16x16x32_bf16 v[200:203], a[240:243], a[136:139], v[200:203]
s_add_u32 m0, s33, 117120
ds_read_b32 a223, v56
v_perm_b32 v63, v80, v19, s52
v_mfma_f32_16x16x32_bf16 v[204:207], a[240:243], a[140:143], v[204:207]
s_waitcnt lgkmcnt(3)
ds_read_b32 a0, v63
v_perm_b32 v62, v80, v19, s53
v_mfma_f32_16x16x32_bf16 v[208:211], a[244:247], a[128:131], v[208:211]
ds_read_b128 a[252:255], v17 offset:26624
buffer_load_dwordx4 v11, s[20:23], 0 offen offset:1664 lds
v_mfma_f32_16x16x32_bf16 v[212:215], a[244:247], a[132:135], v[212:215]
ds_read_b32 a1, v62
v_perm_b32 v61, v84, v19, s52
v_mfma_f32_16x16x32_bf16 v[216:219], a[244:247], a[136:139], v[216:219]
ds_read_b32 a2, v61
v_perm_b32 v60, v84, v19, s53
v_mfma_f32_16x16x32_bf16 v[220:223], a[244:247], a[140:143], v[220:223]
s_waitcnt lgkmcnt(4)
ds_read_b32 a3, v60
buffer_load_dwordx4 v[44:47], v12, s[24:27], 0 offen offset:3072 sc1
v_mfma_f32_16x16x32_bf16 v[160:163], a[248:251], a[176:179], v[160:163]
s_barrier
ds_read_b128 a[224:227], v17 offset:28672
v_perm_b32 v59, v80, v19, s54
v_mfma_f32_16x16x32_bf16 v[164:167], a[248:251], a[180:183], v[164:167]
ds_read_b32 a4, v59
v_perm_b32 v58, v80, v19, s55
v_mfma_f32_16x16x32_bf16 v[168:171], a[248:251], a[184:187], v[168:171]
ds_read_b32 a5, v58
v_perm_b32 v57, v84, v19, s54
v_mfma_f32_16x16x32_bf16 v[172:175], a[248:251], a[188:191], v[172:175]
s_waitcnt lgkmcnt(4)
ds_read_b32 a6, v57
v_mfma_f32_16x16x32_bf16 v[176:179], a[252:255], a[176:179], v[176:179]
ds_read_b128 a[228:231], v17 offset:30720
v_perm_b32 v56, v84, v19, s55
v_mfma_f32_16x16x32_bf16 v[180:183], a[252:255], a[180:183], v[180:183]
ds_read_b32 a7, v56
v_perm_b32 v63, v81, v19, s52
v_mfma_f32_16x16x32_bf16 v[184:187], a[252:255], a[184:187], v[184:187]
ds_read_b32 a8, v63
v_perm_b32 v62, v81, v19, s53
v_mfma_f32_16x16x32_bf16 v[188:191], a[252:255], a[188:191], v[188:191]
s_waitcnt lgkmcnt(4)
ds_read_b32 a9, v62
v_mfma_f32_16x16x32_bf16 v[128:131], a[224:227], a[208:211], v[128:131]
ds_read_b128 a[232:235], v15 offset:0
v_perm_b32 v61, v85, v19, s52
v_mfma_f32_16x16x32_bf16 v[132:135], a[224:227], a[212:215], v[132:135]
ds_read_b32 a10, v61
v_perm_b32 v60, v85, v19, s53
v_mfma_f32_16x16x32_bf16 v[136:139], a[224:227], a[216:219], v[136:139]
s_add_u32 m0, s33, 121088
ds_read_b32 a11, v60
v_perm_b32 v59, v81, v19, s54
v_mfma_f32_16x16x32_bf16 v[140:143], a[224:227], a[220:223], v[140:143]
s_waitcnt lgkmcnt(4)
ds_read_b32 a12, v59
v_perm_b32 v58, v81, v19, s55
v_mfma_f32_16x16x32_bf16 v[144:147], a[228:231], a[208:211], v[144:147]
ds_read_b128 a[236:239], v15 offset:2048
buffer_load_dwordx4 v11, s[20:23], 0 offen offset:1792 lds
v_mfma_f32_16x16x32_bf16 v[148:151], a[228:231], a[212:215], v[148:151]
ds_read_b32 a13, v58
v_perm_b32 v57, v85, v19, s54
v_mfma_f32_16x16x32_bf16 v[152:155], a[228:231], a[216:219], v[152:155]
s_waitcnt vmcnt(11)
v_cmp_ne_u64 s[50:51], s[88:89], v[90:91]
v_cmp_ne_u64 s[44:45], s[88:89], v[94:95]
v_mfma_f32_16x16x32_bf16 v[156:159], a[228:231], a[220:223], v[156:159]
s_waitcnt lgkmcnt(3)
ds_read_b32 a14, v57
v_mfma_f32_16x16x32_bf16 v[192:195], a[232:235], a[144:147], v[192:195]
s_or_b64 s[50:51], s[44:45], s[50:51]
ds_read_b128 a[240:243], v14 offset:4096
v_perm_b32 v56, v85, v19, s55
v_mfma_f32_16x16x32_bf16 v[196:199], a[232:235], a[148:151], v[196:199]
s_cbranch_scc1 L_SLOW29
L_BACK29:
v_mfma_f32_16x16x32_bf16 v[200:203], a[232:235], a[152:155], v[200:203]
ds_read_b32 a15, v56
v_perm_b32 v63, v88, v19, s52
v_mfma_f32_16x16x32_bf16 v[204:207], a[232:235], a[156:159], v[204:207]
s_waitcnt lgkmcnt(3)
ds_read_b32 a16, v63
v_mfma_f32_16x16x32_bf16 v[208:211], a[236:239], a[144:147], v[208:211]
ds_read_b128 a[244:247], v14 offset:6144
v_perm_b32 v62, v88, v19, s53
v_mfma_f32_16x16x32_bf16 v[212:215], a[236:239], a[148:151], v[212:215]
ds_read_b32 a17, v62
v_perm_b32 v61, v92, v19, s52
v_mfma_f32_16x16x32_bf16 v[216:219], a[236:239], a[152:155], v[216:219]
s_add_u32 m0, s33, 125056
ds_read_b32 a18, v61
v_perm_b32 v60, v92, v19, s53
v_mfma_f32_16x16x32_bf16 v[220:223], a[236:239], a[156:159], v[220:223]
s_waitcnt lgkmcnt(4)
ds_read_b32 a19, v60
v_perm_b32 v59, v88, v19, s54
v_mfma_f32_16x16x32_bf16 v[224:227], a[240:243], a[96:99], v[224:227]
ds_read_b128 a[248:251], v14 offset:8192
buffer_load_dwordx4 v11, s[20:23], 0 offen offset:1920 lds
v_mfma_f32_16x16x32_bf16 v[228:231], a[240:243], a[100:103], v[228:231]
ds_read_b32 a20, v59
v_perm_b32 v58, v88, v19, s55
v_mfma_f32_16x16x32_bf16 v[232:235], a[240:243], a[104:107], v[232:235]
ds_read_b32 a21, v58
v_perm_b32 v57, v92, v19, s54
v_mfma_f32_16x16x32_bf16 v[236:239], a[240:243], a[108:111], v[236:239]
s_waitcnt lgkmcnt(4)
ds_read_b32 a22, v57
v_mfma_f32_16x16x32_bf16 v[240:243], a[244:247], a[96:99], v[240:243]
ds_read_b128 a[252:255], v14 offset:10240
v_perm_b32 v56, v92, v19, s55
v_mfma_f32_16x16x32_bf16 v[244:247], a[244:247], a[100:103], v[244:247]
ds_read_b32 a23, v56
v_perm_b32 v63, v89, v19, s52
v_mfma_f32_16x16x32_bf16 v[248:251], a[244:247], a[104:107], v[248:251]
ds_read_b32 a24, v63
v_perm_b32 v62, v89, v19, s53
v_mfma_f32_16x16x32_bf16 v[252:255], a[244:247], a[108:111], v[252:255]
s_waitcnt lgkmcnt(4)
ds_read_b32 a25, v62
v_mfma_f32_16x16x32_bf16 v[128:131], a[248:251], a[0:3], v[128:131]
ds_read_b128 a[224:227], v14 offset:12288
v_perm_b32 v61, v93, v19, s52
v_mfma_f32_16x16x32_bf16 v[132:135], a[248:251], a[4:7], v[132:135]
ds_read_b32 a26, v61
v_perm_b32 v60, v93, v19, s53
v_mfma_f32_16x16x32_bf16 v[136:139], a[248:251], a[8:11], v[136:139]
ds_read_b32 a27, v60
v_perm_b32 v59, v89, v19, s54
v_mfma_f32_16x16x32_bf16 v[140:143], a[248:251], a[12:15], v[140:143]
s_waitcnt lgkmcnt(4)
ds_read_b32 a28, v59
v_mfma_f32_16x16x32_bf16 v[144:147], a[252:255], a[0:3], v[144:147]
ds_read_b128 a[228:231], v14 offset:14336
v_perm_b32 v58, v89, v19, s55
v_mfma_f32_16x16x32_bf16 v[148:151], a[252:255], a[4:7], v[148:151]
ds_read_b32 a29, v58
v_perm_b32 v57, v93, v19, s54
v_mfma_f32_16x16x32_bf16 v[152:155], a[252:255], a[8:11], v[152:155]
ds_read_b32 a30, v57
v_mfma_f32_16x16x32_bf16 v[156:159], a[252:255], a[12:15], v[156:159]
s_waitcnt vmcnt(8) lgkmcnt(4)
v_cmp_ne_u64 s[50:51], s[88:89], v[34:35]
v_cmp_ne_u64 s[44:45], s[88:89], v[38:39]
v_mfma_f32_16x16x32_bf16 v[160:163], a[224:227], a[192:195], v[160:163]
ds_read_b128 a[232:235], v15 offset:8192
v_perm_b32 v56, v93, v19, s55
v_mfma_f32_16x16x32_bf16 v[164:167], a[224:227], a[196:199], v[164:167]
s_or_b64 s[50:51], s[44:45], s[50:51]
ds_read_b32 a31, v56
v_mfma_f32_16x16x32_bf16 v[168:171], a[224:227], a[200:203], v[168:171]
s_cbranch_scc1 L_SLOW30
L_BACK30:
v_mfma_f32_16x16x32_bf16 v[172:175], a[224:227], a[204:207], v[172:175]
s_waitcnt lgkmcnt(2)
v_mfma_f32_16x16x32_bf16 v[176:179], a[228:231], a[192:195], v[176:179]
ds_read_b128 a[236:239], v15 offset:10240
v_mfma_f32_16x16x32_bf16 v[180:183], a[228:231], a[196:199], v[180:183]
v_perm_b32 v63, v32, v19, s52
v_mfma_f32_16x16x32_bf16 v[184:187], a[228:231], a[200:203], v[184:187]
ds_read_b32 a32, v63
v_perm_b32 v62, v32, v19, s53
v_mfma_f32_16x16x32_bf16 v[188:191], a[228:231], a[204:207], v[188:191]
s_waitcnt lgkmcnt(2)
ds_read_b32 a33, v62
v_mfma_f32_16x16x32_bf16 v[128:131], a[232:235], a[16:19], v[128:131]
ds_read_b128 a[240:243], v15 offset:12288
v_perm_b32 v61, v36, v19, s52
v_mfma_f32_16x16x32_bf16 v[132:135], a[232:235], a[20:23], v[132:135]
ds_read_b32 a34, v61
v_perm_b32 v60, v36, v19, s53
v_mfma_f32_16x16x32_bf16 v[136:139], a[232:235], a[24:27], v[136:139]
ds_read_b32 a35, v60
v_perm_b32 v59, v32, v19, s54
v_mfma_f32_16x16x32_bf16 v[140:143], a[232:235], a[28:31], v[140:143]
s_waitcnt lgkmcnt(4)
ds_read_b32 a36, v59
v_mfma_f32_16x16x32_bf16 v[144:147], a[236:239], a[16:19], v[144:147]
ds_read_b128 a[244:247], v15 offset:14336
v_perm_b32 v58, v32, v19, s55
v_mfma_f32_16x16x32_bf16 v[148:151], a[236:239], a[20:23], v[148:151]
ds_read_b32 a37, v58
v_perm_b32 v57, v36, v19, s54
v_mfma_f32_16x16x32_bf16 v[152:155], a[236:239], a[24:27], v[152:155]
ds_read_b32 a38, v57
v_perm_b32 v56, v36, v19, s55
v_mfma_f32_16x16x32_bf16 v[156:159], a[236:239], a[28:31], v[156:159]
s_waitcnt lgkmcnt(4)
ds_read_b32 a39, v56
v_mfma_f32_16x16x32_bf16 v[160:163], a[240:243], a[208:211], v[160:163]
ds_read_b128 a[248:251], v14 offset:16384
v_perm_b32 v63, v33, v19, s52
v_mfma_f32_16x16x32_bf16 v[164:167], a[240:243], a[212:215], v[164:167]
ds_read_b32 a40, v63
v_perm_b32 v62, v33, v19, s53
v_mfma_f32_16x16x32_bf16 v[168:171], a[240:243], a[216:219], v[168:171]
ds_read_b32 a41, v62
v_perm_b32 v61, v37, v19, s52
v_mfma_f32_16x16x32_bf16 v[172:175], a[240:243], a[220:223], v[172:175]
s_waitcnt lgkmcnt(4)
ds_read_b32 a42, v61
v_mfma_f32_16x16x32_bf16 v[176:179], a[244:247], a[208:211], v[176:179]
ds_read_b128 a[252:255], v14 offset:18432
v_perm_b32 v60, v37, v19, s53
v_mfma_f32_16x16x32_bf16 v[180:183], a[244:247], a[212:215], v[180:183]
ds_read_b32 a43, v60
v_perm_b32 v59, v33, v19, s54
v_mfma_f32_16x16x32_bf16 v[184:187], a[244:247], a[216:219], v[184:187]
ds_read_b32 a44, v59
v_perm_b32 v58, v33, v19, s55
v_mfma_f32_16x16x32_bf16 v[188:191], a[244:247], a[220:223], v[188:191]
s_waitcnt lgkmcnt(4)
ds_read_b32 a45, v58
v_mfma_f32_16x16x32_bf16 v[192:195], a[248:251], a[160:163], v[192:195]
s_barrier
ds_read_b128 a[224:227], v14 offset:20480
v_perm_b32 v57, v37, v19, s54
v_mfma_f32_16x16x32_bf16 v[196:199], a[248:251], a[164:167], v[196:199]
ds_read_b32 a46, v57
v_perm_b32 v56, v37, v19, s55
v_mfma_f32_16x16x32_bf16 v[200:203], a[248:251], a[168:171], v[200:203]
ds_read_b32 a47, v56
v_mfma_f32_16x16x32_bf16 v[204:207], a[248:251], a[172:175], v[204:207]
s_waitcnt lgkmcnt(4)
v_mfma_f32_16x16x32_bf16 v[208:211], a[252:255], a[160:163], v[208:211]
ds_read_b128 a[228:231], v14 offset:22528
v_mfma_f32_16x16x32_bf16 v[212:215], a[252:255], a[164:167], v[212:215]
v_mfma_f32_16x16x32_bf16 v[216:219], a[252:255], a[168:171], v[216:219]
v_mfma_f32_16x16x32_bf16 v[220:223], a[252:255], a[172:175], v[220:223]
s_waitcnt vmcnt(2) lgkmcnt(1)
v_cmp_ne_u64 s[50:51], s[88:89], v[42:43]
v_cmp_ne_u64 s[44:45], s[88:89], v[46:47]
v_mfma_f32_16x16x32_bf16 v[128:131], a[224:227], a[32:35], v[128:131]
ds_read_b128 a[232:235], v15 offset:4096
v_mfma_f32_16x16x32_bf16 v[132:135], a[224:227], a[36:39], v[132:135]
s_or_b64 s[50:51], s[44:45], s[50:51]
v_mfma_f32_16x16x32_bf16 v[136:139], a[224:227], a[40:43], v[136:139]
s_cbranch_scc1 L_SLOW31
L_BACK31:
v_mfma_f32_16x16x32_bf16 v[140:143], a[224:227], a[44:47], v[140:143]
s_waitcnt lgkmcnt(1)
v_mfma_f32_16x16x32_bf16 v[144:147], a[228:231], a[32:35], v[144:147]
ds_read_b128 a[236:239], v15 offset:6144
v_mfma_f32_16x16x32_bf16 v[148:151], a[228:231], a[36:39], v[148:151]
v_perm_b32 v63, v40, v19, s52
v_mfma_f32_16x16x32_bf16 v[152:155], a[228:231], a[40:43], v[152:155]
ds_read_b32 a48, v63
v_perm_b32 v62, v40, v19, s53
v_mfma_f32_16x16x32_bf16 v[156:159], a[228:231], a[44:47], v[156:159]
s_waitcnt lgkmcnt(2)
ds_read_b32 a49, v62
v_mfma_f32_16x16x32_bf16 v[224:227], a[232:235], a[112:115], v[224:227]
ds_read_b128 a[240:243], v14 offset:24576
v_perm_b32 v61, v44, v19, s52
v_mfma_f32_16x16x32_bf16 v[228:231], a[232:235], a[116:119], v[228:231]
ds_read_b32 a50, v61
v_perm_b32 v60, v44, v19, s53
v_mfma_f32_16x16x32_bf16 v[232:235], a[232:235], a[120:123], v[232:235]
ds_read_b32 a51, v60
v_perm_b32 v59, v40, v19, s54
v_mfma_f32_16x16x32_bf16 v[236:239], a[232:235], a[124:127], v[236:239]
s_waitcnt lgkmcnt(4)
ds_read_b32 a52, v59
v_mfma_f32_16x16x32_bf16 v[240:243], a[236:239], a[112:115], v[240:243]
ds_read_b128 a[244:247], v14 offset:26624
v_perm_b32 v58, v40, v19, s55
v_mfma_f32_16x16x32_bf16 v[244:247], a[236:239], a[116:119], v[244:247]
ds_read_b32 a53, v58
v_perm_b32 v57, v44, v19, s54
v_mfma_f32_16x16x32_bf16 v[248:251], a[236:239], a[120:123], v[248:251]
ds_read_b32 a54, v57
v_perm_b32 v56, v44, v19, s55
v_mfma_f32_16x16x32_bf16 v[252:255], a[236:239], a[124:127], v[252:255]
s_waitcnt lgkmcnt(4)
ds_read_b32 a55, v56
v_mfma_f32_16x16x32_bf16 v[160:163], a[240:243], a[0:3], v[160:163]
ds_read_b128 a[248:251], v15 offset:16384
v_perm_b32 v63, v41, v19, s52
v_mfma_f32_16x16x32_bf16 v[164:167], a[240:243], a[4:7], v[164:167]
ds_read_b32 a56, v63
v_perm_b32 v62, v41, v19, s53
v_mfma_f32_16x16x32_bf16 v[168:171], a[240:243], a[8:11], v[168:171]
ds_read_b32 a57, v62
v_perm_b32 v61, v45, v19, s52
v_mfma_f32_16x16x32_bf16 v[172:175], a[240:243], a[12:15], v[172:175]
s_waitcnt lgkmcnt(4)
ds_read_b32 a58, v61
v_mfma_f32_16x16x32_bf16 v[176:179], a[244:247], a[0:3], v[176:179]
ds_read_b128 a[252:255], v15 offset:18432
v_perm_b32 v60, v45, v19, s53
v_mfma_f32_16x16x32_bf16 v[180:183], a[244:247], a[4:7], v[180:183]
ds_read_b32 a59, v60
v_perm_b32 v59, v41, v19, s54
v_mfma_f32_16x16x32_bf16 v[184:187], a[244:247], a[8:11], v[184:187]
ds_read_b32 a60, v59
v_perm_b32 v58, v41, v19, s55
v_mfma_f32_16x16x32_bf16 v[188:191], a[244:247], a[12:15], v[188:191]
s_waitcnt lgkmcnt(4)
ds_read_b32 a61, v58
v_mfma_f32_16x16x32_bf16 v[192:195], a[248:251], a[176:179], v[192:195]
ds_read_b128 a[224:227], v15 offset:20480
v_perm_b32 v57, v45, v19, s54
v_mfma_f32_16x16x32_bf16 v[196:199], a[248:251], a[180:183], v[196:199]
ds_read_b32 a62, v57
v_perm_b32 v56, v45, v19, s55
v_mfma_f32_16x16x32_bf16 v[200:203], a[248:251], a[184:187], v[200:203]
ds_read_b32 a63, v56
v_mfma_f32_16x16x32_bf16 v[204:207], a[248:251], a[188:191], v[204:207]
s_waitcnt lgkmcnt(4)
v_mfma_f32_16x16x32_bf16 v[208:211], a[252:255], a[176:179], v[208:211]
ds_read_b128 a[228:231], v15 offset:22528
v_mfma_f32_16x16x32_bf16 v[212:215], a[252:255], a[180:183], v[212:215]
v_mfma_f32_16x16x32_bf16 v[216:219], a[252:255], a[184:187], v[216:219]
v_mfma_f32_16x16x32_bf16 v[220:223], a[252:255], a[188:191], v[220:223]
s_waitcnt lgkmcnt(1)
v_mfma_f32_16x16x32_bf16 v[128:131], a[224:227], a[48:51], v[128:131]
ds_read_b128 a[232:235], v15 offset:24576
v_mfma_f32_16x16x32_bf16 v[132:135], a[224:227], a[52:55], v[132:135]
v_mfma_f32_16x16x32_bf16 v[136:139], a[224:227], a[56:59], v[136:139]
v_mfma_f32_16x16x32_bf16 v[140:143], a[224:227], a[60:63], v[140:143]
s_waitcnt lgkmcnt(1)
v_mfma_f32_16x16x32_bf16 v[144:147], a[228:231], a[48:51], v[144:147]
ds_read_b128 a[236:239], v15 offset:26624
v_mfma_f32_16x16x32_bf16 v[148:151], a[228:231], a[52:55], v[148:151]
v_mfma_f32_16x16x32_bf16 v[152:155], a[228:231], a[56:59], v[152:155]
v_mfma_f32_16x16x32_bf16 v[156:159], a[228:231], a[60:63], v[156:159]
s_waitcnt lgkmcnt(1)
v_mfma_f32_16x16x32_bf16 v[160:163], a[232:235], a[16:19], v[160:163]
ds_read_b128 a[240:243], v14 offset:28672
v_mfma_f32_16x16x32_bf16 v[164:167], a[232:235], a[20:23], v[164:167]
L_PAD5:
s_cbranch_vccnz L_PADRET
v_mfma_f32_16x16x32_bf16 v[168:171], a[232:235], a[24:27], v[168:171]
v_mfma_f32_16x16x32_bf16 v[172:175], a[232:235], a[28:31], v[172:175]
s_waitcnt lgkmcnt(1)
v_mul_f32 v128, v128, v24
v_mul_f32 v132, v132, v25
v_mfma_f32_16x16x32_bf16 v[176:179], a[236:239], a[16:19], v[176:179]
s_waitcnt vmcnt(0)
s_barrier
ds_read_b128 a[244:247], v14 offset:30720
v_mul_f32 v136, v136, v26
v_mfma_f32_16x16x32_bf16 v[180:183], a[236:239], a[20:23], v[180:183]
v_mul_f32 v140, v140, v27
v_cvt_pk_bf16_f32 v120, v128, v132
v_mfma_f32_16x16x32_bf16 v[184:187], a[236:239], a[24:27], v[184:187]
v_cvt_pk_bf16_f32 v121, v136, v140
v_mfma_f32_16x16x32_bf16 v[188:191], a[236:239], a[28:31], v[188:191]
s_waitcnt lgkmcnt(1)
v_mfma_f32_16x16x32_bf16 v[192:195], a[240:243], a[192:195], v[192:195]
ds_read_b128 a[248:251], v14 offset:32768
v_mfma_f32_16x16x32_bf16 v[196:199], a[240:243], a[196:199], v[196:199]
buffer_store_dwordx2 v[120:121], v18, s[28:31], 0 offen nt
v_mul_f32 v129, v129, v24
v_mfma_f32_16x16x32_bf16 v[200:203], a[240:243], a[200:203], v[200:203]
s_add_u32 s28, s28, 7168
v_mul_f32 v133, v133, v25
v_mul_f32 v137, v137, v26
v_mfma_f32_16x16x32_bf16 v[204:207], a[240:243], a[204:207], v[204:207]
s_waitcnt lgkmcnt(1)
v_mul_f32 v141, v141, v27
v_cvt_pk_bf16_f32 v122, v129, v133
v_mfma_f32_16x16x32_bf16 v[208:211], a[244:247], a[192:195], v[208:211]
s_addc_u32 s29, s29, 0
ds_read_b128 a[252:255], v14 offset:34816
v_cvt_pk_bf16_f32 v123, v137, v141
v_mfma_f32_16x16x32_bf16 v[212:215], a[244:247], a[196:199], v[212:215]
buffer_store_dwordx2 v[122:123], v18, s[28:31], 0 offen nt
v_mul_f32 v130, v130, v24
v_mfma_f32_16x16x32_bf16 v[216:219], a[244:247], a[200:203], v[216:219]
s_add_u32 s28, s28, 7168
v_mul_f32 v134, v134, v25
v_mul_f32 v138, v138, v26
v_mfma_f32_16x16x32_bf16 v[220:223], a[244:247], a[204:207], v[220:223]
s_waitcnt lgkmcnt(1)
v_mul_f32 v142, v142, v27
v_cvt_pk_bf16_f32 v124, v130, v134
v_mfma_f32_16x16x32_bf16 v[224:227], a[248:251], a[128:131], v[224:227]
s_addc_u32 s29, s29, 0
ds_read_b128 a[224:227], v14 offset:36864
v_cvt_pk_bf16_f32 v125, v138, v142
v_mfma_f32_16x16x32_bf16 v[228:231], a[248:251], a[132:135], v[228:231]
buffer_store_dwordx2 v[124:125], v18, s[28:31], 0 offen nt
v_mul_f32 v131, v131, v24
v_mfma_f32_16x16x32_bf16 v[232:235], a[248:251], a[136:139], v[232:235]
s_add_u32 s28, s28, 7168
v_mul_f32 v135, v135, v25
v_mul_f32 v139, v139, v26
v_mfma_f32_16x16x32_bf16 v[236:239], a[248:251], a[140:143], v[236:239]
s_waitcnt lgkmcnt(1)
v_mul_f32 v143, v143, v27
v_cvt_pk_bf16_f32 v126, v131, v135
v_mfma_f32_16x16x32_bf16 v[240:243], a[252:255], a[128:131], v[240:243]
s_addc_u32 s29, s29, 0
ds_read_b128 a[228:231], v14 offset:38912
v_cvt_pk_bf16_f32 v127, v139, v143
v_mfma_f32_16x16x32_bf16 v[244:247], a[252:255], a[132:135], v[244:247]
buffer_store_dwordx2 v[126:127], v18, s[28:31], 0 offen nt
v_mul_f32 v144, v144, v24
v_mfma_f32_16x16x32_bf16 v[248:251], a[252:255], a[136:139], v[248:251]
s_add_u32 s28, s28, 93184
v_mul_f32 v148, v148, v25
v_mul_f32 v152, v152, v26
v_mfma_f32_16x16x32_bf16 v[252:255], a[252:255], a[140:143], v[252:255]
s_waitcnt lgkmcnt(1)
v_mul_f32 v156, v156, v27
v_cvt_pk_bf16_f32 v120, v144, v148
v_mfma_f32_16x16x32_bf16 v[160:163], a[224:227], a[32:35], v[160:163]
s_addc_u32 s29, s29, 0
ds_read_b128 a[232:235], v15 offset:28672
v_cvt_pk_bf16_f32 v121, v152, v156
v_mfma_f32_16x16x32_bf16 v[164:167], a[224:227], a[36:39], v[164:167]
buffer_store_dwordx2 v[120:121], v18, s[28:31], 0 offen nt
v_mul_f32 v145, v145, v24
v_mfma_f32_16x16x32_bf16 v[168:171], a[224:227], a[40:43], v[168:171]
s_add_u32 s28, s28, 7168
v_mul_f32 v149, v149, v25
v_mul_f32 v153, v153, v26
v_mfma_f32_16x16x32_bf16 v[172:175], a[224:227], a[44:47], v[172:175]
s_waitcnt lgkmcnt(1)
v_mul_f32 v157, v157, v27
v_cvt_pk_bf16_f32 v122, v145, v149
v_mfma_f32_16x16x32_bf16 v[176:179], a[228:231], a[32:35], v[176:179]
s_addc_u32 s29, s29, 0
ds_read_b128 a[236:239], v15 offset:30720
v_cvt_pk_bf16_f32 v123, v153, v157
v_mfma_f32_16x16x32_bf16 v[180:183], a[228:231], a[36:39], v[180:183]
buffer_store_dwordx2 v[122:123], v18, s[28:31], 0 offen nt
v_mul_f32 v146, v146, v24
v_mfma_f32_16x16x32_bf16 v[184:187], a[228:231], a[40:43], v[184:187]
s_add_u32 s28, s28, 7168
v_mul_f32 v150, v150, v25
v_mul_f32 v154, v154, v26
v_mfma_f32_16x16x32_bf16 v[188:191], a[228:231], a[44:47], v[188:191]
s_waitcnt lgkmcnt(1)
v_mul_f32 v158, v158, v27
v_cvt_pk_bf16_f32 v124, v146, v150
v_mfma_f32_16x16x32_bf16 v[192:195], a[232:235], a[208:211], v[192:195]
s_addc_u32 s29, s29, 0
ds_read_b128 a[240:243], v15 offset:36864
v_cvt_pk_bf16_f32 v125, v154, v158
v_mfma_f32_16x16x32_bf16 v[196:199], a[232:235], a[212:215], v[196:199]
buffer_store_dwordx2 v[124:125], v18, s[28:31], 0 offen nt
v_mul_f32 v147, v147, v24
v_mfma_f32_16x16x32_bf16 v[200:203], a[232:235], a[216:219], v[200:203]
s_add_u32 s28, s28, 7168
v_mul_f32 v151, v151, v25
v_mul_f32 v155, v155, v26
v_mfma_f32_16x16x32_bf16 v[204:207], a[232:235], a[220:223], v[204:207]
s_waitcnt lgkmcnt(1)
v_mul_f32 v159, v159, v27
v_cvt_pk_bf16_f32 v126, v147, v151
v_mfma_f32_16x16x32_bf16 v[208:211], a[236:239], a[208:211], v[208:211]
s_addc_u32 s29, s29, 0
ds_read_b128 a[244:247], v15 offset:38912
v_cvt_pk_bf16_f32 v127, v155, v159
v_mfma_f32_16x16x32_bf16 v[212:215], a[236:239], a[212:215], v[212:215]
buffer_store_dwordx2 v[126:127], v18, s[28:31], 0 offen nt
v_mfma_f32_16x16x32_bf16 v[216:219], a[236:239], a[216:219], v[216:219]
v_mfma_f32_16x16x32_bf16 v[220:223], a[236:239], a[220:223], v[220:223]
s_waitcnt lgkmcnt(1)
v_mfma_f32_16x16x32_bf16 v[160:163], a[240:243], a[48:51], v[160:163]
ds_read_b128 a[248:251], v15 offset:32768
v_mfma_f32_16x16x32_bf16 v[164:167], a[240:243], a[52:55], v[164:167]
v_mfma_f32_16x16x32_bf16 v[168:171], a[240:243], a[56:59], v[168:171]
v_mfma_f32_16x16x32_bf16 v[172:175], a[240:243], a[60:63], v[172:175]
s_waitcnt lgkmcnt(1)
v_mfma_f32_16x16x32_bf16 v[176:179], a[244:247], a[48:51], v[176:179]
ds_read_b128 a[252:255], v15 offset:34816
v_mfma_f32_16x16x32_bf16 v[180:183], a[244:247], a[52:55], v[180:183]
v_mfma_f32_16x16x32_bf16 v[184:187], a[244:247], a[56:59], v[184:187]
v_mfma_f32_16x16x32_bf16 v[188:191], a[244:247], a[60:63], v[188:191]
s_waitcnt lgkmcnt(1)
v_mfma_f32_16x16x32_bf16 v[224:227], a[248:251], a[144:147], v[224:227]
ds_read_b128 a[224:227], v14 offset:40960
v_mfma_f32_16x16x32_bf16 v[228:231], a[248:251], a[148:151], v[228:231]
v_mfma_f32_16x16x32_bf16 v[232:235], a[248:251], a[152:155], v[232:235]
v_mfma_f32_16x16x32_bf16 v[236:239], a[248:251], a[156:159], v[236:239]
s_waitcnt lgkmcnt(1)
v_mul_f32 v160, v160, v24
v_mul_f32 v164, v164, v25
v_mfma_f32_16x16x32_bf16 v[240:243], a[252:255], a[144:147], v[240:243]
s_add_u32 s28, s28, 93184
ds_read_b128 a[228:231], v14 offset:43008
v_mul_f32 v168, v168, v26
v_mfma_f32_16x16x32_bf16 v[244:247], a[252:255], a[148:151], v[244:247]
s_addc_u32 s29, s29, 0
v_mul_f32 v172, v172, v27
v_cvt_pk_bf16_f32 v120, v160, v164
v_mfma_f32_16x16x32_bf16 v[248:251], a[252:255], a[152:155], v[248:251]
v_cvt_pk_bf16_f32 v121, v168, v172
v_mfma_f32_16x16x32_bf16 v[252:255], a[252:255], a[156:159], v[252:255]
s_waitcnt lgkmcnt(1)
v_mfma_f32_16x16x32_bf16 v[192:195], a[224:227], a[0:3], v[192:195]
ds_read_b128 a[232:235], v15 offset:40960
v_mfma_f32_16x16x32_bf16 v[196:199], a[224:227], a[4:7], v[196:199]
buffer_store_dwordx2 v[120:121], v18, s[28:31], 0 offen nt
v_mul_f32 v161, v161, v24
v_mfma_f32_16x16x32_bf16 v[200:203], a[224:227], a[8:11], v[200:203]
s_add_u32 s28, s28, 7168
v_mul_f32 v165, v165, v25
v_mul_f32 v169, v169, v26
v_mfma_f32_16x16x32_bf16 v[204:207], a[224:227], a[12:15], v[204:207]
s_waitcnt lgkmcnt(1)
v_mul_f32 v173, v173, v27
v_cvt_pk_bf16_f32 v122, v161, v165
v_mfma_f32_16x16x32_bf16 v[208:211], a[228:231], a[0:3], v[208:211]
s_addc_u32 s29, s29, 0
ds_read_b128 a[236:239], v15 offset:43008
v_cvt_pk_bf16_f32 v123, v169, v173
v_mfma_f32_16x16x32_bf16 v[212:215], a[228:231], a[4:7], v[212:215]
buffer_store_dwordx2 v[122:123], v18, s[28:31], 0 offen nt
v_mul_f32 v162, v162, v24
v_mfma_f32_16x16x32_bf16 v[216:219], a[228:231], a[8:11], v[216:219]
s_add_u32 s28, s28, 7168
v_mul_f32 v166, v166, v25
v_mul_f32 v170, v170, v26
v_mfma_f32_16x16x32_bf16 v[220:223], a[228:231], a[12:15], v[220:223]
s_waitcnt lgkmcnt(1)
v_mul_f32 v174, v174, v27
v_cvt_pk_bf16_f32 v124, v162, v166
v_mfma_f32_16x16x32_bf16 v[192:195], a[232:235], a[16:19], v[192:195]
s_addc_u32 s29, s29, 0
ds_read_b128 a[240:243], v14 offset:45056
v_cvt_pk_bf16_f32 v125, v170, v174
v_mfma_f32_16x16x32_bf16 v[196:199], a[232:235], a[20:23], v[196:199]
buffer_store_dwordx2 v[124:125], v18, s[28:31], 0 offen nt
v_mul_f32 v163, v163, v24
v_mfma_f32_16x16x32_bf16 v[200:203], a[232:235], a[24:27], v[200:203]
s_add_u32 s28, s28, 7168
v_mul_f32 v167, v167, v25
v_mul_f32 v171, v171, v26
v_mfma_f32_16x16x32_bf16 v[204:207], a[232:235], a[28:31], v[204:207]
s_waitcnt lgkmcnt(1)
v_mul_f32 v175, v175, v27
v_cvt_pk_bf16_f32 v126, v163, v167
v_mfma_f32_16x16x32_bf16 v[208:211], a[236:239], a[16:19], v[208:211]
s_addc_u32 s29, s29, 0
ds_read_b128 a[244:247], v14 offset:47104
v_cvt_pk_bf16_f32 v127, v171, v175
v_mfma_f32_16x16x32_bf16 v[212:215], a[236:239], a[20:23], v[212:215]
buffer_store_dwordx2 v[126:127], v18, s[28:31], 0 offen nt
v_mul_f32 v176, v176, v24
v_mfma_f32_16x16x32_bf16 v[216:219], a[236:239], a[24:27], v[216:219]
s_add_u32 s28, s28, 93184
v_mul_f32 v180, v180, v25
v_mul_f32 v184, v184, v26
v_mfma_f32_16x16x32_bf16 v[220:223], a[236:239], a[28:31], v[220:223]
s_waitcnt lgkmcnt(1)
v_mul_f32 v188, v188, v27
v_cvt_pk_bf16_f32 v120, v176, v180
v_mfma_f32_16x16x32_bf16 v[224:227], a[240:243], a[160:163], v[224:227]
s_addc_u32 s29, s29, 0
ds_read_b128 a[248:251], v14 offset:49152
v_cvt_pk_bf16_f32 v121, v184, v188
v_mfma_f32_16x16x32_bf16 v[228:231], a[240:243], a[164:167], v[228:231]
buffer_store_dwordx2 v[120:121], v18, s[28:31], 0 offen nt
v_mul_f32 v177, v177, v24
v_mfma_f32_16x16x32_bf16 v[232:235], a[240:243], a[168:171], v[232:235]
s_add_u32 s28, s28, 7168
v_mul_f32 v181, v181, v25
v_mul_f32 v185, v185, v26
v_mfma_f32_16x16x32_bf16 v[236:239], a[240:243], a[172:175], v[236:239]
s_waitcnt lgkmcnt(1)
v_mul_f32 v189, v189, v27
v_cvt_pk_bf16_f32 v122, v177, v181
v_mfma_f32_16x16x32_bf16 v[240:243], a[244:247], a[160:163], v[240:243]
s_addc_u32 s29, s29, 0
ds_read_b128 a[252:255], v14 offset:51200
v_cvt_pk_bf16_f32 v123, v185, v189
v_mfma_f32_16x16x32_bf16 v[244:247], a[244:247], a[164:167], v[244:247]
buffer_store_dwordx2 v[122:123], v18, s[28:31], 0 offen nt
v_mul_f32 v178, v178, v24
v_mfma_f32_16x16x32_bf16 v[248:251], a[244:247], a[168:171], v[248:251]
s_add_u32 s28, s28, 7168
v_mul_f32 v182, v182, v25
v_mul_f32 v186, v186, v26
v_mfma_f32_16x16x32_bf16 v[252:255], a[244:247], a[172:175], v[252:255]
s_waitcnt lgkmcnt(1)
v_mul_f32 v190, v190, v27
v_cvt_pk_bf16_f32 v124, v178, v182
v_mfma_f32_16x16x32_bf16 v[192:195], a[248:251], a[32:35], v[192:195]
s_addc_u32 s29, s29, 0
ds_read_b128 a[224:227], v15 offset:45056
v_cvt_pk_bf16_f32 v125, v186, v190
v_mfma_f32_16x16x32_bf16 v[196:199], a[248:251], a[36:39], v[196:199]
buffer_store_dwordx2 v[124:125], v18, s[28:31], 0 offen nt
v_mul_f32 v179, v179, v24
v_mfma_f32_16x16x32_bf16 v[200:203], a[248:251], a[40:43], v[200:203]
s_add_u32 s28, s28, 7168
v_mul_f32 v183, v183, v25
v_mul_f32 v187, v187, v26
v_mfma_f32_16x16x32_bf16 v[204:207], a[248:251], a[44:47], v[204:207]
s_waitcnt lgkmcnt(1)
v_mul_f32 v191, v191, v27
v_cvt_pk_bf16_f32 v126, v179, v183
v_mfma_f32_16x16x32_bf16 v[208:211], a[252:255], a[32:35], v[208:211]
s_addc_u32 s29, s29, 0
ds_read_b128 a[228:231], v15 offset:47104
v_cvt_pk_bf16_f32 v127, v187, v191
v_mfma_f32_16x16x32_bf16 v[212:215], a[252:255], a[36:39], v[212:215]
buffer_store_dwordx2 v[126:127], v18, s[28:31], 0 offen nt
v_mfma_f32_16x16x32_bf16 v[216:219], a[252:255], a[40:43], v[216:219]
v_mfma_f32_16x16x32_bf16 v[220:223], a[252:255], a[44:47], v[220:223]
s_waitcnt lgkmcnt(1)
v_mfma_f32_16x16x32_bf16 v[224:227], a[224:227], a[176:179], v[224:227]
ds_read_b128 a[232:235], v15 offset:49152
v_mfma_f32_16x16x32_bf16 v[228:231], a[224:227], a[180:183], v[228:231]
v_mfma_f32_16x16x32_bf16 v[232:235], a[224:227], a[184:187], v[232:235]
v_mfma_f32_16x16x32_bf16 v[236:239], a[224:227], a[188:191], v[236:239]
s_waitcnt lgkmcnt(1)
v_mfma_f32_16x16x32_bf16 v[240:243], a[228:231], a[176:179], v[240:243]
ds_read_b128 a[236:239], v15 offset:51200
v_mfma_f32_16x16x32_bf16 v[244:247], a[228:231], a[180:183], v[244:247]
v_mfma_f32_16x16x32_bf16 v[248:251], a[228:231], a[184:187], v[248:251]
v_mfma_f32_16x16x32_bf16 v[252:255], a[228:231], a[188:191], v[252:255]
s_waitcnt lgkmcnt(1)
v_mfma_f32_16x16x32_bf16 v[192:195], a[232:235], a[48:51], v[192:195]
ds_read_b128 a[240:243], v14 offset:53248
v_mfma_f32_16x16x32_bf16 v[196:199], a[232:235], a[52:55], v[196:199]
v_mfma_f32_16x16x32_bf16 v[200:203], a[232:235], a[56:59], v[200:203]
v_mfma_f32_16x16x32_bf16 v[204:207], a[232:235], a[60:63], v[204:207]
s_waitcnt lgkmcnt(1)
v_mfma_f32_16x16x32_bf16 v[208:211], a[236:239], a[48:51], v[208:211]
ds_read_b128 a[244:247], v14 offset:55296
v_mfma_f32_16x16x32_bf16 v[212:215], a[236:239], a[52:55], v[212:215]
v_mfma_f32_16x16x32_bf16 v[216:219], a[236:239], a[56:59], v[216:219]
v_mfma_f32_16x16x32_bf16 v[220:223], a[236:239], a[60:63], v[220:223]
s_waitcnt lgkmcnt(1)
v_mfma_f32_16x16x32_bf16 v[224:227], a[240:243], a[192:195], v[224:227]
ds_read_b128 a[248:251], v15 offset:53248
v_mfma_f32_16x16x32_bf16 v[228:231], a[240:243], a[196:199], v[228:231]
v_mfma_f32_16x16x32_bf16 v[232:235], a[240:243], a[200:203], v[232:235]
v_mfma_f32_16x16x32_bf16 v[236:239], a[240:243], a[204:207], v[236:239]
s_waitcnt lgkmcnt(1)
v_mul_f32 v192, v192, v24
v_mul_f32 v196, v196, v25
v_mfma_f32_16x16x32_bf16 v[240:243], a[244:247], a[192:195], v[240:243]
s_add_u32 s28, s28, 93184
ds_read_b128 a[252:255], v15 offset:55296
v_mul_f32 v200, v200, v26
v_mfma_f32_16x16x32_bf16 v[244:247], a[244:247], a[196:199], v[244:247]
s_addc_u32 s29, s29, 0
v_mul_f32 v204, v204, v27
v_cvt_pk_bf16_f32 v120, v192, v196
v_mfma_f32_16x16x32_bf16 v[248:251], a[244:247], a[200:203], v[248:251]
v_cvt_pk_bf16_f32 v121, v200, v204
v_mfma_f32_16x16x32_bf16 v[252:255], a[244:247], a[204:207], v[252:255]
s_waitcnt lgkmcnt(1)
v_mfma_f32_16x16x32_bf16 v[224:227], a[248:251], a[208:211], v[224:227]
ds_read_b128 a[224:227], v14 offset:57344
v_mfma_f32_16x16x32_bf16 v[228:231], a[248:251], a[212:215], v[228:231]
buffer_store_dwordx2 v[120:121], v18, s[28:31], 0 offen nt
v_mul_f32 v193, v193, v24
v_mfma_f32_16x16x32_bf16 v[232:235], a[248:251], a[216:219], v[232:235]
s_add_u32 s28, s28, 7168
v_mul_f32 v197, v197, v25
v_mul_f32 v201, v201, v26
v_mfma_f32_16x16x32_bf16 v[236:239], a[248:251], a[220:223], v[236:239]
s_waitcnt lgkmcnt(1)
v_mul_f32 v205, v205, v27
v_cvt_pk_bf16_f32 v122, v193, v197
v_mfma_f32_16x16x32_bf16 v[240:243], a[252:255], a[208:211], v[240:243]
s_addc_u32 s29, s29, 0
ds_read_b128 a[228:231], v14 offset:59392
v_cvt_pk_bf16_f32 v123, v201, v205
v_mfma_f32_16x16x32_bf16 v[244:247], a[252:255], a[212:215], v[244:247]
buffer_store_dwordx2 v[122:123], v18, s[28:31], 0 offen nt
v_mul_f32 v194, v194, v24
v_mfma_f32_16x16x32_bf16 v[248:251], a[252:255], a[216:219], v[248:251]
s_add_u32 s28, s28, 7168
v_mul_f32 v198, v198, v25
v_mul_f32 v202, v202, v26
v_mfma_f32_16x16x32_bf16 v[252:255], a[252:255], a[220:223], v[252:255]
s_waitcnt lgkmcnt(1)
v_mul_f32 v206, v206, v27
v_cvt_pk_bf16_f32 v124, v194, v198
v_mfma_f32_16x16x32_bf16 v[224:227], a[224:227], a[0:3], v[224:227]
s_addc_u32 s29, s29, 0
ds_read_b128 a[232:235], v15 offset:57344
v_cvt_pk_bf16_f32 v125, v202, v206
v_mfma_f32_16x16x32_bf16 v[228:231], a[224:227], a[4:7], v[228:231]
buffer_store_dwordx2 v[124:125], v18, s[28:31], 0 offen nt
v_mul_f32 v195, v195, v24
v_mfma_f32_16x16x32_bf16 v[232:235], a[224:227], a[8:11], v[232:235]
s_add_u32 s28, s28, 7168
v_mul_f32 v199, v199, v25
v_mul_f32 v203, v203, v26
v_mfma_f32_16x16x32_bf16 v[236:239], a[224:227], a[12:15], v[236:239]
s_waitcnt lgkmcnt(1)
v_mul_f32 v207, v207, v27
v_cvt_pk_bf16_f32 v126, v195, v199
v_mfma_f32_16x16x32_bf16 v[240:243], a[228:231], a[0:3], v[240:243]
s_addc_u32 s29, s29, 0
ds_read_b128 a[236:239], v15 offset:59392
v_cvt_pk_bf16_f32 v127, v203, v207
v_mfma_f32_16x16x32_bf16 v[244:247], a[228:231], a[4:7], v[244:247]
buffer_store_dwordx2 v[126:127], v18, s[28:31], 0 offen nt
v_mul_f32 v208, v208, v24
v_mfma_f32_16x16x32_bf16 v[248:251], a[228:231], a[8:11], v[248:251]
s_add_u32 s28, s28, 93184
v_mul_f32 v212, v212, v25
v_mul_f32 v216, v216, v26
v_mfma_f32_16x16x32_bf16 v[252:255], a[228:231], a[12:15], v[252:255]
s_waitcnt lgkmcnt(1)
v_mul_f32 v220, v220, v27
v_cvt_pk_bf16_f32 v120, v208, v212
v_mfma_f32_16x16x32_bf16 v[224:227], a[232:235], a[16:19], v[224:227]
s_addc_u32 s29, s29, 0
ds_read_b128 a[240:243], v14 offset:61440
v_cvt_pk_bf16_f32 v121, v216, v220
v_mfma_f32_16x16x32_bf16 v[228:231], a[232:235], a[20:23], v[228:231]
buffer_store_dwordx2 v[120:121], v18, s[28:31], 0 offen nt
v_mul_f32 v209, v209, v24
v_mfma_f32_16x16x32_bf16 v[232:235], a[232:235], a[24:27], v[232:235]
s_add_u32 s28, s28, 7168
v_mul_f32 v213, v213, v25
v_mul_f32 v217, v217, v26
v_mfma_f32_16x16x32_bf16 v[236:239], a[232:235], a[28:31], v[236:239]
s_waitcnt lgkmcnt(1)
v_mul_f32 v221, v221, v27
v_cvt_pk_bf16_f32 v122, v209, v213
v_mfma_f32_16x16x32_bf16 v[240:243], a[236:239], a[16:19], v[240:243]
s_addc_u32 s29, s29, 0
ds_read_b128 a[244:247], v14 offset:63488
v_cvt_pk_bf16_f32 v123, v217, v221
v_mfma_f32_16x16x32_bf16 v[244:247], a[236:239], a[20:23], v[244:247]
buffer_store_dwordx2 v[122:123], v18, s[28:31], 0 offen nt
v_mul_f32 v210, v210, v24
v_mfma_f32_16x16x32_bf16 v[248:251], a[236:239], a[24:27], v[248:251]
s_add_u32 s28, s28, 7168
v_mul_f32 v214, v214, v25
v_mul_f32 v218, v218, v26
v_mfma_f32_16x16x32_bf16 v[252:255], a[236:239], a[28:31], v[252:255]
s_waitcnt lgkmcnt(1)
v_mul_f32 v222, v222, v27
v_cvt_pk_bf16_f32 v124, v210, v214
v_mfma_f32_16x16x32_bf16 v[224:227], a[240:243], a[32:35], v[224:227]
s_addc_u32 s29, s29, 0
ds_read_b128 a[248:251], v15 offset:61440
v_cvt_pk_bf16_f32 v125, v218, v222
v_mfma_f32_16x16x32_bf16 v[228:231], a[240:243], a[36:39], v[228:231]
buffer_store_dwordx2 v[124:125], v18, s[28:31], 0 offen nt
v_mul_f32 v211, v211, v24
v_mfma_f32_16x16x32_bf16 v[232:235], a[240:243], a[40:43], v[232:235]
s_add_u32 s28, s28, 7168
v_mul_f32 v215, v215, v25
v_mul_f32 v219, v219, v26
v_mfma_f32_16x16x32_bf16 v[236:239], a[240:243], a[44:47], v[236:239]
s_waitcnt lgkmcnt(1)
v_mul_f32 v223, v223, v27
v_cvt_pk_bf16_f32 v126, v211, v215
v_mfma_f32_16x16x32_bf16 v[240:243], a[244:247], a[32:35], v[240:243]
s_addc_u32 s29, s29, 0
ds_read_b128 a[252:255], v15 offset:63488
v_cvt_pk_bf16_f32 v127, v219, v223
v_mfma_f32_16x16x32_bf16 v[244:247], a[244:247], a[36:39], v[244:247]
buffer_store_dwordx2 v[126:127], v18, s[28:31], 0 offen nt
v_mfma_f32_16x16x32_bf16 v[248:251], a[244:247], a[40:43], v[248:251]
v_mfma_f32_16x16x32_bf16 v[252:255], a[244:247], a[44:47], v[252:255]
s_waitcnt lgkmcnt(1)
v_mfma_f32_16x16x32_bf16 v[224:227], a[248:251], a[48:51], v[224:227]
v_mfma_f32_16x16x32_bf16 v[228:231], a[248:251], a[52:55], v[228:231]
v_mfma_f32_16x16x32_bf16 v[232:235], a[248:251], a[56:59], v[232:235]
v_mfma_f32_16x16x32_bf16 v[236:239], a[248:251], a[60:63], v[236:239]
s_waitcnt lgkmcnt(0)
v_mfma_f32_16x16x32_bf16 v[240:243], a[252:255], a[48:51], v[240:243]
v_mfma_f32_16x16x32_bf16 v[244:247], a[252:255], a[52:55], v[244:247]
v_mfma_f32_16x16x32_bf16 v[248:251], a[252:255], a[56:59], v[248:251]
v_mfma_f32_16x16x32_bf16 v[252:255], a[252:255], a[60:63], v[252:255]
s_nop 7
v_pk_mul_f32 v[224:225], v[224:225], v[24:25] op_sel:[0,0] op_sel_hi:[1,0]
v_pk_mul_f32 v[228:229], v[228:229], v[24:25] op_sel:[0,1] op_sel_hi:[1,1]
v_pk_mul_f32 v[232:233], v[232:233], v[26:27] op_sel:[0,0] op_sel_hi:[1,0]
v_pk_mul_f32 v[236:237], v[236:237], v[26:27] op_sel:[0,1] op_sel_hi:[1,1]
v_cvt_pk_bf16_f32 v120, v224, v228
v_cvt_pk_bf16_f32 v121, v232, v236
s_add_u32 s28, s28, 93184
s_addc_u32 s29, s29, 0
buffer_store_dwordx2 v[120:121], v18, s[28:31], 0 offen nt
v_cvt_pk_bf16_f32 v122, v225, v229
v_cvt_pk_bf16_f32 v123, v233, v237
s_add_u32 s28, s28, 7168
s_addc_u32 s29, s29, 0
buffer_store_dwordx2 v[122:123], v18, s[28:31], 0 offen nt
v_pk_mul_f32 v[226:227], v[226:227], v[24:25] op_sel:[0,0] op_sel_hi:[1,0]
v_pk_mul_f32 v[230:231], v[230:231], v[24:25] op_sel:[0,1] op_sel_hi:[1,1]
v_pk_mul_f32 v[234:235], v[234:235], v[26:27] op_sel:[0,0] op_sel_hi:[1,0]
v_pk_mul_f32 v[238:239], v[238:239], v[26:27] op_sel:[0,1] op_sel_hi:[1,1]
v_cvt_pk_bf16_f32 v124, v226, v230
v_cvt_pk_bf16_f32 v125, v234, v238
s_add_u32 s28, s28, 7168
s_addc_u32 s29, s29, 0
buffer_store_dwordx2 v[124:125], v18, s[28:31], 0 offen nt
v_cvt_pk_bf16_f32 v126, v227, v231
v_cvt_pk_bf16_f32 v127, v235, v239
s_add_u32 s28, s28, 7168
s_addc_u32 s29, s29, 0
buffer_store_dwordx2 v[126:127], v18, s[28:31], 0 offen nt
v_pk_mul_f32 v[240:241], v[240:241], v[24:25] op_sel:[0,0] op_sel_hi:[1,0]
v_pk_mul_f32 v[244:245], v[244:245], v[24:25] op_sel:[0,1] op_sel_hi:[1,1]
v_pk_mul_f32 v[248:249], v[248:249], v[26:27] op_sel:[0,0] op_sel_hi:[1,0]
v_pk_mul_f32 v[252:253], v[252:253], v[26:27] op_sel:[0,1] op_sel_hi:[1,1]
v_cvt_pk_bf16_f32 v120, v240, v244
v_cvt_pk_bf16_f32 v121, v248, v252
s_add_u32 s28, s28, 93184
s_addc_u32 s29, s29, 0
buffer_store_dwordx2 v[120:121], v18, s[28:31], 0 offen nt
v_cvt_pk_bf16_f32 v122, v241, v245
v_cvt_pk_bf16_f32 v123, v249, v253
s_add_u32 s28, s28, 7168
s_addc_u32 s29, s29, 0
buffer_store_dwordx2 v[122:123], v18, s[28:31], 0 offen nt
v_pk_mul_f32 v[242:243], v[242:243], v[24:25] op_sel:[0,0] op_sel_hi:[1,0]
v_pk_mul_f32 v[246:247], v[246:247], v[24:25] op_sel:[0,1] op_sel_hi:[1,1]
v_pk_mul_f32 v[250:251], v[250:251], v[26:27] op_sel:[0,0] op_sel_hi:[1,0]
v_pk_mul_f32 v[254:255], v[254:255], v[26:27] op_sel:[0,1] op_sel_hi:[1,1]
v_cvt_pk_bf16_f32 v124, v242, v246
v_cvt_pk_bf16_f32 v125, v250, v254
s_add_u32 s28, s28, 7168
s_addc_u32 s29, s29, 0
buffer_store_dwordx2 v[124:125], v18, s[28:31], 0 offen nt
v_cvt_pk_bf16_f32 v126, v243, v247
v_cvt_pk_bf16_f32 v127, v251, v255
s_add_u32 s28, s28, 7168
s_addc_u32 s29, s29, 0
buffer_store_dwordx2 v[126:127], v18, s[28:31], 0 offen nt
s_endpgm
L_NOTAG:
buffer_load_dwordx2 v[22:23], off, s[80:83], 0 sc1
s_waitcnt vmcnt(0)
v_readfirstlane_b32 s88, v22
v_readfirstlane_b32 s89, v23
s_sub_u32 s90, s90, 1
s_nop 0
s_cmp_eq_u64 s[88:89], 0
s_cbranch_scc0 L_TAGOK
s_cmp_gt_i32 s90, 0
s_cbranch_scc1 L_NOTAG
s_mov_b32 s26, 0
s_mov_b32 s78, 0
s_mov_b32 s86, 0
s_mov_b64 s[88:89], 1
s_branch L_TAGOK
L_SLOW0:
s_lshr_b32 s91, s40, 6
s_add_u32 s91, s91, 0
s_call_b64 s[100:101], L_WAIT
v_mov_b64 v[32:33], v[120:121]
v_mov_b64 v[36:37], v[124:125]
s_branch L_BACK0
L_SLOW1:
s_lshr_b32 s91, s40, 6
s_add_u32 s91, s91, 1
s_call_b64 s[100:101], L_WAIT
v_mov_b64 v[40:41], v[120:121]
v_mov_b64 v[44:45], v[124:125]
s_branch L_BACK1
L_SLOW2:
s_lshr_b32 s91, s41, 6
s_add_u32 s91, s91, 0
s_call_b64 s[100:101], L_WAIT
v_mov_b64 v[48:49], v[120:121]
v_mov_b64 v[52:53], v[124:125]
s_branch L_BACK2
L_SLOW3:
s_lshr_b32 s91, s41, 6
s_add_u32 s91, s91, 1
s_call_b64 s[100:101], L_WAIT
v_mov_b64 v[96:97], v[120:121]
v_mov_b64 v[100:101], v[124:125]
s_branch L_BACK3
L_SLOW4:
s_lshr_b32 s91, s42, 6
s_add_u32 s91, s91, 0
s_call_b64 s[100:101], L_WAIT
v_mov_b64 v[80:81], v[120:121]
v_mov_b64 v[84:85], v[124:125]
s_branch L_BACK4
L_SLOW5:
s_lshr_b32 s91, s42, 6
s_add_u32 s91, s91, 1
s_call_b64 s[100:101], L_WAIT
v_mov_b64 v[88:89], v[120:121]
v_mov_b64 v[92:93], v[124:125]
s_branch L_BACK5
L_SLOW6:
s_lshr_b32 s91, s43, 6
s_add_u32 s91, s91, 0
s_call_b64 s[100:101], L_WAIT
v_mov_b64 v[32:33], v[120:121]
v_mov_b64 v[36:37], v[124:125]
s_branch L_BACK6
L_SLOW7:
s_lshr_b32 s91, s43, 6
s_add_u32 s91, s91, 1
s_call_b64 s[100:101], L_WAIT
v_mov_b64 v[40:41], v[120:121]
v_mov_b64 v[44:45], v[124:125]
s_branch L_BACK7
L_SLOW8:
s_movk_i32 s91, 8
s_call_b64 s[100:101], L_WAIT
v_mov_b64 v[48:49], v[120:121]
v_mov_b64 v[52:53], v[124:125]
s_branch L_BACK8
L_SLOW9:
s_movk_i32 s91, 9
s_call_b64 s[100:101], L_WAIT
v_mov_b64 v[96:97], v[120:121]
v_mov_b64 v[100:101], v[124:125]
s_branch L_BACK9
L_SLOW10:
s_movk_i32 s91, 10
s_call_b64 s[100:101], L_WAIT
v_mov_b64 v[80:81], v[120:121]
v_mov_b64 v[84:85], v[124:125]
s_branch L_BACK10
L_SLOW11:
s_movk_i32 s91, 11
s_call_b64 s[100:101], L_WAIT
v_mov_b64 v[88:89], v[120:121]
v_mov_b64 v[92:93], v[124:125]
s_branch L_BACK11
L_SLOW12:
s_movk_i32 s91, 12
s_call_b64 s[100:101], L_WAIT
v_mov_b64 v[32:33], v[120:121]
v_mov_b64 v[36:37], v[124:125]
s_branch L_BACK12
L_SLOW13:
s_movk_i32 s91, 13
s_call_b64 s[100:101], L_WAIT
v_mov_b64 v[40:41], v[120:121]
v_mov_b64 v[44:45], v[124:125]
s_branch L_BACK13
L_SLOW14:
s_movk_i32 s91, 14
s_call_b64 s[100:101], L_WAIT
v_mov_b64 v[48:49], v[120:121]
v_mov_b64 v[52:53], v[124:125]
s_branch L_BACK14
L_SLOW15:
s_movk_i32 s91, 15
s_call_b64 s[100:101], L_WAIT
v_mov_b64 v[96:97], v[120:121]
v_mov_b64 v[100:101], v[124:125]
s_branch L_BACK15
L_SLOW16:
s_movk_i32 s91, 16
s_call_b64 s[100:101], L_WAIT
v_mov_b64 v[80:81], v[120:121]
v_mov_b64 v[84:85], v[124:125]
s_branch L_BACK16
L_SLOW17:
s_movk_i32 s91, 17
s_call_b64 s[100:101], L_WAIT
v_mov_b64 v[88:89], v[120:121]
v_mov_b64 v[92:93], v[124:125]
s_branch L_BACK17
L_SLOW18:
s_movk_i32 s91, 18
s_call_b64 s[100:101], L_WAIT
v_mov_b64 v[32:33], v[120:121]
v_mov_b64 v[36:37], v[124:125]
s_branch L_BACK18
L_SLOW19:
s_movk_i32 s91, 19
s_call_b64 s[100:101], L_WAIT
v_mov_b64 v[40:41], v[120:121]
v_mov_b64 v[44:45], v[124:125]
s_branch L_BACK19
L_SLOW20:
s_movk_i32 s91, 20
s_call_b64 s[100:101], L_WAIT
v_mov_b64 v[48:49], v[120:121]
v_mov_b64 v[52:53], v[124:125]
s_branch L_BACK20
L_SLOW21:
s_movk_i32 s91, 21
s_call_b64 s[100:101], L_WAIT
v_mov_b64 v[96:97], v[120:121]
v_mov_b64 v[100:101], v[124:125]
s_branch L_BACK21
L_SLOW22:
s_movk_i32 s91, 22
s_call_b64 s[100:101], L_WAIT
v_mov_b64 v[80:81], v[120:121]
v_mov_b64 v[84:85], v[124:125]
s_branch L_BACK22
L_SLOW23:
s_movk_i32 s91, 23
s_call_b64 s[100:101], L_WAIT
v_mov_b64 v[88:89], v[120:121]
v_mov_b64 v[92:93], v[124:125]
s_branch L_BACK23
L_SLOW24:
s_movk_i32 s91, 24
s_call_b64 s[100:101], L_WAIT
v_mov_b64 v[32:33], v[120:121]
v_mov_b64 v[36:37], v[124:125]
s_branch L_BACK24
L_SLOW25:
s_movk_i32 s91, 25
s_call_b64 s[100:101], L_WAIT
v_mov_b64 v[40:41], v[120:121]
v_mov_b64 v[44:45], v[124:125]
s_branch L_BACK25
L_SLOW26:
s_movk_i32 s91, 26
s_call_b64 s[100:101], L_WAIT
v_mov_b64 v[48:49], v[120:121]
v_mov_b64 v[52:53], v[124:125]
s_branch L_BACK26
L_SLOW27:
s_movk_i32 s91, 27
s_call_b64 s[100:101], L_WAIT
v_mov_b64 v[96:97], v[120:121]
v_mov_b64 v[100:101], v[124:125]
s_branch L_BACK27
L_SLOW28:
s_movk_i32 s91, 28
s_call_b64 s[100:101], L_WAIT
v_mov_b64 v[80:81], v[120:121]
v_mov_b64 v[84:85], v[124:125]
s_branch L_BACK28
L_SLOW29:
s_movk_i32 s91, 29
s_call_b64 s[100:101], L_WAIT
v_mov_b64 v[88:89], v[120:121]
v_mov_b64 v[92:93], v[124:125]
s_branch L_BACK29
L_SLOW30:
s_movk_i32 s91, 30
s_call_b64 s[100:101], L_WAIT
v_mov_b64 v[32:33], v[120:121]
v_mov_b64 v[36:37], v[124:125]
s_branch L_BACK30
L_SLOW31:
s_movk_i32 s91, 31
s_call_b64 s[100:101], L_WAIT
v_mov_b64 v[40:41], v[120:121]
v_mov_b64 v[44:45], v[124:125]
s_branch L_BACK31
L_WAIT:
s_lshl_b32 s47, s91, 11
buffer_load_dwordx4 v[120:123], v13, s[24:27], s47 offen offset:0 sc1
buffer_load_dwordx4 v[124:127], v13, s[24:27], s47 offen offset:1024 sc1
s_waitcnt vmcnt(0)
v_cmp_ne_u64 s[50:51], s[88:89], v[122:123]
v_cmp_ne_u64 s[44:45], s[88:89], v[126:127]
s_sub_u32 s90, s90, 1
s_nop 0
s_or_b64 s[50:51], s[44:45], s[50:51]
s_cbranch_scc0 L_WRET
s_cmp_gt_i32 s90, 0
s_cbranch_scc1 L_WAIT
s_mul_i32 s47, s91, 458752
s_lshl_b32 s46, s39, 8
s_add_u32 s47, s47, s46
s_add_u32 s84, s6, s47
s_addc_u32 s85, s7, 0
s_mov_b32 s86, 387328
s_mov_b32 s87, 0x20000
buffer_load_dwordx4 v[64:67], v30, s[84:87], 0 offen
buffer_load_dwordx4 v[68:71], v30, s[84:87], s92 offen
buffer_load_dwordx4 v[72:75], v30, s[84:87], s93 offen
buffer_load_dwordx4 v[76:79], v30, s[84:87], s94 offen
s_waitcnt vmcnt(0)
v_lshl_add_u64 v[64:65], v[68:69], 4, v[64:65]
v_lshl_add_u64 v[66:67], v[70:71], 4, v[66:67]
v_lshl_add_u64 v[72:73], v[76:77], 4, v[72:73]
v_lshl_add_u64 v[74:75], v[78:79], 4, v[74:75]
v_lshl_or_b32 v64, v72, 8, v64
v_lshl_or_b32 v65, v73, 8, v65
v_lshl_or_b32 v66, v74, 8, v66
v_lshl_or_b32 v67, v75, 8, v67
v_lshl_or_b32 v120, v65, 16, v64
v_lshl_or_b32 v121, v67, 16, v66
s_add_u32 s84, s84, 57344
s_addc_u32 s85, s85, 0
buffer_load_dwordx4 v[64:67], v30, s[84:87], 0 offen
buffer_load_dwordx4 v[68:71], v30, s[84:87], s92 offen
buffer_load_dwordx4 v[72:75], v30, s[84:87], s93 offen
buffer_load_dwordx4 v[76:79], v30, s[84:87], s94 offen
s_waitcnt vmcnt(0)
v_lshl_add_u64 v[64:65], v[68:69], 4, v[64:65]
v_lshl_add_u64 v[66:67], v[70:71], 4, v[66:67]
v_lshl_add_u64 v[72:73], v[76:77], 4, v[72:73]
v_lshl_add_u64 v[74:75], v[78:79], 4, v[74:75]
v_lshl_or_b32 v64, v72, 8, v64
v_lshl_or_b32 v65, v73, 8, v65
v_lshl_or_b32 v66, v74, 8, v66
v_lshl_or_b32 v67, v75, 8, v67
v_lshl_or_b32 v124, v65, 16, v64
v_lshl_or_b32 v125, v67, 16, v66
L_WRET:
s_setpc_b64 s[100:101]
L_END:
s_endpgm
.section .rodata,"a"
.p2align 6
.amdhsa_kernel standalone__normalfloat_lut_af4__prompt_kernel
  .amdhsa_next_free_vgpr 512
  .amdhsa_next_free_sgpr 102
  .amdhsa_accum_offset 256
  .amdhsa_group_segment_fixed_size 0
  .amdhsa_kernarg_size 56
  .amdhsa_user_sgpr_count 2
  .amdhsa_user_sgpr_kernarg_segment_ptr 1
  .amdhsa_system_sgpr_workgroup_id_x 1
.end_amdhsa_kernel
```

```asm
; @launch grid=(256,1,1) block=(256,1,1) lds=163840
.amdgcn_target "amdgcn-amd-amdhsa--gfx950"
.text
.globl standalone__normalfloat_lut_af4__prompt_kernel
.p2align 12
.p2align 8
.type standalone__normalfloat_lut_af4__prompt_kernel,@function
standalone__normalfloat_lut_af4__prompt_kernel:
s_load_dwordx4 s[4:7], s[0:1], 0
s_load_dwordx4 s[12:15], s[0:1], 40
s_load_dwordx4 s[8:11], s[0:1], 24
s_memrealtime s[56:57]
s_cmp_ge_u32 s2, 256
s_cbranch_scc1 L_END
s_getpc_b64 s[48:49]
L_PC0:
v_bfi_b32 v2, 7, v0, s2
v_lshlrev_b32 v2, 7, v2
v_min_u32 v2, L_END-L_PC0, v2
global_load_dword v7, v2, s[48:49]
v_lshrrev_b32 v1, 6, v0
s_cmp_lt_u32 s2, 32
v_readfirstlane_b32 s36, v1
s_cbranch_scc1 L_PACK
s_bfe_u32 s34, s2, 0x20001
s_bfe_u32 s37, s2, 0x20003
s_lshl2_add_u32 s37, s34, s37
s_and_b32 s43, s2, 1
s_mul_i32 s43, s43, 7
s_lshr_b32 s38, s2, 5
s_add_u32 s38, s38, s43
s_lshl2_add_u32 s39, s38, s36
s_sub_u32 s39, s39, 4
v_bfe_u32 v6, v0, 4, 2
v_and_b32 v3, 15, v0
v_mul_u32_u24 v2, 114688, v6
v_lshl_add_u32 v30, v3, 4, v2
s_lshr_b32 s46, s37, 1
s_and_b32 s45, s37, 1
s_lshl3_add_u32 s46, s46, s45
s_mul_i32 s46, s46, 57344
s_lshl_b32 s47, s39, 8
s_add_u32 s46, s46, s47
s_mov_b32 s18, 387328
s_mov_b32 s19, 0x20000
s_mov_b32 s92, 14336
s_mov_b32 s93, 28672
s_mov_b32 s94, 43008
s_waitcnt lgkmcnt(0)
s_add_u32 s16, s6, s46
s_addc_u32 s17, s7, 0
buffer_load_dwordx4 v[104:107], v30, s[16:19], 0 offen
buffer_load_dwordx4 v[108:111], v30, s[16:19], s92 offen
buffer_load_dwordx4 v[112:115], v30, s[16:19], s93 offen
buffer_load_dwordx4 v[116:119], v30, s[16:19], s94 offen
s_branch L_MAIN
L_PACK:
v_lshrrev_b32 v2, 2, v0
v_and_b32 v3, 3, v0
s_lshl_b32 s45, s2, 17
v_lshl_add_u32 v2, v2, 11, s45
v_lshl_add_u32 v17, v3, 7, v2
s_mov_b32 s30, 4194304
s_mov_b32 s31, 0x20000
v_lshlrev_b32 v16, 3, v0
s_cmp_lt_u32 s2, 2
s_cselect_b32 s34, 8, 0
s_mov_b32 s35, 0x20000
v_mov_b64 v[22:23], 0
s_waitcnt lgkmcnt(0)
s_mov_b64 s[32:33], s[12:13]
v_mov_b64 v[20:21], s[56:57]
buffer_atomic_cmpswap_x2 v[20:23], v16, s[32:35], 0 offen sc1
s_mov_b64 s[28:29], s[4:5]
buffer_load_dword v19, v17, s[28:31], 0 offen offset:0
s_branch L_PACK1
L_MAIN:
s_mov_b64 s[20:21], s[4:5]
s_mov_b32 s22, 4194304
s_mov_b32 s23, 0x20000
s_lshl_b32 s46, s37, 18
v_lshrrev_b32 v5, 3, v0
v_lshl_add_u32 v2, v5, 11, s46
v_lshrrev_b32 v4, 4, v0
v_xor_b32 v4, v4, v0
v_and_b32 v4, 7, v4
v_lshl_add_u32 v8, v4, 4, v2
v_add_u32 v9, 65536, v8
v_add_u32 v10, 131072, v8
v_add_u32 v11, 196608, v8
s_lshl_b32 s33, s36, 10
s_lshl_b32 s40, s34, 7
s_add_u32 m0, s33, 65536
s_nop 0
buffer_load_dwordx4 v8, s[20:23], s40 offen lds
s_add_u32 m0, s33, 69632
s_nop 0
buffer_load_dwordx4 v9, s[20:23], s40 offen lds
s_add_u32 m0, s33, 73728
s_nop 0
buffer_load_dwordx4 v10, s[20:23], s40 offen lds
s_add_u32 m0, s33, 77824
s_nop 0
buffer_load_dwordx4 v11, s[20:23], s40 offen lds
v_mov_b32 v2, 0x3da3bf80
s_lshl_b64 exec, exec, 8
v_mov_b32 v2, 0x3e25bf32
s_lshl_b64 exec, exec, 8
v_mov_b32 v2, 0x3e7cbf06
s_lshl_b64 exec, exec, 8
v_mov_b32 v2, 0x3eadbeca
s_lshl_b64 exec, exec, 8
v_mov_b32 v2, 0x3ee2be92
s_lshl_b64 exec, exec, 8
v_mov_b32 v2, 0x3f10be3d
s_lshl_b64 exec, exec, 8
v_mov_b32 v2, 0x3f39bdba
s_lshl_b64 exec, exec, 8
v_mov_b32 v2, 0x3f800000
s_mov_b64 exec, -1
s_and_b32 s45, s36, 1
s_mul_i32 s45, s45, 0x0202
s_lshr_b32 s46, s36, 1
s_mul_i32 s46, s46, 0x02020000
s_add_u32 s45, s45, s46
s_add_u32 s45, s45, 0x05040100
v_mov_b32 v4, s45
v_lshlrev_b32 v5, 8, v5
v_and_b32 v31, 7, v0
v_lshl_add_u32 v31, v31, 4, v5
s_mov_b32 s45, 0xbf32bf80
v_perm_b32 v128, s45, v2, v4
v_mov_b32 v129, v128
v_mov_b64 v[130:131], v[128:129]
ds_write_b128 v31, v[128:131] offset:0
s_mov_b32 s45, 0xbecabf06
v_perm_b32 v132, s45, v2, v4
v_mov_b32 v133, v132
v_mov_b64 v[134:135], v[132:133]
v_and_b32 v5, 31, v0
v_lshlrev_b32 v19, 2, v5
v_and_b32 v0, 63, v0
s_lshl_b32 s46, s39, 7
ds_write_b128 v31, v[132:135] offset:8192
s_mov_b32 s45, 0xbe3dbe92
v_perm_b32 v136, s45, v2, v4
v_mov_b32 v137, v136
v_mov_b64 v[138:139], v[136:137]
v_lshl_add_u32 v28, v3, 3, s46
s_mul_i32 s47, s37, 917504
s_add_u32 s47, s47, s46
s_add_u32 s28, s10, s47
s_addc_u32 s29, s11, 0
ds_write_b128 v31, v[136:139] offset:16384
s_mov_b32 s45, 0xbdba
v_perm_b32 v140, s45, v2, v4
v_mov_b32 v141, v140
v_mov_b64 v[142:143], v[140:141]
s_mov_b32 s30, 86144
s_mov_b32 s31, 0x20000
v_mul_u32_u24 v29, 28672, v6
v_lshl_add_u32 v18, v3, 3, v29
ds_write_b128 v31, v[140:143] offset:24576
s_mov_b32 s45, 0x3e253da3
v_perm_b32 v144, s45, v2, v4
v_mov_b32 v145, v144
v_mov_b64 v[146:147], v[144:145]
v_lshlrev_b32 v29, 7, v3
v_bfe_u32 v5, v0, 1, 3
v_xor_b32 v5, v5, v6
v_lshl_add_u32 v29, v5, 4, v29
s_load_dwordx2 s[88:89], s[12:13], 0
ds_write_b128 v31, v[144:147] offset:32768
s_mov_b32 s45, 0x3ead3e7c
v_perm_b32 v148, s45, v2, v4
v_mov_b32 v149, v148
v_mov_b64 v[150:151], v[148:149]
v_add_u32 v14, 65536, v29
v_xor_b32 v15, 64, v14
v_add_u32 v16, 0x10000, v14
v_add_u32 v17, 0x10000, v15
ds_write_b128 v31, v[148:151] offset:40960
s_mov_b32 s45, 0x3f103ee2
v_perm_b32 v152, s45, v2, v4
v_mov_b32 v153, v152
v_mov_b64 v[154:155], v[152:153]
s_mov_b32 s52, 0x0c0c0400
s_mov_b32 s53, 0x0c0c0500
s_mov_b32 s54, 0x0c0c0600
s_mov_b32 s55, 0x0c0c0700
ds_write_b128 v31, v[152:155] offset:49152
s_mov_b32 s45, 0x3f803f39
v_perm_b32 v156, s45, v2, v4
v_mov_b32 v157, v156
v_mov_b64 v[158:159], v[156:157]
v_lshlrev_b32 v13, 4, v0
v_lshl_add_u32 v12, s40, 5, v13
s_lshl_b32 s47, s39, 16
s_add_u32 s24, s14, s47
s_addc_u32 s25, s15, 0
ds_write_b128 v31, v[156:159] offset:57344
s_lshl_b32 s47, s37, 10
s_add_u32 s76, s24, s47
s_addc_u32 s77, s25, 0
s_movk_i32 s78, 1024
s_mov_b32 s79, 0x20000
s_lshl_b32 s47, s34, 3
s_lshr_b32 s47, 0x90d0b2d, s47
s_bfe_u32 s41, s47, 0x20000
s_lshl_b32 s41, s41, 7
s_bfe_u32 s42, s47, 0x20002
s_lshl_b32 s42, s42, 7
s_bfe_u32 s43, s47, 0x20004
s_lshl_b32 s43, s43, 7
s_lshl_b32 s47, s34, 1
s_lshr_b32 s47, 0x63, s47
s_and_b32 s47, s47, 3
s_sub_u32 s47, s47, s34
s_lshl1_add_u32 s3, s47, 12
s_mul_i32 s47, s3, 458752
s_add_u32 s16, s16, s47
s_addc_u32 s17, s17, 0
s_lshl_b32 s3, s3, 11
s_mov_b32 s26, 65536
s_mov_b32 s27, 0x20000
s_mov_b64 s[80:81], s[12:13]
s_movk_i32 s82, 128
s_mov_b32 s83, 0x20000
s_movk_i32 s90, 4096
s_add_u32 m0, s33, 81920
s_nop 0
buffer_load_dwordx4 v8, s[20:23], s41 offen lds
s_add_u32 m0, s33, 86016
s_nop 0
buffer_load_dwordx4 v9, s[20:23], s41 offen lds
s_add_u32 m0, s33, 90112
s_nop 0
buffer_load_dwordx4 v10, s[20:23], s41 offen lds
s_add_u32 m0, s33, 94208
s_nop 0
buffer_load_dwordx4 v11, s[20:23], s41 offen lds
s_waitcnt vmcnt(8)
v_lshl_add_u64 v[104:105], v[108:109], 4, v[104:105]
v_lshl_add_u64 v[106:107], v[110:111], 4, v[106:107]
v_lshl_add_u64 v[112:113], v[116:117], 4, v[112:113]
v_lshl_add_u64 v[114:115], v[118:119], 4, v[114:115]
v_lshl_or_b32 v104, v112, 8, v104
v_lshl_or_b32 v105, v113, 8, v105
v_lshl_or_b32 v106, v114, 8, v106
v_lshl_or_b32 v107, v115, 8, v107
v_lshl_or_b32 v108, v105, 16, v104
v_lshl_or_b32 v109, v107, 16, v106
s_waitcnt lgkmcnt(0)
s_cmp_eq_u64 s[88:89], 0
s_cbranch_scc1 L_NOTAG
L_TAGOK:
v_mov_b64 v[110:111], s[88:89]
buffer_store_dwordx4 v[108:111], v13, s[76:79], 0 offen sc1
s_add_u32 s76, s76, s3
s_addc_u32 s77, s77, 0
s_waitcnt lgkmcnt(0)
s_barrier
s_mov_b64 vcc, -1
s_cmp_eq_u32 s36, 0
s_cbranch_scc1 L_PAD0
s_cmp_eq_u32 s36, 1
s_cbranch_scc1 L_PAD2
s_cmp_eq_u32 s36, 2
s_cbranch_scc1 L_PAD4
L_PADRET:
s_mov_b64 vcc, 0
s_branch L_STREAM
L_PACK1:
v_and_b32 v0, 63, v0
v_lshrrev_b32 v2, 4, v0
v_and_b32 v3, 15, v0
v_mul_u32_u24 v2, 114688, v2
v_lshl_add_u32 v8, v3, 4, v2
s_movk_i32 s47, 0x3800
v_add_u32 v9, s47, v8
v_add_u32 v10, s47, v9
v_add_u32 v11, s47, v10
v_add_u32 v12, s47, v11
v_add_u32 v13, s47, v12
v_add_u32 v14, s47, v13
v_add_u32 v15, s47, v14
s_sub_u32 s3, s2, 1
s_and_b32 s3, s3, 7
s_lshr_b32 s45, s2, 3
s_lshl2_add_u32 s3, s3, s45
s_mul_i32 s40, s3, 4682
s_lshr_b32 s40, s40, 16
s_mul_i32 s41, s40, 14
s_sub_u32 s41, s3, s41
s_add_u32 s40, s40, 8
s_mov_b32 s22, 14680064
s_mov_b32 s23, 0x20000
s_mov_b64 s[20:21], s[6:7]
s_cmp_ge_u32 s40, 12
s_cselect_b32 s45, 8, 0
s_add_u32 s45, s45, s40
s_lshl2_add_u32 s42, s41, s36
s_mul_i32 s43, s45, 458752
s_lshl_b32 s44, s42, 8
s_add_u32 s43, s43, s44
s_lshl_b32 s44, s42, 5
s_add_u32 s44, s44, s45
s_lshl_b32 s52, s44, 11
s_cmp_lt_u32 s45, 32
s_cselect_b32 s52, s52, 0x1000000
s_cselect_b32 s22, 14680064, 0
s_add_u32 s41, s41, 4
s_add_u32 s40, s40, 2
s_cmp_ge_u32 s41, 14
s_cselect_b32 s48, 14, 0
s_addc_u32 s40, s40, 0
s_sub_u32 s41, s41, s48
s_load_dwordx2 s[50:51], s[12:13], 0
buffer_load_dwordx4 v[32:35], v8, s[20:23], s43 offen
buffer_load_dwordx4 v[36:39], v9, s[20:23], s43 offen
buffer_load_dwordx4 v[40:43], v10, s[20:23], s43 offen
buffer_load_dwordx4 v[44:47], v11, s[20:23], s43 offen
buffer_load_dwordx4 v[48:51], v12, s[20:23], s43 offen
buffer_load_dwordx4 v[52:55], v13, s[20:23], s43 offen
buffer_load_dwordx4 v[56:59], v14, s[20:23], s43 offen
buffer_load_dwordx4 v[60:63], v15, s[20:23], s43 offen
s_mov_b64 s[24:25], s[14:15]
s_mov_b32 s26, 3670016
s_mov_b32 s27, 0x20000
s_movk_i32 s34, 128
v_mov_b32 v16, 0
v_lshlrev_b32 v18, 4, v0
s_movk_i32 s46, 4096
s_waitcnt vmcnt(4) lgkmcnt(0)
v_mov_b64 v[22:23], s[50:51]
s_nop 0
L_PKN:
v_cmp_ne_u64 vcc, 0, v[22:23]
s_sub_u32 s46, s46, 1
s_cmp_gt_i32 s46, 0
s_cbranch_vccnz L_PKGO
s_cbranch_scc0 L_END
buffer_load_dwordx2 v[22:23], v16, s[32:35], 0 offen sc1
s_waitcnt vmcnt(0)
s_branch L_PKN
L_PKGO:
s_call_b64 s[100:101], L_PK0
buffer_store_dwordx4 v[20:23], v18, s[24:27], s52 offen offset:0 sc1
s_waitcnt lgkmcnt(0)
s_call_b64 s[100:101], L_UNIT
s_mov_b32 s53, s49
buffer_load_dwordx4 v[64:67], v8, s[20:23], s43 offen
buffer_load_dwordx4 v[68:71], v9, s[20:23], s43 offen
buffer_load_dwordx4 v[72:75], v10, s[20:23], s43 offen
buffer_load_dwordx4 v[76:79], v11, s[20:23], s43 offen
s_waitcnt vmcnt(5)
s_call_b64 s[100:101], L_PK1
buffer_store_dwordx4 v[20:23], v18, s[24:27], s52 offen offset:1024 sc1
buffer_load_dwordx4 v[80:83], v12, s[20:23], s43 offen
buffer_load_dwordx4 v[84:87], v13, s[20:23], s43 offen
buffer_load_dwordx4 v[88:91], v14, s[20:23], s43 offen
buffer_load_dwordx4 v[92:95], v15, s[20:23], s43 offen
s_waitcnt vmcnt(5)
s_call_b64 s[100:101], L_PK2
buffer_store_dwordx4 v[20:23], v18, s[24:27], s53 offen offset:0 sc1
s_call_b64 s[100:101], L_UNIT
s_mov_b32 s54, s49
buffer_load_dwordx4 v[32:35], v8, s[20:23], s43 offen
buffer_load_dwordx4 v[36:39], v9, s[20:23], s43 offen
buffer_load_dwordx4 v[40:43], v10, s[20:23], s43 offen
buffer_load_dwordx4 v[44:47], v11, s[20:23], s43 offen
s_waitcnt vmcnt(5)
s_call_b64 s[100:101], L_PK3
buffer_store_dwordx4 v[20:23], v18, s[24:27], s53 offen offset:1024 sc1
buffer_load_dwordx4 v[48:51], v12, s[20:23], s43 offen
buffer_load_dwordx4 v[52:55], v13, s[20:23], s43 offen
buffer_load_dwordx4 v[56:59], v14, s[20:23], s43 offen
buffer_load_dwordx4 v[60:63], v15, s[20:23], s43 offen
s_waitcnt vmcnt(5)
s_call_b64 s[100:101], L_PK0
buffer_store_dwordx4 v[20:23], v18, s[24:27], s54 offen offset:0 sc1
s_call_b64 s[100:101], L_UNIT
s_mov_b32 s55, s49
buffer_load_dwordx4 v[64:67], v8, s[20:23], s43 offen
buffer_load_dwordx4 v[68:71], v9, s[20:23], s43 offen
buffer_load_dwordx4 v[72:75], v10, s[20:23], s43 offen
buffer_load_dwordx4 v[76:79], v11, s[20:23], s43 offen
s_waitcnt vmcnt(5)
s_call_b64 s[100:101], L_PK1
buffer_store_dwordx4 v[20:23], v18, s[24:27], s54 offen offset:1024 sc1
buffer_load_dwordx4 v[80:83], v12, s[20:23], s43 offen
buffer_load_dwordx4 v[84:87], v13, s[20:23], s43 offen
buffer_load_dwordx4 v[88:91], v14, s[20:23], s43 offen
buffer_load_dwordx4 v[92:95], v15, s[20:23], s43 offen
s_waitcnt vmcnt(5)
s_call_b64 s[100:101], L_PK2
buffer_store_dwordx4 v[20:23], v18, s[24:27], s55 offen offset:0 sc1
s_call_b64 s[100:101], L_UNIT
s_mov_b32 s52, s49
buffer_load_dwordx4 v[32:35], v8, s[20:23], s43 offen
buffer_load_dwordx4 v[36:39], v9, s[20:23], s43 offen
buffer_load_dwordx4 v[40:43], v10, s[20:23], s43 offen
buffer_load_dwordx4 v[44:47], v11, s[20:23], s43 offen
s_waitcnt vmcnt(5)
s_call_b64 s[100:101], L_PK3
buffer_store_dwordx4 v[20:23], v18, s[24:27], s55 offen offset:1024 sc1
buffer_load_dwordx4 v[48:51], v12, s[20:23], s43 offen
buffer_load_dwordx4 v[52:55], v13, s[20:23], s43 offen
buffer_load_dwordx4 v[56:59], v14, s[20:23], s43 offen
buffer_load_dwordx4 v[60:63], v15, s[20:23], s43 offen
s_waitcnt vmcnt(5)
s_call_b64 s[100:101], L_PK0
buffer_store_dwordx4 v[20:23], v18, s[24:27], s52 offen offset:0 sc1
s_call_b64 s[100:101], L_UNIT
s_mov_b32 s53, s49
buffer_load_dwordx4 v[64:67], v8, s[20:23], s43 offen
buffer_load_dwordx4 v[68:71], v9, s[20:23], s43 offen
buffer_load_dwordx4 v[72:75], v10, s[20:23], s43 offen
buffer_load_dwordx4 v[76:79], v11, s[20:23], s43 offen
s_waitcnt vmcnt(5)
s_call_b64 s[100:101], L_PK1
buffer_store_dwordx4 v[20:23], v18, s[24:27], s52 offen offset:1024 sc1
buffer_load_dwordx4 v[80:83], v12, s[20:23], s43 offen
buffer_load_dwordx4 v[84:87], v13, s[20:23], s43 offen
buffer_load_dwordx4 v[88:91], v14, s[20:23], s43 offen
buffer_load_dwordx4 v[92:95], v15, s[20:23], s43 offen
s_waitcnt vmcnt(5)
s_call_b64 s[100:101], L_PK2
buffer_store_dwordx4 v[20:23], v18, s[24:27], s53 offen offset:0 sc1
s_call_b64 s[100:101], L_UNIT
s_mov_b32 s54, s49
buffer_load_dwordx4 v[32:35], v8, s[20:23], s43 offen
buffer_load_dwordx4 v[36:39], v9, s[20:23], s43 offen
buffer_load_dwordx4 v[40:43], v10, s[20:23], s43 offen
buffer_load_dwordx4 v[44:47], v11, s[20:23], s43 offen
s_waitcnt vmcnt(5)
s_call_b64 s[100:101], L_PK3
buffer_store_dwordx4 v[20:23], v18, s[24:27], s53 offen offset:1024 sc1
buffer_load_dwordx4 v[48:51], v12, s[20:23], s43 offen
buffer_load_dwordx4 v[52:55], v13, s[20:23], s43 offen
buffer_load_dwordx4 v[56:59], v14, s[20:23], s43 offen
buffer_load_dwordx4 v[60:63], v15, s[20:23], s43 offen
s_waitcnt vmcnt(5)
s_call_b64 s[100:101], L_PK0
buffer_store_dwordx4 v[20:23], v18, s[24:27], s54 offen offset:0 sc1
s_waitcnt vmcnt(1)
s_call_b64 s[100:101], L_PK1
buffer_store_dwordx4 v[20:23], v18, s[24:27], s54 offen offset:1024 sc1
s_endpgm
L_UNIT:
s_cmp_ge_u32 s40, 12
s_cselect_b32 s45, 8, 0
s_add_u32 s45, s45, s40
s_lshl2_add_u32 s42, s41, s36
s_mul_i32 s43, s45, 458752
s_lshl_b32 s44, s42, 8
s_add_u32 s43, s43, s44
s_lshl_b32 s44, s42, 5
s_add_u32 s44, s44, s45
s_lshl_b32 s49, s44, 11
s_cmp_lt_u32 s45, 32
s_cselect_b32 s49, s49, 0x1000000
s_cselect_b32 s22, 14680064, 0
s_add_u32 s41, s41, 4
s_add_u32 s40, s40, 2
s_cmp_ge_u32 s41, 14
s_cselect_b32 s48, 14, 0
s_addc_u32 s40, s40, 0
s_sub_u32 s41, s41, s48
s_setpc_b64 s[100:101]
L_PK0:
v_lshl_add_u64 v[32:33], v[36:37], 4, v[32:33]
v_lshl_add_u64 v[34:35], v[38:39], 4, v[34:35]
v_lshl_add_u64 v[40:41], v[44:45], 4, v[40:41]
v_lshl_add_u64 v[42:43], v[46:47], 4, v[42:43]
v_lshl_or_b32 v32, v40, 8, v32
v_lshl_or_b32 v33, v41, 8, v33
v_lshl_or_b32 v34, v42, 8, v34
v_lshl_or_b32 v35, v43, 8, v35
v_lshl_or_b32 v20, v33, 16, v32
v_lshl_or_b32 v21, v35, 16, v34
s_setpc_b64 s[100:101]
L_PK1:
v_lshl_add_u64 v[48:49], v[52:53], 4, v[48:49]
v_lshl_add_u64 v[50:51], v[54:55], 4, v[50:51]
v_lshl_add_u64 v[56:57], v[60:61], 4, v[56:57]
v_lshl_add_u64 v[58:59], v[62:63], 4, v[58:59]
v_lshl_or_b32 v48, v56, 8, v48
v_lshl_or_b32 v49, v57, 8, v49
v_lshl_or_b32 v50, v58, 8, v50
v_lshl_or_b32 v51, v59, 8, v51
v_lshl_or_b32 v20, v49, 16, v48
v_lshl_or_b32 v21, v51, 16, v50
s_setpc_b64 s[100:101]
L_PK2:
v_lshl_add_u64 v[64:65], v[68:69], 4, v[64:65]
v_lshl_add_u64 v[66:67], v[70:71], 4, v[66:67]
v_lshl_add_u64 v[72:73], v[76:77], 4, v[72:73]
v_lshl_add_u64 v[74:75], v[78:79], 4, v[74:75]
v_lshl_or_b32 v64, v72, 8, v64
v_lshl_or_b32 v65, v73, 8, v65
v_lshl_or_b32 v66, v74, 8, v66
v_lshl_or_b32 v67, v75, 8, v67
v_lshl_or_b32 v20, v65, 16, v64
v_lshl_or_b32 v21, v67, 16, v66
s_setpc_b64 s[100:101]
L_PK3:
v_lshl_add_u64 v[80:81], v[84:85], 4, v[80:81]
v_lshl_add_u64 v[82:83], v[86:87], 4, v[82:83]
v_lshl_add_u64 v[88:89], v[92:93], 4, v[88:89]
v_lshl_add_u64 v[90:91], v[94:95], 4, v[90:91]
v_lshl_or_b32 v80, v88, 8, v80
v_lshl_or_b32 v81, v89, 8, v81
v_lshl_or_b32 v82, v90, 8, v82
v_lshl_or_b32 v83, v91, 8, v83
v_lshl_or_b32 v20, v81, 16, v80
v_lshl_or_b32 v21, v83, 16, v82
s_setpc_b64 s[100:101]
.p2align 12
L_STREAM:
L_PAD0:
s_cbranch_vccnz L_PAD1
s_waitcnt vmcnt(0)
buffer_load_dwordx4 v[32:35], v12, s[24:27], 0 offen offset:0 sc1
buffer_load_dwordx4 v[36:39], v12, s[24:27], 0 offen offset:1024 sc1
buffer_load_dwordx4 v[40:43], v12, s[24:27], 0 offen offset:2048 sc1
buffer_load_dwordx4 v[44:47], v12, s[24:27], 0 offen offset:3072 sc1
v_lshl_add_u32 v12, s41, 5, v13
s_barrier
ds_read_b128 a[224:227], v14 offset:0
ds_read_b128 a[228:231], v14 offset:2048
s_waitcnt vmcnt(2)
v_cmp_ne_u64 s[50:51], s[88:89], v[34:35]
v_cmp_ne_u64 s[44:45], s[88:89], v[38:39]
s_or_b64 s[50:51], s[44:45], s[50:51]
s_cbranch_scc1 L_SLOW0
L_BACK0:
v_perm_b32 v64, v32, v19, s52
v_perm_b32 v65, v32, v19, s53
v_perm_b32 v66, v36, v19, s52
v_perm_b32 v67, v36, v19, s53
v_perm_b32 v68, v32, v19, s54
v_perm_b32 v69, v32, v19, s55
v_perm_b32 v70, v36, v19, s54
v_perm_b32 v71, v36, v19, s55
ds_read_b32 a0, v64
ds_read_b32 a1, v65
ds_read_b32 a2, v66
ds_read_b32 a3, v67
ds_read_b32 a4, v68
ds_read_b32 a5, v69
ds_read_b32 a6, v70
ds_read_b32 a7, v71
v_perm_b32 v72, v33, v19, s52
v_perm_b32 v73, v33, v19, s53
v_perm_b32 v74, v37, v19, s52
v_perm_b32 v75, v37, v19, s53
v_perm_b32 v76, v33, v19, s54
v_perm_b32 v77, v33, v19, s55
v_perm_b32 v78, v37, v19, s54
v_perm_b32 v79, v37, v19, s55
ds_read_b32 a8, v72
ds_read_b32 a9, v73
ds_read_b32 a10, v74
ds_read_b32 a11, v75
ds_read_b32 a12, v76
ds_read_b32 a13, v77
ds_read_b32 a14, v78
ds_read_b32 a15, v79
buffer_load_dwordx4 v[48:51], v12, s[24:27], 0 offen offset:0 sc1
s_waitcnt vmcnt(1) lgkmcnt(12)
v_cmp_ne_u64 s[50:51], s[88:89], v[42:43]
v_cmp_ne_u64 s[44:45], s[88:89], v[46:47]
v_mfma_f32_16x16x32_bf16 v[128:131], a[224:227], a[0:3], 0
s_waitcnt lgkmcnt(8)
ds_read_b128 a[232:235], v14 offset:4096
buffer_load_dwordx4 v[52:55], v12, s[24:27], 0 offen offset:1024 sc1
v_mfma_f32_16x16x32_bf16 v[132:135], a[224:227], a[4:7], 0
s_waitcnt lgkmcnt(5)
s_or_b64 s[50:51], s[44:45], s[50:51]
v_mfma_f32_16x16x32_bf16 v[136:139], a[224:227], a[8:11], 0
s_waitcnt lgkmcnt(1)
s_cbranch_scc1 L_SLOW1
L_BACK1:
v_mfma_f32_16x16x32_bf16 v[140:143], a[224:227], a[12:15], 0
buffer_load_dwordx4 v[96:99], v12, s[24:27], 0 offen offset:2048 sc1
v_mfma_f32_16x16x32_bf16 v[144:147], a[228:231], a[0:3], 0
ds_read_b128 a[236:239], v14 offset:6144
buffer_load_dwordx4 v[100:103], v12, s[24:27], 0 offen offset:3072 sc1
v_mfma_f32_16x16x32_bf16 v[148:151], a[228:231], a[4:7], 0
v_perm_b32 v63, v40, v19, s52
v_lshl_add_u32 v12, s42, 5, v13
v_mfma_f32_16x16x32_bf16 v[152:155], a[228:231], a[8:11], 0
s_add_u32 m0, s33, 98304
ds_read_b32 a16, v63
v_perm_b32 v62, v40, v19, s53
v_mfma_f32_16x16x32_bf16 v[156:159], a[228:231], a[12:15], 0
s_waitcnt lgkmcnt(2)
ds_read_b32 a17, v62
v_perm_b32 v61, v44, v19, s52
v_mfma_f32_16x16x32_bf16 v[160:163], a[232:235], a[0:3], 0
ds_read_b128 a[240:243], v14 offset:8192
buffer_load_dwordx4 v8, s[20:23], s42 offen lds
v_mfma_f32_16x16x32_bf16 v[164:167], a[232:235], a[4:7], 0
ds_read_b32 a18, v61
v_perm_b32 v60, v44, v19, s53
v_mfma_f32_16x16x32_bf16 v[168:171], a[232:235], a[8:11], 0
s_add_u32 m0, s33, 102400
ds_read_b32 a19, v60
v_perm_b32 v59, v40, v19, s54
v_mfma_f32_16x16x32_bf16 v[172:175], a[232:235], a[12:15], 0
s_waitcnt lgkmcnt(4)
ds_read_b32 a20, v59
v_perm_b32 v58, v40, v19, s55
v_mfma_f32_16x16x32_bf16 v[176:179], a[236:239], a[0:3], 0
ds_read_b128 a[244:247], v14 offset:10240
buffer_load_dwordx4 v9, s[20:23], s42 offen lds
v_mfma_f32_16x16x32_bf16 v[180:183], a[236:239], a[4:7], 0
ds_read_b32 a21, v58
v_perm_b32 v57, v44, v19, s54
v_mfma_f32_16x16x32_bf16 v[184:187], a[236:239], a[8:11], 0
s_add_u32 m0, s33, 106496
ds_read_b32 a22, v57
v_perm_b32 v56, v44, v19, s55
v_mfma_f32_16x16x32_bf16 v[188:191], a[236:239], a[12:15], 0
s_waitcnt lgkmcnt(4)
ds_read_b32 a23, v56
v_perm_b32 v63, v41, v19, s52
v_mfma_f32_16x16x32_bf16 v[192:195], a[240:243], a[0:3], 0
ds_read_b128 a[248:251], v14 offset:12288
buffer_load_dwordx4 v10, s[20:23], s42 offen lds
v_mfma_f32_16x16x32_bf16 v[196:199], a[240:243], a[4:7], 0
ds_read_b32 a24, v63
v_perm_b32 v62, v41, v19, s53
v_mfma_f32_16x16x32_bf16 v[200:203], a[240:243], a[8:11], 0
s_add_u32 m0, s33, 110592
ds_read_b32 a25, v62
v_perm_b32 v61, v45, v19, s52
v_mfma_f32_16x16x32_bf16 v[204:207], a[240:243], a[12:15], 0
s_waitcnt lgkmcnt(4)
ds_read_b32 a26, v61
v_perm_b32 v60, v45, v19, s53
v_mfma_f32_16x16x32_bf16 v[208:211], a[244:247], a[0:3], 0
ds_read_b128 a[252:255], v14 offset:14336
buffer_load_dwordx4 v11, s[20:23], s42 offen lds
v_mfma_f32_16x16x32_bf16 v[212:215], a[244:247], a[4:7], 0
ds_read_b32 a27, v60
v_perm_b32 v59, v41, v19, s54
v_mfma_f32_16x16x32_bf16 v[216:219], a[244:247], a[8:11], 0
ds_read_b32 a28, v59
v_perm_b32 v58, v41, v19, s55
v_mfma_f32_16x16x32_bf16 v[220:223], a[244:247], a[12:15], 0
s_waitcnt lgkmcnt(4)
ds_read_b32 a29, v58
v_mfma_f32_16x16x32_bf16 v[224:227], a[248:251], a[0:3], 0
ds_read_b128 a[224:227], v15 offset:0
v_perm_b32 v57, v45, v19, s54
v_mfma_f32_16x16x32_bf16 v[228:231], a[248:251], a[4:7], 0
ds_read_b32 a30, v57
v_perm_b32 v56, v45, v19, s55
v_mfma_f32_16x16x32_bf16 v[232:235], a[248:251], a[8:11], 0
ds_read_b32 a31, v56
buffer_load_dwordx4 v[80:83], v12, s[24:27], 0 offen offset:0 sc1
v_mfma_f32_16x16x32_bf16 v[236:239], a[248:251], a[12:15], 0
s_waitcnt lgkmcnt(4)
buffer_load_dwordx4 v[84:87], v12, s[24:27], 0 offen offset:1024 sc1
v_mfma_f32_16x16x32_bf16 v[240:243], a[252:255], a[0:3], 0
ds_read_b128 a[228:231], v15 offset:2048
v_mfma_f32_16x16x32_bf16 v[244:247], a[252:255], a[4:7], 0
v_mfma_f32_16x16x32_bf16 v[248:251], a[252:255], a[8:11], 0
s_waitcnt vmcnt(8)
v_cmp_ne_u64 s[50:51], s[88:89], v[50:51]
v_cmp_ne_u64 s[44:45], s[88:89], v[54:55]
v_mfma_f32_16x16x32_bf16 v[252:255], a[252:255], a[12:15], 0
s_waitcnt lgkmcnt(1)
global_load_dwordx2 v[20:21], v28, s[8:9]
v_mfma_f32_16x16x32_bf16 v[128:131], a[224:227], a[16:19], v[128:131]
s_or_b64 s[50:51], s[44:45], s[50:51]
ds_read_b128 a[232:235], v15 offset:4096
v_mfma_f32_16x16x32_bf16 v[132:135], a[224:227], a[20:23], v[132:135]
s_cbranch_scc1 L_SLOW2
L_BACK2:
v_mfma_f32_16x16x32_bf16 v[136:139], a[224:227], a[24:27], v[136:139]
v_perm_b32 v63, v48, v19, s52
v_mfma_f32_16x16x32_bf16 v[140:143], a[224:227], a[28:31], v[140:143]
s_waitcnt lgkmcnt(1)
ds_read_b32 a32, v63
v_mfma_f32_16x16x32_bf16 v[144:147], a[228:231], a[16:19], v[144:147]
ds_read_b128 a[236:239], v15 offset:6144
v_perm_b32 v62, v48, v19, s53
v_mfma_f32_16x16x32_bf16 v[148:151], a[228:231], a[20:23], v[148:151]
ds_read_b32 a33, v62
v_perm_b32 v61, v52, v19, s52
v_mfma_f32_16x16x32_bf16 v[152:155], a[228:231], a[24:27], v[152:155]
ds_read_b32 a34, v61
v_perm_b32 v60, v52, v19, s53
v_mfma_f32_16x16x32_bf16 v[156:159], a[228:231], a[28:31], v[156:159]
s_waitcnt lgkmcnt(4)
ds_read_b32 a35, v60
v_mfma_f32_16x16x32_bf16 v[160:163], a[232:235], a[16:19], v[160:163]
ds_read_b128 a[240:243], v15 offset:8192
v_perm_b32 v59, v48, v19, s54
v_mfma_f32_16x16x32_bf16 v[164:167], a[232:235], a[20:23], v[164:167]
ds_read_b32 a36, v59
v_perm_b32 v58, v48, v19, s55
v_mfma_f32_16x16x32_bf16 v[168:171], a[232:235], a[24:27], v[168:171]
ds_read_b32 a37, v58
v_perm_b32 v57, v52, v19, s54
v_mfma_f32_16x16x32_bf16 v[172:175], a[232:235], a[28:31], v[172:175]
s_waitcnt lgkmcnt(4)
ds_read_b32 a38, v57
buffer_load_dwordx4 v[88:91], v12, s[24:27], 0 offen offset:2048 sc1
v_mfma_f32_16x16x32_bf16 v[176:179], a[236:239], a[16:19], v[176:179]
ds_read_b128 a[244:247], v15 offset:10240
v_perm_b32 v56, v52, v19, s55
v_mfma_f32_16x16x32_bf16 v[180:183], a[236:239], a[20:23], v[180:183]
buffer_load_dwordx4 v[104:107], v30, s[16:19], 0 offen
v_mfma_f32_16x16x32_bf16 v[184:187], a[236:239], a[24:27], v[184:187]
ds_read_b32 a39, v56
v_perm_b32 v63, v49, v19, s52
v_mfma_f32_16x16x32_bf16 v[188:191], a[236:239], a[28:31], v[188:191]
s_waitcnt lgkmcnt(3)
ds_read_b32 a40, v63
buffer_load_dwordx4 v[92:95], v12, s[24:27], 0 offen offset:3072 sc1
v_mfma_f32_16x16x32_bf16 v[192:195], a[240:243], a[16:19], v[192:195]
ds_read_b128 a[248:251], v15 offset:12288
v_perm_b32 v62, v49, v19, s53
v_mfma_f32_16x16x32_bf16 v[196:199], a[240:243], a[20:23], v[196:199]
ds_read_b32 a41, v62
v_perm_b32 v61, v53, v19, s52
v_mfma_f32_16x16x32_bf16 v[200:203], a[240:243], a[24:27], v[200:203]
s_add_u32 m0, s33, 114688
ds_read_b32 a42, v61
v_perm_b32 v60, v53, v19, s53
v_mfma_f32_16x16x32_bf16 v[204:207], a[240:243], a[28:31], v[204:207]
s_waitcnt lgkmcnt(4)
ds_read_b32 a43, v60
v_perm_b32 v59, v49, v19, s54
v_mfma_f32_16x16x32_bf16 v[208:211], a[244:247], a[16:19], v[208:211]
ds_read_b128 a[252:255], v15 offset:14336
buffer_load_dwordx4 v8, s[20:23], s43 offen lds
v_mfma_f32_16x16x32_bf16 v[212:215], a[244:247], a[20:23], v[212:215]
buffer_load_dwordx4 v[108:111], v30, s[16:19], s92 offen
v_mfma_f32_16x16x32_bf16 v[216:219], a[244:247], a[24:27], v[216:219]
ds_read_b32 a44, v59
v_perm_b32 v58, v49, v19, s55
v_mfma_f32_16x16x32_bf16 v[220:223], a[244:247], a[28:31], v[220:223]
s_waitcnt lgkmcnt(3)
ds_read_b32 a45, v58
v_lshl_add_u32 v12, s43, 5, v13
v_mfma_f32_16x16x32_bf16 v[224:227], a[248:251], a[16:19], v[224:227]
s_barrier
ds_read_b128 a[224:227], v14 offset:16384
v_perm_b32 v57, v53, v19, s54
v_mfma_f32_16x16x32_bf16 v[228:231], a[248:251], a[20:23], v[228:231]
ds_read_b32 a46, v57
v_perm_b32 v56, v53, v19, s55
v_mfma_f32_16x16x32_bf16 v[232:235], a[248:251], a[24:27], v[232:235]
ds_read_b32 a47, v56
v_mfma_f32_16x16x32_bf16 v[236:239], a[248:251], a[28:31], v[236:239]
s_waitcnt lgkmcnt(4)
v_mfma_f32_16x16x32_bf16 v[240:243], a[252:255], a[16:19], v[240:243]
ds_read_b128 a[228:231], v14 offset:18432
v_mfma_f32_16x16x32_bf16 v[244:247], a[252:255], a[20:23], v[244:247]
buffer_load_dwordx4 v[112:115], v30, s[16:19], s93 offen
v_mfma_f32_16x16x32_bf16 v[248:251], a[252:255], a[24:27], v[248:251]
s_waitcnt vmcnt(13)
v_cmp_ne_u64 s[50:51], s[88:89], v[98:99]
v_cmp_ne_u64 s[44:45], s[88:89], v[102:103]
v_mfma_f32_16x16x32_bf16 v[252:255], a[252:255], a[28:31], v[252:255]
s_waitcnt lgkmcnt(1)
v_mfma_f32_16x16x32_bf16 v[128:131], a[224:227], a[32:35], v[128:131]
s_or_b64 s[50:51], s[44:45], s[50:51]
ds_read_b128 a[232:235], v14 offset:20480
v_mfma_f32_16x16x32_bf16 v[132:135], a[224:227], a[36:39], v[132:135]
s_cbranch_scc1 L_SLOW3
L_BACK3:
v_mfma_f32_16x16x32_bf16 v[136:139], a[224:227], a[40:43], v[136:139]
s_add_u32 m0, s33, 118784
v_mfma_f32_16x16x32_bf16 v[140:143], a[224:227], a[44:47], v[140:143]
s_waitcnt lgkmcnt(1)
v_perm_b32 v63, v96, v19, s52
v_mfma_f32_16x16x32_bf16 v[144:147], a[228:231], a[32:35], v[144:147]
ds_read_b128 a[236:239], v14 offset:22528
buffer_load_dwordx4 v9, s[20:23], s43 offen lds
v_mfma_f32_16x16x32_bf16 v[148:151], a[228:231], a[36:39], v[148:151]
buffer_load_dwordx4 v[116:119], v30, s[16:19], s94 offen
v_mfma_f32_16x16x32_bf16 v[152:155], a[228:231], a[40:43], v[152:155]
ds_read_b32 a48, v63
v_perm_b32 v62, v96, v19, s53
v_mfma_f32_16x16x32_bf16 v[156:159], a[228:231], a[44:47], v[156:159]
s_waitcnt lgkmcnt(2)
ds_read_b32 a49, v62
buffer_load_dwordx4 v[32:35], v12, s[24:27], 0 offen offset:0 sc1
v_mfma_f32_16x16x32_bf16 v[160:163], a[232:235], a[32:35], v[160:163]
ds_read_b128 a[240:243], v14 offset:24576
v_perm_b32 v61, v100, v19, s52
v_mfma_f32_16x16x32_bf16 v[164:167], a[232:235], a[36:39], v[164:167]
ds_read_b32 a50, v61
v_perm_b32 v60, v100, v19, s53
v_mfma_f32_16x16x32_bf16 v[168:171], a[232:235], a[40:43], v[168:171]
ds_read_b32 a51, v60
v_perm_b32 v59, v96, v19, s54
v_mfma_f32_16x16x32_bf16 v[172:175], a[232:235], a[44:47], v[172:175]
s_waitcnt lgkmcnt(4)
ds_read_b32 a52, v59
buffer_load_dwordx4 v[36:39], v12, s[24:27], 0 offen offset:1024 sc1
v_mfma_f32_16x16x32_bf16 v[176:179], a[236:239], a[32:35], v[176:179]
ds_read_b128 a[244:247], v14 offset:26624
v_perm_b32 v58, v96, v19, s55
v_mfma_f32_16x16x32_bf16 v[180:183], a[236:239], a[36:39], v[180:183]
ds_read_b32 a53, v58
v_perm_b32 v57, v100, v19, s54
v_mfma_f32_16x16x32_bf16 v[184:187], a[236:239], a[40:43], v[184:187]
s_add_u32 m0, s33, 122880
ds_read_b32 a54, v57
v_perm_b32 v56, v100, v19, s55
v_mfma_f32_16x16x32_bf16 v[188:191], a[236:239], a[44:47], v[188:191]
s_waitcnt lgkmcnt(4)
ds_read_b32 a55, v56
v_perm_b32 v63, v97, v19, s52
v_mfma_f32_16x16x32_bf16 v[192:195], a[240:243], a[32:35], v[192:195]
ds_read_b128 a[248:251], v14 offset:28672
buffer_load_dwordx4 v10, s[20:23], s43 offen lds
v_mfma_f32_16x16x32_bf16 v[196:199], a[240:243], a[36:39], v[196:199]
ds_read_b32 a56, v63
v_perm_b32 v62, v97, v19, s53
v_mfma_f32_16x16x32_bf16 v[200:203], a[240:243], a[40:43], v[200:203]
ds_read_b32 a57, v62
v_perm_b32 v61, v101, v19, s52
v_mfma_f32_16x16x32_bf16 v[204:207], a[240:243], a[44:47], v[204:207]
s_waitcnt lgkmcnt(4)
ds_read_b32 a58, v61
v_mfma_f32_16x16x32_bf16 v[208:211], a[244:247], a[32:35], v[208:211]
ds_read_b128 a[252:255], v14 offset:30720
v_perm_b32 v60, v101, v19, s53
v_mfma_f32_16x16x32_bf16 v[212:215], a[244:247], a[36:39], v[212:215]
ds_read_b32 a59, v60
v_perm_b32 v59, v97, v19, s54
v_mfma_f32_16x16x32_bf16 v[216:219], a[244:247], a[40:43], v[216:219]
ds_read_b32 a60, v59
v_perm_b32 v58, v97, v19, s55
v_mfma_f32_16x16x32_bf16 v[220:223], a[244:247], a[44:47], v[220:223]
s_waitcnt lgkmcnt(4)
ds_read_b32 a61, v58
v_mfma_f32_16x16x32_bf16 v[224:227], a[248:251], a[32:35], v[224:227]
ds_read_b128 a[224:227], v15 offset:16384
v_perm_b32 v57, v101, v19, s54
v_mfma_f32_16x16x32_bf16 v[228:231], a[248:251], a[36:39], v[228:231]
ds_read_b32 a62, v57
v_perm_b32 v56, v101, v19, s55
v_mfma_f32_16x16x32_bf16 v[232:235], a[248:251], a[40:43], v[232:235]
s_add_u32 m0, s33, 126976
ds_read_b32 a63, v56
v_mfma_f32_16x16x32_bf16 v[236:239], a[248:251], a[44:47], v[236:239]
s_waitcnt lgkmcnt(4)
v_mfma_f32_16x16x32_bf16 v[240:243], a[252:255], a[32:35], v[240:243]
ds_read_b128 a[228:231], v15 offset:18432
buffer_load_dwordx4 v11, s[20:23], s43 offen lds
v_mfma_f32_16x16x32_bf16 v[244:247], a[252:255], a[36:39], v[244:247]
v_mfma_f32_16x16x32_bf16 v[248:251], a[252:255], a[40:43], v[248:251]
v_mfma_f32_16x16x32_bf16 v[252:255], a[252:255], a[44:47], v[252:255]
s_waitcnt vmcnt(13) lgkmcnt(1)
v_cmp_ne_u64 s[50:51], s[88:89], v[82:83]
v_cmp_ne_u64 s[44:45], s[88:89], v[86:87]
v_mfma_f32_16x16x32_bf16 v[128:131], a[224:227], a[48:51], v[128:131]
ds_read_b128 a[232:235], v15 offset:20480
v_mfma_f32_16x16x32_bf16 v[132:135], a[224:227], a[52:55], v[132:135]
s_or_b64 s[50:51], s[44:45], s[50:51]
v_mfma_f32_16x16x32_bf16 v[136:139], a[224:227], a[56:59], v[136:139]
s_cbranch_scc1 L_SLOW4
L_BACK4:
v_mfma_f32_16x16x32_bf16 v[140:143], a[224:227], a[60:63], v[140:143]
s_waitcnt lgkmcnt(1)
v_mfma_f32_16x16x32_bf16 v[144:147], a[228:231], a[48:51], v[144:147]
s_waitcnt vmcnt(12)
ds_read_b128 a[236:239], v15 offset:22528
v_lshlrev_b32 v24, 16, v20
v_mfma_f32_16x16x32_bf16 v[148:151], a[228:231], a[52:55], v[148:151]
v_perm_b32 v63, v80, v19, s52
v_and_b32 v25, 0xffff0000, v20
v_mfma_f32_16x16x32_bf16 v[152:155], a[228:231], a[56:59], v[152:155]
ds_read_b32 a64, v63
v_perm_b32 v62, v80, v19, s53
v_mfma_f32_16x16x32_bf16 v[156:159], a[228:231], a[60:63], v[156:159]
s_waitcnt lgkmcnt(2)
ds_read_b32 a65, v62
v_lshlrev_b32 v26, 16, v21
v_mfma_f32_16x16x32_bf16 v[160:163], a[232:235], a[48:51], v[160:163]
ds_read_b128 a[240:243], v15 offset:24576
v_perm_b32 v61, v84, v19, s52
v_mfma_f32_16x16x32_bf16 v[164:167], a[232:235], a[52:55], v[164:167]
ds_read_b32 a66, v61
v_perm_b32 v60, v84, v19, s53
v_mfma_f32_16x16x32_bf16 v[168:171], a[232:235], a[56:59], v[168:171]
ds_read_b32 a67, v60
v_perm_b32 v59, v80, v19, s54
v_mfma_f32_16x16x32_bf16 v[172:175], a[232:235], a[60:63], v[172:175]
s_waitcnt lgkmcnt(4)
ds_read_b32 a68, v59
buffer_load_dwordx4 v[40:43], v12, s[24:27], 0 offen offset:2048 sc1
v_mfma_f32_16x16x32_bf16 v[176:179], a[236:239], a[48:51], v[176:179]
ds_read_b128 a[244:247], v15 offset:26624
v_perm_b32 v58, v80, v19, s55
v_mfma_f32_16x16x32_bf16 v[180:183], a[236:239], a[52:55], v[180:183]
ds_read_b32 a69, v58
v_perm_b32 v57, v84, v19, s54
v_mfma_f32_16x16x32_bf16 v[184:187], a[236:239], a[56:59], v[184:187]
ds_read_b32 a70, v57
v_perm_b32 v56, v84, v19, s55
v_mfma_f32_16x16x32_bf16 v[188:191], a[236:239], a[60:63], v[188:191]
s_waitcnt lgkmcnt(4)
ds_read_b32 a71, v56
buffer_load_dwordx4 v[44:47], v12, s[24:27], 0 offen offset:3072 sc1
v_mfma_f32_16x16x32_bf16 v[192:195], a[240:243], a[48:51], v[192:195]
ds_read_b128 a[248:251], v15 offset:28672
v_perm_b32 v63, v81, v19, s52
v_mfma_f32_16x16x32_bf16 v[196:199], a[240:243], a[52:55], v[196:199]
ds_read_b32 a72, v63
v_perm_b32 v62, v81, v19, s53
v_mfma_f32_16x16x32_bf16 v[200:203], a[240:243], a[56:59], v[200:203]
s_add_u32 m0, s33, 130560
ds_read_b32 a73, v62
v_perm_b32 v61, v85, v19, s52
v_mfma_f32_16x16x32_bf16 v[204:207], a[240:243], a[60:63], v[204:207]
s_waitcnt lgkmcnt(4)
ds_read_b32 a74, v61
v_perm_b32 v60, v85, v19, s53
v_mfma_f32_16x16x32_bf16 v[208:211], a[244:247], a[48:51], v[208:211]
ds_read_b128 a[252:255], v15 offset:30720
buffer_load_dwordx4 v8, s[20:23], 0 offen offset:512 lds
v_mfma_f32_16x16x32_bf16 v[212:215], a[244:247], a[52:55], v[212:215]
ds_read_b32 a75, v60
v_perm_b32 v59, v81, v19, s54
v_mfma_f32_16x16x32_bf16 v[216:219], a[244:247], a[56:59], v[216:219]
ds_read_b32 a76, v59
v_perm_b32 v58, v81, v19, s55
v_mfma_f32_16x16x32_bf16 v[220:223], a[244:247], a[60:63], v[220:223]
s_waitcnt lgkmcnt(4)
ds_read_b32 a77, v58
v_add_u32 v12, 16384, v13
v_mfma_f32_16x16x32_bf16 v[224:227], a[248:251], a[48:51], v[224:227]
s_barrier
ds_read_b128 a[224:227], v14 offset:32768
v_perm_b32 v57, v85, v19, s54
v_mfma_f32_16x16x32_bf16 v[228:231], a[248:251], a[52:55], v[228:231]
ds_read_b32 a78, v57
v_perm_b32 v56, v85, v19, s55
v_mfma_f32_16x16x32_bf16 v[232:235], a[248:251], a[56:59], v[232:235]
ds_read_b32 a79, v56
v_and_b32 v27, 0xffff0000, v21
v_mfma_f32_16x16x32_bf16 v[236:239], a[248:251], a[60:63], v[236:239]
s_waitcnt lgkmcnt(4)
v_mfma_f32_16x16x32_bf16 v[240:243], a[252:255], a[48:51], v[240:243]
ds_read_b128 a[228:231], v14 offset:34816
v_mfma_f32_16x16x32_bf16 v[244:247], a[252:255], a[52:55], v[244:247]
v_mfma_f32_16x16x32_bf16 v[248:251], a[252:255], a[56:59], v[248:251]
s_waitcnt vmcnt(12)
v_cmp_ne_u64 s[50:51], s[88:89], v[90:91]
v_cmp_ne_u64 s[44:45], s[88:89], v[94:95]
v_mfma_f32_16x16x32_bf16 v[252:255], a[252:255], a[60:63], v[252:255]
s_waitcnt lgkmcnt(1)
v_mfma_f32_16x16x32_bf16 v[128:131], a[224:227], a[64:67], v[128:131]
s_or_b64 s[50:51], s[44:45], s[50:51]
ds_read_b128 a[232:235], v14 offset:36864
v_mfma_f32_16x16x32_bf16 v[132:135], a[224:227], a[68:71], v[132:135]
s_cbranch_scc1 L_SLOW5
L_BACK5:
v_mfma_f32_16x16x32_bf16 v[136:139], a[224:227], a[72:75], v[136:139]
s_add_u32 m0, s33, 134656
v_perm_b32 v63, v88, v19, s52
v_mfma_f32_16x16x32_bf16 v[140:143], a[224:227], a[76:79], v[140:143]
s_waitcnt lgkmcnt(1)
ds_read_b32 a80, v63
v_perm_b32 v62, v88, v19, s53
v_mfma_f32_16x16x32_bf16 v[144:147], a[228:231], a[64:67], v[144:147]
ds_read_b128 a[236:239], v14 offset:38912
buffer_load_dwordx4 v9, s[20:23], 0 offen offset:512 lds
v_mfma_f32_16x16x32_bf16 v[148:151], a[228:231], a[68:71], v[148:151]
ds_read_b32 a81, v62
v_perm_b32 v61, v92, v19, s52
v_mfma_f32_16x16x32_bf16 v[152:155], a[228:231], a[72:75], v[152:155]
ds_read_b32 a82, v61
v_perm_b32 v60, v92, v19, s53
v_mfma_f32_16x16x32_bf16 v[156:159], a[228:231], a[76:79], v[156:159]
s_waitcnt lgkmcnt(4)
ds_read_b32 a83, v60
v_mfma_f32_16x16x32_bf16 v[160:163], a[232:235], a[64:67], v[160:163]
ds_read_b128 a[240:243], v14 offset:40960
v_perm_b32 v59, v88, v19, s54
v_mfma_f32_16x16x32_bf16 v[164:167], a[232:235], a[68:71], v[164:167]
ds_read_b32 a84, v59
v_perm_b32 v58, v88, v19, s55
v_mfma_f32_16x16x32_bf16 v[168:171], a[232:235], a[72:75], v[168:171]
ds_read_b32 a85, v58
v_perm_b32 v57, v92, v19, s54
v_mfma_f32_16x16x32_bf16 v[172:175], a[232:235], a[76:79], v[172:175]
s_waitcnt lgkmcnt(4)
ds_read_b32 a86, v57
buffer_load_dwordx4 v[48:51], v12, s[24:27], 0 offen offset:0 sc1
v_mfma_f32_16x16x32_bf16 v[176:179], a[236:239], a[64:67], v[176:179]
ds_read_b128 a[244:247], v14 offset:43008
v_perm_b32 v56, v92, v19, s55
v_mfma_f32_16x16x32_bf16 v[180:183], a[236:239], a[68:71], v[180:183]
ds_read_b32 a87, v56
v_perm_b32 v63, v89, v19, s52
v_mfma_f32_16x16x32_bf16 v[184:187], a[236:239], a[72:75], v[184:187]
s_add_u32 m0, s33, 138752
ds_read_b32 a88, v63
v_perm_b32 v62, v89, v19, s53
v_mfma_f32_16x16x32_bf16 v[188:191], a[236:239], a[76:79], v[188:191]
s_waitcnt lgkmcnt(4)
ds_read_b32 a89, v62
v_perm_b32 v61, v93, v19, s52
v_mfma_f32_16x16x32_bf16 v[192:195], a[240:243], a[64:67], v[192:195]
ds_read_b128 a[248:251], v14 offset:45056
buffer_load_dwordx4 v10, s[20:23], 0 offen offset:512 lds
v_mfma_f32_16x16x32_bf16 v[196:199], a[240:243], a[68:71], v[196:199]
ds_read_b32 a90, v61
v_perm_b32 v60, v93, v19, s53
v_mfma_f32_16x16x32_bf16 v[200:203], a[240:243], a[72:75], v[200:203]
ds_read_b32 a91, v60
v_perm_b32 v59, v89, v19, s54
v_mfma_f32_16x16x32_bf16 v[204:207], a[240:243], a[76:79], v[204:207]
s_waitcnt lgkmcnt(4)
ds_read_b32 a92, v59
buffer_load_dwordx4 v[52:55], v12, s[24:27], 0 offen offset:1024 sc1
v_mfma_f32_16x16x32_bf16 v[208:211], a[244:247], a[64:67], v[208:211]
ds_read_b128 a[252:255], v14 offset:47104
v_mfma_f32_16x16x32_bf16 v[212:215], a[244:247], a[68:71], v[212:215]
s_waitcnt vmcnt(11)
v_perm_b32 v58, v89, v19, s55
v_lshl_add_u64 v[104:105], v[108:109], 4, v[104:105]
v_mfma_f32_16x16x32_bf16 v[216:219], a[244:247], a[72:75], v[216:219]
ds_read_b32 a93, v58
v_perm_b32 v57, v93, v19, s54
v_mfma_f32_16x16x32_bf16 v[220:223], a[244:247], a[76:79], v[220:223]
s_waitcnt lgkmcnt(3)
ds_read_b32 a94, v57
v_perm_b32 v56, v93, v19, s55
v_mfma_f32_16x16x32_bf16 v[224:227], a[248:251], a[64:67], v[224:227]
ds_read_b128 a[224:227], v15 offset:32768
v_lshl_add_u64 v[106:107], v[110:111], 4, v[106:107]
v_mfma_f32_16x16x32_bf16 v[228:231], a[248:251], a[68:71], v[228:231]
ds_read_b32 a95, v56
v_mfma_f32_16x16x32_bf16 v[232:235], a[248:251], a[72:75], v[232:235]
s_waitcnt vmcnt(9)
s_add_u32 m0, s33, 142848
v_cmp_ne_u64 s[50:51], s[88:89], v[34:35]
v_cmp_ne_u64 s[44:45], s[88:89], v[38:39]
v_mfma_f32_16x16x32_bf16 v[236:239], a[248:251], a[76:79], v[236:239]
s_waitcnt lgkmcnt(3)
v_lshl_add_u64 v[112:113], v[116:117], 4, v[112:113]
v_mfma_f32_16x16x32_bf16 v[240:243], a[252:255], a[64:67], v[240:243]
s_or_b64 s[50:51], s[44:45], s[50:51]
ds_read_b128 a[228:231], v15 offset:34816
buffer_load_dwordx4 v11, s[20:23], 0 offen offset:512 lds
v_mfma_f32_16x16x32_bf16 v[244:247], a[252:255], a[68:71], v[244:247]
s_cbranch_scc1 L_SLOW6
L_BACK6:
v_mfma_f32_16x16x32_bf16 v[248:251], a[252:255], a[72:75], v[248:251]
v_perm_b32 v63, v32, v19, s52
v_lshl_add_u64 v[114:115], v[118:119], 4, v[114:115]
v_mfma_f32_16x16x32_bf16 v[252:255], a[252:255], a[76:79], v[252:255]
s_waitcnt lgkmcnt(1)
ds_read_b32 a96, v63
v_mfma_f32_16x16x32_bf16 v[128:131], a[224:227], a[80:83], v[128:131]
ds_read_b128 a[232:235], v15 offset:36864
v_mfma_f32_16x16x32_bf16 v[132:135], a[224:227], a[84:87], v[132:135]
v_perm_b32 v62, v32, v19, s53
v_lshl_or_b32 v104, v112, 8, v104
v_mfma_f32_16x16x32_bf16 v[136:139], a[224:227], a[88:91], v[136:139]
ds_read_b32 a97, v62
v_perm_b32 v61, v36, v19, s52
v_mfma_f32_16x16x32_bf16 v[140:143], a[224:227], a[92:95], v[140:143]
s_waitcnt lgkmcnt(3)
ds_read_b32 a98, v61
v_perm_b32 v60, v36, v19, s53
v_mfma_f32_16x16x32_bf16 v[144:147], a[228:231], a[80:83], v[144:147]
L_PAD1:
s_cbranch_vccnz L_PADRET
ds_read_b128 a[236:239], v15 offset:38912
v_lshl_or_b32 v105, v113, 8, v105
v_mfma_f32_16x16x32_bf16 v[148:151], a[228:231], a[84:87], v[148:151]
ds_read_b32 a99, v60
v_perm_b32 v59, v32, v19, s54
v_mfma_f32_16x16x32_bf16 v[152:155], a[228:231], a[88:91], v[152:155]
ds_read_b32 a100, v59
v_perm_b32 v58, v32, v19, s55
v_mfma_f32_16x16x32_bf16 v[156:159], a[228:231], a[92:95], v[156:159]
s_waitcnt lgkmcnt(4)
ds_read_b32 a101, v58
v_lshl_or_b32 v106, v114, 8, v106
v_mfma_f32_16x16x32_bf16 v[160:163], a[232:235], a[80:83], v[160:163]
ds_read_b128 a[240:243], v15 offset:40960
v_perm_b32 v57, v36, v19, s54
v_mfma_f32_16x16x32_bf16 v[164:167], a[232:235], a[84:87], v[164:167]
ds_read_b32 a102, v57
v_mfma_f32_16x16x32_bf16 v[168:171], a[232:235], a[88:91], v[168:171]
v_perm_b32 v56, v36, v19, s55
v_lshl_or_b32 v107, v115, 8, v107
v_mfma_f32_16x16x32_bf16 v[172:175], a[232:235], a[92:95], v[172:175]
s_waitcnt lgkmcnt(3)
ds_read_b32 a103, v56
buffer_load_dwordx4 v[96:99], v12, s[24:27], 0 offen offset:2048 sc1
v_mfma_f32_16x16x32_bf16 v[176:179], a[236:239], a[80:83], v[176:179]
ds_read_b128 a[244:247], v15 offset:43008
buffer_load_dwordx4 v[100:103], v12, s[24:27], 0 offen offset:3072 sc1
v_mfma_f32_16x16x32_bf16 v[180:183], a[236:239], a[84:87], v[180:183]
v_perm_b32 v63, v33, v19, s52
v_lshl_or_b32 v108, v105, 16, v104
v_mfma_f32_16x16x32_bf16 v[184:187], a[236:239], a[88:91], v[184:187]
ds_read_b32 a104, v63
v_perm_b32 v62, v33, v19, s53
v_mfma_f32_16x16x32_bf16 v[188:191], a[236:239], a[92:95], v[188:191]
s_waitcnt lgkmcnt(3)
ds_read_b32 a105, v62
v_perm_b32 v61, v37, v19, s52
v_mfma_f32_16x16x32_bf16 v[192:195], a[240:243], a[80:83], v[192:195]
ds_read_b128 a[248:251], v15 offset:45056
v_lshl_or_b32 v109, v107, 16, v106
v_mfma_f32_16x16x32_bf16 v[196:199], a[240:243], a[84:87], v[196:199]
ds_read_b32 a106, v61
v_perm_b32 v60, v37, v19, s53
v_mfma_f32_16x16x32_bf16 v[200:203], a[240:243], a[88:91], v[200:203]
s_add_u32 m0, s33, 146816
ds_read_b32 a107, v60
v_add_u32 v12, 20480, v13
v_mfma_f32_16x16x32_bf16 v[204:207], a[240:243], a[92:95], v[204:207]
s_waitcnt lgkmcnt(4)
v_perm_b32 v59, v33, v19, s54
v_mov_b64 v[110:111], s[88:89]
v_mfma_f32_16x16x32_bf16 v[208:211], a[244:247], a[80:83], v[208:211]
ds_read_b128 a[252:255], v15 offset:47104
buffer_load_dwordx4 v8, s[20:23], 0 offen offset:640 lds
v_mfma_f32_16x16x32_bf16 v[212:215], a[244:247], a[84:87], v[212:215]
ds_read_b32 a108, v59
v_perm_b32 v58, v33, v19, s55
v_mfma_f32_16x16x32_bf16 v[216:219], a[244:247], a[88:91], v[216:219]
ds_read_b32 a109, v58
v_perm_b32 v57, v37, v19, s54
v_mfma_f32_16x16x32_bf16 v[220:223], a[244:247], a[92:95], v[220:223]
s_waitcnt lgkmcnt(3)
ds_read_b32 a110, v57
v_mfma_f32_16x16x32_bf16 v[224:227], a[248:251], a[80:83], v[224:227]
s_waitcnt vmcnt(11)
s_barrier
ds_read_b128 a[224:227], v14 offset:49152
v_perm_b32 v56, v37, v19, s55
v_mfma_f32_16x16x32_bf16 v[228:231], a[248:251], a[84:87], v[228:231]
buffer_store_dwordx4 v[108:111], v13, s[76:79], 0 offen sc1
v_mfma_f32_16x16x32_bf16 v[232:235], a[248:251], a[88:91], v[232:235]
ds_read_b32 a111, v56
v_mfma_f32_16x16x32_bf16 v[236:239], a[248:251], a[92:95], v[236:239]
s_waitcnt lgkmcnt(3)
v_mfma_f32_16x16x32_bf16 v[240:243], a[252:255], a[80:83], v[240:243]
ds_read_b128 a[228:231], v14 offset:51200
v_mfma_f32_16x16x32_bf16 v[244:247], a[252:255], a[84:87], v[244:247]
v_mfma_f32_16x16x32_bf16 v[248:251], a[252:255], a[88:91], v[248:251]
s_waitcnt vmcnt(10)
v_cmp_ne_u64 s[50:51], s[88:89], v[42:43]
v_cmp_ne_u64 s[44:45], s[88:89], v[46:47]
v_mfma_f32_16x16x32_bf16 v[252:255], a[252:255], a[92:95], v[252:255]
s_waitcnt lgkmcnt(1)
v_mfma_f32_16x16x32_bf16 v[128:131], a[224:227], a[96:99], v[128:131]
s_or_b64 s[50:51], s[44:45], s[50:51]
ds_read_b128 a[232:235], v14 offset:53248
v_mfma_f32_16x16x32_bf16 v[132:135], a[224:227], a[100:103], v[132:135]
s_cbranch_scc1 L_SLOW7
L_BACK7:
v_mfma_f32_16x16x32_bf16 v[136:139], a[224:227], a[104:107], v[136:139]
s_add_u32 m0, s33, 150912
v_mfma_f32_16x16x32_bf16 v[140:143], a[224:227], a[108:111], v[140:143]
s_waitcnt lgkmcnt(1)
v_mfma_f32_16x16x32_bf16 v[144:147], a[228:231], a[96:99], v[144:147]
ds_read_b128 a[236:239], v14 offset:55296
buffer_load_dwordx4 v9, s[20:23], 0 offen offset:640 lds
v_mfma_f32_16x16x32_bf16 v[148:151], a[228:231], a[100:103], v[148:151]
v_perm_b32 v63, v40, v19, s52
v_mfma_f32_16x16x32_bf16 v[152:155], a[228:231], a[104:107], v[152:155]
ds_read_b32 a112, v63
v_perm_b32 v62, v40, v19, s53
v_mfma_f32_16x16x32_bf16 v[156:159], a[228:231], a[108:111], v[156:159]
s_waitcnt lgkmcnt(2)
ds_read_b32 a113, v62
v_mfma_f32_16x16x32_bf16 v[160:163], a[232:235], a[96:99], v[160:163]
ds_read_b128 a[240:243], v14 offset:57344
v_perm_b32 v61, v44, v19, s52
v_mfma_f32_16x16x32_bf16 v[164:167], a[232:235], a[100:103], v[164:167]
ds_read_b32 a114, v61
v_perm_b32 v60, v44, v19, s53
v_mfma_f32_16x16x32_bf16 v[168:171], a[232:235], a[104:107], v[168:171]
ds_read_b32 a115, v60
v_perm_b32 v59, v40, v19, s54
v_mfma_f32_16x16x32_bf16 v[172:175], a[232:235], a[108:111], v[172:175]
s_waitcnt lgkmcnt(4)
ds_read_b32 a116, v59
buffer_load_dwordx4 v[80:83], v12, s[24:27], 0 offen offset:0 sc1
v_mfma_f32_16x16x32_bf16 v[176:179], a[236:239], a[96:99], v[176:179]
ds_read_b128 a[244:247], v14 offset:59392
v_perm_b32 v58, v40, v19, s55
v_mfma_f32_16x16x32_bf16 v[180:183], a[236:239], a[100:103], v[180:183]
ds_read_b32 a117, v58
v_perm_b32 v57, v44, v19, s54
v_mfma_f32_16x16x32_bf16 v[184:187], a[236:239], a[104:107], v[184:187]
s_add_u32 m0, s33, 155008
ds_read_b32 a118, v57
v_perm_b32 v56, v44, v19, s55
v_mfma_f32_16x16x32_bf16 v[188:191], a[236:239], a[108:111], v[188:191]
s_waitcnt lgkmcnt(4)
ds_read_b32 a119, v56
v_perm_b32 v63, v41, v19, s52
v_mfma_f32_16x16x32_bf16 v[192:195], a[240:243], a[96:99], v[192:195]
ds_read_b128 a[248:251], v14 offset:61440
buffer_load_dwordx4 v10, s[20:23], 0 offen offset:640 lds
v_mfma_f32_16x16x32_bf16 v[196:199], a[240:243], a[100:103], v[196:199]
ds_read_b32 a120, v63
v_perm_b32 v62, v41, v19, s53
v_mfma_f32_16x16x32_bf16 v[200:203], a[240:243], a[104:107], v[200:203]
ds_read_b32 a121, v62
v_perm_b32 v61, v45, v19, s52
v_mfma_f32_16x16x32_bf16 v[204:207], a[240:243], a[108:111], v[204:207]
s_waitcnt lgkmcnt(4)
ds_read_b32 a122, v61
buffer_load_dwordx4 v[84:87], v12, s[24:27], 0 offen offset:1024 sc1
v_mfma_f32_16x16x32_bf16 v[208:211], a[244:247], a[96:99], v[208:211]
ds_read_b128 a[252:255], v14 offset:63488
v_perm_b32 v60, v45, v19, s53
v_mfma_f32_16x16x32_bf16 v[212:215], a[244:247], a[100:103], v[212:215]
ds_read_b32 a123, v60
v_perm_b32 v59, v41, v19, s54
v_mfma_f32_16x16x32_bf16 v[216:219], a[244:247], a[104:107], v[216:219]
ds_read_b32 a124, v59
v_perm_b32 v58, v41, v19, s55
v_mfma_f32_16x16x32_bf16 v[220:223], a[244:247], a[108:111], v[220:223]
s_waitcnt lgkmcnt(4)
ds_read_b32 a125, v58
v_mfma_f32_16x16x32_bf16 v[224:227], a[248:251], a[96:99], v[224:227]
ds_read_b128 a[224:227], v15 offset:49152
v_perm_b32 v57, v45, v19, s54
v_mfma_f32_16x16x32_bf16 v[228:231], a[248:251], a[100:103], v[228:231]
ds_read_b32 a126, v57
v_perm_b32 v56, v45, v19, s55
v_mfma_f32_16x16x32_bf16 v[232:235], a[248:251], a[104:107], v[232:235]
s_add_u32 m0, s33, 159104
ds_read_b32 a127, v56
v_mfma_f32_16x16x32_bf16 v[236:239], a[248:251], a[108:111], v[236:239]
s_waitcnt lgkmcnt(4)
v_mfma_f32_16x16x32_bf16 v[240:243], a[252:255], a[96:99], v[240:243]
ds_read_b128 a[228:231], v15 offset:51200
buffer_load_dwordx4 v11, s[20:23], 0 offen offset:640 lds
v_mfma_f32_16x16x32_bf16 v[244:247], a[252:255], a[100:103], v[244:247]
v_mfma_f32_16x16x32_bf16 v[248:251], a[252:255], a[104:107], v[248:251]
v_mfma_f32_16x16x32_bf16 v[252:255], a[252:255], a[108:111], v[252:255]
s_waitcnt vmcnt(10) lgkmcnt(1)
v_cmp_ne_u64 s[50:51], s[88:89], v[50:51]
v_cmp_ne_u64 s[44:45], s[88:89], v[54:55]
v_mfma_f32_16x16x32_bf16 v[128:131], a[224:227], a[112:115], v[128:131]
ds_read_b128 a[232:235], v15 offset:53248
v_mfma_f32_16x16x32_bf16 v[132:135], a[224:227], a[116:119], v[132:135]
s_or_b64 s[50:51], s[44:45], s[50:51]
v_mfma_f32_16x16x32_bf16 v[136:139], a[224:227], a[120:123], v[136:139]
s_cbranch_scc1 L_SLOW8
L_BACK8:
v_mfma_f32_16x16x32_bf16 v[140:143], a[224:227], a[124:127], v[140:143]
s_waitcnt lgkmcnt(1)
v_mfma_f32_16x16x32_bf16 v[144:147], a[228:231], a[112:115], v[144:147]
ds_read_b128 a[236:239], v15 offset:55296
v_mfma_f32_16x16x32_bf16 v[148:151], a[228:231], a[116:119], v[148:151]
v_perm_b32 v63, v48, v19, s52
v_mfma_f32_16x16x32_bf16 v[152:155], a[228:231], a[120:123], v[152:155]
ds_read_b32 a128, v63
v_perm_b32 v62, v48, v19, s53
v_mfma_f32_16x16x32_bf16 v[156:159], a[228:231], a[124:127], v[156:159]
s_waitcnt lgkmcnt(2)
ds_read_b32 a129, v62
v_mfma_f32_16x16x32_bf16 v[160:163], a[232:235], a[112:115], v[160:163]
ds_read_b128 a[240:243], v15 offset:57344
v_perm_b32 v61, v52, v19, s52
v_mfma_f32_16x16x32_bf16 v[164:167], a[232:235], a[116:119], v[164:167]
ds_read_b32 a130, v61
v_perm_b32 v60, v52, v19, s53
v_mfma_f32_16x16x32_bf16 v[168:171], a[232:235], a[120:123], v[168:171]
ds_read_b32 a131, v60
v_perm_b32 v59, v48, v19, s54
v_mfma_f32_16x16x32_bf16 v[172:175], a[232:235], a[124:127], v[172:175]
s_waitcnt lgkmcnt(4)
ds_read_b32 a132, v59
buffer_load_dwordx4 v[88:91], v12, s[24:27], 0 offen offset:2048 sc1
v_mfma_f32_16x16x32_bf16 v[176:179], a[236:239], a[112:115], v[176:179]
ds_read_b128 a[244:247], v15 offset:59392
v_perm_b32 v58, v48, v19, s55
v_mfma_f32_16x16x32_bf16 v[180:183], a[236:239], a[116:119], v[180:183]
ds_read_b32 a133, v58
v_perm_b32 v57, v52, v19, s54
v_mfma_f32_16x16x32_bf16 v[184:187], a[236:239], a[120:123], v[184:187]
ds_read_b32 a134, v57
v_perm_b32 v56, v52, v19, s55
v_mfma_f32_16x16x32_bf16 v[188:191], a[236:239], a[124:127], v[188:191]
s_waitcnt lgkmcnt(4)
ds_read_b32 a135, v56
buffer_load_dwordx4 v[92:95], v12, s[24:27], 0 offen offset:3072 sc1
v_mfma_f32_16x16x32_bf16 v[192:195], a[240:243], a[112:115], v[192:195]
ds_read_b128 a[248:251], v15 offset:61440
v_perm_b32 v63, v49, v19, s52
v_mfma_f32_16x16x32_bf16 v[196:199], a[240:243], a[116:119], v[196:199]
ds_read_b32 a136, v63
v_perm_b32 v62, v49, v19, s53
v_mfma_f32_16x16x32_bf16 v[200:203], a[240:243], a[120:123], v[200:203]
s_add_u32 m0, s33, 64768
ds_read_b32 a137, v62
v_perm_b32 v61, v53, v19, s52
v_mfma_f32_16x16x32_bf16 v[204:207], a[240:243], a[124:127], v[204:207]
s_waitcnt lgkmcnt(4)
ds_read_b32 a138, v61
v_perm_b32 v60, v53, v19, s53
v_mfma_f32_16x16x32_bf16 v[208:211], a[244:247], a[112:115], v[208:211]
ds_read_b128 a[252:255], v15 offset:63488
buffer_load_dwordx4 v8, s[20:23], 0 offen offset:768 lds
v_mfma_f32_16x16x32_bf16 v[212:215], a[244:247], a[116:119], v[212:215]
ds_read_b32 a139, v60
v_perm_b32 v59, v49, v19, s54
v_mfma_f32_16x16x32_bf16 v[216:219], a[244:247], a[120:123], v[216:219]
ds_read_b32 a140, v59
v_perm_b32 v58, v49, v19, s55
v_mfma_f32_16x16x32_bf16 v[220:223], a[244:247], a[124:127], v[220:223]
s_waitcnt lgkmcnt(4)
ds_read_b32 a141, v58
v_add_u32 v12, 24576, v13
v_mfma_f32_16x16x32_bf16 v[224:227], a[248:251], a[112:115], v[224:227]
s_waitcnt vmcnt(12)
s_barrier
ds_read_b128 a[224:227], v16 offset:0
v_perm_b32 v57, v53, v19, s54
v_mfma_f32_16x16x32_bf16 v[228:231], a[248:251], a[116:119], v[228:231]
ds_read_b32 a142, v57
v_perm_b32 v56, v53, v19, s55
v_mfma_f32_16x16x32_bf16 v[232:235], a[248:251], a[120:123], v[232:235]
ds_read_b32 a143, v56
v_mfma_f32_16x16x32_bf16 v[236:239], a[248:251], a[124:127], v[236:239]
s_waitcnt lgkmcnt(4)
v_mfma_f32_16x16x32_bf16 v[240:243], a[252:255], a[112:115], v[240:243]
ds_read_b128 a[228:231], v16 offset:2048
v_mfma_f32_16x16x32_bf16 v[244:247], a[252:255], a[116:119], v[244:247]
v_mfma_f32_16x16x32_bf16 v[248:251], a[252:255], a[120:123], v[248:251]
s_waitcnt vmcnt(10)
v_cmp_ne_u64 s[50:51], s[88:89], v[98:99]
v_cmp_ne_u64 s[44:45], s[88:89], v[102:103]
v_mfma_f32_16x16x32_bf16 v[252:255], a[252:255], a[124:127], v[252:255]
s_waitcnt lgkmcnt(1)
v_mfma_f32_16x16x32_bf16 v[128:131], a[224:227], a[128:131], v[128:131]
s_or_b64 s[50:51], s[44:45], s[50:51]
ds_read_b128 a[232:235], v16 offset:4096
v_mfma_f32_16x16x32_bf16 v[132:135], a[224:227], a[132:135], v[132:135]
s_cbranch_scc1 L_SLOW9
L_BACK9:
v_mfma_f32_16x16x32_bf16 v[136:139], a[224:227], a[136:139], v[136:139]
s_add_u32 m0, s33, 68864
v_mfma_f32_16x16x32_bf16 v[140:143], a[224:227], a[140:143], v[140:143]
s_waitcnt lgkmcnt(1)
v_mfma_f32_16x16x32_bf16 v[144:147], a[228:231], a[128:131], v[144:147]
ds_read_b128 a[236:239], v16 offset:6144
buffer_load_dwordx4 v9, s[20:23], 0 offen offset:768 lds
v_mfma_f32_16x16x32_bf16 v[148:151], a[228:231], a[132:135], v[148:151]
v_perm_b32 v63, v96, v19, s52
v_mfma_f32_16x16x32_bf16 v[152:155], a[228:231], a[136:139], v[152:155]
ds_read_b32 a144, v63
v_perm_b32 v62, v96, v19, s53
v_mfma_f32_16x16x32_bf16 v[156:159], a[228:231], a[140:143], v[156:159]
s_waitcnt lgkmcnt(2)
ds_read_b32 a145, v62
v_mfma_f32_16x16x32_bf16 v[160:163], a[232:235], a[128:131], v[160:163]
ds_read_b128 a[240:243], v16 offset:8192
v_perm_b32 v61, v100, v19, s52
v_mfma_f32_16x16x32_bf16 v[164:167], a[232:235], a[132:135], v[164:167]
ds_read_b32 a146, v61
v_perm_b32 v60, v100, v19, s53
v_mfma_f32_16x16x32_bf16 v[168:171], a[232:235], a[136:139], v[168:171]
ds_read_b32 a147, v60
v_perm_b32 v59, v96, v19, s54
v_mfma_f32_16x16x32_bf16 v[172:175], a[232:235], a[140:143], v[172:175]
s_waitcnt lgkmcnt(4)
ds_read_b32 a148, v59
buffer_load_dwordx4 v[32:35], v12, s[24:27], 0 offen offset:0 sc1
v_mfma_f32_16x16x32_bf16 v[176:179], a[236:239], a[128:131], v[176:179]
ds_read_b128 a[244:247], v16 offset:10240
v_perm_b32 v58, v96, v19, s55
v_mfma_f32_16x16x32_bf16 v[180:183], a[236:239], a[132:135], v[180:183]
ds_read_b32 a149, v58
v_perm_b32 v57, v100, v19, s54
v_mfma_f32_16x16x32_bf16 v[184:187], a[236:239], a[136:139], v[184:187]
s_add_u32 m0, s33, 72960
ds_read_b32 a150, v57
v_perm_b32 v56, v100, v19, s55
v_mfma_f32_16x16x32_bf16 v[188:191], a[236:239], a[140:143], v[188:191]
s_waitcnt lgkmcnt(4)
ds_read_b32 a151, v56
v_perm_b32 v63, v97, v19, s52
v_mfma_f32_16x16x32_bf16 v[192:195], a[240:243], a[128:131], v[192:195]
ds_read_b128 a[248:251], v16 offset:12288
buffer_load_dwordx4 v10, s[20:23], 0 offen offset:768 lds
v_mfma_f32_16x16x32_bf16 v[196:199], a[240:243], a[132:135], v[196:199]
ds_read_b32 a152, v63
v_perm_b32 v62, v97, v19, s53
v_mfma_f32_16x16x32_bf16 v[200:203], a[240:243], a[136:139], v[200:203]
ds_read_b32 a153, v62
v_perm_b32 v61, v101, v19, s52
v_mfma_f32_16x16x32_bf16 v[204:207], a[240:243], a[140:143], v[204:207]
s_waitcnt lgkmcnt(4)
ds_read_b32 a154, v61
buffer_load_dwordx4 v[36:39], v12, s[24:27], 0 offen offset:1024 sc1
v_mfma_f32_16x16x32_bf16 v[208:211], a[244:247], a[128:131], v[208:211]
ds_read_b128 a[252:255], v16 offset:14336
v_perm_b32 v60, v101, v19, s53
v_mfma_f32_16x16x32_bf16 v[212:215], a[244:247], a[132:135], v[212:215]
ds_read_b32 a155, v60
v_perm_b32 v59, v97, v19, s54
v_mfma_f32_16x16x32_bf16 v[216:219], a[244:247], a[136:139], v[216:219]
ds_read_b32 a156, v59
v_perm_b32 v58, v97, v19, s55
v_mfma_f32_16x16x32_bf16 v[220:223], a[244:247], a[140:143], v[220:223]
s_waitcnt lgkmcnt(4)
ds_read_b32 a157, v58
v_mfma_f32_16x16x32_bf16 v[224:227], a[248:251], a[128:131], v[224:227]
ds_read_b128 a[224:227], v17 offset:0
v_perm_b32 v57, v101, v19, s54
v_mfma_f32_16x16x32_bf16 v[228:231], a[248:251], a[132:135], v[228:231]
ds_read_b32 a158, v57
v_perm_b32 v56, v101, v19, s55
v_mfma_f32_16x16x32_bf16 v[232:235], a[248:251], a[136:139], v[232:235]
s_add_u32 m0, s33, 77056
ds_read_b32 a159, v56
v_mfma_f32_16x16x32_bf16 v[236:239], a[248:251], a[140:143], v[236:239]
s_waitcnt lgkmcnt(4)
v_mfma_f32_16x16x32_bf16 v[240:243], a[252:255], a[128:131], v[240:243]
ds_read_b128 a[228:231], v17 offset:2048
buffer_load_dwordx4 v11, s[20:23], 0 offen offset:768 lds
v_mfma_f32_16x16x32_bf16 v[244:247], a[252:255], a[132:135], v[244:247]
v_mfma_f32_16x16x32_bf16 v[248:251], a[252:255], a[136:139], v[248:251]
v_mfma_f32_16x16x32_bf16 v[252:255], a[252:255], a[140:143], v[252:255]
s_waitcnt vmcnt(9) lgkmcnt(1)
v_cmp_ne_u64 s[50:51], s[88:89], v[82:83]
v_cmp_ne_u64 s[44:45], s[88:89], v[86:87]
v_mfma_f32_16x16x32_bf16 v[128:131], a[224:227], a[144:147], v[128:131]
ds_read_b128 a[232:235], v17 offset:4096
v_mfma_f32_16x16x32_bf16 v[132:135], a[224:227], a[148:151], v[132:135]
s_or_b64 s[50:51], s[44:45], s[50:51]
v_mfma_f32_16x16x32_bf16 v[136:139], a[224:227], a[152:155], v[136:139]
s_cbranch_scc1 L_SLOW10
L_BACK10:
v_mfma_f32_16x16x32_bf16 v[140:143], a[224:227], a[156:159], v[140:143]
s_waitcnt lgkmcnt(1)
v_mfma_f32_16x16x32_bf16 v[144:147], a[228:231], a[144:147], v[144:147]
ds_read_b128 a[236:239], v17 offset:6144
v_mfma_f32_16x16x32_bf16 v[148:151], a[228:231], a[148:151], v[148:151]
v_perm_b32 v63, v80, v19, s52
v_mfma_f32_16x16x32_bf16 v[152:155], a[228:231], a[152:155], v[152:155]
ds_read_b32 a160, v63
v_perm_b32 v62, v80, v19, s53
v_mfma_f32_16x16x32_bf16 v[156:159], a[228:231], a[156:159], v[156:159]
s_waitcnt lgkmcnt(2)
ds_read_b32 a161, v62
v_mfma_f32_16x16x32_bf16 v[160:163], a[232:235], a[144:147], v[160:163]
ds_read_b128 a[240:243], v17 offset:8192
v_perm_b32 v61, v84, v19, s52
v_mfma_f32_16x16x32_bf16 v[164:167], a[232:235], a[148:151], v[164:167]
ds_read_b32 a162, v61
v_perm_b32 v60, v84, v19, s53
v_mfma_f32_16x16x32_bf16 v[168:171], a[232:235], a[152:155], v[168:171]
s_add_u32 m0, s33, 81024
ds_read_b32 a163, v60
v_perm_b32 v59, v80, v19, s54
v_mfma_f32_16x16x32_bf16 v[172:175], a[232:235], a[156:159], v[172:175]
s_waitcnt lgkmcnt(4)
ds_read_b32 a164, v59
v_perm_b32 v58, v80, v19, s55
v_mfma_f32_16x16x32_bf16 v[176:179], a[236:239], a[144:147], v[176:179]
ds_read_b128 a[244:247], v17 offset:10240
buffer_load_dwordx4 v8, s[20:23], 0 offen offset:896 lds
v_mfma_f32_16x16x32_bf16 v[180:183], a[236:239], a[148:151], v[180:183]
ds_read_b32 a165, v58
v_perm_b32 v57, v84, v19, s54
v_mfma_f32_16x16x32_bf16 v[184:187], a[236:239], a[152:155], v[184:187]
ds_read_b32 a166, v57
v_perm_b32 v56, v84, v19, s55
v_mfma_f32_16x16x32_bf16 v[188:191], a[236:239], a[156:159], v[188:191]
s_waitcnt lgkmcnt(4)
ds_read_b32 a167, v56
buffer_load_dwordx4 v[40:43], v12, s[24:27], 0 offen offset:2048 sc1
v_mfma_f32_16x16x32_bf16 v[192:195], a[240:243], a[144:147], v[192:195]
ds_read_b128 a[248:251], v17 offset:12288
v_perm_b32 v63, v81, v19, s52
v_mfma_f32_16x16x32_bf16 v[196:199], a[240:243], a[148:151], v[196:199]
ds_read_b32 a168, v63
v_perm_b32 v62, v81, v19, s53
v_mfma_f32_16x16x32_bf16 v[200:203], a[240:243], a[152:155], v[200:203]
s_add_u32 m0, s33, 85120
ds_read_b32 a169, v62
v_perm_b32 v61, v85, v19, s52
v_mfma_f32_16x16x32_bf16 v[204:207], a[240:243], a[156:159], v[204:207]
s_waitcnt lgkmcnt(4)
ds_read_b32 a170, v61
v_perm_b32 v60, v85, v19, s53
v_mfma_f32_16x16x32_bf16 v[208:211], a[244:247], a[144:147], v[208:211]
ds_read_b128 a[252:255], v17 offset:14336
buffer_load_dwordx4 v9, s[20:23], 0 offen offset:896 lds
v_mfma_f32_16x16x32_bf16 v[212:215], a[244:247], a[148:151], v[212:215]
ds_read_b32 a171, v60
v_perm_b32 v59, v81, v19, s54
v_mfma_f32_16x16x32_bf16 v[216:219], a[244:247], a[152:155], v[216:219]
ds_read_b32 a172, v59
v_perm_b32 v58, v81, v19, s55
v_mfma_f32_16x16x32_bf16 v[220:223], a[244:247], a[156:159], v[220:223]
s_waitcnt lgkmcnt(4)
ds_read_b32 a173, v58
buffer_load_dwordx4 v[44:47], v12, s[24:27], 0 offen offset:3072 sc1
v_mfma_f32_16x16x32_bf16 v[224:227], a[248:251], a[144:147], v[224:227]
s_waitcnt vmcnt(12)
s_barrier
ds_read_b128 a[224:227], v16 offset:16384
v_perm_b32 v57, v85, v19, s54
v_mfma_f32_16x16x32_bf16 v[228:231], a[248:251], a[148:151], v[228:231]
ds_read_b32 a174, v57
v_perm_b32 v56, v85, v19, s55
v_mfma_f32_16x16x32_bf16 v[232:235], a[248:251], a[152:155], v[232:235]
ds_read_b32 a175, v56
v_add_u32 v12, 28672, v13
v_mfma_f32_16x16x32_bf16 v[236:239], a[248:251], a[156:159], v[236:239]
s_waitcnt lgkmcnt(4)
v_mfma_f32_16x16x32_bf16 v[240:243], a[252:255], a[144:147], v[240:243]
ds_read_b128 a[228:231], v16 offset:18432
v_mfma_f32_16x16x32_bf16 v[244:247], a[252:255], a[148:151], v[244:247]
v_mfma_f32_16x16x32_bf16 v[248:251], a[252:255], a[152:155], v[248:251]
s_waitcnt vmcnt(10)
v_cmp_ne_u64 s[50:51], s[88:89], v[90:91]
v_cmp_ne_u64 s[44:45], s[88:89], v[94:95]
v_mfma_f32_16x16x32_bf16 v[252:255], a[252:255], a[156:159], v[252:255]
s_waitcnt lgkmcnt(1)
v_mfma_f32_16x16x32_bf16 v[128:131], a[224:227], a[160:163], v[128:131]
s_or_b64 s[50:51], s[44:45], s[50:51]
ds_read_b128 a[232:235], v16 offset:20480
v_mfma_f32_16x16x32_bf16 v[132:135], a[224:227], a[164:167], v[132:135]
s_cbranch_scc1 L_SLOW11
L_BACK11:
v_mfma_f32_16x16x32_bf16 v[136:139], a[224:227], a[168:171], v[136:139]
s_add_u32 m0, s33, 89216
v_mfma_f32_16x16x32_bf16 v[140:143], a[224:227], a[172:175], v[140:143]
s_waitcnt lgkmcnt(1)
v_mfma_f32_16x16x32_bf16 v[144:147], a[228:231], a[160:163], v[144:147]
ds_read_b128 a[236:239], v16 offset:22528
buffer_load_dwordx4 v10, s[20:23], 0 offen offset:896 lds
v_mfma_f32_16x16x32_bf16 v[148:151], a[228:231], a[164:167], v[148:151]
v_perm_b32 v63, v88, v19, s52
v_mfma_f32_16x16x32_bf16 v[152:155], a[228:231], a[168:171], v[152:155]
ds_read_b32 a176, v63
v_perm_b32 v62, v88, v19, s53
v_mfma_f32_16x16x32_bf16 v[156:159], a[228:231], a[172:175], v[156:159]
s_waitcnt lgkmcnt(2)
ds_read_b32 a177, v62
v_mfma_f32_16x16x32_bf16 v[160:163], a[232:235], a[160:163], v[160:163]
ds_read_b128 a[240:243], v16 offset:24576
v_perm_b32 v61, v92, v19, s52
v_mfma_f32_16x16x32_bf16 v[164:167], a[232:235], a[164:167], v[164:167]
ds_read_b32 a178, v61
v_perm_b32 v60, v92, v19, s53
v_mfma_f32_16x16x32_bf16 v[168:171], a[232:235], a[168:171], v[168:171]
ds_read_b32 a179, v60
v_perm_b32 v59, v88, v19, s54
v_mfma_f32_16x16x32_bf16 v[172:175], a[232:235], a[172:175], v[172:175]
s_waitcnt lgkmcnt(4)
ds_read_b32 a180, v59
buffer_load_dwordx4 v[48:51], v12, s[24:27], 0 offen offset:0 sc1
v_mfma_f32_16x16x32_bf16 v[176:179], a[236:239], a[160:163], v[176:179]
ds_read_b128 a[244:247], v16 offset:26624
v_perm_b32 v58, v88, v19, s55
v_mfma_f32_16x16x32_bf16 v[180:183], a[236:239], a[164:167], v[180:183]
ds_read_b32 a181, v58
v_perm_b32 v57, v92, v19, s54
v_mfma_f32_16x16x32_bf16 v[184:187], a[236:239], a[168:171], v[184:187]
s_add_u32 m0, s33, 93312
ds_read_b32 a182, v57
v_perm_b32 v56, v92, v19, s55
v_mfma_f32_16x16x32_bf16 v[188:191], a[236:239], a[172:175], v[188:191]
s_waitcnt lgkmcnt(4)
ds_read_b32 a183, v56
v_perm_b32 v63, v89, v19, s52
v_mfma_f32_16x16x32_bf16 v[192:195], a[240:243], a[160:163], v[192:195]
ds_read_b128 a[248:251], v16 offset:28672
buffer_load_dwordx4 v11, s[20:23], 0 offen offset:896 lds
v_mfma_f32_16x16x32_bf16 v[196:199], a[240:243], a[164:167], v[196:199]
ds_read_b32 a184, v63
v_perm_b32 v62, v89, v19, s53
v_mfma_f32_16x16x32_bf16 v[200:203], a[240:243], a[168:171], v[200:203]
ds_read_b32 a185, v62
v_perm_b32 v61, v93, v19, s52
v_mfma_f32_16x16x32_bf16 v[204:207], a[240:243], a[172:175], v[204:207]
s_waitcnt lgkmcnt(4)
ds_read_b32 a186, v61
buffer_load_dwordx4 v[52:55], v12, s[24:27], 0 offen offset:1024 sc1
v_mfma_f32_16x16x32_bf16 v[208:211], a[244:247], a[160:163], v[208:211]
ds_read_b128 a[252:255], v16 offset:30720
v_perm_b32 v60, v93, v19, s53
v_mfma_f32_16x16x32_bf16 v[212:215], a[244:247], a[164:167], v[212:215]
ds_read_b32 a187, v60
v_perm_b32 v59, v89, v19, s54
v_mfma_f32_16x16x32_bf16 v[216:219], a[244:247], a[168:171], v[216:219]
ds_read_b32 a188, v59
v_perm_b32 v58, v89, v19, s55
v_mfma_f32_16x16x32_bf16 v[220:223], a[244:247], a[172:175], v[220:223]
s_waitcnt lgkmcnt(4)
ds_read_b32 a189, v58
v_mfma_f32_16x16x32_bf16 v[224:227], a[248:251], a[160:163], v[224:227]
ds_read_b128 a[224:227], v17 offset:16384
v_perm_b32 v57, v93, v19, s54
v_mfma_f32_16x16x32_bf16 v[228:231], a[248:251], a[164:167], v[228:231]
ds_read_b32 a190, v57
v_perm_b32 v56, v93, v19, s55
v_mfma_f32_16x16x32_bf16 v[232:235], a[248:251], a[168:171], v[232:235]
s_add_u32 m0, s33, 97280
ds_read_b32 a191, v56
v_mfma_f32_16x16x32_bf16 v[236:239], a[248:251], a[172:175], v[236:239]
s_waitcnt lgkmcnt(4)
v_mfma_f32_16x16x32_bf16 v[240:243], a[252:255], a[160:163], v[240:243]
ds_read_b128 a[228:231], v17 offset:18432
buffer_load_dwordx4 v8, s[20:23], 0 offen offset:1024 lds
v_mfma_f32_16x16x32_bf16 v[244:247], a[252:255], a[164:167], v[244:247]
v_mfma_f32_16x16x32_bf16 v[248:251], a[252:255], a[168:171], v[248:251]
v_mfma_f32_16x16x32_bf16 v[252:255], a[252:255], a[172:175], v[252:255]
L_PAD2:
s_cbranch_vccnz L_PAD3
s_waitcnt vmcnt(10) lgkmcnt(1)
v_cmp_ne_u64 s[50:51], s[88:89], v[34:35]
v_cmp_ne_u64 s[44:45], s[88:89], v[38:39]
v_mfma_f32_16x16x32_bf16 v[128:131], a[224:227], a[176:179], v[128:131]
ds_read_b128 a[232:235], v17 offset:20480
buffer_load_dwordx4 v[96:99], v12, s[24:27], 0 offen offset:2048 sc1
v_mfma_f32_16x16x32_bf16 v[132:135], a[224:227], a[180:183], v[132:135]
s_or_b64 s[50:51], s[44:45], s[50:51]
buffer_load_dwordx4 v[100:103], v12, s[24:27], 0 offen offset:3072 sc1
v_mfma_f32_16x16x32_bf16 v[136:139], a[224:227], a[184:187], v[136:139]
s_cbranch_scc1 L_SLOW12
L_BACK12:
v_mfma_f32_16x16x32_bf16 v[140:143], a[224:227], a[188:191], v[140:143]
s_waitcnt lgkmcnt(1)
v_add_u32 v12, 32768, v13
v_mfma_f32_16x16x32_bf16 v[144:147], a[228:231], a[176:179], v[144:147]
ds_read_b128 a[236:239], v17 offset:22528
v_mfma_f32_16x16x32_bf16 v[148:151], a[228:231], a[180:183], v[148:151]
v_perm_b32 v63, v32, v19, s52
v_mfma_f32_16x16x32_bf16 v[152:155], a[228:231], a[184:187], v[152:155]
ds_read_b32 a192, v63
v_perm_b32 v62, v32, v19, s53
v_mfma_f32_16x16x32_bf16 v[156:159], a[228:231], a[188:191], v[156:159]
s_waitcnt lgkmcnt(2)
ds_read_b32 a193, v62
v_mfma_f32_16x16x32_bf16 v[160:163], a[232:235], a[176:179], v[160:163]
ds_read_b128 a[240:243], v17 offset:24576
v_perm_b32 v61, v36, v19, s52
v_mfma_f32_16x16x32_bf16 v[164:167], a[232:235], a[180:183], v[164:167]
ds_read_b32 a194, v61
v_perm_b32 v60, v36, v19, s53
v_mfma_f32_16x16x32_bf16 v[168:171], a[232:235], a[184:187], v[168:171]
ds_read_b32 a195, v60
v_perm_b32 v59, v32, v19, s54
v_mfma_f32_16x16x32_bf16 v[172:175], a[232:235], a[188:191], v[172:175]
s_waitcnt lgkmcnt(4)
ds_read_b32 a196, v59
v_mfma_f32_16x16x32_bf16 v[176:179], a[236:239], a[176:179], v[176:179]
ds_read_b128 a[244:247], v17 offset:26624
v_perm_b32 v58, v32, v19, s55
v_mfma_f32_16x16x32_bf16 v[180:183], a[236:239], a[180:183], v[180:183]
ds_read_b32 a197, v58
v_perm_b32 v57, v36, v19, s54
v_mfma_f32_16x16x32_bf16 v[184:187], a[236:239], a[184:187], v[184:187]
ds_read_b32 a198, v57
v_perm_b32 v56, v36, v19, s55
v_mfma_f32_16x16x32_bf16 v[188:191], a[236:239], a[188:191], v[188:191]
s_waitcnt lgkmcnt(4)
ds_read_b32 a199, v56
v_mfma_f32_16x16x32_bf16 v[192:195], a[240:243], a[176:179], v[192:195]
ds_read_b128 a[248:251], v17 offset:28672
v_perm_b32 v63, v33, v19, s52
v_mfma_f32_16x16x32_bf16 v[196:199], a[240:243], a[180:183], v[196:199]
ds_read_b32 a200, v63
v_perm_b32 v62, v33, v19, s53
v_mfma_f32_16x16x32_bf16 v[200:203], a[240:243], a[184:187], v[200:203]
s_add_u32 m0, s33, 101376
ds_read_b32 a201, v62
v_perm_b32 v61, v37, v19, s52
v_mfma_f32_16x16x32_bf16 v[204:207], a[240:243], a[188:191], v[204:207]
s_waitcnt lgkmcnt(4)
ds_read_b32 a202, v61
v_perm_b32 v60, v37, v19, s53
v_mfma_f32_16x16x32_bf16 v[208:211], a[244:247], a[176:179], v[208:211]
ds_read_b128 a[252:255], v17 offset:30720
buffer_load_dwordx4 v9, s[20:23], 0 offen offset:1024 lds
v_mfma_f32_16x16x32_bf16 v[212:215], a[244:247], a[180:183], v[212:215]
ds_read_b32 a203, v60
v_perm_b32 v59, v33, v19, s54
v_mfma_f32_16x16x32_bf16 v[216:219], a[244:247], a[184:187], v[216:219]
ds_read_b32 a204, v59
v_perm_b32 v58, v33, v19, s55
v_mfma_f32_16x16x32_bf16 v[220:223], a[244:247], a[188:191], v[220:223]
s_waitcnt lgkmcnt(4)
ds_read_b32 a205, v58
v_mfma_f32_16x16x32_bf16 v[224:227], a[248:251], a[176:179], v[224:227]
s_waitcnt vmcnt(12)
s_barrier
ds_read_b128 a[224:227], v14 offset:0
v_perm_b32 v57, v37, v19, s54
v_mfma_f32_16x16x32_bf16 v[228:231], a[248:251], a[180:183], v[228:231]
ds_read_b32 a206, v57
v_perm_b32 v56, v37, v19, s55
v_mfma_f32_16x16x32_bf16 v[232:235], a[248:251], a[184:187], v[232:235]
ds_read_b32 a207, v56
buffer_load_dwordx4 v[80:83], v12, s[24:27], 0 offen offset:0 sc1
v_mfma_f32_16x16x32_bf16 v[236:239], a[248:251], a[188:191], v[236:239]
s_waitcnt lgkmcnt(4)
buffer_load_dwordx4 v[84:87], v12, s[24:27], 0 offen offset:1024 sc1
v_mfma_f32_16x16x32_bf16 v[240:243], a[252:255], a[176:179], v[240:243]
ds_read_b128 a[228:231], v14 offset:2048
v_mfma_f32_16x16x32_bf16 v[244:247], a[252:255], a[180:183], v[244:247]
v_mfma_f32_16x16x32_bf16 v[248:251], a[252:255], a[184:187], v[248:251]
s_waitcnt vmcnt(10)
v_cmp_ne_u64 s[50:51], s[88:89], v[42:43]
v_cmp_ne_u64 s[44:45], s[88:89], v[46:47]
v_mfma_f32_16x16x32_bf16 v[252:255], a[252:255], a[188:191], v[252:255]
s_waitcnt lgkmcnt(1)
v_mfma_f32_16x16x32_bf16 v[128:131], a[224:227], a[192:195], v[128:131]
s_or_b64 s[50:51], s[44:45], s[50:51]
ds_read_b128 a[232:235], v14 offset:4096
v_mfma_f32_16x16x32_bf16 v[132:135], a[224:227], a[196:199], v[132:135]
s_cbranch_scc1 L_SLOW13
L_BACK13:
v_mfma_f32_16x16x32_bf16 v[136:139], a[224:227], a[200:203], v[136:139]
s_add_u32 m0, s33, 105472
v_mfma_f32_16x16x32_bf16 v[140:143], a[224:227], a[204:207], v[140:143]
s_waitcnt lgkmcnt(1)
v_mfma_f32_16x16x32_bf16 v[144:147], a[228:231], a[192:195], v[144:147]
ds_read_b128 a[236:239], v14 offset:6144
buffer_load_dwordx4 v10, s[20:23], 0 offen offset:1024 lds
v_mfma_f32_16x16x32_bf16 v[148:151], a[228:231], a[196:199], v[148:151]
v_perm_b32 v63, v40, v19, s52
v_mfma_f32_16x16x32_bf16 v[152:155], a[228:231], a[200:203], v[152:155]
ds_read_b32 a208, v63
v_perm_b32 v62, v40, v19, s53
v_mfma_f32_16x16x32_bf16 v[156:159], a[228:231], a[204:207], v[156:159]
s_waitcnt lgkmcnt(2)
ds_read_b32 a209, v62
v_mfma_f32_16x16x32_bf16 v[160:163], a[232:235], a[192:195], v[160:163]
ds_read_b128 a[240:243], v14 offset:8192
v_perm_b32 v61, v44, v19, s52
v_mfma_f32_16x16x32_bf16 v[164:167], a[232:235], a[196:199], v[164:167]
ds_read_b32 a210, v61
v_perm_b32 v60, v44, v19, s53
v_mfma_f32_16x16x32_bf16 v[168:171], a[232:235], a[200:203], v[168:171]
ds_read_b32 a211, v60
v_perm_b32 v59, v40, v19, s54
v_mfma_f32_16x16x32_bf16 v[172:175], a[232:235], a[204:207], v[172:175]
s_waitcnt lgkmcnt(4)
ds_read_b32 a212, v59
v_mfma_f32_16x16x32_bf16 v[176:179], a[236:239], a[192:195], v[176:179]
ds_read_b128 a[244:247], v14 offset:10240
v_perm_b32 v58, v40, v19, s55
v_mfma_f32_16x16x32_bf16 v[180:183], a[236:239], a[196:199], v[180:183]
ds_read_b32 a213, v58
v_perm_b32 v57, v44, v19, s54
v_mfma_f32_16x16x32_bf16 v[184:187], a[236:239], a[200:203], v[184:187]
s_add_u32 m0, s33, 109440
ds_read_b32 a214, v57
v_perm_b32 v56, v44, v19, s55
v_mfma_f32_16x16x32_bf16 v[188:191], a[236:239], a[204:207], v[188:191]
s_waitcnt lgkmcnt(4)
ds_read_b32 a215, v56
v_perm_b32 v63, v41, v19, s52
v_mfma_f32_16x16x32_bf16 v[192:195], a[240:243], a[192:195], v[192:195]
ds_read_b128 a[248:251], v14 offset:12288
buffer_load_dwordx4 v8, s[20:23], 0 offen offset:1152 lds
v_mfma_f32_16x16x32_bf16 v[196:199], a[240:243], a[196:199], v[196:199]
ds_read_b32 a216, v63
v_perm_b32 v62, v41, v19, s53
v_mfma_f32_16x16x32_bf16 v[200:203], a[240:243], a[200:203], v[200:203]
ds_read_b32 a217, v62
v_perm_b32 v61, v45, v19, s52
v_mfma_f32_16x16x32_bf16 v[204:207], a[240:243], a[204:207], v[204:207]
s_waitcnt lgkmcnt(4)
ds_read_b32 a218, v61
buffer_load_dwordx4 v[88:91], v12, s[24:27], 0 offen offset:2048 sc1
v_mfma_f32_16x16x32_bf16 v[208:211], a[244:247], a[192:195], v[208:211]
ds_read_b128 a[252:255], v14 offset:14336
v_perm_b32 v60, v45, v19, s53
v_mfma_f32_16x16x32_bf16 v[212:215], a[244:247], a[196:199], v[212:215]
ds_read_b32 a219, v60
v_perm_b32 v59, v41, v19, s54
v_mfma_f32_16x16x32_bf16 v[216:219], a[244:247], a[200:203], v[216:219]
ds_read_b32 a220, v59
v_perm_b32 v58, v41, v19, s55
v_mfma_f32_16x16x32_bf16 v[220:223], a[244:247], a[204:207], v[220:223]
s_waitcnt lgkmcnt(4)
ds_read_b32 a221, v58
buffer_load_dwordx4 v[92:95], v12, s[24:27], 0 offen offset:3072 sc1
v_mfma_f32_16x16x32_bf16 v[224:227], a[248:251], a[192:195], v[224:227]
ds_read_b128 a[224:227], v15 offset:0
v_perm_b32 v57, v45, v19, s54
v_mfma_f32_16x16x32_bf16 v[228:231], a[248:251], a[196:199], v[228:231]
ds_read_b32 a222, v57
v_perm_b32 v56, v45, v19, s55
v_mfma_f32_16x16x32_bf16 v[232:235], a[248:251], a[200:203], v[232:235]
s_add_u32 m0, s33, 113664
ds_read_b32 a223, v56
v_add_u32 v12, 36864, v13
v_mfma_f32_16x16x32_bf16 v[236:239], a[248:251], a[204:207], v[236:239]
s_waitcnt lgkmcnt(4)
v_mfma_f32_16x16x32_bf16 v[240:243], a[252:255], a[192:195], v[240:243]
ds_read_b128 a[228:231], v15 offset:2048
buffer_load_dwordx4 v11, s[20:23], 0 offen offset:1024 lds
v_mfma_f32_16x16x32_bf16 v[244:247], a[252:255], a[196:199], v[244:247]
v_mfma_f32_16x16x32_bf16 v[248:251], a[252:255], a[200:203], v[248:251]
s_waitcnt vmcnt(11)
v_cmp_ne_u64 s[50:51], s[88:89], v[50:51]
v_cmp_ne_u64 s[44:45], s[88:89], v[54:55]
v_mfma_f32_16x16x32_bf16 v[252:255], a[252:255], a[204:207], v[252:255]
s_waitcnt lgkmcnt(1)
v_mfma_f32_16x16x32_bf16 v[128:131], a[224:227], a[208:211], v[128:131]
s_or_b64 s[50:51], s[44:45], s[50:51]
ds_read_b128 a[232:235], v15 offset:4096
v_mfma_f32_16x16x32_bf16 v[132:135], a[224:227], a[212:215], v[132:135]
s_cbranch_scc1 L_SLOW14
L_BACK14:
v_mfma_f32_16x16x32_bf16 v[136:139], a[224:227], a[216:219], v[136:139]
v_perm_b32 v63, v48, v19, s52
v_mfma_f32_16x16x32_bf16 v[140:143], a[224:227], a[220:223], v[140:143]
s_waitcnt lgkmcnt(1)
ds_read_b32 a0, v63
v_mfma_f32_16x16x32_bf16 v[144:147], a[228:231], a[208:211], v[144:147]
ds_read_b128 a[236:239], v15 offset:6144
v_perm_b32 v62, v48, v19, s53
v_mfma_f32_16x16x32_bf16 v[148:151], a[228:231], a[212:215], v[148:151]
ds_read_b32 a1, v62
v_perm_b32 v61, v52, v19, s52
v_mfma_f32_16x16x32_bf16 v[152:155], a[228:231], a[216:219], v[152:155]
ds_read_b32 a2, v61
v_perm_b32 v60, v52, v19, s53
v_mfma_f32_16x16x32_bf16 v[156:159], a[228:231], a[220:223], v[156:159]
s_waitcnt lgkmcnt(4)
ds_read_b32 a3, v60
v_mfma_f32_16x16x32_bf16 v[160:163], a[232:235], a[208:211], v[160:163]
ds_read_b128 a[240:243], v15 offset:8192
v_perm_b32 v59, v48, v19, s54
v_mfma_f32_16x16x32_bf16 v[164:167], a[232:235], a[212:215], v[164:167]
ds_read_b32 a4, v59
v_perm_b32 v58, v48, v19, s55
v_mfma_f32_16x16x32_bf16 v[168:171], a[232:235], a[216:219], v[168:171]
ds_read_b32 a5, v58
v_perm_b32 v57, v52, v19, s54
v_mfma_f32_16x16x32_bf16 v[172:175], a[232:235], a[220:223], v[172:175]
s_waitcnt lgkmcnt(4)
ds_read_b32 a6, v57
buffer_load_dwordx4 v[32:35], v12, s[24:27], 0 offen offset:0 sc1
v_mfma_f32_16x16x32_bf16 v[176:179], a[236:239], a[208:211], v[176:179]
ds_read_b128 a[244:247], v15 offset:10240
v_perm_b32 v56, v52, v19, s55
v_mfma_f32_16x16x32_bf16 v[180:183], a[236:239], a[212:215], v[180:183]
ds_read_b32 a7, v56
v_perm_b32 v63, v49, v19, s52
v_mfma_f32_16x16x32_bf16 v[184:187], a[236:239], a[216:219], v[184:187]
ds_read_b32 a8, v63
v_perm_b32 v62, v49, v19, s53
v_mfma_f32_16x16x32_bf16 v[188:191], a[236:239], a[220:223], v[188:191]
s_waitcnt lgkmcnt(4)
ds_read_b32 a9, v62
buffer_load_dwordx4 v[36:39], v12, s[24:27], 0 offen offset:1024 sc1
v_mfma_f32_16x16x32_bf16 v[192:195], a[240:243], a[208:211], v[192:195]
ds_read_b128 a[248:251], v15 offset:12288
v_perm_b32 v61, v53, v19, s52
v_mfma_f32_16x16x32_bf16 v[196:199], a[240:243], a[212:215], v[196:199]
ds_read_b32 a10, v61
v_perm_b32 v60, v53, v19, s53
v_mfma_f32_16x16x32_bf16 v[200:203], a[240:243], a[216:219], v[200:203]
s_add_u32 m0, s33, 117632
ds_read_b32 a11, v60
v_perm_b32 v59, v49, v19, s54
v_mfma_f32_16x16x32_bf16 v[204:207], a[240:243], a[220:223], v[204:207]
s_waitcnt vmcnt(10) lgkmcnt(4)
v_cmp_ne_u64 s[50:51], s[88:89], v[98:99]
v_cmp_ne_u64 s[44:45], s[88:89], v[102:103]
v_mfma_f32_16x16x32_bf16 v[208:211], a[244:247], a[208:211], v[208:211]
ds_read_b128 a[252:255], v15 offset:14336
buffer_load_dwordx4 v9, s[20:23], 0 offen offset:1152 lds
v_mfma_f32_16x16x32_bf16 v[212:215], a[244:247], a[212:215], v[212:215]
ds_read_b32 a12, v59
v_perm_b32 v58, v49, v19, s55
v_mfma_f32_16x16x32_bf16 v[216:219], a[244:247], a[216:219], v[216:219]
s_or_b64 s[50:51], s[44:45], s[50:51]
ds_read_b32 a13, v58
v_perm_b32 v57, v53, v19, s54
v_mfma_f32_16x16x32_bf16 v[220:223], a[244:247], a[220:223], v[220:223]
s_waitcnt lgkmcnt(3)
ds_read_b32 a14, v57
v_mfma_f32_16x16x32_bf16 v[224:227], a[248:251], a[208:211], v[224:227]
s_barrier
ds_read_b128 a[224:227], v14 offset:16384
v_perm_b32 v56, v53, v19, s55
v_mfma_f32_16x16x32_bf16 v[228:231], a[248:251], a[212:215], v[228:231]
s_cbranch_scc1 L_SLOW15
L_BACK15:
v_mfma_f32_16x16x32_bf16 v[232:235], a[248:251], a[216:219], v[232:235]
ds_read_b32 a15, v56
v_perm_b32 v63, v96, v19, s52
v_mfma_f32_16x16x32_bf16 v[236:239], a[248:251], a[220:223], v[236:239]
s_waitcnt lgkmcnt(3)
ds_read_b32 a16, v63
v_mfma_f32_16x16x32_bf16 v[240:243], a[252:255], a[208:211], v[240:243]
ds_read_b128 a[228:231], v14 offset:18432
v_perm_b32 v62, v96, v19, s53
v_mfma_f32_16x16x32_bf16 v[244:247], a[252:255], a[212:215], v[244:247]
ds_read_b32 a17, v62
v_perm_b32 v61, v100, v19, s52
v_mfma_f32_16x16x32_bf16 v[248:251], a[252:255], a[216:219], v[248:251]
ds_read_b32 a18, v61
v_perm_b32 v60, v100, v19, s53
v_mfma_f32_16x16x32_bf16 v[252:255], a[252:255], a[220:223], v[252:255]
s_waitcnt lgkmcnt(4)
ds_read_b32 a19, v60
v_mfma_f32_16x16x32_bf16 v[128:131], a[224:227], a[0:3], v[128:131]
ds_read_b128 a[232:235], v14 offset:20480
v_perm_b32 v59, v96, v19, s54
v_mfma_f32_16x16x32_bf16 v[132:135], a[224:227], a[4:7], v[132:135]
ds_read_b32 a20, v59
v_perm_b32 v58, v96, v19, s55
v_mfma_f32_16x16x32_bf16 v[136:139], a[224:227], a[8:11], v[136:139]
s_add_u32 m0, s33, 121600
ds_read_b32 a21, v58
v_perm_b32 v57, v100, v19, s54
v_mfma_f32_16x16x32_bf16 v[140:143], a[224:227], a[12:15], v[140:143]
s_waitcnt lgkmcnt(4)
ds_read_b32 a22, v57
v_perm_b32 v56, v100, v19, s55
v_mfma_f32_16x16x32_bf16 v[144:147], a[228:231], a[0:3], v[144:147]
ds_read_b128 a[236:239], v14 offset:22528
buffer_load_dwordx4 v8, s[20:23], 0 offen offset:1280 lds
v_mfma_f32_16x16x32_bf16 v[148:151], a[228:231], a[4:7], v[148:151]
ds_read_b32 a23, v56
v_perm_b32 v63, v97, v19, s52
v_mfma_f32_16x16x32_bf16 v[152:155], a[228:231], a[8:11], v[152:155]
ds_read_b32 a24, v63
v_perm_b32 v62, v97, v19, s53
v_mfma_f32_16x16x32_bf16 v[156:159], a[228:231], a[12:15], v[156:159]
s_waitcnt lgkmcnt(4)
ds_read_b32 a25, v62
buffer_load_dwordx4 v[40:43], v12, s[24:27], 0 offen offset:2048 sc1
v_mfma_f32_16x16x32_bf16 v[160:163], a[232:235], a[0:3], v[160:163]
ds_read_b128 a[240:243], v14 offset:24576
v_perm_b32 v61, v101, v19, s52
v_mfma_f32_16x16x32_bf16 v[164:167], a[232:235], a[4:7], v[164:167]
ds_read_b32 a26, v61
v_perm_b32 v60, v101, v19, s53
v_mfma_f32_16x16x32_bf16 v[168:171], a[232:235], a[8:11], v[168:171]
ds_read_b32 a27, v60
v_perm_b32 v59, v97, v19, s54
v_mfma_f32_16x16x32_bf16 v[172:175], a[232:235], a[12:15], v[172:175]
s_waitcnt lgkmcnt(4)
ds_read_b32 a28, v59
buffer_load_dwordx4 v[44:47], v12, s[24:27], 0 offen offset:3072 sc1
v_mfma_f32_16x16x32_bf16 v[176:179], a[236:239], a[0:3], v[176:179]
ds_read_b128 a[244:247], v14 offset:26624
v_perm_b32 v58, v97, v19, s55
v_mfma_f32_16x16x32_bf16 v[180:183], a[236:239], a[4:7], v[180:183]
ds_read_b32 a29, v58
v_perm_b32 v57, v101, v19, s54
v_mfma_f32_16x16x32_bf16 v[184:187], a[236:239], a[8:11], v[184:187]
s_waitcnt vmcnt(11)
s_add_u32 m0, s33, 125824
v_cmp_ne_u64 s[50:51], s[88:89], v[82:83]
v_cmp_ne_u64 s[44:45], s[88:89], v[86:87]
v_mfma_f32_16x16x32_bf16 v[188:191], a[236:239], a[12:15], v[188:191]
s_waitcnt lgkmcnt(3)
ds_read_b32 a30, v57
v_perm_b32 v56, v101, v19, s55
v_mfma_f32_16x16x32_bf16 v[192:195], a[240:243], a[0:3], v[192:195]
s_or_b64 s[50:51], s[44:45], s[50:51]
ds_read_b128 a[248:251], v14 offset:28672
buffer_load_dwordx4 v10, s[20:23], 0 offen offset:1152 lds
v_mfma_f32_16x16x32_bf16 v[196:199], a[240:243], a[4:7], v[196:199]
s_cbranch_scc1 L_SLOW16
L_BACK16:
v_mfma_f32_16x16x32_bf16 v[200:203], a[240:243], a[8:11], v[200:203]
ds_read_b32 a31, v56
v_perm_b32 v63, v80, v19, s52
v_mfma_f32_16x16x32_bf16 v[204:207], a[240:243], a[12:15], v[204:207]
s_waitcnt lgkmcnt(3)
ds_read_b32 a32, v63
v_add_u32 v12, 40960, v13
v_mfma_f32_16x16x32_bf16 v[208:211], a[244:247], a[0:3], v[208:211]
ds_read_b128 a[252:255], v14 offset:30720
v_perm_b32 v62, v80, v19, s53
v_mfma_f32_16x16x32_bf16 v[212:215], a[244:247], a[4:7], v[212:215]
ds_read_b32 a33, v62
v_perm_b32 v61, v84, v19, s52
v_mfma_f32_16x16x32_bf16 v[216:219], a[244:247], a[8:11], v[216:219]
ds_read_b32 a34, v61
v_perm_b32 v60, v84, v19, s53
v_mfma_f32_16x16x32_bf16 v[220:223], a[244:247], a[12:15], v[220:223]
s_waitcnt lgkmcnt(4)
ds_read_b32 a35, v60
v_mfma_f32_16x16x32_bf16 v[224:227], a[248:251], a[0:3], v[224:227]
ds_read_b128 a[224:227], v15 offset:16384
v_perm_b32 v59, v80, v19, s54
v_mfma_f32_16x16x32_bf16 v[228:231], a[248:251], a[4:7], v[228:231]
ds_read_b32 a36, v59
v_perm_b32 v58, v80, v19, s55
v_mfma_f32_16x16x32_bf16 v[232:235], a[248:251], a[8:11], v[232:235]
s_add_u32 m0, s33, 129792
ds_read_b32 a37, v58
v_perm_b32 v57, v84, v19, s54
v_mfma_f32_16x16x32_bf16 v[236:239], a[248:251], a[12:15], v[236:239]
s_waitcnt lgkmcnt(4)
ds_read_b32 a38, v57
v_perm_b32 v56, v84, v19, s55
v_mfma_f32_16x16x32_bf16 v[240:243], a[252:255], a[0:3], v[240:243]
ds_read_b128 a[228:231], v15 offset:18432
buffer_load_dwordx4 v9, s[20:23], 0 offen offset:1280 lds
v_mfma_f32_16x16x32_bf16 v[244:247], a[252:255], a[4:7], v[244:247]
ds_read_b32 a39, v56
v_perm_b32 v63, v81, v19, s52
v_mfma_f32_16x16x32_bf16 v[248:251], a[252:255], a[8:11], v[248:251]
ds_read_b32 a40, v63
v_perm_b32 v62, v81, v19, s53
v_mfma_f32_16x16x32_bf16 v[252:255], a[252:255], a[12:15], v[252:255]
s_waitcnt lgkmcnt(4)
ds_read_b32 a41, v62
buffer_load_dwordx4 v[48:51], v12, s[24:27], 0 offen offset:0 sc1
v_mfma_f32_16x16x32_bf16 v[128:131], a[224:227], a[16:19], v[128:131]
ds_read_b128 a[232:235], v15 offset:20480
v_perm_b32 v61, v85, v19, s52
v_mfma_f32_16x16x32_bf16 v[132:135], a[224:227], a[20:23], v[132:135]
ds_read_b32 a42, v61
v_perm_b32 v60, v85, v19, s53
v_mfma_f32_16x16x32_bf16 v[136:139], a[224:227], a[24:27], v[136:139]
ds_read_b32 a43, v60
v_perm_b32 v59, v81, v19, s54
v_mfma_f32_16x16x32_bf16 v[140:143], a[224:227], a[28:31], v[140:143]
s_waitcnt lgkmcnt(4)
ds_read_b32 a44, v59
buffer_load_dwordx4 v[52:55], v12, s[24:27], 0 offen offset:1024 sc1
v_mfma_f32_16x16x32_bf16 v[144:147], a[228:231], a[16:19], v[144:147]
ds_read_b128 a[236:239], v15 offset:22528
v_perm_b32 v58, v81, v19, s55
v_mfma_f32_16x16x32_bf16 v[148:151], a[228:231], a[20:23], v[148:151]
ds_read_b32 a45, v58
v_perm_b32 v57, v85, v19, s54
v_mfma_f32_16x16x32_bf16 v[152:155], a[228:231], a[24:27], v[152:155]
s_waitcnt vmcnt(11)
v_cmp_ne_u64 s[50:51], s[88:89], v[90:91]
v_cmp_ne_u64 s[44:45], s[88:89], v[94:95]
v_mfma_f32_16x16x32_bf16 v[156:159], a[228:231], a[28:31], v[156:159]
s_waitcnt lgkmcnt(3)
ds_read_b32 a46, v57
v_mfma_f32_16x16x32_bf16 v[160:163], a[232:235], a[16:19], v[160:163]
s_or_b64 s[50:51], s[44:45], s[50:51]
ds_read_b128 a[240:243], v15 offset:24576
v_perm_b32 v56, v85, v19, s55
v_mfma_f32_16x16x32_bf16 v[164:167], a[232:235], a[20:23], v[164:167]
s_cbranch_scc1 L_SLOW17
L_BACK17:
v_mfma_f32_16x16x32_bf16 v[168:171], a[232:235], a[24:27], v[168:171]
s_add_u32 m0, s33, 133760
ds_read_b32 a47, v56
v_perm_b32 v63, v88, v19, s52
v_mfma_f32_16x16x32_bf16 v[172:175], a[232:235], a[28:31], v[172:175]
s_waitcnt lgkmcnt(3)
ds_read_b32 a48, v63
v_perm_b32 v62, v88, v19, s53
v_mfma_f32_16x16x32_bf16 v[176:179], a[236:239], a[16:19], v[176:179]
ds_read_b128 a[244:247], v15 offset:26624
buffer_load_dwordx4 v8, s[20:23], 0 offen offset:1408 lds
v_mfma_f32_16x16x32_bf16 v[180:183], a[236:239], a[20:23], v[180:183]
ds_read_b32 a49, v62
v_perm_b32 v61, v92, v19, s52
v_mfma_f32_16x16x32_bf16 v[184:187], a[236:239], a[24:27], v[184:187]
ds_read_b32 a50, v61
v_perm_b32 v60, v92, v19, s53
v_mfma_f32_16x16x32_bf16 v[188:191], a[236:239], a[28:31], v[188:191]
s_waitcnt lgkmcnt(4)
ds_read_b32 a51, v60
v_mfma_f32_16x16x32_bf16 v[192:195], a[240:243], a[16:19], v[192:195]
ds_read_b128 a[248:251], v14 offset:32768
v_perm_b32 v59, v88, v19, s54
v_mfma_f32_16x16x32_bf16 v[196:199], a[240:243], a[20:23], v[196:199]
ds_read_b32 a52, v59
v_perm_b32 v58, v88, v19, s55
v_mfma_f32_16x16x32_bf16 v[200:203], a[240:243], a[24:27], v[200:203]
s_add_u32 m0, s33, 137984
ds_read_b32 a53, v58
v_perm_b32 v57, v92, v19, s54
v_mfma_f32_16x16x32_bf16 v[204:207], a[240:243], a[28:31], v[204:207]
s_waitcnt lgkmcnt(4)
ds_read_b32 a54, v57
v_perm_b32 v56, v92, v19, s55
v_mfma_f32_16x16x32_bf16 v[208:211], a[244:247], a[16:19], v[208:211]
ds_read_b128 a[252:255], v14 offset:34816
buffer_load_dwordx4 v10, s[20:23], 0 offen offset:1280 lds
v_mfma_f32_16x16x32_bf16 v[212:215], a[244:247], a[20:23], v[212:215]
ds_read_b32 a55, v56
v_perm_b32 v63, v89, v19, s52
v_mfma_f32_16x16x32_bf16 v[216:219], a[244:247], a[24:27], v[216:219]
ds_read_b32 a56, v63
v_perm_b32 v62, v89, v19, s53
v_mfma_f32_16x16x32_bf16 v[220:223], a[244:247], a[28:31], v[220:223]
s_waitcnt lgkmcnt(4)
ds_read_b32 a57, v62
buffer_load_dwordx4 v[96:99], v12, s[24:27], 0 offen offset:2048 sc1
v_mfma_f32_16x16x32_bf16 v[128:131], a[248:251], a[32:35], v[128:131]
s_waitcnt vmcnt(13)
s_barrier
ds_read_b128 a[224:227], v15 offset:28672
v_perm_b32 v61, v93, v19, s52
v_mfma_f32_16x16x32_bf16 v[132:135], a[248:251], a[36:39], v[132:135]
ds_read_b32 a58, v61
v_perm_b32 v60, v93, v19, s53
v_mfma_f32_16x16x32_bf16 v[136:139], a[248:251], a[40:43], v[136:139]
ds_read_b32 a59, v60
v_perm_b32 v59, v89, v19, s54
v_mfma_f32_16x16x32_bf16 v[140:143], a[248:251], a[44:47], v[140:143]
s_waitcnt lgkmcnt(4)
ds_read_b32 a60, v59
buffer_load_dwordx4 v[100:103], v12, s[24:27], 0 offen offset:3072 sc1
v_mfma_f32_16x16x32_bf16 v[144:147], a[252:255], a[32:35], v[144:147]
ds_read_b128 a[228:231], v15 offset:30720
v_perm_b32 v58, v89, v19, s55
v_mfma_f32_16x16x32_bf16 v[148:151], a[252:255], a[36:39], v[148:151]
ds_read_b32 a61, v58
v_perm_b32 v57, v93, v19, s54
v_mfma_f32_16x16x32_bf16 v[152:155], a[252:255], a[40:43], v[152:155]
s_waitcnt vmcnt(12)
v_cmp_ne_u64 s[50:51], s[88:89], v[34:35]
v_cmp_ne_u64 s[44:45], s[88:89], v[38:39]
v_mfma_f32_16x16x32_bf16 v[156:159], a[252:255], a[44:47], v[156:159]
s_waitcnt lgkmcnt(3)
ds_read_b32 a62, v57
v_add_u32 v12, 45056, v13
v_mfma_f32_16x16x32_bf16 v[224:227], a[224:227], a[16:19], v[224:227]
s_or_b64 s[50:51], s[44:45], s[50:51]
ds_read_b128 a[232:235], v14 offset:36864
v_perm_b32 v56, v93, v19, s55
v_mfma_f32_16x16x32_bf16 v[228:231], a[224:227], a[20:23], v[228:231]
s_cbranch_scc1 L_SLOW18
L_BACK18:
v_mfma_f32_16x16x32_bf16 v[232:235], a[224:227], a[24:27], v[232:235]
s_add_u32 m0, s33, 142208
ds_read_b32 a63, v56
v_perm_b32 v63, v32, v19, s52
v_mfma_f32_16x16x32_bf16 v[236:239], a[224:227], a[28:31], v[236:239]
s_waitcnt lgkmcnt(3)
ds_read_b32 a64, v63
v_perm_b32 v62, v32, v19, s53
v_mfma_f32_16x16x32_bf16 v[240:243], a[228:231], a[16:19], v[240:243]
ds_read_b128 a[236:239], v14 offset:38912
buffer_load_dwordx4 v11, s[20:23], 0 offen offset:1152 lds
v_mfma_f32_16x16x32_bf16 v[244:247], a[228:231], a[20:23], v[244:247]
ds_read_b32 a65, v62
v_perm_b32 v61, v36, v19, s52
v_mfma_f32_16x16x32_bf16 v[248:251], a[228:231], a[24:27], v[248:251]
ds_read_b32 a66, v61
v_perm_b32 v60, v36, v19, s53
v_mfma_f32_16x16x32_bf16 v[252:255], a[228:231], a[28:31], v[252:255]
s_waitcnt lgkmcnt(4)
ds_read_b32 a67, v60
v_mfma_f32_16x16x32_bf16 v[160:163], a[232:235], a[32:35], v[160:163]
ds_read_b128 a[240:243], v15 offset:32768
v_perm_b32 v59, v32, v19, s54
v_mfma_f32_16x16x32_bf16 v[164:167], a[232:235], a[36:39], v[164:167]
ds_read_b32 a68, v59
v_perm_b32 v58, v32, v19, s55
v_mfma_f32_16x16x32_bf16 v[168:171], a[232:235], a[40:43], v[168:171]
ds_read_b32 a69, v58
v_perm_b32 v57, v36, v19, s54
v_mfma_f32_16x16x32_bf16 v[172:175], a[232:235], a[44:47], v[172:175]
s_waitcnt lgkmcnt(4)
ds_read_b32 a70, v57
buffer_load_dwordx4 v[80:83], v12, s[24:27], 0 offen offset:0 sc1
v_mfma_f32_16x16x32_bf16 v[176:179], a[236:239], a[32:35], v[176:179]
L_PAD3:
s_cbranch_vccnz L_PADRET
ds_read_b128 a[244:247], v15 offset:34816
v_perm_b32 v56, v36, v19, s55
v_mfma_f32_16x16x32_bf16 v[180:183], a[236:239], a[36:39], v[180:183]
ds_read_b32 a71, v56
v_perm_b32 v63, v33, v19, s52
v_mfma_f32_16x16x32_bf16 v[184:187], a[236:239], a[40:43], v[184:187]
s_add_u32 m0, s33, 146048
ds_read_b32 a72, v63
v_perm_b32 v62, v33, v19, s53
v_mfma_f32_16x16x32_bf16 v[188:191], a[236:239], a[44:47], v[188:191]
s_waitcnt lgkmcnt(4)
ds_read_b32 a73, v62
v_perm_b32 v61, v37, v19, s52
v_mfma_f32_16x16x32_bf16 v[128:131], a[240:243], a[48:51], v[128:131]
ds_read_b128 a[248:251], v14 offset:40960
buffer_load_dwordx4 v9, s[20:23], 0 offen offset:1408 lds
v_mfma_f32_16x16x32_bf16 v[132:135], a[240:243], a[52:55], v[132:135]
ds_read_b32 a74, v61
v_perm_b32 v60, v37, v19, s53
v_mfma_f32_16x16x32_bf16 v[136:139], a[240:243], a[56:59], v[136:139]
ds_read_b32 a75, v60
v_perm_b32 v59, v33, v19, s54
v_mfma_f32_16x16x32_bf16 v[140:143], a[240:243], a[60:63], v[140:143]
s_waitcnt lgkmcnt(4)
ds_read_b32 a76, v59
buffer_load_dwordx4 v[84:87], v12, s[24:27], 0 offen offset:1024 sc1
v_mfma_f32_16x16x32_bf16 v[144:147], a[244:247], a[48:51], v[144:147]
ds_read_b128 a[252:255], v14 offset:43008
v_perm_b32 v58, v33, v19, s55
v_mfma_f32_16x16x32_bf16 v[148:151], a[244:247], a[52:55], v[148:151]
ds_read_b32 a77, v58
v_perm_b32 v57, v37, v19, s54
v_mfma_f32_16x16x32_bf16 v[152:155], a[244:247], a[56:59], v[152:155]
s_waitcnt vmcnt(12)
v_cmp_ne_u64 s[50:51], s[88:89], v[42:43]
v_cmp_ne_u64 s[44:45], s[88:89], v[46:47]
v_mfma_f32_16x16x32_bf16 v[156:159], a[244:247], a[60:63], v[156:159]
s_waitcnt lgkmcnt(3)
ds_read_b32 a78, v57
v_mfma_f32_16x16x32_bf16 v[192:195], a[248:251], a[32:35], v[192:195]
s_or_b64 s[50:51], s[44:45], s[50:51]
ds_read_b128 a[224:227], v15 offset:36864
v_perm_b32 v56, v37, v19, s55
v_mfma_f32_16x16x32_bf16 v[196:199], a[248:251], a[36:39], v[196:199]
s_cbranch_scc1 L_SLOW19
L_BACK19:
v_mfma_f32_16x16x32_bf16 v[200:203], a[248:251], a[40:43], v[200:203]
s_add_u32 m0, s33, 150016
ds_read_b32 a79, v56
v_perm_b32 v63, v40, v19, s52
v_mfma_f32_16x16x32_bf16 v[204:207], a[248:251], a[44:47], v[204:207]
s_waitcnt lgkmcnt(3)
ds_read_b32 a80, v63
v_perm_b32 v62, v40, v19, s53
v_mfma_f32_16x16x32_bf16 v[208:211], a[252:255], a[32:35], v[208:211]
ds_read_b128 a[228:231], v15 offset:38912
buffer_load_dwordx4 v8, s[20:23], 0 offen offset:1536 lds
v_mfma_f32_16x16x32_bf16 v[212:215], a[252:255], a[36:39], v[212:215]
ds_read_b32 a81, v62
v_perm_b32 v61, v44, v19, s52
v_mfma_f32_16x16x32_bf16 v[216:219], a[252:255], a[40:43], v[216:219]
ds_read_b32 a82, v61
v_perm_b32 v60, v44, v19, s53
v_mfma_f32_16x16x32_bf16 v[220:223], a[252:255], a[44:47], v[220:223]
s_waitcnt lgkmcnt(4)
ds_read_b32 a83, v60
buffer_load_dwordx4 v[88:91], v12, s[24:27], 0 offen offset:2048 sc1
v_mfma_f32_16x16x32_bf16 v[160:163], a[224:227], a[48:51], v[160:163]
ds_read_b128 a[232:235], v14 offset:45056
v_perm_b32 v59, v40, v19, s54
v_mfma_f32_16x16x32_bf16 v[164:167], a[224:227], a[52:55], v[164:167]
ds_read_b32 a84, v59
v_perm_b32 v58, v40, v19, s55
v_mfma_f32_16x16x32_bf16 v[168:171], a[224:227], a[56:59], v[168:171]
ds_read_b32 a85, v58
v_perm_b32 v57, v44, v19, s54
v_mfma_f32_16x16x32_bf16 v[172:175], a[224:227], a[60:63], v[172:175]
s_waitcnt lgkmcnt(4)
ds_read_b32 a86, v57
buffer_load_dwordx4 v[92:95], v12, s[24:27], 0 offen offset:3072 sc1
v_mfma_f32_16x16x32_bf16 v[176:179], a[228:231], a[48:51], v[176:179]
ds_read_b128 a[236:239], v14 offset:47104
v_perm_b32 v56, v44, v19, s55
v_mfma_f32_16x16x32_bf16 v[180:183], a[228:231], a[52:55], v[180:183]
ds_read_b32 a87, v56
v_perm_b32 v63, v41, v19, s52
v_mfma_f32_16x16x32_bf16 v[184:187], a[228:231], a[56:59], v[184:187]
ds_read_b32 a88, v63
v_perm_b32 v62, v41, v19, s53
v_mfma_f32_16x16x32_bf16 v[188:191], a[228:231], a[60:63], v[188:191]
s_waitcnt lgkmcnt(4)
ds_read_b32 a89, v62
v_add_u32 v12, 49152, v13
v_mfma_f32_16x16x32_bf16 v[128:131], a[232:235], a[64:67], v[128:131]
ds_read_b128 a[240:243], v15 offset:40960
v_perm_b32 v61, v45, v19, s52
v_mfma_f32_16x16x32_bf16 v[132:135], a[232:235], a[68:71], v[132:135]
ds_read_b32 a90, v61
v_perm_b32 v60, v45, v19, s53
v_mfma_f32_16x16x32_bf16 v[136:139], a[232:235], a[72:75], v[136:139]
ds_read_b32 a91, v60
v_perm_b32 v59, v41, v19, s54
v_mfma_f32_16x16x32_bf16 v[140:143], a[232:235], a[76:79], v[140:143]
s_waitcnt lgkmcnt(4)
ds_read_b32 a92, v59
v_mfma_f32_16x16x32_bf16 v[144:147], a[236:239], a[64:67], v[144:147]
ds_read_b128 a[244:247], v15 offset:43008
v_perm_b32 v58, v41, v19, s55
v_mfma_f32_16x16x32_bf16 v[148:151], a[236:239], a[68:71], v[148:151]
ds_read_b32 a93, v58
v_perm_b32 v57, v45, v19, s54
v_mfma_f32_16x16x32_bf16 v[152:155], a[236:239], a[72:75], v[152:155]
s_waitcnt vmcnt(11)
v_cmp_ne_u64 s[50:51], s[88:89], v[50:51]
v_cmp_ne_u64 s[44:45], s[88:89], v[54:55]
v_mfma_f32_16x16x32_bf16 v[156:159], a[236:239], a[76:79], v[156:159]
s_waitcnt lgkmcnt(3)
ds_read_b32 a94, v57
v_mfma_f32_16x16x32_bf16 v[192:195], a[240:243], a[48:51], v[192:195]
s_or_b64 s[50:51], s[44:45], s[50:51]
ds_read_b128 a[248:251], v14 offset:49152
v_perm_b32 v56, v45, v19, s55
v_mfma_f32_16x16x32_bf16 v[196:199], a[240:243], a[52:55], v[196:199]
s_cbranch_scc1 L_SLOW20
L_BACK20:
v_mfma_f32_16x16x32_bf16 v[200:203], a[240:243], a[56:59], v[200:203]
ds_read_b32 a95, v56
v_perm_b32 v63, v48, v19, s52
v_mfma_f32_16x16x32_bf16 v[204:207], a[240:243], a[60:63], v[204:207]
s_waitcnt lgkmcnt(3)
ds_read_b32 a96, v63
v_mfma_f32_16x16x32_bf16 v[208:211], a[244:247], a[48:51], v[208:211]
ds_read_b128 a[252:255], v14 offset:51200
v_perm_b32 v62, v48, v19, s53
v_mfma_f32_16x16x32_bf16 v[212:215], a[244:247], a[52:55], v[212:215]
ds_read_b32 a97, v62
v_perm_b32 v61, v52, v19, s52
v_mfma_f32_16x16x32_bf16 v[216:219], a[244:247], a[56:59], v[216:219]
ds_read_b32 a98, v61
v_perm_b32 v60, v52, v19, s53
v_mfma_f32_16x16x32_bf16 v[220:223], a[244:247], a[60:63], v[220:223]
s_waitcnt lgkmcnt(4)
ds_read_b32 a99, v60
v_mfma_f32_16x16x32_bf16 v[224:227], a[248:251], a[32:35], v[224:227]
s_barrier
ds_read_b128 a[224:227], v14 offset:53248
v_perm_b32 v59, v48, v19, s54
v_mfma_f32_16x16x32_bf16 v[228:231], a[248:251], a[36:39], v[228:231]
ds_read_b32 a100, v59
v_perm_b32 v58, v48, v19, s55
v_mfma_f32_16x16x32_bf16 v[232:235], a[248:251], a[40:43], v[232:235]
ds_read_b32 a101, v58
v_perm_b32 v57, v52, v19, s54
v_mfma_f32_16x16x32_bf16 v[236:239], a[248:251], a[44:47], v[236:239]
s_waitcnt lgkmcnt(4)
ds_read_b32 a102, v57
buffer_load_dwordx4 v[32:35], v12, s[24:27], 0 offen offset:0 sc1
v_mfma_f32_16x16x32_bf16 v[240:243], a[252:255], a[32:35], v[240:243]
ds_read_b128 a[228:231], v14 offset:55296
v_perm_b32 v56, v52, v19, s55
v_mfma_f32_16x16x32_bf16 v[244:247], a[252:255], a[36:39], v[244:247]
ds_read_b32 a103, v56
v_perm_b32 v63, v49, v19, s52
v_mfma_f32_16x16x32_bf16 v[248:251], a[252:255], a[40:43], v[248:251]
ds_read_b32 a104, v63
v_perm_b32 v62, v49, v19, s53
v_mfma_f32_16x16x32_bf16 v[252:255], a[252:255], a[44:47], v[252:255]
s_waitcnt lgkmcnt(4)
ds_read_b32 a105, v62
buffer_load_dwordx4 v[36:39], v12, s[24:27], 0 offen offset:1024 sc1
v_mfma_f32_16x16x32_bf16 v[160:163], a[224:227], a[64:67], v[160:163]
ds_read_b128 a[232:235], v15 offset:45056
v_perm_b32 v61, v53, v19, s52
v_mfma_f32_16x16x32_bf16 v[164:167], a[224:227], a[68:71], v[164:167]
ds_read_b32 a106, v61
v_perm_b32 v60, v53, v19, s53
v_mfma_f32_16x16x32_bf16 v[168:171], a[224:227], a[72:75], v[168:171]
s_add_u32 m0, s33, 154112
ds_read_b32 a107, v60
v_perm_b32 v59, v49, v19, s54
v_mfma_f32_16x16x32_bf16 v[172:175], a[224:227], a[76:79], v[172:175]
s_waitcnt lgkmcnt(4)
ds_read_b32 a108, v59
v_perm_b32 v58, v49, v19, s55
v_mfma_f32_16x16x32_bf16 v[176:179], a[228:231], a[64:67], v[176:179]
ds_read_b128 a[236:239], v15 offset:47104
buffer_load_dwordx4 v9, s[20:23], 0 offen offset:1536 lds
v_mfma_f32_16x16x32_bf16 v[180:183], a[228:231], a[68:71], v[180:183]
ds_read_b32 a109, v58
v_perm_b32 v57, v53, v19, s54
v_mfma_f32_16x16x32_bf16 v[184:187], a[228:231], a[72:75], v[184:187]
s_waitcnt vmcnt(10)
v_cmp_ne_u64 s[50:51], s[88:89], v[98:99]
v_cmp_ne_u64 s[44:45], s[88:89], v[102:103]
v_mfma_f32_16x16x32_bf16 v[188:191], a[228:231], a[76:79], v[188:191]
s_waitcnt lgkmcnt(3)
ds_read_b32 a110, v57
v_mfma_f32_16x16x32_bf16 v[128:131], a[232:235], a[80:83], v[128:131]
s_or_b64 s[50:51], s[44:45], s[50:51]
ds_read_b128 a[240:243], v15 offset:53248
v_perm_b32 v56, v53, v19, s55
v_mfma_f32_16x16x32_bf16 v[132:135], a[232:235], a[84:87], v[132:135]
s_cbranch_scc1 L_SLOW21
L_BACK21:
v_mfma_f32_16x16x32_bf16 v[136:139], a[232:235], a[88:91], v[136:139]
ds_read_b32 a111, v56
v_perm_b32 v63, v96, v19, s52
v_mfma_f32_16x16x32_bf16 v[140:143], a[232:235], a[92:95], v[140:143]
s_waitcnt lgkmcnt(3)
ds_read_b32 a112, v63
v_mfma_f32_16x16x32_bf16 v[144:147], a[236:239], a[80:83], v[144:147]
ds_read_b128 a[244:247], v15 offset:55296
v_perm_b32 v62, v96, v19, s53
v_mfma_f32_16x16x32_bf16 v[148:151], a[236:239], a[84:87], v[148:151]
ds_read_b32 a113, v62
v_perm_b32 v61, v100, v19, s52
v_mfma_f32_16x16x32_bf16 v[152:155], a[236:239], a[88:91], v[152:155]
s_add_u32 m0, s33, 158080
ds_read_b32 a114, v61
v_perm_b32 v60, v100, v19, s53
v_mfma_f32_16x16x32_bf16 v[156:159], a[236:239], a[92:95], v[156:159]
s_waitcnt lgkmcnt(4)
ds_read_b32 a115, v60
v_perm_b32 v59, v96, v19, s54
v_mfma_f32_16x16x32_bf16 v[160:163], a[240:243], a[80:83], v[160:163]
ds_read_b128 a[248:251], v14 offset:57344
buffer_load_dwordx4 v8, s[20:23], 0 offen offset:1664 lds
v_mfma_f32_16x16x32_bf16 v[164:167], a[240:243], a[84:87], v[164:167]
ds_read_b32 a116, v59
v_perm_b32 v58, v96, v19, s55
v_mfma_f32_16x16x32_bf16 v[168:171], a[240:243], a[88:91], v[168:171]
ds_read_b32 a117, v58
v_perm_b32 v57, v100, v19, s54
v_mfma_f32_16x16x32_bf16 v[172:175], a[240:243], a[92:95], v[172:175]
s_waitcnt lgkmcnt(4)
ds_read_b32 a118, v57
buffer_load_dwordx4 v[40:43], v12, s[24:27], 0 offen offset:2048 sc1
v_mfma_f32_16x16x32_bf16 v[176:179], a[244:247], a[80:83], v[176:179]
ds_read_b128 a[252:255], v14 offset:59392
v_perm_b32 v56, v100, v19, s55
v_mfma_f32_16x16x32_bf16 v[180:183], a[244:247], a[84:87], v[180:183]
ds_read_b32 a119, v56
v_perm_b32 v63, v97, v19, s52
v_mfma_f32_16x16x32_bf16 v[184:187], a[244:247], a[88:91], v[184:187]
ds_read_b32 a120, v63
v_perm_b32 v62, v97, v19, s53
v_mfma_f32_16x16x32_bf16 v[188:191], a[244:247], a[92:95], v[188:191]
s_waitcnt lgkmcnt(4)
ds_read_b32 a121, v62
buffer_load_dwordx4 v[44:47], v12, s[24:27], 0 offen offset:3072 sc1
v_mfma_f32_16x16x32_bf16 v[128:131], a[248:251], a[96:99], v[128:131]
ds_read_b128 a[224:227], v14 offset:61440
v_perm_b32 v61, v101, v19, s52
v_mfma_f32_16x16x32_bf16 v[132:135], a[248:251], a[100:103], v[132:135]
ds_read_b32 a122, v61
v_perm_b32 v60, v101, v19, s53
v_mfma_f32_16x16x32_bf16 v[136:139], a[248:251], a[104:107], v[136:139]
s_add_u32 m0, s33, 64128
ds_read_b32 a123, v60
v_perm_b32 v59, v97, v19, s54
v_mfma_f32_16x16x32_bf16 v[140:143], a[248:251], a[108:111], v[140:143]
s_waitcnt lgkmcnt(4)
ds_read_b32 a124, v59
v_perm_b32 v58, v97, v19, s55
v_mfma_f32_16x16x32_bf16 v[144:147], a[252:255], a[96:99], v[144:147]
ds_read_b128 a[228:231], v14 offset:63488
buffer_load_dwordx4 v10, s[20:23], 0 offen offset:1408 lds
v_mfma_f32_16x16x32_bf16 v[148:151], a[252:255], a[100:103], v[148:151]
ds_read_b32 a125, v58
v_perm_b32 v57, v101, v19, s54
v_mfma_f32_16x16x32_bf16 v[152:155], a[252:255], a[104:107], v[152:155]
s_waitcnt vmcnt(10)
v_cmp_ne_u64 s[50:51], s[88:89], v[82:83]
v_cmp_ne_u64 s[44:45], s[88:89], v[86:87]
v_mfma_f32_16x16x32_bf16 v[156:159], a[252:255], a[108:111], v[156:159]
s_waitcnt lgkmcnt(3)
ds_read_b32 a126, v57
v_add_u32 v12, 53248, v13
v_mfma_f32_16x16x32_bf16 v[192:195], a[224:227], a[64:67], v[192:195]
s_or_b64 s[50:51], s[44:45], s[50:51]
ds_read_b128 a[232:235], v15 offset:49152
v_perm_b32 v56, v101, v19, s55
v_mfma_f32_16x16x32_bf16 v[196:199], a[224:227], a[68:71], v[196:199]
s_cbranch_scc1 L_SLOW22
L_BACK22:
v_mfma_f32_16x16x32_bf16 v[200:203], a[224:227], a[72:75], v[200:203]
ds_read_b32 a127, v56
v_perm_b32 v63, v80, v19, s52
v_mfma_f32_16x16x32_bf16 v[204:207], a[224:227], a[76:79], v[204:207]
s_waitcnt lgkmcnt(3)
ds_read_b32 a128, v63
v_mfma_f32_16x16x32_bf16 v[208:211], a[228:231], a[64:67], v[208:211]
ds_read_b128 a[236:239], v15 offset:51200
v_perm_b32 v62, v80, v19, s53
v_mfma_f32_16x16x32_bf16 v[212:215], a[228:231], a[68:71], v[212:215]
ds_read_b32 a129, v62
v_perm_b32 v61, v84, v19, s52
v_mfma_f32_16x16x32_bf16 v[216:219], a[228:231], a[72:75], v[216:219]
s_add_u32 m0, s33, 68352
ds_read_b32 a130, v61
v_perm_b32 v60, v84, v19, s53
v_mfma_f32_16x16x32_bf16 v[220:223], a[228:231], a[76:79], v[220:223]
s_waitcnt lgkmcnt(4)
ds_read_b32 a131, v60
v_perm_b32 v59, v80, v19, s54
v_mfma_f32_16x16x32_bf16 v[224:227], a[232:235], a[48:51], v[224:227]
ds_read_b128 a[240:243], v15 offset:57344
buffer_load_dwordx4 v11, s[20:23], 0 offen offset:1280 lds
v_mfma_f32_16x16x32_bf16 v[228:231], a[232:235], a[52:55], v[228:231]
ds_read_b32 a132, v59
v_perm_b32 v58, v80, v19, s55
v_mfma_f32_16x16x32_bf16 v[232:235], a[232:235], a[56:59], v[232:235]
ds_read_b32 a133, v58
v_perm_b32 v57, v84, v19, s54
v_mfma_f32_16x16x32_bf16 v[236:239], a[232:235], a[60:63], v[236:239]
s_waitcnt lgkmcnt(4)
ds_read_b32 a134, v57
buffer_load_dwordx4 v[48:51], v12, s[24:27], 0 offen offset:0 sc1
v_mfma_f32_16x16x32_bf16 v[240:243], a[236:239], a[48:51], v[240:243]
ds_read_b128 a[244:247], v15 offset:59392
v_perm_b32 v56, v84, v19, s55
v_mfma_f32_16x16x32_bf16 v[244:247], a[236:239], a[52:55], v[244:247]
ds_read_b32 a135, v56
v_perm_b32 v63, v81, v19, s52
v_mfma_f32_16x16x32_bf16 v[248:251], a[236:239], a[56:59], v[248:251]
ds_read_b32 a136, v63
v_perm_b32 v62, v81, v19, s53
v_mfma_f32_16x16x32_bf16 v[252:255], a[236:239], a[60:63], v[252:255]
s_waitcnt lgkmcnt(4)
ds_read_b32 a137, v62
buffer_load_dwordx4 v[52:55], v12, s[24:27], 0 offen offset:1024 sc1
v_mfma_f32_16x16x32_bf16 v[128:131], a[240:243], a[112:115], v[128:131]
ds_read_b128 a[248:251], v16 offset:0
v_perm_b32 v61, v85, v19, s52
v_mfma_f32_16x16x32_bf16 v[132:135], a[240:243], a[116:119], v[132:135]
ds_read_b32 a138, v61
v_perm_b32 v60, v85, v19, s53
v_mfma_f32_16x16x32_bf16 v[136:139], a[240:243], a[120:123], v[136:139]
s_add_u32 m0, s33, 71936
ds_read_b32 a139, v60
v_perm_b32 v59, v81, v19, s54
v_mfma_f32_16x16x32_bf16 v[140:143], a[240:243], a[124:127], v[140:143]
s_waitcnt vmcnt(10) lgkmcnt(4)
v_cmp_ne_u64 s[50:51], s[88:89], v[90:91]
v_cmp_ne_u64 s[44:45], s[88:89], v[94:95]
v_mfma_f32_16x16x32_bf16 v[144:147], a[244:247], a[112:115], v[144:147]
ds_read_b128 a[252:255], v16 offset:2048
buffer_load_dwordx4 v8, s[20:23], 0 offen offset:1792 lds
v_mfma_f32_16x16x32_bf16 v[148:151], a[244:247], a[116:119], v[148:151]
ds_read_b32 a140, v59
v_perm_b32 v58, v81, v19, s55
v_mfma_f32_16x16x32_bf16 v[152:155], a[244:247], a[120:123], v[152:155]
s_or_b64 s[50:51], s[44:45], s[50:51]
ds_read_b32 a141, v58
v_perm_b32 v57, v85, v19, s54
v_mfma_f32_16x16x32_bf16 v[156:159], a[244:247], a[124:127], v[156:159]
s_waitcnt lgkmcnt(3)
ds_read_b32 a142, v57
v_mfma_f32_16x16x32_bf16 v[160:163], a[248:251], a[96:99], v[160:163]
s_barrier
ds_read_b128 a[224:227], v15 offset:61440
v_perm_b32 v56, v85, v19, s55
v_mfma_f32_16x16x32_bf16 v[164:167], a[248:251], a[100:103], v[164:167]
s_cbranch_scc1 L_SLOW23
L_BACK23:
v_mfma_f32_16x16x32_bf16 v[168:171], a[248:251], a[104:107], v[168:171]
ds_read_b32 a143, v56
v_perm_b32 v63, v88, v19, s52
v_mfma_f32_16x16x32_bf16 v[172:175], a[248:251], a[108:111], v[172:175]
s_waitcnt lgkmcnt(3)
ds_read_b32 a144, v63
v_mfma_f32_16x16x32_bf16 v[176:179], a[252:255], a[96:99], v[176:179]
ds_read_b128 a[228:231], v15 offset:63488
v_perm_b32 v62, v88, v19, s53
v_mfma_f32_16x16x32_bf16 v[180:183], a[252:255], a[100:103], v[180:183]
ds_read_b32 a145, v62
v_perm_b32 v61, v92, v19, s52
v_mfma_f32_16x16x32_bf16 v[184:187], a[252:255], a[104:107], v[184:187]
s_add_u32 m0, s33, 76160
ds_read_b32 a146, v61
v_perm_b32 v60, v92, v19, s53
v_mfma_f32_16x16x32_bf16 v[188:191], a[252:255], a[108:111], v[188:191]
s_waitcnt lgkmcnt(4)
ds_read_b32 a147, v60
v_perm_b32 v59, v88, v19, s54
v_mfma_f32_16x16x32_bf16 v[192:195], a[224:227], a[80:83], v[192:195]
ds_read_b128 a[232:235], v16 offset:4096
buffer_load_dwordx4 v9, s[20:23], 0 offen offset:1664 lds
v_mfma_f32_16x16x32_bf16 v[196:199], a[224:227], a[84:87], v[196:199]
ds_read_b32 a148, v59
v_perm_b32 v58, v88, v19, s55
v_mfma_f32_16x16x32_bf16 v[200:203], a[224:227], a[88:91], v[200:203]
ds_read_b32 a149, v58
v_perm_b32 v57, v92, v19, s54
v_mfma_f32_16x16x32_bf16 v[204:207], a[224:227], a[92:95], v[204:207]
s_waitcnt lgkmcnt(4)
ds_read_b32 a150, v57
buffer_load_dwordx4 v[96:99], v12, s[24:27], 0 offen offset:2048 sc1
v_mfma_f32_16x16x32_bf16 v[208:211], a[228:231], a[80:83], v[208:211]
ds_read_b128 a[236:239], v16 offset:6144
v_perm_b32 v56, v92, v19, s55
v_mfma_f32_16x16x32_bf16 v[212:215], a[228:231], a[84:87], v[212:215]
ds_read_b32 a151, v56
v_perm_b32 v63, v89, v19, s52
v_mfma_f32_16x16x32_bf16 v[216:219], a[228:231], a[88:91], v[216:219]
ds_read_b32 a152, v63
v_perm_b32 v62, v89, v19, s53
v_mfma_f32_16x16x32_bf16 v[220:223], a[228:231], a[92:95], v[220:223]
s_waitcnt lgkmcnt(4)
ds_read_b32 a153, v62
buffer_load_dwordx4 v[100:103], v12, s[24:27], 0 offen offset:3072 sc1
v_mfma_f32_16x16x32_bf16 v[128:131], a[232:235], a[128:131], v[128:131]
ds_read_b128 a[240:243], v17 offset:0
v_perm_b32 v61, v93, v19, s52
v_mfma_f32_16x16x32_bf16 v[132:135], a[232:235], a[132:135], v[132:135]
ds_read_b32 a154, v61
v_perm_b32 v60, v93, v19, s53
v_mfma_f32_16x16x32_bf16 v[136:139], a[232:235], a[136:139], v[136:139]
s_add_u32 m0, s33, 80384
ds_read_b32 a155, v60
v_perm_b32 v59, v89, v19, s54
v_mfma_f32_16x16x32_bf16 v[140:143], a[232:235], a[140:143], v[140:143]
s_waitcnt lgkmcnt(4)
ds_read_b32 a156, v59
v_perm_b32 v58, v89, v19, s55
v_mfma_f32_16x16x32_bf16 v[144:147], a[236:239], a[128:131], v[144:147]
ds_read_b128 a[244:247], v17 offset:2048
buffer_load_dwordx4 v10, s[20:23], 0 offen offset:1536 lds
v_mfma_f32_16x16x32_bf16 v[148:151], a[236:239], a[132:135], v[148:151]
ds_read_b32 a157, v58
v_perm_b32 v57, v93, v19, s54
v_mfma_f32_16x16x32_bf16 v[152:155], a[236:239], a[136:139], v[152:155]
s_waitcnt vmcnt(13)
v_cmp_ne_u64 s[50:51], s[88:89], v[34:35]
v_cmp_ne_u64 s[44:45], s[88:89], v[38:39]
v_mfma_f32_16x16x32_bf16 v[156:159], a[236:239], a[140:143], v[156:159]
s_waitcnt lgkmcnt(3)
ds_read_b32 a158, v57
v_add_u32 v12, 57344, v13
v_mfma_f32_16x16x32_bf16 v[160:163], a[240:243], a[112:115], v[160:163]
s_or_b64 s[50:51], s[44:45], s[50:51]
ds_read_b128 a[248:251], v17 offset:4096
v_perm_b32 v56, v93, v19, s55
v_mfma_f32_16x16x32_bf16 v[164:167], a[240:243], a[116:119], v[164:167]
s_cbranch_scc1 L_SLOW24
L_BACK24:
v_mfma_f32_16x16x32_bf16 v[168:171], a[240:243], a[120:123], v[168:171]
ds_read_b32 a159, v56
v_perm_b32 v63, v32, v19, s52
v_mfma_f32_16x16x32_bf16 v[172:175], a[240:243], a[124:127], v[172:175]
s_waitcnt lgkmcnt(3)
ds_read_b32 a160, v63
v_mfma_f32_16x16x32_bf16 v[176:179], a[244:247], a[112:115], v[176:179]
ds_read_b128 a[252:255], v17 offset:6144
v_perm_b32 v62, v32, v19, s53
v_mfma_f32_16x16x32_bf16 v[180:183], a[244:247], a[116:119], v[180:183]
ds_read_b32 a161, v62
v_perm_b32 v61, v36, v19, s52
v_mfma_f32_16x16x32_bf16 v[184:187], a[244:247], a[120:123], v[184:187]
s_add_u32 m0, s33, 84096
ds_read_b32 a162, v61
v_perm_b32 v60, v36, v19, s53
v_mfma_f32_16x16x32_bf16 v[188:191], a[244:247], a[124:127], v[188:191]
s_waitcnt lgkmcnt(4)
ds_read_b32 a163, v60
v_perm_b32 v59, v32, v19, s54
v_mfma_f32_16x16x32_bf16 v[128:131], a[248:251], a[144:147], v[128:131]
ds_read_b128 a[224:227], v16 offset:8192
buffer_load_dwordx4 v8, s[20:23], 0 offen offset:1920 lds
v_mfma_f32_16x16x32_bf16 v[132:135], a[248:251], a[148:151], v[132:135]
ds_read_b32 a164, v59
v_perm_b32 v58, v32, v19, s55
v_mfma_f32_16x16x32_bf16 v[136:139], a[248:251], a[152:155], v[136:139]
ds_read_b32 a165, v58
v_perm_b32 v57, v36, v19, s54
v_mfma_f32_16x16x32_bf16 v[140:143], a[248:251], a[156:159], v[140:143]
s_waitcnt lgkmcnt(4)
ds_read_b32 a166, v57
buffer_load_dwordx4 v[80:83], v12, s[24:27], 0 offen offset:0 sc1
v_mfma_f32_16x16x32_bf16 v[144:147], a[252:255], a[144:147], v[144:147]
ds_read_b128 a[228:231], v16 offset:10240
v_perm_b32 v56, v36, v19, s55
v_mfma_f32_16x16x32_bf16 v[148:151], a[252:255], a[148:151], v[148:151]
ds_read_b32 a167, v56
v_perm_b32 v63, v33, v19, s52
v_mfma_f32_16x16x32_bf16 v[152:155], a[252:255], a[152:155], v[152:155]
ds_read_b32 a168, v63
v_perm_b32 v62, v33, v19, s53
v_mfma_f32_16x16x32_bf16 v[156:159], a[252:255], a[156:159], v[156:159]
s_waitcnt lgkmcnt(4)
ds_read_b32 a169, v62
buffer_load_dwordx4 v[84:87], v12, s[24:27], 0 offen offset:1024 sc1
v_mfma_f32_16x16x32_bf16 v[192:195], a[224:227], a[96:99], v[192:195]
ds_read_b128 a[232:235], v16 offset:12288
v_perm_b32 v61, v37, v19, s52
v_mfma_f32_16x16x32_bf16 v[196:199], a[224:227], a[100:103], v[196:199]
ds_read_b32 a170, v61
v_perm_b32 v60, v37, v19, s53
v_mfma_f32_16x16x32_bf16 v[200:203], a[224:227], a[104:107], v[200:203]
s_add_u32 m0, s33, 88320
ds_read_b32 a171, v60
v_perm_b32 v59, v33, v19, s54
v_mfma_f32_16x16x32_bf16 v[204:207], a[224:227], a[108:111], v[204:207]
s_waitcnt lgkmcnt(4)
ds_read_b32 a172, v59
v_perm_b32 v58, v33, v19, s55
v_mfma_f32_16x16x32_bf16 v[208:211], a[228:231], a[96:99], v[208:211]
ds_read_b128 a[236:239], v16 offset:14336
buffer_load_dwordx4 v9, s[20:23], 0 offen offset:1792 lds
v_mfma_f32_16x16x32_bf16 v[212:215], a[228:231], a[100:103], v[212:215]
ds_read_b32 a173, v58
v_perm_b32 v57, v37, v19, s54
v_mfma_f32_16x16x32_bf16 v[216:219], a[228:231], a[104:107], v[216:219]
s_waitcnt vmcnt(13)
v_cmp_ne_u64 s[50:51], s[88:89], v[42:43]
v_cmp_ne_u64 s[44:45], s[88:89], v[46:47]
v_mfma_f32_16x16x32_bf16 v[220:223], a[228:231], a[108:111], v[220:223]
s_waitcnt lgkmcnt(3)
ds_read_b32 a174, v57
v_mfma_f32_16x16x32_bf16 v[224:227], a[232:235], a[64:67], v[224:227]
s_or_b64 s[50:51], s[44:45], s[50:51]
ds_read_b128 a[240:243], v16 offset:16384
v_perm_b32 v56, v37, v19, s55
v_mfma_f32_16x16x32_bf16 v[228:231], a[232:235], a[68:71], v[228:231]
s_cbranch_scc1 L_SLOW25
L_BACK25:
v_mfma_f32_16x16x32_bf16 v[232:235], a[232:235], a[72:75], v[232:235]
ds_read_b32 a175, v56
v_perm_b32 v63, v40, v19, s52
v_mfma_f32_16x16x32_bf16 v[236:239], a[232:235], a[76:79], v[236:239]
s_waitcnt lgkmcnt(3)
ds_read_b32 a176, v63
v_mfma_f32_16x16x32_bf16 v[240:243], a[236:239], a[64:67], v[240:243]
ds_read_b128 a[244:247], v16 offset:18432
v_perm_b32 v62, v40, v19, s53
v_mfma_f32_16x16x32_bf16 v[244:247], a[236:239], a[68:71], v[244:247]
ds_read_b32 a177, v62
v_perm_b32 v61, v44, v19, s52
v_mfma_f32_16x16x32_bf16 v[248:251], a[236:239], a[72:75], v[248:251]
s_add_u32 m0, s33, 92544
ds_read_b32 a178, v61
v_perm_b32 v60, v44, v19, s53
v_mfma_f32_16x16x32_bf16 v[252:255], a[236:239], a[76:79], v[252:255]
s_waitcnt lgkmcnt(4)
ds_read_b32 a179, v60
v_perm_b32 v59, v40, v19, s54
v_mfma_f32_16x16x32_bf16 v[160:163], a[240:243], a[128:131], v[160:163]
ds_read_b128 a[248:251], v16 offset:20480
buffer_load_dwordx4 v10, s[20:23], 0 offen offset:1664 lds
v_mfma_f32_16x16x32_bf16 v[164:167], a[240:243], a[132:135], v[164:167]
L_PAD4:
s_cbranch_vccnz L_PAD5
ds_read_b32 a180, v59
v_perm_b32 v58, v40, v19, s55
v_mfma_f32_16x16x32_bf16 v[168:171], a[240:243], a[136:139], v[168:171]
ds_read_b32 a181, v58
v_perm_b32 v57, v44, v19, s54
v_mfma_f32_16x16x32_bf16 v[172:175], a[240:243], a[140:143], v[172:175]
s_waitcnt lgkmcnt(4)
ds_read_b32 a182, v57
buffer_load_dwordx4 v[88:91], v12, s[24:27], 0 offen offset:2048 sc1
v_mfma_f32_16x16x32_bf16 v[176:179], a[244:247], a[128:131], v[176:179]
ds_read_b128 a[252:255], v16 offset:22528
v_perm_b32 v56, v44, v19, s55
v_mfma_f32_16x16x32_bf16 v[180:183], a[244:247], a[132:135], v[180:183]
ds_read_b32 a183, v56
v_perm_b32 v63, v41, v19, s52
v_mfma_f32_16x16x32_bf16 v[184:187], a[244:247], a[136:139], v[184:187]
ds_read_b32 a184, v63
v_perm_b32 v62, v41, v19, s53
v_mfma_f32_16x16x32_bf16 v[188:191], a[244:247], a[140:143], v[188:191]
s_waitcnt lgkmcnt(4)
ds_read_b32 a185, v62
buffer_load_dwordx4 v[92:95], v12, s[24:27], 0 offen offset:3072 sc1
v_mfma_f32_16x16x32_bf16 v[128:131], a[248:251], a[160:163], v[128:131]
s_waitcnt vmcnt(15)
s_barrier
ds_read_b128 a[224:227], v17 offset:16384
v_perm_b32 v61, v45, v19, s52
v_mfma_f32_16x16x32_bf16 v[132:135], a[248:251], a[164:167], v[132:135]
ds_read_b32 a186, v61
v_perm_b32 v60, v45, v19, s53
v_mfma_f32_16x16x32_bf16 v[136:139], a[248:251], a[168:171], v[136:139]
s_add_u32 m0, s33, 96896
ds_read_b32 a187, v60
v_perm_b32 v59, v41, v19, s54
v_mfma_f32_16x16x32_bf16 v[140:143], a[248:251], a[172:175], v[140:143]
s_waitcnt lgkmcnt(4)
ds_read_b32 a188, v59
v_perm_b32 v58, v41, v19, s55
v_mfma_f32_16x16x32_bf16 v[144:147], a[252:255], a[160:163], v[144:147]
ds_read_b128 a[228:231], v17 offset:18432
buffer_load_dwordx4 v11, s[20:23], 0 offen offset:1408 lds
v_mfma_f32_16x16x32_bf16 v[148:151], a[252:255], a[164:167], v[148:151]
ds_read_b32 a189, v58
v_perm_b32 v57, v45, v19, s54
v_mfma_f32_16x16x32_bf16 v[152:155], a[252:255], a[168:171], v[152:155]
s_waitcnt vmcnt(13)
v_cmp_ne_u64 s[50:51], s[88:89], v[50:51]
v_cmp_ne_u64 s[44:45], s[88:89], v[54:55]
v_mfma_f32_16x16x32_bf16 v[156:159], a[252:255], a[172:175], v[156:159]
s_waitcnt lgkmcnt(3)
ds_read_b32 a190, v57
v_add_u32 v12, 61440, v13
v_mfma_f32_16x16x32_bf16 v[160:163], a[224:227], a[144:147], v[160:163]
s_or_b64 s[50:51], s[44:45], s[50:51]
ds_read_b128 a[232:235], v17 offset:8192
v_perm_b32 v56, v45, v19, s55
v_mfma_f32_16x16x32_bf16 v[164:167], a[224:227], a[148:151], v[164:167]
s_cbranch_scc1 L_SLOW26
L_BACK26:
v_mfma_f32_16x16x32_bf16 v[168:171], a[224:227], a[152:155], v[168:171]
ds_read_b32 a191, v56
v_perm_b32 v63, v48, v19, s52
v_mfma_f32_16x16x32_bf16 v[172:175], a[224:227], a[156:159], v[172:175]
s_waitcnt lgkmcnt(3)
ds_read_b32 a192, v63
v_mfma_f32_16x16x32_bf16 v[176:179], a[228:231], a[144:147], v[176:179]
ds_read_b128 a[236:239], v17 offset:10240
v_perm_b32 v62, v48, v19, s53
v_mfma_f32_16x16x32_bf16 v[180:183], a[228:231], a[148:151], v[180:183]
ds_read_b32 a193, v62
v_perm_b32 v61, v52, v19, s52
v_mfma_f32_16x16x32_bf16 v[184:187], a[228:231], a[152:155], v[184:187]
s_add_u32 m0, s33, 100480
ds_read_b32 a194, v61
v_perm_b32 v60, v52, v19, s53
v_mfma_f32_16x16x32_bf16 v[188:191], a[228:231], a[156:159], v[188:191]
s_waitcnt lgkmcnt(4)
ds_read_b32 a195, v60
v_perm_b32 v59, v48, v19, s54
v_mfma_f32_16x16x32_bf16 v[192:195], a[232:235], a[112:115], v[192:195]
ds_read_b128 a[240:243], v17 offset:20480
buffer_load_dwordx4 v9, s[20:23], 0 offen offset:1920 lds
v_mfma_f32_16x16x32_bf16 v[196:199], a[232:235], a[116:119], v[196:199]
ds_read_b32 a196, v59
v_perm_b32 v58, v48, v19, s55
v_mfma_f32_16x16x32_bf16 v[200:203], a[232:235], a[120:123], v[200:203]
ds_read_b32 a197, v58
v_perm_b32 v57, v52, v19, s54
v_mfma_f32_16x16x32_bf16 v[204:207], a[232:235], a[124:127], v[204:207]
s_waitcnt lgkmcnt(4)
ds_read_b32 a198, v57
buffer_load_dwordx4 v[32:35], v12, s[24:27], 0 offen offset:0 sc1
v_mfma_f32_16x16x32_bf16 v[208:211], a[236:239], a[112:115], v[208:211]
ds_read_b128 a[244:247], v17 offset:22528
v_perm_b32 v56, v52, v19, s55
v_mfma_f32_16x16x32_bf16 v[212:215], a[236:239], a[116:119], v[212:215]
ds_read_b32 a199, v56
v_perm_b32 v63, v49, v19, s52
v_mfma_f32_16x16x32_bf16 v[216:219], a[236:239], a[120:123], v[216:219]
ds_read_b32 a200, v63
v_perm_b32 v62, v49, v19, s53
v_mfma_f32_16x16x32_bf16 v[220:223], a[236:239], a[124:127], v[220:223]
s_waitcnt lgkmcnt(4)
ds_read_b32 a201, v62
buffer_load_dwordx4 v[36:39], v12, s[24:27], 0 offen offset:1024 sc1
v_mfma_f32_16x16x32_bf16 v[128:131], a[240:243], a[176:179], v[128:131]
ds_read_b128 a[248:251], v17 offset:12288
v_perm_b32 v61, v53, v19, s52
v_mfma_f32_16x16x32_bf16 v[132:135], a[240:243], a[180:183], v[132:135]
ds_read_b32 a202, v61
v_perm_b32 v60, v53, v19, s53
v_mfma_f32_16x16x32_bf16 v[136:139], a[240:243], a[184:187], v[136:139]
s_add_u32 m0, s33, 104704
ds_read_b32 a203, v60
v_perm_b32 v59, v49, v19, s54
v_mfma_f32_16x16x32_bf16 v[140:143], a[240:243], a[188:191], v[140:143]
s_waitcnt lgkmcnt(4)
ds_read_b32 a204, v59
v_perm_b32 v58, v49, v19, s55
v_mfma_f32_16x16x32_bf16 v[144:147], a[244:247], a[176:179], v[144:147]
ds_read_b128 a[252:255], v17 offset:14336
buffer_load_dwordx4 v10, s[20:23], 0 offen offset:1792 lds
v_mfma_f32_16x16x32_bf16 v[148:151], a[244:247], a[180:183], v[148:151]
ds_read_b32 a205, v58
v_perm_b32 v57, v53, v19, s54
v_mfma_f32_16x16x32_bf16 v[152:155], a[244:247], a[184:187], v[152:155]
s_waitcnt vmcnt(13)
v_cmp_ne_u64 s[50:51], s[88:89], v[98:99]
v_cmp_ne_u64 s[44:45], s[88:89], v[102:103]
v_mfma_f32_16x16x32_bf16 v[156:159], a[244:247], a[188:191], v[156:159]
s_waitcnt lgkmcnt(3)
ds_read_b32 a206, v57
v_mfma_f32_16x16x32_bf16 v[224:227], a[248:251], a[80:83], v[224:227]
s_or_b64 s[50:51], s[44:45], s[50:51]
ds_read_b128 a[224:227], v16 offset:24576
v_perm_b32 v56, v53, v19, s55
v_mfma_f32_16x16x32_bf16 v[228:231], a[248:251], a[84:87], v[228:231]
s_cbranch_scc1 L_SLOW27
L_BACK27:
v_mfma_f32_16x16x32_bf16 v[232:235], a[248:251], a[88:91], v[232:235]
ds_read_b32 a207, v56
v_perm_b32 v63, v96, v19, s52
v_mfma_f32_16x16x32_bf16 v[236:239], a[248:251], a[92:95], v[236:239]
s_waitcnt lgkmcnt(3)
ds_read_b32 a208, v63
v_mfma_f32_16x16x32_bf16 v[240:243], a[252:255], a[80:83], v[240:243]
ds_read_b128 a[228:231], v16 offset:26624
v_perm_b32 v62, v96, v19, s53
v_mfma_f32_16x16x32_bf16 v[244:247], a[252:255], a[84:87], v[244:247]
ds_read_b32 a209, v62
v_perm_b32 v61, v100, v19, s52
v_mfma_f32_16x16x32_bf16 v[248:251], a[252:255], a[88:91], v[248:251]
s_add_u32 m0, s33, 109056
ds_read_b32 a210, v61
v_perm_b32 v60, v100, v19, s53
v_mfma_f32_16x16x32_bf16 v[252:255], a[252:255], a[92:95], v[252:255]
s_waitcnt lgkmcnt(4)
ds_read_b32 a211, v60
v_perm_b32 v59, v96, v19, s54
v_mfma_f32_16x16x32_bf16 v[160:163], a[224:227], a[160:163], v[160:163]
ds_read_b128 a[232:235], v16 offset:28672
buffer_load_dwordx4 v11, s[20:23], 0 offen offset:1536 lds
v_mfma_f32_16x16x32_bf16 v[164:167], a[224:227], a[164:167], v[164:167]
ds_read_b32 a212, v59
v_perm_b32 v58, v96, v19, s55
v_mfma_f32_16x16x32_bf16 v[168:171], a[224:227], a[168:171], v[168:171]
ds_read_b32 a213, v58
v_perm_b32 v57, v100, v19, s54
v_mfma_f32_16x16x32_bf16 v[172:175], a[224:227], a[172:175], v[172:175]
s_waitcnt lgkmcnt(4)
ds_read_b32 a214, v57
v_mfma_f32_16x16x32_bf16 v[176:179], a[228:231], a[160:163], v[176:179]
ds_read_b128 a[236:239], v16 offset:30720
v_perm_b32 v56, v100, v19, s55
v_mfma_f32_16x16x32_bf16 v[180:183], a[228:231], a[164:167], v[180:183]
ds_read_b32 a215, v56
v_perm_b32 v63, v97, v19, s52
v_mfma_f32_16x16x32_bf16 v[184:187], a[228:231], a[168:171], v[184:187]
ds_read_b32 a216, v63
v_perm_b32 v62, v97, v19, s53
v_mfma_f32_16x16x32_bf16 v[188:191], a[228:231], a[172:175], v[188:191]
s_waitcnt lgkmcnt(4)
ds_read_b32 a217, v62
v_mfma_f32_16x16x32_bf16 v[128:131], a[232:235], a[192:195], v[128:131]
ds_read_b128 a[240:243], v14 offset:0
v_perm_b32 v61, v101, v19, s52
v_mfma_f32_16x16x32_bf16 v[132:135], a[232:235], a[196:199], v[132:135]
ds_read_b32 a218, v61
v_perm_b32 v60, v101, v19, s53
v_mfma_f32_16x16x32_bf16 v[136:139], a[232:235], a[200:203], v[136:139]
s_add_u32 m0, s33, 112768
ds_read_b32 a219, v60
v_perm_b32 v59, v97, v19, s54
v_mfma_f32_16x16x32_bf16 v[140:143], a[232:235], a[204:207], v[140:143]
s_waitcnt lgkmcnt(4)
ds_read_b32 a220, v59
v_perm_b32 v58, v97, v19, s55
v_mfma_f32_16x16x32_bf16 v[144:147], a[236:239], a[192:195], v[144:147]
ds_read_b128 a[244:247], v14 offset:2048
buffer_load_dwordx4 v10, s[20:23], 0 offen offset:1920 lds
v_mfma_f32_16x16x32_bf16 v[148:151], a[236:239], a[196:199], v[148:151]
ds_read_b32 a221, v58
v_perm_b32 v57, v101, v19, s54
v_mfma_f32_16x16x32_bf16 v[152:155], a[236:239], a[200:203], v[152:155]
s_waitcnt vmcnt(11)
v_cmp_ne_u64 s[50:51], s[88:89], v[82:83]
v_cmp_ne_u64 s[44:45], s[88:89], v[86:87]
v_mfma_f32_16x16x32_bf16 v[156:159], a[236:239], a[204:207], v[156:159]
s_waitcnt lgkmcnt(3)
ds_read_b32 a222, v57
buffer_load_dwordx4 v[40:43], v12, s[24:27], 0 offen offset:2048 sc1
v_mfma_f32_16x16x32_bf16 v[192:195], a[240:243], a[128:131], v[192:195]
s_or_b64 s[50:51], s[44:45], s[50:51]
ds_read_b128 a[248:251], v17 offset:24576
v_perm_b32 v56, v101, v19, s55
v_mfma_f32_16x16x32_bf16 v[196:199], a[240:243], a[132:135], v[196:199]
s_cbranch_scc1 L_SLOW28
L_BACK28:
v_mfma_f32_16x16x32_bf16 v[200:203], a[240:243], a[136:139], v[200:203]
s_add_u32 m0, s33, 117120
ds_read_b32 a223, v56
v_perm_b32 v63, v80, v19, s52
v_mfma_f32_16x16x32_bf16 v[204:207], a[240:243], a[140:143], v[204:207]
s_waitcnt lgkmcnt(3)
ds_read_b32 a0, v63
v_perm_b32 v62, v80, v19, s53
v_mfma_f32_16x16x32_bf16 v[208:211], a[244:247], a[128:131], v[208:211]
ds_read_b128 a[252:255], v17 offset:26624
buffer_load_dwordx4 v11, s[20:23], 0 offen offset:1664 lds
v_mfma_f32_16x16x32_bf16 v[212:215], a[244:247], a[132:135], v[212:215]
ds_read_b32 a1, v62
v_perm_b32 v61, v84, v19, s52
v_mfma_f32_16x16x32_bf16 v[216:219], a[244:247], a[136:139], v[216:219]
ds_read_b32 a2, v61
v_perm_b32 v60, v84, v19, s53
v_mfma_f32_16x16x32_bf16 v[220:223], a[244:247], a[140:143], v[220:223]
s_waitcnt lgkmcnt(4)
ds_read_b32 a3, v60
buffer_load_dwordx4 v[44:47], v12, s[24:27], 0 offen offset:3072 sc1
v_mfma_f32_16x16x32_bf16 v[160:163], a[248:251], a[176:179], v[160:163]
s_barrier
ds_read_b128 a[224:227], v17 offset:28672
v_perm_b32 v59, v80, v19, s54
v_mfma_f32_16x16x32_bf16 v[164:167], a[248:251], a[180:183], v[164:167]
ds_read_b32 a4, v59
v_perm_b32 v58, v80, v19, s55
v_mfma_f32_16x16x32_bf16 v[168:171], a[248:251], a[184:187], v[168:171]
ds_read_b32 a5, v58
v_perm_b32 v57, v84, v19, s54
v_mfma_f32_16x16x32_bf16 v[172:175], a[248:251], a[188:191], v[172:175]
s_waitcnt lgkmcnt(4)
ds_read_b32 a6, v57
v_mfma_f32_16x16x32_bf16 v[176:179], a[252:255], a[176:179], v[176:179]
ds_read_b128 a[228:231], v17 offset:30720
v_perm_b32 v56, v84, v19, s55
v_mfma_f32_16x16x32_bf16 v[180:183], a[252:255], a[180:183], v[180:183]
ds_read_b32 a7, v56
v_perm_b32 v63, v81, v19, s52
v_mfma_f32_16x16x32_bf16 v[184:187], a[252:255], a[184:187], v[184:187]
ds_read_b32 a8, v63
v_perm_b32 v62, v81, v19, s53
v_mfma_f32_16x16x32_bf16 v[188:191], a[252:255], a[188:191], v[188:191]
s_waitcnt lgkmcnt(4)
ds_read_b32 a9, v62
v_mfma_f32_16x16x32_bf16 v[128:131], a[224:227], a[208:211], v[128:131]
ds_read_b128 a[232:235], v15 offset:0
v_perm_b32 v61, v85, v19, s52
v_mfma_f32_16x16x32_bf16 v[132:135], a[224:227], a[212:215], v[132:135]
ds_read_b32 a10, v61
v_perm_b32 v60, v85, v19, s53
v_mfma_f32_16x16x32_bf16 v[136:139], a[224:227], a[216:219], v[136:139]
s_add_u32 m0, s33, 121088
ds_read_b32 a11, v60
v_perm_b32 v59, v81, v19, s54
v_mfma_f32_16x16x32_bf16 v[140:143], a[224:227], a[220:223], v[140:143]
s_waitcnt lgkmcnt(4)
ds_read_b32 a12, v59
v_perm_b32 v58, v81, v19, s55
v_mfma_f32_16x16x32_bf16 v[144:147], a[228:231], a[208:211], v[144:147]
ds_read_b128 a[236:239], v15 offset:2048
buffer_load_dwordx4 v11, s[20:23], 0 offen offset:1792 lds
v_mfma_f32_16x16x32_bf16 v[148:151], a[228:231], a[212:215], v[148:151]
ds_read_b32 a13, v58
v_perm_b32 v57, v85, v19, s54
v_mfma_f32_16x16x32_bf16 v[152:155], a[228:231], a[216:219], v[152:155]
s_waitcnt vmcnt(11)
v_cmp_ne_u64 s[50:51], s[88:89], v[90:91]
v_cmp_ne_u64 s[44:45], s[88:89], v[94:95]
v_mfma_f32_16x16x32_bf16 v[156:159], a[228:231], a[220:223], v[156:159]
s_waitcnt lgkmcnt(3)
ds_read_b32 a14, v57
v_mfma_f32_16x16x32_bf16 v[192:195], a[232:235], a[144:147], v[192:195]
s_or_b64 s[50:51], s[44:45], s[50:51]
ds_read_b128 a[240:243], v14 offset:4096
v_perm_b32 v56, v85, v19, s55
v_mfma_f32_16x16x32_bf16 v[196:199], a[232:235], a[148:151], v[196:199]
s_cbranch_scc1 L_SLOW29
L_BACK29:
v_mfma_f32_16x16x32_bf16 v[200:203], a[232:235], a[152:155], v[200:203]
ds_read_b32 a15, v56
v_perm_b32 v63, v88, v19, s52
v_mfma_f32_16x16x32_bf16 v[204:207], a[232:235], a[156:159], v[204:207]
s_waitcnt lgkmcnt(3)
ds_read_b32 a16, v63
v_mfma_f32_16x16x32_bf16 v[208:211], a[236:239], a[144:147], v[208:211]
ds_read_b128 a[244:247], v14 offset:6144
v_perm_b32 v62, v88, v19, s53
v_mfma_f32_16x16x32_bf16 v[212:215], a[236:239], a[148:151], v[212:215]
ds_read_b32 a17, v62
v_perm_b32 v61, v92, v19, s52
v_mfma_f32_16x16x32_bf16 v[216:219], a[236:239], a[152:155], v[216:219]
s_add_u32 m0, s33, 125056
ds_read_b32 a18, v61
v_perm_b32 v60, v92, v19, s53
v_mfma_f32_16x16x32_bf16 v[220:223], a[236:239], a[156:159], v[220:223]
s_waitcnt lgkmcnt(4)
ds_read_b32 a19, v60
v_perm_b32 v59, v88, v19, s54
v_mfma_f32_16x16x32_bf16 v[224:227], a[240:243], a[96:99], v[224:227]
ds_read_b128 a[248:251], v14 offset:8192
buffer_load_dwordx4 v11, s[20:23], 0 offen offset:1920 lds
v_mfma_f32_16x16x32_bf16 v[228:231], a[240:243], a[100:103], v[228:231]
ds_read_b32 a20, v59
v_perm_b32 v58, v88, v19, s55
v_mfma_f32_16x16x32_bf16 v[232:235], a[240:243], a[104:107], v[232:235]
ds_read_b32 a21, v58
v_perm_b32 v57, v92, v19, s54
v_mfma_f32_16x16x32_bf16 v[236:239], a[240:243], a[108:111], v[236:239]
s_waitcnt lgkmcnt(4)
ds_read_b32 a22, v57
v_mfma_f32_16x16x32_bf16 v[240:243], a[244:247], a[96:99], v[240:243]
ds_read_b128 a[252:255], v14 offset:10240
v_perm_b32 v56, v92, v19, s55
v_mfma_f32_16x16x32_bf16 v[244:247], a[244:247], a[100:103], v[244:247]
ds_read_b32 a23, v56
v_perm_b32 v63, v89, v19, s52
v_mfma_f32_16x16x32_bf16 v[248:251], a[244:247], a[104:107], v[248:251]
ds_read_b32 a24, v63
v_perm_b32 v62, v89, v19, s53
v_mfma_f32_16x16x32_bf16 v[252:255], a[244:247], a[108:111], v[252:255]
s_waitcnt lgkmcnt(4)
ds_read_b32 a25, v62
v_mfma_f32_16x16x32_bf16 v[128:131], a[248:251], a[0:3], v[128:131]
ds_read_b128 a[224:227], v14 offset:12288
v_perm_b32 v61, v93, v19, s52
v_mfma_f32_16x16x32_bf16 v[132:135], a[248:251], a[4:7], v[132:135]
ds_read_b32 a26, v61
v_perm_b32 v60, v93, v19, s53
v_mfma_f32_16x16x32_bf16 v[136:139], a[248:251], a[8:11], v[136:139]
ds_read_b32 a27, v60
v_perm_b32 v59, v89, v19, s54
v_mfma_f32_16x16x32_bf16 v[140:143], a[248:251], a[12:15], v[140:143]
s_waitcnt lgkmcnt(4)
ds_read_b32 a28, v59
v_mfma_f32_16x16x32_bf16 v[144:147], a[252:255], a[0:3], v[144:147]
ds_read_b128 a[228:231], v14 offset:14336
v_perm_b32 v58, v89, v19, s55
v_mfma_f32_16x16x32_bf16 v[148:151], a[252:255], a[4:7], v[148:151]
ds_read_b32 a29, v58
v_perm_b32 v57, v93, v19, s54
v_mfma_f32_16x16x32_bf16 v[152:155], a[252:255], a[8:11], v[152:155]
ds_read_b32 a30, v57
v_mfma_f32_16x16x32_bf16 v[156:159], a[252:255], a[12:15], v[156:159]
s_waitcnt vmcnt(8) lgkmcnt(4)
v_cmp_ne_u64 s[50:51], s[88:89], v[34:35]
v_cmp_ne_u64 s[44:45], s[88:89], v[38:39]
v_mfma_f32_16x16x32_bf16 v[160:163], a[224:227], a[192:195], v[160:163]
ds_read_b128 a[232:235], v15 offset:8192
v_perm_b32 v56, v93, v19, s55
v_mfma_f32_16x16x32_bf16 v[164:167], a[224:227], a[196:199], v[164:167]
s_or_b64 s[50:51], s[44:45], s[50:51]
ds_read_b32 a31, v56
v_mfma_f32_16x16x32_bf16 v[168:171], a[224:227], a[200:203], v[168:171]
s_cbranch_scc1 L_SLOW30
L_BACK30:
v_mfma_f32_16x16x32_bf16 v[172:175], a[224:227], a[204:207], v[172:175]
s_waitcnt lgkmcnt(2)
v_mfma_f32_16x16x32_bf16 v[176:179], a[228:231], a[192:195], v[176:179]
ds_read_b128 a[236:239], v15 offset:10240
v_mfma_f32_16x16x32_bf16 v[180:183], a[228:231], a[196:199], v[180:183]
v_perm_b32 v63, v32, v19, s52
v_mfma_f32_16x16x32_bf16 v[184:187], a[228:231], a[200:203], v[184:187]
ds_read_b32 a32, v63
v_perm_b32 v62, v32, v19, s53
v_mfma_f32_16x16x32_bf16 v[188:191], a[228:231], a[204:207], v[188:191]
s_waitcnt lgkmcnt(2)
ds_read_b32 a33, v62
v_mfma_f32_16x16x32_bf16 v[128:131], a[232:235], a[16:19], v[128:131]
ds_read_b128 a[240:243], v15 offset:12288
v_perm_b32 v61, v36, v19, s52
v_mfma_f32_16x16x32_bf16 v[132:135], a[232:235], a[20:23], v[132:135]
ds_read_b32 a34, v61
v_perm_b32 v60, v36, v19, s53
v_mfma_f32_16x16x32_bf16 v[136:139], a[232:235], a[24:27], v[136:139]
ds_read_b32 a35, v60
v_perm_b32 v59, v32, v19, s54
v_mfma_f32_16x16x32_bf16 v[140:143], a[232:235], a[28:31], v[140:143]
s_waitcnt lgkmcnt(4)
ds_read_b32 a36, v59
v_mfma_f32_16x16x32_bf16 v[144:147], a[236:239], a[16:19], v[144:147]
ds_read_b128 a[244:247], v15 offset:14336
v_perm_b32 v58, v32, v19, s55
v_mfma_f32_16x16x32_bf16 v[148:151], a[236:239], a[20:23], v[148:151]
ds_read_b32 a37, v58
v_perm_b32 v57, v36, v19, s54
v_mfma_f32_16x16x32_bf16 v[152:155], a[236:239], a[24:27], v[152:155]
ds_read_b32 a38, v57
v_perm_b32 v56, v36, v19, s55
v_mfma_f32_16x16x32_bf16 v[156:159], a[236:239], a[28:31], v[156:159]
s_waitcnt lgkmcnt(4)
ds_read_b32 a39, v56
v_mfma_f32_16x16x32_bf16 v[160:163], a[240:243], a[208:211], v[160:163]
ds_read_b128 a[248:251], v14 offset:16384
v_perm_b32 v63, v33, v19, s52
v_mfma_f32_16x16x32_bf16 v[164:167], a[240:243], a[212:215], v[164:167]
ds_read_b32 a40, v63
v_perm_b32 v62, v33, v19, s53
v_mfma_f32_16x16x32_bf16 v[168:171], a[240:243], a[216:219], v[168:171]
ds_read_b32 a41, v62
v_perm_b32 v61, v37, v19, s52
v_mfma_f32_16x16x32_bf16 v[172:175], a[240:243], a[220:223], v[172:175]
s_waitcnt lgkmcnt(4)
ds_read_b32 a42, v61
v_mfma_f32_16x16x32_bf16 v[176:179], a[244:247], a[208:211], v[176:179]
ds_read_b128 a[252:255], v14 offset:18432
v_perm_b32 v60, v37, v19, s53
v_mfma_f32_16x16x32_bf16 v[180:183], a[244:247], a[212:215], v[180:183]
ds_read_b32 a43, v60
v_perm_b32 v59, v33, v19, s54
v_mfma_f32_16x16x32_bf16 v[184:187], a[244:247], a[216:219], v[184:187]
ds_read_b32 a44, v59
v_perm_b32 v58, v33, v19, s55
v_mfma_f32_16x16x32_bf16 v[188:191], a[244:247], a[220:223], v[188:191]
s_waitcnt lgkmcnt(4)
ds_read_b32 a45, v58
v_mfma_f32_16x16x32_bf16 v[192:195], a[248:251], a[160:163], v[192:195]
s_barrier
ds_read_b128 a[224:227], v14 offset:20480
v_perm_b32 v57, v37, v19, s54
v_mfma_f32_16x16x32_bf16 v[196:199], a[248:251], a[164:167], v[196:199]
ds_read_b32 a46, v57
v_perm_b32 v56, v37, v19, s55
v_mfma_f32_16x16x32_bf16 v[200:203], a[248:251], a[168:171], v[200:203]
ds_read_b32 a47, v56
v_mfma_f32_16x16x32_bf16 v[204:207], a[248:251], a[172:175], v[204:207]
s_waitcnt lgkmcnt(4)
v_mfma_f32_16x16x32_bf16 v[208:211], a[252:255], a[160:163], v[208:211]
ds_read_b128 a[228:231], v14 offset:22528
v_mfma_f32_16x16x32_bf16 v[212:215], a[252:255], a[164:167], v[212:215]
v_mfma_f32_16x16x32_bf16 v[216:219], a[252:255], a[168:171], v[216:219]
v_mfma_f32_16x16x32_bf16 v[220:223], a[252:255], a[172:175], v[220:223]
s_waitcnt vmcnt(2) lgkmcnt(1)
v_cmp_ne_u64 s[50:51], s[88:89], v[42:43]
v_cmp_ne_u64 s[44:45], s[88:89], v[46:47]
v_mfma_f32_16x16x32_bf16 v[128:131], a[224:227], a[32:35], v[128:131]
ds_read_b128 a[232:235], v15 offset:4096
v_mfma_f32_16x16x32_bf16 v[132:135], a[224:227], a[36:39], v[132:135]
s_or_b64 s[50:51], s[44:45], s[50:51]
v_mfma_f32_16x16x32_bf16 v[136:139], a[224:227], a[40:43], v[136:139]
s_cbranch_scc1 L_SLOW31
L_BACK31:
v_mfma_f32_16x16x32_bf16 v[140:143], a[224:227], a[44:47], v[140:143]
s_waitcnt lgkmcnt(1)
v_mfma_f32_16x16x32_bf16 v[144:147], a[228:231], a[32:35], v[144:147]
ds_read_b128 a[236:239], v15 offset:6144
v_mfma_f32_16x16x32_bf16 v[148:151], a[228:231], a[36:39], v[148:151]
v_perm_b32 v63, v40, v19, s52
v_mfma_f32_16x16x32_bf16 v[152:155], a[228:231], a[40:43], v[152:155]
ds_read_b32 a48, v63
v_perm_b32 v62, v40, v19, s53
v_mfma_f32_16x16x32_bf16 v[156:159], a[228:231], a[44:47], v[156:159]
s_waitcnt lgkmcnt(2)
ds_read_b32 a49, v62
v_mfma_f32_16x16x32_bf16 v[224:227], a[232:235], a[112:115], v[224:227]
ds_read_b128 a[240:243], v14 offset:24576
v_perm_b32 v61, v44, v19, s52
v_mfma_f32_16x16x32_bf16 v[228:231], a[232:235], a[116:119], v[228:231]
ds_read_b32 a50, v61
v_perm_b32 v60, v44, v19, s53
v_mfma_f32_16x16x32_bf16 v[232:235], a[232:235], a[120:123], v[232:235]
ds_read_b32 a51, v60
v_perm_b32 v59, v40, v19, s54
v_mfma_f32_16x16x32_bf16 v[236:239], a[232:235], a[124:127], v[236:239]
s_waitcnt lgkmcnt(4)
ds_read_b32 a52, v59
v_mfma_f32_16x16x32_bf16 v[240:243], a[236:239], a[112:115], v[240:243]
ds_read_b128 a[244:247], v14 offset:26624
v_perm_b32 v58, v40, v19, s55
v_mfma_f32_16x16x32_bf16 v[244:247], a[236:239], a[116:119], v[244:247]
ds_read_b32 a53, v58
v_perm_b32 v57, v44, v19, s54
v_mfma_f32_16x16x32_bf16 v[248:251], a[236:239], a[120:123], v[248:251]
ds_read_b32 a54, v57
v_perm_b32 v56, v44, v19, s55
v_mfma_f32_16x16x32_bf16 v[252:255], a[236:239], a[124:127], v[252:255]
s_waitcnt lgkmcnt(4)
ds_read_b32 a55, v56
v_mfma_f32_16x16x32_bf16 v[160:163], a[240:243], a[0:3], v[160:163]
ds_read_b128 a[248:251], v15 offset:16384
v_perm_b32 v63, v41, v19, s52
v_mfma_f32_16x16x32_bf16 v[164:167], a[240:243], a[4:7], v[164:167]
ds_read_b32 a56, v63
v_perm_b32 v62, v41, v19, s53
v_mfma_f32_16x16x32_bf16 v[168:171], a[240:243], a[8:11], v[168:171]
ds_read_b32 a57, v62
v_perm_b32 v61, v45, v19, s52
v_mfma_f32_16x16x32_bf16 v[172:175], a[240:243], a[12:15], v[172:175]
s_waitcnt lgkmcnt(4)
ds_read_b32 a58, v61
v_mfma_f32_16x16x32_bf16 v[176:179], a[244:247], a[0:3], v[176:179]
ds_read_b128 a[252:255], v15 offset:18432
v_perm_b32 v60, v45, v19, s53
v_mfma_f32_16x16x32_bf16 v[180:183], a[244:247], a[4:7], v[180:183]
ds_read_b32 a59, v60
v_perm_b32 v59, v41, v19, s54
v_mfma_f32_16x16x32_bf16 v[184:187], a[244:247], a[8:11], v[184:187]
ds_read_b32 a60, v59
v_perm_b32 v58, v41, v19, s55
v_mfma_f32_16x16x32_bf16 v[188:191], a[244:247], a[12:15], v[188:191]
s_waitcnt lgkmcnt(4)
ds_read_b32 a61, v58
v_mfma_f32_16x16x32_bf16 v[192:195], a[248:251], a[176:179], v[192:195]
ds_read_b128 a[224:227], v15 offset:20480
v_perm_b32 v57, v45, v19, s54
v_mfma_f32_16x16x32_bf16 v[196:199], a[248:251], a[180:183], v[196:199]
ds_read_b32 a62, v57
v_perm_b32 v56, v45, v19, s55
v_mfma_f32_16x16x32_bf16 v[200:203], a[248:251], a[184:187], v[200:203]
ds_read_b32 a63, v56
v_mfma_f32_16x16x32_bf16 v[204:207], a[248:251], a[188:191], v[204:207]
s_waitcnt lgkmcnt(4)
v_mfma_f32_16x16x32_bf16 v[208:211], a[252:255], a[176:179], v[208:211]
ds_read_b128 a[228:231], v15 offset:22528
v_mfma_f32_16x16x32_bf16 v[212:215], a[252:255], a[180:183], v[212:215]
v_mfma_f32_16x16x32_bf16 v[216:219], a[252:255], a[184:187], v[216:219]
v_mfma_f32_16x16x32_bf16 v[220:223], a[252:255], a[188:191], v[220:223]
s_waitcnt lgkmcnt(1)
v_mfma_f32_16x16x32_bf16 v[128:131], a[224:227], a[48:51], v[128:131]
ds_read_b128 a[232:235], v15 offset:24576
v_mfma_f32_16x16x32_bf16 v[132:135], a[224:227], a[52:55], v[132:135]
v_mfma_f32_16x16x32_bf16 v[136:139], a[224:227], a[56:59], v[136:139]
v_mfma_f32_16x16x32_bf16 v[140:143], a[224:227], a[60:63], v[140:143]
s_waitcnt lgkmcnt(1)
v_mfma_f32_16x16x32_bf16 v[144:147], a[228:231], a[48:51], v[144:147]
ds_read_b128 a[236:239], v15 offset:26624
v_mfma_f32_16x16x32_bf16 v[148:151], a[228:231], a[52:55], v[148:151]
v_mfma_f32_16x16x32_bf16 v[152:155], a[228:231], a[56:59], v[152:155]
v_mfma_f32_16x16x32_bf16 v[156:159], a[228:231], a[60:63], v[156:159]
s_waitcnt lgkmcnt(1)
v_mfma_f32_16x16x32_bf16 v[160:163], a[232:235], a[16:19], v[160:163]
ds_read_b128 a[240:243], v14 offset:28672
v_mfma_f32_16x16x32_bf16 v[164:167], a[232:235], a[20:23], v[164:167]
L_PAD5:
s_cbranch_vccnz L_PADRET
v_mfma_f32_16x16x32_bf16 v[168:171], a[232:235], a[24:27], v[168:171]
v_mfma_f32_16x16x32_bf16 v[172:175], a[232:235], a[28:31], v[172:175]
s_waitcnt lgkmcnt(1)
v_mul_f32 v128, v128, v24
v_mul_f32 v132, v132, v25
v_mfma_f32_16x16x32_bf16 v[176:179], a[236:239], a[16:19], v[176:179]
s_waitcnt vmcnt(0)
s_barrier
ds_read_b128 a[244:247], v14 offset:30720
v_mul_f32 v136, v136, v26
v_mfma_f32_16x16x32_bf16 v[180:183], a[236:239], a[20:23], v[180:183]
v_mul_f32 v140, v140, v27
v_cvt_pk_bf16_f32 v120, v128, v132
v_mfma_f32_16x16x32_bf16 v[184:187], a[236:239], a[24:27], v[184:187]
v_cvt_pk_bf16_f32 v121, v136, v140
v_mfma_f32_16x16x32_bf16 v[188:191], a[236:239], a[28:31], v[188:191]
s_waitcnt lgkmcnt(1)
v_mfma_f32_16x16x32_bf16 v[192:195], a[240:243], a[192:195], v[192:195]
ds_read_b128 a[248:251], v14 offset:32768
v_mfma_f32_16x16x32_bf16 v[196:199], a[240:243], a[196:199], v[196:199]
buffer_store_dwordx2 v[120:121], v18, s[28:31], 0 offen nt
v_mul_f32 v129, v129, v24
v_mfma_f32_16x16x32_bf16 v[200:203], a[240:243], a[200:203], v[200:203]
s_add_u32 s28, s28, 7168
v_mul_f32 v133, v133, v25
v_mul_f32 v137, v137, v26
v_mfma_f32_16x16x32_bf16 v[204:207], a[240:243], a[204:207], v[204:207]
s_waitcnt lgkmcnt(1)
v_mul_f32 v141, v141, v27
v_cvt_pk_bf16_f32 v122, v129, v133
v_mfma_f32_16x16x32_bf16 v[208:211], a[244:247], a[192:195], v[208:211]
s_addc_u32 s29, s29, 0
ds_read_b128 a[252:255], v14 offset:34816
v_cvt_pk_bf16_f32 v123, v137, v141
v_mfma_f32_16x16x32_bf16 v[212:215], a[244:247], a[196:199], v[212:215]
buffer_store_dwordx2 v[122:123], v18, s[28:31], 0 offen nt
v_mul_f32 v130, v130, v24
v_mfma_f32_16x16x32_bf16 v[216:219], a[244:247], a[200:203], v[216:219]
s_add_u32 s28, s28, 7168
v_mul_f32 v134, v134, v25
v_mul_f32 v138, v138, v26
v_mfma_f32_16x16x32_bf16 v[220:223], a[244:247], a[204:207], v[220:223]
s_waitcnt lgkmcnt(1)
v_mul_f32 v142, v142, v27
v_cvt_pk_bf16_f32 v124, v130, v134
v_mfma_f32_16x16x32_bf16 v[224:227], a[248:251], a[128:131], v[224:227]
s_addc_u32 s29, s29, 0
ds_read_b128 a[224:227], v14 offset:36864
v_cvt_pk_bf16_f32 v125, v138, v142
v_mfma_f32_16x16x32_bf16 v[228:231], a[248:251], a[132:135], v[228:231]
buffer_store_dwordx2 v[124:125], v18, s[28:31], 0 offen nt
v_mul_f32 v131, v131, v24
v_mfma_f32_16x16x32_bf16 v[232:235], a[248:251], a[136:139], v[232:235]
s_add_u32 s28, s28, 7168
v_mul_f32 v135, v135, v25
v_mul_f32 v139, v139, v26
v_mfma_f32_16x16x32_bf16 v[236:239], a[248:251], a[140:143], v[236:239]
s_waitcnt lgkmcnt(1)
v_mul_f32 v143, v143, v27
v_cvt_pk_bf16_f32 v126, v131, v135
v_mfma_f32_16x16x32_bf16 v[240:243], a[252:255], a[128:131], v[240:243]
s_addc_u32 s29, s29, 0
ds_read_b128 a[228:231], v14 offset:38912
v_cvt_pk_bf16_f32 v127, v139, v143
v_mfma_f32_16x16x32_bf16 v[244:247], a[252:255], a[132:135], v[244:247]
buffer_store_dwordx2 v[126:127], v18, s[28:31], 0 offen nt
v_mul_f32 v144, v144, v24
v_mfma_f32_16x16x32_bf16 v[248:251], a[252:255], a[136:139], v[248:251]
s_add_u32 s28, s28, 93184
v_mul_f32 v148, v148, v25
v_mul_f32 v152, v152, v26
v_mfma_f32_16x16x32_bf16 v[252:255], a[252:255], a[140:143], v[252:255]
s_waitcnt lgkmcnt(1)
v_mul_f32 v156, v156, v27
v_cvt_pk_bf16_f32 v120, v144, v148
v_mfma_f32_16x16x32_bf16 v[160:163], a[224:227], a[32:35], v[160:163]
s_addc_u32 s29, s29, 0
ds_read_b128 a[232:235], v15 offset:28672
v_cvt_pk_bf16_f32 v121, v152, v156
v_mfma_f32_16x16x32_bf16 v[164:167], a[224:227], a[36:39], v[164:167]
buffer_store_dwordx2 v[120:121], v18, s[28:31], 0 offen nt
v_mul_f32 v145, v145, v24
v_mfma_f32_16x16x32_bf16 v[168:171], a[224:227], a[40:43], v[168:171]
s_add_u32 s28, s28, 7168
v_mul_f32 v149, v149, v25
v_mul_f32 v153, v153, v26
v_mfma_f32_16x16x32_bf16 v[172:175], a[224:227], a[44:47], v[172:175]
s_waitcnt lgkmcnt(1)
v_mul_f32 v157, v157, v27
v_cvt_pk_bf16_f32 v122, v145, v149
v_mfma_f32_16x16x32_bf16 v[176:179], a[228:231], a[32:35], v[176:179]
s_addc_u32 s29, s29, 0
ds_read_b128 a[236:239], v15 offset:30720
v_cvt_pk_bf16_f32 v123, v153, v157
v_mfma_f32_16x16x32_bf16 v[180:183], a[228:231], a[36:39], v[180:183]
buffer_store_dwordx2 v[122:123], v18, s[28:31], 0 offen nt
v_mul_f32 v146, v146, v24
v_mfma_f32_16x16x32_bf16 v[184:187], a[228:231], a[40:43], v[184:187]
s_add_u32 s28, s28, 7168
v_mul_f32 v150, v150, v25
v_mul_f32 v154, v154, v26
v_mfma_f32_16x16x32_bf16 v[188:191], a[228:231], a[44:47], v[188:191]
s_waitcnt lgkmcnt(1)
v_mul_f32 v158, v158, v27
v_cvt_pk_bf16_f32 v124, v146, v150
v_mfma_f32_16x16x32_bf16 v[192:195], a[232:235], a[208:211], v[192:195]
s_addc_u32 s29, s29, 0
ds_read_b128 a[240:243], v15 offset:36864
v_cvt_pk_bf16_f32 v125, v154, v158
v_mfma_f32_16x16x32_bf16 v[196:199], a[232:235], a[212:215], v[196:199]
buffer_store_dwordx2 v[124:125], v18, s[28:31], 0 offen nt
v_mul_f32 v147, v147, v24
v_mfma_f32_16x16x32_bf16 v[200:203], a[232:235], a[216:219], v[200:203]
s_add_u32 s28, s28, 7168
v_mul_f32 v151, v151, v25
v_mul_f32 v155, v155, v26
v_mfma_f32_16x16x32_bf16 v[204:207], a[232:235], a[220:223], v[204:207]
s_waitcnt lgkmcnt(1)
v_mul_f32 v159, v159, v27
v_cvt_pk_bf16_f32 v126, v147, v151
v_mfma_f32_16x16x32_bf16 v[208:211], a[236:239], a[208:211], v[208:211]
s_addc_u32 s29, s29, 0
ds_read_b128 a[244:247], v15 offset:38912
v_cvt_pk_bf16_f32 v127, v155, v159
v_mfma_f32_16x16x32_bf16 v[212:215], a[236:239], a[212:215], v[212:215]
buffer_store_dwordx2 v[126:127], v18, s[28:31], 0 offen nt
v_mfma_f32_16x16x32_bf16 v[216:219], a[236:239], a[216:219], v[216:219]
v_mfma_f32_16x16x32_bf16 v[220:223], a[236:239], a[220:223], v[220:223]
s_waitcnt lgkmcnt(1)
v_mfma_f32_16x16x32_bf16 v[160:163], a[240:243], a[48:51], v[160:163]
ds_read_b128 a[248:251], v15 offset:32768
v_mfma_f32_16x16x32_bf16 v[164:167], a[240:243], a[52:55], v[164:167]
v_mfma_f32_16x16x32_bf16 v[168:171], a[240:243], a[56:59], v[168:171]
v_mfma_f32_16x16x32_bf16 v[172:175], a[240:243], a[60:63], v[172:175]
s_waitcnt lgkmcnt(1)
v_mfma_f32_16x16x32_bf16 v[176:179], a[244:247], a[48:51], v[176:179]
ds_read_b128 a[252:255], v15 offset:34816
v_mfma_f32_16x16x32_bf16 v[180:183], a[244:247], a[52:55], v[180:183]
v_mfma_f32_16x16x32_bf16 v[184:187], a[244:247], a[56:59], v[184:187]
v_mfma_f32_16x16x32_bf16 v[188:191], a[244:247], a[60:63], v[188:191]
s_waitcnt lgkmcnt(1)
v_mfma_f32_16x16x32_bf16 v[224:227], a[248:251], a[144:147], v[224:227]
ds_read_b128 a[224:227], v14 offset:40960
v_mfma_f32_16x16x32_bf16 v[228:231], a[248:251], a[148:151], v[228:231]
v_mfma_f32_16x16x32_bf16 v[232:235], a[248:251], a[152:155], v[232:235]
v_mfma_f32_16x16x32_bf16 v[236:239], a[248:251], a[156:159], v[236:239]
s_waitcnt lgkmcnt(1)
v_mul_f32 v160, v160, v24
v_mul_f32 v164, v164, v25
v_mfma_f32_16x16x32_bf16 v[240:243], a[252:255], a[144:147], v[240:243]
s_add_u32 s28, s28, 93184
ds_read_b128 a[228:231], v14 offset:43008
v_mul_f32 v168, v168, v26
v_mfma_f32_16x16x32_bf16 v[244:247], a[252:255], a[148:151], v[244:247]
s_addc_u32 s29, s29, 0
v_mul_f32 v172, v172, v27
v_cvt_pk_bf16_f32 v120, v160, v164
v_mfma_f32_16x16x32_bf16 v[248:251], a[252:255], a[152:155], v[248:251]
v_cvt_pk_bf16_f32 v121, v168, v172
v_mfma_f32_16x16x32_bf16 v[252:255], a[252:255], a[156:159], v[252:255]
s_waitcnt lgkmcnt(1)
v_mfma_f32_16x16x32_bf16 v[192:195], a[224:227], a[0:3], v[192:195]
ds_read_b128 a[232:235], v15 offset:40960
v_mfma_f32_16x16x32_bf16 v[196:199], a[224:227], a[4:7], v[196:199]
buffer_store_dwordx2 v[120:121], v18, s[28:31], 0 offen nt
v_mul_f32 v161, v161, v24
v_mfma_f32_16x16x32_bf16 v[200:203], a[224:227], a[8:11], v[200:203]
s_add_u32 s28, s28, 7168
v_mul_f32 v165, v165, v25
v_mul_f32 v169, v169, v26
v_mfma_f32_16x16x32_bf16 v[204:207], a[224:227], a[12:15], v[204:207]
s_waitcnt lgkmcnt(1)
v_mul_f32 v173, v173, v27
v_cvt_pk_bf16_f32 v122, v161, v165
v_mfma_f32_16x16x32_bf16 v[208:211], a[228:231], a[0:3], v[208:211]
s_addc_u32 s29, s29, 0
ds_read_b128 a[236:239], v15 offset:43008
v_cvt_pk_bf16_f32 v123, v169, v173
v_mfma_f32_16x16x32_bf16 v[212:215], a[228:231], a[4:7], v[212:215]
buffer_store_dwordx2 v[122:123], v18, s[28:31], 0 offen nt
v_mul_f32 v162, v162, v24
v_mfma_f32_16x16x32_bf16 v[216:219], a[228:231], a[8:11], v[216:219]
s_add_u32 s28, s28, 7168
v_mul_f32 v166, v166, v25
v_mul_f32 v170, v170, v26
v_mfma_f32_16x16x32_bf16 v[220:223], a[228:231], a[12:15], v[220:223]
s_waitcnt lgkmcnt(1)
v_mul_f32 v174, v174, v27
v_cvt_pk_bf16_f32 v124, v162, v166
v_mfma_f32_16x16x32_bf16 v[192:195], a[232:235], a[16:19], v[192:195]
s_addc_u32 s29, s29, 0
ds_read_b128 a[240:243], v14 offset:45056
v_cvt_pk_bf16_f32 v125, v170, v174
v_mfma_f32_16x16x32_bf16 v[196:199], a[232:235], a[20:23], v[196:199]
buffer_store_dwordx2 v[124:125], v18, s[28:31], 0 offen nt
v_mul_f32 v163, v163, v24
v_mfma_f32_16x16x32_bf16 v[200:203], a[232:235], a[24:27], v[200:203]
s_add_u32 s28, s28, 7168
v_mul_f32 v167, v167, v25
v_mul_f32 v171, v171, v26
v_mfma_f32_16x16x32_bf16 v[204:207], a[232:235], a[28:31], v[204:207]
s_waitcnt lgkmcnt(1)
v_mul_f32 v175, v175, v27
v_cvt_pk_bf16_f32 v126, v163, v167
v_mfma_f32_16x16x32_bf16 v[208:211], a[236:239], a[16:19], v[208:211]
s_addc_u32 s29, s29, 0
ds_read_b128 a[244:247], v14 offset:47104
v_cvt_pk_bf16_f32 v127, v171, v175
v_mfma_f32_16x16x32_bf16 v[212:215], a[236:239], a[20:23], v[212:215]
buffer_store_dwordx2 v[126:127], v18, s[28:31], 0 offen nt
v_mul_f32 v176, v176, v24
v_mfma_f32_16x16x32_bf16 v[216:219], a[236:239], a[24:27], v[216:219]
s_add_u32 s28, s28, 93184
v_mul_f32 v180, v180, v25
v_mul_f32 v184, v184, v26
v_mfma_f32_16x16x32_bf16 v[220:223], a[236:239], a[28:31], v[220:223]
s_waitcnt lgkmcnt(1)
v_mul_f32 v188, v188, v27
v_cvt_pk_bf16_f32 v120, v176, v180
v_mfma_f32_16x16x32_bf16 v[224:227], a[240:243], a[160:163], v[224:227]
s_addc_u32 s29, s29, 0
ds_read_b128 a[248:251], v14 offset:49152
v_cvt_pk_bf16_f32 v121, v184, v188
v_mfma_f32_16x16x32_bf16 v[228:231], a[240:243], a[164:167], v[228:231]
buffer_store_dwordx2 v[120:121], v18, s[28:31], 0 offen nt
v_mul_f32 v177, v177, v24
v_mfma_f32_16x16x32_bf16 v[232:235], a[240:243], a[168:171], v[232:235]
s_add_u32 s28, s28, 7168
v_mul_f32 v181, v181, v25
v_mul_f32 v185, v185, v26
v_mfma_f32_16x16x32_bf16 v[236:239], a[240:243], a[172:175], v[236:239]
s_waitcnt lgkmcnt(1)
v_mul_f32 v189, v189, v27
v_cvt_pk_bf16_f32 v122, v177, v181
v_mfma_f32_16x16x32_bf16 v[240:243], a[244:247], a[160:163], v[240:243]
s_addc_u32 s29, s29, 0
ds_read_b128 a[252:255], v14 offset:51200
v_cvt_pk_bf16_f32 v123, v185, v189
v_mfma_f32_16x16x32_bf16 v[244:247], a[244:247], a[164:167], v[244:247]
buffer_store_dwordx2 v[122:123], v18, s[28:31], 0 offen nt
v_mul_f32 v178, v178, v24
v_mfma_f32_16x16x32_bf16 v[248:251], a[244:247], a[168:171], v[248:251]
s_add_u32 s28, s28, 7168
v_mul_f32 v182, v182, v25
v_mul_f32 v186, v186, v26
v_mfma_f32_16x16x32_bf16 v[252:255], a[244:247], a[172:175], v[252:255]
s_waitcnt lgkmcnt(1)
v_mul_f32 v190, v190, v27
v_cvt_pk_bf16_f32 v124, v178, v182
v_mfma_f32_16x16x32_bf16 v[192:195], a[248:251], a[32:35], v[192:195]
s_addc_u32 s29, s29, 0
ds_read_b128 a[224:227], v15 offset:45056
v_cvt_pk_bf16_f32 v125, v186, v190
v_mfma_f32_16x16x32_bf16 v[196:199], a[248:251], a[36:39], v[196:199]
buffer_store_dwordx2 v[124:125], v18, s[28:31], 0 offen nt
v_mul_f32 v179, v179, v24
v_mfma_f32_16x16x32_bf16 v[200:203], a[248:251], a[40:43], v[200:203]
s_add_u32 s28, s28, 7168
v_mul_f32 v183, v183, v25
v_mul_f32 v187, v187, v26
v_mfma_f32_16x16x32_bf16 v[204:207], a[248:251], a[44:47], v[204:207]
s_waitcnt lgkmcnt(1)
v_mul_f32 v191, v191, v27
v_cvt_pk_bf16_f32 v126, v179, v183
v_mfma_f32_16x16x32_bf16 v[208:211], a[252:255], a[32:35], v[208:211]
s_addc_u32 s29, s29, 0
ds_read_b128 a[228:231], v15 offset:47104
v_cvt_pk_bf16_f32 v127, v187, v191
v_mfma_f32_16x16x32_bf16 v[212:215], a[252:255], a[36:39], v[212:215]
buffer_store_dwordx2 v[126:127], v18, s[28:31], 0 offen nt
v_mfma_f32_16x16x32_bf16 v[216:219], a[252:255], a[40:43], v[216:219]
v_mfma_f32_16x16x32_bf16 v[220:223], a[252:255], a[44:47], v[220:223]
s_waitcnt lgkmcnt(1)
v_mfma_f32_16x16x32_bf16 v[224:227], a[224:227], a[176:179], v[224:227]
ds_read_b128 a[232:235], v15 offset:49152
v_mfma_f32_16x16x32_bf16 v[228:231], a[224:227], a[180:183], v[228:231]
v_mfma_f32_16x16x32_bf16 v[232:235], a[224:227], a[184:187], v[232:235]
v_mfma_f32_16x16x32_bf16 v[236:239], a[224:227], a[188:191], v[236:239]
s_waitcnt lgkmcnt(1)
v_mfma_f32_16x16x32_bf16 v[240:243], a[228:231], a[176:179], v[240:243]
ds_read_b128 a[236:239], v15 offset:51200
v_mfma_f32_16x16x32_bf16 v[244:247], a[228:231], a[180:183], v[244:247]
v_mfma_f32_16x16x32_bf16 v[248:251], a[228:231], a[184:187], v[248:251]
v_mfma_f32_16x16x32_bf16 v[252:255], a[228:231], a[188:191], v[252:255]
s_waitcnt lgkmcnt(1)
v_mfma_f32_16x16x32_bf16 v[192:195], a[232:235], a[48:51], v[192:195]
ds_read_b128 a[240:243], v14 offset:53248
v_mfma_f32_16x16x32_bf16 v[196:199], a[232:235], a[52:55], v[196:199]
v_mfma_f32_16x16x32_bf16 v[200:203], a[232:235], a[56:59], v[200:203]
v_mfma_f32_16x16x32_bf16 v[204:207], a[232:235], a[60:63], v[204:207]
s_waitcnt lgkmcnt(1)
v_mfma_f32_16x16x32_bf16 v[208:211], a[236:239], a[48:51], v[208:211]
ds_read_b128 a[244:247], v14 offset:55296
v_mfma_f32_16x16x32_bf16 v[212:215], a[236:239], a[52:55], v[212:215]
v_mfma_f32_16x16x32_bf16 v[216:219], a[236:239], a[56:59], v[216:219]
v_mfma_f32_16x16x32_bf16 v[220:223], a[236:239], a[60:63], v[220:223]
s_waitcnt lgkmcnt(1)
v_mfma_f32_16x16x32_bf16 v[224:227], a[240:243], a[192:195], v[224:227]
ds_read_b128 a[248:251], v15 offset:53248
v_mfma_f32_16x16x32_bf16 v[228:231], a[240:243], a[196:199], v[228:231]
v_mfma_f32_16x16x32_bf16 v[232:235], a[240:243], a[200:203], v[232:235]
v_mfma_f32_16x16x32_bf16 v[236:239], a[240:243], a[204:207], v[236:239]
s_waitcnt lgkmcnt(1)
v_mul_f32 v192, v192, v24
v_mul_f32 v196, v196, v25
v_mfma_f32_16x16x32_bf16 v[240:243], a[244:247], a[192:195], v[240:243]
s_add_u32 s28, s28, 93184
ds_read_b128 a[252:255], v15 offset:55296
v_mul_f32 v200, v200, v26
v_mfma_f32_16x16x32_bf16 v[244:247], a[244:247], a[196:199], v[244:247]
s_addc_u32 s29, s29, 0
v_mul_f32 v204, v204, v27
v_cvt_pk_bf16_f32 v120, v192, v196
v_mfma_f32_16x16x32_bf16 v[248:251], a[244:247], a[200:203], v[248:251]
v_cvt_pk_bf16_f32 v121, v200, v204
v_mfma_f32_16x16x32_bf16 v[252:255], a[244:247], a[204:207], v[252:255]
s_waitcnt lgkmcnt(1)
v_mfma_f32_16x16x32_bf16 v[224:227], a[248:251], a[208:211], v[224:227]
ds_read_b128 a[224:227], v14 offset:57344
v_mfma_f32_16x16x32_bf16 v[228:231], a[248:251], a[212:215], v[228:231]
buffer_store_dwordx2 v[120:121], v18, s[28:31], 0 offen nt
v_mul_f32 v193, v193, v24
v_mfma_f32_16x16x32_bf16 v[232:235], a[248:251], a[216:219], v[232:235]
s_add_u32 s28, s28, 7168
v_mul_f32 v197, v197, v25
v_mul_f32 v201, v201, v26
v_mfma_f32_16x16x32_bf16 v[236:239], a[248:251], a[220:223], v[236:239]
s_waitcnt lgkmcnt(1)
v_mul_f32 v205, v205, v27
v_cvt_pk_bf16_f32 v122, v193, v197
v_mfma_f32_16x16x32_bf16 v[240:243], a[252:255], a[208:211], v[240:243]
s_addc_u32 s29, s29, 0
ds_read_b128 a[228:231], v14 offset:59392
v_cvt_pk_bf16_f32 v123, v201, v205
v_mfma_f32_16x16x32_bf16 v[244:247], a[252:255], a[212:215], v[244:247]
buffer_store_dwordx2 v[122:123], v18, s[28:31], 0 offen nt
v_mul_f32 v194, v194, v24
v_mfma_f32_16x16x32_bf16 v[248:251], a[252:255], a[216:219], v[248:251]
s_add_u32 s28, s28, 7168
v_mul_f32 v198, v198, v25
v_mul_f32 v202, v202, v26
v_mfma_f32_16x16x32_bf16 v[252:255], a[252:255], a[220:223], v[252:255]
s_waitcnt lgkmcnt(1)
v_mul_f32 v206, v206, v27
v_cvt_pk_bf16_f32 v124, v194, v198
v_mfma_f32_16x16x32_bf16 v[224:227], a[224:227], a[0:3], v[224:227]
s_addc_u32 s29, s29, 0
ds_read_b128 a[232:235], v15 offset:57344
v_cvt_pk_bf16_f32 v125, v202, v206
v_mfma_f32_16x16x32_bf16 v[228:231], a[224:227], a[4:7], v[228:231]
buffer_store_dwordx2 v[124:125], v18, s[28:31], 0 offen nt
v_mul_f32 v195, v195, v24
v_mfma_f32_16x16x32_bf16 v[232:235], a[224:227], a[8:11], v[232:235]
s_add_u32 s28, s28, 7168
v_mul_f32 v199, v199, v25
v_mul_f32 v203, v203, v26
v_mfma_f32_16x16x32_bf16 v[236:239], a[224:227], a[12:15], v[236:239]
s_waitcnt lgkmcnt(1)
v_mul_f32 v207, v207, v27
v_cvt_pk_bf16_f32 v126, v195, v199
v_mfma_f32_16x16x32_bf16 v[240:243], a[228:231], a[0:3], v[240:243]
s_addc_u32 s29, s29, 0
ds_read_b128 a[236:239], v15 offset:59392
v_cvt_pk_bf16_f32 v127, v203, v207
v_mfma_f32_16x16x32_bf16 v[244:247], a[228:231], a[4:7], v[244:247]
buffer_store_dwordx2 v[126:127], v18, s[28:31], 0 offen nt
v_mul_f32 v208, v208, v24
v_mfma_f32_16x16x32_bf16 v[248:251], a[228:231], a[8:11], v[248:251]
s_add_u32 s28, s28, 93184
v_mul_f32 v212, v212, v25
v_mul_f32 v216, v216, v26
v_mfma_f32_16x16x32_bf16 v[252:255], a[228:231], a[12:15], v[252:255]
s_waitcnt lgkmcnt(1)
v_mul_f32 v220, v220, v27
v_cvt_pk_bf16_f32 v120, v208, v212
v_mfma_f32_16x16x32_bf16 v[224:227], a[232:235], a[16:19], v[224:227]
s_addc_u32 s29, s29, 0
ds_read_b128 a[240:243], v14 offset:61440
v_cvt_pk_bf16_f32 v121, v216, v220
v_mfma_f32_16x16x32_bf16 v[228:231], a[232:235], a[20:23], v[228:231]
buffer_store_dwordx2 v[120:121], v18, s[28:31], 0 offen nt
v_mul_f32 v209, v209, v24
v_mfma_f32_16x16x32_bf16 v[232:235], a[232:235], a[24:27], v[232:235]
s_add_u32 s28, s28, 7168
v_mul_f32 v213, v213, v25
v_mul_f32 v217, v217, v26
v_mfma_f32_16x16x32_bf16 v[236:239], a[232:235], a[28:31], v[236:239]
s_waitcnt lgkmcnt(1)
v_mul_f32 v221, v221, v27
v_cvt_pk_bf16_f32 v122, v209, v213
v_mfma_f32_16x16x32_bf16 v[240:243], a[236:239], a[16:19], v[240:243]
s_addc_u32 s29, s29, 0
ds_read_b128 a[244:247], v14 offset:63488
v_cvt_pk_bf16_f32 v123, v217, v221
v_mfma_f32_16x16x32_bf16 v[244:247], a[236:239], a[20:23], v[244:247]
buffer_store_dwordx2 v[122:123], v18, s[28:31], 0 offen nt
v_mul_f32 v210, v210, v24
v_mfma_f32_16x16x32_bf16 v[248:251], a[236:239], a[24:27], v[248:251]
s_add_u32 s28, s28, 7168
v_mul_f32 v214, v214, v25
v_mul_f32 v218, v218, v26
v_mfma_f32_16x16x32_bf16 v[252:255], a[236:239], a[28:31], v[252:255]
s_waitcnt lgkmcnt(1)
v_mul_f32 v222, v222, v27
v_cvt_pk_bf16_f32 v124, v210, v214
v_mfma_f32_16x16x32_bf16 v[224:227], a[240:243], a[32:35], v[224:227]
s_addc_u32 s29, s29, 0
ds_read_b128 a[248:251], v15 offset:61440
v_cvt_pk_bf16_f32 v125, v218, v222
v_mfma_f32_16x16x32_bf16 v[228:231], a[240:243], a[36:39], v[228:231]
buffer_store_dwordx2 v[124:125], v18, s[28:31], 0 offen nt
v_mul_f32 v211, v211, v24
v_mfma_f32_16x16x32_bf16 v[232:235], a[240:243], a[40:43], v[232:235]
s_add_u32 s28, s28, 7168
v_mul_f32 v215, v215, v25
v_mul_f32 v219, v219, v26
v_mfma_f32_16x16x32_bf16 v[236:239], a[240:243], a[44:47], v[236:239]
s_waitcnt lgkmcnt(1)
v_mul_f32 v223, v223, v27
v_cvt_pk_bf16_f32 v126, v211, v215
v_mfma_f32_16x16x32_bf16 v[240:243], a[244:247], a[32:35], v[240:243]
s_addc_u32 s29, s29, 0
ds_read_b128 a[252:255], v15 offset:63488
v_cvt_pk_bf16_f32 v127, v219, v223
v_mfma_f32_16x16x32_bf16 v[244:247], a[244:247], a[36:39], v[244:247]
buffer_store_dwordx2 v[126:127], v18, s[28:31], 0 offen nt
v_mfma_f32_16x16x32_bf16 v[248:251], a[244:247], a[40:43], v[248:251]
v_mfma_f32_16x16x32_bf16 v[252:255], a[244:247], a[44:47], v[252:255]
s_waitcnt lgkmcnt(1)
v_mfma_f32_16x16x32_bf16 v[224:227], a[248:251], a[48:51], v[224:227]
v_mfma_f32_16x16x32_bf16 v[228:231], a[248:251], a[52:55], v[228:231]
v_mfma_f32_16x16x32_bf16 v[232:235], a[248:251], a[56:59], v[232:235]
v_mfma_f32_16x16x32_bf16 v[236:239], a[248:251], a[60:63], v[236:239]
s_waitcnt lgkmcnt(0)
v_mfma_f32_16x16x32_bf16 v[240:243], a[252:255], a[48:51], v[240:243]
v_mfma_f32_16x16x32_bf16 v[244:247], a[252:255], a[52:55], v[244:247]
v_mfma_f32_16x16x32_bf16 v[248:251], a[252:255], a[56:59], v[248:251]
v_mfma_f32_16x16x32_bf16 v[252:255], a[252:255], a[60:63], v[252:255]
s_nop 7
v_pk_mul_f32 v[224:225], v[224:225], v[24:25] op_sel:[0,0] op_sel_hi:[1,0]
v_pk_mul_f32 v[228:229], v[228:229], v[24:25] op_sel:[0,1] op_sel_hi:[1,1]
v_pk_mul_f32 v[232:233], v[232:233], v[26:27] op_sel:[0,0] op_sel_hi:[1,0]
v_pk_mul_f32 v[236:237], v[236:237], v[26:27] op_sel:[0,1] op_sel_hi:[1,1]
v_cvt_pk_bf16_f32 v120, v224, v228
v_cvt_pk_bf16_f32 v121, v232, v236
s_add_u32 s28, s28, 93184
s_addc_u32 s29, s29, 0
buffer_store_dwordx2 v[120:121], v18, s[28:31], 0 offen nt
v_cvt_pk_bf16_f32 v122, v225, v229
v_cvt_pk_bf16_f32 v123, v233, v237
s_add_u32 s28, s28, 7168
s_addc_u32 s29, s29, 0
buffer_store_dwordx2 v[122:123], v18, s[28:31], 0 offen nt
v_pk_mul_f32 v[226:227], v[226:227], v[24:25] op_sel:[0,0] op_sel_hi:[1,0]
v_pk_mul_f32 v[230:231], v[230:231], v[24:25] op_sel:[0,1] op_sel_hi:[1,1]
v_pk_mul_f32 v[234:235], v[234:235], v[26:27] op_sel:[0,0] op_sel_hi:[1,0]
v_pk_mul_f32 v[238:239], v[238:239], v[26:27] op_sel:[0,1] op_sel_hi:[1,1]
v_cvt_pk_bf16_f32 v124, v226, v230
v_cvt_pk_bf16_f32 v125, v234, v238
s_add_u32 s28, s28, 7168
s_addc_u32 s29, s29, 0
buffer_store_dwordx2 v[124:125], v18, s[28:31], 0 offen nt
v_cvt_pk_bf16_f32 v126, v227, v231
v_cvt_pk_bf16_f32 v127, v235, v239
s_add_u32 s28, s28, 7168
s_addc_u32 s29, s29, 0
buffer_store_dwordx2 v[126:127], v18, s[28:31], 0 offen nt
v_pk_mul_f32 v[240:241], v[240:241], v[24:25] op_sel:[0,0] op_sel_hi:[1,0]
v_pk_mul_f32 v[244:245], v[244:245], v[24:25] op_sel:[0,1] op_sel_hi:[1,1]
v_pk_mul_f32 v[248:249], v[248:249], v[26:27] op_sel:[0,0] op_sel_hi:[1,0]
v_pk_mul_f32 v[252:253], v[252:253], v[26:27] op_sel:[0,1] op_sel_hi:[1,1]
v_cvt_pk_bf16_f32 v120, v240, v244
v_cvt_pk_bf16_f32 v121, v248, v252
s_add_u32 s28, s28, 93184
s_addc_u32 s29, s29, 0
buffer_store_dwordx2 v[120:121], v18, s[28:31], 0 offen nt
v_cvt_pk_bf16_f32 v122, v241, v245
v_cvt_pk_bf16_f32 v123, v249, v253
s_add_u32 s28, s28, 7168
s_addc_u32 s29, s29, 0
buffer_store_dwordx2 v[122:123], v18, s[28:31], 0 offen nt
v_pk_mul_f32 v[242:243], v[242:243], v[24:25] op_sel:[0,0] op_sel_hi:[1,0]
v_pk_mul_f32 v[246:247], v[246:247], v[24:25] op_sel:[0,1] op_sel_hi:[1,1]
v_pk_mul_f32 v[250:251], v[250:251], v[26:27] op_sel:[0,0] op_sel_hi:[1,0]
v_pk_mul_f32 v[254:255], v[254:255], v[26:27] op_sel:[0,1] op_sel_hi:[1,1]
v_cvt_pk_bf16_f32 v124, v242, v246
v_cvt_pk_bf16_f32 v125, v250, v254
s_add_u32 s28, s28, 7168
s_addc_u32 s29, s29, 0
buffer_store_dwordx2 v[124:125], v18, s[28:31], 0 offen nt
v_cvt_pk_bf16_f32 v126, v243, v247
v_cvt_pk_bf16_f32 v127, v251, v255
s_add_u32 s28, s28, 7168
s_addc_u32 s29, s29, 0
buffer_store_dwordx2 v[126:127], v18, s[28:31], 0 offen nt
s_endpgm
L_NOTAG:
buffer_load_dwordx2 v[22:23], off, s[80:83], 0 sc1
s_waitcnt vmcnt(0)
v_readfirstlane_b32 s88, v22
v_readfirstlane_b32 s89, v23
s_sub_u32 s90, s90, 1
s_nop 0
s_cmp_eq_u64 s[88:89], 0
s_cbranch_scc0 L_TAGOK
s_cmp_gt_i32 s90, 0
s_cbranch_scc1 L_NOTAG
s_mov_b32 s26, 0
s_mov_b32 s78, 0
s_mov_b32 s86, 0
s_mov_b64 s[88:89], 1
s_branch L_TAGOK
L_SLOW0:
s_lshr_b32 s47, s40, 6
s_add_u32 s47, s47, 1
s_lshl_b32 s47, s47, 11
buffer_load_dwordx4 v[40:43], v13, s[24:27], s47 offen offset:0 sc1
buffer_load_dwordx4 v[44:47], v13, s[24:27], s47 offen offset:1024 sc1
s_lshr_b32 s91, s40, 6
s_add_u32 s91, s91, 0
s_call_b64 s[100:101], L_WAIT
v_mov_b64 v[32:33], v[120:121]
v_mov_b64 v[36:37], v[124:125]
s_branch L_BACK0
L_SLOW1:
s_lshr_b32 s47, s41, 6
s_add_u32 s47, s47, 0
s_lshl_b32 s47, s47, 11
buffer_load_dwordx4 v[48:51], v13, s[24:27], s47 offen offset:0 sc1
buffer_load_dwordx4 v[52:55], v13, s[24:27], s47 offen offset:1024 sc1
s_lshr_b32 s91, s40, 6
s_add_u32 s91, s91, 1
s_call_b64 s[100:101], L_WAIT
v_mov_b64 v[40:41], v[120:121]
v_mov_b64 v[44:45], v[124:125]
s_branch L_BACK1
L_SLOW2:
s_lshr_b32 s47, s41, 6
s_add_u32 s47, s47, 1
s_lshl_b32 s47, s47, 11
buffer_load_dwordx4 v[96:99], v13, s[24:27], s47 offen offset:0 sc1
buffer_load_dwordx4 v[100:103], v13, s[24:27], s47 offen offset:1024 sc1
s_lshr_b32 s47, s42, 6
s_add_u32 s47, s47, 0
s_lshl_b32 s47, s47, 11
buffer_load_dwordx4 v[80:83], v13, s[24:27], s47 offen offset:0 sc1
buffer_load_dwordx4 v[84:87], v13, s[24:27], s47 offen offset:1024 sc1
s_lshr_b32 s91, s41, 6
s_add_u32 s91, s91, 0
s_call_b64 s[100:101], L_WAIT
v_mov_b64 v[48:49], v[120:121]
v_mov_b64 v[52:53], v[124:125]
s_branch L_BACK2
L_SLOW3:
s_lshr_b32 s47, s42, 6
s_add_u32 s47, s47, 0
s_lshl_b32 s47, s47, 11
buffer_load_dwordx4 v[80:83], v13, s[24:27], s47 offen offset:0 sc1
buffer_load_dwordx4 v[84:87], v13, s[24:27], s47 offen offset:1024 sc1
s_lshr_b32 s47, s42, 6
s_add_u32 s47, s47, 1
s_lshl_b32 s47, s47, 11
buffer_load_dwordx4 v[88:91], v13, s[24:27], s47 offen offset:0 sc1
buffer_load_dwordx4 v[92:95], v13, s[24:27], s47 offen offset:1024 sc1
s_lshr_b32 s91, s41, 6
s_add_u32 s91, s91, 1
s_call_b64 s[100:101], L_WAIT
v_mov_b64 v[96:97], v[120:121]
v_mov_b64 v[100:101], v[124:125]
s_branch L_BACK3
L_SLOW4:
s_lshr_b32 s47, s42, 6
s_add_u32 s47, s47, 1
s_lshl_b32 s47, s47, 11
buffer_load_dwordx4 v[88:91], v13, s[24:27], s47 offen offset:0 sc1
buffer_load_dwordx4 v[92:95], v13, s[24:27], s47 offen offset:1024 sc1
s_lshr_b32 s47, s43, 6
s_add_u32 s47, s47, 0
s_lshl_b32 s47, s47, 11
buffer_load_dwordx4 v[32:35], v13, s[24:27], s47 offen offset:0 sc1
buffer_load_dwordx4 v[36:39], v13, s[24:27], s47 offen offset:1024 sc1
s_lshr_b32 s91, s42, 6
s_add_u32 s91, s91, 0
s_call_b64 s[100:101], L_WAIT
v_mov_b64 v[80:81], v[120:121]
v_mov_b64 v[84:85], v[124:125]
s_branch L_BACK4
L_SLOW5:
s_lshr_b32 s47, s43, 6
s_add_u32 s47, s47, 0
s_lshl_b32 s47, s47, 11
buffer_load_dwordx4 v[32:35], v13, s[24:27], s47 offen offset:0 sc1
buffer_load_dwordx4 v[36:39], v13, s[24:27], s47 offen offset:1024 sc1
s_lshr_b32 s47, s43, 6
s_add_u32 s47, s47, 1
s_lshl_b32 s47, s47, 11
buffer_load_dwordx4 v[40:43], v13, s[24:27], s47 offen offset:0 sc1
buffer_load_dwordx4 v[44:47], v13, s[24:27], s47 offen offset:1024 sc1
s_lshr_b32 s91, s42, 6
s_add_u32 s91, s91, 1
s_call_b64 s[100:101], L_WAIT
v_mov_b64 v[88:89], v[120:121]
v_mov_b64 v[92:93], v[124:125]
s_branch L_BACK5
L_SLOW6:
s_lshr_b32 s47, s43, 6
s_add_u32 s47, s47, 1
s_lshl_b32 s47, s47, 11
buffer_load_dwordx4 v[40:43], v13, s[24:27], s47 offen offset:0 sc1
buffer_load_dwordx4 v[44:47], v13, s[24:27], s47 offen offset:1024 sc1
s_movk_i32 s47, 8
s_lshl_b32 s47, s47, 11
buffer_load_dwordx4 v[48:51], v13, s[24:27], s47 offen offset:0 sc1
buffer_load_dwordx4 v[52:55], v13, s[24:27], s47 offen offset:1024 sc1
s_lshr_b32 s91, s43, 6
s_add_u32 s91, s91, 0
s_call_b64 s[100:101], L_WAIT
v_mov_b64 v[32:33], v[120:121]
v_mov_b64 v[36:37], v[124:125]
s_branch L_BACK6
L_SLOW7:
s_movk_i32 s47, 8
s_lshl_b32 s47, s47, 11
buffer_load_dwordx4 v[48:51], v13, s[24:27], s47 offen offset:0 sc1
buffer_load_dwordx4 v[52:55], v13, s[24:27], s47 offen offset:1024 sc1
s_movk_i32 s47, 9
s_lshl_b32 s47, s47, 11
buffer_load_dwordx4 v[96:99], v13, s[24:27], s47 offen offset:0 sc1
buffer_load_dwordx4 v[100:103], v13, s[24:27], s47 offen offset:1024 sc1
s_lshr_b32 s91, s43, 6
s_add_u32 s91, s91, 1
s_call_b64 s[100:101], L_WAIT
v_mov_b64 v[40:41], v[120:121]
v_mov_b64 v[44:45], v[124:125]
s_branch L_BACK7
L_SLOW8:
s_movk_i32 s47, 9
s_lshl_b32 s47, s47, 11
buffer_load_dwordx4 v[96:99], v13, s[24:27], s47 offen offset:0 sc1
buffer_load_dwordx4 v[100:103], v13, s[24:27], s47 offen offset:1024 sc1
s_movk_i32 s47, 10
s_lshl_b32 s47, s47, 11
buffer_load_dwordx4 v[80:83], v13, s[24:27], s47 offen offset:0 sc1
buffer_load_dwordx4 v[84:87], v13, s[24:27], s47 offen offset:1024 sc1
s_movk_i32 s91, 8
s_call_b64 s[100:101], L_WAIT
v_mov_b64 v[48:49], v[120:121]
v_mov_b64 v[52:53], v[124:125]
s_branch L_BACK8
L_SLOW9:
s_movk_i32 s47, 10
s_lshl_b32 s47, s47, 11
buffer_load_dwordx4 v[80:83], v13, s[24:27], s47 offen offset:0 sc1
buffer_load_dwordx4 v[84:87], v13, s[24:27], s47 offen offset:1024 sc1
s_movk_i32 s47, 11
s_lshl_b32 s47, s47, 11
buffer_load_dwordx4 v[88:91], v13, s[24:27], s47 offen offset:0 sc1
buffer_load_dwordx4 v[92:95], v13, s[24:27], s47 offen offset:1024 sc1
s_movk_i32 s91, 9
s_call_b64 s[100:101], L_WAIT
v_mov_b64 v[96:97], v[120:121]
v_mov_b64 v[100:101], v[124:125]
s_branch L_BACK9
L_SLOW10:
s_movk_i32 s47, 11
s_lshl_b32 s47, s47, 11
buffer_load_dwordx4 v[88:91], v13, s[24:27], s47 offen offset:0 sc1
buffer_load_dwordx4 v[92:95], v13, s[24:27], s47 offen offset:1024 sc1
s_movk_i32 s47, 12
s_lshl_b32 s47, s47, 11
buffer_load_dwordx4 v[32:35], v13, s[24:27], s47 offen offset:0 sc1
buffer_load_dwordx4 v[36:39], v13, s[24:27], s47 offen offset:1024 sc1
s_movk_i32 s91, 10
s_call_b64 s[100:101], L_WAIT
v_mov_b64 v[80:81], v[120:121]
v_mov_b64 v[84:85], v[124:125]
s_branch L_BACK10
L_SLOW11:
s_movk_i32 s47, 12
s_lshl_b32 s47, s47, 11
buffer_load_dwordx4 v[32:35], v13, s[24:27], s47 offen offset:0 sc1
buffer_load_dwordx4 v[36:39], v13, s[24:27], s47 offen offset:1024 sc1
s_movk_i32 s47, 13
s_lshl_b32 s47, s47, 11
buffer_load_dwordx4 v[40:43], v13, s[24:27], s47 offen offset:0 sc1
buffer_load_dwordx4 v[44:47], v13, s[24:27], s47 offen offset:1024 sc1
s_movk_i32 s91, 11
s_call_b64 s[100:101], L_WAIT
v_mov_b64 v[88:89], v[120:121]
v_mov_b64 v[92:93], v[124:125]
s_branch L_BACK11
L_SLOW12:
s_movk_i32 s47, 13
s_lshl_b32 s47, s47, 11
buffer_load_dwordx4 v[40:43], v13, s[24:27], s47 offen offset:0 sc1
buffer_load_dwordx4 v[44:47], v13, s[24:27], s47 offen offset:1024 sc1
s_movk_i32 s47, 14
s_lshl_b32 s47, s47, 11
buffer_load_dwordx4 v[48:51], v13, s[24:27], s47 offen offset:0 sc1
buffer_load_dwordx4 v[52:55], v13, s[24:27], s47 offen offset:1024 sc1
s_movk_i32 s91, 12
s_call_b64 s[100:101], L_WAIT
v_mov_b64 v[32:33], v[120:121]
v_mov_b64 v[36:37], v[124:125]
s_branch L_BACK12
L_SLOW13:
s_movk_i32 s47, 14
s_lshl_b32 s47, s47, 11
buffer_load_dwordx4 v[48:51], v13, s[24:27], s47 offen offset:0 sc1
buffer_load_dwordx4 v[52:55], v13, s[24:27], s47 offen offset:1024 sc1
s_movk_i32 s47, 15
s_lshl_b32 s47, s47, 11
buffer_load_dwordx4 v[96:99], v13, s[24:27], s47 offen offset:0 sc1
buffer_load_dwordx4 v[100:103], v13, s[24:27], s47 offen offset:1024 sc1
s_movk_i32 s91, 13
s_call_b64 s[100:101], L_WAIT
v_mov_b64 v[40:41], v[120:121]
v_mov_b64 v[44:45], v[124:125]
s_branch L_BACK13
L_SLOW14:
s_movk_i32 s47, 15
s_lshl_b32 s47, s47, 11
buffer_load_dwordx4 v[96:99], v13, s[24:27], s47 offen offset:0 sc1
buffer_load_dwordx4 v[100:103], v13, s[24:27], s47 offen offset:1024 sc1
s_movk_i32 s47, 16
s_lshl_b32 s47, s47, 11
buffer_load_dwordx4 v[80:83], v13, s[24:27], s47 offen offset:0 sc1
buffer_load_dwordx4 v[84:87], v13, s[24:27], s47 offen offset:1024 sc1
s_movk_i32 s91, 14
s_call_b64 s[100:101], L_WAIT
v_mov_b64 v[48:49], v[120:121]
v_mov_b64 v[52:53], v[124:125]
s_branch L_BACK14
L_SLOW15:
s_movk_i32 s47, 16
s_lshl_b32 s47, s47, 11
buffer_load_dwordx4 v[80:83], v13, s[24:27], s47 offen offset:0 sc1
buffer_load_dwordx4 v[84:87], v13, s[24:27], s47 offen offset:1024 sc1
s_movk_i32 s47, 17
s_lshl_b32 s47, s47, 11
buffer_load_dwordx4 v[88:91], v13, s[24:27], s47 offen offset:0 sc1
buffer_load_dwordx4 v[92:95], v13, s[24:27], s47 offen offset:1024 sc1
s_movk_i32 s91, 15
s_call_b64 s[100:101], L_WAIT
v_mov_b64 v[96:97], v[120:121]
v_mov_b64 v[100:101], v[124:125]
s_branch L_BACK15
L_SLOW16:
s_movk_i32 s47, 17
s_lshl_b32 s47, s47, 11
buffer_load_dwordx4 v[88:91], v13, s[24:27], s47 offen offset:0 sc1
buffer_load_dwordx4 v[92:95], v13, s[24:27], s47 offen offset:1024 sc1
s_movk_i32 s47, 18
s_lshl_b32 s47, s47, 11
buffer_load_dwordx4 v[32:35], v13, s[24:27], s47 offen offset:0 sc1
buffer_load_dwordx4 v[36:39], v13, s[24:27], s47 offen offset:1024 sc1
s_movk_i32 s91, 16
s_call_b64 s[100:101], L_WAIT
v_mov_b64 v[80:81], v[120:121]
v_mov_b64 v[84:85], v[124:125]
s_branch L_BACK16
L_SLOW17:
s_movk_i32 s47, 18
s_lshl_b32 s47, s47, 11
buffer_load_dwordx4 v[32:35], v13, s[24:27], s47 offen offset:0 sc1
buffer_load_dwordx4 v[36:39], v13, s[24:27], s47 offen offset:1024 sc1
s_movk_i32 s47, 19
s_lshl_b32 s47, s47, 11
buffer_load_dwordx4 v[40:43], v13, s[24:27], s47 offen offset:0 sc1
buffer_load_dwordx4 v[44:47], v13, s[24:27], s47 offen offset:1024 sc1
s_movk_i32 s91, 17
s_call_b64 s[100:101], L_WAIT
v_mov_b64 v[88:89], v[120:121]
v_mov_b64 v[92:93], v[124:125]
s_branch L_BACK17
L_SLOW18:
s_movk_i32 s47, 19
s_lshl_b32 s47, s47, 11
buffer_load_dwordx4 v[40:43], v13, s[24:27], s47 offen offset:0 sc1
buffer_load_dwordx4 v[44:47], v13, s[24:27], s47 offen offset:1024 sc1
s_movk_i32 s47, 20
s_lshl_b32 s47, s47, 11
buffer_load_dwordx4 v[48:51], v13, s[24:27], s47 offen offset:0 sc1
buffer_load_dwordx4 v[52:55], v13, s[24:27], s47 offen offset:1024 sc1
s_movk_i32 s91, 18
s_call_b64 s[100:101], L_WAIT
v_mov_b64 v[32:33], v[120:121]
v_mov_b64 v[36:37], v[124:125]
s_branch L_BACK18
L_SLOW19:
s_movk_i32 s47, 20
s_lshl_b32 s47, s47, 11
buffer_load_dwordx4 v[48:51], v13, s[24:27], s47 offen offset:0 sc1
buffer_load_dwordx4 v[52:55], v13, s[24:27], s47 offen offset:1024 sc1
s_movk_i32 s47, 21
s_lshl_b32 s47, s47, 11
buffer_load_dwordx4 v[96:99], v13, s[24:27], s47 offen offset:0 sc1
buffer_load_dwordx4 v[100:103], v13, s[24:27], s47 offen offset:1024 sc1
s_movk_i32 s91, 19
s_call_b64 s[100:101], L_WAIT
v_mov_b64 v[40:41], v[120:121]
v_mov_b64 v[44:45], v[124:125]
s_branch L_BACK19
L_SLOW20:
s_movk_i32 s47, 21
s_lshl_b32 s47, s47, 11
buffer_load_dwordx4 v[96:99], v13, s[24:27], s47 offen offset:0 sc1
buffer_load_dwordx4 v[100:103], v13, s[24:27], s47 offen offset:1024 sc1
s_movk_i32 s47, 22
s_lshl_b32 s47, s47, 11
buffer_load_dwordx4 v[80:83], v13, s[24:27], s47 offen offset:0 sc1
buffer_load_dwordx4 v[84:87], v13, s[24:27], s47 offen offset:1024 sc1
s_movk_i32 s91, 20
s_call_b64 s[100:101], L_WAIT
v_mov_b64 v[48:49], v[120:121]
v_mov_b64 v[52:53], v[124:125]
s_branch L_BACK20
L_SLOW21:
s_movk_i32 s47, 22
s_lshl_b32 s47, s47, 11
buffer_load_dwordx4 v[80:83], v13, s[24:27], s47 offen offset:0 sc1
buffer_load_dwordx4 v[84:87], v13, s[24:27], s47 offen offset:1024 sc1
s_movk_i32 s47, 23
s_lshl_b32 s47, s47, 11
buffer_load_dwordx4 v[88:91], v13, s[24:27], s47 offen offset:0 sc1
buffer_load_dwordx4 v[92:95], v13, s[24:27], s47 offen offset:1024 sc1
s_movk_i32 s91, 21
s_call_b64 s[100:101], L_WAIT
v_mov_b64 v[96:97], v[120:121]
v_mov_b64 v[100:101], v[124:125]
s_branch L_BACK21
L_SLOW22:
s_movk_i32 s47, 23
s_lshl_b32 s47, s47, 11
buffer_load_dwordx4 v[88:91], v13, s[24:27], s47 offen offset:0 sc1
buffer_load_dwordx4 v[92:95], v13, s[24:27], s47 offen offset:1024 sc1
s_movk_i32 s47, 24
s_lshl_b32 s47, s47, 11
buffer_load_dwordx4 v[32:35], v13, s[24:27], s47 offen offset:0 sc1
buffer_load_dwordx4 v[36:39], v13, s[24:27], s47 offen offset:1024 sc1
s_movk_i32 s91, 22
s_call_b64 s[100:101], L_WAIT
v_mov_b64 v[80:81], v[120:121]
v_mov_b64 v[84:85], v[124:125]
s_branch L_BACK22
L_SLOW23:
s_movk_i32 s47, 24
s_lshl_b32 s47, s47, 11
buffer_load_dwordx4 v[32:35], v13, s[24:27], s47 offen offset:0 sc1
buffer_load_dwordx4 v[36:39], v13, s[24:27], s47 offen offset:1024 sc1
s_movk_i32 s47, 25
s_lshl_b32 s47, s47, 11
buffer_load_dwordx4 v[40:43], v13, s[24:27], s47 offen offset:0 sc1
buffer_load_dwordx4 v[44:47], v13, s[24:27], s47 offen offset:1024 sc1
s_movk_i32 s91, 23
s_call_b64 s[100:101], L_WAIT
v_mov_b64 v[88:89], v[120:121]
v_mov_b64 v[92:93], v[124:125]
s_branch L_BACK23
L_SLOW24:
s_movk_i32 s47, 25
s_lshl_b32 s47, s47, 11
buffer_load_dwordx4 v[40:43], v13, s[24:27], s47 offen offset:0 sc1
buffer_load_dwordx4 v[44:47], v13, s[24:27], s47 offen offset:1024 sc1
s_movk_i32 s47, 26
s_lshl_b32 s47, s47, 11
buffer_load_dwordx4 v[48:51], v13, s[24:27], s47 offen offset:0 sc1
buffer_load_dwordx4 v[52:55], v13, s[24:27], s47 offen offset:1024 sc1
s_movk_i32 s91, 24
s_call_b64 s[100:101], L_WAIT
v_mov_b64 v[32:33], v[120:121]
v_mov_b64 v[36:37], v[124:125]
s_branch L_BACK24
L_SLOW25:
s_movk_i32 s47, 26
s_lshl_b32 s47, s47, 11
buffer_load_dwordx4 v[48:51], v13, s[24:27], s47 offen offset:0 sc1
buffer_load_dwordx4 v[52:55], v13, s[24:27], s47 offen offset:1024 sc1
s_movk_i32 s47, 27
s_lshl_b32 s47, s47, 11
buffer_load_dwordx4 v[96:99], v13, s[24:27], s47 offen offset:0 sc1
buffer_load_dwordx4 v[100:103], v13, s[24:27], s47 offen offset:1024 sc1
s_movk_i32 s91, 25
s_call_b64 s[100:101], L_WAIT
v_mov_b64 v[40:41], v[120:121]
v_mov_b64 v[44:45], v[124:125]
s_branch L_BACK25
L_SLOW26:
s_movk_i32 s47, 27
s_lshl_b32 s47, s47, 11
buffer_load_dwordx4 v[96:99], v13, s[24:27], s47 offen offset:0 sc1
buffer_load_dwordx4 v[100:103], v13, s[24:27], s47 offen offset:1024 sc1
s_movk_i32 s47, 28
s_lshl_b32 s47, s47, 11
buffer_load_dwordx4 v[80:83], v13, s[24:27], s47 offen offset:0 sc1
buffer_load_dwordx4 v[84:87], v13, s[24:27], s47 offen offset:1024 sc1
s_movk_i32 s91, 26
s_call_b64 s[100:101], L_WAIT
v_mov_b64 v[48:49], v[120:121]
v_mov_b64 v[52:53], v[124:125]
s_branch L_BACK26
L_SLOW27:
s_movk_i32 s47, 28
s_lshl_b32 s47, s47, 11
buffer_load_dwordx4 v[80:83], v13, s[24:27], s47 offen offset:0 sc1
buffer_load_dwordx4 v[84:87], v13, s[24:27], s47 offen offset:1024 sc1
s_movk_i32 s47, 29
s_lshl_b32 s47, s47, 11
buffer_load_dwordx4 v[88:91], v13, s[24:27], s47 offen offset:0 sc1
buffer_load_dwordx4 v[92:95], v13, s[24:27], s47 offen offset:1024 sc1
s_movk_i32 s91, 27
s_call_b64 s[100:101], L_WAIT
v_mov_b64 v[96:97], v[120:121]
v_mov_b64 v[100:101], v[124:125]
s_branch L_BACK27
L_SLOW28:
s_movk_i32 s47, 29
s_lshl_b32 s47, s47, 11
buffer_load_dwordx4 v[88:91], v13, s[24:27], s47 offen offset:0 sc1
buffer_load_dwordx4 v[92:95], v13, s[24:27], s47 offen offset:1024 sc1
s_movk_i32 s47, 30
s_lshl_b32 s47, s47, 11
buffer_load_dwordx4 v[32:35], v13, s[24:27], s47 offen offset:0 sc1
buffer_load_dwordx4 v[36:39], v13, s[24:27], s47 offen offset:1024 sc1
s_movk_i32 s91, 28
s_call_b64 s[100:101], L_WAIT
v_mov_b64 v[80:81], v[120:121]
v_mov_b64 v[84:85], v[124:125]
s_branch L_BACK28
L_SLOW29:
s_movk_i32 s47, 30
s_lshl_b32 s47, s47, 11
buffer_load_dwordx4 v[32:35], v13, s[24:27], s47 offen offset:0 sc1
buffer_load_dwordx4 v[36:39], v13, s[24:27], s47 offen offset:1024 sc1
s_movk_i32 s47, 31
s_lshl_b32 s47, s47, 11
buffer_load_dwordx4 v[40:43], v13, s[24:27], s47 offen offset:0 sc1
buffer_load_dwordx4 v[44:47], v13, s[24:27], s47 offen offset:1024 sc1
s_movk_i32 s91, 29
s_call_b64 s[100:101], L_WAIT
v_mov_b64 v[88:89], v[120:121]
v_mov_b64 v[92:93], v[124:125]
s_branch L_BACK29
L_SLOW30:
s_movk_i32 s47, 31
s_lshl_b32 s47, s47, 11
buffer_load_dwordx4 v[40:43], v13, s[24:27], s47 offen offset:0 sc1
buffer_load_dwordx4 v[44:47], v13, s[24:27], s47 offen offset:1024 sc1
s_movk_i32 s91, 30
s_call_b64 s[100:101], L_WAIT
v_mov_b64 v[32:33], v[120:121]
v_mov_b64 v[36:37], v[124:125]
s_branch L_BACK30
L_SLOW31:
s_movk_i32 s91, 31
s_call_b64 s[100:101], L_WAIT
v_mov_b64 v[40:41], v[120:121]
v_mov_b64 v[44:45], v[124:125]
s_branch L_BACK31
L_WAIT:
s_lshl_b32 s47, s91, 11
buffer_load_dwordx4 v[120:123], v13, s[24:27], s47 offen offset:0 sc1
buffer_load_dwordx4 v[124:127], v13, s[24:27], s47 offen offset:1024 sc1
s_waitcnt vmcnt(0)
v_cmp_ne_u64 s[50:51], s[88:89], v[122:123]
v_cmp_ne_u64 s[44:45], s[88:89], v[126:127]
s_sub_u32 s90, s90, 1
s_nop 0
s_or_b64 s[50:51], s[44:45], s[50:51]
s_cbranch_scc0 L_WRET
s_cmp_gt_i32 s90, 0
s_cbranch_scc1 L_WAIT
s_mul_i32 s47, s91, 458752
s_lshl_b32 s46, s39, 8
s_add_u32 s47, s47, s46
s_add_u32 s84, s6, s47
s_addc_u32 s85, s7, 0
s_mov_b32 s86, 387328
s_mov_b32 s87, 0x20000
buffer_load_dwordx4 v[64:67], v30, s[84:87], 0 offen
buffer_load_dwordx4 v[68:71], v30, s[84:87], s92 offen
buffer_load_dwordx4 v[72:75], v30, s[84:87], s93 offen
buffer_load_dwordx4 v[76:79], v30, s[84:87], s94 offen
s_waitcnt vmcnt(0)
v_lshl_add_u64 v[64:65], v[68:69], 4, v[64:65]
v_lshl_add_u64 v[66:67], v[70:71], 4, v[66:67]
v_lshl_add_u64 v[72:73], v[76:77], 4, v[72:73]
v_lshl_add_u64 v[74:75], v[78:79], 4, v[74:75]
v_lshl_or_b32 v64, v72, 8, v64
v_lshl_or_b32 v65, v73, 8, v65
v_lshl_or_b32 v66, v74, 8, v66
v_lshl_or_b32 v67, v75, 8, v67
v_lshl_or_b32 v120, v65, 16, v64
v_lshl_or_b32 v121, v67, 16, v66
s_add_u32 s84, s84, 57344
s_addc_u32 s85, s85, 0
buffer_load_dwordx4 v[64:67], v30, s[84:87], 0 offen
buffer_load_dwordx4 v[68:71], v30, s[84:87], s92 offen
buffer_load_dwordx4 v[72:75], v30, s[84:87], s93 offen
buffer_load_dwordx4 v[76:79], v30, s[84:87], s94 offen
s_waitcnt vmcnt(0)
v_lshl_add_u64 v[64:65], v[68:69], 4, v[64:65]
v_lshl_add_u64 v[66:67], v[70:71], 4, v[66:67]
v_lshl_add_u64 v[72:73], v[76:77], 4, v[72:73]
v_lshl_add_u64 v[74:75], v[78:79], 4, v[74:75]
v_lshl_or_b32 v64, v72, 8, v64
v_lshl_or_b32 v65, v73, 8, v65
v_lshl_or_b32 v66, v74, 8, v66
v_lshl_or_b32 v67, v75, 8, v67
v_lshl_or_b32 v124, v65, 16, v64
v_lshl_or_b32 v125, v67, 16, v66
L_WRET:
s_setpc_b64 s[100:101]
L_END:
s_endpgm
.section .rodata,"a"
.p2align 6
.amdhsa_kernel standalone__normalfloat_lut_af4__prompt_kernel
  .amdhsa_next_free_vgpr 512
  .amdhsa_next_free_sgpr 102
  .amdhsa_accum_offset 256
  .amdhsa_group_segment_fixed_size 0
  .amdhsa_kernarg_size 56
  .amdhsa_user_sgpr_count 2
  .amdhsa_user_sgpr_kernarg_segment_ptr 1
  .amdhsa_system_sgpr_workgroup_id_x 1
.end_amdhsa_kernel
```

```asm
; @launch grid=(256,1,1) block=(256,1,1) lds=163840
.amdgcn_target "amdgcn-amd-amdhsa--gfx950"
.text
.globl standalone__normalfloat_lut_af4__prompt_kernel
.p2align 12
.p2align 8
.type standalone__normalfloat_lut_af4__prompt_kernel,@function
standalone__normalfloat_lut_af4__prompt_kernel:
s_load_dwordx4 s[4:7], s[0:1], 0
s_load_dwordx4 s[12:15], s[0:1], 40
s_load_dwordx4 s[8:11], s[0:1], 24
s_memrealtime s[56:57]
s_cmp_ge_u32 s2, 256
s_cbranch_scc1 L_END
s_getpc_b64 s[48:49]
L_PC0:
v_bfi_b32 v2, 7, v0, s2
v_lshlrev_b32 v2, 7, v2
v_min_u32 v2, L_END-L_PC0, v2
global_load_dword v7, v2, s[48:49]
v_lshrrev_b32 v1, 6, v0
s_cmp_lt_u32 s2, 32
v_readfirstlane_b32 s36, v1
s_cbranch_scc1 L_PACK
s_bfe_u32 s34, s2, 0x20001
s_bfe_u32 s37, s2, 0x20003
s_lshl2_add_u32 s37, s34, s37
s_and_b32 s43, s2, 1
s_mul_i32 s43, s43, 7
s_lshr_b32 s38, s2, 5
s_add_u32 s38, s38, s43
s_lshl2_add_u32 s39, s38, s36
s_sub_u32 s39, s39, 4
v_bfe_u32 v6, v0, 4, 2
v_and_b32 v3, 15, v0
v_mul_u32_u24 v2, 114688, v6
v_lshl_add_u32 v30, v3, 4, v2
s_lshr_b32 s46, s37, 1
s_and_b32 s45, s37, 1
s_lshl3_add_u32 s46, s46, s45
s_mul_i32 s46, s46, 57344
s_lshl_b32 s47, s39, 8
s_add_u32 s46, s46, s47
s_mov_b32 s18, 387328
s_mov_b32 s19, 0x20000
s_mov_b32 s92, 14336
s_mov_b32 s93, 28672
s_mov_b32 s94, 43008
s_waitcnt lgkmcnt(0)
s_add_u32 s16, s6, s46
s_addc_u32 s17, s7, 0
buffer_load_dwordx4 v[104:107], v30, s[16:19], 0 offen
buffer_load_dwordx4 v[108:111], v30, s[16:19], s92 offen
buffer_load_dwordx4 v[112:115], v30, s[16:19], s93 offen
buffer_load_dwordx4 v[116:119], v30, s[16:19], s94 offen
s_branch L_MAIN
L_PACK:
v_lshrrev_b32 v2, 2, v0
v_and_b32 v3, 3, v0
s_lshl_b32 s45, s2, 17
v_lshl_add_u32 v2, v2, 11, s45
v_lshl_add_u32 v17, v3, 7, v2
s_mov_b32 s30, 4194304
s_mov_b32 s31, 0x20000
v_lshlrev_b32 v16, 3, v0
s_cmp_lt_u32 s2, 2
s_cselect_b32 s34, 8, 0
s_mov_b32 s35, 0x20000
v_mov_b64 v[22:23], 0
s_waitcnt lgkmcnt(0)
s_mov_b64 s[32:33], s[12:13]
v_mov_b64 v[20:21], s[56:57]
buffer_atomic_cmpswap_x2 v[20:23], v16, s[32:35], 0 offen sc1
s_mov_b64 s[28:29], s[4:5]
buffer_load_dword v19, v17, s[28:31], 0 offen offset:0
s_branch L_PACK1
L_MAIN:
s_mov_b64 s[20:21], s[4:5]
s_mov_b32 s22, 4194304
s_mov_b32 s23, 0x20000
s_lshl_b32 s46, s37, 18
v_lshrrev_b32 v5, 3, v0
v_lshl_add_u32 v2, v5, 11, s46
v_lshrrev_b32 v4, 4, v0
v_xor_b32 v4, v4, v0
v_and_b32 v4, 7, v4
v_lshl_add_u32 v8, v4, 4, v2
v_add_u32 v9, 65536, v8
v_add_u32 v10, 131072, v8
v_add_u32 v11, 196608, v8
s_lshl_b32 s33, s36, 10
s_lshl_b32 s40, s34, 7
s_add_u32 m0, s33, 65536
s_nop 0
buffer_load_dwordx4 v8, s[20:23], s40 offen lds
s_add_u32 m0, s33, 69632
s_nop 0
buffer_load_dwordx4 v9, s[20:23], s40 offen lds
s_add_u32 m0, s33, 73728
s_nop 0
buffer_load_dwordx4 v10, s[20:23], s40 offen lds
s_add_u32 m0, s33, 77824
s_nop 0
buffer_load_dwordx4 v11, s[20:23], s40 offen lds
v_mov_b32 v2, 0x3da3bf80
s_lshl_b64 exec, exec, 8
v_mov_b32 v2, 0x3e25bf32
s_lshl_b64 exec, exec, 8
v_mov_b32 v2, 0x3e7cbf06
s_lshl_b64 exec, exec, 8
v_mov_b32 v2, 0x3eadbeca
s_lshl_b64 exec, exec, 8
v_mov_b32 v2, 0x3ee2be92
s_lshl_b64 exec, exec, 8
v_mov_b32 v2, 0x3f10be3d
s_lshl_b64 exec, exec, 8
v_mov_b32 v2, 0x3f39bdba
s_lshl_b64 exec, exec, 8
v_mov_b32 v2, 0x3f800000
s_mov_b64 exec, -1
s_and_b32 s45, s36, 1
s_mul_i32 s45, s45, 0x0202
s_lshr_b32 s46, s36, 1
s_mul_i32 s46, s46, 0x02020000
s_add_u32 s45, s45, s46
s_add_u32 s45, s45, 0x05040100
v_mov_b32 v4, s45
v_lshlrev_b32 v5, 8, v5
v_and_b32 v31, 7, v0
v_lshl_add_u32 v31, v31, 4, v5
s_mov_b32 s45, 0xbf32bf80
v_perm_b32 v128, s45, v2, v4
v_mov_b32 v129, v128
v_mov_b64 v[130:131], v[128:129]
ds_write_b128 v31, v[128:131] offset:0
s_mov_b32 s45, 0xbecabf06
v_perm_b32 v132, s45, v2, v4
v_mov_b32 v133, v132
v_mov_b64 v[134:135], v[132:133]
v_and_b32 v5, 31, v0
v_lshlrev_b32 v19, 2, v5
v_and_b32 v0, 63, v0
s_lshl_b32 s46, s39, 7
ds_write_b128 v31, v[132:135] offset:8192
s_mov_b32 s45, 0xbe3dbe92
v_perm_b32 v136, s45, v2, v4
v_mov_b32 v137, v136
v_mov_b64 v[138:139], v[136:137]
v_lshl_add_u32 v28, v3, 3, s46
s_mul_i32 s47, s37, 917504
s_add_u32 s47, s47, s46
s_add_u32 s28, s10, s47
s_addc_u32 s29, s11, 0
ds_write_b128 v31, v[136:139] offset:16384
s_mov_b32 s45, 0xbdba
v_perm_b32 v140, s45, v2, v4
v_mov_b32 v141, v140
v_mov_b64 v[142:143], v[140:141]
s_mov_b32 s30, 86144
s_mov_b32 s31, 0x20000
v_mul_u32_u24 v29, 28672, v6
v_lshl_add_u32 v18, v3, 3, v29
ds_write_b128 v31, v[140:143] offset:24576
s_mov_b32 s45, 0x3e253da3
v_perm_b32 v144, s45, v2, v4
v_mov_b32 v145, v144
v_mov_b64 v[146:147], v[144:145]
v_lshlrev_b32 v29, 7, v3
v_bfe_u32 v5, v0, 1, 3
v_xor_b32 v5, v5, v6
v_lshl_add_u32 v29, v5, 4, v29
s_load_dwordx2 s[88:89], s[12:13], 0
ds_write_b128 v31, v[144:147] offset:32768
s_mov_b32 s45, 0x3ead3e7c
v_perm_b32 v148, s45, v2, v4
v_mov_b32 v149, v148
v_mov_b64 v[150:151], v[148:149]
v_add_u32 v14, 65536, v29
v_xor_b32 v15, 64, v14
v_add_u32 v16, 0x10000, v14
v_add_u32 v17, 0x10000, v15
ds_write_b128 v31, v[148:151] offset:40960
s_mov_b32 s45, 0x3f103ee2
v_perm_b32 v152, s45, v2, v4
v_mov_b32 v153, v152
v_mov_b64 v[154:155], v[152:153]
s_mov_b32 s52, 0x0c0c0400
s_mov_b32 s53, 0x0c0c0500
s_mov_b32 s54, 0x0c0c0600
s_mov_b32 s55, 0x0c0c0700
ds_write_b128 v31, v[152:155] offset:49152
s_mov_b32 s45, 0x3f803f39
v_perm_b32 v156, s45, v2, v4
v_mov_b32 v157, v156
v_mov_b64 v[158:159], v[156:157]
v_lshlrev_b32 v13, 4, v0
s_lshl_b32 s47, s39, 16
s_add_u32 s24, s14, s47
s_addc_u32 s25, s15, 0
s_lshl_b32 s47, s37, 10
ds_write_b128 v31, v[156:159] offset:57344
s_add_u32 s76, s24, s47
s_addc_u32 s77, s25, 0
s_movk_i32 s78, 1024
s_mov_b32 s79, 0x20000
s_lshl_b32 s47, s34, 3
s_lshr_b32 s47, 0x90d0b2d, s47
s_bfe_u32 s41, s47, 0x20000
s_lshl_b32 s41, s41, 7
s_bfe_u32 s42, s47, 0x20002
s_lshl_b32 s42, s42, 7
s_bfe_u32 s43, s47, 0x20004
s_lshl_b32 s43, s43, 7
s_lshl_b32 s47, s34, 1
s_lshr_b32 s47, 0x63, s47
s_and_b32 s47, s47, 3
s_sub_u32 s47, s47, s34
s_lshl1_add_u32 s3, s47, 14
s_mul_i32 s47, s3, 458752
s_add_u32 s16, s16, s47
s_addc_u32 s17, s17, 0
s_lshl_b32 s3, s3, 11
v_lshl_add_u32 v12, s41, 5, v13
s_mul_i32 s47, s34, 917504
s_lshl_b32 s46, s39, 8
s_add_u32 s47, s47, s46
s_add_u32 s84, s6, s47
s_addc_u32 s85, s7, 0
s_mov_b32 s86, 903424
s_mov_b32 s87, 0x20000
v_add_u32 v31, 458752, v30
s_mov_b32 s95, 57344
s_mov_b32 s96, 71680
s_mov_b32 s97, 86016
s_mov_b32 s98, 100352
s_mov_b32 s26, 65536
s_mov_b32 s27, 0x20000
s_mov_b64 s[80:81], s[12:13]
s_movk_i32 s82, 128
s_mov_b32 s83, 0x20000
s_movk_i32 s90, 4096
buffer_load_dwordx4 v[64:67], v30, s[84:87], 0 offen
buffer_load_dwordx4 v[68:71], v30, s[84:87], s92 offen
buffer_load_dwordx4 v[72:75], v30, s[84:87], s93 offen
buffer_load_dwordx4 v[76:79], v30, s[84:87], s94 offen
s_mov_b64 vcc, -1
s_branch L_PAD0
L_PADRET0:
s_mov_b64 vcc, 0
s_waitcnt vmcnt(8)
v_lshl_add_u64 v[104:105], v[108:109], 4, v[104:105]
v_lshl_add_u64 v[106:107], v[110:111], 4, v[106:107]
v_lshl_add_u64 v[112:113], v[116:117], 4, v[112:113]
v_lshl_add_u64 v[114:115], v[118:119], 4, v[114:115]
v_lshl_or_b32 v104, v112, 8, v104
v_lshl_or_b32 v105, v113, 8, v105
v_lshl_or_b32 v106, v114, 8, v106
v_lshl_or_b32 v107, v115, 8, v107
v_lshl_or_b32 v108, v105, 16, v104
v_lshl_or_b32 v109, v107, 16, v106
buffer_load_dwordx4 v[80:83], v30, s[84:87], s95 offen
buffer_load_dwordx4 v[84:87], v30, s[84:87], s96 offen
buffer_load_dwordx4 v[88:91], v30, s[84:87], s97 offen
buffer_load_dwordx4 v[92:95], v30, s[84:87], s98 offen
s_waitcnt lgkmcnt(0)
s_cmp_eq_u64 s[88:89], 0
s_cbranch_scc1 L_NOTAG
L_TAGOK:
v_mov_b64 v[110:111], s[88:89]
buffer_store_dwordx4 v[108:111], v13, s[76:79], 0 offen sc1
s_add_u32 s76, s76, s3
s_addc_u32 s77, s77, 0
s_waitcnt lgkmcnt(0)
s_nop 0
s_branch L_STREAM
L_PACK1:
v_and_b32 v0, 63, v0
v_lshrrev_b32 v2, 4, v0
v_and_b32 v3, 15, v0
v_mul_u32_u24 v2, 114688, v2
v_lshl_add_u32 v8, v3, 4, v2
s_movk_i32 s47, 0x3800
v_add_u32 v9, s47, v8
v_add_u32 v10, s47, v9
v_add_u32 v11, s47, v10
v_add_u32 v12, s47, v11
v_add_u32 v13, s47, v12
v_add_u32 v14, s47, v13
v_add_u32 v15, s47, v14
s_sub_u32 s3, s2, 1
s_and_b32 s3, s3, 7
s_lshr_b32 s45, s2, 3
s_lshl2_add_u32 s3, s3, s45
s_mul_i32 s40, s3, 4682
s_lshr_b32 s40, s40, 16
s_mul_i32 s41, s40, 14
s_sub_u32 s41, s3, s41
s_add_u32 s40, s40, 8
s_mov_b32 s22, 14680064
s_mov_b32 s23, 0x20000
s_mov_b64 s[20:21], s[6:7]
s_cmp_ge_u32 s40, 14
s_cselect_b32 s45, 8, 0
s_add_u32 s45, s45, s40
s_lshl2_add_u32 s42, s41, s36
s_mul_i32 s43, s45, 458752
s_lshl_b32 s44, s42, 8
s_add_u32 s43, s43, s44
s_lshl_b32 s44, s42, 5
s_add_u32 s44, s44, s45
s_lshl_b32 s52, s44, 11
s_cmp_lt_u32 s45, 32
s_cselect_b32 s52, s52, 0x1000000
s_cselect_b32 s22, 14680064, 0
s_add_u32 s41, s41, 4
s_add_u32 s40, s40, 2
s_cmp_ge_u32 s41, 14
s_cselect_b32 s48, 14, 0
s_addc_u32 s40, s40, 0
s_sub_u32 s41, s41, s48
s_load_dwordx2 s[50:51], s[12:13], 0
buffer_load_dwordx4 v[32:35], v8, s[20:23], s43 offen
buffer_load_dwordx4 v[36:39], v9, s[20:23], s43 offen
buffer_load_dwordx4 v[40:43], v10, s[20:23], s43 offen
buffer_load_dwordx4 v[44:47], v11, s[20:23], s43 offen
buffer_load_dwordx4 v[48:51], v12, s[20:23], s43 offen
buffer_load_dwordx4 v[52:55], v13, s[20:23], s43 offen
buffer_load_dwordx4 v[56:59], v14, s[20:23], s43 offen
buffer_load_dwordx4 v[60:63], v15, s[20:23], s43 offen
s_mov_b64 s[24:25], s[14:15]
s_mov_b32 s26, 3670016
s_mov_b32 s27, 0x20000
s_movk_i32 s34, 128
v_mov_b32 v16, 0
v_lshlrev_b32 v18, 4, v0
s_movk_i32 s46, 4096
s_waitcnt vmcnt(4) lgkmcnt(0)
v_mov_b64 v[22:23], s[50:51]
s_nop 0
L_PKN:
v_cmp_ne_u64 vcc, 0, v[22:23]
s_sub_u32 s46, s46, 1
s_cmp_gt_i32 s46, 0
s_cbranch_vccnz L_PKGO
s_cbranch_scc0 L_END
buffer_load_dwordx2 v[22:23], v16, s[32:35], 0 offen sc1
s_waitcnt vmcnt(0)
s_branch L_PKN
L_PKGO:
s_call_b64 s[100:101], L_PK0
buffer_store_dwordx4 v[20:23], v18, s[24:27], s52 offen offset:0 sc1
s_waitcnt lgkmcnt(0)
s_call_b64 s[100:101], L_UNIT
s_mov_b32 s53, s49
buffer_load_dwordx4 v[64:67], v8, s[20:23], s43 offen
buffer_load_dwordx4 v[68:71], v9, s[20:23], s43 offen
buffer_load_dwordx4 v[72:75], v10, s[20:23], s43 offen
buffer_load_dwordx4 v[76:79], v11, s[20:23], s43 offen
s_waitcnt vmcnt(5)
s_call_b64 s[100:101], L_PK1
buffer_store_dwordx4 v[20:23], v18, s[24:27], s52 offen offset:1024 sc1
buffer_load_dwordx4 v[80:83], v12, s[20:23], s43 offen
buffer_load_dwordx4 v[84:87], v13, s[20:23], s43 offen
buffer_load_dwordx4 v[88:91], v14, s[20:23], s43 offen
buffer_load_dwordx4 v[92:95], v15, s[20:23], s43 offen
s_waitcnt vmcnt(5)
s_call_b64 s[100:101], L_PK2
buffer_store_dwordx4 v[20:23], v18, s[24:27], s53 offen offset:0 sc1
s_call_b64 s[100:101], L_UNIT
s_mov_b32 s54, s49
buffer_load_dwordx4 v[32:35], v8, s[20:23], s43 offen
buffer_load_dwordx4 v[36:39], v9, s[20:23], s43 offen
buffer_load_dwordx4 v[40:43], v10, s[20:23], s43 offen
buffer_load_dwordx4 v[44:47], v11, s[20:23], s43 offen
s_waitcnt vmcnt(5)
s_call_b64 s[100:101], L_PK3
buffer_store_dwordx4 v[20:23], v18, s[24:27], s53 offen offset:1024 sc1
buffer_load_dwordx4 v[48:51], v12, s[20:23], s43 offen
buffer_load_dwordx4 v[52:55], v13, s[20:23], s43 offen
buffer_load_dwordx4 v[56:59], v14, s[20:23], s43 offen
buffer_load_dwordx4 v[60:63], v15, s[20:23], s43 offen
s_waitcnt vmcnt(5)
s_call_b64 s[100:101], L_PK0
buffer_store_dwordx4 v[20:23], v18, s[24:27], s54 offen offset:0 sc1
s_call_b64 s[100:101], L_UNIT
s_mov_b32 s55, s49
buffer_load_dwordx4 v[64:67], v8, s[20:23], s43 offen
buffer_load_dwordx4 v[68:71], v9, s[20:23], s43 offen
buffer_load_dwordx4 v[72:75], v10, s[20:23], s43 offen
buffer_load_dwordx4 v[76:79], v11, s[20:23], s43 offen
s_waitcnt vmcnt(5)
s_call_b64 s[100:101], L_PK1
buffer_store_dwordx4 v[20:23], v18, s[24:27], s54 offen offset:1024 sc1
buffer_load_dwordx4 v[80:83], v12, s[20:23], s43 offen
buffer_load_dwordx4 v[84:87], v13, s[20:23], s43 offen
buffer_load_dwordx4 v[88:91], v14, s[20:23], s43 offen
buffer_load_dwordx4 v[92:95], v15, s[20:23], s43 offen
s_waitcnt vmcnt(5)
s_call_b64 s[100:101], L_PK2
buffer_store_dwordx4 v[20:23], v18, s[24:27], s55 offen offset:0 sc1
s_call_b64 s[100:101], L_UNIT
s_mov_b32 s52, s49
buffer_load_dwordx4 v[32:35], v8, s[20:23], s43 offen
buffer_load_dwordx4 v[36:39], v9, s[20:23], s43 offen
buffer_load_dwordx4 v[40:43], v10, s[20:23], s43 offen
buffer_load_dwordx4 v[44:47], v11, s[20:23], s43 offen
s_waitcnt vmcnt(5)
s_call_b64 s[100:101], L_PK3
buffer_store_dwordx4 v[20:23], v18, s[24:27], s55 offen offset:1024 sc1
buffer_load_dwordx4 v[48:51], v12, s[20:23], s43 offen
buffer_load_dwordx4 v[52:55], v13, s[20:23], s43 offen
buffer_load_dwordx4 v[56:59], v14, s[20:23], s43 offen
buffer_load_dwordx4 v[60:63], v15, s[20:23], s43 offen
s_waitcnt vmcnt(5)
s_call_b64 s[100:101], L_PK0
buffer_store_dwordx4 v[20:23], v18, s[24:27], s52 offen offset:0 sc1
s_call_b64 s[100:101], L_UNIT
s_mov_b32 s53, s49
buffer_load_dwordx4 v[64:67], v8, s[20:23], s43 offen
buffer_load_dwordx4 v[68:71], v9, s[20:23], s43 offen
buffer_load_dwordx4 v[72:75], v10, s[20:23], s43 offen
buffer_load_dwordx4 v[76:79], v11, s[20:23], s43 offen
s_waitcnt vmcnt(5)
s_call_b64 s[100:101], L_PK1
buffer_store_dwordx4 v[20:23], v18, s[24:27], s52 offen offset:1024 sc1
buffer_load_dwordx4 v[80:83], v12, s[20:23], s43 offen
buffer_load_dwordx4 v[84:87], v13, s[20:23], s43 offen
buffer_load_dwordx4 v[88:91], v14, s[20:23], s43 offen
buffer_load_dwordx4 v[92:95], v15, s[20:23], s43 offen
s_waitcnt vmcnt(5)
s_call_b64 s[100:101], L_PK2
buffer_store_dwordx4 v[20:23], v18, s[24:27], s53 offen offset:0 sc1
s_call_b64 s[100:101], L_UNIT
s_mov_b32 s54, s49
buffer_load_dwordx4 v[32:35], v8, s[20:23], s43 offen
buffer_load_dwordx4 v[36:39], v9, s[20:23], s43 offen
buffer_load_dwordx4 v[40:43], v10, s[20:23], s43 offen
buffer_load_dwordx4 v[44:47], v11, s[20:23], s43 offen
s_waitcnt vmcnt(5)
s_call_b64 s[100:101], L_PK3
buffer_store_dwordx4 v[20:23], v18, s[24:27], s53 offen offset:1024 sc1
buffer_load_dwordx4 v[48:51], v12, s[20:23], s43 offen
buffer_load_dwordx4 v[52:55], v13, s[20:23], s43 offen
buffer_load_dwordx4 v[56:59], v14, s[20:23], s43 offen
buffer_load_dwordx4 v[60:63], v15, s[20:23], s43 offen
s_waitcnt vmcnt(5)
s_call_b64 s[100:101], L_PK0
buffer_store_dwordx4 v[20:23], v18, s[24:27], s54 offen offset:0 sc1
s_waitcnt vmcnt(1)
s_call_b64 s[100:101], L_PK1
buffer_store_dwordx4 v[20:23], v18, s[24:27], s54 offen offset:1024 sc1
s_endpgm
L_UNIT:
s_cmp_ge_u32 s40, 14
s_cselect_b32 s45, 8, 0
s_add_u32 s45, s45, s40
s_lshl2_add_u32 s42, s41, s36
s_mul_i32 s43, s45, 458752
s_lshl_b32 s44, s42, 8
s_add_u32 s43, s43, s44
s_lshl_b32 s44, s42, 5
s_add_u32 s44, s44, s45
s_lshl_b32 s49, s44, 11
s_cmp_lt_u32 s45, 32
s_cselect_b32 s49, s49, 0x1000000
s_cselect_b32 s22, 14680064, 0
s_add_u32 s41, s41, 4
s_add_u32 s40, s40, 2
s_cmp_ge_u32 s41, 14
s_cselect_b32 s48, 14, 0
s_addc_u32 s40, s40, 0
s_sub_u32 s41, s41, s48
s_setpc_b64 s[100:101]
L_PK0:
v_lshl_add_u64 v[32:33], v[36:37], 4, v[32:33]
v_lshl_add_u64 v[34:35], v[38:39], 4, v[34:35]
v_lshl_add_u64 v[40:41], v[44:45], 4, v[40:41]
v_lshl_add_u64 v[42:43], v[46:47], 4, v[42:43]
v_lshl_or_b32 v32, v40, 8, v32
v_lshl_or_b32 v33, v41, 8, v33
v_lshl_or_b32 v34, v42, 8, v34
v_lshl_or_b32 v35, v43, 8, v35
v_lshl_or_b32 v20, v33, 16, v32
v_lshl_or_b32 v21, v35, 16, v34
s_setpc_b64 s[100:101]
L_PK1:
v_lshl_add_u64 v[48:49], v[52:53], 4, v[48:49]
v_lshl_add_u64 v[50:51], v[54:55], 4, v[50:51]
v_lshl_add_u64 v[56:57], v[60:61], 4, v[56:57]
v_lshl_add_u64 v[58:59], v[62:63], 4, v[58:59]
v_lshl_or_b32 v48, v56, 8, v48
v_lshl_or_b32 v49, v57, 8, v49
v_lshl_or_b32 v50, v58, 8, v50
v_lshl_or_b32 v51, v59, 8, v51
v_lshl_or_b32 v20, v49, 16, v48
v_lshl_or_b32 v21, v51, 16, v50
s_setpc_b64 s[100:101]
L_PK2:
v_lshl_add_u64 v[64:65], v[68:69], 4, v[64:65]
v_lshl_add_u64 v[66:67], v[70:71], 4, v[66:67]
v_lshl_add_u64 v[72:73], v[76:77], 4, v[72:73]
v_lshl_add_u64 v[74:75], v[78:79], 4, v[74:75]
v_lshl_or_b32 v64, v72, 8, v64
v_lshl_or_b32 v65, v73, 8, v65
v_lshl_or_b32 v66, v74, 8, v66
v_lshl_or_b32 v67, v75, 8, v67
v_lshl_or_b32 v20, v65, 16, v64
v_lshl_or_b32 v21, v67, 16, v66
s_setpc_b64 s[100:101]
L_PK3:
v_lshl_add_u64 v[80:81], v[84:85], 4, v[80:81]
v_lshl_add_u64 v[82:83], v[86:87], 4, v[82:83]
v_lshl_add_u64 v[88:89], v[92:93], 4, v[88:89]
v_lshl_add_u64 v[90:91], v[94:95], 4, v[90:91]
v_lshl_or_b32 v80, v88, 8, v80
v_lshl_or_b32 v81, v89, 8, v81
v_lshl_or_b32 v82, v90, 8, v82
v_lshl_or_b32 v83, v91, 8, v83
v_lshl_or_b32 v20, v81, 16, v80
v_lshl_or_b32 v21, v83, 16, v82
s_setpc_b64 s[100:101]
.p2align 12
L_STREAM:
L_PAD0:
s_cbranch_vccnz L_PADRET0
buffer_load_dwordx4 v[96:99], v31, s[84:87], 0 offen
buffer_load_dwordx4 v[100:103], v31, s[84:87], s92 offen
buffer_load_dwordx4 v[104:107], v31, s[84:87], s93 offen
buffer_load_dwordx4 v[108:111], v31, s[84:87], s94 offen
buffer_load_dwordx4 v[112:115], v31, s[84:87], s95 offen
buffer_load_dwordx4 v[116:119], v31, s[84:87], s96 offen
buffer_load_dwordx4 v[120:123], v31, s[84:87], s97 offen
buffer_load_dwordx4 v[124:127], v31, s[84:87], s98 offen
s_waitcnt vmcnt(17)
s_barrier
ds_read_b128 a[224:227], v14 offset:0
s_waitcnt vmcnt(15)
v_lshl_add_u64 v[64:65], v[68:69], 4, v[64:65]
v_lshl_add_u64 v[66:67], v[70:71], 4, v[66:67]
v_lshl_add_u32 v64, v64, 8, v19
v_lshl_add_u32 v65, v65, 8, v19
v_lshl_add_u32 v66, v66, 8, v19
v_lshl_add_u32 v67, v67, 8, v19
ds_read_b32 a0, v64
ds_read_b32 a4, v65
ds_read_b32 a8, v66
ds_read_b32 a12, v67
s_waitcnt vmcnt(13)
ds_read_b128 a[228:231], v14 offset:2048
v_lshl_add_u64 v[72:73], v[76:77], 4, v[72:73]
v_lshl_add_u64 v[74:75], v[78:79], 4, v[74:75]
v_lshl_add_u32 v72, v72, 8, v19
v_lshl_add_u32 v73, v73, 8, v19
v_lshl_add_u32 v74, v74, 8, v19
v_lshl_add_u32 v75, v75, 8, v19
ds_read_b32 a1, v72
ds_read_b32 a5, v73
ds_read_b32 a9, v74
ds_read_b32 a13, v75
s_waitcnt vmcnt(11)
v_lshl_add_u64 v[80:81], v[84:85], 4, v[80:81]
v_lshl_add_u64 v[82:83], v[86:87], 4, v[82:83]
v_lshl_add_u32 v80, v80, 8, v19
v_lshl_add_u32 v81, v81, 8, v19
v_lshl_add_u32 v82, v82, 8, v19
v_lshl_add_u32 v83, v83, 8, v19
ds_read_b32 a2, v80
ds_read_b32 a6, v81
ds_read_b32 a10, v82
ds_read_b32 a14, v83
s_waitcnt vmcnt(9)
v_lshl_add_u64 v[88:89], v[92:93], 4, v[88:89]
v_lshl_add_u64 v[90:91], v[94:95], 4, v[90:91]
v_lshl_add_u32 v88, v88, 8, v19
v_lshl_add_u32 v89, v89, 8, v19
v_lshl_add_u32 v90, v90, 8, v19
v_lshl_add_u32 v91, v91, 8, v19
ds_read_b32 a3, v88
ds_read_b32 a7, v89
ds_read_b32 a11, v90
ds_read_b32 a15, v91
s_waitcnt lgkmcnt(3)
v_mfma_f32_16x16x32_bf16 v[128:131], a[224:227], a[0:3], 0
s_waitcnt lgkmcnt(2)
ds_read_b128 a[232:235], v14 offset:4096
v_mfma_f32_16x16x32_bf16 v[132:135], a[224:227], a[4:7], 0
s_waitcnt lgkmcnt(2)
v_mfma_f32_16x16x32_bf16 v[136:139], a[224:227], a[8:11], 0
s_waitcnt lgkmcnt(1)
s_add_u32 m0, s33, 81920
v_mfma_f32_16x16x32_bf16 v[140:143], a[224:227], a[12:15], 0
v_mfma_f32_16x16x32_bf16 v[144:147], a[228:231], a[0:3], 0
ds_read_b128 a[236:239], v14 offset:6144
buffer_load_dwordx4 v8, s[20:23], s41 offen lds
v_mfma_f32_16x16x32_bf16 v[148:151], a[228:231], a[4:7], 0
v_mfma_f32_16x16x32_bf16 v[152:155], a[228:231], a[8:11], 0
s_add_u32 m0, s33, 86016
v_mfma_f32_16x16x32_bf16 v[156:159], a[228:231], a[12:15], 0
s_waitcnt lgkmcnt(1)
v_mfma_f32_16x16x32_bf16 v[160:163], a[232:235], a[0:3], 0
ds_read_b128 a[240:243], v14 offset:8192
buffer_load_dwordx4 v9, s[20:23], s41 offen lds
v_mfma_f32_16x16x32_bf16 v[164:167], a[232:235], a[4:7], 0
v_mfma_f32_16x16x32_bf16 v[168:171], a[232:235], a[8:11], 0
s_add_u32 m0, s33, 90112
v_mfma_f32_16x16x32_bf16 v[172:175], a[232:235], a[12:15], 0
s_waitcnt lgkmcnt(1)
v_mfma_f32_16x16x32_bf16 v[176:179], a[236:239], a[0:3], 0
ds_read_b128 a[244:247], v14 offset:10240
buffer_load_dwordx4 v10, s[20:23], s41 offen lds
v_mfma_f32_16x16x32_bf16 v[180:183], a[236:239], a[4:7], 0
v_mfma_f32_16x16x32_bf16 v[184:187], a[236:239], a[8:11], 0
s_add_u32 m0, s33, 94208
v_mfma_f32_16x16x32_bf16 v[188:191], a[236:239], a[12:15], 0
s_waitcnt lgkmcnt(1)
v_mfma_f32_16x16x32_bf16 v[192:195], a[240:243], a[0:3], 0
buffer_load_dwordx4 v11, s[20:23], s41 offen lds
v_mfma_f32_16x16x32_bf16 v[196:199], a[240:243], a[4:7], 0
v_mfma_f32_16x16x32_bf16 v[200:203], a[240:243], a[8:11], 0
v_mfma_f32_16x16x32_bf16 v[204:207], a[240:243], a[12:15], 0
s_waitcnt lgkmcnt(0)
v_mfma_f32_16x16x32_bf16 v[208:211], a[244:247], a[0:3], 0
ds_read_b128 a[248:251], v14 offset:12288
buffer_load_dwordx4 v[32:35], v12, s[24:27], 0 offen offset:0 sc1
v_mfma_f32_16x16x32_bf16 v[212:215], a[244:247], a[4:7], 0
buffer_load_dwordx4 v[36:39], v12, s[24:27], 0 offen offset:1024 sc1
v_mfma_f32_16x16x32_bf16 v[216:219], a[244:247], a[8:11], 0
v_mfma_f32_16x16x32_bf16 v[220:223], a[244:247], a[12:15], 0
s_waitcnt vmcnt(12)
ds_read_b128 a[252:255], v14 offset:14336
v_lshl_add_u64 v[96:97], v[100:101], 4, v[96:97]
v_lshl_add_u64 v[98:99], v[102:103], 4, v[98:99]
v_lshl_add_u32 v96, v96, 8, v19
v_lshl_add_u32 v97, v97, 8, v19
v_lshl_add_u32 v98, v98, 8, v19
v_lshl_add_u32 v99, v99, 8, v19
ds_read_b32 a16, v96
ds_read_b32 a20, v97
ds_read_b32 a24, v98
ds_read_b32 a28, v99
s_waitcnt vmcnt(10)
v_lshl_add_u64 v[104:105], v[108:109], 4, v[104:105]
v_lshl_add_u64 v[106:107], v[110:111], 4, v[106:107]
v_lshl_add_u32 v104, v104, 8, v19
v_lshl_add_u32 v105, v105, 8, v19
v_lshl_add_u32 v106, v106, 8, v19
v_lshl_add_u32 v107, v107, 8, v19
ds_read_b32 a17, v104
ds_read_b32 a21, v105
ds_read_b32 a25, v106
ds_read_b32 a29, v107
s_waitcnt vmcnt(8)
v_lshl_add_u64 v[112:113], v[116:117], 4, v[112:113]
v_lshl_add_u64 v[114:115], v[118:119], 4, v[114:115]
v_lshl_add_u32 v112, v112, 8, v19
v_lshl_add_u32 v113, v113, 8, v19
v_lshl_add_u32 v114, v114, 8, v19
v_lshl_add_u32 v115, v115, 8, v19
ds_read_b32 a18, v112
ds_read_b32 a22, v113
ds_read_b32 a26, v114
ds_read_b32 a30, v115
s_waitcnt vmcnt(6) lgkmcnt(13)
v_lshl_add_u64 v[120:121], v[124:125], 4, v[120:121]
v_lshl_add_u64 v[122:123], v[126:127], 4, v[122:123]
v_lshl_add_u32 v120, v120, 8, v19
v_lshl_add_u32 v121, v121, 8, v19
v_lshl_add_u32 v122, v122, 8, v19
v_lshl_add_u32 v123, v123, 8, v19
ds_read_b32 a19, v120
ds_read_b32 a23, v121
ds_read_b32 a27, v122
ds_read_b32 a31, v123
v_mfma_f32_16x16x32_bf16 v[224:227], a[248:251], a[0:3], 0
ds_read_b128 a[224:227], v15 offset:0
v_mfma_f32_16x16x32_bf16 v[228:231], a[248:251], a[4:7], 0
v_mfma_f32_16x16x32_bf16 v[232:235], a[248:251], a[8:11], 0
global_load_dwordx2 v[20:21], v28, s[8:9]
v_mfma_f32_16x16x32_bf16 v[236:239], a[248:251], a[12:15], 0
s_waitcnt lgkmcnt(5)
v_mfma_f32_16x16x32_bf16 v[240:243], a[252:255], a[0:3], 0
ds_read_b128 a[228:231], v15 offset:2048
buffer_load_dwordx4 v[40:43], v12, s[24:27], 0 offen offset:2048 sc1
v_mfma_f32_16x16x32_bf16 v[244:247], a[252:255], a[4:7], 0
buffer_load_dwordx4 v[44:47], v12, s[24:27], 0 offen offset:3072 sc1
v_lshl_add_u32 v12, s42, 5, v13
v_mfma_f32_16x16x32_bf16 v[248:251], a[252:255], a[8:11], 0
v_mfma_f32_16x16x32_bf16 v[252:255], a[252:255], a[12:15], 0
s_waitcnt lgkmcnt(1)
v_mfma_f32_16x16x32_bf16 v[128:131], a[224:227], a[16:19], v[128:131]
ds_read_b128 a[232:235], v15 offset:4096
v_mfma_f32_16x16x32_bf16 v[132:135], a[224:227], a[20:23], v[132:135]
v_mfma_f32_16x16x32_bf16 v[136:139], a[224:227], a[24:27], v[136:139]
v_mfma_f32_16x16x32_bf16 v[140:143], a[224:227], a[28:31], v[140:143]
s_waitcnt lgkmcnt(1)
v_mfma_f32_16x16x32_bf16 v[144:147], a[228:231], a[16:19], v[144:147]
ds_read_b128 a[236:239], v15 offset:6144
v_mfma_f32_16x16x32_bf16 v[148:151], a[228:231], a[20:23], v[148:151]
v_mfma_f32_16x16x32_bf16 v[152:155], a[228:231], a[24:27], v[152:155]
v_mfma_f32_16x16x32_bf16 v[156:159], a[228:231], a[28:31], v[156:159]
s_waitcnt lgkmcnt(1)
v_mfma_f32_16x16x32_bf16 v[160:163], a[232:235], a[16:19], v[160:163]
ds_read_b128 a[240:243], v15 offset:8192
v_mfma_f32_16x16x32_bf16 v[164:167], a[232:235], a[20:23], v[164:167]
v_mfma_f32_16x16x32_bf16 v[168:171], a[232:235], a[24:27], v[168:171]
v_mfma_f32_16x16x32_bf16 v[172:175], a[232:235], a[28:31], v[172:175]
s_waitcnt lgkmcnt(1)
v_mfma_f32_16x16x32_bf16 v[176:179], a[236:239], a[16:19], v[176:179]
ds_read_b128 a[244:247], v15 offset:10240
v_mfma_f32_16x16x32_bf16 v[180:183], a[236:239], a[20:23], v[180:183]
v_mfma_f32_16x16x32_bf16 v[184:187], a[236:239], a[24:27], v[184:187]
v_mfma_f32_16x16x32_bf16 v[188:191], a[236:239], a[28:31], v[188:191]
s_waitcnt lgkmcnt(1)
v_mfma_f32_16x16x32_bf16 v[192:195], a[240:243], a[16:19], v[192:195]
ds_read_b128 a[248:251], v15 offset:12288
buffer_load_dwordx4 v[48:51], v12, s[24:27], 0 offen offset:0 sc1
v_mfma_f32_16x16x32_bf16 v[196:199], a[240:243], a[20:23], v[196:199]
buffer_load_dwordx4 v[52:55], v12, s[24:27], 0 offen offset:1024 sc1
v_mfma_f32_16x16x32_bf16 v[200:203], a[240:243], a[24:27], v[200:203]
v_mfma_f32_16x16x32_bf16 v[204:207], a[240:243], a[28:31], v[204:207]
s_waitcnt lgkmcnt(1)
v_mfma_f32_16x16x32_bf16 v[208:211], a[244:247], a[16:19], v[208:211]
s_waitcnt vmcnt(7)
s_barrier
ds_read_b128 a[252:255], v15 offset:14336
v_mfma_f32_16x16x32_bf16 v[212:215], a[244:247], a[20:23], v[212:215]
v_mfma_f32_16x16x32_bf16 v[216:219], a[244:247], a[24:27], v[216:219]
s_add_u32 m0, s33, 98304
v_mfma_f32_16x16x32_bf16 v[220:223], a[244:247], a[28:31], v[220:223]
s_waitcnt lgkmcnt(1)
v_mfma_f32_16x16x32_bf16 v[224:227], a[248:251], a[16:19], v[224:227]
buffer_load_dwordx4 v8, s[20:23], s42 offen lds
v_mfma_f32_16x16x32_bf16 v[228:231], a[248:251], a[20:23], v[228:231]
v_mfma_f32_16x16x32_bf16 v[232:235], a[248:251], a[24:27], v[232:235]
s_add_u32 m0, s33, 102400
v_mfma_f32_16x16x32_bf16 v[236:239], a[248:251], a[28:31], v[236:239]
s_waitcnt lgkmcnt(0)
v_mfma_f32_16x16x32_bf16 v[240:243], a[252:255], a[16:19], v[240:243]
ds_read_b128 a[224:227], v14 offset:16384
buffer_load_dwordx4 v9, s[20:23], s42 offen lds
v_mfma_f32_16x16x32_bf16 v[244:247], a[252:255], a[20:23], v[244:247]
v_mfma_f32_16x16x32_bf16 v[248:251], a[252:255], a[24:27], v[248:251]
s_add_u32 m0, s33, 106496
v_mfma_f32_16x16x32_bf16 v[252:255], a[252:255], a[28:31], v[252:255]
ds_read_b128 a[228:231], v14 offset:18432
buffer_load_dwordx4 v10, s[20:23], s42 offen lds
s_mov_b64 vcc, -1
s_cmp_eq_u32 s36, 0
s_cbranch_scc1 L_PAD1
s_cmp_eq_u32 s36, 1
s_cbranch_scc1 L_PAD3
s_cmp_eq_u32 s36, 2
s_cbranch_scc1 L_PAD5
s_cmp_eq_u32 s36, 3
s_cbranch_scc1 L_PADRET
L_PADRET:
s_mov_b64 vcc, 0
s_waitcnt vmcnt(8)
v_cmp_ne_u64 s[50:51], s[88:89], v[34:35]
v_cmp_ne_u64 s[44:45], s[88:89], v[38:39]
s_or_b64 s[50:51], s[44:45], s[50:51]
s_cbranch_scc1 L_SLOW2
L_BACK2:
v_perm_b32 v64, v32, v19, s52
v_perm_b32 v65, v32, v19, s53
v_perm_b32 v66, v36, v19, s52
v_perm_b32 v67, v36, v19, s53
v_perm_b32 v68, v32, v19, s54
v_perm_b32 v69, v32, v19, s55
v_perm_b32 v70, v36, v19, s54
v_perm_b32 v71, v36, v19, s55
ds_read_b32 a32, v64
ds_read_b32 a33, v65
ds_read_b32 a34, v66
ds_read_b32 a35, v67
ds_read_b32 a36, v68
ds_read_b32 a37, v69
ds_read_b32 a38, v70
ds_read_b32 a39, v71
v_perm_b32 v72, v33, v19, s52
v_perm_b32 v73, v33, v19, s53
v_perm_b32 v74, v37, v19, s52
v_perm_b32 v75, v37, v19, s53
v_perm_b32 v76, v33, v19, s54
v_perm_b32 v77, v33, v19, s55
v_perm_b32 v78, v37, v19, s54
v_perm_b32 v79, v37, v19, s55
ds_read_b32 a40, v72
ds_read_b32 a41, v73
ds_read_b32 a42, v74
ds_read_b32 a43, v75
ds_read_b32 a44, v76
ds_read_b32 a45, v77
ds_read_b32 a46, v78
ds_read_b32 a47, v79
s_waitcnt vmcnt(5)
s_add_u32 m0, s33, 110592
v_cmp_ne_u64 s[50:51], s[88:89], v[42:43]
v_cmp_ne_u64 s[44:45], s[88:89], v[46:47]
s_or_b64 s[50:51], s[44:45], s[50:51]
s_cbranch_scc1 L_SLOW3
L_BACK3:
s_waitcnt lgkmcnt(12)
v_mfma_f32_16x16x32_bf16 v[128:131], a[224:227], a[32:35], v[128:131]
s_waitcnt lgkmcnt(8)
ds_read_b128 a[232:235], v14 offset:20480
buffer_load_dwordx4 v11, s[20:23], s42 offen lds
v_mfma_f32_16x16x32_bf16 v[132:135], a[224:227], a[36:39], v[132:135]
s_waitcnt lgkmcnt(5)
v_perm_b32 v63, v40, v19, s52
v_mfma_f32_16x16x32_bf16 v[136:139], a[224:227], a[40:43], v[136:139]
s_waitcnt lgkmcnt(1)
s_add_u32 m0, s33, 114688
ds_read_b32 a48, v63
v_perm_b32 v62, v40, v19, s53
v_mfma_f32_16x16x32_bf16 v[140:143], a[224:227], a[44:47], v[140:143]
ds_read_b32 a49, v62
v_perm_b32 v61, v44, v19, s52
v_mfma_f32_16x16x32_bf16 v[144:147], a[228:231], a[32:35], v[144:147]
ds_read_b128 a[236:239], v14 offset:22528
buffer_load_dwordx4 v8, s[20:23], s43 offen lds
v_mfma_f32_16x16x32_bf16 v[148:151], a[228:231], a[36:39], v[148:151]
ds_read_b32 a50, v61
v_perm_b32 v60, v44, v19, s53
v_mfma_f32_16x16x32_bf16 v[152:155], a[228:231], a[40:43], v[152:155]
s_add_u32 m0, s33, 118784
ds_read_b32 a51, v60
v_perm_b32 v59, v40, v19, s54
v_mfma_f32_16x16x32_bf16 v[156:159], a[228:231], a[44:47], v[156:159]
s_waitcnt lgkmcnt(4)
ds_read_b32 a52, v59
v_perm_b32 v58, v40, v19, s55
v_mfma_f32_16x16x32_bf16 v[160:163], a[232:235], a[32:35], v[160:163]
ds_read_b128 a[240:243], v14 offset:24576
buffer_load_dwordx4 v9, s[20:23], s43 offen lds
v_mfma_f32_16x16x32_bf16 v[164:167], a[232:235], a[36:39], v[164:167]
buffer_load_dwordx4 v[104:107], v30, s[16:19], 0 offen
v_mfma_f32_16x16x32_bf16 v[168:171], a[232:235], a[40:43], v[168:171]
s_add_u32 m0, s33, 122880
ds_read_b32 a53, v58
v_perm_b32 v57, v44, v19, s54
v_mfma_f32_16x16x32_bf16 v[172:175], a[232:235], a[44:47], v[172:175]
s_waitcnt lgkmcnt(3)
ds_read_b32 a54, v57
v_perm_b32 v56, v44, v19, s55
v_mfma_f32_16x16x32_bf16 v[176:179], a[236:239], a[32:35], v[176:179]
ds_read_b128 a[244:247], v14 offset:26624
buffer_load_dwordx4 v10, s[20:23], s43 offen lds
v_mfma_f32_16x16x32_bf16 v[180:183], a[236:239], a[36:39], v[180:183]
ds_read_b32 a55, v56
v_perm_b32 v63, v41, v19, s52
v_mfma_f32_16x16x32_bf16 v[184:187], a[236:239], a[40:43], v[184:187]
ds_read_b32 a56, v63
v_perm_b32 v62, v41, v19, s53
v_mfma_f32_16x16x32_bf16 v[188:191], a[236:239], a[44:47], v[188:191]
s_waitcnt lgkmcnt(4)
ds_read_b32 a57, v62
buffer_load_dwordx4 v[96:99], v12, s[24:27], 0 offen offset:2048 sc1
v_mfma_f32_16x16x32_bf16 v[192:195], a[240:243], a[32:35], v[192:195]
ds_read_b128 a[248:251], v14 offset:28672
v_perm_b32 v61, v45, v19, s52
v_mfma_f32_16x16x32_bf16 v[196:199], a[240:243], a[36:39], v[196:199]
buffer_load_dwordx4 v[108:111], v30, s[16:19], s92 offen
v_mfma_f32_16x16x32_bf16 v[200:203], a[240:243], a[40:43], v[200:203]
s_add_u32 m0, s33, 126976
ds_read_b32 a58, v61
v_perm_b32 v60, v45, v19, s53
v_mfma_f32_16x16x32_bf16 v[204:207], a[240:243], a[44:47], v[204:207]
s_waitcnt lgkmcnt(3)
ds_read_b32 a59, v60
v_perm_b32 v59, v41, v19, s54
v_mfma_f32_16x16x32_bf16 v[208:211], a[244:247], a[32:35], v[208:211]
ds_read_b128 a[252:255], v14 offset:30720
buffer_load_dwordx4 v11, s[20:23], s43 offen lds
v_mfma_f32_16x16x32_bf16 v[212:215], a[244:247], a[36:39], v[212:215]
ds_read_b32 a60, v59
v_perm_b32 v58, v41, v19, s55
v_mfma_f32_16x16x32_bf16 v[216:219], a[244:247], a[40:43], v[216:219]
ds_read_b32 a61, v58
v_perm_b32 v57, v45, v19, s54
v_mfma_f32_16x16x32_bf16 v[220:223], a[244:247], a[44:47], v[220:223]
s_waitcnt lgkmcnt(4)
ds_read_b32 a62, v57
buffer_load_dwordx4 v[100:103], v12, s[24:27], 0 offen offset:3072 sc1
v_mfma_f32_16x16x32_bf16 v[224:227], a[248:251], a[32:35], v[224:227]
ds_read_b128 a[224:227], v15 offset:16384
v_perm_b32 v56, v45, v19, s55
v_mfma_f32_16x16x32_bf16 v[228:231], a[248:251], a[36:39], v[228:231]
buffer_load_dwordx4 v[112:115], v30, s[16:19], s93 offen
v_mfma_f32_16x16x32_bf16 v[232:235], a[248:251], a[40:43], v[232:235]
ds_read_b32 a63, v56
v_lshl_add_u32 v12, s43, 5, v13
v_mfma_f32_16x16x32_bf16 v[236:239], a[248:251], a[44:47], v[236:239]
s_waitcnt lgkmcnt(3)
buffer_load_dwordx4 v[80:83], v12, s[24:27], 0 offen offset:0 sc1
v_mfma_f32_16x16x32_bf16 v[240:243], a[252:255], a[32:35], v[240:243]
ds_read_b128 a[228:231], v15 offset:18432
buffer_load_dwordx4 v[84:87], v12, s[24:27], 0 offen offset:1024 sc1
v_mfma_f32_16x16x32_bf16 v[244:247], a[252:255], a[36:39], v[244:247]
v_lshlrev_b32 v24, 16, v20
v_and_b32 v25, 0xffff0000, v20
v_mfma_f32_16x16x32_bf16 v[248:251], a[252:255], a[40:43], v[248:251]
s_waitcnt vmcnt(15)
v_cmp_ne_u64 s[50:51], s[88:89], v[50:51]
v_cmp_ne_u64 s[44:45], s[88:89], v[54:55]
v_mfma_f32_16x16x32_bf16 v[252:255], a[252:255], a[44:47], v[252:255]
s_waitcnt lgkmcnt(1)
v_lshlrev_b32 v26, 16, v21
v_and_b32 v27, 0xffff0000, v21
v_mfma_f32_16x16x32_bf16 v[128:131], a[224:227], a[48:51], v[128:131]
s_or_b64 s[50:51], s[44:45], s[50:51]
ds_read_b128 a[232:235], v15 offset:20480
v_mfma_f32_16x16x32_bf16 v[132:135], a[224:227], a[52:55], v[132:135]
buffer_load_dwordx4 v[116:119], v30, s[16:19], s94 offen
v_mfma_f32_16x16x32_bf16 v[136:139], a[224:227], a[56:59], v[136:139]
s_cbranch_scc1 L_SLOW4
L_BACK4:
v_mfma_f32_16x16x32_bf16 v[140:143], a[224:227], a[60:63], v[140:143]
s_waitcnt lgkmcnt(1)
v_mfma_f32_16x16x32_bf16 v[144:147], a[228:231], a[48:51], v[144:147]
ds_read_b128 a[236:239], v15 offset:22528
v_mfma_f32_16x16x32_bf16 v[148:151], a[228:231], a[52:55], v[148:151]
v_perm_b32 v63, v48, v19, s52
v_mfma_f32_16x16x32_bf16 v[152:155], a[228:231], a[56:59], v[152:155]
ds_read_b32 a64, v63
v_perm_b32 v62, v48, v19, s53
v_mfma_f32_16x16x32_bf16 v[156:159], a[228:231], a[60:63], v[156:159]
s_waitcnt lgkmcnt(2)
ds_read_b32 a65, v62
buffer_load_dwordx4 v[88:91], v12, s[24:27], 0 offen offset:2048 sc1
v_mfma_f32_16x16x32_bf16 v[160:163], a[232:235], a[48:51], v[160:163]
ds_read_b128 a[240:243], v15 offset:24576
v_perm_b32 v61, v52, v19, s52
v_mfma_f32_16x16x32_bf16 v[164:167], a[232:235], a[52:55], v[164:167]
ds_read_b32 a66, v61
v_perm_b32 v60, v52, v19, s53
v_mfma_f32_16x16x32_bf16 v[168:171], a[232:235], a[56:59], v[168:171]
s_add_u32 m0, s33, 130560
ds_read_b32 a67, v60
v_perm_b32 v59, v48, v19, s54
v_mfma_f32_16x16x32_bf16 v[172:175], a[232:235], a[60:63], v[172:175]
s_waitcnt lgkmcnt(4)
ds_read_b32 a68, v59
v_perm_b32 v58, v48, v19, s55
v_mfma_f32_16x16x32_bf16 v[176:179], a[236:239], a[48:51], v[176:179]
ds_read_b128 a[244:247], v15 offset:26624
buffer_load_dwordx4 v8, s[20:23], 0 offen offset:512 lds
v_mfma_f32_16x16x32_bf16 v[180:183], a[236:239], a[52:55], v[180:183]
ds_read_b32 a69, v58
v_perm_b32 v57, v52, v19, s54
v_mfma_f32_16x16x32_bf16 v[184:187], a[236:239], a[56:59], v[184:187]
ds_read_b32 a70, v57
v_perm_b32 v56, v52, v19, s55
v_mfma_f32_16x16x32_bf16 v[188:191], a[236:239], a[60:63], v[188:191]
s_waitcnt lgkmcnt(4)
ds_read_b32 a71, v56
buffer_load_dwordx4 v[92:95], v12, s[24:27], 0 offen offset:3072 sc1
v_mfma_f32_16x16x32_bf16 v[192:195], a[240:243], a[48:51], v[192:195]
s_waitcnt vmcnt(15)
s_barrier
ds_read_b128 a[248:251], v15 offset:28672
v_perm_b32 v63, v49, v19, s52
v_mfma_f32_16x16x32_bf16 v[196:199], a[240:243], a[52:55], v[196:199]
ds_read_b32 a72, v63
v_perm_b32 v62, v49, v19, s53
v_mfma_f32_16x16x32_bf16 v[200:203], a[240:243], a[56:59], v[200:203]
ds_read_b32 a73, v62
v_perm_b32 v61, v53, v19, s52
v_mfma_f32_16x16x32_bf16 v[204:207], a[240:243], a[60:63], v[204:207]
s_waitcnt lgkmcnt(4)
ds_read_b32 a74, v61
v_add_u32 v12, 16384, v13
v_mfma_f32_16x16x32_bf16 v[208:211], a[244:247], a[48:51], v[208:211]
ds_read_b128 a[252:255], v15 offset:30720
v_perm_b32 v60, v53, v19, s53
v_mfma_f32_16x16x32_bf16 v[212:215], a[244:247], a[52:55], v[212:215]
ds_read_b32 a75, v60
v_perm_b32 v59, v49, v19, s54
v_mfma_f32_16x16x32_bf16 v[216:219], a[244:247], a[56:59], v[216:219]
ds_read_b32 a76, v59
v_perm_b32 v58, v49, v19, s55
v_mfma_f32_16x16x32_bf16 v[220:223], a[244:247], a[60:63], v[220:223]
s_waitcnt lgkmcnt(4)
ds_read_b32 a77, v58
v_mfma_f32_16x16x32_bf16 v[224:227], a[248:251], a[48:51], v[224:227]
ds_read_b128 a[224:227], v14 offset:32768
v_perm_b32 v57, v53, v19, s54
v_mfma_f32_16x16x32_bf16 v[228:231], a[248:251], a[52:55], v[228:231]
ds_read_b32 a78, v57
v_perm_b32 v56, v53, v19, s55
v_mfma_f32_16x16x32_bf16 v[232:235], a[248:251], a[56:59], v[232:235]
s_add_u32 m0, s33, 134656
ds_read_b32 a79, v56
v_mfma_f32_16x16x32_bf16 v[236:239], a[248:251], a[60:63], v[236:239]
s_waitcnt lgkmcnt(4)
v_mfma_f32_16x16x32_bf16 v[240:243], a[252:255], a[48:51], v[240:243]
ds_read_b128 a[228:231], v14 offset:34816
buffer_load_dwordx4 v9, s[20:23], 0 offen offset:512 lds
v_mfma_f32_16x16x32_bf16 v[244:247], a[252:255], a[52:55], v[244:247]
v_mfma_f32_16x16x32_bf16 v[248:251], a[252:255], a[56:59], v[248:251]
v_mfma_f32_16x16x32_bf16 v[252:255], a[252:255], a[60:63], v[252:255]
s_waitcnt vmcnt(8) lgkmcnt(1)
v_cmp_ne_u64 s[50:51], s[88:89], v[98:99]
v_cmp_ne_u64 s[44:45], s[88:89], v[102:103]
v_mfma_f32_16x16x32_bf16 v[128:131], a[224:227], a[64:67], v[128:131]
ds_read_b128 a[232:235], v14 offset:36864
v_mfma_f32_16x16x32_bf16 v[132:135], a[224:227], a[68:71], v[132:135]
s_or_b64 s[50:51], s[44:45], s[50:51]
v_mfma_f32_16x16x32_bf16 v[136:139], a[224:227], a[72:75], v[136:139]
s_cbranch_scc1 L_SLOW5
L_BACK5:
v_mfma_f32_16x16x32_bf16 v[140:143], a[224:227], a[76:79], v[140:143]
s_waitcnt lgkmcnt(1)
v_mfma_f32_16x16x32_bf16 v[144:147], a[228:231], a[64:67], v[144:147]
ds_read_b128 a[236:239], v14 offset:38912
v_mfma_f32_16x16x32_bf16 v[148:151], a[228:231], a[68:71], v[148:151]
v_perm_b32 v63, v96, v19, s52
v_mfma_f32_16x16x32_bf16 v[152:155], a[228:231], a[72:75], v[152:155]
s_add_u32 m0, s33, 138752
ds_read_b32 a80, v63
v_perm_b32 v62, v96, v19, s53
v_mfma_f32_16x16x32_bf16 v[156:159], a[228:231], a[76:79], v[156:159]
s_waitcnt lgkmcnt(2)
ds_read_b32 a81, v62
v_perm_b32 v61, v100, v19, s52
v_mfma_f32_16x16x32_bf16 v[160:163], a[232:235], a[64:67], v[160:163]
ds_read_b128 a[240:243], v14 offset:40960
buffer_load_dwordx4 v10, s[20:23], 0 offen offset:512 lds
v_mfma_f32_16x16x32_bf16 v[164:167], a[232:235], a[68:71], v[164:167]
ds_read_b32 a82, v61
v_perm_b32 v60, v100, v19, s53
v_mfma_f32_16x16x32_bf16 v[168:171], a[232:235], a[72:75], v[168:171]
ds_read_b32 a83, v60
v_perm_b32 v59, v96, v19, s54
v_mfma_f32_16x16x32_bf16 v[172:175], a[232:235], a[76:79], v[172:175]
s_waitcnt lgkmcnt(4)
ds_read_b32 a84, v59
buffer_load_dwordx4 v[32:35], v12, s[24:27], 0 offen offset:0 sc1
v_mfma_f32_16x16x32_bf16 v[176:179], a[236:239], a[64:67], v[176:179]
ds_read_b128 a[244:247], v14 offset:43008
v_perm_b32 v58, v96, v19, s55
v_mfma_f32_16x16x32_bf16 v[180:183], a[236:239], a[68:71], v[180:183]
ds_read_b32 a85, v58
v_perm_b32 v57, v100, v19, s54
v_mfma_f32_16x16x32_bf16 v[184:187], a[236:239], a[72:75], v[184:187]
ds_read_b32 a86, v57
v_perm_b32 v56, v100, v19, s55
v_mfma_f32_16x16x32_bf16 v[188:191], a[236:239], a[76:79], v[188:191]
s_waitcnt lgkmcnt(4)
ds_read_b32 a87, v56
buffer_load_dwordx4 v[36:39], v12, s[24:27], 0 offen offset:1024 sc1
v_mfma_f32_16x16x32_bf16 v[192:195], a[240:243], a[64:67], v[192:195]
ds_read_b128 a[248:251], v14 offset:45056
v_perm_b32 v63, v97, v19, s52
v_mfma_f32_16x16x32_bf16 v[196:199], a[240:243], a[68:71], v[196:199]
ds_read_b32 a88, v63
v_perm_b32 v62, v97, v19, s53
v_mfma_f32_16x16x32_bf16 v[200:203], a[240:243], a[72:75], v[200:203]
s_add_u32 m0, s33, 142848
ds_read_b32 a89, v62
v_perm_b32 v61, v101, v19, s52
v_mfma_f32_16x16x32_bf16 v[204:207], a[240:243], a[76:79], v[204:207]
s_waitcnt lgkmcnt(4)
ds_read_b32 a90, v61
v_perm_b32 v60, v101, v19, s53
v_mfma_f32_16x16x32_bf16 v[208:211], a[244:247], a[64:67], v[208:211]
ds_read_b128 a[252:255], v14 offset:47104
buffer_load_dwordx4 v11, s[20:23], 0 offen offset:512 lds
v_mfma_f32_16x16x32_bf16 v[212:215], a[244:247], a[68:71], v[212:215]
ds_read_b32 a91, v60
v_perm_b32 v59, v97, v19, s54
v_mfma_f32_16x16x32_bf16 v[216:219], a[244:247], a[72:75], v[216:219]
ds_read_b32 a92, v59
v_perm_b32 v58, v97, v19, s55
v_mfma_f32_16x16x32_bf16 v[220:223], a[244:247], a[76:79], v[220:223]
s_waitcnt lgkmcnt(4)
ds_read_b32 a93, v58
v_mfma_f32_16x16x32_bf16 v[224:227], a[248:251], a[64:67], v[224:227]
ds_read_b128 a[224:227], v15 offset:32768
v_perm_b32 v57, v101, v19, s54
v_mfma_f32_16x16x32_bf16 v[228:231], a[248:251], a[68:71], v[228:231]
L_PAD1:
s_cbranch_vccnz L_PAD2
ds_read_b32 a94, v57
v_perm_b32 v56, v101, v19, s55
v_mfma_f32_16x16x32_bf16 v[232:235], a[248:251], a[72:75], v[232:235]
ds_read_b32 a95, v56
v_mfma_f32_16x16x32_bf16 v[236:239], a[248:251], a[76:79], v[236:239]
s_waitcnt lgkmcnt(4)
v_mfma_f32_16x16x32_bf16 v[240:243], a[252:255], a[64:67], v[240:243]
ds_read_b128 a[228:231], v15 offset:34816
v_mfma_f32_16x16x32_bf16 v[244:247], a[252:255], a[68:71], v[244:247]
v_mfma_f32_16x16x32_bf16 v[248:251], a[252:255], a[72:75], v[248:251]
v_mfma_f32_16x16x32_bf16 v[252:255], a[252:255], a[76:79], v[252:255]
s_waitcnt vmcnt(9) lgkmcnt(1)
v_cmp_ne_u64 s[50:51], s[88:89], v[82:83]
v_cmp_ne_u64 s[44:45], s[88:89], v[86:87]
v_mfma_f32_16x16x32_bf16 v[128:131], a[224:227], a[80:83], v[128:131]
ds_read_b128 a[232:235], v15 offset:36864
v_mfma_f32_16x16x32_bf16 v[132:135], a[224:227], a[84:87], v[132:135]
s_or_b64 s[50:51], s[44:45], s[50:51]
v_mfma_f32_16x16x32_bf16 v[136:139], a[224:227], a[88:91], v[136:139]
s_cbranch_scc1 L_SLOW6
L_BACK6:
v_mfma_f32_16x16x32_bf16 v[140:143], a[224:227], a[92:95], v[140:143]
s_waitcnt lgkmcnt(1)
v_mfma_f32_16x16x32_bf16 v[144:147], a[228:231], a[80:83], v[144:147]
ds_read_b128 a[236:239], v15 offset:38912
v_perm_b32 v63, v80, v19, s52
v_mfma_f32_16x16x32_bf16 v[148:151], a[228:231], a[84:87], v[148:151]
ds_read_b32 a96, v63
v_perm_b32 v62, v80, v19, s53
v_mfma_f32_16x16x32_bf16 v[152:155], a[228:231], a[88:91], v[152:155]
ds_read_b32 a97, v62
v_perm_b32 v61, v84, v19, s52
v_mfma_f32_16x16x32_bf16 v[156:159], a[228:231], a[92:95], v[156:159]
s_waitcnt lgkmcnt(3)
ds_read_b32 a98, v61
v_mfma_f32_16x16x32_bf16 v[160:163], a[232:235], a[80:83], v[160:163]
ds_read_b128 a[240:243], v15 offset:40960
v_perm_b32 v60, v84, v19, s53
v_mfma_f32_16x16x32_bf16 v[164:167], a[232:235], a[84:87], v[164:167]
ds_read_b32 a99, v60
v_perm_b32 v59, v80, v19, s54
v_mfma_f32_16x16x32_bf16 v[168:171], a[232:235], a[88:91], v[168:171]
s_add_u32 m0, s33, 146816
ds_read_b32 a100, v59
v_perm_b32 v58, v80, v19, s55
v_mfma_f32_16x16x32_bf16 v[172:175], a[232:235], a[92:95], v[172:175]
s_waitcnt lgkmcnt(4)
ds_read_b32 a101, v58
v_perm_b32 v57, v84, v19, s54
v_mfma_f32_16x16x32_bf16 v[176:179], a[236:239], a[80:83], v[176:179]
ds_read_b128 a[244:247], v15 offset:43008
buffer_load_dwordx4 v8, s[20:23], 0 offen offset:640 lds
v_mfma_f32_16x16x32_bf16 v[180:183], a[236:239], a[84:87], v[180:183]
ds_read_b32 a102, v57
v_perm_b32 v56, v84, v19, s55
v_mfma_f32_16x16x32_bf16 v[184:187], a[236:239], a[88:91], v[184:187]
ds_read_b32 a103, v56
v_perm_b32 v63, v81, v19, s52
v_mfma_f32_16x16x32_bf16 v[188:191], a[236:239], a[92:95], v[188:191]
s_waitcnt lgkmcnt(4)
ds_read_b32 a104, v63
buffer_load_dwordx4 v[40:43], v12, s[24:27], 0 offen offset:2048 sc1
v_mfma_f32_16x16x32_bf16 v[192:195], a[240:243], a[80:83], v[192:195]
s_barrier
ds_read_b128 a[248:251], v15 offset:45056
buffer_load_dwordx4 v[44:47], v12, s[24:27], 0 offen offset:3072 sc1
v_mfma_f32_16x16x32_bf16 v[196:199], a[240:243], a[84:87], v[196:199]
s_waitcnt vmcnt(11)
v_perm_b32 v62, v81, v19, s53
v_lshl_add_u64 v[104:105], v[108:109], 4, v[104:105]
v_mfma_f32_16x16x32_bf16 v[200:203], a[240:243], a[88:91], v[200:203]
ds_read_b32 a105, v62
v_perm_b32 v61, v85, v19, s52
v_mfma_f32_16x16x32_bf16 v[204:207], a[240:243], a[92:95], v[204:207]
s_waitcnt lgkmcnt(3)
ds_read_b32 a106, v61
v_perm_b32 v60, v85, v19, s53
v_mfma_f32_16x16x32_bf16 v[208:211], a[244:247], a[80:83], v[208:211]
ds_read_b128 a[252:255], v15 offset:47104
v_lshl_add_u64 v[106:107], v[110:111], 4, v[106:107]
v_mfma_f32_16x16x32_bf16 v[212:215], a[244:247], a[84:87], v[212:215]
ds_read_b32 a107, v60
v_perm_b32 v59, v81, v19, s54
v_mfma_f32_16x16x32_bf16 v[216:219], a[244:247], a[88:91], v[216:219]
ds_read_b32 a108, v59
v_perm_b32 v58, v81, v19, s55
v_mfma_f32_16x16x32_bf16 v[220:223], a[244:247], a[92:95], v[220:223]
s_waitcnt lgkmcnt(4)
ds_read_b32 a109, v58
v_lshl_add_u64 v[112:113], v[116:117], 4, v[112:113]
v_mfma_f32_16x16x32_bf16 v[224:227], a[248:251], a[80:83], v[224:227]
ds_read_b128 a[224:227], v14 offset:49152
v_perm_b32 v57, v85, v19, s54
v_mfma_f32_16x16x32_bf16 v[228:231], a[248:251], a[84:87], v[228:231]
ds_read_b32 a110, v57
v_perm_b32 v56, v85, v19, s55
v_mfma_f32_16x16x32_bf16 v[232:235], a[248:251], a[88:91], v[232:235]
s_add_u32 m0, s33, 150912
ds_read_b32 a111, v56
v_lshl_add_u64 v[114:115], v[118:119], 4, v[114:115]
v_mfma_f32_16x16x32_bf16 v[236:239], a[248:251], a[92:95], v[236:239]
s_waitcnt vmcnt(8) lgkmcnt(4)
v_cmp_ne_u64 s[50:51], s[88:89], v[90:91]
v_cmp_ne_u64 s[44:45], s[88:89], v[94:95]
v_mfma_f32_16x16x32_bf16 v[240:243], a[252:255], a[80:83], v[240:243]
ds_read_b128 a[228:231], v14 offset:51200
buffer_load_dwordx4 v9, s[20:23], 0 offen offset:640 lds
v_mfma_f32_16x16x32_bf16 v[244:247], a[252:255], a[84:87], v[244:247]
s_or_b64 s[50:51], s[44:45], s[50:51]
v_lshl_or_b32 v104, v112, 8, v104
v_add_u32 v12, 20480, v13
v_mfma_f32_16x16x32_bf16 v[248:251], a[252:255], a[88:91], v[248:251]
s_cbranch_scc1 L_SLOW7
L_BACK7:
v_mfma_f32_16x16x32_bf16 v[252:255], a[252:255], a[92:95], v[252:255]
s_waitcnt lgkmcnt(1)
v_mfma_f32_16x16x32_bf16 v[128:131], a[224:227], a[96:99], v[128:131]
ds_read_b128 a[232:235], v14 offset:53248
v_lshl_or_b32 v105, v113, 8, v105
v_mfma_f32_16x16x32_bf16 v[132:135], a[224:227], a[100:103], v[132:135]
v_perm_b32 v63, v88, v19, s52
v_mfma_f32_16x16x32_bf16 v[136:139], a[224:227], a[104:107], v[136:139]
ds_read_b32 a112, v63
v_perm_b32 v62, v88, v19, s53
v_mfma_f32_16x16x32_bf16 v[140:143], a[224:227], a[108:111], v[140:143]
s_waitcnt lgkmcnt(2)
ds_read_b32 a113, v62
v_lshl_or_b32 v106, v114, 8, v106
v_mfma_f32_16x16x32_bf16 v[144:147], a[228:231], a[96:99], v[144:147]
ds_read_b128 a[236:239], v14 offset:55296
v_perm_b32 v61, v92, v19, s52
v_mfma_f32_16x16x32_bf16 v[148:151], a[228:231], a[100:103], v[148:151]
ds_read_b32 a114, v61
v_mfma_f32_16x16x32_bf16 v[152:155], a[228:231], a[104:107], v[152:155]
s_add_u32 m0, s33, 155008
v_perm_b32 v60, v92, v19, s53
v_lshl_or_b32 v107, v115, 8, v107
v_mfma_f32_16x16x32_bf16 v[156:159], a[228:231], a[108:111], v[156:159]
s_waitcnt lgkmcnt(3)
ds_read_b32 a115, v60
v_mfma_f32_16x16x32_bf16 v[160:163], a[232:235], a[96:99], v[160:163]
ds_read_b128 a[240:243], v14 offset:57344
buffer_load_dwordx4 v10, s[20:23], 0 offen offset:640 lds
v_mfma_f32_16x16x32_bf16 v[164:167], a[232:235], a[100:103], v[164:167]
v_perm_b32 v59, v88, v19, s54
v_lshl_or_b32 v108, v105, 16, v104
v_mfma_f32_16x16x32_bf16 v[168:171], a[232:235], a[104:107], v[168:171]
ds_read_b32 a116, v59
v_perm_b32 v58, v88, v19, s55
v_mfma_f32_16x16x32_bf16 v[172:175], a[232:235], a[108:111], v[172:175]
s_waitcnt lgkmcnt(3)
ds_read_b32 a117, v58
v_perm_b32 v57, v92, v19, s54
v_mfma_f32_16x16x32_bf16 v[176:179], a[236:239], a[96:99], v[176:179]
ds_read_b128 a[244:247], v14 offset:59392
v_lshl_or_b32 v109, v107, 16, v106
v_mfma_f32_16x16x32_bf16 v[180:183], a[236:239], a[100:103], v[180:183]
ds_read_b32 a118, v57
v_perm_b32 v56, v92, v19, s55
v_mfma_f32_16x16x32_bf16 v[184:187], a[236:239], a[104:107], v[184:187]
ds_read_b32 a119, v56
v_perm_b32 v63, v89, v19, s52
v_mfma_f32_16x16x32_bf16 v[188:191], a[236:239], a[108:111], v[188:191]
s_waitcnt lgkmcnt(4)
ds_read_b32 a120, v63
v_mov_b64 v[110:111], s[88:89]
v_mfma_f32_16x16x32_bf16 v[192:195], a[240:243], a[96:99], v[192:195]
ds_read_b128 a[248:251], v14 offset:61440
v_perm_b32 v62, v89, v19, s53
v_mfma_f32_16x16x32_bf16 v[196:199], a[240:243], a[100:103], v[196:199]
ds_read_b32 a121, v62
v_perm_b32 v61, v93, v19, s52
v_mfma_f32_16x16x32_bf16 v[200:203], a[240:243], a[104:107], v[200:203]
s_add_u32 m0, s33, 159104
ds_read_b32 a122, v61
v_perm_b32 v60, v93, v19, s53
v_mfma_f32_16x16x32_bf16 v[204:207], a[240:243], a[108:111], v[204:207]
s_waitcnt lgkmcnt(4)
ds_read_b32 a123, v60
v_perm_b32 v59, v89, v19, s54
v_mfma_f32_16x16x32_bf16 v[208:211], a[244:247], a[96:99], v[208:211]
ds_read_b128 a[252:255], v14 offset:63488
buffer_load_dwordx4 v11, s[20:23], 0 offen offset:640 lds
v_mfma_f32_16x16x32_bf16 v[212:215], a[244:247], a[100:103], v[212:215]
buffer_store_dwordx4 v[108:111], v13, s[76:79], 0 offen sc1
v_mfma_f32_16x16x32_bf16 v[216:219], a[244:247], a[104:107], v[216:219]
ds_read_b32 a124, v59
v_perm_b32 v58, v89, v19, s55
v_mfma_f32_16x16x32_bf16 v[220:223], a[244:247], a[108:111], v[220:223]
s_waitcnt lgkmcnt(3)
ds_read_b32 a125, v58
buffer_load_dwordx4 v[48:51], v12, s[24:27], 0 offen offset:0 sc1
v_mfma_f32_16x16x32_bf16 v[224:227], a[248:251], a[96:99], v[224:227]
ds_read_b128 a[224:227], v15 offset:49152
v_perm_b32 v57, v93, v19, s54
v_mfma_f32_16x16x32_bf16 v[228:231], a[248:251], a[100:103], v[228:231]
ds_read_b32 a126, v57
v_perm_b32 v56, v93, v19, s55
v_mfma_f32_16x16x32_bf16 v[232:235], a[248:251], a[104:107], v[232:235]
ds_read_b32 a127, v56
buffer_load_dwordx4 v[52:55], v12, s[24:27], 0 offen offset:1024 sc1
v_mfma_f32_16x16x32_bf16 v[236:239], a[248:251], a[108:111], v[236:239]
s_waitcnt lgkmcnt(4)
v_mfma_f32_16x16x32_bf16 v[240:243], a[252:255], a[96:99], v[240:243]
ds_read_b128 a[228:231], v15 offset:51200
v_mfma_f32_16x16x32_bf16 v[244:247], a[252:255], a[100:103], v[244:247]
v_mfma_f32_16x16x32_bf16 v[248:251], a[252:255], a[104:107], v[248:251]
v_mfma_f32_16x16x32_bf16 v[252:255], a[252:255], a[108:111], v[252:255]
s_waitcnt vmcnt(10) lgkmcnt(1)
v_cmp_ne_u64 s[50:51], s[88:89], v[34:35]
v_cmp_ne_u64 s[44:45], s[88:89], v[38:39]
v_mfma_f32_16x16x32_bf16 v[128:131], a[224:227], a[112:115], v[128:131]
ds_read_b128 a[232:235], v15 offset:53248
v_mfma_f32_16x16x32_bf16 v[132:135], a[224:227], a[116:119], v[132:135]
s_or_b64 s[50:51], s[44:45], s[50:51]
v_mfma_f32_16x16x32_bf16 v[136:139], a[224:227], a[120:123], v[136:139]
s_cbranch_scc1 L_SLOW8
L_BACK8:
v_mfma_f32_16x16x32_bf16 v[140:143], a[224:227], a[124:127], v[140:143]
s_waitcnt lgkmcnt(1)
v_mfma_f32_16x16x32_bf16 v[144:147], a[228:231], a[112:115], v[144:147]
ds_read_b128 a[236:239], v15 offset:55296
v_mfma_f32_16x16x32_bf16 v[148:151], a[228:231], a[116:119], v[148:151]
v_perm_b32 v63, v32, v19, s52
v_mfma_f32_16x16x32_bf16 v[152:155], a[228:231], a[120:123], v[152:155]
ds_read_b32 a128, v63
v_perm_b32 v62, v32, v19, s53
v_mfma_f32_16x16x32_bf16 v[156:159], a[228:231], a[124:127], v[156:159]
s_waitcnt lgkmcnt(2)
ds_read_b32 a129, v62
v_mfma_f32_16x16x32_bf16 v[160:163], a[232:235], a[112:115], v[160:163]
ds_read_b128 a[240:243], v15 offset:57344
v_perm_b32 v61, v36, v19, s52
v_mfma_f32_16x16x32_bf16 v[164:167], a[232:235], a[116:119], v[164:167]
ds_read_b32 a130, v61
v_perm_b32 v60, v36, v19, s53
v_mfma_f32_16x16x32_bf16 v[168:171], a[232:235], a[120:123], v[168:171]
s_add_u32 m0, s33, 64768
ds_read_b32 a131, v60
v_perm_b32 v59, v32, v19, s54
v_mfma_f32_16x16x32_bf16 v[172:175], a[232:235], a[124:127], v[172:175]
s_waitcnt lgkmcnt(4)
ds_read_b32 a132, v59
v_perm_b32 v58, v32, v19, s55
v_mfma_f32_16x16x32_bf16 v[176:179], a[236:239], a[112:115], v[176:179]
ds_read_b128 a[244:247], v15 offset:59392
buffer_load_dwordx4 v8, s[20:23], 0 offen offset:768 lds
v_mfma_f32_16x16x32_bf16 v[180:183], a[236:239], a[116:119], v[180:183]
ds_read_b32 a133, v58
v_perm_b32 v57, v36, v19, s54
v_mfma_f32_16x16x32_bf16 v[184:187], a[236:239], a[120:123], v[184:187]
ds_read_b32 a134, v57
v_perm_b32 v56, v36, v19, s55
v_mfma_f32_16x16x32_bf16 v[188:191], a[236:239], a[124:127], v[188:191]
s_waitcnt lgkmcnt(4)
ds_read_b32 a135, v56
buffer_load_dwordx4 v[96:99], v12, s[24:27], 0 offen offset:2048 sc1
v_mfma_f32_16x16x32_bf16 v[192:195], a[240:243], a[112:115], v[192:195]
s_waitcnt vmcnt(11)
s_barrier
ds_read_b128 a[248:251], v15 offset:61440
v_perm_b32 v63, v33, v19, s52
v_mfma_f32_16x16x32_bf16 v[196:199], a[240:243], a[116:119], v[196:199]
ds_read_b32 a136, v63
v_perm_b32 v62, v33, v19, s53
v_mfma_f32_16x16x32_bf16 v[200:203], a[240:243], a[120:123], v[200:203]
ds_read_b32 a137, v62
v_perm_b32 v61, v37, v19, s52
v_mfma_f32_16x16x32_bf16 v[204:207], a[240:243], a[124:127], v[204:207]
s_waitcnt lgkmcnt(4)
ds_read_b32 a138, v61
buffer_load_dwordx4 v[100:103], v12, s[24:27], 0 offen offset:3072 sc1
v_mfma_f32_16x16x32_bf16 v[208:211], a[244:247], a[112:115], v[208:211]
ds_read_b128 a[252:255], v15 offset:63488
v_perm_b32 v60, v37, v19, s53
v_mfma_f32_16x16x32_bf16 v[212:215], a[244:247], a[116:119], v[212:215]
ds_read_b32 a139, v60
v_perm_b32 v59, v33, v19, s54
v_mfma_f32_16x16x32_bf16 v[216:219], a[244:247], a[120:123], v[216:219]
ds_read_b32 a140, v59
v_perm_b32 v58, v33, v19, s55
v_mfma_f32_16x16x32_bf16 v[220:223], a[244:247], a[124:127], v[220:223]
s_waitcnt lgkmcnt(4)
ds_read_b32 a141, v58
v_add_u32 v12, 24576, v13
v_mfma_f32_16x16x32_bf16 v[224:227], a[248:251], a[112:115], v[224:227]
ds_read_b128 a[224:227], v16 offset:0
v_perm_b32 v57, v37, v19, s54
v_mfma_f32_16x16x32_bf16 v[228:231], a[248:251], a[116:119], v[228:231]
ds_read_b32 a142, v57
v_perm_b32 v56, v37, v19, s55
v_mfma_f32_16x16x32_bf16 v[232:235], a[248:251], a[120:123], v[232:235]
s_add_u32 m0, s33, 68864
ds_read_b32 a143, v56
v_mfma_f32_16x16x32_bf16 v[236:239], a[248:251], a[124:127], v[236:239]
s_waitcnt lgkmcnt(4)
v_mfma_f32_16x16x32_bf16 v[240:243], a[252:255], a[112:115], v[240:243]
ds_read_b128 a[228:231], v16 offset:2048
buffer_load_dwordx4 v9, s[20:23], 0 offen offset:768 lds
v_mfma_f32_16x16x32_bf16 v[244:247], a[252:255], a[116:119], v[244:247]
v_mfma_f32_16x16x32_bf16 v[248:251], a[252:255], a[120:123], v[248:251]
v_mfma_f32_16x16x32_bf16 v[252:255], a[252:255], a[124:127], v[252:255]
s_waitcnt vmcnt(10) lgkmcnt(1)
v_cmp_ne_u64 s[50:51], s[88:89], v[42:43]
v_cmp_ne_u64 s[44:45], s[88:89], v[46:47]
v_mfma_f32_16x16x32_bf16 v[128:131], a[224:227], a[128:131], v[128:131]
ds_read_b128 a[232:235], v16 offset:4096
v_mfma_f32_16x16x32_bf16 v[132:135], a[224:227], a[132:135], v[132:135]
s_or_b64 s[50:51], s[44:45], s[50:51]
v_mfma_f32_16x16x32_bf16 v[136:139], a[224:227], a[136:139], v[136:139]
s_cbranch_scc1 L_SLOW9
L_BACK9:
v_mfma_f32_16x16x32_bf16 v[140:143], a[224:227], a[140:143], v[140:143]
s_waitcnt lgkmcnt(1)
v_mfma_f32_16x16x32_bf16 v[144:147], a[228:231], a[128:131], v[144:147]
ds_read_b128 a[236:239], v16 offset:6144
v_mfma_f32_16x16x32_bf16 v[148:151], a[228:231], a[132:135], v[148:151]
v_perm_b32 v63, v40, v19, s52
v_mfma_f32_16x16x32_bf16 v[152:155], a[228:231], a[136:139], v[152:155]
s_add_u32 m0, s33, 72960
ds_read_b32 a144, v63
v_perm_b32 v62, v40, v19, s53
v_mfma_f32_16x16x32_bf16 v[156:159], a[228:231], a[140:143], v[156:159]
s_waitcnt lgkmcnt(2)
ds_read_b32 a145, v62
v_perm_b32 v61, v44, v19, s52
v_mfma_f32_16x16x32_bf16 v[160:163], a[232:235], a[128:131], v[160:163]
ds_read_b128 a[240:243], v16 offset:8192
buffer_load_dwordx4 v10, s[20:23], 0 offen offset:768 lds
v_mfma_f32_16x16x32_bf16 v[164:167], a[232:235], a[132:135], v[164:167]
ds_read_b32 a146, v61
v_perm_b32 v60, v44, v19, s53
v_mfma_f32_16x16x32_bf16 v[168:171], a[232:235], a[136:139], v[168:171]
ds_read_b32 a147, v60
v_perm_b32 v59, v40, v19, s54
v_mfma_f32_16x16x32_bf16 v[172:175], a[232:235], a[140:143], v[172:175]
s_waitcnt lgkmcnt(4)
ds_read_b32 a148, v59
buffer_load_dwordx4 v[80:83], v12, s[24:27], 0 offen offset:0 sc1
v_mfma_f32_16x16x32_bf16 v[176:179], a[236:239], a[128:131], v[176:179]
ds_read_b128 a[244:247], v16 offset:10240
v_perm_b32 v58, v40, v19, s55
v_mfma_f32_16x16x32_bf16 v[180:183], a[236:239], a[132:135], v[180:183]
ds_read_b32 a149, v58
v_perm_b32 v57, v44, v19, s54
v_mfma_f32_16x16x32_bf16 v[184:187], a[236:239], a[136:139], v[184:187]
ds_read_b32 a150, v57
v_perm_b32 v56, v44, v19, s55
v_mfma_f32_16x16x32_bf16 v[188:191], a[236:239], a[140:143], v[188:191]
s_waitcnt lgkmcnt(4)
ds_read_b32 a151, v56
buffer_load_dwordx4 v[84:87], v12, s[24:27], 0 offen offset:1024 sc1
v_mfma_f32_16x16x32_bf16 v[192:195], a[240:243], a[128:131], v[192:195]
ds_read_b128 a[248:251], v16 offset:12288
v_perm_b32 v63, v41, v19, s52
v_mfma_f32_16x16x32_bf16 v[196:199], a[240:243], a[132:135], v[196:199]
ds_read_b32 a152, v63
v_perm_b32 v62, v41, v19, s53
v_mfma_f32_16x16x32_bf16 v[200:203], a[240:243], a[136:139], v[200:203]
s_add_u32 m0, s33, 77056
ds_read_b32 a153, v62
v_perm_b32 v61, v45, v19, s52
v_mfma_f32_16x16x32_bf16 v[204:207], a[240:243], a[140:143], v[204:207]
s_waitcnt lgkmcnt(4)
ds_read_b32 a154, v61
v_perm_b32 v60, v45, v19, s53
v_mfma_f32_16x16x32_bf16 v[208:211], a[244:247], a[128:131], v[208:211]
ds_read_b128 a[252:255], v16 offset:14336
buffer_load_dwordx4 v11, s[20:23], 0 offen offset:768 lds
v_mfma_f32_16x16x32_bf16 v[212:215], a[244:247], a[132:135], v[212:215]
ds_read_b32 a155, v60
v_perm_b32 v59, v41, v19, s54
v_mfma_f32_16x16x32_bf16 v[216:219], a[244:247], a[136:139], v[216:219]
ds_read_b32 a156, v59
v_perm_b32 v58, v41, v19, s55
v_mfma_f32_16x16x32_bf16 v[220:223], a[244:247], a[140:143], v[220:223]
s_waitcnt lgkmcnt(4)
ds_read_b32 a157, v58
v_mfma_f32_16x16x32_bf16 v[224:227], a[248:251], a[128:131], v[224:227]
ds_read_b128 a[224:227], v17 offset:0
v_perm_b32 v57, v45, v19, s54
v_mfma_f32_16x16x32_bf16 v[228:231], a[248:251], a[132:135], v[228:231]
ds_read_b32 a158, v57
v_perm_b32 v56, v45, v19, s55
v_mfma_f32_16x16x32_bf16 v[232:235], a[248:251], a[136:139], v[232:235]
ds_read_b32 a159, v56
v_mfma_f32_16x16x32_bf16 v[236:239], a[248:251], a[140:143], v[236:239]
s_waitcnt lgkmcnt(4)
v_mfma_f32_16x16x32_bf16 v[240:243], a[252:255], a[128:131], v[240:243]
ds_read_b128 a[228:231], v17 offset:2048
v_mfma_f32_16x16x32_bf16 v[244:247], a[252:255], a[132:135], v[244:247]
v_mfma_f32_16x16x32_bf16 v[248:251], a[252:255], a[136:139], v[248:251]
v_mfma_f32_16x16x32_bf16 v[252:255], a[252:255], a[140:143], v[252:255]
s_waitcnt vmcnt(8) lgkmcnt(1)
v_cmp_ne_u64 s[50:51], s[88:89], v[50:51]
v_cmp_ne_u64 s[44:45], s[88:89], v[54:55]
v_mfma_f32_16x16x32_bf16 v[128:131], a[224:227], a[144:147], v[128:131]
ds_read_b128 a[232:235], v17 offset:4096
v_mfma_f32_16x16x32_bf16 v[132:135], a[224:227], a[148:151], v[132:135]
s_or_b64 s[50:51], s[44:45], s[50:51]
v_mfma_f32_16x16x32_bf16 v[136:139], a[224:227], a[152:155], v[136:139]
s_cbranch_scc1 L_SLOW10
L_BACK10:
v_mfma_f32_16x16x32_bf16 v[140:143], a[224:227], a[156:159], v[140:143]
s_waitcnt lgkmcnt(1)
v_mfma_f32_16x16x32_bf16 v[144:147], a[228:231], a[144:147], v[144:147]
ds_read_b128 a[236:239], v17 offset:6144
v_mfma_f32_16x16x32_bf16 v[148:151], a[228:231], a[148:151], v[148:151]
v_perm_b32 v63, v48, v19, s52
v_mfma_f32_16x16x32_bf16 v[152:155], a[228:231], a[152:155], v[152:155]
ds_read_b32 a160, v63
v_perm_b32 v62, v48, v19, s53
v_mfma_f32_16x16x32_bf16 v[156:159], a[228:231], a[156:159], v[156:159]
s_waitcnt lgkmcnt(2)
ds_read_b32 a161, v62
v_mfma_f32_16x16x32_bf16 v[160:163], a[232:235], a[144:147], v[160:163]
ds_read_b128 a[240:243], v17 offset:8192
v_perm_b32 v61, v52, v19, s52
v_mfma_f32_16x16x32_bf16 v[164:167], a[232:235], a[148:151], v[164:167]
ds_read_b32 a162, v61
v_perm_b32 v60, v52, v19, s53
v_mfma_f32_16x16x32_bf16 v[168:171], a[232:235], a[152:155], v[168:171]
s_add_u32 m0, s33, 81024
ds_read_b32 a163, v60
v_perm_b32 v59, v48, v19, s54
v_mfma_f32_16x16x32_bf16 v[172:175], a[232:235], a[156:159], v[172:175]
s_waitcnt lgkmcnt(4)
ds_read_b32 a164, v59
v_perm_b32 v58, v48, v19, s55
v_mfma_f32_16x16x32_bf16 v[176:179], a[236:239], a[144:147], v[176:179]
ds_read_b128 a[244:247], v17 offset:10240
buffer_load_dwordx4 v8, s[20:23], 0 offen offset:896 lds
v_mfma_f32_16x16x32_bf16 v[180:183], a[236:239], a[148:151], v[180:183]
ds_read_b32 a165, v58
v_perm_b32 v57, v52, v19, s54
v_mfma_f32_16x16x32_bf16 v[184:187], a[236:239], a[152:155], v[184:187]
ds_read_b32 a166, v57
v_perm_b32 v56, v52, v19, s55
v_mfma_f32_16x16x32_bf16 v[188:191], a[236:239], a[156:159], v[188:191]
s_waitcnt lgkmcnt(4)
ds_read_b32 a167, v56
buffer_load_dwordx4 v[88:91], v12, s[24:27], 0 offen offset:2048 sc1
v_mfma_f32_16x16x32_bf16 v[192:195], a[240:243], a[144:147], v[192:195]
s_barrier
ds_read_b128 a[248:251], v17 offset:12288
v_perm_b32 v63, v49, v19, s52
v_mfma_f32_16x16x32_bf16 v[196:199], a[240:243], a[148:151], v[196:199]
ds_read_b32 a168, v63
v_perm_b32 v62, v49, v19, s53
v_mfma_f32_16x16x32_bf16 v[200:203], a[240:243], a[152:155], v[200:203]
ds_read_b32 a169, v62
v_perm_b32 v61, v53, v19, s52
v_mfma_f32_16x16x32_bf16 v[204:207], a[240:243], a[156:159], v[204:207]
s_waitcnt lgkmcnt(4)
ds_read_b32 a170, v61
buffer_load_dwordx4 v[92:95], v12, s[24:27], 0 offen offset:3072 sc1
v_mfma_f32_16x16x32_bf16 v[208:211], a[244:247], a[144:147], v[208:211]
ds_read_b128 a[252:255], v17 offset:14336
v_perm_b32 v60, v53, v19, s53
v_mfma_f32_16x16x32_bf16 v[212:215], a[244:247], a[148:151], v[212:215]
ds_read_b32 a171, v60
v_perm_b32 v59, v49, v19, s54
v_mfma_f32_16x16x32_bf16 v[216:219], a[244:247], a[152:155], v[216:219]
ds_read_b32 a172, v59
v_perm_b32 v58, v49, v19, s55
v_mfma_f32_16x16x32_bf16 v[220:223], a[244:247], a[156:159], v[220:223]
s_waitcnt lgkmcnt(4)
ds_read_b32 a173, v58
v_add_u32 v12, 28672, v13
v_mfma_f32_16x16x32_bf16 v[224:227], a[248:251], a[144:147], v[224:227]
ds_read_b128 a[224:227], v16 offset:16384
v_perm_b32 v57, v53, v19, s54
v_mfma_f32_16x16x32_bf16 v[228:231], a[248:251], a[148:151], v[228:231]
ds_read_b32 a174, v57
v_perm_b32 v56, v53, v19, s55
v_mfma_f32_16x16x32_bf16 v[232:235], a[248:251], a[152:155], v[232:235]
s_add_u32 m0, s33, 85120
ds_read_b32 a175, v56
v_mfma_f32_16x16x32_bf16 v[236:239], a[248:251], a[156:159], v[236:239]
s_waitcnt lgkmcnt(4)
v_mfma_f32_16x16x32_bf16 v[240:243], a[252:255], a[144:147], v[240:243]
ds_read_b128 a[228:231], v16 offset:18432
buffer_load_dwordx4 v9, s[20:23], 0 offen offset:896 lds
v_mfma_f32_16x16x32_bf16 v[244:247], a[252:255], a[148:151], v[244:247]
v_mfma_f32_16x16x32_bf16 v[248:251], a[252:255], a[152:155], v[248:251]
v_mfma_f32_16x16x32_bf16 v[252:255], a[252:255], a[156:159], v[252:255]
s_waitcnt vmcnt(9) lgkmcnt(1)
v_cmp_ne_u64 s[50:51], s[88:89], v[98:99]
v_cmp_ne_u64 s[44:45], s[88:89], v[102:103]
v_mfma_f32_16x16x32_bf16 v[128:131], a[224:227], a[160:163], v[128:131]
ds_read_b128 a[232:235], v16 offset:20480
v_mfma_f32_16x16x32_bf16 v[132:135], a[224:227], a[164:167], v[132:135]
s_or_b64 s[50:51], s[44:45], s[50:51]
v_mfma_f32_16x16x32_bf16 v[136:139], a[224:227], a[168:171], v[136:139]
s_cbranch_scc1 L_SLOW11
L_BACK11:
v_mfma_f32_16x16x32_bf16 v[140:143], a[224:227], a[172:175], v[140:143]
s_waitcnt lgkmcnt(1)
v_mfma_f32_16x16x32_bf16 v[144:147], a[228:231], a[160:163], v[144:147]
ds_read_b128 a[236:239], v16 offset:22528
v_mfma_f32_16x16x32_bf16 v[148:151], a[228:231], a[164:167], v[148:151]
v_perm_b32 v63, v96, v19, s52
v_mfma_f32_16x16x32_bf16 v[152:155], a[228:231], a[168:171], v[152:155]
s_add_u32 m0, s33, 89216
ds_read_b32 a176, v63
v_perm_b32 v62, v96, v19, s53
v_mfma_f32_16x16x32_bf16 v[156:159], a[228:231], a[172:175], v[156:159]
s_waitcnt lgkmcnt(2)
ds_read_b32 a177, v62
v_perm_b32 v61, v100, v19, s52
v_mfma_f32_16x16x32_bf16 v[160:163], a[232:235], a[160:163], v[160:163]
ds_read_b128 a[240:243], v16 offset:24576
buffer_load_dwordx4 v10, s[20:23], 0 offen offset:896 lds
v_mfma_f32_16x16x32_bf16 v[164:167], a[232:235], a[164:167], v[164:167]
ds_read_b32 a178, v61
v_perm_b32 v60, v100, v19, s53
v_mfma_f32_16x16x32_bf16 v[168:171], a[232:235], a[168:171], v[168:171]
ds_read_b32 a179, v60
v_perm_b32 v59, v96, v19, s54
v_mfma_f32_16x16x32_bf16 v[172:175], a[232:235], a[172:175], v[172:175]
s_waitcnt lgkmcnt(4)
ds_read_b32 a180, v59
buffer_load_dwordx4 v[32:35], v12, s[24:27], 0 offen offset:0 sc1
v_mfma_f32_16x16x32_bf16 v[176:179], a[236:239], a[160:163], v[176:179]
ds_read_b128 a[244:247], v16 offset:26624
v_perm_b32 v58, v96, v19, s55
v_mfma_f32_16x16x32_bf16 v[180:183], a[236:239], a[164:167], v[180:183]
ds_read_b32 a181, v58
v_perm_b32 v57, v100, v19, s54
v_mfma_f32_16x16x32_bf16 v[184:187], a[236:239], a[168:171], v[184:187]
ds_read_b32 a182, v57
v_perm_b32 v56, v100, v19, s55
v_mfma_f32_16x16x32_bf16 v[188:191], a[236:239], a[172:175], v[188:191]
s_waitcnt lgkmcnt(4)
ds_read_b32 a183, v56
buffer_load_dwordx4 v[36:39], v12, s[24:27], 0 offen offset:1024 sc1
v_mfma_f32_16x16x32_bf16 v[192:195], a[240:243], a[160:163], v[192:195]
ds_read_b128 a[248:251], v16 offset:28672
v_perm_b32 v63, v97, v19, s52
v_mfma_f32_16x16x32_bf16 v[196:199], a[240:243], a[164:167], v[196:199]
ds_read_b32 a184, v63
v_perm_b32 v62, v97, v19, s53
v_mfma_f32_16x16x32_bf16 v[200:203], a[240:243], a[168:171], v[200:203]
s_add_u32 m0, s33, 93312
ds_read_b32 a185, v62
v_perm_b32 v61, v101, v19, s52
v_mfma_f32_16x16x32_bf16 v[204:207], a[240:243], a[172:175], v[204:207]
s_waitcnt lgkmcnt(4)
ds_read_b32 a186, v61
v_perm_b32 v60, v101, v19, s53
v_mfma_f32_16x16x32_bf16 v[208:211], a[244:247], a[160:163], v[208:211]
L_PAD2:
s_cbranch_vccnz L_PADRET
ds_read_b128 a[252:255], v16 offset:30720
buffer_load_dwordx4 v11, s[20:23], 0 offen offset:896 lds
v_mfma_f32_16x16x32_bf16 v[212:215], a[244:247], a[164:167], v[212:215]
ds_read_b32 a187, v60
v_perm_b32 v59, v97, v19, s54
v_mfma_f32_16x16x32_bf16 v[216:219], a[244:247], a[168:171], v[216:219]
ds_read_b32 a188, v59
v_perm_b32 v58, v97, v19, s55
v_mfma_f32_16x16x32_bf16 v[220:223], a[244:247], a[172:175], v[220:223]
s_waitcnt lgkmcnt(4)
ds_read_b32 a189, v58
v_mfma_f32_16x16x32_bf16 v[224:227], a[248:251], a[160:163], v[224:227]
ds_read_b128 a[224:227], v17 offset:16384
v_perm_b32 v57, v101, v19, s54
v_mfma_f32_16x16x32_bf16 v[228:231], a[248:251], a[164:167], v[228:231]
ds_read_b32 a190, v57
v_perm_b32 v56, v101, v19, s55
v_mfma_f32_16x16x32_bf16 v[232:235], a[248:251], a[168:171], v[232:235]
ds_read_b32 a191, v56
v_mfma_f32_16x16x32_bf16 v[236:239], a[248:251], a[172:175], v[236:239]
s_waitcnt lgkmcnt(4)
v_mfma_f32_16x16x32_bf16 v[240:243], a[252:255], a[160:163], v[240:243]
ds_read_b128 a[228:231], v17 offset:18432
v_mfma_f32_16x16x32_bf16 v[244:247], a[252:255], a[164:167], v[244:247]
v_mfma_f32_16x16x32_bf16 v[248:251], a[252:255], a[168:171], v[248:251]
v_mfma_f32_16x16x32_bf16 v[252:255], a[252:255], a[172:175], v[252:255]
s_waitcnt vmcnt(9) lgkmcnt(1)
v_cmp_ne_u64 s[50:51], s[88:89], v[82:83]
v_cmp_ne_u64 s[44:45], s[88:89], v[86:87]
v_mfma_f32_16x16x32_bf16 v[128:131], a[224:227], a[176:179], v[128:131]
ds_read_b128 a[232:235], v17 offset:20480
v_mfma_f32_16x16x32_bf16 v[132:135], a[224:227], a[180:183], v[132:135]
s_or_b64 s[50:51], s[44:45], s[50:51]
v_mfma_f32_16x16x32_bf16 v[136:139], a[224:227], a[184:187], v[136:139]
s_cbranch_scc1 L_SLOW12
L_BACK12:
v_mfma_f32_16x16x32_bf16 v[140:143], a[224:227], a[188:191], v[140:143]
s_waitcnt lgkmcnt(1)
buffer_load_dwordx4 v[40:43], v12, s[24:27], 0 offen offset:2048 sc1
v_mfma_f32_16x16x32_bf16 v[144:147], a[228:231], a[176:179], v[144:147]
ds_read_b128 a[236:239], v17 offset:22528
buffer_load_dwordx4 v[44:47], v12, s[24:27], 0 offen offset:3072 sc1
v_mfma_f32_16x16x32_bf16 v[148:151], a[228:231], a[180:183], v[148:151]
v_perm_b32 v63, v80, v19, s52
v_add_u32 v12, 32768, v13
v_mfma_f32_16x16x32_bf16 v[152:155], a[228:231], a[184:187], v[152:155]
ds_read_b32 a192, v63
v_perm_b32 v62, v80, v19, s53
v_mfma_f32_16x16x32_bf16 v[156:159], a[228:231], a[188:191], v[156:159]
s_waitcnt lgkmcnt(2)
ds_read_b32 a193, v62
v_mfma_f32_16x16x32_bf16 v[160:163], a[232:235], a[176:179], v[160:163]
ds_read_b128 a[240:243], v17 offset:24576
v_perm_b32 v61, v84, v19, s52
v_mfma_f32_16x16x32_bf16 v[164:167], a[232:235], a[180:183], v[164:167]
ds_read_b32 a194, v61
v_perm_b32 v60, v84, v19, s53
v_mfma_f32_16x16x32_bf16 v[168:171], a[232:235], a[184:187], v[168:171]
s_add_u32 m0, s33, 97280
ds_read_b32 a195, v60
v_perm_b32 v59, v80, v19, s54
v_mfma_f32_16x16x32_bf16 v[172:175], a[232:235], a[188:191], v[172:175]
s_waitcnt lgkmcnt(4)
ds_read_b32 a196, v59
v_perm_b32 v58, v80, v19, s55
v_mfma_f32_16x16x32_bf16 v[176:179], a[236:239], a[176:179], v[176:179]
ds_read_b128 a[244:247], v17 offset:26624
buffer_load_dwordx4 v8, s[20:23], 0 offen offset:1024 lds
v_mfma_f32_16x16x32_bf16 v[180:183], a[236:239], a[180:183], v[180:183]
ds_read_b32 a197, v58
v_perm_b32 v57, v84, v19, s54
v_mfma_f32_16x16x32_bf16 v[184:187], a[236:239], a[184:187], v[184:187]
ds_read_b32 a198, v57
v_perm_b32 v56, v84, v19, s55
v_mfma_f32_16x16x32_bf16 v[188:191], a[236:239], a[188:191], v[188:191]
s_waitcnt lgkmcnt(4)
ds_read_b32 a199, v56
v_mfma_f32_16x16x32_bf16 v[192:195], a[240:243], a[176:179], v[192:195]
s_waitcnt vmcnt(11)
s_barrier
ds_read_b128 a[248:251], v17 offset:28672
v_perm_b32 v63, v81, v19, s52
v_mfma_f32_16x16x32_bf16 v[196:199], a[240:243], a[180:183], v[196:199]
ds_read_b32 a200, v63
v_perm_b32 v62, v81, v19, s53
v_mfma_f32_16x16x32_bf16 v[200:203], a[240:243], a[184:187], v[200:203]
ds_read_b32 a201, v62
v_perm_b32 v61, v85, v19, s52
v_mfma_f32_16x16x32_bf16 v[204:207], a[240:243], a[188:191], v[204:207]
s_waitcnt lgkmcnt(4)
ds_read_b32 a202, v61
v_mfma_f32_16x16x32_bf16 v[208:211], a[244:247], a[176:179], v[208:211]
ds_read_b128 a[252:255], v17 offset:30720
v_perm_b32 v60, v85, v19, s53
v_mfma_f32_16x16x32_bf16 v[212:215], a[244:247], a[180:183], v[212:215]
ds_read_b32 a203, v60
v_perm_b32 v59, v81, v19, s54
v_mfma_f32_16x16x32_bf16 v[216:219], a[244:247], a[184:187], v[216:219]
ds_read_b32 a204, v59
v_perm_b32 v58, v81, v19, s55
v_mfma_f32_16x16x32_bf16 v[220:223], a[244:247], a[188:191], v[220:223]
s_waitcnt lgkmcnt(4)
ds_read_b32 a205, v58
v_mfma_f32_16x16x32_bf16 v[224:227], a[248:251], a[176:179], v[224:227]
ds_read_b128 a[224:227], v14 offset:0
v_perm_b32 v57, v85, v19, s54
v_mfma_f32_16x16x32_bf16 v[228:231], a[248:251], a[180:183], v[228:231]
ds_read_b32 a206, v57
v_perm_b32 v56, v85, v19, s55
v_mfma_f32_16x16x32_bf16 v[232:235], a[248:251], a[184:187], v[232:235]
s_add_u32 m0, s33, 101376
ds_read_b32 a207, v56
buffer_load_dwordx4 v[48:51], v12, s[24:27], 0 offen offset:0 sc1
v_mfma_f32_16x16x32_bf16 v[236:239], a[248:251], a[188:191], v[236:239]
s_waitcnt lgkmcnt(4)
buffer_load_dwordx4 v[52:55], v12, s[24:27], 0 offen offset:1024 sc1
v_mfma_f32_16x16x32_bf16 v[240:243], a[252:255], a[176:179], v[240:243]
ds_read_b128 a[228:231], v14 offset:2048
buffer_load_dwordx4 v9, s[20:23], 0 offen offset:1024 lds
v_mfma_f32_16x16x32_bf16 v[244:247], a[252:255], a[180:183], v[244:247]
v_mfma_f32_16x16x32_bf16 v[248:251], a[252:255], a[184:187], v[248:251]
v_mfma_f32_16x16x32_bf16 v[252:255], a[252:255], a[188:191], v[252:255]
s_waitcnt vmcnt(11) lgkmcnt(1)
v_cmp_ne_u64 s[50:51], s[88:89], v[90:91]
v_cmp_ne_u64 s[44:45], s[88:89], v[94:95]
v_mfma_f32_16x16x32_bf16 v[128:131], a[224:227], a[192:195], v[128:131]
ds_read_b128 a[232:235], v14 offset:4096
v_mfma_f32_16x16x32_bf16 v[132:135], a[224:227], a[196:199], v[132:135]
s_or_b64 s[50:51], s[44:45], s[50:51]
v_mfma_f32_16x16x32_bf16 v[136:139], a[224:227], a[200:203], v[136:139]
s_cbranch_scc1 L_SLOW13
L_BACK13:
v_mfma_f32_16x16x32_bf16 v[140:143], a[224:227], a[204:207], v[140:143]
s_waitcnt lgkmcnt(1)
v_mfma_f32_16x16x32_bf16 v[144:147], a[228:231], a[192:195], v[144:147]
ds_read_b128 a[236:239], v14 offset:6144
v_mfma_f32_16x16x32_bf16 v[148:151], a[228:231], a[196:199], v[148:151]
v_perm_b32 v63, v88, v19, s52
v_mfma_f32_16x16x32_bf16 v[152:155], a[228:231], a[200:203], v[152:155]
s_add_u32 m0, s33, 105472
ds_read_b32 a208, v63
v_perm_b32 v62, v88, v19, s53
v_mfma_f32_16x16x32_bf16 v[156:159], a[228:231], a[204:207], v[156:159]
s_waitcnt lgkmcnt(2)
ds_read_b32 a209, v62
v_perm_b32 v61, v92, v19, s52
v_mfma_f32_16x16x32_bf16 v[160:163], a[232:235], a[192:195], v[160:163]
ds_read_b128 a[240:243], v14 offset:8192
buffer_load_dwordx4 v10, s[20:23], 0 offen offset:1024 lds
v_mfma_f32_16x16x32_bf16 v[164:167], a[232:235], a[196:199], v[164:167]
ds_read_b32 a210, v61
v_perm_b32 v60, v92, v19, s53
v_mfma_f32_16x16x32_bf16 v[168:171], a[232:235], a[200:203], v[168:171]
ds_read_b32 a211, v60
v_perm_b32 v59, v88, v19, s54
v_mfma_f32_16x16x32_bf16 v[172:175], a[232:235], a[204:207], v[172:175]
s_waitcnt lgkmcnt(4)
ds_read_b32 a212, v59
v_mfma_f32_16x16x32_bf16 v[176:179], a[236:239], a[192:195], v[176:179]
ds_read_b128 a[244:247], v14 offset:10240
v_perm_b32 v58, v88, v19, s55
v_mfma_f32_16x16x32_bf16 v[180:183], a[236:239], a[196:199], v[180:183]
ds_read_b32 a213, v58
v_perm_b32 v57, v92, v19, s54
v_mfma_f32_16x16x32_bf16 v[184:187], a[236:239], a[200:203], v[184:187]
ds_read_b32 a214, v57
v_perm_b32 v56, v92, v19, s55
v_mfma_f32_16x16x32_bf16 v[188:191], a[236:239], a[204:207], v[188:191]
s_waitcnt lgkmcnt(4)
ds_read_b32 a215, v56
v_mfma_f32_16x16x32_bf16 v[192:195], a[240:243], a[192:195], v[192:195]
ds_read_b128 a[248:251], v14 offset:12288
v_perm_b32 v63, v89, v19, s52
v_mfma_f32_16x16x32_bf16 v[196:199], a[240:243], a[196:199], v[196:199]
ds_read_b32 a216, v63
v_perm_b32 v62, v89, v19, s53
v_mfma_f32_16x16x32_bf16 v[200:203], a[240:243], a[200:203], v[200:203]
s_add_u32 m0, s33, 109440
ds_read_b32 a217, v62
v_perm_b32 v61, v93, v19, s52
v_mfma_f32_16x16x32_bf16 v[204:207], a[240:243], a[204:207], v[204:207]
s_waitcnt lgkmcnt(4)
ds_read_b32 a218, v61
v_perm_b32 v60, v93, v19, s53
v_mfma_f32_16x16x32_bf16 v[208:211], a[244:247], a[192:195], v[208:211]
ds_read_b128 a[252:255], v14 offset:14336
buffer_load_dwordx4 v8, s[20:23], 0 offen offset:1152 lds
v_mfma_f32_16x16x32_bf16 v[212:215], a[244:247], a[196:199], v[212:215]
ds_read_b32 a219, v60
v_perm_b32 v59, v89, v19, s54
v_mfma_f32_16x16x32_bf16 v[216:219], a[244:247], a[200:203], v[216:219]
ds_read_b32 a220, v59
v_perm_b32 v58, v89, v19, s55
v_mfma_f32_16x16x32_bf16 v[220:223], a[244:247], a[204:207], v[220:223]
s_waitcnt lgkmcnt(4)
ds_read_b32 a221, v58
buffer_load_dwordx4 v[96:99], v12, s[24:27], 0 offen offset:2048 sc1
v_mfma_f32_16x16x32_bf16 v[224:227], a[248:251], a[192:195], v[224:227]
ds_read_b128 a[224:227], v15 offset:0
v_perm_b32 v57, v93, v19, s54
v_mfma_f32_16x16x32_bf16 v[228:231], a[248:251], a[196:199], v[228:231]
ds_read_b32 a222, v57
v_perm_b32 v56, v93, v19, s55
v_mfma_f32_16x16x32_bf16 v[232:235], a[248:251], a[200:203], v[232:235]
ds_read_b32 a223, v56
buffer_load_dwordx4 v[100:103], v12, s[24:27], 0 offen offset:3072 sc1
v_mfma_f32_16x16x32_bf16 v[236:239], a[248:251], a[204:207], v[236:239]
s_waitcnt lgkmcnt(4)
v_add_u32 v12, 36864, v13
v_mfma_f32_16x16x32_bf16 v[240:243], a[252:255], a[192:195], v[240:243]
ds_read_b128 a[228:231], v15 offset:2048
v_mfma_f32_16x16x32_bf16 v[244:247], a[252:255], a[196:199], v[244:247]
v_mfma_f32_16x16x32_bf16 v[248:251], a[252:255], a[200:203], v[248:251]
s_waitcnt vmcnt(11)
v_cmp_ne_u64 s[50:51], s[88:89], v[34:35]
v_cmp_ne_u64 s[44:45], s[88:89], v[38:39]
v_mfma_f32_16x16x32_bf16 v[252:255], a[252:255], a[204:207], v[252:255]
s_waitcnt lgkmcnt(1)
v_mfma_f32_16x16x32_bf16 v[128:131], a[224:227], a[208:211], v[128:131]
s_or_b64 s[50:51], s[44:45], s[50:51]
ds_read_b128 a[232:235], v15 offset:4096
v_mfma_f32_16x16x32_bf16 v[132:135], a[224:227], a[212:215], v[132:135]
s_cbranch_scc1 L_SLOW14
L_BACK14:
v_mfma_f32_16x16x32_bf16 v[136:139], a[224:227], a[216:219], v[136:139]
v_perm_b32 v63, v32, v19, s52
v_mfma_f32_16x16x32_bf16 v[140:143], a[224:227], a[220:223], v[140:143]
s_waitcnt lgkmcnt(1)
ds_read_b32 a0, v63
v_mfma_f32_16x16x32_bf16 v[144:147], a[228:231], a[208:211], v[144:147]
ds_read_b128 a[236:239], v15 offset:6144
v_perm_b32 v62, v32, v19, s53
v_mfma_f32_16x16x32_bf16 v[148:151], a[228:231], a[212:215], v[148:151]
ds_read_b32 a1, v62
v_perm_b32 v61, v36, v19, s52
v_mfma_f32_16x16x32_bf16 v[152:155], a[228:231], a[216:219], v[152:155]
ds_read_b32 a2, v61
v_perm_b32 v60, v36, v19, s53
v_mfma_f32_16x16x32_bf16 v[156:159], a[228:231], a[220:223], v[156:159]
s_waitcnt lgkmcnt(4)
ds_read_b32 a3, v60
v_mfma_f32_16x16x32_bf16 v[160:163], a[232:235], a[208:211], v[160:163]
ds_read_b128 a[240:243], v15 offset:8192
v_perm_b32 v59, v32, v19, s54
v_mfma_f32_16x16x32_bf16 v[164:167], a[232:235], a[212:215], v[164:167]
ds_read_b32 a4, v59
v_perm_b32 v58, v32, v19, s55
v_mfma_f32_16x16x32_bf16 v[168:171], a[232:235], a[216:219], v[168:171]
s_add_u32 m0, s33, 113664
ds_read_b32 a5, v58
v_perm_b32 v57, v36, v19, s54
v_mfma_f32_16x16x32_bf16 v[172:175], a[232:235], a[220:223], v[172:175]
s_waitcnt lgkmcnt(4)
ds_read_b32 a6, v57
v_perm_b32 v56, v36, v19, s55
v_mfma_f32_16x16x32_bf16 v[176:179], a[236:239], a[208:211], v[176:179]
ds_read_b128 a[244:247], v15 offset:10240
buffer_load_dwordx4 v11, s[20:23], 0 offen offset:1024 lds
v_mfma_f32_16x16x32_bf16 v[180:183], a[236:239], a[212:215], v[180:183]
ds_read_b32 a7, v56
v_perm_b32 v63, v33, v19, s52
v_mfma_f32_16x16x32_bf16 v[184:187], a[236:239], a[216:219], v[184:187]
ds_read_b32 a8, v63
v_perm_b32 v62, v33, v19, s53
v_mfma_f32_16x16x32_bf16 v[188:191], a[236:239], a[220:223], v[188:191]
s_waitcnt lgkmcnt(4)
ds_read_b32 a9, v62
buffer_load_dwordx4 v[80:83], v12, s[24:27], 0 offen offset:0 sc1
v_mfma_f32_16x16x32_bf16 v[192:195], a[240:243], a[208:211], v[192:195]
s_waitcnt vmcnt(12)
s_barrier
ds_read_b128 a[248:251], v15 offset:12288
v_perm_b32 v61, v37, v19, s52
v_mfma_f32_16x16x32_bf16 v[196:199], a[240:243], a[212:215], v[196:199]
ds_read_b32 a10, v61
v_perm_b32 v60, v37, v19, s53
v_mfma_f32_16x16x32_bf16 v[200:203], a[240:243], a[216:219], v[200:203]
ds_read_b32 a11, v60
v_perm_b32 v59, v33, v19, s54
v_mfma_f32_16x16x32_bf16 v[204:207], a[240:243], a[220:223], v[204:207]
s_waitcnt lgkmcnt(4)
ds_read_b32 a12, v59
buffer_load_dwordx4 v[84:87], v12, s[24:27], 0 offen offset:1024 sc1
v_mfma_f32_16x16x32_bf16 v[208:211], a[244:247], a[208:211], v[208:211]
ds_read_b128 a[252:255], v15 offset:14336
v_perm_b32 v58, v33, v19, s55
v_mfma_f32_16x16x32_bf16 v[212:215], a[244:247], a[212:215], v[212:215]
ds_read_b32 a13, v58
v_perm_b32 v57, v37, v19, s54
v_mfma_f32_16x16x32_bf16 v[216:219], a[244:247], a[216:219], v[216:219]
s_waitcnt vmcnt(11)
v_cmp_ne_u64 s[50:51], s[88:89], v[42:43]
v_cmp_ne_u64 s[44:45], s[88:89], v[46:47]
v_mfma_f32_16x16x32_bf16 v[220:223], a[244:247], a[220:223], v[220:223]
s_waitcnt lgkmcnt(3)
ds_read_b32 a14, v57
v_mfma_f32_16x16x32_bf16 v[224:227], a[248:251], a[208:211], v[224:227]
s_or_b64 s[50:51], s[44:45], s[50:51]
ds_read_b128 a[224:227], v14 offset:16384
v_perm_b32 v56, v37, v19, s55
v_mfma_f32_16x16x32_bf16 v[228:231], a[248:251], a[212:215], v[228:231]
s_cbranch_scc1 L_SLOW15
L_BACK15:
v_mfma_f32_16x16x32_bf16 v[232:235], a[248:251], a[216:219], v[232:235]
s_add_u32 m0, s33, 117632
ds_read_b32 a15, v56
v_perm_b32 v63, v40, v19, s52
v_mfma_f32_16x16x32_bf16 v[236:239], a[248:251], a[220:223], v[236:239]
s_waitcnt lgkmcnt(3)
ds_read_b32 a16, v63
v_perm_b32 v62, v40, v19, s53
v_mfma_f32_16x16x32_bf16 v[240:243], a[252:255], a[208:211], v[240:243]
ds_read_b128 a[228:231], v14 offset:18432
buffer_load_dwordx4 v9, s[20:23], 0 offen offset:1152 lds
v_mfma_f32_16x16x32_bf16 v[244:247], a[252:255], a[212:215], v[244:247]
ds_read_b32 a17, v62
v_perm_b32 v61, v44, v19, s52
v_mfma_f32_16x16x32_bf16 v[248:251], a[252:255], a[216:219], v[248:251]
ds_read_b32 a18, v61
v_perm_b32 v60, v44, v19, s53
v_mfma_f32_16x16x32_bf16 v[252:255], a[252:255], a[220:223], v[252:255]
s_waitcnt lgkmcnt(4)
ds_read_b32 a19, v60
v_mfma_f32_16x16x32_bf16 v[128:131], a[224:227], a[0:3], v[128:131]
ds_read_b128 a[232:235], v14 offset:20480
v_perm_b32 v59, v40, v19, s54
v_mfma_f32_16x16x32_bf16 v[132:135], a[224:227], a[4:7], v[132:135]
ds_read_b32 a20, v59
v_perm_b32 v58, v40, v19, s55
v_mfma_f32_16x16x32_bf16 v[136:139], a[224:227], a[8:11], v[136:139]
ds_read_b32 a21, v58
v_perm_b32 v57, v44, v19, s54
v_mfma_f32_16x16x32_bf16 v[140:143], a[224:227], a[12:15], v[140:143]
s_waitcnt lgkmcnt(4)
ds_read_b32 a22, v57
buffer_load_dwordx4 v[88:91], v12, s[24:27], 0 offen offset:2048 sc1
v_mfma_f32_16x16x32_bf16 v[144:147], a[228:231], a[0:3], v[144:147]
ds_read_b128 a[236:239], v14 offset:22528
v_perm_b32 v56, v44, v19, s55
v_mfma_f32_16x16x32_bf16 v[148:151], a[228:231], a[4:7], v[148:151]
ds_read_b32 a23, v56
v_perm_b32 v63, v41, v19, s52
v_mfma_f32_16x16x32_bf16 v[152:155], a[228:231], a[8:11], v[152:155]
s_add_u32 m0, s33, 121600
ds_read_b32 a24, v63
v_perm_b32 v62, v41, v19, s53
v_mfma_f32_16x16x32_bf16 v[156:159], a[228:231], a[12:15], v[156:159]
s_waitcnt lgkmcnt(4)
ds_read_b32 a25, v62
v_perm_b32 v61, v45, v19, s52
v_mfma_f32_16x16x32_bf16 v[160:163], a[232:235], a[0:3], v[160:163]
ds_read_b128 a[240:243], v14 offset:24576
buffer_load_dwordx4 v8, s[20:23], 0 offen offset:1280 lds
v_mfma_f32_16x16x32_bf16 v[164:167], a[232:235], a[4:7], v[164:167]
ds_read_b32 a26, v61
v_perm_b32 v60, v45, v19, s53
v_mfma_f32_16x16x32_bf16 v[168:171], a[232:235], a[8:11], v[168:171]
ds_read_b32 a27, v60
v_perm_b32 v59, v41, v19, s54
v_mfma_f32_16x16x32_bf16 v[172:175], a[232:235], a[12:15], v[172:175]
s_waitcnt lgkmcnt(4)
ds_read_b32 a28, v59
buffer_load_dwordx4 v[92:95], v12, s[24:27], 0 offen offset:3072 sc1
v_mfma_f32_16x16x32_bf16 v[176:179], a[236:239], a[0:3], v[176:179]
ds_read_b128 a[244:247], v14 offset:26624
v_perm_b32 v58, v41, v19, s55
v_mfma_f32_16x16x32_bf16 v[180:183], a[236:239], a[4:7], v[180:183]
ds_read_b32 a29, v58
v_perm_b32 v57, v45, v19, s54
v_mfma_f32_16x16x32_bf16 v[184:187], a[236:239], a[8:11], v[184:187]
s_waitcnt vmcnt(12)
v_cmp_ne_u64 s[50:51], s[88:89], v[50:51]
v_cmp_ne_u64 s[44:45], s[88:89], v[54:55]
v_mfma_f32_16x16x32_bf16 v[188:191], a[236:239], a[12:15], v[188:191]
s_waitcnt lgkmcnt(3)
ds_read_b32 a30, v57
v_add_u32 v12, 40960, v13
v_mfma_f32_16x16x32_bf16 v[192:195], a[240:243], a[0:3], v[192:195]
s_or_b64 s[50:51], s[44:45], s[50:51]
ds_read_b128 a[248:251], v14 offset:28672
v_perm_b32 v56, v45, v19, s55
v_mfma_f32_16x16x32_bf16 v[196:199], a[240:243], a[4:7], v[196:199]
s_cbranch_scc1 L_SLOW16
L_BACK16:
v_mfma_f32_16x16x32_bf16 v[200:203], a[240:243], a[8:11], v[200:203]
s_add_u32 m0, s33, 125824
ds_read_b32 a31, v56
v_perm_b32 v63, v48, v19, s52
v_mfma_f32_16x16x32_bf16 v[204:207], a[240:243], a[12:15], v[204:207]
s_waitcnt lgkmcnt(3)
ds_read_b32 a32, v63
v_perm_b32 v62, v48, v19, s53
v_mfma_f32_16x16x32_bf16 v[208:211], a[244:247], a[0:3], v[208:211]
ds_read_b128 a[252:255], v14 offset:30720
buffer_load_dwordx4 v10, s[20:23], 0 offen offset:1152 lds
v_mfma_f32_16x16x32_bf16 v[212:215], a[244:247], a[4:7], v[212:215]
ds_read_b32 a33, v62
v_perm_b32 v61, v52, v19, s52
v_mfma_f32_16x16x32_bf16 v[216:219], a[244:247], a[8:11], v[216:219]
ds_read_b32 a34, v61
v_perm_b32 v60, v52, v19, s53
v_mfma_f32_16x16x32_bf16 v[220:223], a[244:247], a[12:15], v[220:223]
s_waitcnt lgkmcnt(4)
ds_read_b32 a35, v60
buffer_load_dwordx4 v[32:35], v12, s[24:27], 0 offen offset:0 sc1
v_mfma_f32_16x16x32_bf16 v[224:227], a[248:251], a[0:3], v[224:227]
ds_read_b128 a[224:227], v15 offset:16384
v_perm_b32 v59, v48, v19, s54
v_mfma_f32_16x16x32_bf16 v[228:231], a[248:251], a[4:7], v[228:231]
ds_read_b32 a36, v59
v_perm_b32 v58, v48, v19, s55
v_mfma_f32_16x16x32_bf16 v[232:235], a[248:251], a[8:11], v[232:235]
ds_read_b32 a37, v58
v_perm_b32 v57, v52, v19, s54
v_mfma_f32_16x16x32_bf16 v[236:239], a[248:251], a[12:15], v[236:239]
s_waitcnt lgkmcnt(4)
ds_read_b32 a38, v57
buffer_load_dwordx4 v[36:39], v12, s[24:27], 0 offen offset:1024 sc1
v_mfma_f32_16x16x32_bf16 v[240:243], a[252:255], a[0:3], v[240:243]
ds_read_b128 a[228:231], v15 offset:18432
v_perm_b32 v56, v52, v19, s55
v_mfma_f32_16x16x32_bf16 v[244:247], a[252:255], a[4:7], v[244:247]
ds_read_b32 a39, v56
v_perm_b32 v63, v49, v19, s52
v_mfma_f32_16x16x32_bf16 v[248:251], a[252:255], a[8:11], v[248:251]
ds_read_b32 a40, v63
v_perm_b32 v62, v49, v19, s53
v_mfma_f32_16x16x32_bf16 v[252:255], a[252:255], a[12:15], v[252:255]
s_waitcnt lgkmcnt(4)
ds_read_b32 a41, v62
v_mfma_f32_16x16x32_bf16 v[128:131], a[224:227], a[16:19], v[128:131]
ds_read_b128 a[232:235], v15 offset:20480
v_perm_b32 v61, v53, v19, s52
v_mfma_f32_16x16x32_bf16 v[132:135], a[224:227], a[20:23], v[132:135]
ds_read_b32 a42, v61
v_perm_b32 v60, v53, v19, s53
v_mfma_f32_16x16x32_bf16 v[136:139], a[224:227], a[24:27], v[136:139]
s_add_u32 m0, s33, 129792
ds_read_b32 a43, v60
v_perm_b32 v59, v49, v19, s54
v_mfma_f32_16x16x32_bf16 v[140:143], a[224:227], a[28:31], v[140:143]
s_waitcnt lgkmcnt(4)
ds_read_b32 a44, v59
v_perm_b32 v58, v49, v19, s55
v_mfma_f32_16x16x32_bf16 v[144:147], a[228:231], a[16:19], v[144:147]
ds_read_b128 a[236:239], v15 offset:22528
buffer_load_dwordx4 v9, s[20:23], 0 offen offset:1280 lds
v_mfma_f32_16x16x32_bf16 v[148:151], a[228:231], a[20:23], v[148:151]
ds_read_b32 a45, v58
v_perm_b32 v57, v53, v19, s54
v_mfma_f32_16x16x32_bf16 v[152:155], a[228:231], a[24:27], v[152:155]
s_waitcnt vmcnt(11)
v_cmp_ne_u64 s[50:51], s[88:89], v[98:99]
v_cmp_ne_u64 s[44:45], s[88:89], v[102:103]
v_mfma_f32_16x16x32_bf16 v[156:159], a[228:231], a[28:31], v[156:159]
s_waitcnt lgkmcnt(3)
ds_read_b32 a46, v57
v_mfma_f32_16x16x32_bf16 v[160:163], a[232:235], a[16:19], v[160:163]
s_or_b64 s[50:51], s[44:45], s[50:51]
ds_read_b128 a[240:243], v15 offset:24576
v_perm_b32 v56, v53, v19, s55
v_mfma_f32_16x16x32_bf16 v[164:167], a[232:235], a[20:23], v[164:167]
s_cbranch_scc1 L_SLOW17
L_BACK17:
v_mfma_f32_16x16x32_bf16 v[168:171], a[232:235], a[24:27], v[168:171]
s_add_u32 m0, s33, 133760
ds_read_b32 a47, v56
v_perm_b32 v63, v96, v19, s52
v_mfma_f32_16x16x32_bf16 v[172:175], a[232:235], a[28:31], v[172:175]
s_waitcnt lgkmcnt(3)
ds_read_b32 a48, v63
v_perm_b32 v62, v96, v19, s53
v_mfma_f32_16x16x32_bf16 v[176:179], a[236:239], a[16:19], v[176:179]
ds_read_b128 a[244:247], v15 offset:26624
buffer_load_dwordx4 v8, s[20:23], 0 offen offset:1408 lds
v_mfma_f32_16x16x32_bf16 v[180:183], a[236:239], a[20:23], v[180:183]
ds_read_b32 a49, v62
v_perm_b32 v61, v100, v19, s52
v_mfma_f32_16x16x32_bf16 v[184:187], a[236:239], a[24:27], v[184:187]
ds_read_b32 a50, v61
v_perm_b32 v60, v100, v19, s53
v_mfma_f32_16x16x32_bf16 v[188:191], a[236:239], a[28:31], v[188:191]
s_waitcnt lgkmcnt(4)
ds_read_b32 a51, v60
v_mfma_f32_16x16x32_bf16 v[192:195], a[240:243], a[16:19], v[192:195]
s_barrier
ds_read_b128 a[248:251], v14 offset:32768
v_perm_b32 v59, v96, v19, s54
v_mfma_f32_16x16x32_bf16 v[196:199], a[240:243], a[20:23], v[196:199]
ds_read_b32 a52, v59
v_perm_b32 v58, v96, v19, s55
v_mfma_f32_16x16x32_bf16 v[200:203], a[240:243], a[24:27], v[200:203]
ds_read_b32 a53, v58
v_perm_b32 v57, v100, v19, s54
v_mfma_f32_16x16x32_bf16 v[204:207], a[240:243], a[28:31], v[204:207]
s_waitcnt lgkmcnt(4)
ds_read_b32 a54, v57
buffer_load_dwordx4 v[40:43], v12, s[24:27], 0 offen offset:2048 sc1
v_mfma_f32_16x16x32_bf16 v[208:211], a[244:247], a[16:19], v[208:211]
ds_read_b128 a[252:255], v14 offset:34816
v_perm_b32 v56, v100, v19, s55
v_mfma_f32_16x16x32_bf16 v[212:215], a[244:247], a[20:23], v[212:215]
ds_read_b32 a55, v56
v_perm_b32 v63, v97, v19, s52
v_mfma_f32_16x16x32_bf16 v[216:219], a[244:247], a[24:27], v[216:219]
ds_read_b32 a56, v63
v_perm_b32 v62, v97, v19, s53
v_mfma_f32_16x16x32_bf16 v[220:223], a[244:247], a[28:31], v[220:223]
s_waitcnt lgkmcnt(4)
ds_read_b32 a57, v62
buffer_load_dwordx4 v[44:47], v12, s[24:27], 0 offen offset:3072 sc1
v_mfma_f32_16x16x32_bf16 v[128:131], a[248:251], a[32:35], v[128:131]
ds_read_b128 a[224:227], v15 offset:28672
v_perm_b32 v61, v101, v19, s52
v_mfma_f32_16x16x32_bf16 v[132:135], a[248:251], a[36:39], v[132:135]
ds_read_b32 a58, v61
v_perm_b32 v60, v101, v19, s53
v_mfma_f32_16x16x32_bf16 v[136:139], a[248:251], a[40:43], v[136:139]
s_add_u32 m0, s33, 137984
ds_read_b32 a59, v60
v_perm_b32 v59, v97, v19, s54
v_mfma_f32_16x16x32_bf16 v[140:143], a[248:251], a[44:47], v[140:143]
s_waitcnt lgkmcnt(4)
ds_read_b32 a60, v59
v_perm_b32 v58, v97, v19, s55
v_mfma_f32_16x16x32_bf16 v[144:147], a[252:255], a[32:35], v[144:147]
ds_read_b128 a[228:231], v15 offset:30720
buffer_load_dwordx4 v10, s[20:23], 0 offen offset:1280 lds
v_mfma_f32_16x16x32_bf16 v[148:151], a[252:255], a[36:39], v[148:151]
ds_read_b32 a61, v58
v_perm_b32 v57, v101, v19, s54
v_mfma_f32_16x16x32_bf16 v[152:155], a[252:255], a[40:43], v[152:155]
s_waitcnt vmcnt(12)
v_cmp_ne_u64 s[50:51], s[88:89], v[82:83]
v_cmp_ne_u64 s[44:45], s[88:89], v[86:87]
v_mfma_f32_16x16x32_bf16 v[156:159], a[252:255], a[44:47], v[156:159]
s_waitcnt lgkmcnt(3)
ds_read_b32 a62, v57
v_add_u32 v12, 45056, v13
v_mfma_f32_16x16x32_bf16 v[224:227], a[224:227], a[16:19], v[224:227]
s_or_b64 s[50:51], s[44:45], s[50:51]
ds_read_b128 a[232:235], v14 offset:36864
v_perm_b32 v56, v101, v19, s55
v_mfma_f32_16x16x32_bf16 v[228:231], a[224:227], a[20:23], v[228:231]
s_cbranch_scc1 L_SLOW18
L_BACK18:
v_mfma_f32_16x16x32_bf16 v[232:235], a[224:227], a[24:27], v[232:235]
ds_read_b32 a63, v56
v_perm_b32 v63, v80, v19, s52
v_mfma_f32_16x16x32_bf16 v[236:239], a[224:227], a[28:31], v[236:239]
s_waitcnt lgkmcnt(3)
ds_read_b32 a64, v63
v_mfma_f32_16x16x32_bf16 v[240:243], a[228:231], a[16:19], v[240:243]
L_PAD3:
s_cbranch_vccnz L_PAD4
ds_read_b128 a[236:239], v14 offset:38912
v_perm_b32 v62, v80, v19, s53
v_mfma_f32_16x16x32_bf16 v[244:247], a[228:231], a[20:23], v[244:247]
ds_read_b32 a65, v62
v_perm_b32 v61, v84, v19, s52
v_mfma_f32_16x16x32_bf16 v[248:251], a[228:231], a[24:27], v[248:251]
s_add_u32 m0, s33, 142208
ds_read_b32 a66, v61
v_perm_b32 v60, v84, v19, s53
v_mfma_f32_16x16x32_bf16 v[252:255], a[228:231], a[28:31], v[252:255]
s_waitcnt lgkmcnt(4)
ds_read_b32 a67, v60
v_perm_b32 v59, v80, v19, s54
v_mfma_f32_16x16x32_bf16 v[160:163], a[232:235], a[32:35], v[160:163]
ds_read_b128 a[240:243], v15 offset:32768
buffer_load_dwordx4 v11, s[20:23], 0 offen offset:1152 lds
v_mfma_f32_16x16x32_bf16 v[164:167], a[232:235], a[36:39], v[164:167]
ds_read_b32 a68, v59
v_perm_b32 v58, v80, v19, s55
v_mfma_f32_16x16x32_bf16 v[168:171], a[232:235], a[40:43], v[168:171]
ds_read_b32 a69, v58
v_perm_b32 v57, v84, v19, s54
v_mfma_f32_16x16x32_bf16 v[172:175], a[232:235], a[44:47], v[172:175]
s_waitcnt lgkmcnt(4)
ds_read_b32 a70, v57
buffer_load_dwordx4 v[48:51], v12, s[24:27], 0 offen offset:0 sc1
v_mfma_f32_16x16x32_bf16 v[176:179], a[236:239], a[32:35], v[176:179]
ds_read_b128 a[244:247], v15 offset:34816
v_perm_b32 v56, v84, v19, s55
v_mfma_f32_16x16x32_bf16 v[180:183], a[236:239], a[36:39], v[180:183]
ds_read_b32 a71, v56
v_perm_b32 v63, v81, v19, s52
v_mfma_f32_16x16x32_bf16 v[184:187], a[236:239], a[40:43], v[184:187]
ds_read_b32 a72, v63
v_perm_b32 v62, v81, v19, s53
v_mfma_f32_16x16x32_bf16 v[188:191], a[236:239], a[44:47], v[188:191]
s_waitcnt lgkmcnt(4)
ds_read_b32 a73, v62
buffer_load_dwordx4 v[52:55], v12, s[24:27], 0 offen offset:1024 sc1
v_mfma_f32_16x16x32_bf16 v[128:131], a[240:243], a[48:51], v[128:131]
ds_read_b128 a[248:251], v14 offset:40960
v_perm_b32 v61, v85, v19, s52
v_mfma_f32_16x16x32_bf16 v[132:135], a[240:243], a[52:55], v[132:135]
ds_read_b32 a74, v61
v_perm_b32 v60, v85, v19, s53
v_mfma_f32_16x16x32_bf16 v[136:139], a[240:243], a[56:59], v[136:139]
s_add_u32 m0, s33, 146048
ds_read_b32 a75, v60
v_perm_b32 v59, v81, v19, s54
v_mfma_f32_16x16x32_bf16 v[140:143], a[240:243], a[60:63], v[140:143]
s_waitcnt lgkmcnt(4)
ds_read_b32 a76, v59
v_perm_b32 v58, v81, v19, s55
v_mfma_f32_16x16x32_bf16 v[144:147], a[244:247], a[48:51], v[144:147]
ds_read_b128 a[252:255], v14 offset:43008
buffer_load_dwordx4 v9, s[20:23], 0 offen offset:1408 lds
v_mfma_f32_16x16x32_bf16 v[148:151], a[244:247], a[52:55], v[148:151]
ds_read_b32 a77, v58
v_perm_b32 v57, v85, v19, s54
v_mfma_f32_16x16x32_bf16 v[152:155], a[244:247], a[56:59], v[152:155]
s_waitcnt vmcnt(12)
v_cmp_ne_u64 s[50:51], s[88:89], v[90:91]
v_cmp_ne_u64 s[44:45], s[88:89], v[94:95]
v_mfma_f32_16x16x32_bf16 v[156:159], a[244:247], a[60:63], v[156:159]
s_waitcnt lgkmcnt(3)
ds_read_b32 a78, v57
v_mfma_f32_16x16x32_bf16 v[192:195], a[248:251], a[32:35], v[192:195]
s_or_b64 s[50:51], s[44:45], s[50:51]
ds_read_b128 a[224:227], v15 offset:36864
v_perm_b32 v56, v85, v19, s55
v_mfma_f32_16x16x32_bf16 v[196:199], a[248:251], a[36:39], v[196:199]
s_cbranch_scc1 L_SLOW19
L_BACK19:
v_mfma_f32_16x16x32_bf16 v[200:203], a[248:251], a[40:43], v[200:203]
ds_read_b32 a79, v56
v_perm_b32 v63, v88, v19, s52
v_mfma_f32_16x16x32_bf16 v[204:207], a[248:251], a[44:47], v[204:207]
s_waitcnt lgkmcnt(3)
ds_read_b32 a80, v63
v_mfma_f32_16x16x32_bf16 v[208:211], a[252:255], a[32:35], v[208:211]
ds_read_b128 a[228:231], v15 offset:38912
v_perm_b32 v62, v88, v19, s53
v_mfma_f32_16x16x32_bf16 v[212:215], a[252:255], a[36:39], v[212:215]
ds_read_b32 a81, v62
v_perm_b32 v61, v92, v19, s52
v_mfma_f32_16x16x32_bf16 v[216:219], a[252:255], a[40:43], v[216:219]
ds_read_b32 a82, v61
v_perm_b32 v60, v92, v19, s53
v_mfma_f32_16x16x32_bf16 v[220:223], a[252:255], a[44:47], v[220:223]
s_waitcnt lgkmcnt(4)
ds_read_b32 a83, v60
v_mfma_f32_16x16x32_bf16 v[160:163], a[224:227], a[48:51], v[160:163]
ds_read_b128 a[232:235], v14 offset:45056
v_perm_b32 v59, v88, v19, s54
v_mfma_f32_16x16x32_bf16 v[164:167], a[224:227], a[52:55], v[164:167]
ds_read_b32 a84, v59
v_perm_b32 v58, v88, v19, s55
v_mfma_f32_16x16x32_bf16 v[168:171], a[224:227], a[56:59], v[168:171]
ds_read_b32 a85, v58
v_perm_b32 v57, v92, v19, s54
v_mfma_f32_16x16x32_bf16 v[172:175], a[224:227], a[60:63], v[172:175]
s_waitcnt lgkmcnt(4)
ds_read_b32 a86, v57
buffer_load_dwordx4 v[96:99], v12, s[24:27], 0 offen offset:2048 sc1
v_mfma_f32_16x16x32_bf16 v[176:179], a[228:231], a[48:51], v[176:179]
ds_read_b128 a[236:239], v14 offset:47104
v_perm_b32 v56, v92, v19, s55
v_mfma_f32_16x16x32_bf16 v[180:183], a[228:231], a[52:55], v[180:183]
ds_read_b32 a87, v56
v_perm_b32 v63, v89, v19, s52
v_mfma_f32_16x16x32_bf16 v[184:187], a[228:231], a[56:59], v[184:187]
ds_read_b32 a88, v63
v_perm_b32 v62, v89, v19, s53
v_mfma_f32_16x16x32_bf16 v[188:191], a[228:231], a[60:63], v[188:191]
s_waitcnt lgkmcnt(4)
ds_read_b32 a89, v62
buffer_load_dwordx4 v[100:103], v12, s[24:27], 0 offen offset:3072 sc1
v_mfma_f32_16x16x32_bf16 v[128:131], a[232:235], a[64:67], v[128:131]
ds_read_b128 a[240:243], v15 offset:40960
v_perm_b32 v61, v93, v19, s52
v_mfma_f32_16x16x32_bf16 v[132:135], a[232:235], a[68:71], v[132:135]
ds_read_b32 a90, v61
v_perm_b32 v60, v93, v19, s53
v_mfma_f32_16x16x32_bf16 v[136:139], a[232:235], a[72:75], v[136:139]
s_add_u32 m0, s33, 150016
ds_read_b32 a91, v60
v_perm_b32 v59, v89, v19, s54
v_mfma_f32_16x16x32_bf16 v[140:143], a[232:235], a[76:79], v[140:143]
s_waitcnt vmcnt(11) lgkmcnt(4)
v_cmp_ne_u64 s[50:51], s[88:89], v[34:35]
v_cmp_ne_u64 s[44:45], s[88:89], v[38:39]
v_mfma_f32_16x16x32_bf16 v[144:147], a[236:239], a[64:67], v[144:147]
ds_read_b128 a[244:247], v15 offset:43008
buffer_load_dwordx4 v8, s[20:23], 0 offen offset:1536 lds
v_mfma_f32_16x16x32_bf16 v[148:151], a[236:239], a[68:71], v[148:151]
ds_read_b32 a92, v59
v_perm_b32 v58, v89, v19, s55
v_mfma_f32_16x16x32_bf16 v[152:155], a[236:239], a[72:75], v[152:155]
s_or_b64 s[50:51], s[44:45], s[50:51]
ds_read_b32 a93, v58
v_perm_b32 v57, v93, v19, s54
v_mfma_f32_16x16x32_bf16 v[156:159], a[236:239], a[76:79], v[156:159]
s_waitcnt lgkmcnt(3)
ds_read_b32 a94, v57
v_add_u32 v12, 49152, v13
v_mfma_f32_16x16x32_bf16 v[192:195], a[240:243], a[48:51], v[192:195]
s_barrier
ds_read_b128 a[248:251], v14 offset:49152
v_perm_b32 v56, v93, v19, s55
v_mfma_f32_16x16x32_bf16 v[196:199], a[240:243], a[52:55], v[196:199]
s_cbranch_scc1 L_SLOW20
L_BACK20:
v_mfma_f32_16x16x32_bf16 v[200:203], a[240:243], a[56:59], v[200:203]
ds_read_b32 a95, v56
v_perm_b32 v63, v32, v19, s52
v_mfma_f32_16x16x32_bf16 v[204:207], a[240:243], a[60:63], v[204:207]
s_waitcnt lgkmcnt(3)
ds_read_b32 a96, v63
v_mfma_f32_16x16x32_bf16 v[208:211], a[244:247], a[48:51], v[208:211]
ds_read_b128 a[252:255], v14 offset:51200
v_perm_b32 v62, v32, v19, s53
v_mfma_f32_16x16x32_bf16 v[212:215], a[244:247], a[52:55], v[212:215]
ds_read_b32 a97, v62
v_perm_b32 v61, v36, v19, s52
v_mfma_f32_16x16x32_bf16 v[216:219], a[244:247], a[56:59], v[216:219]
ds_read_b32 a98, v61
v_perm_b32 v60, v36, v19, s53
v_mfma_f32_16x16x32_bf16 v[220:223], a[244:247], a[60:63], v[220:223]
s_waitcnt lgkmcnt(4)
ds_read_b32 a99, v60
v_mfma_f32_16x16x32_bf16 v[224:227], a[248:251], a[32:35], v[224:227]
ds_read_b128 a[224:227], v14 offset:53248
v_perm_b32 v59, v32, v19, s54
v_mfma_f32_16x16x32_bf16 v[228:231], a[248:251], a[36:39], v[228:231]
ds_read_b32 a100, v59
v_perm_b32 v58, v32, v19, s55
v_mfma_f32_16x16x32_bf16 v[232:235], a[248:251], a[40:43], v[232:235]
s_add_u32 m0, s33, 154112
ds_read_b32 a101, v58
v_perm_b32 v57, v36, v19, s54
v_mfma_f32_16x16x32_bf16 v[236:239], a[248:251], a[44:47], v[236:239]
s_waitcnt lgkmcnt(4)
ds_read_b32 a102, v57
v_perm_b32 v56, v36, v19, s55
v_mfma_f32_16x16x32_bf16 v[240:243], a[252:255], a[32:35], v[240:243]
ds_read_b128 a[228:231], v14 offset:55296
buffer_load_dwordx4 v9, s[20:23], 0 offen offset:1536 lds
v_mfma_f32_16x16x32_bf16 v[244:247], a[252:255], a[36:39], v[244:247]
ds_read_b32 a103, v56
v_perm_b32 v63, v33, v19, s52
v_mfma_f32_16x16x32_bf16 v[248:251], a[252:255], a[40:43], v[248:251]
ds_read_b32 a104, v63
v_perm_b32 v62, v33, v19, s53
v_mfma_f32_16x16x32_bf16 v[252:255], a[252:255], a[44:47], v[252:255]
s_waitcnt lgkmcnt(4)
ds_read_b32 a105, v62
buffer_load_dwordx4 v[80:83], v12, s[24:27], 0 offen offset:0 sc1
v_mfma_f32_16x16x32_bf16 v[160:163], a[224:227], a[64:67], v[160:163]
ds_read_b128 a[232:235], v15 offset:45056
v_perm_b32 v61, v37, v19, s52
v_mfma_f32_16x16x32_bf16 v[164:167], a[224:227], a[68:71], v[164:167]
ds_read_b32 a106, v61
v_perm_b32 v60, v37, v19, s53
v_mfma_f32_16x16x32_bf16 v[168:171], a[224:227], a[72:75], v[168:171]
ds_read_b32 a107, v60
v_perm_b32 v59, v33, v19, s54
v_mfma_f32_16x16x32_bf16 v[172:175], a[224:227], a[76:79], v[172:175]
s_waitcnt lgkmcnt(4)
ds_read_b32 a108, v59
buffer_load_dwordx4 v[84:87], v12, s[24:27], 0 offen offset:1024 sc1
v_mfma_f32_16x16x32_bf16 v[176:179], a[228:231], a[64:67], v[176:179]
ds_read_b128 a[236:239], v15 offset:47104
v_perm_b32 v58, v33, v19, s55
v_mfma_f32_16x16x32_bf16 v[180:183], a[228:231], a[68:71], v[180:183]
ds_read_b32 a109, v58
v_perm_b32 v57, v37, v19, s54
v_mfma_f32_16x16x32_bf16 v[184:187], a[228:231], a[72:75], v[184:187]
s_waitcnt vmcnt(11)
s_add_u32 m0, s33, 158080
v_cmp_ne_u64 s[50:51], s[88:89], v[42:43]
v_cmp_ne_u64 s[44:45], s[88:89], v[46:47]
v_mfma_f32_16x16x32_bf16 v[188:191], a[228:231], a[76:79], v[188:191]
s_waitcnt lgkmcnt(3)
ds_read_b32 a110, v57
v_perm_b32 v56, v37, v19, s55
v_mfma_f32_16x16x32_bf16 v[128:131], a[232:235], a[80:83], v[128:131]
s_or_b64 s[50:51], s[44:45], s[50:51]
ds_read_b128 a[240:243], v15 offset:53248
buffer_load_dwordx4 v8, s[20:23], 0 offen offset:1664 lds
v_mfma_f32_16x16x32_bf16 v[132:135], a[232:235], a[84:87], v[132:135]
s_cbranch_scc1 L_SLOW21
L_BACK21:
v_mfma_f32_16x16x32_bf16 v[136:139], a[232:235], a[88:91], v[136:139]
ds_read_b32 a111, v56
v_perm_b32 v63, v40, v19, s52
v_mfma_f32_16x16x32_bf16 v[140:143], a[232:235], a[92:95], v[140:143]
s_waitcnt lgkmcnt(3)
ds_read_b32 a112, v63
v_mfma_f32_16x16x32_bf16 v[144:147], a[236:239], a[80:83], v[144:147]
ds_read_b128 a[244:247], v15 offset:55296
v_perm_b32 v62, v40, v19, s53
v_mfma_f32_16x16x32_bf16 v[148:151], a[236:239], a[84:87], v[148:151]
ds_read_b32 a113, v62
v_perm_b32 v61, v44, v19, s52
v_mfma_f32_16x16x32_bf16 v[152:155], a[236:239], a[88:91], v[152:155]
ds_read_b32 a114, v61
v_perm_b32 v60, v44, v19, s53
v_mfma_f32_16x16x32_bf16 v[156:159], a[236:239], a[92:95], v[156:159]
s_waitcnt lgkmcnt(4)
ds_read_b32 a115, v60
v_mfma_f32_16x16x32_bf16 v[160:163], a[240:243], a[80:83], v[160:163]
ds_read_b128 a[248:251], v14 offset:57344
v_perm_b32 v59, v40, v19, s54
v_mfma_f32_16x16x32_bf16 v[164:167], a[240:243], a[84:87], v[164:167]
ds_read_b32 a116, v59
v_perm_b32 v58, v40, v19, s55
v_mfma_f32_16x16x32_bf16 v[168:171], a[240:243], a[88:91], v[168:171]
s_add_u32 m0, s33, 64128
ds_read_b32 a117, v58
v_perm_b32 v57, v44, v19, s54
v_mfma_f32_16x16x32_bf16 v[172:175], a[240:243], a[92:95], v[172:175]
s_waitcnt lgkmcnt(4)
ds_read_b32 a118, v57
v_perm_b32 v56, v44, v19, s55
v_mfma_f32_16x16x32_bf16 v[176:179], a[244:247], a[80:83], v[176:179]
ds_read_b128 a[252:255], v14 offset:59392
buffer_load_dwordx4 v10, s[20:23], 0 offen offset:1408 lds
v_mfma_f32_16x16x32_bf16 v[180:183], a[244:247], a[84:87], v[180:183]
ds_read_b32 a119, v56
v_perm_b32 v63, v41, v19, s52
v_mfma_f32_16x16x32_bf16 v[184:187], a[244:247], a[88:91], v[184:187]
ds_read_b32 a120, v63
v_perm_b32 v62, v41, v19, s53
v_mfma_f32_16x16x32_bf16 v[188:191], a[244:247], a[92:95], v[188:191]
s_waitcnt lgkmcnt(4)
ds_read_b32 a121, v62
buffer_load_dwordx4 v[88:91], v12, s[24:27], 0 offen offset:2048 sc1
v_mfma_f32_16x16x32_bf16 v[128:131], a[248:251], a[96:99], v[128:131]
ds_read_b128 a[224:227], v14 offset:61440
v_perm_b32 v61, v45, v19, s52
v_mfma_f32_16x16x32_bf16 v[132:135], a[248:251], a[100:103], v[132:135]
ds_read_b32 a122, v61
v_perm_b32 v60, v45, v19, s53
v_mfma_f32_16x16x32_bf16 v[136:139], a[248:251], a[104:107], v[136:139]
ds_read_b32 a123, v60
v_perm_b32 v59, v41, v19, s54
v_mfma_f32_16x16x32_bf16 v[140:143], a[248:251], a[108:111], v[140:143]
s_waitcnt lgkmcnt(4)
ds_read_b32 a124, v59
buffer_load_dwordx4 v[92:95], v12, s[24:27], 0 offen offset:3072 sc1
v_mfma_f32_16x16x32_bf16 v[144:147], a[252:255], a[96:99], v[144:147]
ds_read_b128 a[228:231], v14 offset:63488
v_perm_b32 v58, v41, v19, s55
v_mfma_f32_16x16x32_bf16 v[148:151], a[252:255], a[100:103], v[148:151]
ds_read_b32 a125, v58
v_perm_b32 v57, v45, v19, s54
v_mfma_f32_16x16x32_bf16 v[152:155], a[252:255], a[104:107], v[152:155]
s_waitcnt vmcnt(11)
v_cmp_ne_u64 s[50:51], s[88:89], v[50:51]
v_cmp_ne_u64 s[44:45], s[88:89], v[54:55]
v_mfma_f32_16x16x32_bf16 v[156:159], a[252:255], a[108:111], v[156:159]
s_waitcnt lgkmcnt(3)
ds_read_b32 a126, v57
v_add_u32 v12, 53248, v13
v_mfma_f32_16x16x32_bf16 v[192:195], a[224:227], a[64:67], v[192:195]
s_or_b64 s[50:51], s[44:45], s[50:51]
ds_read_b128 a[232:235], v15 offset:49152
v_perm_b32 v56, v45, v19, s55
v_mfma_f32_16x16x32_bf16 v[196:199], a[224:227], a[68:71], v[196:199]
s_cbranch_scc1 L_SLOW22
L_BACK22:
v_mfma_f32_16x16x32_bf16 v[200:203], a[224:227], a[72:75], v[200:203]
ds_read_b32 a127, v56
v_perm_b32 v63, v48, v19, s52
v_mfma_f32_16x16x32_bf16 v[204:207], a[224:227], a[76:79], v[204:207]
s_waitcnt lgkmcnt(3)
ds_read_b32 a128, v63
v_mfma_f32_16x16x32_bf16 v[208:211], a[228:231], a[64:67], v[208:211]
ds_read_b128 a[236:239], v15 offset:51200
v_perm_b32 v62, v48, v19, s53
v_mfma_f32_16x16x32_bf16 v[212:215], a[228:231], a[68:71], v[212:215]
ds_read_b32 a129, v62
v_perm_b32 v61, v52, v19, s52
v_mfma_f32_16x16x32_bf16 v[216:219], a[228:231], a[72:75], v[216:219]
s_add_u32 m0, s33, 68352
ds_read_b32 a130, v61
v_perm_b32 v60, v52, v19, s53
v_mfma_f32_16x16x32_bf16 v[220:223], a[228:231], a[76:79], v[220:223]
s_waitcnt lgkmcnt(4)
ds_read_b32 a131, v60
v_perm_b32 v59, v48, v19, s54
v_mfma_f32_16x16x32_bf16 v[224:227], a[232:235], a[48:51], v[224:227]
ds_read_b128 a[240:243], v15 offset:57344
buffer_load_dwordx4 v11, s[20:23], 0 offen offset:1280 lds
v_mfma_f32_16x16x32_bf16 v[228:231], a[232:235], a[52:55], v[228:231]
ds_read_b32 a132, v59
v_perm_b32 v58, v48, v19, s55
v_mfma_f32_16x16x32_bf16 v[232:235], a[232:235], a[56:59], v[232:235]
ds_read_b32 a133, v58
v_perm_b32 v57, v52, v19, s54
v_mfma_f32_16x16x32_bf16 v[236:239], a[232:235], a[60:63], v[236:239]
s_waitcnt lgkmcnt(4)
ds_read_b32 a134, v57
buffer_load_dwordx4 v[32:35], v12, s[24:27], 0 offen offset:0 sc1
v_mfma_f32_16x16x32_bf16 v[240:243], a[236:239], a[48:51], v[240:243]
ds_read_b128 a[244:247], v15 offset:59392
v_perm_b32 v56, v52, v19, s55
v_mfma_f32_16x16x32_bf16 v[244:247], a[236:239], a[52:55], v[244:247]
ds_read_b32 a135, v56
v_perm_b32 v63, v49, v19, s52
v_mfma_f32_16x16x32_bf16 v[248:251], a[236:239], a[56:59], v[248:251]
ds_read_b32 a136, v63
v_perm_b32 v62, v49, v19, s53
v_mfma_f32_16x16x32_bf16 v[252:255], a[236:239], a[60:63], v[252:255]
s_waitcnt lgkmcnt(4)
ds_read_b32 a137, v62
buffer_load_dwordx4 v[36:39], v12, s[24:27], 0 offen offset:1024 sc1
v_mfma_f32_16x16x32_bf16 v[128:131], a[240:243], a[112:115], v[128:131]
s_waitcnt vmcnt(13)
s_barrier
ds_read_b128 a[248:251], v16 offset:0
v_perm_b32 v61, v53, v19, s52
v_mfma_f32_16x16x32_bf16 v[132:135], a[240:243], a[116:119], v[132:135]
ds_read_b32 a138, v61
v_perm_b32 v60, v53, v19, s53
v_mfma_f32_16x16x32_bf16 v[136:139], a[240:243], a[120:123], v[136:139]
s_add_u32 m0, s33, 71936
ds_read_b32 a139, v60
v_perm_b32 v59, v49, v19, s54
v_mfma_f32_16x16x32_bf16 v[140:143], a[240:243], a[124:127], v[140:143]
s_waitcnt lgkmcnt(4)
ds_read_b32 a140, v59
v_perm_b32 v58, v49, v19, s55
v_mfma_f32_16x16x32_bf16 v[144:147], a[244:247], a[112:115], v[144:147]
ds_read_b128 a[252:255], v16 offset:2048
buffer_load_dwordx4 v8, s[20:23], 0 offen offset:1792 lds
v_mfma_f32_16x16x32_bf16 v[148:151], a[244:247], a[116:119], v[148:151]
ds_read_b32 a141, v58
v_perm_b32 v57, v53, v19, s54
v_mfma_f32_16x16x32_bf16 v[152:155], a[244:247], a[120:123], v[152:155]
s_waitcnt vmcnt(12)
v_cmp_ne_u64 s[50:51], s[88:89], v[98:99]
v_cmp_ne_u64 s[44:45], s[88:89], v[102:103]
v_mfma_f32_16x16x32_bf16 v[156:159], a[244:247], a[124:127], v[156:159]
s_waitcnt lgkmcnt(3)
ds_read_b32 a142, v57
v_mfma_f32_16x16x32_bf16 v[160:163], a[248:251], a[96:99], v[160:163]
s_or_b64 s[50:51], s[44:45], s[50:51]
ds_read_b128 a[224:227], v15 offset:61440
v_perm_b32 v56, v53, v19, s55
v_mfma_f32_16x16x32_bf16 v[164:167], a[248:251], a[100:103], v[164:167]
s_cbranch_scc1 L_SLOW23
L_BACK23:
v_mfma_f32_16x16x32_bf16 v[168:171], a[248:251], a[104:107], v[168:171]
ds_read_b32 a143, v56
v_perm_b32 v63, v96, v19, s52
v_mfma_f32_16x16x32_bf16 v[172:175], a[248:251], a[108:111], v[172:175]
s_waitcnt lgkmcnt(3)
ds_read_b32 a144, v63
v_mfma_f32_16x16x32_bf16 v[176:179], a[252:255], a[96:99], v[176:179]
ds_read_b128 a[228:231], v15 offset:63488
v_perm_b32 v62, v96, v19, s53
v_mfma_f32_16x16x32_bf16 v[180:183], a[252:255], a[100:103], v[180:183]
ds_read_b32 a145, v62
v_perm_b32 v61, v100, v19, s52
v_mfma_f32_16x16x32_bf16 v[184:187], a[252:255], a[104:107], v[184:187]
s_add_u32 m0, s33, 76160
ds_read_b32 a146, v61
v_perm_b32 v60, v100, v19, s53
v_mfma_f32_16x16x32_bf16 v[188:191], a[252:255], a[108:111], v[188:191]
s_waitcnt lgkmcnt(4)
ds_read_b32 a147, v60
v_perm_b32 v59, v96, v19, s54
v_mfma_f32_16x16x32_bf16 v[192:195], a[224:227], a[80:83], v[192:195]
ds_read_b128 a[232:235], v16 offset:4096
buffer_load_dwordx4 v9, s[20:23], 0 offen offset:1664 lds
v_mfma_f32_16x16x32_bf16 v[196:199], a[224:227], a[84:87], v[196:199]
ds_read_b32 a148, v59
v_perm_b32 v58, v96, v19, s55
v_mfma_f32_16x16x32_bf16 v[200:203], a[224:227], a[88:91], v[200:203]
ds_read_b32 a149, v58
v_perm_b32 v57, v100, v19, s54
v_mfma_f32_16x16x32_bf16 v[204:207], a[224:227], a[92:95], v[204:207]
s_waitcnt lgkmcnt(4)
ds_read_b32 a150, v57
buffer_load_dwordx4 v[40:43], v12, s[24:27], 0 offen offset:2048 sc1
v_mfma_f32_16x16x32_bf16 v[208:211], a[228:231], a[80:83], v[208:211]
ds_read_b128 a[236:239], v16 offset:6144
v_perm_b32 v56, v100, v19, s55
v_mfma_f32_16x16x32_bf16 v[212:215], a[228:231], a[84:87], v[212:215]
ds_read_b32 a151, v56
v_perm_b32 v63, v97, v19, s52
v_mfma_f32_16x16x32_bf16 v[216:219], a[228:231], a[88:91], v[216:219]
ds_read_b32 a152, v63
v_perm_b32 v62, v97, v19, s53
v_mfma_f32_16x16x32_bf16 v[220:223], a[228:231], a[92:95], v[220:223]
s_waitcnt lgkmcnt(4)
ds_read_b32 a153, v62
buffer_load_dwordx4 v[44:47], v12, s[24:27], 0 offen offset:3072 sc1
v_mfma_f32_16x16x32_bf16 v[128:131], a[232:235], a[128:131], v[128:131]
ds_read_b128 a[240:243], v17 offset:0
v_perm_b32 v61, v101, v19, s52
v_mfma_f32_16x16x32_bf16 v[132:135], a[232:235], a[132:135], v[132:135]
ds_read_b32 a154, v61
v_perm_b32 v60, v101, v19, s53
v_mfma_f32_16x16x32_bf16 v[136:139], a[232:235], a[136:139], v[136:139]
s_add_u32 m0, s33, 80384
ds_read_b32 a155, v60
v_perm_b32 v59, v97, v19, s54
v_mfma_f32_16x16x32_bf16 v[140:143], a[232:235], a[140:143], v[140:143]
s_waitcnt lgkmcnt(4)
ds_read_b32 a156, v59
v_perm_b32 v58, v97, v19, s55
v_mfma_f32_16x16x32_bf16 v[144:147], a[236:239], a[128:131], v[144:147]
ds_read_b128 a[244:247], v17 offset:2048
buffer_load_dwordx4 v10, s[20:23], 0 offen offset:1536 lds
v_mfma_f32_16x16x32_bf16 v[148:151], a[236:239], a[132:135], v[148:151]
ds_read_b32 a157, v58
v_perm_b32 v57, v101, v19, s54
v_mfma_f32_16x16x32_bf16 v[152:155], a[236:239], a[136:139], v[152:155]
s_waitcnt vmcnt(12)
v_cmp_ne_u64 s[50:51], s[88:89], v[82:83]
v_cmp_ne_u64 s[44:45], s[88:89], v[86:87]
v_mfma_f32_16x16x32_bf16 v[156:159], a[236:239], a[140:143], v[156:159]
s_waitcnt lgkmcnt(3)
ds_read_b32 a158, v57
v_add_u32 v12, 57344, v13
v_mfma_f32_16x16x32_bf16 v[160:163], a[240:243], a[112:115], v[160:163]
s_or_b64 s[50:51], s[44:45], s[50:51]
ds_read_b128 a[248:251], v17 offset:4096
v_perm_b32 v56, v101, v19, s55
v_mfma_f32_16x16x32_bf16 v[164:167], a[240:243], a[116:119], v[164:167]
s_cbranch_scc1 L_SLOW24
L_BACK24:
v_mfma_f32_16x16x32_bf16 v[168:171], a[240:243], a[120:123], v[168:171]
ds_read_b32 a159, v56
v_perm_b32 v63, v80, v19, s52
v_mfma_f32_16x16x32_bf16 v[172:175], a[240:243], a[124:127], v[172:175]
s_waitcnt lgkmcnt(3)
ds_read_b32 a160, v63
v_mfma_f32_16x16x32_bf16 v[176:179], a[244:247], a[112:115], v[176:179]
ds_read_b128 a[252:255], v17 offset:6144
v_perm_b32 v62, v80, v19, s53
v_mfma_f32_16x16x32_bf16 v[180:183], a[244:247], a[116:119], v[180:183]
ds_read_b32 a161, v62
v_perm_b32 v61, v84, v19, s52
v_mfma_f32_16x16x32_bf16 v[184:187], a[244:247], a[120:123], v[184:187]
s_add_u32 m0, s33, 84096
ds_read_b32 a162, v61
v_perm_b32 v60, v84, v19, s53
v_mfma_f32_16x16x32_bf16 v[188:191], a[244:247], a[124:127], v[188:191]
s_waitcnt lgkmcnt(4)
ds_read_b32 a163, v60
v_perm_b32 v59, v80, v19, s54
v_mfma_f32_16x16x32_bf16 v[128:131], a[248:251], a[144:147], v[128:131]
ds_read_b128 a[224:227], v16 offset:8192
buffer_load_dwordx4 v8, s[20:23], 0 offen offset:1920 lds
v_mfma_f32_16x16x32_bf16 v[132:135], a[248:251], a[148:151], v[132:135]
ds_read_b32 a164, v59
v_perm_b32 v58, v80, v19, s55
v_mfma_f32_16x16x32_bf16 v[136:139], a[248:251], a[152:155], v[136:139]
ds_read_b32 a165, v58
v_perm_b32 v57, v84, v19, s54
v_mfma_f32_16x16x32_bf16 v[140:143], a[248:251], a[156:159], v[140:143]
s_waitcnt lgkmcnt(4)
ds_read_b32 a166, v57
buffer_load_dwordx4 v[48:51], v12, s[24:27], 0 offen offset:0 sc1
v_mfma_f32_16x16x32_bf16 v[144:147], a[252:255], a[144:147], v[144:147]
ds_read_b128 a[228:231], v16 offset:10240
v_perm_b32 v56, v84, v19, s55
v_mfma_f32_16x16x32_bf16 v[148:151], a[252:255], a[148:151], v[148:151]
ds_read_b32 a167, v56
v_perm_b32 v63, v81, v19, s52
v_mfma_f32_16x16x32_bf16 v[152:155], a[252:255], a[152:155], v[152:155]
ds_read_b32 a168, v63
v_perm_b32 v62, v81, v19, s53
v_mfma_f32_16x16x32_bf16 v[156:159], a[252:255], a[156:159], v[156:159]
s_waitcnt lgkmcnt(4)
ds_read_b32 a169, v62
buffer_load_dwordx4 v[52:55], v12, s[24:27], 0 offen offset:1024 sc1
v_mfma_f32_16x16x32_bf16 v[192:195], a[224:227], a[96:99], v[192:195]
ds_read_b128 a[232:235], v16 offset:12288
v_perm_b32 v61, v85, v19, s52
v_mfma_f32_16x16x32_bf16 v[196:199], a[224:227], a[100:103], v[196:199]
ds_read_b32 a170, v61
v_perm_b32 v60, v85, v19, s53
v_mfma_f32_16x16x32_bf16 v[200:203], a[224:227], a[104:107], v[200:203]
s_add_u32 m0, s33, 88320
ds_read_b32 a171, v60
v_perm_b32 v59, v81, v19, s54
v_mfma_f32_16x16x32_bf16 v[204:207], a[224:227], a[108:111], v[204:207]
s_waitcnt lgkmcnt(4)
ds_read_b32 a172, v59
v_perm_b32 v58, v81, v19, s55
v_mfma_f32_16x16x32_bf16 v[208:211], a[228:231], a[96:99], v[208:211]
ds_read_b128 a[236:239], v16 offset:14336
buffer_load_dwordx4 v9, s[20:23], 0 offen offset:1792 lds
v_mfma_f32_16x16x32_bf16 v[212:215], a[228:231], a[100:103], v[212:215]
ds_read_b32 a173, v58
v_perm_b32 v57, v85, v19, s54
v_mfma_f32_16x16x32_bf16 v[216:219], a[228:231], a[104:107], v[216:219]
s_waitcnt vmcnt(12)
v_cmp_ne_u64 s[50:51], s[88:89], v[90:91]
v_cmp_ne_u64 s[44:45], s[88:89], v[94:95]
v_mfma_f32_16x16x32_bf16 v[220:223], a[228:231], a[108:111], v[220:223]
s_waitcnt lgkmcnt(3)
ds_read_b32 a174, v57
v_mfma_f32_16x16x32_bf16 v[224:227], a[232:235], a[64:67], v[224:227]
L_PAD4:
s_cbranch_vccnz L_PADRET
s_or_b64 s[50:51], s[44:45], s[50:51]
ds_read_b128 a[240:243], v16 offset:16384
v_perm_b32 v56, v85, v19, s55
v_mfma_f32_16x16x32_bf16 v[228:231], a[232:235], a[68:71], v[228:231]
s_cbranch_scc1 L_SLOW25
L_BACK25:
v_mfma_f32_16x16x32_bf16 v[232:235], a[232:235], a[72:75], v[232:235]
s_add_u32 m0, s33, 92544
ds_read_b32 a175, v56
v_perm_b32 v63, v88, v19, s52
v_mfma_f32_16x16x32_bf16 v[236:239], a[232:235], a[76:79], v[236:239]
s_waitcnt lgkmcnt(3)
ds_read_b32 a176, v63
v_perm_b32 v62, v88, v19, s53
v_mfma_f32_16x16x32_bf16 v[240:243], a[236:239], a[64:67], v[240:243]
ds_read_b128 a[244:247], v16 offset:18432
buffer_load_dwordx4 v10, s[20:23], 0 offen offset:1664 lds
v_mfma_f32_16x16x32_bf16 v[244:247], a[236:239], a[68:71], v[244:247]
ds_read_b32 a177, v62
v_perm_b32 v61, v92, v19, s52
v_mfma_f32_16x16x32_bf16 v[248:251], a[236:239], a[72:75], v[248:251]
ds_read_b32 a178, v61
v_perm_b32 v60, v92, v19, s53
v_mfma_f32_16x16x32_bf16 v[252:255], a[236:239], a[76:79], v[252:255]
s_waitcnt lgkmcnt(4)
ds_read_b32 a179, v60
v_mfma_f32_16x16x32_bf16 v[160:163], a[240:243], a[128:131], v[160:163]
s_barrier
ds_read_b128 a[248:251], v16 offset:20480
v_perm_b32 v59, v88, v19, s54
v_mfma_f32_16x16x32_bf16 v[164:167], a[240:243], a[132:135], v[164:167]
ds_read_b32 a180, v59
v_perm_b32 v58, v88, v19, s55
v_mfma_f32_16x16x32_bf16 v[168:171], a[240:243], a[136:139], v[168:171]
ds_read_b32 a181, v58
v_perm_b32 v57, v92, v19, s54
v_mfma_f32_16x16x32_bf16 v[172:175], a[240:243], a[140:143], v[172:175]
s_waitcnt lgkmcnt(4)
ds_read_b32 a182, v57
buffer_load_dwordx4 v[96:99], v12, s[24:27], 0 offen offset:2048 sc1
v_mfma_f32_16x16x32_bf16 v[176:179], a[244:247], a[128:131], v[176:179]
ds_read_b128 a[252:255], v16 offset:22528
v_perm_b32 v56, v92, v19, s55
v_mfma_f32_16x16x32_bf16 v[180:183], a[244:247], a[132:135], v[180:183]
ds_read_b32 a183, v56
v_perm_b32 v63, v89, v19, s52
v_mfma_f32_16x16x32_bf16 v[184:187], a[244:247], a[136:139], v[184:187]
ds_read_b32 a184, v63
v_perm_b32 v62, v89, v19, s53
v_mfma_f32_16x16x32_bf16 v[188:191], a[244:247], a[140:143], v[188:191]
s_waitcnt lgkmcnt(4)
ds_read_b32 a185, v62
buffer_load_dwordx4 v[100:103], v12, s[24:27], 0 offen offset:3072 sc1
v_mfma_f32_16x16x32_bf16 v[128:131], a[248:251], a[160:163], v[128:131]
ds_read_b128 a[224:227], v17 offset:16384
v_perm_b32 v61, v93, v19, s52
v_mfma_f32_16x16x32_bf16 v[132:135], a[248:251], a[164:167], v[132:135]
ds_read_b32 a186, v61
v_perm_b32 v60, v93, v19, s53
v_mfma_f32_16x16x32_bf16 v[136:139], a[248:251], a[168:171], v[136:139]
s_add_u32 m0, s33, 96896
ds_read_b32 a187, v60
v_perm_b32 v59, v89, v19, s54
v_mfma_f32_16x16x32_bf16 v[140:143], a[248:251], a[172:175], v[140:143]
s_waitcnt lgkmcnt(4)
ds_read_b32 a188, v59
v_perm_b32 v58, v89, v19, s55
v_mfma_f32_16x16x32_bf16 v[144:147], a[252:255], a[160:163], v[144:147]
ds_read_b128 a[228:231], v17 offset:18432
buffer_load_dwordx4 v11, s[20:23], 0 offen offset:1408 lds
v_mfma_f32_16x16x32_bf16 v[148:151], a[252:255], a[164:167], v[148:151]
ds_read_b32 a189, v58
v_perm_b32 v57, v93, v19, s54
v_mfma_f32_16x16x32_bf16 v[152:155], a[252:255], a[168:171], v[152:155]
s_waitcnt vmcnt(13)
v_cmp_ne_u64 s[50:51], s[88:89], v[34:35]
v_cmp_ne_u64 s[44:45], s[88:89], v[38:39]
v_mfma_f32_16x16x32_bf16 v[156:159], a[252:255], a[172:175], v[156:159]
s_waitcnt lgkmcnt(3)
ds_read_b32 a190, v57
v_add_u32 v12, 61440, v13
v_mfma_f32_16x16x32_bf16 v[160:163], a[224:227], a[144:147], v[160:163]
s_or_b64 s[50:51], s[44:45], s[50:51]
ds_read_b128 a[232:235], v17 offset:8192
v_perm_b32 v56, v93, v19, s55
v_mfma_f32_16x16x32_bf16 v[164:167], a[224:227], a[148:151], v[164:167]
s_cbranch_scc1 L_SLOW26
L_BACK26:
v_mfma_f32_16x16x32_bf16 v[168:171], a[224:227], a[152:155], v[168:171]
ds_read_b32 a191, v56
v_perm_b32 v63, v32, v19, s52
v_mfma_f32_16x16x32_bf16 v[172:175], a[224:227], a[156:159], v[172:175]
s_waitcnt lgkmcnt(3)
ds_read_b32 a192, v63
v_mfma_f32_16x16x32_bf16 v[176:179], a[228:231], a[144:147], v[176:179]
ds_read_b128 a[236:239], v17 offset:10240
v_perm_b32 v62, v32, v19, s53
v_mfma_f32_16x16x32_bf16 v[180:183], a[228:231], a[148:151], v[180:183]
ds_read_b32 a193, v62
v_perm_b32 v61, v36, v19, s52
v_mfma_f32_16x16x32_bf16 v[184:187], a[228:231], a[152:155], v[184:187]
s_add_u32 m0, s33, 100480
ds_read_b32 a194, v61
v_perm_b32 v60, v36, v19, s53
v_mfma_f32_16x16x32_bf16 v[188:191], a[228:231], a[156:159], v[188:191]
s_waitcnt lgkmcnt(4)
ds_read_b32 a195, v60
v_perm_b32 v59, v32, v19, s54
v_mfma_f32_16x16x32_bf16 v[192:195], a[232:235], a[112:115], v[192:195]
ds_read_b128 a[240:243], v17 offset:20480
buffer_load_dwordx4 v9, s[20:23], 0 offen offset:1920 lds
v_mfma_f32_16x16x32_bf16 v[196:199], a[232:235], a[116:119], v[196:199]
ds_read_b32 a196, v59
v_perm_b32 v58, v32, v19, s55
v_mfma_f32_16x16x32_bf16 v[200:203], a[232:235], a[120:123], v[200:203]
ds_read_b32 a197, v58
v_perm_b32 v57, v36, v19, s54
v_mfma_f32_16x16x32_bf16 v[204:207], a[232:235], a[124:127], v[204:207]
s_waitcnt lgkmcnt(4)
ds_read_b32 a198, v57
buffer_load_dwordx4 v[80:83], v12, s[24:27], 0 offen offset:0 sc1
v_mfma_f32_16x16x32_bf16 v[208:211], a[236:239], a[112:115], v[208:211]
ds_read_b128 a[244:247], v17 offset:22528
v_perm_b32 v56, v36, v19, s55
v_mfma_f32_16x16x32_bf16 v[212:215], a[236:239], a[116:119], v[212:215]
ds_read_b32 a199, v56
v_perm_b32 v63, v33, v19, s52
v_mfma_f32_16x16x32_bf16 v[216:219], a[236:239], a[120:123], v[216:219]
ds_read_b32 a200, v63
v_perm_b32 v62, v33, v19, s53
v_mfma_f32_16x16x32_bf16 v[220:223], a[236:239], a[124:127], v[220:223]
s_waitcnt lgkmcnt(4)
ds_read_b32 a201, v62
buffer_load_dwordx4 v[84:87], v12, s[24:27], 0 offen offset:1024 sc1
v_mfma_f32_16x16x32_bf16 v[128:131], a[240:243], a[176:179], v[128:131]
ds_read_b128 a[248:251], v17 offset:12288
v_perm_b32 v61, v37, v19, s52
v_mfma_f32_16x16x32_bf16 v[132:135], a[240:243], a[180:183], v[132:135]
ds_read_b32 a202, v61
v_perm_b32 v60, v37, v19, s53
v_mfma_f32_16x16x32_bf16 v[136:139], a[240:243], a[184:187], v[136:139]
s_add_u32 m0, s33, 104704
ds_read_b32 a203, v60
v_perm_b32 v59, v33, v19, s54
v_mfma_f32_16x16x32_bf16 v[140:143], a[240:243], a[188:191], v[140:143]
s_waitcnt lgkmcnt(4)
ds_read_b32 a204, v59
v_perm_b32 v58, v33, v19, s55
v_mfma_f32_16x16x32_bf16 v[144:147], a[244:247], a[176:179], v[144:147]
ds_read_b128 a[252:255], v17 offset:14336
buffer_load_dwordx4 v10, s[20:23], 0 offen offset:1792 lds
v_mfma_f32_16x16x32_bf16 v[148:151], a[244:247], a[180:183], v[148:151]
ds_read_b32 a205, v58
v_perm_b32 v57, v37, v19, s54
v_mfma_f32_16x16x32_bf16 v[152:155], a[244:247], a[184:187], v[152:155]
s_waitcnt vmcnt(13)
v_cmp_ne_u64 s[50:51], s[88:89], v[42:43]
v_cmp_ne_u64 s[44:45], s[88:89], v[46:47]
v_mfma_f32_16x16x32_bf16 v[156:159], a[244:247], a[188:191], v[156:159]
s_waitcnt lgkmcnt(3)
ds_read_b32 a206, v57
v_mfma_f32_16x16x32_bf16 v[224:227], a[248:251], a[80:83], v[224:227]
s_or_b64 s[50:51], s[44:45], s[50:51]
ds_read_b128 a[224:227], v16 offset:24576
v_perm_b32 v56, v37, v19, s55
v_mfma_f32_16x16x32_bf16 v[228:231], a[248:251], a[84:87], v[228:231]
s_cbranch_scc1 L_SLOW27
L_BACK27:
v_mfma_f32_16x16x32_bf16 v[232:235], a[248:251], a[88:91], v[232:235]
ds_read_b32 a207, v56
v_perm_b32 v63, v40, v19, s52
v_mfma_f32_16x16x32_bf16 v[236:239], a[248:251], a[92:95], v[236:239]
s_waitcnt lgkmcnt(3)
ds_read_b32 a208, v63
v_mfma_f32_16x16x32_bf16 v[240:243], a[252:255], a[80:83], v[240:243]
ds_read_b128 a[228:231], v16 offset:26624
v_perm_b32 v62, v40, v19, s53
v_mfma_f32_16x16x32_bf16 v[244:247], a[252:255], a[84:87], v[244:247]
ds_read_b32 a209, v62
v_perm_b32 v61, v44, v19, s52
v_mfma_f32_16x16x32_bf16 v[248:251], a[252:255], a[88:91], v[248:251]
s_add_u32 m0, s33, 109056
ds_read_b32 a210, v61
v_perm_b32 v60, v44, v19, s53
v_mfma_f32_16x16x32_bf16 v[252:255], a[252:255], a[92:95], v[252:255]
s_waitcnt lgkmcnt(4)
ds_read_b32 a211, v60
v_perm_b32 v59, v40, v19, s54
v_mfma_f32_16x16x32_bf16 v[160:163], a[224:227], a[160:163], v[160:163]
ds_read_b128 a[232:235], v16 offset:28672
buffer_load_dwordx4 v11, s[20:23], 0 offen offset:1536 lds
v_mfma_f32_16x16x32_bf16 v[164:167], a[224:227], a[164:167], v[164:167]
ds_read_b32 a212, v59
v_perm_b32 v58, v40, v19, s55
v_mfma_f32_16x16x32_bf16 v[168:171], a[224:227], a[168:171], v[168:171]
ds_read_b32 a213, v58
v_perm_b32 v57, v44, v19, s54
v_mfma_f32_16x16x32_bf16 v[172:175], a[224:227], a[172:175], v[172:175]
s_waitcnt lgkmcnt(4)
ds_read_b32 a214, v57
v_mfma_f32_16x16x32_bf16 v[176:179], a[228:231], a[160:163], v[176:179]
ds_read_b128 a[236:239], v16 offset:30720
v_perm_b32 v56, v44, v19, s55
v_mfma_f32_16x16x32_bf16 v[180:183], a[228:231], a[164:167], v[180:183]
ds_read_b32 a215, v56
v_perm_b32 v63, v41, v19, s52
v_mfma_f32_16x16x32_bf16 v[184:187], a[228:231], a[168:171], v[184:187]
ds_read_b32 a216, v63
v_perm_b32 v62, v41, v19, s53
v_mfma_f32_16x16x32_bf16 v[188:191], a[228:231], a[172:175], v[188:191]
s_waitcnt lgkmcnt(4)
ds_read_b32 a217, v62
v_mfma_f32_16x16x32_bf16 v[128:131], a[232:235], a[192:195], v[128:131]
ds_read_b128 a[240:243], v14 offset:0
v_perm_b32 v61, v45, v19, s52
v_mfma_f32_16x16x32_bf16 v[132:135], a[232:235], a[196:199], v[132:135]
ds_read_b32 a218, v61
v_perm_b32 v60, v45, v19, s53
v_mfma_f32_16x16x32_bf16 v[136:139], a[232:235], a[200:203], v[136:139]
s_add_u32 m0, s33, 112768
ds_read_b32 a219, v60
v_perm_b32 v59, v41, v19, s54
v_mfma_f32_16x16x32_bf16 v[140:143], a[232:235], a[204:207], v[140:143]
s_waitcnt vmcnt(10) lgkmcnt(4)
v_cmp_ne_u64 s[50:51], s[88:89], v[50:51]
v_cmp_ne_u64 s[44:45], s[88:89], v[54:55]
v_mfma_f32_16x16x32_bf16 v[144:147], a[236:239], a[192:195], v[144:147]
ds_read_b128 a[244:247], v14 offset:2048
buffer_load_dwordx4 v10, s[20:23], 0 offen offset:1920 lds
v_mfma_f32_16x16x32_bf16 v[148:151], a[236:239], a[196:199], v[148:151]
ds_read_b32 a220, v59
v_perm_b32 v58, v41, v19, s55
v_mfma_f32_16x16x32_bf16 v[152:155], a[236:239], a[200:203], v[152:155]
s_or_b64 s[50:51], s[44:45], s[50:51]
ds_read_b32 a221, v58
v_perm_b32 v57, v45, v19, s54
v_mfma_f32_16x16x32_bf16 v[156:159], a[236:239], a[204:207], v[156:159]
s_waitcnt lgkmcnt(3)
ds_read_b32 a222, v57
buffer_load_dwordx4 v[88:91], v12, s[24:27], 0 offen offset:2048 sc1
v_mfma_f32_16x16x32_bf16 v[192:195], a[240:243], a[128:131], v[192:195]
s_barrier
ds_read_b128 a[248:251], v17 offset:24576
v_perm_b32 v56, v45, v19, s55
v_mfma_f32_16x16x32_bf16 v[196:199], a[240:243], a[132:135], v[196:199]
s_cbranch_scc1 L_SLOW28
L_BACK28:
v_mfma_f32_16x16x32_bf16 v[200:203], a[240:243], a[136:139], v[200:203]
ds_read_b32 a223, v56
v_perm_b32 v63, v48, v19, s52
v_mfma_f32_16x16x32_bf16 v[204:207], a[240:243], a[140:143], v[204:207]
s_waitcnt lgkmcnt(3)
ds_read_b32 a0, v63
buffer_load_dwordx4 v[92:95], v12, s[24:27], 0 offen offset:3072 sc1
v_mfma_f32_16x16x32_bf16 v[208:211], a[244:247], a[128:131], v[208:211]
ds_read_b128 a[252:255], v17 offset:26624
v_perm_b32 v62, v48, v19, s53
v_mfma_f32_16x16x32_bf16 v[212:215], a[244:247], a[132:135], v[212:215]
ds_read_b32 a1, v62
v_perm_b32 v61, v52, v19, s52
v_mfma_f32_16x16x32_bf16 v[216:219], a[244:247], a[136:139], v[216:219]
s_add_u32 m0, s33, 117120
ds_read_b32 a2, v61
v_perm_b32 v60, v52, v19, s53
v_mfma_f32_16x16x32_bf16 v[220:223], a[244:247], a[140:143], v[220:223]
s_waitcnt lgkmcnt(4)
ds_read_b32 a3, v60
v_perm_b32 v59, v48, v19, s54
v_mfma_f32_16x16x32_bf16 v[160:163], a[248:251], a[176:179], v[160:163]
ds_read_b128 a[224:227], v17 offset:28672
buffer_load_dwordx4 v11, s[20:23], 0 offen offset:1664 lds
v_mfma_f32_16x16x32_bf16 v[164:167], a[248:251], a[180:183], v[164:167]
ds_read_b32 a4, v59
v_perm_b32 v58, v48, v19, s55
v_mfma_f32_16x16x32_bf16 v[168:171], a[248:251], a[184:187], v[168:171]
ds_read_b32 a5, v58
v_perm_b32 v57, v52, v19, s54
v_mfma_f32_16x16x32_bf16 v[172:175], a[248:251], a[188:191], v[172:175]
s_waitcnt lgkmcnt(4)
ds_read_b32 a6, v57
v_mfma_f32_16x16x32_bf16 v[176:179], a[252:255], a[176:179], v[176:179]
ds_read_b128 a[228:231], v17 offset:30720
v_perm_b32 v56, v52, v19, s55
v_mfma_f32_16x16x32_bf16 v[180:183], a[252:255], a[180:183], v[180:183]
ds_read_b32 a7, v56
v_perm_b32 v63, v49, v19, s52
v_mfma_f32_16x16x32_bf16 v[184:187], a[252:255], a[184:187], v[184:187]
ds_read_b32 a8, v63
v_perm_b32 v62, v49, v19, s53
v_mfma_f32_16x16x32_bf16 v[188:191], a[252:255], a[188:191], v[188:191]
s_waitcnt lgkmcnt(4)
ds_read_b32 a9, v62
v_mfma_f32_16x16x32_bf16 v[128:131], a[224:227], a[208:211], v[128:131]
ds_read_b128 a[232:235], v15 offset:0
v_perm_b32 v61, v53, v19, s52
v_mfma_f32_16x16x32_bf16 v[132:135], a[224:227], a[212:215], v[132:135]
ds_read_b32 a10, v61
v_perm_b32 v60, v53, v19, s53
v_mfma_f32_16x16x32_bf16 v[136:139], a[224:227], a[216:219], v[136:139]
s_add_u32 m0, s33, 121088
ds_read_b32 a11, v60
v_perm_b32 v59, v49, v19, s54
v_mfma_f32_16x16x32_bf16 v[140:143], a[224:227], a[220:223], v[140:143]
s_waitcnt lgkmcnt(4)
ds_read_b32 a12, v59
v_perm_b32 v58, v49, v19, s55
v_mfma_f32_16x16x32_bf16 v[144:147], a[228:231], a[208:211], v[144:147]
ds_read_b128 a[236:239], v15 offset:2048
buffer_load_dwordx4 v11, s[20:23], 0 offen offset:1792 lds
v_mfma_f32_16x16x32_bf16 v[148:151], a[228:231], a[212:215], v[148:151]
ds_read_b32 a13, v58
v_perm_b32 v57, v53, v19, s54
v_mfma_f32_16x16x32_bf16 v[152:155], a[228:231], a[216:219], v[152:155]
s_waitcnt vmcnt(11)
v_cmp_ne_u64 s[50:51], s[88:89], v[98:99]
v_cmp_ne_u64 s[44:45], s[88:89], v[102:103]
v_mfma_f32_16x16x32_bf16 v[156:159], a[228:231], a[220:223], v[156:159]
s_waitcnt lgkmcnt(3)
ds_read_b32 a14, v57
v_mfma_f32_16x16x32_bf16 v[192:195], a[232:235], a[144:147], v[192:195]
s_or_b64 s[50:51], s[44:45], s[50:51]
ds_read_b128 a[240:243], v14 offset:4096
v_perm_b32 v56, v53, v19, s55
v_mfma_f32_16x16x32_bf16 v[196:199], a[232:235], a[148:151], v[196:199]
s_cbranch_scc1 L_SLOW29
L_BACK29:
v_mfma_f32_16x16x32_bf16 v[200:203], a[232:235], a[152:155], v[200:203]
ds_read_b32 a15, v56
v_perm_b32 v63, v96, v19, s52
v_mfma_f32_16x16x32_bf16 v[204:207], a[232:235], a[156:159], v[204:207]
s_waitcnt lgkmcnt(3)
ds_read_b32 a16, v63
v_mfma_f32_16x16x32_bf16 v[208:211], a[236:239], a[144:147], v[208:211]
ds_read_b128 a[244:247], v14 offset:6144
v_perm_b32 v62, v96, v19, s53
v_mfma_f32_16x16x32_bf16 v[212:215], a[236:239], a[148:151], v[212:215]
ds_read_b32 a17, v62
v_perm_b32 v61, v100, v19, s52
v_mfma_f32_16x16x32_bf16 v[216:219], a[236:239], a[152:155], v[216:219]
s_add_u32 m0, s33, 125056
ds_read_b32 a18, v61
v_perm_b32 v60, v100, v19, s53
v_mfma_f32_16x16x32_bf16 v[220:223], a[236:239], a[156:159], v[220:223]
s_waitcnt lgkmcnt(4)
ds_read_b32 a19, v60
v_perm_b32 v59, v96, v19, s54
v_mfma_f32_16x16x32_bf16 v[224:227], a[240:243], a[96:99], v[224:227]
ds_read_b128 a[248:251], v14 offset:8192
buffer_load_dwordx4 v11, s[20:23], 0 offen offset:1920 lds
v_mfma_f32_16x16x32_bf16 v[228:231], a[240:243], a[100:103], v[228:231]
ds_read_b32 a20, v59
v_perm_b32 v58, v96, v19, s55
v_mfma_f32_16x16x32_bf16 v[232:235], a[240:243], a[104:107], v[232:235]
ds_read_b32 a21, v58
v_perm_b32 v57, v100, v19, s54
v_mfma_f32_16x16x32_bf16 v[236:239], a[240:243], a[108:111], v[236:239]
s_waitcnt lgkmcnt(4)
ds_read_b32 a22, v57
v_mfma_f32_16x16x32_bf16 v[240:243], a[244:247], a[96:99], v[240:243]
ds_read_b128 a[252:255], v14 offset:10240
v_perm_b32 v56, v100, v19, s55
v_mfma_f32_16x16x32_bf16 v[244:247], a[244:247], a[100:103], v[244:247]
ds_read_b32 a23, v56
v_perm_b32 v63, v97, v19, s52
v_mfma_f32_16x16x32_bf16 v[248:251], a[244:247], a[104:107], v[248:251]
ds_read_b32 a24, v63
v_perm_b32 v62, v97, v19, s53
v_mfma_f32_16x16x32_bf16 v[252:255], a[244:247], a[108:111], v[252:255]
s_waitcnt lgkmcnt(4)
ds_read_b32 a25, v62
v_mfma_f32_16x16x32_bf16 v[128:131], a[248:251], a[0:3], v[128:131]
ds_read_b128 a[224:227], v14 offset:12288
v_perm_b32 v61, v101, v19, s52
v_mfma_f32_16x16x32_bf16 v[132:135], a[248:251], a[4:7], v[132:135]
ds_read_b32 a26, v61
v_perm_b32 v60, v101, v19, s53
v_mfma_f32_16x16x32_bf16 v[136:139], a[248:251], a[8:11], v[136:139]
ds_read_b32 a27, v60
v_perm_b32 v59, v97, v19, s54
v_mfma_f32_16x16x32_bf16 v[140:143], a[248:251], a[12:15], v[140:143]
s_waitcnt lgkmcnt(4)
ds_read_b32 a28, v59
v_mfma_f32_16x16x32_bf16 v[144:147], a[252:255], a[0:3], v[144:147]
ds_read_b128 a[228:231], v14 offset:14336
v_perm_b32 v58, v97, v19, s55
v_mfma_f32_16x16x32_bf16 v[148:151], a[252:255], a[4:7], v[148:151]
ds_read_b32 a29, v58
v_perm_b32 v57, v101, v19, s54
v_mfma_f32_16x16x32_bf16 v[152:155], a[252:255], a[8:11], v[152:155]
ds_read_b32 a30, v57
v_mfma_f32_16x16x32_bf16 v[156:159], a[252:255], a[12:15], v[156:159]
s_waitcnt vmcnt(8) lgkmcnt(4)
v_cmp_ne_u64 s[50:51], s[88:89], v[82:83]
v_cmp_ne_u64 s[44:45], s[88:89], v[86:87]
v_mfma_f32_16x16x32_bf16 v[160:163], a[224:227], a[192:195], v[160:163]
ds_read_b128 a[232:235], v15 offset:8192
v_perm_b32 v56, v101, v19, s55
v_mfma_f32_16x16x32_bf16 v[164:167], a[224:227], a[196:199], v[164:167]
s_or_b64 s[50:51], s[44:45], s[50:51]
ds_read_b32 a31, v56
v_mfma_f32_16x16x32_bf16 v[168:171], a[224:227], a[200:203], v[168:171]
s_cbranch_scc1 L_SLOW30
L_BACK30:
v_mfma_f32_16x16x32_bf16 v[172:175], a[224:227], a[204:207], v[172:175]
s_waitcnt lgkmcnt(2)
v_mfma_f32_16x16x32_bf16 v[176:179], a[228:231], a[192:195], v[176:179]
ds_read_b128 a[236:239], v15 offset:10240
v_mfma_f32_16x16x32_bf16 v[180:183], a[228:231], a[196:199], v[180:183]
v_perm_b32 v63, v80, v19, s52
v_mfma_f32_16x16x32_bf16 v[184:187], a[228:231], a[200:203], v[184:187]
ds_read_b32 a32, v63
v_perm_b32 v62, v80, v19, s53
v_mfma_f32_16x16x32_bf16 v[188:191], a[228:231], a[204:207], v[188:191]
s_waitcnt lgkmcnt(2)
ds_read_b32 a33, v62
v_mfma_f32_16x16x32_bf16 v[128:131], a[232:235], a[16:19], v[128:131]
ds_read_b128 a[240:243], v15 offset:12288
v_perm_b32 v61, v84, v19, s52
v_mfma_f32_16x16x32_bf16 v[132:135], a[232:235], a[20:23], v[132:135]
ds_read_b32 a34, v61
v_perm_b32 v60, v84, v19, s53
v_mfma_f32_16x16x32_bf16 v[136:139], a[232:235], a[24:27], v[136:139]
ds_read_b32 a35, v60
v_perm_b32 v59, v80, v19, s54
v_mfma_f32_16x16x32_bf16 v[140:143], a[232:235], a[28:31], v[140:143]
s_waitcnt lgkmcnt(4)
ds_read_b32 a36, v59
v_mfma_f32_16x16x32_bf16 v[144:147], a[236:239], a[16:19], v[144:147]
ds_read_b128 a[244:247], v15 offset:14336
v_perm_b32 v58, v80, v19, s55
v_mfma_f32_16x16x32_bf16 v[148:151], a[236:239], a[20:23], v[148:151]
ds_read_b32 a37, v58
v_perm_b32 v57, v84, v19, s54
v_mfma_f32_16x16x32_bf16 v[152:155], a[236:239], a[24:27], v[152:155]
ds_read_b32 a38, v57
v_perm_b32 v56, v84, v19, s55
v_mfma_f32_16x16x32_bf16 v[156:159], a[236:239], a[28:31], v[156:159]
s_waitcnt lgkmcnt(4)
ds_read_b32 a39, v56
v_mfma_f32_16x16x32_bf16 v[160:163], a[240:243], a[208:211], v[160:163]
s_barrier
ds_read_b128 a[248:251], v14 offset:16384
v_perm_b32 v63, v81, v19, s52
v_mfma_f32_16x16x32_bf16 v[164:167], a[240:243], a[212:215], v[164:167]
ds_read_b32 a40, v63
v_perm_b32 v62, v81, v19, s53
v_mfma_f32_16x16x32_bf16 v[168:171], a[240:243], a[216:219], v[168:171]
ds_read_b32 a41, v62
v_perm_b32 v61, v85, v19, s52
v_mfma_f32_16x16x32_bf16 v[172:175], a[240:243], a[220:223], v[172:175]
s_waitcnt lgkmcnt(4)
ds_read_b32 a42, v61
v_mfma_f32_16x16x32_bf16 v[176:179], a[244:247], a[208:211], v[176:179]
ds_read_b128 a[252:255], v14 offset:18432
v_perm_b32 v60, v85, v19, s53
v_mfma_f32_16x16x32_bf16 v[180:183], a[244:247], a[212:215], v[180:183]
ds_read_b32 a43, v60
v_perm_b32 v59, v81, v19, s54
v_mfma_f32_16x16x32_bf16 v[184:187], a[244:247], a[216:219], v[184:187]
ds_read_b32 a44, v59
v_perm_b32 v58, v81, v19, s55
v_mfma_f32_16x16x32_bf16 v[188:191], a[244:247], a[220:223], v[188:191]
s_waitcnt lgkmcnt(4)
ds_read_b32 a45, v58
v_mfma_f32_16x16x32_bf16 v[192:195], a[248:251], a[160:163], v[192:195]
ds_read_b128 a[224:227], v14 offset:20480
v_perm_b32 v57, v85, v19, s54
v_mfma_f32_16x16x32_bf16 v[196:199], a[248:251], a[164:167], v[196:199]
ds_read_b32 a46, v57
v_perm_b32 v56, v85, v19, s55
v_mfma_f32_16x16x32_bf16 v[200:203], a[248:251], a[168:171], v[200:203]
ds_read_b32 a47, v56
v_mfma_f32_16x16x32_bf16 v[204:207], a[248:251], a[172:175], v[204:207]
s_waitcnt lgkmcnt(4)
v_mfma_f32_16x16x32_bf16 v[208:211], a[252:255], a[160:163], v[208:211]
ds_read_b128 a[228:231], v14 offset:22528
v_mfma_f32_16x16x32_bf16 v[212:215], a[252:255], a[164:167], v[212:215]
v_mfma_f32_16x16x32_bf16 v[216:219], a[252:255], a[168:171], v[216:219]
v_mfma_f32_16x16x32_bf16 v[220:223], a[252:255], a[172:175], v[220:223]
s_waitcnt vmcnt(3) lgkmcnt(1)
v_cmp_ne_u64 s[50:51], s[88:89], v[90:91]
v_cmp_ne_u64 s[44:45], s[88:89], v[94:95]
v_mfma_f32_16x16x32_bf16 v[128:131], a[224:227], a[32:35], v[128:131]
ds_read_b128 a[232:235], v15 offset:4096
v_mfma_f32_16x16x32_bf16 v[132:135], a[224:227], a[36:39], v[132:135]
s_or_b64 s[50:51], s[44:45], s[50:51]
v_mfma_f32_16x16x32_bf16 v[136:139], a[224:227], a[40:43], v[136:139]
s_cbranch_scc1 L_SLOW31
L_BACK31:
v_mfma_f32_16x16x32_bf16 v[140:143], a[224:227], a[44:47], v[140:143]
s_waitcnt lgkmcnt(1)
v_mfma_f32_16x16x32_bf16 v[144:147], a[228:231], a[32:35], v[144:147]
ds_read_b128 a[236:239], v15 offset:6144
v_mfma_f32_16x16x32_bf16 v[148:151], a[228:231], a[36:39], v[148:151]
v_perm_b32 v63, v88, v19, s52
v_mfma_f32_16x16x32_bf16 v[152:155], a[228:231], a[40:43], v[152:155]
ds_read_b32 a48, v63
v_perm_b32 v62, v88, v19, s53
v_mfma_f32_16x16x32_bf16 v[156:159], a[228:231], a[44:47], v[156:159]
s_waitcnt lgkmcnt(2)
ds_read_b32 a49, v62
v_mfma_f32_16x16x32_bf16 v[224:227], a[232:235], a[112:115], v[224:227]
ds_read_b128 a[240:243], v14 offset:24576
v_perm_b32 v61, v92, v19, s52
v_mfma_f32_16x16x32_bf16 v[228:231], a[232:235], a[116:119], v[228:231]
ds_read_b32 a50, v61
v_perm_b32 v60, v92, v19, s53
v_mfma_f32_16x16x32_bf16 v[232:235], a[232:235], a[120:123], v[232:235]
ds_read_b32 a51, v60
v_perm_b32 v59, v88, v19, s54
v_mfma_f32_16x16x32_bf16 v[236:239], a[232:235], a[124:127], v[236:239]
s_waitcnt lgkmcnt(4)
ds_read_b32 a52, v59
v_mfma_f32_16x16x32_bf16 v[240:243], a[236:239], a[112:115], v[240:243]
ds_read_b128 a[244:247], v14 offset:26624
v_perm_b32 v58, v88, v19, s55
v_mfma_f32_16x16x32_bf16 v[244:247], a[236:239], a[116:119], v[244:247]
ds_read_b32 a53, v58
v_perm_b32 v57, v92, v19, s54
v_mfma_f32_16x16x32_bf16 v[248:251], a[236:239], a[120:123], v[248:251]
ds_read_b32 a54, v57
v_perm_b32 v56, v92, v19, s55
v_mfma_f32_16x16x32_bf16 v[252:255], a[236:239], a[124:127], v[252:255]
s_waitcnt lgkmcnt(4)
ds_read_b32 a55, v56
v_mfma_f32_16x16x32_bf16 v[160:163], a[240:243], a[0:3], v[160:163]
ds_read_b128 a[248:251], v15 offset:16384
v_perm_b32 v63, v89, v19, s52
v_mfma_f32_16x16x32_bf16 v[164:167], a[240:243], a[4:7], v[164:167]
ds_read_b32 a56, v63
v_perm_b32 v62, v89, v19, s53
v_mfma_f32_16x16x32_bf16 v[168:171], a[240:243], a[8:11], v[168:171]
ds_read_b32 a57, v62
v_perm_b32 v61, v93, v19, s52
v_mfma_f32_16x16x32_bf16 v[172:175], a[240:243], a[12:15], v[172:175]
s_waitcnt lgkmcnt(4)
ds_read_b32 a58, v61
v_mfma_f32_16x16x32_bf16 v[176:179], a[244:247], a[0:3], v[176:179]
ds_read_b128 a[252:255], v15 offset:18432
v_perm_b32 v60, v93, v19, s53
v_mfma_f32_16x16x32_bf16 v[180:183], a[244:247], a[4:7], v[180:183]
ds_read_b32 a59, v60
v_perm_b32 v59, v89, v19, s54
v_mfma_f32_16x16x32_bf16 v[184:187], a[244:247], a[8:11], v[184:187]
ds_read_b32 a60, v59
v_perm_b32 v58, v89, v19, s55
v_mfma_f32_16x16x32_bf16 v[188:191], a[244:247], a[12:15], v[188:191]
s_waitcnt lgkmcnt(4)
ds_read_b32 a61, v58
v_mfma_f32_16x16x32_bf16 v[192:195], a[248:251], a[176:179], v[192:195]
L_PAD5:
s_cbranch_vccnz L_PADRET
ds_read_b128 a[224:227], v15 offset:20480
v_perm_b32 v57, v93, v19, s54
v_mfma_f32_16x16x32_bf16 v[196:199], a[248:251], a[180:183], v[196:199]
ds_read_b32 a62, v57
v_perm_b32 v56, v93, v19, s55
v_mfma_f32_16x16x32_bf16 v[200:203], a[248:251], a[184:187], v[200:203]
ds_read_b32 a63, v56
v_mfma_f32_16x16x32_bf16 v[204:207], a[248:251], a[188:191], v[204:207]
s_waitcnt lgkmcnt(4)
v_mfma_f32_16x16x32_bf16 v[208:211], a[252:255], a[176:179], v[208:211]
ds_read_b128 a[228:231], v15 offset:22528
v_mfma_f32_16x16x32_bf16 v[212:215], a[252:255], a[180:183], v[212:215]
v_mfma_f32_16x16x32_bf16 v[216:219], a[252:255], a[184:187], v[216:219]
v_mfma_f32_16x16x32_bf16 v[220:223], a[252:255], a[188:191], v[220:223]
s_waitcnt lgkmcnt(1)
v_mfma_f32_16x16x32_bf16 v[128:131], a[224:227], a[48:51], v[128:131]
ds_read_b128 a[232:235], v15 offset:24576
v_mfma_f32_16x16x32_bf16 v[132:135], a[224:227], a[52:55], v[132:135]
v_mfma_f32_16x16x32_bf16 v[136:139], a[224:227], a[56:59], v[136:139]
v_mfma_f32_16x16x32_bf16 v[140:143], a[224:227], a[60:63], v[140:143]
s_waitcnt lgkmcnt(1)
v_mfma_f32_16x16x32_bf16 v[144:147], a[228:231], a[48:51], v[144:147]
ds_read_b128 a[236:239], v15 offset:26624
v_mfma_f32_16x16x32_bf16 v[148:151], a[228:231], a[52:55], v[148:151]
v_mfma_f32_16x16x32_bf16 v[152:155], a[228:231], a[56:59], v[152:155]
v_mfma_f32_16x16x32_bf16 v[156:159], a[228:231], a[60:63], v[156:159]
s_waitcnt lgkmcnt(1)
v_mfma_f32_16x16x32_bf16 v[160:163], a[232:235], a[16:19], v[160:163]
ds_read_b128 a[240:243], v14 offset:28672
v_mfma_f32_16x16x32_bf16 v[164:167], a[232:235], a[20:23], v[164:167]
v_mfma_f32_16x16x32_bf16 v[168:171], a[232:235], a[24:27], v[168:171]
v_mfma_f32_16x16x32_bf16 v[172:175], a[232:235], a[28:31], v[172:175]
s_waitcnt lgkmcnt(1)
v_mul_f32 v128, v128, v24
v_mul_f32 v132, v132, v25
v_mfma_f32_16x16x32_bf16 v[176:179], a[236:239], a[16:19], v[176:179]
s_waitcnt vmcnt(0)
s_barrier
ds_read_b128 a[244:247], v14 offset:30720
v_mul_f32 v136, v136, v26
v_mfma_f32_16x16x32_bf16 v[180:183], a[236:239], a[20:23], v[180:183]
v_mul_f32 v140, v140, v27
v_cvt_pk_bf16_f32 v120, v128, v132
v_mfma_f32_16x16x32_bf16 v[184:187], a[236:239], a[24:27], v[184:187]
v_cvt_pk_bf16_f32 v121, v136, v140
v_mfma_f32_16x16x32_bf16 v[188:191], a[236:239], a[28:31], v[188:191]
s_waitcnt lgkmcnt(1)
v_mfma_f32_16x16x32_bf16 v[192:195], a[240:243], a[192:195], v[192:195]
ds_read_b128 a[248:251], v14 offset:32768
v_mfma_f32_16x16x32_bf16 v[196:199], a[240:243], a[196:199], v[196:199]
buffer_store_dwordx2 v[120:121], v18, s[28:31], 0 offen nt
v_mul_f32 v129, v129, v24
v_mfma_f32_16x16x32_bf16 v[200:203], a[240:243], a[200:203], v[200:203]
s_add_u32 s28, s28, 7168
v_mul_f32 v133, v133, v25
v_mul_f32 v137, v137, v26
v_mfma_f32_16x16x32_bf16 v[204:207], a[240:243], a[204:207], v[204:207]
s_waitcnt lgkmcnt(1)
v_mul_f32 v141, v141, v27
v_cvt_pk_bf16_f32 v122, v129, v133
v_mfma_f32_16x16x32_bf16 v[208:211], a[244:247], a[192:195], v[208:211]
s_addc_u32 s29, s29, 0
ds_read_b128 a[252:255], v14 offset:34816
v_cvt_pk_bf16_f32 v123, v137, v141
v_mfma_f32_16x16x32_bf16 v[212:215], a[244:247], a[196:199], v[212:215]
buffer_store_dwordx2 v[122:123], v18, s[28:31], 0 offen nt
v_mul_f32 v130, v130, v24
v_mfma_f32_16x16x32_bf16 v[216:219], a[244:247], a[200:203], v[216:219]
s_add_u32 s28, s28, 7168
v_mul_f32 v134, v134, v25
v_mul_f32 v138, v138, v26
v_mfma_f32_16x16x32_bf16 v[220:223], a[244:247], a[204:207], v[220:223]
s_waitcnt lgkmcnt(1)
v_mul_f32 v142, v142, v27
v_cvt_pk_bf16_f32 v124, v130, v134
v_mfma_f32_16x16x32_bf16 v[224:227], a[248:251], a[128:131], v[224:227]
s_addc_u32 s29, s29, 0
ds_read_b128 a[224:227], v14 offset:36864
v_cvt_pk_bf16_f32 v125, v138, v142
v_mfma_f32_16x16x32_bf16 v[228:231], a[248:251], a[132:135], v[228:231]
buffer_store_dwordx2 v[124:125], v18, s[28:31], 0 offen nt
v_mul_f32 v131, v131, v24
v_mfma_f32_16x16x32_bf16 v[232:235], a[248:251], a[136:139], v[232:235]
s_add_u32 s28, s28, 7168
v_mul_f32 v135, v135, v25
v_mul_f32 v139, v139, v26
v_mfma_f32_16x16x32_bf16 v[236:239], a[248:251], a[140:143], v[236:239]
s_waitcnt lgkmcnt(1)
v_mul_f32 v143, v143, v27
v_cvt_pk_bf16_f32 v126, v131, v135
v_mfma_f32_16x16x32_bf16 v[240:243], a[252:255], a[128:131], v[240:243]
s_addc_u32 s29, s29, 0
ds_read_b128 a[228:231], v14 offset:38912
v_cvt_pk_bf16_f32 v127, v139, v143
v_mfma_f32_16x16x32_bf16 v[244:247], a[252:255], a[132:135], v[244:247]
buffer_store_dwordx2 v[126:127], v18, s[28:31], 0 offen nt
v_mul_f32 v144, v144, v24
v_mfma_f32_16x16x32_bf16 v[248:251], a[252:255], a[136:139], v[248:251]
s_add_u32 s28, s28, 93184
v_mul_f32 v148, v148, v25
v_mul_f32 v152, v152, v26
v_mfma_f32_16x16x32_bf16 v[252:255], a[252:255], a[140:143], v[252:255]
s_waitcnt lgkmcnt(1)
v_mul_f32 v156, v156, v27
v_cvt_pk_bf16_f32 v120, v144, v148
v_mfma_f32_16x16x32_bf16 v[160:163], a[224:227], a[32:35], v[160:163]
s_addc_u32 s29, s29, 0
ds_read_b128 a[232:235], v15 offset:28672
v_cvt_pk_bf16_f32 v121, v152, v156
v_mfma_f32_16x16x32_bf16 v[164:167], a[224:227], a[36:39], v[164:167]
buffer_store_dwordx2 v[120:121], v18, s[28:31], 0 offen nt
v_mul_f32 v145, v145, v24
v_mfma_f32_16x16x32_bf16 v[168:171], a[224:227], a[40:43], v[168:171]
s_add_u32 s28, s28, 7168
v_mul_f32 v149, v149, v25
v_mul_f32 v153, v153, v26
v_mfma_f32_16x16x32_bf16 v[172:175], a[224:227], a[44:47], v[172:175]
s_waitcnt lgkmcnt(1)
v_mul_f32 v157, v157, v27
v_cvt_pk_bf16_f32 v122, v145, v149
v_mfma_f32_16x16x32_bf16 v[176:179], a[228:231], a[32:35], v[176:179]
s_addc_u32 s29, s29, 0
ds_read_b128 a[236:239], v15 offset:30720
v_cvt_pk_bf16_f32 v123, v153, v157
v_mfma_f32_16x16x32_bf16 v[180:183], a[228:231], a[36:39], v[180:183]
buffer_store_dwordx2 v[122:123], v18, s[28:31], 0 offen nt
v_mul_f32 v146, v146, v24
v_mfma_f32_16x16x32_bf16 v[184:187], a[228:231], a[40:43], v[184:187]
s_add_u32 s28, s28, 7168
v_mul_f32 v150, v150, v25
v_mul_f32 v154, v154, v26
v_mfma_f32_16x16x32_bf16 v[188:191], a[228:231], a[44:47], v[188:191]
s_waitcnt lgkmcnt(1)
v_mul_f32 v158, v158, v27
v_cvt_pk_bf16_f32 v124, v146, v150
v_mfma_f32_16x16x32_bf16 v[192:195], a[232:235], a[208:211], v[192:195]
s_addc_u32 s29, s29, 0
ds_read_b128 a[240:243], v15 offset:36864
v_cvt_pk_bf16_f32 v125, v154, v158
v_mfma_f32_16x16x32_bf16 v[196:199], a[232:235], a[212:215], v[196:199]
buffer_store_dwordx2 v[124:125], v18, s[28:31], 0 offen nt
v_mul_f32 v147, v147, v24
v_mfma_f32_16x16x32_bf16 v[200:203], a[232:235], a[216:219], v[200:203]
s_add_u32 s28, s28, 7168
v_mul_f32 v151, v151, v25
v_mul_f32 v155, v155, v26
v_mfma_f32_16x16x32_bf16 v[204:207], a[232:235], a[220:223], v[204:207]
s_waitcnt lgkmcnt(1)
v_mul_f32 v159, v159, v27
v_cvt_pk_bf16_f32 v126, v147, v151
v_mfma_f32_16x16x32_bf16 v[208:211], a[236:239], a[208:211], v[208:211]
s_addc_u32 s29, s29, 0
ds_read_b128 a[244:247], v15 offset:38912
v_cvt_pk_bf16_f32 v127, v155, v159
v_mfma_f32_16x16x32_bf16 v[212:215], a[236:239], a[212:215], v[212:215]
buffer_store_dwordx2 v[126:127], v18, s[28:31], 0 offen nt
v_mfma_f32_16x16x32_bf16 v[216:219], a[236:239], a[216:219], v[216:219]
v_mfma_f32_16x16x32_bf16 v[220:223], a[236:239], a[220:223], v[220:223]
s_waitcnt lgkmcnt(1)
v_mfma_f32_16x16x32_bf16 v[160:163], a[240:243], a[48:51], v[160:163]
ds_read_b128 a[248:251], v15 offset:32768
v_mfma_f32_16x16x32_bf16 v[164:167], a[240:243], a[52:55], v[164:167]
v_mfma_f32_16x16x32_bf16 v[168:171], a[240:243], a[56:59], v[168:171]
v_mfma_f32_16x16x32_bf16 v[172:175], a[240:243], a[60:63], v[172:175]
s_waitcnt lgkmcnt(1)
v_mfma_f32_16x16x32_bf16 v[176:179], a[244:247], a[48:51], v[176:179]
ds_read_b128 a[252:255], v15 offset:34816
v_mfma_f32_16x16x32_bf16 v[180:183], a[244:247], a[52:55], v[180:183]
v_mfma_f32_16x16x32_bf16 v[184:187], a[244:247], a[56:59], v[184:187]
v_mfma_f32_16x16x32_bf16 v[188:191], a[244:247], a[60:63], v[188:191]
s_waitcnt lgkmcnt(1)
v_mfma_f32_16x16x32_bf16 v[224:227], a[248:251], a[144:147], v[224:227]
ds_read_b128 a[224:227], v14 offset:40960
v_mfma_f32_16x16x32_bf16 v[228:231], a[248:251], a[148:151], v[228:231]
v_mfma_f32_16x16x32_bf16 v[232:235], a[248:251], a[152:155], v[232:235]
v_mfma_f32_16x16x32_bf16 v[236:239], a[248:251], a[156:159], v[236:239]
s_waitcnt lgkmcnt(1)
v_mul_f32 v160, v160, v24
v_mul_f32 v164, v164, v25
v_mfma_f32_16x16x32_bf16 v[240:243], a[252:255], a[144:147], v[240:243]
s_add_u32 s28, s28, 93184
ds_read_b128 a[228:231], v14 offset:43008
v_mul_f32 v168, v168, v26
v_mfma_f32_16x16x32_bf16 v[244:247], a[252:255], a[148:151], v[244:247]
s_addc_u32 s29, s29, 0
v_mul_f32 v172, v172, v27
v_cvt_pk_bf16_f32 v120, v160, v164
v_mfma_f32_16x16x32_bf16 v[248:251], a[252:255], a[152:155], v[248:251]
v_cvt_pk_bf16_f32 v121, v168, v172
v_mfma_f32_16x16x32_bf16 v[252:255], a[252:255], a[156:159], v[252:255]
s_waitcnt lgkmcnt(1)
v_mfma_f32_16x16x32_bf16 v[192:195], a[224:227], a[0:3], v[192:195]
ds_read_b128 a[232:235], v15 offset:40960
v_mfma_f32_16x16x32_bf16 v[196:199], a[224:227], a[4:7], v[196:199]
buffer_store_dwordx2 v[120:121], v18, s[28:31], 0 offen nt
v_mul_f32 v161, v161, v24
v_mfma_f32_16x16x32_bf16 v[200:203], a[224:227], a[8:11], v[200:203]
s_add_u32 s28, s28, 7168
v_mul_f32 v165, v165, v25
v_mul_f32 v169, v169, v26
v_mfma_f32_16x16x32_bf16 v[204:207], a[224:227], a[12:15], v[204:207]
s_waitcnt lgkmcnt(1)
v_mul_f32 v173, v173, v27
v_cvt_pk_bf16_f32 v122, v161, v165
v_mfma_f32_16x16x32_bf16 v[208:211], a[228:231], a[0:3], v[208:211]
s_addc_u32 s29, s29, 0
ds_read_b128 a[236:239], v15 offset:43008
v_cvt_pk_bf16_f32 v123, v169, v173
v_mfma_f32_16x16x32_bf16 v[212:215], a[228:231], a[4:7], v[212:215]
buffer_store_dwordx2 v[122:123], v18, s[28:31], 0 offen nt
v_mul_f32 v162, v162, v24
v_mfma_f32_16x16x32_bf16 v[216:219], a[228:231], a[8:11], v[216:219]
s_add_u32 s28, s28, 7168
v_mul_f32 v166, v166, v25
v_mul_f32 v170, v170, v26
v_mfma_f32_16x16x32_bf16 v[220:223], a[228:231], a[12:15], v[220:223]
s_waitcnt lgkmcnt(1)
v_mul_f32 v174, v174, v27
v_cvt_pk_bf16_f32 v124, v162, v166
v_mfma_f32_16x16x32_bf16 v[192:195], a[232:235], a[16:19], v[192:195]
s_addc_u32 s29, s29, 0
ds_read_b128 a[240:243], v14 offset:45056
v_cvt_pk_bf16_f32 v125, v170, v174
v_mfma_f32_16x16x32_bf16 v[196:199], a[232:235], a[20:23], v[196:199]
buffer_store_dwordx2 v[124:125], v18, s[28:31], 0 offen nt
v_mul_f32 v163, v163, v24
v_mfma_f32_16x16x32_bf16 v[200:203], a[232:235], a[24:27], v[200:203]
s_add_u32 s28, s28, 7168
v_mul_f32 v167, v167, v25
v_mul_f32 v171, v171, v26
v_mfma_f32_16x16x32_bf16 v[204:207], a[232:235], a[28:31], v[204:207]
s_waitcnt lgkmcnt(1)
v_mul_f32 v175, v175, v27
v_cvt_pk_bf16_f32 v126, v163, v167
v_mfma_f32_16x16x32_bf16 v[208:211], a[236:239], a[16:19], v[208:211]
s_addc_u32 s29, s29, 0
ds_read_b128 a[244:247], v14 offset:47104
v_cvt_pk_bf16_f32 v127, v171, v175
v_mfma_f32_16x16x32_bf16 v[212:215], a[236:239], a[20:23], v[212:215]
buffer_store_dwordx2 v[126:127], v18, s[28:31], 0 offen nt
v_mul_f32 v176, v176, v24
v_mfma_f32_16x16x32_bf16 v[216:219], a[236:239], a[24:27], v[216:219]
s_add_u32 s28, s28, 93184
v_mul_f32 v180, v180, v25
v_mul_f32 v184, v184, v26
v_mfma_f32_16x16x32_bf16 v[220:223], a[236:239], a[28:31], v[220:223]
s_waitcnt lgkmcnt(1)
v_mul_f32 v188, v188, v27
v_cvt_pk_bf16_f32 v120, v176, v180
v_mfma_f32_16x16x32_bf16 v[224:227], a[240:243], a[160:163], v[224:227]
s_addc_u32 s29, s29, 0
ds_read_b128 a[248:251], v14 offset:49152
v_cvt_pk_bf16_f32 v121, v184, v188
v_mfma_f32_16x16x32_bf16 v[228:231], a[240:243], a[164:167], v[228:231]
buffer_store_dwordx2 v[120:121], v18, s[28:31], 0 offen nt
v_mul_f32 v177, v177, v24
v_mfma_f32_16x16x32_bf16 v[232:235], a[240:243], a[168:171], v[232:235]
s_add_u32 s28, s28, 7168
v_mul_f32 v181, v181, v25
v_mul_f32 v185, v185, v26
v_mfma_f32_16x16x32_bf16 v[236:239], a[240:243], a[172:175], v[236:239]
s_waitcnt lgkmcnt(1)
v_mul_f32 v189, v189, v27
v_cvt_pk_bf16_f32 v122, v177, v181
v_mfma_f32_16x16x32_bf16 v[240:243], a[244:247], a[160:163], v[240:243]
s_addc_u32 s29, s29, 0
ds_read_b128 a[252:255], v14 offset:51200
v_cvt_pk_bf16_f32 v123, v185, v189
v_mfma_f32_16x16x32_bf16 v[244:247], a[244:247], a[164:167], v[244:247]
buffer_store_dwordx2 v[122:123], v18, s[28:31], 0 offen nt
v_mul_f32 v178, v178, v24
v_mfma_f32_16x16x32_bf16 v[248:251], a[244:247], a[168:171], v[248:251]
s_add_u32 s28, s28, 7168
v_mul_f32 v182, v182, v25
v_mul_f32 v186, v186, v26
v_mfma_f32_16x16x32_bf16 v[252:255], a[244:247], a[172:175], v[252:255]
s_waitcnt lgkmcnt(1)
v_mul_f32 v190, v190, v27
v_cvt_pk_bf16_f32 v124, v178, v182
v_mfma_f32_16x16x32_bf16 v[192:195], a[248:251], a[32:35], v[192:195]
s_addc_u32 s29, s29, 0
ds_read_b128 a[224:227], v15 offset:45056
v_cvt_pk_bf16_f32 v125, v186, v190
v_mfma_f32_16x16x32_bf16 v[196:199], a[248:251], a[36:39], v[196:199]
buffer_store_dwordx2 v[124:125], v18, s[28:31], 0 offen nt
v_mul_f32 v179, v179, v24
v_mfma_f32_16x16x32_bf16 v[200:203], a[248:251], a[40:43], v[200:203]
s_add_u32 s28, s28, 7168
v_mul_f32 v183, v183, v25
v_mul_f32 v187, v187, v26
v_mfma_f32_16x16x32_bf16 v[204:207], a[248:251], a[44:47], v[204:207]
s_waitcnt lgkmcnt(1)
v_mul_f32 v191, v191, v27
v_cvt_pk_bf16_f32 v126, v179, v183
v_mfma_f32_16x16x32_bf16 v[208:211], a[252:255], a[32:35], v[208:211]
s_addc_u32 s29, s29, 0
ds_read_b128 a[228:231], v15 offset:47104
v_cvt_pk_bf16_f32 v127, v187, v191
v_mfma_f32_16x16x32_bf16 v[212:215], a[252:255], a[36:39], v[212:215]
buffer_store_dwordx2 v[126:127], v18, s[28:31], 0 offen nt
v_mfma_f32_16x16x32_bf16 v[216:219], a[252:255], a[40:43], v[216:219]
v_mfma_f32_16x16x32_bf16 v[220:223], a[252:255], a[44:47], v[220:223]
s_waitcnt lgkmcnt(1)
v_mfma_f32_16x16x32_bf16 v[224:227], a[224:227], a[176:179], v[224:227]
ds_read_b128 a[232:235], v15 offset:49152
v_mfma_f32_16x16x32_bf16 v[228:231], a[224:227], a[180:183], v[228:231]
v_mfma_f32_16x16x32_bf16 v[232:235], a[224:227], a[184:187], v[232:235]
v_mfma_f32_16x16x32_bf16 v[236:239], a[224:227], a[188:191], v[236:239]
s_waitcnt lgkmcnt(1)
v_mfma_f32_16x16x32_bf16 v[240:243], a[228:231], a[176:179], v[240:243]
ds_read_b128 a[236:239], v15 offset:51200
v_mfma_f32_16x16x32_bf16 v[244:247], a[228:231], a[180:183], v[244:247]
v_mfma_f32_16x16x32_bf16 v[248:251], a[228:231], a[184:187], v[248:251]
v_mfma_f32_16x16x32_bf16 v[252:255], a[228:231], a[188:191], v[252:255]
s_waitcnt lgkmcnt(1)
v_mfma_f32_16x16x32_bf16 v[192:195], a[232:235], a[48:51], v[192:195]
ds_read_b128 a[240:243], v14 offset:53248
v_mfma_f32_16x16x32_bf16 v[196:199], a[232:235], a[52:55], v[196:199]
v_mfma_f32_16x16x32_bf16 v[200:203], a[232:235], a[56:59], v[200:203]
v_mfma_f32_16x16x32_bf16 v[204:207], a[232:235], a[60:63], v[204:207]
s_waitcnt lgkmcnt(1)
v_mfma_f32_16x16x32_bf16 v[208:211], a[236:239], a[48:51], v[208:211]
ds_read_b128 a[244:247], v14 offset:55296
v_mfma_f32_16x16x32_bf16 v[212:215], a[236:239], a[52:55], v[212:215]
v_mfma_f32_16x16x32_bf16 v[216:219], a[236:239], a[56:59], v[216:219]
v_mfma_f32_16x16x32_bf16 v[220:223], a[236:239], a[60:63], v[220:223]
s_waitcnt lgkmcnt(1)
v_mfma_f32_16x16x32_bf16 v[224:227], a[240:243], a[192:195], v[224:227]
ds_read_b128 a[248:251], v15 offset:53248
v_mfma_f32_16x16x32_bf16 v[228:231], a[240:243], a[196:199], v[228:231]
v_mfma_f32_16x16x32_bf16 v[232:235], a[240:243], a[200:203], v[232:235]
v_mfma_f32_16x16x32_bf16 v[236:239], a[240:243], a[204:207], v[236:239]
s_waitcnt lgkmcnt(1)
v_mul_f32 v192, v192, v24
v_mul_f32 v196, v196, v25
v_mfma_f32_16x16x32_bf16 v[240:243], a[244:247], a[192:195], v[240:243]
s_add_u32 s28, s28, 93184
ds_read_b128 a[252:255], v15 offset:55296
v_mul_f32 v200, v200, v26
v_mfma_f32_16x16x32_bf16 v[244:247], a[244:247], a[196:199], v[244:247]
s_addc_u32 s29, s29, 0
v_mul_f32 v204, v204, v27
v_cvt_pk_bf16_f32 v120, v192, v196
v_mfma_f32_16x16x32_bf16 v[248:251], a[244:247], a[200:203], v[248:251]
v_cvt_pk_bf16_f32 v121, v200, v204
v_mfma_f32_16x16x32_bf16 v[252:255], a[244:247], a[204:207], v[252:255]
s_waitcnt lgkmcnt(1)
v_mfma_f32_16x16x32_bf16 v[224:227], a[248:251], a[208:211], v[224:227]
ds_read_b128 a[224:227], v14 offset:57344
v_mfma_f32_16x16x32_bf16 v[228:231], a[248:251], a[212:215], v[228:231]
buffer_store_dwordx2 v[120:121], v18, s[28:31], 0 offen nt
v_mul_f32 v193, v193, v24
v_mfma_f32_16x16x32_bf16 v[232:235], a[248:251], a[216:219], v[232:235]
s_add_u32 s28, s28, 7168
v_mul_f32 v197, v197, v25
v_mul_f32 v201, v201, v26
v_mfma_f32_16x16x32_bf16 v[236:239], a[248:251], a[220:223], v[236:239]
s_waitcnt lgkmcnt(1)
v_mul_f32 v205, v205, v27
v_cvt_pk_bf16_f32 v122, v193, v197
v_mfma_f32_16x16x32_bf16 v[240:243], a[252:255], a[208:211], v[240:243]
s_addc_u32 s29, s29, 0
ds_read_b128 a[228:231], v14 offset:59392
v_cvt_pk_bf16_f32 v123, v201, v205
v_mfma_f32_16x16x32_bf16 v[244:247], a[252:255], a[212:215], v[244:247]
buffer_store_dwordx2 v[122:123], v18, s[28:31], 0 offen nt
v_mul_f32 v194, v194, v24
v_mfma_f32_16x16x32_bf16 v[248:251], a[252:255], a[216:219], v[248:251]
s_add_u32 s28, s28, 7168
v_mul_f32 v198, v198, v25
v_mul_f32 v202, v202, v26
v_mfma_f32_16x16x32_bf16 v[252:255], a[252:255], a[220:223], v[252:255]
s_waitcnt lgkmcnt(1)
v_mul_f32 v206, v206, v27
v_cvt_pk_bf16_f32 v124, v194, v198
v_mfma_f32_16x16x32_bf16 v[224:227], a[224:227], a[0:3], v[224:227]
s_addc_u32 s29, s29, 0
ds_read_b128 a[232:235], v15 offset:57344
v_cvt_pk_bf16_f32 v125, v202, v206
v_mfma_f32_16x16x32_bf16 v[228:231], a[224:227], a[4:7], v[228:231]
buffer_store_dwordx2 v[124:125], v18, s[28:31], 0 offen nt
v_mul_f32 v195, v195, v24
v_mfma_f32_16x16x32_bf16 v[232:235], a[224:227], a[8:11], v[232:235]
s_add_u32 s28, s28, 7168
v_mul_f32 v199, v199, v25
v_mul_f32 v203, v203, v26
v_mfma_f32_16x16x32_bf16 v[236:239], a[224:227], a[12:15], v[236:239]
s_waitcnt lgkmcnt(1)
v_mul_f32 v207, v207, v27
v_cvt_pk_bf16_f32 v126, v195, v199
v_mfma_f32_16x16x32_bf16 v[240:243], a[228:231], a[0:3], v[240:243]
s_addc_u32 s29, s29, 0
ds_read_b128 a[236:239], v15 offset:59392
v_cvt_pk_bf16_f32 v127, v203, v207
v_mfma_f32_16x16x32_bf16 v[244:247], a[228:231], a[4:7], v[244:247]
buffer_store_dwordx2 v[126:127], v18, s[28:31], 0 offen nt
v_mul_f32 v208, v208, v24
v_mfma_f32_16x16x32_bf16 v[248:251], a[228:231], a[8:11], v[248:251]
s_add_u32 s28, s28, 93184
v_mul_f32 v212, v212, v25
v_mul_f32 v216, v216, v26
v_mfma_f32_16x16x32_bf16 v[252:255], a[228:231], a[12:15], v[252:255]
s_waitcnt lgkmcnt(1)
v_mul_f32 v220, v220, v27
v_cvt_pk_bf16_f32 v120, v208, v212
v_mfma_f32_16x16x32_bf16 v[224:227], a[232:235], a[16:19], v[224:227]
s_addc_u32 s29, s29, 0
ds_read_b128 a[240:243], v14 offset:61440
v_cvt_pk_bf16_f32 v121, v216, v220
v_mfma_f32_16x16x32_bf16 v[228:231], a[232:235], a[20:23], v[228:231]
buffer_store_dwordx2 v[120:121], v18, s[28:31], 0 offen nt
v_mul_f32 v209, v209, v24
v_mfma_f32_16x16x32_bf16 v[232:235], a[232:235], a[24:27], v[232:235]
s_add_u32 s28, s28, 7168
v_mul_f32 v213, v213, v25
v_mul_f32 v217, v217, v26
v_mfma_f32_16x16x32_bf16 v[236:239], a[232:235], a[28:31], v[236:239]
s_waitcnt lgkmcnt(1)
v_mul_f32 v221, v221, v27
v_cvt_pk_bf16_f32 v122, v209, v213
v_mfma_f32_16x16x32_bf16 v[240:243], a[236:239], a[16:19], v[240:243]
s_addc_u32 s29, s29, 0
ds_read_b128 a[244:247], v14 offset:63488
v_cvt_pk_bf16_f32 v123, v217, v221
v_mfma_f32_16x16x32_bf16 v[244:247], a[236:239], a[20:23], v[244:247]
buffer_store_dwordx2 v[122:123], v18, s[28:31], 0 offen nt
v_mul_f32 v210, v210, v24
v_mfma_f32_16x16x32_bf16 v[248:251], a[236:239], a[24:27], v[248:251]
s_add_u32 s28, s28, 7168
v_mul_f32 v214, v214, v25
v_mul_f32 v218, v218, v26
v_mfma_f32_16x16x32_bf16 v[252:255], a[236:239], a[28:31], v[252:255]
s_waitcnt lgkmcnt(1)
v_mul_f32 v222, v222, v27
v_cvt_pk_bf16_f32 v124, v210, v214
v_mfma_f32_16x16x32_bf16 v[224:227], a[240:243], a[32:35], v[224:227]
s_addc_u32 s29, s29, 0
ds_read_b128 a[248:251], v15 offset:61440
v_cvt_pk_bf16_f32 v125, v218, v222
v_mfma_f32_16x16x32_bf16 v[228:231], a[240:243], a[36:39], v[228:231]
buffer_store_dwordx2 v[124:125], v18, s[28:31], 0 offen nt
v_mul_f32 v211, v211, v24
v_mfma_f32_16x16x32_bf16 v[232:235], a[240:243], a[40:43], v[232:235]
s_add_u32 s28, s28, 7168
v_mul_f32 v215, v215, v25
v_mul_f32 v219, v219, v26
v_mfma_f32_16x16x32_bf16 v[236:239], a[240:243], a[44:47], v[236:239]
s_waitcnt lgkmcnt(1)
v_mul_f32 v223, v223, v27
v_cvt_pk_bf16_f32 v126, v211, v215
v_mfma_f32_16x16x32_bf16 v[240:243], a[244:247], a[32:35], v[240:243]
s_addc_u32 s29, s29, 0
ds_read_b128 a[252:255], v15 offset:63488
v_cvt_pk_bf16_f32 v127, v219, v223
v_mfma_f32_16x16x32_bf16 v[244:247], a[244:247], a[36:39], v[244:247]
buffer_store_dwordx2 v[126:127], v18, s[28:31], 0 offen nt
v_mfma_f32_16x16x32_bf16 v[248:251], a[244:247], a[40:43], v[248:251]
v_mfma_f32_16x16x32_bf16 v[252:255], a[244:247], a[44:47], v[252:255]
s_waitcnt lgkmcnt(1)
v_mfma_f32_16x16x32_bf16 v[224:227], a[248:251], a[48:51], v[224:227]
v_mfma_f32_16x16x32_bf16 v[228:231], a[248:251], a[52:55], v[228:231]
v_mfma_f32_16x16x32_bf16 v[232:235], a[248:251], a[56:59], v[232:235]
v_mfma_f32_16x16x32_bf16 v[236:239], a[248:251], a[60:63], v[236:239]
s_waitcnt lgkmcnt(0)
v_mfma_f32_16x16x32_bf16 v[240:243], a[252:255], a[48:51], v[240:243]
v_mfma_f32_16x16x32_bf16 v[244:247], a[252:255], a[52:55], v[244:247]
v_mfma_f32_16x16x32_bf16 v[248:251], a[252:255], a[56:59], v[248:251]
v_mfma_f32_16x16x32_bf16 v[252:255], a[252:255], a[60:63], v[252:255]
s_nop 7
v_pk_mul_f32 v[224:225], v[224:225], v[24:25] op_sel:[0,0] op_sel_hi:[1,0]
v_pk_mul_f32 v[228:229], v[228:229], v[24:25] op_sel:[0,1] op_sel_hi:[1,1]
v_pk_mul_f32 v[232:233], v[232:233], v[26:27] op_sel:[0,0] op_sel_hi:[1,0]
v_pk_mul_f32 v[236:237], v[236:237], v[26:27] op_sel:[0,1] op_sel_hi:[1,1]
v_cvt_pk_bf16_f32 v120, v224, v228
v_cvt_pk_bf16_f32 v121, v232, v236
s_add_u32 s28, s28, 93184
s_addc_u32 s29, s29, 0
buffer_store_dwordx2 v[120:121], v18, s[28:31], 0 offen nt
v_cvt_pk_bf16_f32 v122, v225, v229
v_cvt_pk_bf16_f32 v123, v233, v237
s_add_u32 s28, s28, 7168
s_addc_u32 s29, s29, 0
buffer_store_dwordx2 v[122:123], v18, s[28:31], 0 offen nt
v_pk_mul_f32 v[226:227], v[226:227], v[24:25] op_sel:[0,0] op_sel_hi:[1,0]
v_pk_mul_f32 v[230:231], v[230:231], v[24:25] op_sel:[0,1] op_sel_hi:[1,1]
v_pk_mul_f32 v[234:235], v[234:235], v[26:27] op_sel:[0,0] op_sel_hi:[1,0]
v_pk_mul_f32 v[238:239], v[238:239], v[26:27] op_sel:[0,1] op_sel_hi:[1,1]
v_cvt_pk_bf16_f32 v124, v226, v230
v_cvt_pk_bf16_f32 v125, v234, v238
s_add_u32 s28, s28, 7168
s_addc_u32 s29, s29, 0
buffer_store_dwordx2 v[124:125], v18, s[28:31], 0 offen nt
v_cvt_pk_bf16_f32 v126, v227, v231
v_cvt_pk_bf16_f32 v127, v235, v239
s_add_u32 s28, s28, 7168
s_addc_u32 s29, s29, 0
buffer_store_dwordx2 v[126:127], v18, s[28:31], 0 offen nt
v_pk_mul_f32 v[240:241], v[240:241], v[24:25] op_sel:[0,0] op_sel_hi:[1,0]
v_pk_mul_f32 v[244:245], v[244:245], v[24:25] op_sel:[0,1] op_sel_hi:[1,1]
v_pk_mul_f32 v[248:249], v[248:249], v[26:27] op_sel:[0,0] op_sel_hi:[1,0]
v_pk_mul_f32 v[252:253], v[252:253], v[26:27] op_sel:[0,1] op_sel_hi:[1,1]
v_cvt_pk_bf16_f32 v120, v240, v244
v_cvt_pk_bf16_f32 v121, v248, v252
s_add_u32 s28, s28, 93184
s_addc_u32 s29, s29, 0
buffer_store_dwordx2 v[120:121], v18, s[28:31], 0 offen nt
v_cvt_pk_bf16_f32 v122, v241, v245
v_cvt_pk_bf16_f32 v123, v249, v253
s_add_u32 s28, s28, 7168
s_addc_u32 s29, s29, 0
buffer_store_dwordx2 v[122:123], v18, s[28:31], 0 offen nt
v_pk_mul_f32 v[242:243], v[242:243], v[24:25] op_sel:[0,0] op_sel_hi:[1,0]
v_pk_mul_f32 v[246:247], v[246:247], v[24:25] op_sel:[0,1] op_sel_hi:[1,1]
v_pk_mul_f32 v[250:251], v[250:251], v[26:27] op_sel:[0,0] op_sel_hi:[1,0]
v_pk_mul_f32 v[254:255], v[254:255], v[26:27] op_sel:[0,1] op_sel_hi:[1,1]
v_cvt_pk_bf16_f32 v124, v242, v246
v_cvt_pk_bf16_f32 v125, v250, v254
s_add_u32 s28, s28, 7168
s_addc_u32 s29, s29, 0
buffer_store_dwordx2 v[124:125], v18, s[28:31], 0 offen nt
v_cvt_pk_bf16_f32 v126, v243, v247
v_cvt_pk_bf16_f32 v127, v251, v255
s_add_u32 s28, s28, 7168
s_addc_u32 s29, s29, 0
buffer_store_dwordx2 v[126:127], v18, s[28:31], 0 offen nt
s_endpgm
L_NOTAG:
buffer_load_dwordx2 v[22:23], off, s[80:83], 0 sc1
s_waitcnt vmcnt(0)
v_readfirstlane_b32 s88, v22
v_readfirstlane_b32 s89, v23
s_sub_u32 s90, s90, 1
s_nop 0
s_cmp_eq_u64 s[88:89], 0
s_cbranch_scc0 L_TAGOK
s_cmp_gt_i32 s90, 0
s_cbranch_scc1 L_NOTAG
s_mov_b32 s26, 0
s_mov_b32 s78, 0
s_mov_b64 s[88:89], 1
s_branch L_TAGOK
L_SLOW2:
s_lshr_b32 s47, s41, 6
s_add_u32 s47, s47, 1
s_lshl_b32 s47, s47, 11
buffer_load_dwordx4 v[40:43], v13, s[24:27], s47 offen offset:0 sc1
buffer_load_dwordx4 v[44:47], v13, s[24:27], s47 offen offset:1024 sc1
s_lshr_b32 s47, s42, 6
s_add_u32 s47, s47, 0
s_lshl_b32 s47, s47, 11
buffer_load_dwordx4 v[48:51], v13, s[24:27], s47 offen offset:0 sc1
buffer_load_dwordx4 v[52:55], v13, s[24:27], s47 offen offset:1024 sc1
s_lshr_b32 s91, s41, 6
s_add_u32 s91, s91, 0
s_call_b64 s[100:101], L_WAIT
v_mov_b64 v[32:33], v[120:121]
v_mov_b64 v[36:37], v[124:125]
s_branch L_BACK2
L_SLOW3:
s_lshr_b32 s47, s42, 6
s_add_u32 s47, s47, 0
s_lshl_b32 s47, s47, 11
buffer_load_dwordx4 v[48:51], v13, s[24:27], s47 offen offset:0 sc1
buffer_load_dwordx4 v[52:55], v13, s[24:27], s47 offen offset:1024 sc1
s_lshr_b32 s91, s41, 6
s_add_u32 s91, s91, 1
s_call_b64 s[100:101], L_WAIT
v_mov_b64 v[40:41], v[120:121]
v_mov_b64 v[44:45], v[124:125]
s_branch L_BACK3
L_SLOW4:
s_lshr_b32 s47, s42, 6
s_add_u32 s47, s47, 1
s_lshl_b32 s47, s47, 11
buffer_load_dwordx4 v[96:99], v13, s[24:27], s47 offen offset:0 sc1
buffer_load_dwordx4 v[100:103], v13, s[24:27], s47 offen offset:1024 sc1
s_lshr_b32 s47, s43, 6
s_add_u32 s47, s47, 0
s_lshl_b32 s47, s47, 11
buffer_load_dwordx4 v[80:83], v13, s[24:27], s47 offen offset:0 sc1
buffer_load_dwordx4 v[84:87], v13, s[24:27], s47 offen offset:1024 sc1
s_lshr_b32 s91, s42, 6
s_add_u32 s91, s91, 0
s_call_b64 s[100:101], L_WAIT
v_mov_b64 v[48:49], v[120:121]
v_mov_b64 v[52:53], v[124:125]
s_branch L_BACK4
L_SLOW5:
s_lshr_b32 s47, s43, 6
s_add_u32 s47, s47, 0
s_lshl_b32 s47, s47, 11
buffer_load_dwordx4 v[80:83], v13, s[24:27], s47 offen offset:0 sc1
buffer_load_dwordx4 v[84:87], v13, s[24:27], s47 offen offset:1024 sc1
s_lshr_b32 s47, s43, 6
s_add_u32 s47, s47, 1
s_lshl_b32 s47, s47, 11
buffer_load_dwordx4 v[88:91], v13, s[24:27], s47 offen offset:0 sc1
buffer_load_dwordx4 v[92:95], v13, s[24:27], s47 offen offset:1024 sc1
s_lshr_b32 s91, s42, 6
s_add_u32 s91, s91, 1
s_call_b64 s[100:101], L_WAIT
v_mov_b64 v[96:97], v[120:121]
v_mov_b64 v[100:101], v[124:125]
s_branch L_BACK5
L_SLOW6:
s_lshr_b32 s47, s43, 6
s_add_u32 s47, s47, 1
s_lshl_b32 s47, s47, 11
buffer_load_dwordx4 v[88:91], v13, s[24:27], s47 offen offset:0 sc1
buffer_load_dwordx4 v[92:95], v13, s[24:27], s47 offen offset:1024 sc1
s_movk_i32 s47, 8
s_lshl_b32 s47, s47, 11
buffer_load_dwordx4 v[32:35], v13, s[24:27], s47 offen offset:0 sc1
buffer_load_dwordx4 v[36:39], v13, s[24:27], s47 offen offset:1024 sc1
s_lshr_b32 s91, s43, 6
s_add_u32 s91, s91, 0
s_call_b64 s[100:101], L_WAIT
v_mov_b64 v[80:81], v[120:121]
v_mov_b64 v[84:85], v[124:125]
s_branch L_BACK6
L_SLOW7:
s_movk_i32 s47, 8
s_lshl_b32 s47, s47, 11
buffer_load_dwordx4 v[32:35], v13, s[24:27], s47 offen offset:0 sc1
buffer_load_dwordx4 v[36:39], v13, s[24:27], s47 offen offset:1024 sc1
s_movk_i32 s47, 9
s_lshl_b32 s47, s47, 11
buffer_load_dwordx4 v[40:43], v13, s[24:27], s47 offen offset:0 sc1
buffer_load_dwordx4 v[44:47], v13, s[24:27], s47 offen offset:1024 sc1
s_lshr_b32 s91, s43, 6
s_add_u32 s91, s91, 1
s_call_b64 s[100:101], L_WAIT
v_mov_b64 v[88:89], v[120:121]
v_mov_b64 v[92:93], v[124:125]
s_branch L_BACK7
L_SLOW8:
s_movk_i32 s47, 9
s_lshl_b32 s47, s47, 11
buffer_load_dwordx4 v[40:43], v13, s[24:27], s47 offen offset:0 sc1
buffer_load_dwordx4 v[44:47], v13, s[24:27], s47 offen offset:1024 sc1
s_movk_i32 s47, 10
s_lshl_b32 s47, s47, 11
buffer_load_dwordx4 v[48:51], v13, s[24:27], s47 offen offset:0 sc1
buffer_load_dwordx4 v[52:55], v13, s[24:27], s47 offen offset:1024 sc1
s_movk_i32 s91, 8
s_call_b64 s[100:101], L_WAIT
v_mov_b64 v[32:33], v[120:121]
v_mov_b64 v[36:37], v[124:125]
s_branch L_BACK8
L_SLOW9:
s_movk_i32 s47, 10
s_lshl_b32 s47, s47, 11
buffer_load_dwordx4 v[48:51], v13, s[24:27], s47 offen offset:0 sc1
buffer_load_dwordx4 v[52:55], v13, s[24:27], s47 offen offset:1024 sc1
s_movk_i32 s47, 11
s_lshl_b32 s47, s47, 11
buffer_load_dwordx4 v[96:99], v13, s[24:27], s47 offen offset:0 sc1
buffer_load_dwordx4 v[100:103], v13, s[24:27], s47 offen offset:1024 sc1
s_movk_i32 s91, 9
s_call_b64 s[100:101], L_WAIT
v_mov_b64 v[40:41], v[120:121]
v_mov_b64 v[44:45], v[124:125]
s_branch L_BACK9
L_SLOW10:
s_movk_i32 s47, 11
s_lshl_b32 s47, s47, 11
buffer_load_dwordx4 v[96:99], v13, s[24:27], s47 offen offset:0 sc1
buffer_load_dwordx4 v[100:103], v13, s[24:27], s47 offen offset:1024 sc1
s_movk_i32 s47, 12
s_lshl_b32 s47, s47, 11
buffer_load_dwordx4 v[80:83], v13, s[24:27], s47 offen offset:0 sc1
buffer_load_dwordx4 v[84:87], v13, s[24:27], s47 offen offset:1024 sc1
s_movk_i32 s91, 10
s_call_b64 s[100:101], L_WAIT
v_mov_b64 v[48:49], v[120:121]
v_mov_b64 v[52:53], v[124:125]
s_branch L_BACK10
L_SLOW11:
s_movk_i32 s47, 12
s_lshl_b32 s47, s47, 11
buffer_load_dwordx4 v[80:83], v13, s[24:27], s47 offen offset:0 sc1
buffer_load_dwordx4 v[84:87], v13, s[24:27], s47 offen offset:1024 sc1
s_movk_i32 s47, 13
s_lshl_b32 s47, s47, 11
buffer_load_dwordx4 v[88:91], v13, s[24:27], s47 offen offset:0 sc1
buffer_load_dwordx4 v[92:95], v13, s[24:27], s47 offen offset:1024 sc1
s_movk_i32 s91, 11
s_call_b64 s[100:101], L_WAIT
v_mov_b64 v[96:97], v[120:121]
v_mov_b64 v[100:101], v[124:125]
s_branch L_BACK11
L_SLOW12:
s_movk_i32 s47, 13
s_lshl_b32 s47, s47, 11
buffer_load_dwordx4 v[88:91], v13, s[24:27], s47 offen offset:0 sc1
buffer_load_dwordx4 v[92:95], v13, s[24:27], s47 offen offset:1024 sc1
s_movk_i32 s47, 14
s_lshl_b32 s47, s47, 11
buffer_load_dwordx4 v[32:35], v13, s[24:27], s47 offen offset:0 sc1
buffer_load_dwordx4 v[36:39], v13, s[24:27], s47 offen offset:1024 sc1
s_movk_i32 s91, 12
s_call_b64 s[100:101], L_WAIT
v_mov_b64 v[80:81], v[120:121]
v_mov_b64 v[84:85], v[124:125]
s_branch L_BACK12
L_SLOW13:
s_movk_i32 s47, 14
s_lshl_b32 s47, s47, 11
buffer_load_dwordx4 v[32:35], v13, s[24:27], s47 offen offset:0 sc1
buffer_load_dwordx4 v[36:39], v13, s[24:27], s47 offen offset:1024 sc1
s_movk_i32 s47, 15
s_lshl_b32 s47, s47, 11
buffer_load_dwordx4 v[40:43], v13, s[24:27], s47 offen offset:0 sc1
buffer_load_dwordx4 v[44:47], v13, s[24:27], s47 offen offset:1024 sc1
s_movk_i32 s91, 13
s_call_b64 s[100:101], L_WAIT
v_mov_b64 v[88:89], v[120:121]
v_mov_b64 v[92:93], v[124:125]
s_branch L_BACK13
L_SLOW14:
s_movk_i32 s47, 15
s_lshl_b32 s47, s47, 11
buffer_load_dwordx4 v[40:43], v13, s[24:27], s47 offen offset:0 sc1
buffer_load_dwordx4 v[44:47], v13, s[24:27], s47 offen offset:1024 sc1
s_movk_i32 s47, 16
s_lshl_b32 s47, s47, 11
buffer_load_dwordx4 v[48:51], v13, s[24:27], s47 offen offset:0 sc1
buffer_load_dwordx4 v[52:55], v13, s[24:27], s47 offen offset:1024 sc1
s_movk_i32 s91, 14
s_call_b64 s[100:101], L_WAIT
v_mov_b64 v[32:33], v[120:121]
v_mov_b64 v[36:37], v[124:125]
s_branch L_BACK14
L_SLOW15:
s_movk_i32 s47, 16
s_lshl_b32 s47, s47, 11
buffer_load_dwordx4 v[48:51], v13, s[24:27], s47 offen offset:0 sc1
buffer_load_dwordx4 v[52:55], v13, s[24:27], s47 offen offset:1024 sc1
s_movk_i32 s47, 17
s_lshl_b32 s47, s47, 11
buffer_load_dwordx4 v[96:99], v13, s[24:27], s47 offen offset:0 sc1
buffer_load_dwordx4 v[100:103], v13, s[24:27], s47 offen offset:1024 sc1
s_movk_i32 s91, 15
s_call_b64 s[100:101], L_WAIT
v_mov_b64 v[40:41], v[120:121]
v_mov_b64 v[44:45], v[124:125]
s_branch L_BACK15
L_SLOW16:
s_movk_i32 s47, 17
s_lshl_b32 s47, s47, 11
buffer_load_dwordx4 v[96:99], v13, s[24:27], s47 offen offset:0 sc1
buffer_load_dwordx4 v[100:103], v13, s[24:27], s47 offen offset:1024 sc1
s_movk_i32 s47, 18
s_lshl_b32 s47, s47, 11
buffer_load_dwordx4 v[80:83], v13, s[24:27], s47 offen offset:0 sc1
buffer_load_dwordx4 v[84:87], v13, s[24:27], s47 offen offset:1024 sc1
s_movk_i32 s91, 16
s_call_b64 s[100:101], L_WAIT
v_mov_b64 v[48:49], v[120:121]
v_mov_b64 v[52:53], v[124:125]
s_branch L_BACK16
L_SLOW17:
s_movk_i32 s47, 18
s_lshl_b32 s47, s47, 11
buffer_load_dwordx4 v[80:83], v13, s[24:27], s47 offen offset:0 sc1
buffer_load_dwordx4 v[84:87], v13, s[24:27], s47 offen offset:1024 sc1
s_movk_i32 s47, 19
s_lshl_b32 s47, s47, 11
buffer_load_dwordx4 v[88:91], v13, s[24:27], s47 offen offset:0 sc1
buffer_load_dwordx4 v[92:95], v13, s[24:27], s47 offen offset:1024 sc1
s_movk_i32 s91, 17
s_call_b64 s[100:101], L_WAIT
v_mov_b64 v[96:97], v[120:121]
v_mov_b64 v[100:101], v[124:125]
s_branch L_BACK17
L_SLOW18:
s_movk_i32 s47, 19
s_lshl_b32 s47, s47, 11
buffer_load_dwordx4 v[88:91], v13, s[24:27], s47 offen offset:0 sc1
buffer_load_dwordx4 v[92:95], v13, s[24:27], s47 offen offset:1024 sc1
s_movk_i32 s47, 20
s_lshl_b32 s47, s47, 11
buffer_load_dwordx4 v[32:35], v13, s[24:27], s47 offen offset:0 sc1
buffer_load_dwordx4 v[36:39], v13, s[24:27], s47 offen offset:1024 sc1
s_movk_i32 s91, 18
s_call_b64 s[100:101], L_WAIT
v_mov_b64 v[80:81], v[120:121]
v_mov_b64 v[84:85], v[124:125]
s_branch L_BACK18
L_SLOW19:
s_movk_i32 s47, 20
s_lshl_b32 s47, s47, 11
buffer_load_dwordx4 v[32:35], v13, s[24:27], s47 offen offset:0 sc1
buffer_load_dwordx4 v[36:39], v13, s[24:27], s47 offen offset:1024 sc1
s_movk_i32 s47, 21
s_lshl_b32 s47, s47, 11
buffer_load_dwordx4 v[40:43], v13, s[24:27], s47 offen offset:0 sc1
buffer_load_dwordx4 v[44:47], v13, s[24:27], s47 offen offset:1024 sc1
s_movk_i32 s91, 19
s_call_b64 s[100:101], L_WAIT
v_mov_b64 v[88:89], v[120:121]
v_mov_b64 v[92:93], v[124:125]
s_branch L_BACK19
L_SLOW20:
s_movk_i32 s47, 21
s_lshl_b32 s47, s47, 11
buffer_load_dwordx4 v[40:43], v13, s[24:27], s47 offen offset:0 sc1
buffer_load_dwordx4 v[44:47], v13, s[24:27], s47 offen offset:1024 sc1
s_movk_i32 s47, 22
s_lshl_b32 s47, s47, 11
buffer_load_dwordx4 v[48:51], v13, s[24:27], s47 offen offset:0 sc1
buffer_load_dwordx4 v[52:55], v13, s[24:27], s47 offen offset:1024 sc1
s_movk_i32 s91, 20
s_call_b64 s[100:101], L_WAIT
v_mov_b64 v[32:33], v[120:121]
v_mov_b64 v[36:37], v[124:125]
s_branch L_BACK20
L_SLOW21:
s_movk_i32 s47, 22
s_lshl_b32 s47, s47, 11
buffer_load_dwordx4 v[48:51], v13, s[24:27], s47 offen offset:0 sc1
buffer_load_dwordx4 v[52:55], v13, s[24:27], s47 offen offset:1024 sc1
s_movk_i32 s47, 23
s_lshl_b32 s47, s47, 11
buffer_load_dwordx4 v[96:99], v13, s[24:27], s47 offen offset:0 sc1
buffer_load_dwordx4 v[100:103], v13, s[24:27], s47 offen offset:1024 sc1
s_movk_i32 s91, 21
s_call_b64 s[100:101], L_WAIT
v_mov_b64 v[40:41], v[120:121]
v_mov_b64 v[44:45], v[124:125]
s_branch L_BACK21
L_SLOW22:
s_movk_i32 s47, 23
s_lshl_b32 s47, s47, 11
buffer_load_dwordx4 v[96:99], v13, s[24:27], s47 offen offset:0 sc1
buffer_load_dwordx4 v[100:103], v13, s[24:27], s47 offen offset:1024 sc1
s_movk_i32 s47, 24
s_lshl_b32 s47, s47, 11
buffer_load_dwordx4 v[80:83], v13, s[24:27], s47 offen offset:0 sc1
buffer_load_dwordx4 v[84:87], v13, s[24:27], s47 offen offset:1024 sc1
s_movk_i32 s91, 22
s_call_b64 s[100:101], L_WAIT
v_mov_b64 v[48:49], v[120:121]
v_mov_b64 v[52:53], v[124:125]
s_branch L_BACK22
L_SLOW23:
s_movk_i32 s47, 24
s_lshl_b32 s47, s47, 11
buffer_load_dwordx4 v[80:83], v13, s[24:27], s47 offen offset:0 sc1
buffer_load_dwordx4 v[84:87], v13, s[24:27], s47 offen offset:1024 sc1
s_movk_i32 s47, 25
s_lshl_b32 s47, s47, 11
buffer_load_dwordx4 v[88:91], v13, s[24:27], s47 offen offset:0 sc1
buffer_load_dwordx4 v[92:95], v13, s[24:27], s47 offen offset:1024 sc1
s_movk_i32 s91, 23
s_call_b64 s[100:101], L_WAIT
v_mov_b64 v[96:97], v[120:121]
v_mov_b64 v[100:101], v[124:125]
s_branch L_BACK23
L_SLOW24:
s_movk_i32 s47, 25
s_lshl_b32 s47, s47, 11
buffer_load_dwordx4 v[88:91], v13, s[24:27], s47 offen offset:0 sc1
buffer_load_dwordx4 v[92:95], v13, s[24:27], s47 offen offset:1024 sc1
s_movk_i32 s47, 26
s_lshl_b32 s47, s47, 11
buffer_load_dwordx4 v[32:35], v13, s[24:27], s47 offen offset:0 sc1
buffer_load_dwordx4 v[36:39], v13, s[24:27], s47 offen offset:1024 sc1
s_movk_i32 s91, 24
s_call_b64 s[100:101], L_WAIT
v_mov_b64 v[80:81], v[120:121]
v_mov_b64 v[84:85], v[124:125]
s_branch L_BACK24
L_SLOW25:
s_movk_i32 s47, 26
s_lshl_b32 s47, s47, 11
buffer_load_dwordx4 v[32:35], v13, s[24:27], s47 offen offset:0 sc1
buffer_load_dwordx4 v[36:39], v13, s[24:27], s47 offen offset:1024 sc1
s_movk_i32 s47, 27
s_lshl_b32 s47, s47, 11
buffer_load_dwordx4 v[40:43], v13, s[24:27], s47 offen offset:0 sc1
buffer_load_dwordx4 v[44:47], v13, s[24:27], s47 offen offset:1024 sc1
s_movk_i32 s91, 25
s_call_b64 s[100:101], L_WAIT
v_mov_b64 v[88:89], v[120:121]
v_mov_b64 v[92:93], v[124:125]
s_branch L_BACK25
L_SLOW26:
s_movk_i32 s47, 27
s_lshl_b32 s47, s47, 11
buffer_load_dwordx4 v[40:43], v13, s[24:27], s47 offen offset:0 sc1
buffer_load_dwordx4 v[44:47], v13, s[24:27], s47 offen offset:1024 sc1
s_movk_i32 s47, 28
s_lshl_b32 s47, s47, 11
buffer_load_dwordx4 v[48:51], v13, s[24:27], s47 offen offset:0 sc1
buffer_load_dwordx4 v[52:55], v13, s[24:27], s47 offen offset:1024 sc1
s_movk_i32 s91, 26
s_call_b64 s[100:101], L_WAIT
v_mov_b64 v[32:33], v[120:121]
v_mov_b64 v[36:37], v[124:125]
s_branch L_BACK26
L_SLOW27:
s_movk_i32 s47, 28
s_lshl_b32 s47, s47, 11
buffer_load_dwordx4 v[48:51], v13, s[24:27], s47 offen offset:0 sc1
buffer_load_dwordx4 v[52:55], v13, s[24:27], s47 offen offset:1024 sc1
s_movk_i32 s47, 29
s_lshl_b32 s47, s47, 11
buffer_load_dwordx4 v[96:99], v13, s[24:27], s47 offen offset:0 sc1
buffer_load_dwordx4 v[100:103], v13, s[24:27], s47 offen offset:1024 sc1
s_movk_i32 s91, 27
s_call_b64 s[100:101], L_WAIT
v_mov_b64 v[40:41], v[120:121]
v_mov_b64 v[44:45], v[124:125]
s_branch L_BACK27
L_SLOW28:
s_movk_i32 s47, 29
s_lshl_b32 s47, s47, 11
buffer_load_dwordx4 v[96:99], v13, s[24:27], s47 offen offset:0 sc1
buffer_load_dwordx4 v[100:103], v13, s[24:27], s47 offen offset:1024 sc1
s_movk_i32 s47, 30
s_lshl_b32 s47, s47, 11
buffer_load_dwordx4 v[80:83], v13, s[24:27], s47 offen offset:0 sc1
buffer_load_dwordx4 v[84:87], v13, s[24:27], s47 offen offset:1024 sc1
s_movk_i32 s91, 28
s_call_b64 s[100:101], L_WAIT
v_mov_b64 v[48:49], v[120:121]
v_mov_b64 v[52:53], v[124:125]
s_branch L_BACK28
L_SLOW29:
s_movk_i32 s47, 30
s_lshl_b32 s47, s47, 11
buffer_load_dwordx4 v[80:83], v13, s[24:27], s47 offen offset:0 sc1
buffer_load_dwordx4 v[84:87], v13, s[24:27], s47 offen offset:1024 sc1
s_movk_i32 s47, 31
s_lshl_b32 s47, s47, 11
buffer_load_dwordx4 v[88:91], v13, s[24:27], s47 offen offset:0 sc1
buffer_load_dwordx4 v[92:95], v13, s[24:27], s47 offen offset:1024 sc1
s_movk_i32 s91, 29
s_call_b64 s[100:101], L_WAIT
v_mov_b64 v[96:97], v[120:121]
v_mov_b64 v[100:101], v[124:125]
s_branch L_BACK29
L_SLOW30:
s_movk_i32 s47, 31
s_lshl_b32 s47, s47, 11
buffer_load_dwordx4 v[88:91], v13, s[24:27], s47 offen offset:0 sc1
buffer_load_dwordx4 v[92:95], v13, s[24:27], s47 offen offset:1024 sc1
s_movk_i32 s91, 30
s_call_b64 s[100:101], L_WAIT
v_mov_b64 v[80:81], v[120:121]
v_mov_b64 v[84:85], v[124:125]
s_branch L_BACK30
L_SLOW31:
s_movk_i32 s91, 31
s_call_b64 s[100:101], L_WAIT
v_mov_b64 v[88:89], v[120:121]
v_mov_b64 v[92:93], v[124:125]
s_branch L_BACK31
L_WAIT:
s_lshl_b32 s47, s91, 11
buffer_load_dwordx4 v[120:123], v13, s[24:27], s47 offen offset:0 sc1
buffer_load_dwordx4 v[124:127], v13, s[24:27], s47 offen offset:1024 sc1
s_waitcnt vmcnt(0)
v_cmp_ne_u64 s[50:51], s[88:89], v[122:123]
v_cmp_ne_u64 s[44:45], s[88:89], v[126:127]
s_sub_u32 s90, s90, 1
s_nop 0
s_or_b64 s[50:51], s[44:45], s[50:51]
s_cbranch_scc0 L_WRET
s_cmp_gt_i32 s90, 0
s_cbranch_scc1 L_WAIT
s_mul_i32 s47, s91, 458752
s_lshl_b32 s46, s39, 8
s_add_u32 s47, s47, s46
s_add_u32 s84, s6, s47
s_addc_u32 s85, s7, 0
s_mov_b32 s86, 387328
s_mov_b32 s87, 0x20000
buffer_load_dwordx4 v[64:67], v30, s[84:87], 0 offen
buffer_load_dwordx4 v[68:71], v30, s[84:87], s92 offen
buffer_load_dwordx4 v[72:75], v30, s[84:87], s93 offen
buffer_load_dwordx4 v[76:79], v30, s[84:87], s94 offen
s_waitcnt vmcnt(0)
v_lshl_add_u64 v[64:65], v[68:69], 4, v[64:65]
v_lshl_add_u64 v[66:67], v[70:71], 4, v[66:67]
v_lshl_add_u64 v[72:73], v[76:77], 4, v[72:73]
v_lshl_add_u64 v[74:75], v[78:79], 4, v[74:75]
v_lshl_or_b32 v64, v72, 8, v64
v_lshl_or_b32 v65, v73, 8, v65
v_lshl_or_b32 v66, v74, 8, v66
v_lshl_or_b32 v67, v75, 8, v67
v_lshl_or_b32 v120, v65, 16, v64
v_lshl_or_b32 v121, v67, 16, v66
s_add_u32 s84, s84, 57344
s_addc_u32 s85, s85, 0
buffer_load_dwordx4 v[64:67], v30, s[84:87], 0 offen
buffer_load_dwordx4 v[68:71], v30, s[84:87], s92 offen
buffer_load_dwordx4 v[72:75], v30, s[84:87], s93 offen
buffer_load_dwordx4 v[76:79], v30, s[84:87], s94 offen
s_waitcnt vmcnt(0)
v_lshl_add_u64 v[64:65], v[68:69], 4, v[64:65]
v_lshl_add_u64 v[66:67], v[70:71], 4, v[66:67]
v_lshl_add_u64 v[72:73], v[76:77], 4, v[72:73]
v_lshl_add_u64 v[74:75], v[78:79], 4, v[74:75]
v_lshl_or_b32 v64, v72, 8, v64
v_lshl_or_b32 v65, v73, 8, v65
v_lshl_or_b32 v66, v74, 8, v66
v_lshl_or_b32 v67, v75, 8, v67
v_lshl_or_b32 v124, v65, 16, v64
v_lshl_or_b32 v125, v67, 16, v66
L_WRET:
s_setpc_b64 s[100:101]
L_END:
s_endpgm
.section .rodata,"a"
.p2align 6
.amdhsa_kernel standalone__normalfloat_lut_af4__prompt_kernel
  .amdhsa_next_free_vgpr 512
  .amdhsa_next_free_sgpr 102
  .amdhsa_accum_offset 256
  .amdhsa_group_segment_fixed_size 0
  .amdhsa_kernarg_size 56
  .amdhsa_user_sgpr_count 2
  .amdhsa_user_sgpr_kernarg_segment_ptr 1
  .amdhsa_system_sgpr_workgroup_id_x 1
.end_amdhsa_kernel
```

```asm
; @launch grid=(256,1,1) block=(256,1,1) lds=163840
.amdgcn_target "amdgcn-amd-amdhsa--gfx950"
.text
.globl standalone__normalfloat_lut_af4__prompt_kernel
.p2align 12
.p2align 8
.type standalone__normalfloat_lut_af4__prompt_kernel,@function
standalone__normalfloat_lut_af4__prompt_kernel:
s_load_dwordx4 s[4:7], s[0:1], 0
s_load_dwordx4 s[12:15], s[0:1], 40
s_load_dwordx4 s[8:11], s[0:1], 24
s_memrealtime s[56:57]
s_cmp_ge_u32 s2, 256
s_cbranch_scc1 L_END
s_getpc_b64 s[48:49]
L_PC0:
v_bfi_b32 v2, 7, v0, s2
v_lshlrev_b32 v2, 7, v2
v_min_u32 v2, L_END-L_PC0, v2
global_load_dword v7, v2, s[48:49]
v_lshrrev_b32 v1, 6, v0
s_cmp_lt_u32 s2, 32
v_readfirstlane_b32 s36, v1
s_cbranch_scc1 L_PACK
s_bfe_u32 s34, s2, 0x20001
s_bfe_u32 s37, s2, 0x20003
s_lshl2_add_u32 s37, s34, s37
s_and_b32 s43, s2, 1
s_mul_i32 s43, s43, 7
s_lshr_b32 s38, s2, 5
s_add_u32 s38, s38, s43
s_lshl2_add_u32 s39, s38, s36
s_sub_u32 s39, s39, 4
v_bfe_u32 v6, v0, 4, 2
v_and_b32 v3, 15, v0
v_mul_u32_u24 v2, 114688, v6
v_lshl_add_u32 v30, v3, 4, v2
s_lshr_b32 s46, s37, 1
s_and_b32 s45, s37, 1
s_lshl3_add_u32 s46, s46, s45
s_mul_i32 s46, s46, 57344
s_lshl_b32 s47, s39, 8
s_add_u32 s44, s46, s47
s_mov_b32 s18, 387328
s_mov_b32 s19, 0x20000
s_mov_b32 s92, 14336
s_mov_b32 s93, 28672
s_mov_b32 s94, 43008
s_waitcnt lgkmcnt(0)
s_add_u32 s16, s6, s44
s_addc_u32 s17, s7, 0
buffer_load_dwordx4 v[104:107], v30, s[16:19], 0 offen
buffer_load_dwordx4 v[108:111], v30, s[16:19], s92 offen
buffer_load_dwordx4 v[112:115], v30, s[16:19], s93 offen
buffer_load_dwordx4 v[116:119], v30, s[16:19], s94 offen
s_branch L_MAIN
L_PACK:
v_lshrrev_b32 v2, 2, v0
v_and_b32 v3, 3, v0
s_lshl_b32 s45, s2, 17
v_lshl_add_u32 v2, v2, 11, s45
v_lshl_add_u32 v17, v3, 7, v2
s_mov_b32 s30, 4194304
s_mov_b32 s31, 0x20000
v_lshlrev_b32 v16, 3, v0
s_cmp_lt_u32 s2, 2
s_cselect_b32 s34, 8, 0
s_mov_b32 s35, 0x20000
v_mov_b64 v[22:23], 0
s_waitcnt lgkmcnt(0)
s_mov_b64 s[32:33], s[12:13]
v_mov_b64 v[20:21], s[56:57]
buffer_atomic_cmpswap_x2 v[20:23], v16, s[32:35], 0 offen sc1
s_mov_b64 s[28:29], s[4:5]
buffer_load_dword v19, v17, s[28:31], 0 offen offset:0
s_branch L_PACK1
L_MAIN:
s_mov_b64 s[20:21], s[4:5]
s_mov_b32 s22, 4194304
s_mov_b32 s23, 0x20000
s_lshl_b32 s46, s37, 18
v_lshrrev_b32 v5, 3, v0
v_lshl_add_u32 v2, v5, 11, s46
v_lshrrev_b32 v4, 4, v0
v_xor_b32 v4, v4, v0
v_and_b32 v4, 7, v4
v_lshl_add_u32 v8, v4, 4, v2
v_add_u32 v9, 65536, v8
v_add_u32 v10, 131072, v8
v_add_u32 v11, 196608, v8
s_lshl_b32 s33, s36, 10
s_mul_i32 s47, s45, 114688
s_sub_u32 s47, s44, s47
s_add_u32 s47, s47, 57344
s_add_u32 s84, s6, s47
s_addc_u32 s85, s7, 0
s_mov_b32 s86, 387328
s_mov_b32 s87, 0x20000
s_lshl_b32 s40, s34, 7
s_add_u32 m0, s33, 65536
s_nop 0
buffer_load_dwordx4 v8, s[20:23], s40 offen lds
s_add_u32 m0, s33, 69632
s_nop 0
buffer_load_dwordx4 v9, s[20:23], s40 offen lds
s_add_u32 m0, s33, 73728
s_nop 0
buffer_load_dwordx4 v10, s[20:23], s40 offen lds
s_add_u32 m0, s33, 77824
s_nop 0
buffer_load_dwordx4 v11, s[20:23], s40 offen lds
v_mov_b32 v2, 0x3da3bf80
s_lshl_b64 exec, exec, 8
v_mov_b32 v2, 0x3e25bf32
s_lshl_b64 exec, exec, 8
v_mov_b32 v2, 0x3e7cbf06
s_lshl_b64 exec, exec, 8
v_mov_b32 v2, 0x3eadbeca
s_lshl_b64 exec, exec, 8
v_mov_b32 v2, 0x3ee2be92
s_lshl_b64 exec, exec, 8
v_mov_b32 v2, 0x3f10be3d
s_lshl_b64 exec, exec, 8
v_mov_b32 v2, 0x3f39bdba
s_lshl_b64 exec, exec, 8
v_mov_b32 v2, 0x3f800000
s_mov_b64 exec, -1
s_and_b32 s45, s36, 1
s_mul_i32 s45, s45, 0x0202
s_lshr_b32 s46, s36, 1
s_mul_i32 s46, s46, 0x02020000
s_add_u32 s45, s45, s46
s_add_u32 s45, s45, 0x05040100
v_mov_b32 v4, s45
v_lshlrev_b32 v5, 8, v5
v_and_b32 v31, 7, v0
v_lshl_add_u32 v31, v31, 4, v5
s_mov_b32 s45, 0xbf32bf80
v_perm_b32 v128, s45, v2, v4
v_mov_b32 v129, v128
v_mov_b64 v[130:131], v[128:129]
ds_write_b128 v31, v[128:131] offset:0
s_mov_b32 s45, 0xbecabf06
v_perm_b32 v132, s45, v2, v4
v_mov_b32 v133, v132
v_mov_b64 v[134:135], v[132:133]
v_and_b32 v5, 31, v0
v_lshlrev_b32 v19, 2, v5
v_and_b32 v0, 63, v0
s_lshl_b32 s46, s39, 7
ds_write_b128 v31, v[132:135] offset:8192
s_mov_b32 s45, 0xbe3dbe92
v_perm_b32 v136, s45, v2, v4
v_mov_b32 v137, v136
v_mov_b64 v[138:139], v[136:137]
v_lshl_add_u32 v28, v3, 3, s46
s_mul_i32 s47, s37, 917504
s_add_u32 s47, s47, s46
s_add_u32 s28, s10, s47
s_addc_u32 s29, s11, 0
ds_write_b128 v31, v[136:139] offset:16384
s_mov_b32 s45, 0xbdba
v_perm_b32 v140, s45, v2, v4
v_mov_b32 v141, v140
v_mov_b64 v[142:143], v[140:141]
s_mov_b32 s30, 86144
s_mov_b32 s31, 0x20000
v_mul_u32_u24 v29, 28672, v6
v_lshl_add_u32 v18, v3, 3, v29
ds_write_b128 v31, v[140:143] offset:24576
s_mov_b32 s45, 0x3e253da3
v_perm_b32 v144, s45, v2, v4
v_mov_b32 v145, v144
v_mov_b64 v[146:147], v[144:145]
v_lshlrev_b32 v29, 7, v3
v_bfe_u32 v5, v0, 1, 3
v_xor_b32 v5, v5, v6
v_lshl_add_u32 v29, v5, 4, v29
s_load_dwordx2 s[88:89], s[12:13], 0
ds_write_b128 v31, v[144:147] offset:32768
s_mov_b32 s45, 0x3ead3e7c
v_perm_b32 v148, s45, v2, v4
v_mov_b32 v149, v148
v_mov_b64 v[150:151], v[148:149]
v_add_u32 v14, 65536, v29
v_xor_b32 v15, 64, v14
v_add_u32 v16, 0x10000, v14
v_add_u32 v17, 0x10000, v15
ds_write_b128 v31, v[148:151] offset:40960
s_mov_b32 s45, 0x3f103ee2
v_perm_b32 v152, s45, v2, v4
v_mov_b32 v153, v152
v_mov_b64 v[154:155], v[152:153]
s_mov_b32 s52, 0x0c0c0400
s_mov_b32 s53, 0x0c0c0500
s_mov_b32 s54, 0x0c0c0600
s_mov_b32 s55, 0x0c0c0700
ds_write_b128 v31, v[152:155] offset:49152
s_mov_b32 s45, 0x3f803f39
v_perm_b32 v156, s45, v2, v4
v_mov_b32 v157, v156
v_mov_b64 v[158:159], v[156:157]
v_lshlrev_b32 v13, 4, v0
s_lshl_b32 s47, s39, 16
s_add_u32 s24, s14, s47
s_addc_u32 s25, s15, 0
s_lshl_b32 s47, s37, 10
ds_write_b128 v31, v[156:159] offset:57344
s_add_u32 s76, s24, s47
s_addc_u32 s77, s25, 0
s_movk_i32 s78, 1024
s_mov_b32 s79, 0x20000
s_lshl_b32 s47, s34, 3
s_lshr_b32 s47, 0x90d0b2d, s47
s_bfe_u32 s41, s47, 0x20000
s_lshl_b32 s41, s41, 7
s_bfe_u32 s42, s47, 0x20002
s_lshl_b32 s42, s42, 7
s_bfe_u32 s43, s47, 0x20004
s_lshl_b32 s43, s43, 7
s_lshl_b32 s47, s34, 1
s_lshr_b32 s47, 0x63, s47
s_and_b32 s47, s47, 3
s_sub_u32 s47, s47, s34
s_lshl1_add_u32 s3, s47, 14
s_mul_i32 s47, s3, 458752
s_add_u32 s16, s16, s47
s_addc_u32 s17, s17, 0
s_lshl_b32 s3, s3, 11
s_lshr_b32 s35, s37, 1
s_xor_b32 s35, s35, 1
v_lshl_add_u32 v12, s35, 11, v13
s_and_b32 s47, s37, 2
s_lshl_b32 s47, s47, 5
v_xor_b32 v2, s47, v14
v_xor_b32 v4, 64, v2
s_mov_b32 s26, 65536
s_mov_b32 s27, 0x20000
s_mov_b64 s[80:81], s[12:13]
s_movk_i32 s82, 128
s_mov_b32 s83, 0x20000
s_movk_i32 s90, 4096
buffer_load_dwordx4 v[64:67], v30, s[84:87], 0 offen
buffer_load_dwordx4 v[68:71], v30, s[84:87], s92 offen
buffer_load_dwordx4 v[72:75], v30, s[84:87], s93 offen
buffer_load_dwordx4 v[76:79], v30, s[84:87], s94 offen
s_mov_b64 vcc, -1
s_branch L_PAD0
L_PADRET0:
s_mov_b64 vcc, 0
s_waitcnt vmcnt(8)
v_lshl_add_u64 v[104:105], v[108:109], 4, v[104:105]
v_lshl_add_u64 v[106:107], v[110:111], 4, v[106:107]
v_lshl_add_u64 v[112:113], v[116:117], 4, v[112:113]
v_lshl_add_u64 v[114:115], v[118:119], 4, v[114:115]
v_lshl_or_b32 v116, v112, 8, v104
v_lshl_or_b32 v117, v113, 8, v105
v_lshl_or_b32 v118, v114, 8, v106
v_lshl_or_b32 v119, v115, 8, v107
v_lshl_or_b32 v108, v117, 16, v116
v_lshl_or_b32 v109, v119, 16, v118
s_waitcnt lgkmcnt(0)
s_cmp_eq_u64 s[88:89], 0
s_cbranch_scc1 L_NOTAG
L_TAGOK:
v_mov_b64 v[110:111], s[88:89]
buffer_store_dwordx4 v[108:111], v13, s[76:79], 0 offen sc1
s_add_u32 s76, s76, s3
s_addc_u32 s77, s77, 0
s_waitcnt lgkmcnt(0)
s_nop 0
s_branch L_STREAM
L_PACK1:
v_and_b32 v0, 63, v0
v_lshrrev_b32 v2, 4, v0
v_and_b32 v3, 15, v0
v_mul_u32_u24 v2, 114688, v2
v_lshl_add_u32 v8, v3, 4, v2
s_movk_i32 s47, 0x3800
v_add_u32 v9, s47, v8
v_add_u32 v10, s47, v9
v_add_u32 v11, s47, v10
v_add_u32 v12, s47, v11
v_add_u32 v13, s47, v12
v_add_u32 v14, s47, v13
v_add_u32 v15, s47, v14
s_sub_u32 s3, s2, 1
s_and_b32 s3, s3, 7
s_lshr_b32 s45, s2, 3
s_lshl2_add_u32 s3, s3, s45
s_mul_i32 s40, s3, 4682
s_lshr_b32 s40, s40, 16
s_mul_i32 s41, s40, 14
s_sub_u32 s41, s3, s41
s_add_u32 s40, s40, 8
s_mov_b32 s22, 14680064
s_mov_b32 s23, 0x20000
s_mov_b64 s[20:21], s[6:7]
s_cmp_ge_u32 s40, 14
s_cselect_b32 s45, 8, 0
s_add_u32 s45, s45, s40
s_lshl2_add_u32 s42, s41, s36
s_mul_i32 s43, s45, 458752
s_lshl_b32 s44, s42, 8
s_add_u32 s43, s43, s44
s_lshl_b32 s44, s42, 5
s_add_u32 s44, s44, s45
s_lshl_b32 s52, s44, 11
s_cmp_lt_u32 s45, 32
s_cselect_b32 s52, s52, 0x1000000
s_cselect_b32 s22, 14680064, 0
s_add_u32 s41, s41, 4
s_add_u32 s40, s40, 2
s_cmp_ge_u32 s41, 14
s_cselect_b32 s48, 14, 0
s_addc_u32 s40, s40, 0
s_sub_u32 s41, s41, s48
s_load_dwordx2 s[50:51], s[12:13], 0
buffer_load_dwordx4 v[32:35], v8, s[20:23], s43 offen
buffer_load_dwordx4 v[36:39], v9, s[20:23], s43 offen
buffer_load_dwordx4 v[40:43], v10, s[20:23], s43 offen
buffer_load_dwordx4 v[44:47], v11, s[20:23], s43 offen
buffer_load_dwordx4 v[48:51], v12, s[20:23], s43 offen
buffer_load_dwordx4 v[52:55], v13, s[20:23], s43 offen
buffer_load_dwordx4 v[56:59], v14, s[20:23], s43 offen
buffer_load_dwordx4 v[60:63], v15, s[20:23], s43 offen
s_mov_b64 s[24:25], s[14:15]
s_mov_b32 s26, 3670016
s_mov_b32 s27, 0x20000
s_movk_i32 s34, 128
v_mov_b32 v16, 0
v_lshlrev_b32 v18, 4, v0
s_movk_i32 s46, 4096
s_waitcnt vmcnt(4) lgkmcnt(0)
v_mov_b64 v[22:23], s[50:51]
s_nop 0
L_PKN:
v_cmp_ne_u64 vcc, 0, v[22:23]
s_sub_u32 s46, s46, 1
s_cmp_gt_i32 s46, 0
s_cbranch_vccnz L_PKGO
s_cbranch_scc0 L_END
buffer_load_dwordx2 v[22:23], v16, s[32:35], 0 offen sc1
s_waitcnt vmcnt(0)
s_branch L_PKN
L_PKGO:
s_call_b64 s[100:101], L_PK0
buffer_store_dwordx4 v[20:23], v18, s[24:27], s52 offen offset:0 sc1
s_waitcnt lgkmcnt(0)
s_call_b64 s[100:101], L_UNIT
s_mov_b32 s53, s49
buffer_load_dwordx4 v[64:67], v8, s[20:23], s43 offen
buffer_load_dwordx4 v[68:71], v9, s[20:23], s43 offen
buffer_load_dwordx4 v[72:75], v10, s[20:23], s43 offen
buffer_load_dwordx4 v[76:79], v11, s[20:23], s43 offen
s_waitcnt vmcnt(5)
s_call_b64 s[100:101], L_PK1
buffer_store_dwordx4 v[20:23], v18, s[24:27], s52 offen offset:1024 sc1
buffer_load_dwordx4 v[80:83], v12, s[20:23], s43 offen
buffer_load_dwordx4 v[84:87], v13, s[20:23], s43 offen
buffer_load_dwordx4 v[88:91], v14, s[20:23], s43 offen
buffer_load_dwordx4 v[92:95], v15, s[20:23], s43 offen
s_waitcnt vmcnt(5)
s_call_b64 s[100:101], L_PK2
buffer_store_dwordx4 v[20:23], v18, s[24:27], s53 offen offset:0 sc1
s_call_b64 s[100:101], L_UNIT
s_mov_b32 s54, s49
buffer_load_dwordx4 v[32:35], v8, s[20:23], s43 offen
buffer_load_dwordx4 v[36:39], v9, s[20:23], s43 offen
buffer_load_dwordx4 v[40:43], v10, s[20:23], s43 offen
buffer_load_dwordx4 v[44:47], v11, s[20:23], s43 offen
s_waitcnt vmcnt(5)
s_call_b64 s[100:101], L_PK3
buffer_store_dwordx4 v[20:23], v18, s[24:27], s53 offen offset:1024 sc1
buffer_load_dwordx4 v[48:51], v12, s[20:23], s43 offen
buffer_load_dwordx4 v[52:55], v13, s[20:23], s43 offen
buffer_load_dwordx4 v[56:59], v14, s[20:23], s43 offen
buffer_load_dwordx4 v[60:63], v15, s[20:23], s43 offen
s_waitcnt vmcnt(5)
s_call_b64 s[100:101], L_PK0
buffer_store_dwordx4 v[20:23], v18, s[24:27], s54 offen offset:0 sc1
s_call_b64 s[100:101], L_UNIT
s_mov_b32 s55, s49
buffer_load_dwordx4 v[64:67], v8, s[20:23], s43 offen
buffer_load_dwordx4 v[68:71], v9, s[20:23], s43 offen
buffer_load_dwordx4 v[72:75], v10, s[20:23], s43 offen
buffer_load_dwordx4 v[76:79], v11, s[20:23], s43 offen
s_waitcnt vmcnt(5)
s_call_b64 s[100:101], L_PK1
buffer_store_dwordx4 v[20:23], v18, s[24:27], s54 offen offset:1024 sc1
buffer_load_dwordx4 v[80:83], v12, s[20:23], s43 offen
buffer_load_dwordx4 v[84:87], v13, s[20:23], s43 offen
buffer_load_dwordx4 v[88:91], v14, s[20:23], s43 offen
buffer_load_dwordx4 v[92:95], v15, s[20:23], s43 offen
s_waitcnt vmcnt(5)
s_call_b64 s[100:101], L_PK2
buffer_store_dwordx4 v[20:23], v18, s[24:27], s55 offen offset:0 sc1
s_call_b64 s[100:101], L_UNIT
s_mov_b32 s52, s49
buffer_load_dwordx4 v[32:35], v8, s[20:23], s43 offen
buffer_load_dwordx4 v[36:39], v9, s[20:23], s43 offen
buffer_load_dwordx4 v[40:43], v10, s[20:23], s43 offen
buffer_load_dwordx4 v[44:47], v11, s[20:23], s43 offen
s_waitcnt vmcnt(5)
s_call_b64 s[100:101], L_PK3
buffer_store_dwordx4 v[20:23], v18, s[24:27], s55 offen offset:1024 sc1
buffer_load_dwordx4 v[48:51], v12, s[20:23], s43 offen
buffer_load_dwordx4 v[52:55], v13, s[20:23], s43 offen
buffer_load_dwordx4 v[56:59], v14, s[20:23], s43 offen
buffer_load_dwordx4 v[60:63], v15, s[20:23], s43 offen
s_waitcnt vmcnt(5)
s_call_b64 s[100:101], L_PK0
buffer_store_dwordx4 v[20:23], v18, s[24:27], s52 offen offset:0 sc1
s_call_b64 s[100:101], L_UNIT
s_mov_b32 s53, s49
buffer_load_dwordx4 v[64:67], v8, s[20:23], s43 offen
buffer_load_dwordx4 v[68:71], v9, s[20:23], s43 offen
buffer_load_dwordx4 v[72:75], v10, s[20:23], s43 offen
buffer_load_dwordx4 v[76:79], v11, s[20:23], s43 offen
s_waitcnt vmcnt(5)
s_call_b64 s[100:101], L_PK1
buffer_store_dwordx4 v[20:23], v18, s[24:27], s52 offen offset:1024 sc1
buffer_load_dwordx4 v[80:83], v12, s[20:23], s43 offen
buffer_load_dwordx4 v[84:87], v13, s[20:23], s43 offen
buffer_load_dwordx4 v[88:91], v14, s[20:23], s43 offen
buffer_load_dwordx4 v[92:95], v15, s[20:23], s43 offen
s_waitcnt vmcnt(5)
s_call_b64 s[100:101], L_PK2
buffer_store_dwordx4 v[20:23], v18, s[24:27], s53 offen offset:0 sc1
s_call_b64 s[100:101], L_UNIT
s_mov_b32 s54, s49
buffer_load_dwordx4 v[32:35], v8, s[20:23], s43 offen
buffer_load_dwordx4 v[36:39], v9, s[20:23], s43 offen
buffer_load_dwordx4 v[40:43], v10, s[20:23], s43 offen
buffer_load_dwordx4 v[44:47], v11, s[20:23], s43 offen
s_waitcnt vmcnt(5)
s_call_b64 s[100:101], L_PK3
buffer_store_dwordx4 v[20:23], v18, s[24:27], s53 offen offset:1024 sc1
buffer_load_dwordx4 v[48:51], v12, s[20:23], s43 offen
buffer_load_dwordx4 v[52:55], v13, s[20:23], s43 offen
buffer_load_dwordx4 v[56:59], v14, s[20:23], s43 offen
buffer_load_dwordx4 v[60:63], v15, s[20:23], s43 offen
s_waitcnt vmcnt(5)
s_call_b64 s[100:101], L_PK0
buffer_store_dwordx4 v[20:23], v18, s[24:27], s54 offen offset:0 sc1
s_waitcnt vmcnt(1)
s_call_b64 s[100:101], L_PK1
buffer_store_dwordx4 v[20:23], v18, s[24:27], s54 offen offset:1024 sc1
s_endpgm
L_UNIT:
s_cmp_ge_u32 s40, 14
s_cselect_b32 s45, 8, 0
s_add_u32 s45, s45, s40
s_lshl2_add_u32 s42, s41, s36
s_mul_i32 s43, s45, 458752
s_lshl_b32 s44, s42, 8
s_add_u32 s43, s43, s44
s_lshl_b32 s44, s42, 5
s_add_u32 s44, s44, s45
s_lshl_b32 s49, s44, 11
s_cmp_lt_u32 s45, 32
s_cselect_b32 s49, s49, 0x1000000
s_cselect_b32 s22, 14680064, 0
s_add_u32 s41, s41, 4
s_add_u32 s40, s40, 2
s_cmp_ge_u32 s41, 14
s_cselect_b32 s48, 14, 0
s_addc_u32 s40, s40, 0
s_sub_u32 s41, s41, s48
s_setpc_b64 s[100:101]
L_PK0:
v_lshl_add_u64 v[32:33], v[36:37], 4, v[32:33]
v_lshl_add_u64 v[34:35], v[38:39], 4, v[34:35]
v_lshl_add_u64 v[40:41], v[44:45], 4, v[40:41]
v_lshl_add_u64 v[42:43], v[46:47], 4, v[42:43]
v_lshl_or_b32 v44, v40, 8, v32
v_lshl_or_b32 v45, v41, 8, v33
v_lshl_or_b32 v46, v42, 8, v34
v_lshl_or_b32 v47, v43, 8, v35
v_lshl_or_b32 v20, v45, 16, v44
v_lshl_or_b32 v21, v47, 16, v46
s_setpc_b64 s[100:101]
L_PK1:
v_lshl_add_u64 v[48:49], v[52:53], 4, v[48:49]
v_lshl_add_u64 v[50:51], v[54:55], 4, v[50:51]
v_lshl_add_u64 v[56:57], v[60:61], 4, v[56:57]
v_lshl_add_u64 v[58:59], v[62:63], 4, v[58:59]
v_lshl_or_b32 v60, v56, 8, v48
v_lshl_or_b32 v61, v57, 8, v49
v_lshl_or_b32 v62, v58, 8, v50
v_lshl_or_b32 v63, v59, 8, v51
v_lshl_or_b32 v20, v61, 16, v60
v_lshl_or_b32 v21, v63, 16, v62
s_setpc_b64 s[100:101]
L_PK2:
v_lshl_add_u64 v[64:65], v[68:69], 4, v[64:65]
v_lshl_add_u64 v[66:67], v[70:71], 4, v[66:67]
v_lshl_add_u64 v[72:73], v[76:77], 4, v[72:73]
v_lshl_add_u64 v[74:75], v[78:79], 4, v[74:75]
v_lshl_or_b32 v76, v72, 8, v64
v_lshl_or_b32 v77, v73, 8, v65
v_lshl_or_b32 v78, v74, 8, v66
v_lshl_or_b32 v79, v75, 8, v67
v_lshl_or_b32 v20, v77, 16, v76
v_lshl_or_b32 v21, v79, 16, v78
s_setpc_b64 s[100:101]
L_PK3:
v_lshl_add_u64 v[80:81], v[84:85], 4, v[80:81]
v_lshl_add_u64 v[82:83], v[86:87], 4, v[82:83]
v_lshl_add_u64 v[88:89], v[92:93], 4, v[88:89]
v_lshl_add_u64 v[90:91], v[94:95], 4, v[90:91]
v_lshl_or_b32 v92, v88, 8, v80
v_lshl_or_b32 v93, v89, 8, v81
v_lshl_or_b32 v94, v90, 8, v82
v_lshl_or_b32 v95, v91, 8, v83
v_lshl_or_b32 v20, v93, 16, v92
v_lshl_or_b32 v21, v95, 16, v94
s_setpc_b64 s[100:101]
.p2align 12
L_STREAM:
L_PAD0:
s_cbranch_vccnz L_PADRET0
s_add_u32 m0, s33, 81920
s_nop 0
buffer_load_dwordx4 v8, s[20:23], s41 offen lds
s_add_u32 m0, s33, 86016
s_nop 0
buffer_load_dwordx4 v9, s[20:23], s41 offen lds
s_add_u32 m0, s33, 90112
s_nop 0
buffer_load_dwordx4 v10, s[20:23], s41 offen lds
s_add_u32 m0, s33, 94208
s_nop 0
buffer_load_dwordx4 v11, s[20:23], s41 offen lds
s_waitcnt vmcnt(9)
s_barrier
ds_read_b128 a[224:227], v2 offset:0
ds_read_b128 a[228:231], v2 offset:2048
v_lshl_add_u32 v104, v104, 8, v19
v_lshl_add_u32 v105, v105, 8, v19
v_lshl_add_u32 v106, v106, 8, v19
v_lshl_add_u32 v107, v107, 8, v19
v_lshl_add_u32 v112, v112, 8, v19
v_lshl_add_u32 v113, v113, 8, v19
v_lshl_add_u32 v114, v114, 8, v19
v_lshl_add_u32 v115, v115, 8, v19
s_waitcnt vmcnt(5)
v_lshl_add_u64 v[64:65], v[68:69], 4, v[64:65]
v_lshl_add_u64 v[66:67], v[70:71], 4, v[66:67]
v_lshl_add_u64 v[72:73], v[76:77], 4, v[72:73]
v_lshl_add_u64 v[74:75], v[78:79], 4, v[74:75]
v_lshl_add_u32 v64, v64, 8, v19
v_lshl_add_u32 v65, v65, 8, v19
v_lshl_add_u32 v66, v66, 8, v19
v_lshl_add_u32 v67, v67, 8, v19
v_lshl_add_u32 v72, v72, 8, v19
v_lshl_add_u32 v73, v73, 8, v19
v_lshl_add_u32 v74, v74, 8, v19
v_lshl_add_u32 v75, v75, 8, v19
s_bitcmp1_b32 s37, 0
s_cbranch_scc0 L_NOSWAP
v_swap_b32 v104, v64
v_swap_b32 v105, v65
v_swap_b32 v106, v66
v_swap_b32 v107, v67
v_swap_b32 v112, v72
v_swap_b32 v113, v73
v_swap_b32 v114, v74
v_swap_b32 v115, v75
L_NOSWAP:
ds_read_b32 a0, v104
ds_read_b32 a1, v112
ds_read_b32 a2, v64
ds_read_b32 a3, v72
ds_read_b32 a4, v105
ds_read_b32 a5, v113
ds_read_b32 a6, v65
ds_read_b32 a7, v73
ds_read_b32 a8, v106
ds_read_b32 a9, v114
ds_read_b32 a10, v66
ds_read_b32 a11, v74
ds_read_b32 a12, v107
ds_read_b32 a13, v115
ds_read_b32 a14, v67
ds_read_b32 a15, v75
s_waitcnt lgkmcnt(12)
v_mfma_f32_16x16x32_bf16 v[128:131], a[224:227], a[0:3], 0
s_waitcnt lgkmcnt(8)
ds_read_b128 a[232:235], v2 offset:4096
v_mfma_f32_16x16x32_bf16 v[132:135], a[224:227], a[4:7], 0
s_waitcnt lgkmcnt(5)
v_mfma_f32_16x16x32_bf16 v[136:139], a[224:227], a[8:11], 0
s_waitcnt vmcnt(4) lgkmcnt(1)
buffer_load_dwordx4 v[32:35], v12, s[24:27], 0 offen offset:0 sc1
v_mfma_f32_16x16x32_bf16 v[140:143], a[224:227], a[12:15], 0
buffer_load_dwordx4 v[36:39], v12, s[24:27], 0 offen offset:1024 sc1
v_mfma_f32_16x16x32_bf16 v[144:147], a[228:231], a[0:3], 0
ds_read_b128 a[236:239], v2 offset:6144
v_lshl_add_u32 v12, s41, 5, v13
v_mfma_f32_16x16x32_bf16 v[148:151], a[228:231], a[4:7], 0
v_mfma_f32_16x16x32_bf16 v[152:155], a[228:231], a[8:11], 0
v_mfma_f32_16x16x32_bf16 v[156:159], a[228:231], a[12:15], 0
s_waitcnt lgkmcnt(1)
v_mfma_f32_16x16x32_bf16 v[160:163], a[232:235], a[0:3], 0
ds_read_b128 a[240:243], v2 offset:8192
v_mfma_f32_16x16x32_bf16 v[164:167], a[232:235], a[4:7], 0
v_mfma_f32_16x16x32_bf16 v[168:171], a[232:235], a[8:11], 0
v_mfma_f32_16x16x32_bf16 v[172:175], a[232:235], a[12:15], 0
s_waitcnt lgkmcnt(1)
v_mfma_f32_16x16x32_bf16 v[176:179], a[236:239], a[0:3], 0
ds_read_b128 a[244:247], v2 offset:10240
v_mfma_f32_16x16x32_bf16 v[180:183], a[236:239], a[4:7], 0
v_mfma_f32_16x16x32_bf16 v[184:187], a[236:239], a[8:11], 0
v_mfma_f32_16x16x32_bf16 v[188:191], a[236:239], a[12:15], 0
s_waitcnt lgkmcnt(1)
v_mfma_f32_16x16x32_bf16 v[192:195], a[240:243], a[0:3], 0
ds_read_b128 a[248:251], v2 offset:12288
v_mfma_f32_16x16x32_bf16 v[196:199], a[240:243], a[4:7], 0
v_mfma_f32_16x16x32_bf16 v[200:203], a[240:243], a[8:11], 0
v_mfma_f32_16x16x32_bf16 v[204:207], a[240:243], a[12:15], 0
s_waitcnt lgkmcnt(1)
v_mfma_f32_16x16x32_bf16 v[208:211], a[244:247], a[0:3], 0
ds_read_b128 a[252:255], v2 offset:14336
v_mfma_f32_16x16x32_bf16 v[212:215], a[244:247], a[4:7], 0
v_mfma_f32_16x16x32_bf16 v[216:219], a[244:247], a[8:11], 0
v_mfma_f32_16x16x32_bf16 v[220:223], a[244:247], a[12:15], 0
s_waitcnt lgkmcnt(1)
v_mfma_f32_16x16x32_bf16 v[224:227], a[248:251], a[0:3], 0
buffer_load_dwordx4 v[40:43], v12, s[24:27], 0 offen offset:0 sc1
v_mfma_f32_16x16x32_bf16 v[228:231], a[248:251], a[4:7], 0
buffer_load_dwordx4 v[44:47], v12, s[24:27], 0 offen offset:1024 sc1
v_mfma_f32_16x16x32_bf16 v[232:235], a[248:251], a[8:11], 0
v_mfma_f32_16x16x32_bf16 v[236:239], a[248:251], a[12:15], 0
s_waitcnt lgkmcnt(0)
v_mfma_f32_16x16x32_bf16 v[240:243], a[252:255], a[0:3], 0
ds_read_b128 a[224:227], v4 offset:0
v_mfma_f32_16x16x32_bf16 v[244:247], a[252:255], a[4:7], 0
v_mfma_f32_16x16x32_bf16 v[248:251], a[252:255], a[8:11], 0
global_load_dwordx2 v[20:21], v28, s[8:9]
v_mfma_f32_16x16x32_bf16 v[252:255], a[252:255], a[12:15], 0
ds_read_b128 a[228:231], v4 offset:2048
s_mov_b64 vcc, -1
s_cmp_eq_u32 s36, 0
s_cbranch_scc1 L_PAD1
s_cmp_eq_u32 s36, 1
s_cbranch_scc1 L_PAD3
s_cmp_eq_u32 s36, 2
s_cbranch_scc1 L_PAD5
s_cmp_eq_u32 s36, 3
s_cbranch_scc1 L_PADRET
L_PADRET:
s_mov_b64 vcc, 0
s_waitcnt vmcnt(3)
v_cmp_ne_u64 s[50:51], s[88:89], v[34:35]
v_cmp_ne_u64 s[44:45], s[88:89], v[38:39]
s_or_b64 s[50:51], s[44:45], s[50:51]
s_cbranch_scc1 L_SLOW1
L_BACK1:
v_perm_b32 v64, v32, v19, s52
v_perm_b32 v65, v32, v19, s53
v_perm_b32 v66, v36, v19, s52
v_perm_b32 v67, v36, v19, s53
v_perm_b32 v68, v32, v19, s54
v_perm_b32 v69, v32, v19, s55
v_perm_b32 v70, v36, v19, s54
v_perm_b32 v71, v36, v19, s55
ds_read_b32 a16, v64
ds_read_b32 a17, v65
ds_read_b32 a18, v66
ds_read_b32 a19, v67
ds_read_b32 a20, v68
ds_read_b32 a21, v69
ds_read_b32 a22, v70
ds_read_b32 a23, v71
v_perm_b32 v72, v33, v19, s52
v_perm_b32 v73, v33, v19, s53
v_perm_b32 v74, v37, v19, s52
v_perm_b32 v75, v37, v19, s53
v_perm_b32 v76, v33, v19, s54
v_perm_b32 v77, v33, v19, s55
v_perm_b32 v78, v37, v19, s54
v_perm_b32 v79, v37, v19, s55
ds_read_b32 a24, v72
ds_read_b32 a25, v73
ds_read_b32 a26, v74
ds_read_b32 a27, v75
ds_read_b32 a28, v76
ds_read_b32 a29, v77
ds_read_b32 a30, v78
ds_read_b32 a31, v79
s_waitcnt lgkmcnt(12)
v_mfma_f32_16x16x32_bf16 v[128:131], a[224:227], a[16:19], v[128:131]
s_waitcnt lgkmcnt(8)
ds_read_b128 a[232:235], v4 offset:4096
v_mfma_f32_16x16x32_bf16 v[132:135], a[224:227], a[20:23], v[132:135]
s_waitcnt lgkmcnt(5)
v_mfma_f32_16x16x32_bf16 v[136:139], a[224:227], a[24:27], v[136:139]
s_waitcnt lgkmcnt(1)
v_mfma_f32_16x16x32_bf16 v[140:143], a[224:227], a[28:31], v[140:143]
v_mfma_f32_16x16x32_bf16 v[144:147], a[228:231], a[16:19], v[144:147]
ds_read_b128 a[236:239], v4 offset:6144
buffer_load_dwordx4 v[48:51], v12, s[24:27], 0 offen offset:2048 sc1
v_mfma_f32_16x16x32_bf16 v[148:151], a[228:231], a[20:23], v[148:151]
buffer_load_dwordx4 v[52:55], v12, s[24:27], 0 offen offset:3072 sc1
v_lshl_add_u32 v12, s42, 5, v13
v_mfma_f32_16x16x32_bf16 v[152:155], a[228:231], a[24:27], v[152:155]
s_add_u32 m0, s33, 98304
v_mfma_f32_16x16x32_bf16 v[156:159], a[228:231], a[28:31], v[156:159]
s_waitcnt lgkmcnt(1)
v_mfma_f32_16x16x32_bf16 v[160:163], a[232:235], a[16:19], v[160:163]
ds_read_b128 a[240:243], v4 offset:8192
buffer_load_dwordx4 v8, s[20:23], s42 offen lds
v_mfma_f32_16x16x32_bf16 v[164:167], a[232:235], a[20:23], v[164:167]
v_mfma_f32_16x16x32_bf16 v[168:171], a[232:235], a[24:27], v[168:171]
s_add_u32 m0, s33, 102400
v_mfma_f32_16x16x32_bf16 v[172:175], a[232:235], a[28:31], v[172:175]
s_waitcnt lgkmcnt(1)
v_mfma_f32_16x16x32_bf16 v[176:179], a[236:239], a[16:19], v[176:179]
ds_read_b128 a[244:247], v4 offset:10240
buffer_load_dwordx4 v9, s[20:23], s42 offen lds
v_mfma_f32_16x16x32_bf16 v[180:183], a[236:239], a[20:23], v[180:183]
v_mfma_f32_16x16x32_bf16 v[184:187], a[236:239], a[24:27], v[184:187]
s_add_u32 m0, s33, 106496
v_mfma_f32_16x16x32_bf16 v[188:191], a[236:239], a[28:31], v[188:191]
s_waitcnt lgkmcnt(1)
v_mfma_f32_16x16x32_bf16 v[192:195], a[240:243], a[16:19], v[192:195]
buffer_load_dwordx4 v10, s[20:23], s42 offen lds
v_mfma_f32_16x16x32_bf16 v[196:199], a[240:243], a[20:23], v[196:199]
buffer_load_dwordx4 v[96:99], v12, s[24:27], 0 offen offset:0 sc1
v_mfma_f32_16x16x32_bf16 v[200:203], a[240:243], a[24:27], v[200:203]
s_add_u32 m0, s33, 110592
buffer_load_dwordx4 v[100:103], v12, s[24:27], 0 offen offset:1024 sc1
v_mfma_f32_16x16x32_bf16 v[204:207], a[240:243], a[28:31], v[204:207]
s_waitcnt lgkmcnt(0)
v_mfma_f32_16x16x32_bf16 v[208:211], a[244:247], a[16:19], v[208:211]
s_barrier
ds_read_b128 a[248:251], v4 offset:12288
buffer_load_dwordx4 v11, s[20:23], s42 offen lds
v_mfma_f32_16x16x32_bf16 v[212:215], a[244:247], a[20:23], v[212:215]
v_mfma_f32_16x16x32_bf16 v[216:219], a[244:247], a[24:27], v[216:219]
s_add_u32 m0, s33, 114688
v_mfma_f32_16x16x32_bf16 v[220:223], a[244:247], a[28:31], v[220:223]
ds_read_b128 a[252:255], v4 offset:14336
buffer_load_dwordx4 v8, s[20:23], s43 offen lds
s_waitcnt vmcnt(10)
v_cmp_ne_u64 s[50:51], s[88:89], v[42:43]
v_cmp_ne_u64 s[44:45], s[88:89], v[46:47]
s_or_b64 s[50:51], s[44:45], s[50:51]
s_cbranch_scc1 L_SLOW2
L_BACK2:
v_perm_b32 v64, v40, v19, s52
v_perm_b32 v65, v40, v19, s53
v_perm_b32 v66, v44, v19, s52
v_perm_b32 v67, v44, v19, s53
v_perm_b32 v68, v40, v19, s54
v_perm_b32 v69, v40, v19, s55
v_perm_b32 v70, v44, v19, s54
v_perm_b32 v71, v44, v19, s55
ds_read_b32 a32, v64
ds_read_b32 a33, v65
ds_read_b32 a34, v66
ds_read_b32 a35, v67
ds_read_b32 a36, v68
ds_read_b32 a37, v69
ds_read_b32 a38, v70
ds_read_b32 a39, v71
v_perm_b32 v72, v41, v19, s52
v_perm_b32 v73, v41, v19, s53
v_perm_b32 v74, v45, v19, s52
v_perm_b32 v75, v45, v19, s53
v_perm_b32 v76, v41, v19, s54
v_perm_b32 v77, v41, v19, s55
v_perm_b32 v78, v45, v19, s54
v_perm_b32 v79, v45, v19, s55
ds_read_b32 a40, v72
ds_read_b32 a41, v73
ds_read_b32 a42, v74
ds_read_b32 a43, v75
ds_read_b32 a44, v76
ds_read_b32 a45, v77
ds_read_b32 a46, v78
ds_read_b32 a47, v79
s_waitcnt lgkmcnt(15)
v_mfma_f32_16x16x32_bf16 v[224:227], a[248:251], a[16:19], v[224:227]
ds_read_b128 a[224:227], v14 offset:16384
v_mfma_f32_16x16x32_bf16 v[228:231], a[248:251], a[20:23], v[228:231]
buffer_load_dwordx4 v[80:83], v12, s[24:27], 0 offen offset:2048 sc1
v_mfma_f32_16x16x32_bf16 v[232:235], a[248:251], a[24:27], v[232:235]
s_add_u32 m0, s33, 118784
buffer_load_dwordx4 v[84:87], v12, s[24:27], 0 offen offset:3072 sc1
v_mfma_f32_16x16x32_bf16 v[236:239], a[248:251], a[28:31], v[236:239]
s_waitcnt vmcnt(9)
v_cmp_ne_u64 s[50:51], s[88:89], v[50:51]
v_cmp_ne_u64 s[44:45], s[88:89], v[54:55]
v_mfma_f32_16x16x32_bf16 v[240:243], a[252:255], a[16:19], v[240:243]
ds_read_b128 a[228:231], v14 offset:18432
buffer_load_dwordx4 v9, s[20:23], s43 offen lds
v_mfma_f32_16x16x32_bf16 v[244:247], a[252:255], a[20:23], v[244:247]
s_or_b64 s[50:51], s[44:45], s[50:51]
v_lshl_add_u32 v12, s43, 5, v13
v_mfma_f32_16x16x32_bf16 v[248:251], a[252:255], a[24:27], v[248:251]
s_cbranch_scc1 L_SLOW3
L_BACK3:
v_mfma_f32_16x16x32_bf16 v[252:255], a[252:255], a[28:31], v[252:255]
s_waitcnt lgkmcnt(1)
v_mfma_f32_16x16x32_bf16 v[128:131], a[224:227], a[32:35], v[128:131]
ds_read_b128 a[232:235], v14 offset:20480
v_mfma_f32_16x16x32_bf16 v[132:135], a[224:227], a[36:39], v[132:135]
v_perm_b32 v63, v48, v19, s52
v_mfma_f32_16x16x32_bf16 v[136:139], a[224:227], a[40:43], v[136:139]
ds_read_b32 a48, v63
v_perm_b32 v62, v48, v19, s53
v_mfma_f32_16x16x32_bf16 v[140:143], a[224:227], a[44:47], v[140:143]
s_waitcnt lgkmcnt(2)
ds_read_b32 a49, v62
v_mfma_f32_16x16x32_bf16 v[144:147], a[228:231], a[32:35], v[144:147]
ds_read_b128 a[236:239], v14 offset:22528
v_perm_b32 v61, v52, v19, s52
v_mfma_f32_16x16x32_bf16 v[148:151], a[228:231], a[36:39], v[148:151]
ds_read_b32 a50, v61
v_perm_b32 v60, v52, v19, s53
v_mfma_f32_16x16x32_bf16 v[152:155], a[228:231], a[40:43], v[152:155]
s_add_u32 m0, s33, 122880
ds_read_b32 a51, v60
v_perm_b32 v59, v48, v19, s54
v_mfma_f32_16x16x32_bf16 v[156:159], a[228:231], a[44:47], v[156:159]
s_waitcnt lgkmcnt(4)
ds_read_b32 a52, v59
v_perm_b32 v58, v48, v19, s55
v_mfma_f32_16x16x32_bf16 v[160:163], a[232:235], a[32:35], v[160:163]
ds_read_b128 a[240:243], v14 offset:24576
buffer_load_dwordx4 v10, s[20:23], s43 offen lds
v_mfma_f32_16x16x32_bf16 v[164:167], a[232:235], a[36:39], v[164:167]
buffer_load_dwordx4 v[104:107], v30, s[16:19], 0 offen
v_mfma_f32_16x16x32_bf16 v[168:171], a[232:235], a[40:43], v[168:171]
ds_read_b32 a53, v58
v_perm_b32 v57, v52, v19, s54
v_mfma_f32_16x16x32_bf16 v[172:175], a[232:235], a[44:47], v[172:175]
s_waitcnt lgkmcnt(3)
ds_read_b32 a54, v57
buffer_load_dwordx4 v[88:91], v12, s[24:27], 0 offen offset:0 sc1
v_mfma_f32_16x16x32_bf16 v[176:179], a[236:239], a[32:35], v[176:179]
ds_read_b128 a[244:247], v14 offset:26624
v_perm_b32 v56, v52, v19, s55
v_mfma_f32_16x16x32_bf16 v[180:183], a[236:239], a[36:39], v[180:183]
ds_read_b32 a55, v56
v_perm_b32 v63, v49, v19, s52
v_mfma_f32_16x16x32_bf16 v[184:187], a[236:239], a[40:43], v[184:187]
ds_read_b32 a56, v63
v_perm_b32 v62, v49, v19, s53
v_mfma_f32_16x16x32_bf16 v[188:191], a[236:239], a[44:47], v[188:191]
s_waitcnt lgkmcnt(4)
ds_read_b32 a57, v62
buffer_load_dwordx4 v[92:95], v12, s[24:27], 0 offen offset:1024 sc1
v_mfma_f32_16x16x32_bf16 v[192:195], a[240:243], a[32:35], v[192:195]
ds_read_b128 a[248:251], v14 offset:28672
v_perm_b32 v61, v53, v19, s52
v_mfma_f32_16x16x32_bf16 v[196:199], a[240:243], a[36:39], v[196:199]
buffer_load_dwordx4 v[108:111], v30, s[16:19], s92 offen
v_mfma_f32_16x16x32_bf16 v[200:203], a[240:243], a[40:43], v[200:203]
s_add_u32 m0, s33, 126976
ds_read_b32 a58, v61
v_perm_b32 v60, v53, v19, s53
v_mfma_f32_16x16x32_bf16 v[204:207], a[240:243], a[44:47], v[204:207]
s_waitcnt lgkmcnt(3)
ds_read_b32 a59, v60
v_perm_b32 v59, v49, v19, s54
v_mfma_f32_16x16x32_bf16 v[208:211], a[244:247], a[32:35], v[208:211]
ds_read_b128 a[252:255], v14 offset:30720
buffer_load_dwordx4 v11, s[20:23], s43 offen lds
v_mfma_f32_16x16x32_bf16 v[212:215], a[244:247], a[36:39], v[212:215]
ds_read_b32 a60, v59
v_perm_b32 v58, v49, v19, s55
v_mfma_f32_16x16x32_bf16 v[216:219], a[244:247], a[40:43], v[216:219]
ds_read_b32 a61, v58
v_perm_b32 v57, v53, v19, s54
v_mfma_f32_16x16x32_bf16 v[220:223], a[244:247], a[44:47], v[220:223]
s_waitcnt lgkmcnt(4)
ds_read_b32 a62, v57
v_mfma_f32_16x16x32_bf16 v[224:227], a[248:251], a[32:35], v[224:227]
ds_read_b128 a[224:227], v15 offset:16384
v_perm_b32 v56, v53, v19, s55
v_mfma_f32_16x16x32_bf16 v[228:231], a[248:251], a[36:39], v[228:231]
buffer_load_dwordx4 v[112:115], v30, s[16:19], s93 offen
v_mfma_f32_16x16x32_bf16 v[232:235], a[248:251], a[40:43], v[232:235]
ds_read_b32 a63, v56
v_mfma_f32_16x16x32_bf16 v[236:239], a[248:251], a[44:47], v[236:239]
s_waitcnt lgkmcnt(3)
v_mfma_f32_16x16x32_bf16 v[240:243], a[252:255], a[32:35], v[240:243]
ds_read_b128 a[228:231], v15 offset:18432
v_lshlrev_b32 v24, 16, v20
v_mfma_f32_16x16x32_bf16 v[244:247], a[252:255], a[36:39], v[244:247]
v_and_b32 v25, 0xffff0000, v20
v_lshlrev_b32 v26, 16, v21
v_mfma_f32_16x16x32_bf16 v[248:251], a[252:255], a[40:43], v[248:251]
s_waitcnt vmcnt(12)
v_cmp_ne_u64 s[50:51], s[88:89], v[98:99]
v_cmp_ne_u64 s[44:45], s[88:89], v[102:103]
v_mfma_f32_16x16x32_bf16 v[252:255], a[252:255], a[44:47], v[252:255]
s_waitcnt lgkmcnt(1)
v_and_b32 v27, 0xffff0000, v21
v_mfma_f32_16x16x32_bf16 v[128:131], a[224:227], a[48:51], v[128:131]
s_or_b64 s[50:51], s[44:45], s[50:51]
ds_read_b128 a[232:235], v15 offset:20480
v_mfma_f32_16x16x32_bf16 v[132:135], a[224:227], a[52:55], v[132:135]
buffer_load_dwordx4 v[116:119], v30, s[16:19], s94 offen
v_mfma_f32_16x16x32_bf16 v[136:139], a[224:227], a[56:59], v[136:139]
s_cbranch_scc1 L_SLOW4
L_BACK4:
v_mfma_f32_16x16x32_bf16 v[140:143], a[224:227], a[60:63], v[140:143]
s_waitcnt lgkmcnt(1)
v_mfma_f32_16x16x32_bf16 v[144:147], a[228:231], a[48:51], v[144:147]
ds_read_b128 a[236:239], v15 offset:22528
v_mfma_f32_16x16x32_bf16 v[148:151], a[228:231], a[52:55], v[148:151]
v_perm_b32 v63, v96, v19, s52
v_mfma_f32_16x16x32_bf16 v[152:155], a[228:231], a[56:59], v[152:155]
ds_read_b32 a64, v63
v_perm_b32 v62, v96, v19, s53
v_mfma_f32_16x16x32_bf16 v[156:159], a[228:231], a[60:63], v[156:159]
s_waitcnt lgkmcnt(2)
ds_read_b32 a65, v62
buffer_load_dwordx4 v[32:35], v12, s[24:27], 0 offen offset:2048 sc1
v_mfma_f32_16x16x32_bf16 v[160:163], a[232:235], a[48:51], v[160:163]
ds_read_b128 a[240:243], v15 offset:24576
v_perm_b32 v61, v100, v19, s52
v_mfma_f32_16x16x32_bf16 v[164:167], a[232:235], a[52:55], v[164:167]
ds_read_b32 a66, v61
v_perm_b32 v60, v100, v19, s53
v_mfma_f32_16x16x32_bf16 v[168:171], a[232:235], a[56:59], v[168:171]
s_add_u32 m0, s33, 130560
ds_read_b32 a67, v60
v_perm_b32 v59, v96, v19, s54
v_mfma_f32_16x16x32_bf16 v[172:175], a[232:235], a[60:63], v[172:175]
s_waitcnt lgkmcnt(4)
ds_read_b32 a68, v59
v_perm_b32 v58, v96, v19, s55
v_mfma_f32_16x16x32_bf16 v[176:179], a[236:239], a[48:51], v[176:179]
ds_read_b128 a[244:247], v15 offset:26624
buffer_load_dwordx4 v8, s[20:23], 0 offen offset:512 lds
v_mfma_f32_16x16x32_bf16 v[180:183], a[236:239], a[52:55], v[180:183]
ds_read_b32 a69, v58
v_perm_b32 v57, v100, v19, s54
v_mfma_f32_16x16x32_bf16 v[184:187], a[236:239], a[56:59], v[184:187]
ds_read_b32 a70, v57
v_perm_b32 v56, v100, v19, s55
v_mfma_f32_16x16x32_bf16 v[188:191], a[236:239], a[60:63], v[188:191]
s_waitcnt lgkmcnt(4)
ds_read_b32 a71, v56
buffer_load_dwordx4 v[36:39], v12, s[24:27], 0 offen offset:3072 sc1
v_mfma_f32_16x16x32_bf16 v[192:195], a[240:243], a[48:51], v[192:195]
s_waitcnt vmcnt(15)
s_barrier
ds_read_b128 a[248:251], v15 offset:28672
v_perm_b32 v63, v97, v19, s52
v_mfma_f32_16x16x32_bf16 v[196:199], a[240:243], a[52:55], v[196:199]
ds_read_b32 a72, v63
v_perm_b32 v62, v97, v19, s53
v_mfma_f32_16x16x32_bf16 v[200:203], a[240:243], a[56:59], v[200:203]
ds_read_b32 a73, v62
v_perm_b32 v61, v101, v19, s52
v_mfma_f32_16x16x32_bf16 v[204:207], a[240:243], a[60:63], v[204:207]
s_waitcnt lgkmcnt(4)
ds_read_b32 a74, v61
v_add_u32 v12, 16384, v13
v_mfma_f32_16x16x32_bf16 v[208:211], a[244:247], a[48:51], v[208:211]
ds_read_b128 a[252:255], v15 offset:30720
v_perm_b32 v60, v101, v19, s53
v_mfma_f32_16x16x32_bf16 v[212:215], a[244:247], a[52:55], v[212:215]
ds_read_b32 a75, v60
v_perm_b32 v59, v97, v19, s54
v_mfma_f32_16x16x32_bf16 v[216:219], a[244:247], a[56:59], v[216:219]
ds_read_b32 a76, v59
v_perm_b32 v58, v97, v19, s55
v_mfma_f32_16x16x32_bf16 v[220:223], a[244:247], a[60:63], v[220:223]
s_waitcnt lgkmcnt(4)
ds_read_b32 a77, v58
v_mfma_f32_16x16x32_bf16 v[224:227], a[248:251], a[48:51], v[224:227]
ds_read_b128 a[224:227], v14 offset:32768
v_perm_b32 v57, v101, v19, s54
v_mfma_f32_16x16x32_bf16 v[228:231], a[248:251], a[52:55], v[228:231]
ds_read_b32 a78, v57
v_perm_b32 v56, v101, v19, s55
v_mfma_f32_16x16x32_bf16 v[232:235], a[248:251], a[56:59], v[232:235]
s_add_u32 m0, s33, 134656
ds_read_b32 a79, v56
v_mfma_f32_16x16x32_bf16 v[236:239], a[248:251], a[60:63], v[236:239]
s_waitcnt lgkmcnt(4)
v_mfma_f32_16x16x32_bf16 v[240:243], a[252:255], a[48:51], v[240:243]
ds_read_b128 a[228:231], v14 offset:34816
buffer_load_dwordx4 v9, s[20:23], 0 offen offset:512 lds
v_mfma_f32_16x16x32_bf16 v[244:247], a[252:255], a[52:55], v[244:247]
v_mfma_f32_16x16x32_bf16 v[248:251], a[252:255], a[56:59], v[248:251]
v_mfma_f32_16x16x32_bf16 v[252:255], a[252:255], a[60:63], v[252:255]
s_waitcnt vmcnt(13) lgkmcnt(1)
v_cmp_ne_u64 s[50:51], s[88:89], v[82:83]
v_cmp_ne_u64 s[44:45], s[88:89], v[86:87]
v_mfma_f32_16x16x32_bf16 v[128:131], a[224:227], a[64:67], v[128:131]
ds_read_b128 a[232:235], v14 offset:36864
v_mfma_f32_16x16x32_bf16 v[132:135], a[224:227], a[68:71], v[132:135]
s_or_b64 s[50:51], s[44:45], s[50:51]
v_mfma_f32_16x16x32_bf16 v[136:139], a[224:227], a[72:75], v[136:139]
s_cbranch_scc1 L_SLOW5
L_BACK5:
v_mfma_f32_16x16x32_bf16 v[140:143], a[224:227], a[76:79], v[140:143]
s_waitcnt lgkmcnt(1)
v_mfma_f32_16x16x32_bf16 v[144:147], a[228:231], a[64:67], v[144:147]
ds_read_b128 a[236:239], v14 offset:38912
v_mfma_f32_16x16x32_bf16 v[148:151], a[228:231], a[68:71], v[148:151]
v_perm_b32 v63, v80, v19, s52
v_mfma_f32_16x16x32_bf16 v[152:155], a[228:231], a[72:75], v[152:155]
s_add_u32 m0, s33, 138752
ds_read_b32 a80, v63
v_perm_b32 v62, v80, v19, s53
v_mfma_f32_16x16x32_bf16 v[156:159], a[228:231], a[76:79], v[156:159]
s_waitcnt lgkmcnt(2)
ds_read_b32 a81, v62
v_perm_b32 v61, v84, v19, s52
v_mfma_f32_16x16x32_bf16 v[160:163], a[232:235], a[64:67], v[160:163]
ds_read_b128 a[240:243], v14 offset:40960
buffer_load_dwordx4 v10, s[20:23], 0 offen offset:512 lds
v_mfma_f32_16x16x32_bf16 v[164:167], a[232:235], a[68:71], v[164:167]
ds_read_b32 a82, v61
v_perm_b32 v60, v84, v19, s53
v_mfma_f32_16x16x32_bf16 v[168:171], a[232:235], a[72:75], v[168:171]
ds_read_b32 a83, v60
v_perm_b32 v59, v80, v19, s54
v_mfma_f32_16x16x32_bf16 v[172:175], a[232:235], a[76:79], v[172:175]
s_waitcnt lgkmcnt(4)
ds_read_b32 a84, v59
buffer_load_dwordx4 v[40:43], v12, s[24:27], 0 offen offset:0 sc1
v_mfma_f32_16x16x32_bf16 v[176:179], a[236:239], a[64:67], v[176:179]
ds_read_b128 a[244:247], v14 offset:43008
v_perm_b32 v58, v80, v19, s55
v_mfma_f32_16x16x32_bf16 v[180:183], a[236:239], a[68:71], v[180:183]
ds_read_b32 a85, v58
v_perm_b32 v57, v84, v19, s54
v_mfma_f32_16x16x32_bf16 v[184:187], a[236:239], a[72:75], v[184:187]
ds_read_b32 a86, v57
v_perm_b32 v56, v84, v19, s55
v_mfma_f32_16x16x32_bf16 v[188:191], a[236:239], a[76:79], v[188:191]
s_waitcnt lgkmcnt(4)
ds_read_b32 a87, v56
buffer_load_dwordx4 v[44:47], v12, s[24:27], 0 offen offset:1024 sc1
v_mfma_f32_16x16x32_bf16 v[192:195], a[240:243], a[64:67], v[192:195]
ds_read_b128 a[248:251], v14 offset:45056
v_perm_b32 v63, v81, v19, s52
v_mfma_f32_16x16x32_bf16 v[196:199], a[240:243], a[68:71], v[196:199]
ds_read_b32 a88, v63
v_perm_b32 v62, v81, v19, s53
v_mfma_f32_16x16x32_bf16 v[200:203], a[240:243], a[72:75], v[200:203]
s_add_u32 m0, s33, 142848
ds_read_b32 a89, v62
v_perm_b32 v61, v85, v19, s52
v_mfma_f32_16x16x32_bf16 v[204:207], a[240:243], a[76:79], v[204:207]
s_waitcnt lgkmcnt(4)
ds_read_b32 a90, v61
v_perm_b32 v60, v85, v19, s53
v_mfma_f32_16x16x32_bf16 v[208:211], a[244:247], a[64:67], v[208:211]
ds_read_b128 a[252:255], v14 offset:47104
buffer_load_dwordx4 v11, s[20:23], 0 offen offset:512 lds
v_mfma_f32_16x16x32_bf16 v[212:215], a[244:247], a[68:71], v[212:215]
ds_read_b32 a91, v60
v_perm_b32 v59, v81, v19, s54
v_mfma_f32_16x16x32_bf16 v[216:219], a[244:247], a[72:75], v[216:219]
ds_read_b32 a92, v59
v_perm_b32 v58, v81, v19, s55
v_mfma_f32_16x16x32_bf16 v[220:223], a[244:247], a[76:79], v[220:223]
s_waitcnt lgkmcnt(4)
ds_read_b32 a93, v58
v_mfma_f32_16x16x32_bf16 v[224:227], a[248:251], a[64:67], v[224:227]
ds_read_b128 a[224:227], v15 offset:32768
v_perm_b32 v57, v85, v19, s54
v_mfma_f32_16x16x32_bf16 v[228:231], a[248:251], a[68:71], v[228:231]
ds_read_b32 a94, v57
v_perm_b32 v56, v85, v19, s55
v_mfma_f32_16x16x32_bf16 v[232:235], a[248:251], a[72:75], v[232:235]
ds_read_b32 a95, v56
v_mfma_f32_16x16x32_bf16 v[236:239], a[248:251], a[76:79], v[236:239]
s_waitcnt lgkmcnt(4)
v_mfma_f32_16x16x32_bf16 v[240:243], a[252:255], a[64:67], v[240:243]
ds_read_b128 a[228:231], v15 offset:34816
v_mfma_f32_16x16x32_bf16 v[244:247], a[252:255], a[68:71], v[244:247]
v_mfma_f32_16x16x32_bf16 v[248:251], a[252:255], a[72:75], v[248:251]
v_mfma_f32_16x16x32_bf16 v[252:255], a[252:255], a[76:79], v[252:255]
L_PAD1:
s_cbranch_vccnz L_PAD2
s_waitcnt vmcnt(12) lgkmcnt(1)
v_cmp_ne_u64 s[50:51], s[88:89], v[90:91]
v_cmp_ne_u64 s[44:45], s[88:89], v[94:95]
v_mfma_f32_16x16x32_bf16 v[128:131], a[224:227], a[80:83], v[128:131]
ds_read_b128 a[232:235], v15 offset:36864
v_mfma_f32_16x16x32_bf16 v[132:135], a[224:227], a[84:87], v[132:135]
s_or_b64 s[50:51], s[44:45], s[50:51]
v_mfma_f32_16x16x32_bf16 v[136:139], a[224:227], a[88:91], v[136:139]
s_cbranch_scc1 L_SLOW6
L_BACK6:
v_mfma_f32_16x16x32_bf16 v[140:143], a[224:227], a[92:95], v[140:143]
s_waitcnt lgkmcnt(1)
v_mfma_f32_16x16x32_bf16 v[144:147], a[228:231], a[80:83], v[144:147]
ds_read_b128 a[236:239], v15 offset:38912
v_perm_b32 v63, v88, v19, s52
v_mfma_f32_16x16x32_bf16 v[148:151], a[228:231], a[84:87], v[148:151]
ds_read_b32 a96, v63
v_perm_b32 v62, v88, v19, s53
v_mfma_f32_16x16x32_bf16 v[152:155], a[228:231], a[88:91], v[152:155]
ds_read_b32 a97, v62
v_perm_b32 v61, v92, v19, s52
v_mfma_f32_16x16x32_bf16 v[156:159], a[228:231], a[92:95], v[156:159]
s_waitcnt lgkmcnt(3)
ds_read_b32 a98, v61
v_mfma_f32_16x16x32_bf16 v[160:163], a[232:235], a[80:83], v[160:163]
ds_read_b128 a[240:243], v15 offset:40960
v_perm_b32 v60, v92, v19, s53
v_mfma_f32_16x16x32_bf16 v[164:167], a[232:235], a[84:87], v[164:167]
ds_read_b32 a99, v60
v_perm_b32 v59, v88, v19, s54
v_mfma_f32_16x16x32_bf16 v[168:171], a[232:235], a[88:91], v[168:171]
s_add_u32 m0, s33, 146816
ds_read_b32 a100, v59
v_perm_b32 v58, v88, v19, s55
v_mfma_f32_16x16x32_bf16 v[172:175], a[232:235], a[92:95], v[172:175]
s_waitcnt lgkmcnt(4)
ds_read_b32 a101, v58
v_perm_b32 v57, v92, v19, s54
v_mfma_f32_16x16x32_bf16 v[176:179], a[236:239], a[80:83], v[176:179]
ds_read_b128 a[244:247], v15 offset:43008
buffer_load_dwordx4 v8, s[20:23], 0 offen offset:640 lds
v_mfma_f32_16x16x32_bf16 v[180:183], a[236:239], a[84:87], v[180:183]
ds_read_b32 a102, v57
v_perm_b32 v56, v92, v19, s55
v_mfma_f32_16x16x32_bf16 v[184:187], a[236:239], a[88:91], v[184:187]
ds_read_b32 a103, v56
v_perm_b32 v63, v89, v19, s52
v_mfma_f32_16x16x32_bf16 v[188:191], a[236:239], a[92:95], v[188:191]
s_waitcnt lgkmcnt(4)
ds_read_b32 a104, v63
buffer_load_dwordx4 v[48:51], v12, s[24:27], 0 offen offset:2048 sc1
v_mfma_f32_16x16x32_bf16 v[192:195], a[240:243], a[80:83], v[192:195]
s_waitcnt vmcnt(12)
s_barrier
ds_read_b128 a[248:251], v15 offset:45056
buffer_load_dwordx4 v[52:55], v12, s[24:27], 0 offen offset:3072 sc1
v_mfma_f32_16x16x32_bf16 v[196:199], a[240:243], a[84:87], v[196:199]
s_waitcnt vmcnt(11)
v_perm_b32 v62, v89, v19, s53
v_lshl_add_u64 v[104:105], v[108:109], 4, v[104:105]
v_mfma_f32_16x16x32_bf16 v[200:203], a[240:243], a[88:91], v[200:203]
ds_read_b32 a105, v62
v_perm_b32 v61, v93, v19, s52
v_mfma_f32_16x16x32_bf16 v[204:207], a[240:243], a[92:95], v[204:207]
s_waitcnt lgkmcnt(3)
ds_read_b32 a106, v61
v_perm_b32 v60, v93, v19, s53
v_mfma_f32_16x16x32_bf16 v[208:211], a[244:247], a[80:83], v[208:211]
ds_read_b128 a[252:255], v15 offset:47104
v_lshl_add_u64 v[106:107], v[110:111], 4, v[106:107]
v_mfma_f32_16x16x32_bf16 v[212:215], a[244:247], a[84:87], v[212:215]
ds_read_b32 a107, v60
v_perm_b32 v59, v89, v19, s54
v_mfma_f32_16x16x32_bf16 v[216:219], a[244:247], a[88:91], v[216:219]
ds_read_b32 a108, v59
v_perm_b32 v58, v89, v19, s55
v_mfma_f32_16x16x32_bf16 v[220:223], a[244:247], a[92:95], v[220:223]
s_waitcnt lgkmcnt(4)
ds_read_b32 a109, v58
v_lshl_add_u64 v[112:113], v[116:117], 4, v[112:113]
v_mfma_f32_16x16x32_bf16 v[224:227], a[248:251], a[80:83], v[224:227]
ds_read_b128 a[224:227], v14 offset:49152
v_perm_b32 v57, v93, v19, s54
v_mfma_f32_16x16x32_bf16 v[228:231], a[248:251], a[84:87], v[228:231]
ds_read_b32 a110, v57
v_perm_b32 v56, v93, v19, s55
v_mfma_f32_16x16x32_bf16 v[232:235], a[248:251], a[88:91], v[232:235]
s_add_u32 m0, s33, 150912
ds_read_b32 a111, v56
v_lshl_add_u64 v[114:115], v[118:119], 4, v[114:115]
v_mfma_f32_16x16x32_bf16 v[236:239], a[248:251], a[92:95], v[236:239]
s_waitcnt vmcnt(8) lgkmcnt(4)
v_cmp_ne_u64 s[50:51], s[88:89], v[34:35]
v_cmp_ne_u64 s[44:45], s[88:89], v[38:39]
v_mfma_f32_16x16x32_bf16 v[240:243], a[252:255], a[80:83], v[240:243]
ds_read_b128 a[228:231], v14 offset:51200
buffer_load_dwordx4 v9, s[20:23], 0 offen offset:640 lds
v_mfma_f32_16x16x32_bf16 v[244:247], a[252:255], a[84:87], v[244:247]
s_or_b64 s[50:51], s[44:45], s[50:51]
v_lshl_or_b32 v116, v112, 8, v104
v_add_u32 v12, 20480, v13
v_mfma_f32_16x16x32_bf16 v[248:251], a[252:255], a[88:91], v[248:251]
s_cbranch_scc1 L_SLOW7
L_BACK7:
v_mfma_f32_16x16x32_bf16 v[252:255], a[252:255], a[92:95], v[252:255]
s_waitcnt lgkmcnt(1)
v_mfma_f32_16x16x32_bf16 v[128:131], a[224:227], a[96:99], v[128:131]
ds_read_b128 a[232:235], v14 offset:53248
v_lshl_or_b32 v117, v113, 8, v105
v_mfma_f32_16x16x32_bf16 v[132:135], a[224:227], a[100:103], v[132:135]
v_perm_b32 v63, v32, v19, s52
v_mfma_f32_16x16x32_bf16 v[136:139], a[224:227], a[104:107], v[136:139]
ds_read_b32 a112, v63
v_perm_b32 v62, v32, v19, s53
v_mfma_f32_16x16x32_bf16 v[140:143], a[224:227], a[108:111], v[140:143]
s_waitcnt lgkmcnt(2)
ds_read_b32 a113, v62
v_lshl_or_b32 v118, v114, 8, v106
v_mfma_f32_16x16x32_bf16 v[144:147], a[228:231], a[96:99], v[144:147]
ds_read_b128 a[236:239], v14 offset:55296
v_perm_b32 v61, v36, v19, s52
v_mfma_f32_16x16x32_bf16 v[148:151], a[228:231], a[100:103], v[148:151]
ds_read_b32 a114, v61
v_mfma_f32_16x16x32_bf16 v[152:155], a[228:231], a[104:107], v[152:155]
s_add_u32 m0, s33, 155008
v_perm_b32 v60, v36, v19, s53
v_lshl_or_b32 v119, v115, 8, v107
v_mfma_f32_16x16x32_bf16 v[156:159], a[228:231], a[108:111], v[156:159]
s_waitcnt lgkmcnt(3)
ds_read_b32 a115, v60
v_mfma_f32_16x16x32_bf16 v[160:163], a[232:235], a[96:99], v[160:163]
ds_read_b128 a[240:243], v14 offset:57344
buffer_load_dwordx4 v10, s[20:23], 0 offen offset:640 lds
v_mfma_f32_16x16x32_bf16 v[164:167], a[232:235], a[100:103], v[164:167]
v_perm_b32 v59, v32, v19, s54
v_lshl_or_b32 v108, v117, 16, v116
v_mfma_f32_16x16x32_bf16 v[168:171], a[232:235], a[104:107], v[168:171]
ds_read_b32 a116, v59
v_perm_b32 v58, v32, v19, s55
v_mfma_f32_16x16x32_bf16 v[172:175], a[232:235], a[108:111], v[172:175]
s_waitcnt lgkmcnt(3)
ds_read_b32 a117, v58
v_perm_b32 v57, v36, v19, s54
v_mfma_f32_16x16x32_bf16 v[176:179], a[236:239], a[96:99], v[176:179]
ds_read_b128 a[244:247], v14 offset:59392
v_lshl_or_b32 v109, v119, 16, v118
v_mfma_f32_16x16x32_bf16 v[180:183], a[236:239], a[100:103], v[180:183]
ds_read_b32 a118, v57
v_perm_b32 v56, v36, v19, s55
v_mfma_f32_16x16x32_bf16 v[184:187], a[236:239], a[104:107], v[184:187]
ds_read_b32 a119, v56
v_perm_b32 v63, v33, v19, s52
v_mfma_f32_16x16x32_bf16 v[188:191], a[236:239], a[108:111], v[188:191]
s_waitcnt lgkmcnt(4)
ds_read_b32 a120, v63
v_mov_b64 v[110:111], s[88:89]
v_mfma_f32_16x16x32_bf16 v[192:195], a[240:243], a[96:99], v[192:195]
ds_read_b128 a[248:251], v14 offset:61440
v_perm_b32 v62, v33, v19, s53
v_mfma_f32_16x16x32_bf16 v[196:199], a[240:243], a[100:103], v[196:199]
ds_read_b32 a121, v62
v_perm_b32 v61, v37, v19, s52
v_mfma_f32_16x16x32_bf16 v[200:203], a[240:243], a[104:107], v[200:203]
s_add_u32 m0, s33, 159104
ds_read_b32 a122, v61
v_perm_b32 v60, v37, v19, s53
v_mfma_f32_16x16x32_bf16 v[204:207], a[240:243], a[108:111], v[204:207]
s_waitcnt lgkmcnt(4)
ds_read_b32 a123, v60
v_perm_b32 v59, v33, v19, s54
v_mfma_f32_16x16x32_bf16 v[208:211], a[244:247], a[96:99], v[208:211]
ds_read_b128 a[252:255], v14 offset:63488
buffer_load_dwordx4 v11, s[20:23], 0 offen offset:640 lds
v_mfma_f32_16x16x32_bf16 v[212:215], a[244:247], a[100:103], v[212:215]
buffer_store_dwordx4 v[108:111], v13, s[76:79], 0 offen sc1
v_mfma_f32_16x16x32_bf16 v[216:219], a[244:247], a[104:107], v[216:219]
ds_read_b32 a124, v59
v_perm_b32 v58, v33, v19, s55
v_mfma_f32_16x16x32_bf16 v[220:223], a[244:247], a[108:111], v[220:223]
s_waitcnt lgkmcnt(3)
ds_read_b32 a125, v58
buffer_load_dwordx4 v[96:99], v12, s[24:27], 0 offen offset:0 sc1
v_mfma_f32_16x16x32_bf16 v[224:227], a[248:251], a[96:99], v[224:227]
ds_read_b128 a[224:227], v15 offset:49152
v_perm_b32 v57, v37, v19, s54
v_mfma_f32_16x16x32_bf16 v[228:231], a[248:251], a[100:103], v[228:231]
ds_read_b32 a126, v57
v_perm_b32 v56, v37, v19, s55
v_mfma_f32_16x16x32_bf16 v[232:235], a[248:251], a[104:107], v[232:235]
ds_read_b32 a127, v56
buffer_load_dwordx4 v[100:103], v12, s[24:27], 0 offen offset:1024 sc1
v_mfma_f32_16x16x32_bf16 v[236:239], a[248:251], a[108:111], v[236:239]
s_waitcnt lgkmcnt(4)
v_mfma_f32_16x16x32_bf16 v[240:243], a[252:255], a[96:99], v[240:243]
ds_read_b128 a[228:231], v15 offset:51200
v_mfma_f32_16x16x32_bf16 v[244:247], a[252:255], a[100:103], v[244:247]
v_mfma_f32_16x16x32_bf16 v[248:251], a[252:255], a[104:107], v[248:251]
v_mfma_f32_16x16x32_bf16 v[252:255], a[252:255], a[108:111], v[252:255]
s_waitcnt vmcnt(10) lgkmcnt(1)
v_cmp_ne_u64 s[50:51], s[88:89], v[42:43]
v_cmp_ne_u64 s[44:45], s[88:89], v[46:47]
v_mfma_f32_16x16x32_bf16 v[128:131], a[224:227], a[112:115], v[128:131]
ds_read_b128 a[232:235], v15 offset:53248
v_mfma_f32_16x16x32_bf16 v[132:135], a[224:227], a[116:119], v[132:135]
s_or_b64 s[50:51], s[44:45], s[50:51]
v_mfma_f32_16x16x32_bf16 v[136:139], a[224:227], a[120:123], v[136:139]
s_cbranch_scc1 L_SLOW8
L_BACK8:
v_mfma_f32_16x16x32_bf16 v[140:143], a[224:227], a[124:127], v[140:143]
s_waitcnt lgkmcnt(1)
v_mfma_f32_16x16x32_bf16 v[144:147], a[228:231], a[112:115], v[144:147]
ds_read_b128 a[236:239], v15 offset:55296
v_mfma_f32_16x16x32_bf16 v[148:151], a[228:231], a[116:119], v[148:151]
v_perm_b32 v63, v40, v19, s52
v_mfma_f32_16x16x32_bf16 v[152:155], a[228:231], a[120:123], v[152:155]
ds_read_b32 a128, v63
v_perm_b32 v62, v40, v19, s53
v_mfma_f32_16x16x32_bf16 v[156:159], a[228:231], a[124:127], v[156:159]
s_waitcnt lgkmcnt(2)
ds_read_b32 a129, v62
v_mfma_f32_16x16x32_bf16 v[160:163], a[232:235], a[112:115], v[160:163]
ds_read_b128 a[240:243], v15 offset:57344
v_perm_b32 v61, v44, v19, s52
v_mfma_f32_16x16x32_bf16 v[164:167], a[232:235], a[116:119], v[164:167]
ds_read_b32 a130, v61
v_perm_b32 v60, v44, v19, s53
v_mfma_f32_16x16x32_bf16 v[168:171], a[232:235], a[120:123], v[168:171]
s_add_u32 m0, s33, 64768
ds_read_b32 a131, v60
v_perm_b32 v59, v40, v19, s54
v_mfma_f32_16x16x32_bf16 v[172:175], a[232:235], a[124:127], v[172:175]
s_waitcnt lgkmcnt(4)
ds_read_b32 a132, v59
v_perm_b32 v58, v40, v19, s55
v_mfma_f32_16x16x32_bf16 v[176:179], a[236:239], a[112:115], v[176:179]
ds_read_b128 a[244:247], v15 offset:59392
buffer_load_dwordx4 v8, s[20:23], 0 offen offset:768 lds
v_mfma_f32_16x16x32_bf16 v[180:183], a[236:239], a[116:119], v[180:183]
ds_read_b32 a133, v58
v_perm_b32 v57, v44, v19, s54
v_mfma_f32_16x16x32_bf16 v[184:187], a[236:239], a[120:123], v[184:187]
ds_read_b32 a134, v57
v_perm_b32 v56, v44, v19, s55
v_mfma_f32_16x16x32_bf16 v[188:191], a[236:239], a[124:127], v[188:191]
s_waitcnt lgkmcnt(4)
ds_read_b32 a135, v56
buffer_load_dwordx4 v[80:83], v12, s[24:27], 0 offen offset:2048 sc1
v_mfma_f32_16x16x32_bf16 v[192:195], a[240:243], a[112:115], v[192:195]
s_waitcnt vmcnt(11)
s_barrier
ds_read_b128 a[248:251], v15 offset:61440
v_perm_b32 v63, v41, v19, s52
v_mfma_f32_16x16x32_bf16 v[196:199], a[240:243], a[116:119], v[196:199]
ds_read_b32 a136, v63
v_perm_b32 v62, v41, v19, s53
v_mfma_f32_16x16x32_bf16 v[200:203], a[240:243], a[120:123], v[200:203]
ds_read_b32 a137, v62
v_perm_b32 v61, v45, v19, s52
v_mfma_f32_16x16x32_bf16 v[204:207], a[240:243], a[124:127], v[204:207]
s_waitcnt lgkmcnt(4)
ds_read_b32 a138, v61
buffer_load_dwordx4 v[84:87], v12, s[24:27], 0 offen offset:3072 sc1
v_mfma_f32_16x16x32_bf16 v[208:211], a[244:247], a[112:115], v[208:211]
ds_read_b128 a[252:255], v15 offset:63488
v_perm_b32 v60, v45, v19, s53
v_mfma_f32_16x16x32_bf16 v[212:215], a[244:247], a[116:119], v[212:215]
ds_read_b32 a139, v60
v_perm_b32 v59, v41, v19, s54
v_mfma_f32_16x16x32_bf16 v[216:219], a[244:247], a[120:123], v[216:219]
ds_read_b32 a140, v59
v_perm_b32 v58, v41, v19, s55
v_mfma_f32_16x16x32_bf16 v[220:223], a[244:247], a[124:127], v[220:223]
s_waitcnt lgkmcnt(4)
ds_read_b32 a141, v58
v_add_u32 v12, 24576, v13
v_mfma_f32_16x16x32_bf16 v[224:227], a[248:251], a[112:115], v[224:227]
ds_read_b128 a[224:227], v16 offset:0
v_perm_b32 v57, v45, v19, s54
v_mfma_f32_16x16x32_bf16 v[228:231], a[248:251], a[116:119], v[228:231]
ds_read_b32 a142, v57
v_perm_b32 v56, v45, v19, s55
v_mfma_f32_16x16x32_bf16 v[232:235], a[248:251], a[120:123], v[232:235]
s_add_u32 m0, s33, 68864
ds_read_b32 a143, v56
v_mfma_f32_16x16x32_bf16 v[236:239], a[248:251], a[124:127], v[236:239]
s_waitcnt lgkmcnt(4)
v_mfma_f32_16x16x32_bf16 v[240:243], a[252:255], a[112:115], v[240:243]
ds_read_b128 a[228:231], v16 offset:2048
buffer_load_dwordx4 v9, s[20:23], 0 offen offset:768 lds
v_mfma_f32_16x16x32_bf16 v[244:247], a[252:255], a[116:119], v[244:247]
v_mfma_f32_16x16x32_bf16 v[248:251], a[252:255], a[120:123], v[248:251]
v_mfma_f32_16x16x32_bf16 v[252:255], a[252:255], a[124:127], v[252:255]
s_waitcnt vmcnt(10) lgkmcnt(1)
v_cmp_ne_u64 s[50:51], s[88:89], v[50:51]
v_cmp_ne_u64 s[44:45], s[88:89], v[54:55]
v_mfma_f32_16x16x32_bf16 v[128:131], a[224:227], a[128:131], v[128:131]
ds_read_b128 a[232:235], v16 offset:4096
v_mfma_f32_16x16x32_bf16 v[132:135], a[224:227], a[132:135], v[132:135]
s_or_b64 s[50:51], s[44:45], s[50:51]
v_mfma_f32_16x16x32_bf16 v[136:139], a[224:227], a[136:139], v[136:139]
s_cbranch_scc1 L_SLOW9
L_BACK9:
v_mfma_f32_16x16x32_bf16 v[140:143], a[224:227], a[140:143], v[140:143]
s_waitcnt lgkmcnt(1)
v_mfma_f32_16x16x32_bf16 v[144:147], a[228:231], a[128:131], v[144:147]
ds_read_b128 a[236:239], v16 offset:6144
v_mfma_f32_16x16x32_bf16 v[148:151], a[228:231], a[132:135], v[148:151]
v_perm_b32 v63, v48, v19, s52
v_mfma_f32_16x16x32_bf16 v[152:155], a[228:231], a[136:139], v[152:155]
s_add_u32 m0, s33, 72960
ds_read_b32 a144, v63
v_perm_b32 v62, v48, v19, s53
v_mfma_f32_16x16x32_bf16 v[156:159], a[228:231], a[140:143], v[156:159]
s_waitcnt lgkmcnt(2)
ds_read_b32 a145, v62
v_perm_b32 v61, v52, v19, s52
v_mfma_f32_16x16x32_bf16 v[160:163], a[232:235], a[128:131], v[160:163]
ds_read_b128 a[240:243], v16 offset:8192
buffer_load_dwordx4 v10, s[20:23], 0 offen offset:768 lds
v_mfma_f32_16x16x32_bf16 v[164:167], a[232:235], a[132:135], v[164:167]
ds_read_b32 a146, v61
v_perm_b32 v60, v52, v19, s53
v_mfma_f32_16x16x32_bf16 v[168:171], a[232:235], a[136:139], v[168:171]
ds_read_b32 a147, v60
v_perm_b32 v59, v48, v19, s54
v_mfma_f32_16x16x32_bf16 v[172:175], a[232:235], a[140:143], v[172:175]
s_waitcnt lgkmcnt(4)
ds_read_b32 a148, v59
buffer_load_dwordx4 v[88:91], v12, s[24:27], 0 offen offset:0 sc1
v_mfma_f32_16x16x32_bf16 v[176:179], a[236:239], a[128:131], v[176:179]
ds_read_b128 a[244:247], v16 offset:10240
v_perm_b32 v58, v48, v19, s55
v_mfma_f32_16x16x32_bf16 v[180:183], a[236:239], a[132:135], v[180:183]
ds_read_b32 a149, v58
v_perm_b32 v57, v52, v19, s54
v_mfma_f32_16x16x32_bf16 v[184:187], a[236:239], a[136:139], v[184:187]
ds_read_b32 a150, v57
v_perm_b32 v56, v52, v19, s55
v_mfma_f32_16x16x32_bf16 v[188:191], a[236:239], a[140:143], v[188:191]
s_waitcnt lgkmcnt(4)
ds_read_b32 a151, v56
buffer_load_dwordx4 v[92:95], v12, s[24:27], 0 offen offset:1024 sc1
v_mfma_f32_16x16x32_bf16 v[192:195], a[240:243], a[128:131], v[192:195]
ds_read_b128 a[248:251], v16 offset:12288
v_perm_b32 v63, v49, v19, s52
v_mfma_f32_16x16x32_bf16 v[196:199], a[240:243], a[132:135], v[196:199]
ds_read_b32 a152, v63
v_perm_b32 v62, v49, v19, s53
v_mfma_f32_16x16x32_bf16 v[200:203], a[240:243], a[136:139], v[200:203]
s_add_u32 m0, s33, 77056
ds_read_b32 a153, v62
v_perm_b32 v61, v53, v19, s52
v_mfma_f32_16x16x32_bf16 v[204:207], a[240:243], a[140:143], v[204:207]
s_waitcnt lgkmcnt(4)
ds_read_b32 a154, v61
v_perm_b32 v60, v53, v19, s53
v_mfma_f32_16x16x32_bf16 v[208:211], a[244:247], a[128:131], v[208:211]
ds_read_b128 a[252:255], v16 offset:14336
buffer_load_dwordx4 v11, s[20:23], 0 offen offset:768 lds
v_mfma_f32_16x16x32_bf16 v[212:215], a[244:247], a[132:135], v[212:215]
ds_read_b32 a155, v60
v_perm_b32 v59, v49, v19, s54
v_mfma_f32_16x16x32_bf16 v[216:219], a[244:247], a[136:139], v[216:219]
ds_read_b32 a156, v59
v_perm_b32 v58, v49, v19, s55
v_mfma_f32_16x16x32_bf16 v[220:223], a[244:247], a[140:143], v[220:223]
s_waitcnt lgkmcnt(4)
ds_read_b32 a157, v58
v_mfma_f32_16x16x32_bf16 v[224:227], a[248:251], a[128:131], v[224:227]
ds_read_b128 a[224:227], v17 offset:0
v_perm_b32 v57, v53, v19, s54
v_mfma_f32_16x16x32_bf16 v[228:231], a[248:251], a[132:135], v[228:231]
ds_read_b32 a158, v57
v_perm_b32 v56, v53, v19, s55
v_mfma_f32_16x16x32_bf16 v[232:235], a[248:251], a[136:139], v[232:235]
ds_read_b32 a159, v56
v_mfma_f32_16x16x32_bf16 v[236:239], a[248:251], a[140:143], v[236:239]
s_waitcnt lgkmcnt(4)
v_mfma_f32_16x16x32_bf16 v[240:243], a[252:255], a[128:131], v[240:243]
ds_read_b128 a[228:231], v17 offset:2048
v_mfma_f32_16x16x32_bf16 v[244:247], a[252:255], a[132:135], v[244:247]
v_mfma_f32_16x16x32_bf16 v[248:251], a[252:255], a[136:139], v[248:251]
v_mfma_f32_16x16x32_bf16 v[252:255], a[252:255], a[140:143], v[252:255]
s_waitcnt vmcnt(8) lgkmcnt(1)
v_cmp_ne_u64 s[50:51], s[88:89], v[98:99]
v_cmp_ne_u64 s[44:45], s[88:89], v[102:103]
v_mfma_f32_16x16x32_bf16 v[128:131], a[224:227], a[144:147], v[128:131]
ds_read_b128 a[232:235], v17 offset:4096
v_mfma_f32_16x16x32_bf16 v[132:135], a[224:227], a[148:151], v[132:135]
s_or_b64 s[50:51], s[44:45], s[50:51]
v_mfma_f32_16x16x32_bf16 v[136:139], a[224:227], a[152:155], v[136:139]
s_cbranch_scc1 L_SLOW10
L_BACK10:
v_mfma_f32_16x16x32_bf16 v[140:143], a[224:227], a[156:159], v[140:143]
s_waitcnt lgkmcnt(1)
v_mfma_f32_16x16x32_bf16 v[144:147], a[228:231], a[144:147], v[144:147]
ds_read_b128 a[236:239], v17 offset:6144
v_mfma_f32_16x16x32_bf16 v[148:151], a[228:231], a[148:151], v[148:151]
v_perm_b32 v63, v96, v19, s52
v_mfma_f32_16x16x32_bf16 v[152:155], a[228:231], a[152:155], v[152:155]
ds_read_b32 a160, v63
v_perm_b32 v62, v96, v19, s53
v_mfma_f32_16x16x32_bf16 v[156:159], a[228:231], a[156:159], v[156:159]
s_waitcnt lgkmcnt(2)
ds_read_b32 a161, v62
v_mfma_f32_16x16x32_bf16 v[160:163], a[232:235], a[144:147], v[160:163]
ds_read_b128 a[240:243], v17 offset:8192
v_perm_b32 v61, v100, v19, s52
v_mfma_f32_16x16x32_bf16 v[164:167], a[232:235], a[148:151], v[164:167]
ds_read_b32 a162, v61
v_perm_b32 v60, v100, v19, s53
v_mfma_f32_16x16x32_bf16 v[168:171], a[232:235], a[152:155], v[168:171]
s_add_u32 m0, s33, 81024
ds_read_b32 a163, v60
v_perm_b32 v59, v96, v19, s54
v_mfma_f32_16x16x32_bf16 v[172:175], a[232:235], a[156:159], v[172:175]
s_waitcnt lgkmcnt(4)
ds_read_b32 a164, v59
v_perm_b32 v58, v96, v19, s55
v_mfma_f32_16x16x32_bf16 v[176:179], a[236:239], a[144:147], v[176:179]
ds_read_b128 a[244:247], v17 offset:10240
buffer_load_dwordx4 v8, s[20:23], 0 offen offset:896 lds
v_mfma_f32_16x16x32_bf16 v[180:183], a[236:239], a[148:151], v[180:183]
ds_read_b32 a165, v58
v_perm_b32 v57, v100, v19, s54
v_mfma_f32_16x16x32_bf16 v[184:187], a[236:239], a[152:155], v[184:187]
ds_read_b32 a166, v57
v_perm_b32 v56, v100, v19, s55
v_mfma_f32_16x16x32_bf16 v[188:191], a[236:239], a[156:159], v[188:191]
s_waitcnt lgkmcnt(4)
ds_read_b32 a167, v56
buffer_load_dwordx4 v[32:35], v12, s[24:27], 0 offen offset:2048 sc1
v_mfma_f32_16x16x32_bf16 v[192:195], a[240:243], a[144:147], v[192:195]
s_barrier
ds_read_b128 a[248:251], v17 offset:12288
v_perm_b32 v63, v97, v19, s52
v_mfma_f32_16x16x32_bf16 v[196:199], a[240:243], a[148:151], v[196:199]
ds_read_b32 a168, v63
v_perm_b32 v62, v97, v19, s53
v_mfma_f32_16x16x32_bf16 v[200:203], a[240:243], a[152:155], v[200:203]
ds_read_b32 a169, v62
v_perm_b32 v61, v101, v19, s52
v_mfma_f32_16x16x32_bf16 v[204:207], a[240:243], a[156:159], v[204:207]
s_waitcnt lgkmcnt(4)
ds_read_b32 a170, v61
buffer_load_dwordx4 v[36:39], v12, s[24:27], 0 offen offset:3072 sc1
v_mfma_f32_16x16x32_bf16 v[208:211], a[244:247], a[144:147], v[208:211]
ds_read_b128 a[252:255], v17 offset:14336
v_perm_b32 v60, v101, v19, s53
v_mfma_f32_16x16x32_bf16 v[212:215], a[244:247], a[148:151], v[212:215]
ds_read_b32 a171, v60
v_perm_b32 v59, v97, v19, s54
v_mfma_f32_16x16x32_bf16 v[216:219], a[244:247], a[152:155], v[216:219]
ds_read_b32 a172, v59
v_perm_b32 v58, v97, v19, s55
v_mfma_f32_16x16x32_bf16 v[220:223], a[244:247], a[156:159], v[220:223]
s_waitcnt lgkmcnt(4)
ds_read_b32 a173, v58
v_add_u32 v12, 28672, v13
v_mfma_f32_16x16x32_bf16 v[224:227], a[248:251], a[144:147], v[224:227]
ds_read_b128 a[224:227], v16 offset:16384
v_perm_b32 v57, v101, v19, s54
v_mfma_f32_16x16x32_bf16 v[228:231], a[248:251], a[148:151], v[228:231]
ds_read_b32 a174, v57
v_perm_b32 v56, v101, v19, s55
v_mfma_f32_16x16x32_bf16 v[232:235], a[248:251], a[152:155], v[232:235]
s_add_u32 m0, s33, 85120
ds_read_b32 a175, v56
v_mfma_f32_16x16x32_bf16 v[236:239], a[248:251], a[156:159], v[236:239]
s_waitcnt lgkmcnt(4)
v_mfma_f32_16x16x32_bf16 v[240:243], a[252:255], a[144:147], v[240:243]
ds_read_b128 a[228:231], v16 offset:18432
buffer_load_dwordx4 v9, s[20:23], 0 offen offset:896 lds
v_mfma_f32_16x16x32_bf16 v[244:247], a[252:255], a[148:151], v[244:247]
v_mfma_f32_16x16x32_bf16 v[248:251], a[252:255], a[152:155], v[248:251]
v_mfma_f32_16x16x32_bf16 v[252:255], a[252:255], a[156:159], v[252:255]
s_waitcnt vmcnt(9) lgkmcnt(1)
v_cmp_ne_u64 s[50:51], s[88:89], v[82:83]
v_cmp_ne_u64 s[44:45], s[88:89], v[86:87]
v_mfma_f32_16x16x32_bf16 v[128:131], a[224:227], a[160:163], v[128:131]
ds_read_b128 a[232:235], v16 offset:20480
v_mfma_f32_16x16x32_bf16 v[132:135], a[224:227], a[164:167], v[132:135]
s_or_b64 s[50:51], s[44:45], s[50:51]
v_mfma_f32_16x16x32_bf16 v[136:139], a[224:227], a[168:171], v[136:139]
s_cbranch_scc1 L_SLOW11
L_BACK11:
v_mfma_f32_16x16x32_bf16 v[140:143], a[224:227], a[172:175], v[140:143]
s_waitcnt lgkmcnt(1)
v_mfma_f32_16x16x32_bf16 v[144:147], a[228:231], a[160:163], v[144:147]
ds_read_b128 a[236:239], v16 offset:22528
v_mfma_f32_16x16x32_bf16 v[148:151], a[228:231], a[164:167], v[148:151]
v_perm_b32 v63, v80, v19, s52
v_mfma_f32_16x16x32_bf16 v[152:155], a[228:231], a[168:171], v[152:155]
s_add_u32 m0, s33, 89216
ds_read_b32 a176, v63
v_perm_b32 v62, v80, v19, s53
v_mfma_f32_16x16x32_bf16 v[156:159], a[228:231], a[172:175], v[156:159]
s_waitcnt lgkmcnt(2)
ds_read_b32 a177, v62
v_perm_b32 v61, v84, v19, s52
v_mfma_f32_16x16x32_bf16 v[160:163], a[232:235], a[160:163], v[160:163]
ds_read_b128 a[240:243], v16 offset:24576
buffer_load_dwordx4 v10, s[20:23], 0 offen offset:896 lds
v_mfma_f32_16x16x32_bf16 v[164:167], a[232:235], a[164:167], v[164:167]
ds_read_b32 a178, v61
v_perm_b32 v60, v84, v19, s53
v_mfma_f32_16x16x32_bf16 v[168:171], a[232:235], a[168:171], v[168:171]
ds_read_b32 a179, v60
v_perm_b32 v59, v80, v19, s54
v_mfma_f32_16x16x32_bf16 v[172:175], a[232:235], a[172:175], v[172:175]
s_waitcnt lgkmcnt(4)
ds_read_b32 a180, v59
buffer_load_dwordx4 v[40:43], v12, s[24:27], 0 offen offset:0 sc1
v_mfma_f32_16x16x32_bf16 v[176:179], a[236:239], a[160:163], v[176:179]
ds_read_b128 a[244:247], v16 offset:26624
v_perm_b32 v58, v80, v19, s55
v_mfma_f32_16x16x32_bf16 v[180:183], a[236:239], a[164:167], v[180:183]
ds_read_b32 a181, v58
v_perm_b32 v57, v84, v19, s54
v_mfma_f32_16x16x32_bf16 v[184:187], a[236:239], a[168:171], v[184:187]
ds_read_b32 a182, v57
v_perm_b32 v56, v84, v19, s55
v_mfma_f32_16x16x32_bf16 v[188:191], a[236:239], a[172:175], v[188:191]
s_waitcnt lgkmcnt(4)
ds_read_b32 a183, v56
buffer_load_dwordx4 v[44:47], v12, s[24:27], 0 offen offset:1024 sc1
v_mfma_f32_16x16x32_bf16 v[192:195], a[240:243], a[160:163], v[192:195]
ds_read_b128 a[248:251], v16 offset:28672
v_perm_b32 v63, v81, v19, s52
v_mfma_f32_16x16x32_bf16 v[196:199], a[240:243], a[164:167], v[196:199]
ds_read_b32 a184, v63
v_perm_b32 v62, v81, v19, s53
v_mfma_f32_16x16x32_bf16 v[200:203], a[240:243], a[168:171], v[200:203]
s_add_u32 m0, s33, 93312
ds_read_b32 a185, v62
v_perm_b32 v61, v85, v19, s52
v_mfma_f32_16x16x32_bf16 v[204:207], a[240:243], a[172:175], v[204:207]
s_waitcnt lgkmcnt(4)
ds_read_b32 a186, v61
v_perm_b32 v60, v85, v19, s53
v_mfma_f32_16x16x32_bf16 v[208:211], a[244:247], a[160:163], v[208:211]
ds_read_b128 a[252:255], v16 offset:30720
buffer_load_dwordx4 v11, s[20:23], 0 offen offset:896 lds
v_mfma_f32_16x16x32_bf16 v[212:215], a[244:247], a[164:167], v[212:215]
ds_read_b32 a187, v60
v_perm_b32 v59, v81, v19, s54
v_mfma_f32_16x16x32_bf16 v[216:219], a[244:247], a[168:171], v[216:219]
ds_read_b32 a188, v59
v_perm_b32 v58, v81, v19, s55
v_mfma_f32_16x16x32_bf16 v[220:223], a[244:247], a[172:175], v[220:223]
L_PAD2:
s_cbranch_vccnz L_PADRET
s_waitcnt lgkmcnt(4)
ds_read_b32 a189, v58
v_mfma_f32_16x16x32_bf16 v[224:227], a[248:251], a[160:163], v[224:227]
ds_read_b128 a[224:227], v17 offset:16384
v_perm_b32 v57, v85, v19, s54
v_mfma_f32_16x16x32_bf16 v[228:231], a[248:251], a[164:167], v[228:231]
ds_read_b32 a190, v57
v_perm_b32 v56, v85, v19, s55
v_mfma_f32_16x16x32_bf16 v[232:235], a[248:251], a[168:171], v[232:235]
ds_read_b32 a191, v56
v_mfma_f32_16x16x32_bf16 v[236:239], a[248:251], a[172:175], v[236:239]
s_waitcnt lgkmcnt(4)
v_mfma_f32_16x16x32_bf16 v[240:243], a[252:255], a[160:163], v[240:243]
ds_read_b128 a[228:231], v17 offset:18432
v_mfma_f32_16x16x32_bf16 v[244:247], a[252:255], a[164:167], v[244:247]
v_mfma_f32_16x16x32_bf16 v[248:251], a[252:255], a[168:171], v[248:251]
v_mfma_f32_16x16x32_bf16 v[252:255], a[252:255], a[172:175], v[252:255]
s_waitcnt vmcnt(9) lgkmcnt(1)
v_cmp_ne_u64 s[50:51], s[88:89], v[90:91]
v_cmp_ne_u64 s[44:45], s[88:89], v[94:95]
v_mfma_f32_16x16x32_bf16 v[128:131], a[224:227], a[176:179], v[128:131]
ds_read_b128 a[232:235], v17 offset:20480
v_mfma_f32_16x16x32_bf16 v[132:135], a[224:227], a[180:183], v[132:135]
s_or_b64 s[50:51], s[44:45], s[50:51]
v_mfma_f32_16x16x32_bf16 v[136:139], a[224:227], a[184:187], v[136:139]
s_cbranch_scc1 L_SLOW12
L_BACK12:
v_mfma_f32_16x16x32_bf16 v[140:143], a[224:227], a[188:191], v[140:143]
s_waitcnt lgkmcnt(1)
buffer_load_dwordx4 v[48:51], v12, s[24:27], 0 offen offset:2048 sc1
v_mfma_f32_16x16x32_bf16 v[144:147], a[228:231], a[176:179], v[144:147]
ds_read_b128 a[236:239], v17 offset:22528
buffer_load_dwordx4 v[52:55], v12, s[24:27], 0 offen offset:3072 sc1
v_mfma_f32_16x16x32_bf16 v[148:151], a[228:231], a[180:183], v[148:151]
v_perm_b32 v63, v88, v19, s52
v_add_u32 v12, 32768, v13
v_mfma_f32_16x16x32_bf16 v[152:155], a[228:231], a[184:187], v[152:155]
ds_read_b32 a192, v63
v_perm_b32 v62, v88, v19, s53
v_mfma_f32_16x16x32_bf16 v[156:159], a[228:231], a[188:191], v[156:159]
s_waitcnt lgkmcnt(2)
ds_read_b32 a193, v62
v_mfma_f32_16x16x32_bf16 v[160:163], a[232:235], a[176:179], v[160:163]
ds_read_b128 a[240:243], v17 offset:24576
v_perm_b32 v61, v92, v19, s52
v_mfma_f32_16x16x32_bf16 v[164:167], a[232:235], a[180:183], v[164:167]
ds_read_b32 a194, v61
v_perm_b32 v60, v92, v19, s53
v_mfma_f32_16x16x32_bf16 v[168:171], a[232:235], a[184:187], v[168:171]
s_add_u32 m0, s33, 97280
ds_read_b32 a195, v60
v_perm_b32 v59, v88, v19, s54
v_mfma_f32_16x16x32_bf16 v[172:175], a[232:235], a[188:191], v[172:175]
s_waitcnt lgkmcnt(4)
ds_read_b32 a196, v59
v_perm_b32 v58, v88, v19, s55
v_mfma_f32_16x16x32_bf16 v[176:179], a[236:239], a[176:179], v[176:179]
ds_read_b128 a[244:247], v17 offset:26624
buffer_load_dwordx4 v8, s[20:23], 0 offen offset:1024 lds
v_mfma_f32_16x16x32_bf16 v[180:183], a[236:239], a[180:183], v[180:183]
ds_read_b32 a197, v58
v_perm_b32 v57, v92, v19, s54
v_mfma_f32_16x16x32_bf16 v[184:187], a[236:239], a[184:187], v[184:187]
ds_read_b32 a198, v57
v_perm_b32 v56, v92, v19, s55
v_mfma_f32_16x16x32_bf16 v[188:191], a[236:239], a[188:191], v[188:191]
s_waitcnt lgkmcnt(4)
ds_read_b32 a199, v56
v_mfma_f32_16x16x32_bf16 v[192:195], a[240:243], a[176:179], v[192:195]
s_waitcnt vmcnt(11)
s_barrier
ds_read_b128 a[248:251], v17 offset:28672
v_perm_b32 v63, v89, v19, s52
v_mfma_f32_16x16x32_bf16 v[196:199], a[240:243], a[180:183], v[196:199]
ds_read_b32 a200, v63
v_perm_b32 v62, v89, v19, s53
v_mfma_f32_16x16x32_bf16 v[200:203], a[240:243], a[184:187], v[200:203]
ds_read_b32 a201, v62
v_perm_b32 v61, v93, v19, s52
v_mfma_f32_16x16x32_bf16 v[204:207], a[240:243], a[188:191], v[204:207]
s_waitcnt lgkmcnt(4)
ds_read_b32 a202, v61
v_mfma_f32_16x16x32_bf16 v[208:211], a[244:247], a[176:179], v[208:211]
ds_read_b128 a[252:255], v17 offset:30720
v_perm_b32 v60, v93, v19, s53
v_mfma_f32_16x16x32_bf16 v[212:215], a[244:247], a[180:183], v[212:215]
ds_read_b32 a203, v60
v_perm_b32 v59, v89, v19, s54
v_mfma_f32_16x16x32_bf16 v[216:219], a[244:247], a[184:187], v[216:219]
ds_read_b32 a204, v59
v_perm_b32 v58, v89, v19, s55
v_mfma_f32_16x16x32_bf16 v[220:223], a[244:247], a[188:191], v[220:223]
s_waitcnt lgkmcnt(4)
ds_read_b32 a205, v58
v_mfma_f32_16x16x32_bf16 v[224:227], a[248:251], a[176:179], v[224:227]
ds_read_b128 a[224:227], v14 offset:0
v_perm_b32 v57, v93, v19, s54
v_mfma_f32_16x16x32_bf16 v[228:231], a[248:251], a[180:183], v[228:231]
ds_read_b32 a206, v57
v_perm_b32 v56, v93, v19, s55
v_mfma_f32_16x16x32_bf16 v[232:235], a[248:251], a[184:187], v[232:235]
s_add_u32 m0, s33, 101376
ds_read_b32 a207, v56
buffer_load_dwordx4 v[96:99], v12, s[24:27], 0 offen offset:0 sc1
v_mfma_f32_16x16x32_bf16 v[236:239], a[248:251], a[188:191], v[236:239]
s_waitcnt lgkmcnt(4)
buffer_load_dwordx4 v[100:103], v12, s[24:27], 0 offen offset:1024 sc1
v_mfma_f32_16x16x32_bf16 v[240:243], a[252:255], a[176:179], v[240:243]
ds_read_b128 a[228:231], v14 offset:2048
buffer_load_dwordx4 v9, s[20:23], 0 offen offset:1024 lds
v_mfma_f32_16x16x32_bf16 v[244:247], a[252:255], a[180:183], v[244:247]
v_mfma_f32_16x16x32_bf16 v[248:251], a[252:255], a[184:187], v[248:251]
v_mfma_f32_16x16x32_bf16 v[252:255], a[252:255], a[188:191], v[252:255]
s_waitcnt vmcnt(11) lgkmcnt(1)
v_cmp_ne_u64 s[50:51], s[88:89], v[34:35]
v_cmp_ne_u64 s[44:45], s[88:89], v[38:39]
v_mfma_f32_16x16x32_bf16 v[128:131], a[224:227], a[192:195], v[128:131]
ds_read_b128 a[232:235], v14 offset:4096
v_mfma_f32_16x16x32_bf16 v[132:135], a[224:227], a[196:199], v[132:135]
s_or_b64 s[50:51], s[44:45], s[50:51]
v_mfma_f32_16x16x32_bf16 v[136:139], a[224:227], a[200:203], v[136:139]
s_cbranch_scc1 L_SLOW13
L_BACK13:
v_mfma_f32_16x16x32_bf16 v[140:143], a[224:227], a[204:207], v[140:143]
s_waitcnt lgkmcnt(1)
v_mfma_f32_16x16x32_bf16 v[144:147], a[228:231], a[192:195], v[144:147]
ds_read_b128 a[236:239], v14 offset:6144
v_mfma_f32_16x16x32_bf16 v[148:151], a[228:231], a[196:199], v[148:151]
v_perm_b32 v63, v32, v19, s52
v_mfma_f32_16x16x32_bf16 v[152:155], a[228:231], a[200:203], v[152:155]
s_add_u32 m0, s33, 105472
ds_read_b32 a208, v63
v_perm_b32 v62, v32, v19, s53
v_mfma_f32_16x16x32_bf16 v[156:159], a[228:231], a[204:207], v[156:159]
s_waitcnt lgkmcnt(2)
ds_read_b32 a209, v62
v_perm_b32 v61, v36, v19, s52
v_mfma_f32_16x16x32_bf16 v[160:163], a[232:235], a[192:195], v[160:163]
ds_read_b128 a[240:243], v14 offset:8192
buffer_load_dwordx4 v10, s[20:23], 0 offen offset:1024 lds
v_mfma_f32_16x16x32_bf16 v[164:167], a[232:235], a[196:199], v[164:167]
ds_read_b32 a210, v61
v_perm_b32 v60, v36, v19, s53
v_mfma_f32_16x16x32_bf16 v[168:171], a[232:235], a[200:203], v[168:171]
ds_read_b32 a211, v60
v_perm_b32 v59, v32, v19, s54
v_mfma_f32_16x16x32_bf16 v[172:175], a[232:235], a[204:207], v[172:175]
s_waitcnt lgkmcnt(4)
ds_read_b32 a212, v59
v_mfma_f32_16x16x32_bf16 v[176:179], a[236:239], a[192:195], v[176:179]
ds_read_b128 a[244:247], v14 offset:10240
v_perm_b32 v58, v32, v19, s55
v_mfma_f32_16x16x32_bf16 v[180:183], a[236:239], a[196:199], v[180:183]
ds_read_b32 a213, v58
v_perm_b32 v57, v36, v19, s54
v_mfma_f32_16x16x32_bf16 v[184:187], a[236:239], a[200:203], v[184:187]
ds_read_b32 a214, v57
v_perm_b32 v56, v36, v19, s55
v_mfma_f32_16x16x32_bf16 v[188:191], a[236:239], a[204:207], v[188:191]
s_waitcnt lgkmcnt(4)
ds_read_b32 a215, v56
v_mfma_f32_16x16x32_bf16 v[192:195], a[240:243], a[192:195], v[192:195]
ds_read_b128 a[248:251], v14 offset:12288
v_perm_b32 v63, v33, v19, s52
v_mfma_f32_16x16x32_bf16 v[196:199], a[240:243], a[196:199], v[196:199]
ds_read_b32 a216, v63
v_perm_b32 v62, v33, v19, s53
v_mfma_f32_16x16x32_bf16 v[200:203], a[240:243], a[200:203], v[200:203]
s_add_u32 m0, s33, 109440
ds_read_b32 a217, v62
v_perm_b32 v61, v37, v19, s52
v_mfma_f32_16x16x32_bf16 v[204:207], a[240:243], a[204:207], v[204:207]
s_waitcnt lgkmcnt(4)
ds_read_b32 a218, v61
v_perm_b32 v60, v37, v19, s53
v_mfma_f32_16x16x32_bf16 v[208:211], a[244:247], a[192:195], v[208:211]
ds_read_b128 a[252:255], v14 offset:14336
buffer_load_dwordx4 v8, s[20:23], 0 offen offset:1152 lds
v_mfma_f32_16x16x32_bf16 v[212:215], a[244:247], a[196:199], v[212:215]
ds_read_b32 a219, v60
v_perm_b32 v59, v33, v19, s54
v_mfma_f32_16x16x32_bf16 v[216:219], a[244:247], a[200:203], v[216:219]
ds_read_b32 a220, v59
v_perm_b32 v58, v33, v19, s55
v_mfma_f32_16x16x32_bf16 v[220:223], a[244:247], a[204:207], v[220:223]
s_waitcnt lgkmcnt(4)
ds_read_b32 a221, v58
buffer_load_dwordx4 v[80:83], v12, s[24:27], 0 offen offset:2048 sc1
v_mfma_f32_16x16x32_bf16 v[224:227], a[248:251], a[192:195], v[224:227]
ds_read_b128 a[224:227], v15 offset:0
v_perm_b32 v57, v37, v19, s54
v_mfma_f32_16x16x32_bf16 v[228:231], a[248:251], a[196:199], v[228:231]
ds_read_b32 a222, v57
v_perm_b32 v56, v37, v19, s55
v_mfma_f32_16x16x32_bf16 v[232:235], a[248:251], a[200:203], v[232:235]
ds_read_b32 a223, v56
buffer_load_dwordx4 v[84:87], v12, s[24:27], 0 offen offset:3072 sc1
v_mfma_f32_16x16x32_bf16 v[236:239], a[248:251], a[204:207], v[236:239]
s_waitcnt lgkmcnt(4)
v_add_u32 v12, 36864, v13
v_mfma_f32_16x16x32_bf16 v[240:243], a[252:255], a[192:195], v[240:243]
ds_read_b128 a[228:231], v15 offset:2048
v_mfma_f32_16x16x32_bf16 v[244:247], a[252:255], a[196:199], v[244:247]
v_mfma_f32_16x16x32_bf16 v[248:251], a[252:255], a[200:203], v[248:251]
s_waitcnt vmcnt(11)
v_cmp_ne_u64 s[50:51], s[88:89], v[42:43]
v_cmp_ne_u64 s[44:45], s[88:89], v[46:47]
v_mfma_f32_16x16x32_bf16 v[252:255], a[252:255], a[204:207], v[252:255]
s_waitcnt lgkmcnt(1)
v_mfma_f32_16x16x32_bf16 v[128:131], a[224:227], a[208:211], v[128:131]
s_or_b64 s[50:51], s[44:45], s[50:51]
ds_read_b128 a[232:235], v15 offset:4096
v_mfma_f32_16x16x32_bf16 v[132:135], a[224:227], a[212:215], v[132:135]
s_cbranch_scc1 L_SLOW14
L_BACK14:
v_mfma_f32_16x16x32_bf16 v[136:139], a[224:227], a[216:219], v[136:139]
v_perm_b32 v63, v40, v19, s52
v_mfma_f32_16x16x32_bf16 v[140:143], a[224:227], a[220:223], v[140:143]
s_waitcnt lgkmcnt(1)
ds_read_b32 a0, v63
v_mfma_f32_16x16x32_bf16 v[144:147], a[228:231], a[208:211], v[144:147]
ds_read_b128 a[236:239], v15 offset:6144
v_perm_b32 v62, v40, v19, s53
v_mfma_f32_16x16x32_bf16 v[148:151], a[228:231], a[212:215], v[148:151]
ds_read_b32 a1, v62
v_perm_b32 v61, v44, v19, s52
v_mfma_f32_16x16x32_bf16 v[152:155], a[228:231], a[216:219], v[152:155]
ds_read_b32 a2, v61
v_perm_b32 v60, v44, v19, s53
v_mfma_f32_16x16x32_bf16 v[156:159], a[228:231], a[220:223], v[156:159]
s_waitcnt lgkmcnt(4)
ds_read_b32 a3, v60
v_mfma_f32_16x16x32_bf16 v[160:163], a[232:235], a[208:211], v[160:163]
ds_read_b128 a[240:243], v15 offset:8192
v_perm_b32 v59, v40, v19, s54
v_mfma_f32_16x16x32_bf16 v[164:167], a[232:235], a[212:215], v[164:167]
ds_read_b32 a4, v59
v_perm_b32 v58, v40, v19, s55
v_mfma_f32_16x16x32_bf16 v[168:171], a[232:235], a[216:219], v[168:171]
s_add_u32 m0, s33, 113664
ds_read_b32 a5, v58
v_perm_b32 v57, v44, v19, s54
v_mfma_f32_16x16x32_bf16 v[172:175], a[232:235], a[220:223], v[172:175]
s_waitcnt lgkmcnt(4)
ds_read_b32 a6, v57
v_perm_b32 v56, v44, v19, s55
v_mfma_f32_16x16x32_bf16 v[176:179], a[236:239], a[208:211], v[176:179]
ds_read_b128 a[244:247], v15 offset:10240
buffer_load_dwordx4 v11, s[20:23], 0 offen offset:1024 lds
v_mfma_f32_16x16x32_bf16 v[180:183], a[236:239], a[212:215], v[180:183]
ds_read_b32 a7, v56
v_perm_b32 v63, v41, v19, s52
v_mfma_f32_16x16x32_bf16 v[184:187], a[236:239], a[216:219], v[184:187]
ds_read_b32 a8, v63
v_perm_b32 v62, v41, v19, s53
v_mfma_f32_16x16x32_bf16 v[188:191], a[236:239], a[220:223], v[188:191]
s_waitcnt lgkmcnt(4)
ds_read_b32 a9, v62
buffer_load_dwordx4 v[88:91], v12, s[24:27], 0 offen offset:0 sc1
v_mfma_f32_16x16x32_bf16 v[192:195], a[240:243], a[208:211], v[192:195]
s_waitcnt vmcnt(12)
s_barrier
ds_read_b128 a[248:251], v15 offset:12288
v_perm_b32 v61, v45, v19, s52
v_mfma_f32_16x16x32_bf16 v[196:199], a[240:243], a[212:215], v[196:199]
ds_read_b32 a10, v61
v_perm_b32 v60, v45, v19, s53
v_mfma_f32_16x16x32_bf16 v[200:203], a[240:243], a[216:219], v[200:203]
ds_read_b32 a11, v60
v_perm_b32 v59, v41, v19, s54
v_mfma_f32_16x16x32_bf16 v[204:207], a[240:243], a[220:223], v[204:207]
s_waitcnt lgkmcnt(4)
ds_read_b32 a12, v59
buffer_load_dwordx4 v[92:95], v12, s[24:27], 0 offen offset:1024 sc1
v_mfma_f32_16x16x32_bf16 v[208:211], a[244:247], a[208:211], v[208:211]
ds_read_b128 a[252:255], v15 offset:14336
v_perm_b32 v58, v41, v19, s55
v_mfma_f32_16x16x32_bf16 v[212:215], a[244:247], a[212:215], v[212:215]
ds_read_b32 a13, v58
v_perm_b32 v57, v45, v19, s54
v_mfma_f32_16x16x32_bf16 v[216:219], a[244:247], a[216:219], v[216:219]
s_waitcnt vmcnt(11)
v_cmp_ne_u64 s[50:51], s[88:89], v[50:51]
v_cmp_ne_u64 s[44:45], s[88:89], v[54:55]
v_mfma_f32_16x16x32_bf16 v[220:223], a[244:247], a[220:223], v[220:223]
s_waitcnt lgkmcnt(3)
ds_read_b32 a14, v57
v_mfma_f32_16x16x32_bf16 v[224:227], a[248:251], a[208:211], v[224:227]
s_or_b64 s[50:51], s[44:45], s[50:51]
ds_read_b128 a[224:227], v14 offset:16384
v_perm_b32 v56, v45, v19, s55
v_mfma_f32_16x16x32_bf16 v[228:231], a[248:251], a[212:215], v[228:231]
s_cbranch_scc1 L_SLOW15
L_BACK15:
v_mfma_f32_16x16x32_bf16 v[232:235], a[248:251], a[216:219], v[232:235]
s_add_u32 m0, s33, 117632
ds_read_b32 a15, v56
v_perm_b32 v63, v48, v19, s52
v_mfma_f32_16x16x32_bf16 v[236:239], a[248:251], a[220:223], v[236:239]
s_waitcnt lgkmcnt(3)
ds_read_b32 a16, v63
v_perm_b32 v62, v48, v19, s53
v_mfma_f32_16x16x32_bf16 v[240:243], a[252:255], a[208:211], v[240:243]
ds_read_b128 a[228:231], v14 offset:18432
buffer_load_dwordx4 v9, s[20:23], 0 offen offset:1152 lds
v_mfma_f32_16x16x32_bf16 v[244:247], a[252:255], a[212:215], v[244:247]
ds_read_b32 a17, v62
v_perm_b32 v61, v52, v19, s52
v_mfma_f32_16x16x32_bf16 v[248:251], a[252:255], a[216:219], v[248:251]
ds_read_b32 a18, v61
v_perm_b32 v60, v52, v19, s53
v_mfma_f32_16x16x32_bf16 v[252:255], a[252:255], a[220:223], v[252:255]
s_waitcnt lgkmcnt(4)
ds_read_b32 a19, v60
v_mfma_f32_16x16x32_bf16 v[128:131], a[224:227], a[0:3], v[128:131]
ds_read_b128 a[232:235], v14 offset:20480
v_perm_b32 v59, v48, v19, s54
v_mfma_f32_16x16x32_bf16 v[132:135], a[224:227], a[4:7], v[132:135]
ds_read_b32 a20, v59
v_perm_b32 v58, v48, v19, s55
v_mfma_f32_16x16x32_bf16 v[136:139], a[224:227], a[8:11], v[136:139]
ds_read_b32 a21, v58
v_perm_b32 v57, v52, v19, s54
v_mfma_f32_16x16x32_bf16 v[140:143], a[224:227], a[12:15], v[140:143]
s_waitcnt lgkmcnt(4)
ds_read_b32 a22, v57
buffer_load_dwordx4 v[32:35], v12, s[24:27], 0 offen offset:2048 sc1
v_mfma_f32_16x16x32_bf16 v[144:147], a[228:231], a[0:3], v[144:147]
ds_read_b128 a[236:239], v14 offset:22528
v_perm_b32 v56, v52, v19, s55
v_mfma_f32_16x16x32_bf16 v[148:151], a[228:231], a[4:7], v[148:151]
ds_read_b32 a23, v56
v_perm_b32 v63, v49, v19, s52
v_mfma_f32_16x16x32_bf16 v[152:155], a[228:231], a[8:11], v[152:155]
s_add_u32 m0, s33, 121600
ds_read_b32 a24, v63
v_perm_b32 v62, v49, v19, s53
v_mfma_f32_16x16x32_bf16 v[156:159], a[228:231], a[12:15], v[156:159]
s_waitcnt lgkmcnt(4)
ds_read_b32 a25, v62
v_perm_b32 v61, v53, v19, s52
v_mfma_f32_16x16x32_bf16 v[160:163], a[232:235], a[0:3], v[160:163]
ds_read_b128 a[240:243], v14 offset:24576
buffer_load_dwordx4 v8, s[20:23], 0 offen offset:1280 lds
v_mfma_f32_16x16x32_bf16 v[164:167], a[232:235], a[4:7], v[164:167]
ds_read_b32 a26, v61
v_perm_b32 v60, v53, v19, s53
v_mfma_f32_16x16x32_bf16 v[168:171], a[232:235], a[8:11], v[168:171]
ds_read_b32 a27, v60
v_perm_b32 v59, v49, v19, s54
v_mfma_f32_16x16x32_bf16 v[172:175], a[232:235], a[12:15], v[172:175]
s_waitcnt lgkmcnt(4)
ds_read_b32 a28, v59
buffer_load_dwordx4 v[36:39], v12, s[24:27], 0 offen offset:3072 sc1
v_mfma_f32_16x16x32_bf16 v[176:179], a[236:239], a[0:3], v[176:179]
ds_read_b128 a[244:247], v14 offset:26624
v_perm_b32 v58, v49, v19, s55
v_mfma_f32_16x16x32_bf16 v[180:183], a[236:239], a[4:7], v[180:183]
ds_read_b32 a29, v58
v_perm_b32 v57, v53, v19, s54
v_mfma_f32_16x16x32_bf16 v[184:187], a[236:239], a[8:11], v[184:187]
s_waitcnt vmcnt(12)
v_cmp_ne_u64 s[50:51], s[88:89], v[98:99]
v_cmp_ne_u64 s[44:45], s[88:89], v[102:103]
v_mfma_f32_16x16x32_bf16 v[188:191], a[236:239], a[12:15], v[188:191]
s_waitcnt lgkmcnt(3)
ds_read_b32 a30, v57
v_add_u32 v12, 40960, v13
v_mfma_f32_16x16x32_bf16 v[192:195], a[240:243], a[0:3], v[192:195]
s_or_b64 s[50:51], s[44:45], s[50:51]
ds_read_b128 a[248:251], v14 offset:28672
v_perm_b32 v56, v53, v19, s55
v_mfma_f32_16x16x32_bf16 v[196:199], a[240:243], a[4:7], v[196:199]
s_cbranch_scc1 L_SLOW16
L_BACK16:
v_mfma_f32_16x16x32_bf16 v[200:203], a[240:243], a[8:11], v[200:203]
s_add_u32 m0, s33, 125824
ds_read_b32 a31, v56
v_perm_b32 v63, v96, v19, s52
v_mfma_f32_16x16x32_bf16 v[204:207], a[240:243], a[12:15], v[204:207]
s_waitcnt lgkmcnt(3)
ds_read_b32 a32, v63
v_perm_b32 v62, v96, v19, s53
v_mfma_f32_16x16x32_bf16 v[208:211], a[244:247], a[0:3], v[208:211]
ds_read_b128 a[252:255], v14 offset:30720
buffer_load_dwordx4 v10, s[20:23], 0 offen offset:1152 lds
v_mfma_f32_16x16x32_bf16 v[212:215], a[244:247], a[4:7], v[212:215]
ds_read_b32 a33, v62
v_perm_b32 v61, v100, v19, s52
v_mfma_f32_16x16x32_bf16 v[216:219], a[244:247], a[8:11], v[216:219]
ds_read_b32 a34, v61
v_perm_b32 v60, v100, v19, s53
v_mfma_f32_16x16x32_bf16 v[220:223], a[244:247], a[12:15], v[220:223]
s_waitcnt lgkmcnt(4)
ds_read_b32 a35, v60
buffer_load_dwordx4 v[40:43], v12, s[24:27], 0 offen offset:0 sc1
v_mfma_f32_16x16x32_bf16 v[224:227], a[248:251], a[0:3], v[224:227]
ds_read_b128 a[224:227], v15 offset:16384
v_perm_b32 v59, v96, v19, s54
v_mfma_f32_16x16x32_bf16 v[228:231], a[248:251], a[4:7], v[228:231]
ds_read_b32 a36, v59
v_perm_b32 v58, v96, v19, s55
v_mfma_f32_16x16x32_bf16 v[232:235], a[248:251], a[8:11], v[232:235]
ds_read_b32 a37, v58
v_perm_b32 v57, v100, v19, s54
v_mfma_f32_16x16x32_bf16 v[236:239], a[248:251], a[12:15], v[236:239]
s_waitcnt lgkmcnt(4)
ds_read_b32 a38, v57
buffer_load_dwordx4 v[44:47], v12, s[24:27], 0 offen offset:1024 sc1
v_mfma_f32_16x16x32_bf16 v[240:243], a[252:255], a[0:3], v[240:243]
ds_read_b128 a[228:231], v15 offset:18432
v_perm_b32 v56, v100, v19, s55
v_mfma_f32_16x16x32_bf16 v[244:247], a[252:255], a[4:7], v[244:247]
ds_read_b32 a39, v56
v_perm_b32 v63, v97, v19, s52
v_mfma_f32_16x16x32_bf16 v[248:251], a[252:255], a[8:11], v[248:251]
ds_read_b32 a40, v63
v_perm_b32 v62, v97, v19, s53
v_mfma_f32_16x16x32_bf16 v[252:255], a[252:255], a[12:15], v[252:255]
s_waitcnt lgkmcnt(4)
ds_read_b32 a41, v62
v_mfma_f32_16x16x32_bf16 v[128:131], a[224:227], a[16:19], v[128:131]
ds_read_b128 a[232:235], v15 offset:20480
v_perm_b32 v61, v101, v19, s52
v_mfma_f32_16x16x32_bf16 v[132:135], a[224:227], a[20:23], v[132:135]
ds_read_b32 a42, v61
v_perm_b32 v60, v101, v19, s53
v_mfma_f32_16x16x32_bf16 v[136:139], a[224:227], a[24:27], v[136:139]
s_add_u32 m0, s33, 129792
ds_read_b32 a43, v60
v_perm_b32 v59, v97, v19, s54
v_mfma_f32_16x16x32_bf16 v[140:143], a[224:227], a[28:31], v[140:143]
s_waitcnt lgkmcnt(4)
ds_read_b32 a44, v59
v_perm_b32 v58, v97, v19, s55
v_mfma_f32_16x16x32_bf16 v[144:147], a[228:231], a[16:19], v[144:147]
ds_read_b128 a[236:239], v15 offset:22528
buffer_load_dwordx4 v9, s[20:23], 0 offen offset:1280 lds
v_mfma_f32_16x16x32_bf16 v[148:151], a[228:231], a[20:23], v[148:151]
ds_read_b32 a45, v58
v_perm_b32 v57, v101, v19, s54
v_mfma_f32_16x16x32_bf16 v[152:155], a[228:231], a[24:27], v[152:155]
s_waitcnt vmcnt(11)
v_cmp_ne_u64 s[50:51], s[88:89], v[82:83]
v_cmp_ne_u64 s[44:45], s[88:89], v[86:87]
v_mfma_f32_16x16x32_bf16 v[156:159], a[228:231], a[28:31], v[156:159]
s_waitcnt lgkmcnt(3)
ds_read_b32 a46, v57
v_mfma_f32_16x16x32_bf16 v[160:163], a[232:235], a[16:19], v[160:163]
s_or_b64 s[50:51], s[44:45], s[50:51]
ds_read_b128 a[240:243], v15 offset:24576
v_perm_b32 v56, v101, v19, s55
v_mfma_f32_16x16x32_bf16 v[164:167], a[232:235], a[20:23], v[164:167]
s_cbranch_scc1 L_SLOW17
L_BACK17:
v_mfma_f32_16x16x32_bf16 v[168:171], a[232:235], a[24:27], v[168:171]
s_add_u32 m0, s33, 133760
ds_read_b32 a47, v56
v_perm_b32 v63, v80, v19, s52
v_mfma_f32_16x16x32_bf16 v[172:175], a[232:235], a[28:31], v[172:175]
s_waitcnt lgkmcnt(3)
ds_read_b32 a48, v63
v_perm_b32 v62, v80, v19, s53
v_mfma_f32_16x16x32_bf16 v[176:179], a[236:239], a[16:19], v[176:179]
ds_read_b128 a[244:247], v15 offset:26624
buffer_load_dwordx4 v8, s[20:23], 0 offen offset:1408 lds
v_mfma_f32_16x16x32_bf16 v[180:183], a[236:239], a[20:23], v[180:183]
ds_read_b32 a49, v62
v_perm_b32 v61, v84, v19, s52
v_mfma_f32_16x16x32_bf16 v[184:187], a[236:239], a[24:27], v[184:187]
ds_read_b32 a50, v61
v_perm_b32 v60, v84, v19, s53
v_mfma_f32_16x16x32_bf16 v[188:191], a[236:239], a[28:31], v[188:191]
s_waitcnt lgkmcnt(4)
ds_read_b32 a51, v60
v_mfma_f32_16x16x32_bf16 v[192:195], a[240:243], a[16:19], v[192:195]
s_barrier
ds_read_b128 a[248:251], v14 offset:32768
v_perm_b32 v59, v80, v19, s54
v_mfma_f32_16x16x32_bf16 v[196:199], a[240:243], a[20:23], v[196:199]
ds_read_b32 a52, v59
v_perm_b32 v58, v80, v19, s55
v_mfma_f32_16x16x32_bf16 v[200:203], a[240:243], a[24:27], v[200:203]
ds_read_b32 a53, v58
v_perm_b32 v57, v84, v19, s54
v_mfma_f32_16x16x32_bf16 v[204:207], a[240:243], a[28:31], v[204:207]
s_waitcnt lgkmcnt(4)
ds_read_b32 a54, v57
buffer_load_dwordx4 v[48:51], v12, s[24:27], 0 offen offset:2048 sc1
v_mfma_f32_16x16x32_bf16 v[208:211], a[244:247], a[16:19], v[208:211]
ds_read_b128 a[252:255], v14 offset:34816
v_perm_b32 v56, v84, v19, s55
v_mfma_f32_16x16x32_bf16 v[212:215], a[244:247], a[20:23], v[212:215]
ds_read_b32 a55, v56
v_perm_b32 v63, v81, v19, s52
v_mfma_f32_16x16x32_bf16 v[216:219], a[244:247], a[24:27], v[216:219]
ds_read_b32 a56, v63
v_perm_b32 v62, v81, v19, s53
v_mfma_f32_16x16x32_bf16 v[220:223], a[244:247], a[28:31], v[220:223]
s_waitcnt lgkmcnt(4)
ds_read_b32 a57, v62
buffer_load_dwordx4 v[52:55], v12, s[24:27], 0 offen offset:3072 sc1
v_mfma_f32_16x16x32_bf16 v[128:131], a[248:251], a[32:35], v[128:131]
ds_read_b128 a[224:227], v15 offset:28672
v_perm_b32 v61, v85, v19, s52
v_mfma_f32_16x16x32_bf16 v[132:135], a[248:251], a[36:39], v[132:135]
ds_read_b32 a58, v61
v_perm_b32 v60, v85, v19, s53
v_mfma_f32_16x16x32_bf16 v[136:139], a[248:251], a[40:43], v[136:139]
s_add_u32 m0, s33, 137984
ds_read_b32 a59, v60
v_perm_b32 v59, v81, v19, s54
v_mfma_f32_16x16x32_bf16 v[140:143], a[248:251], a[44:47], v[140:143]
s_waitcnt lgkmcnt(4)
ds_read_b32 a60, v59
v_perm_b32 v58, v81, v19, s55
v_mfma_f32_16x16x32_bf16 v[144:147], a[252:255], a[32:35], v[144:147]
ds_read_b128 a[228:231], v15 offset:30720
buffer_load_dwordx4 v10, s[20:23], 0 offen offset:1280 lds
v_mfma_f32_16x16x32_bf16 v[148:151], a[252:255], a[36:39], v[148:151]
ds_read_b32 a61, v58
v_perm_b32 v57, v85, v19, s54
v_mfma_f32_16x16x32_bf16 v[152:155], a[252:255], a[40:43], v[152:155]
s_waitcnt vmcnt(12)
v_cmp_ne_u64 s[50:51], s[88:89], v[90:91]
v_cmp_ne_u64 s[44:45], s[88:89], v[94:95]
v_mfma_f32_16x16x32_bf16 v[156:159], a[252:255], a[44:47], v[156:159]
s_waitcnt lgkmcnt(3)
ds_read_b32 a62, v57
v_add_u32 v12, 45056, v13
v_mfma_f32_16x16x32_bf16 v[224:227], a[224:227], a[16:19], v[224:227]
s_or_b64 s[50:51], s[44:45], s[50:51]
ds_read_b128 a[232:235], v14 offset:36864
v_perm_b32 v56, v85, v19, s55
v_mfma_f32_16x16x32_bf16 v[228:231], a[224:227], a[20:23], v[228:231]
s_cbranch_scc1 L_SLOW18
L_BACK18:
v_mfma_f32_16x16x32_bf16 v[232:235], a[224:227], a[24:27], v[232:235]
ds_read_b32 a63, v56
v_perm_b32 v63, v88, v19, s52
v_mfma_f32_16x16x32_bf16 v[236:239], a[224:227], a[28:31], v[236:239]
s_waitcnt lgkmcnt(3)
ds_read_b32 a64, v63
v_mfma_f32_16x16x32_bf16 v[240:243], a[228:231], a[16:19], v[240:243]
ds_read_b128 a[236:239], v14 offset:38912
v_perm_b32 v62, v88, v19, s53
v_mfma_f32_16x16x32_bf16 v[244:247], a[228:231], a[20:23], v[244:247]
ds_read_b32 a65, v62
v_perm_b32 v61, v92, v19, s52
v_mfma_f32_16x16x32_bf16 v[248:251], a[228:231], a[24:27], v[248:251]
s_add_u32 m0, s33, 142208
ds_read_b32 a66, v61
v_perm_b32 v60, v92, v19, s53
v_mfma_f32_16x16x32_bf16 v[252:255], a[228:231], a[28:31], v[252:255]
L_PAD3:
s_cbranch_vccnz L_PAD4
s_waitcnt lgkmcnt(4)
ds_read_b32 a67, v60
v_perm_b32 v59, v88, v19, s54
v_mfma_f32_16x16x32_bf16 v[160:163], a[232:235], a[32:35], v[160:163]
ds_read_b128 a[240:243], v15 offset:32768
buffer_load_dwordx4 v11, s[20:23], 0 offen offset:1152 lds
v_mfma_f32_16x16x32_bf16 v[164:167], a[232:235], a[36:39], v[164:167]
ds_read_b32 a68, v59
v_perm_b32 v58, v88, v19, s55
v_mfma_f32_16x16x32_bf16 v[168:171], a[232:235], a[40:43], v[168:171]
ds_read_b32 a69, v58
v_perm_b32 v57, v92, v19, s54
v_mfma_f32_16x16x32_bf16 v[172:175], a[232:235], a[44:47], v[172:175]
s_waitcnt lgkmcnt(4)
ds_read_b32 a70, v57
buffer_load_dwordx4 v[96:99], v12, s[24:27], 0 offen offset:0 sc1
v_mfma_f32_16x16x32_bf16 v[176:179], a[236:239], a[32:35], v[176:179]
ds_read_b128 a[244:247], v15 offset:34816
v_perm_b32 v56, v92, v19, s55
v_mfma_f32_16x16x32_bf16 v[180:183], a[236:239], a[36:39], v[180:183]
ds_read_b32 a71, v56
v_perm_b32 v63, v89, v19, s52
v_mfma_f32_16x16x32_bf16 v[184:187], a[236:239], a[40:43], v[184:187]
ds_read_b32 a72, v63
v_perm_b32 v62, v89, v19, s53
v_mfma_f32_16x16x32_bf16 v[188:191], a[236:239], a[44:47], v[188:191]
s_waitcnt lgkmcnt(4)
ds_read_b32 a73, v62
buffer_load_dwordx4 v[100:103], v12, s[24:27], 0 offen offset:1024 sc1
v_mfma_f32_16x16x32_bf16 v[128:131], a[240:243], a[48:51], v[128:131]
ds_read_b128 a[248:251], v14 offset:40960
v_perm_b32 v61, v93, v19, s52
v_mfma_f32_16x16x32_bf16 v[132:135], a[240:243], a[52:55], v[132:135]
ds_read_b32 a74, v61
v_perm_b32 v60, v93, v19, s53
v_mfma_f32_16x16x32_bf16 v[136:139], a[240:243], a[56:59], v[136:139]
s_add_u32 m0, s33, 146048
ds_read_b32 a75, v60
v_perm_b32 v59, v89, v19, s54
v_mfma_f32_16x16x32_bf16 v[140:143], a[240:243], a[60:63], v[140:143]
s_waitcnt lgkmcnt(4)
ds_read_b32 a76, v59
v_perm_b32 v58, v89, v19, s55
v_mfma_f32_16x16x32_bf16 v[144:147], a[244:247], a[48:51], v[144:147]
ds_read_b128 a[252:255], v14 offset:43008
buffer_load_dwordx4 v9, s[20:23], 0 offen offset:1408 lds
v_mfma_f32_16x16x32_bf16 v[148:151], a[244:247], a[52:55], v[148:151]
ds_read_b32 a77, v58
v_perm_b32 v57, v93, v19, s54
v_mfma_f32_16x16x32_bf16 v[152:155], a[244:247], a[56:59], v[152:155]
s_waitcnt vmcnt(12)
v_cmp_ne_u64 s[50:51], s[88:89], v[34:35]
v_cmp_ne_u64 s[44:45], s[88:89], v[38:39]
v_mfma_f32_16x16x32_bf16 v[156:159], a[244:247], a[60:63], v[156:159]
s_waitcnt lgkmcnt(3)
ds_read_b32 a78, v57
v_mfma_f32_16x16x32_bf16 v[192:195], a[248:251], a[32:35], v[192:195]
s_or_b64 s[50:51], s[44:45], s[50:51]
ds_read_b128 a[224:227], v15 offset:36864
v_perm_b32 v56, v93, v19, s55
v_mfma_f32_16x16x32_bf16 v[196:199], a[248:251], a[36:39], v[196:199]
s_cbranch_scc1 L_SLOW19
L_BACK19:
v_mfma_f32_16x16x32_bf16 v[200:203], a[248:251], a[40:43], v[200:203]
ds_read_b32 a79, v56
v_perm_b32 v63, v32, v19, s52
v_mfma_f32_16x16x32_bf16 v[204:207], a[248:251], a[44:47], v[204:207]
s_waitcnt lgkmcnt(3)
ds_read_b32 a80, v63
v_mfma_f32_16x16x32_bf16 v[208:211], a[252:255], a[32:35], v[208:211]
ds_read_b128 a[228:231], v15 offset:38912
v_perm_b32 v62, v32, v19, s53
v_mfma_f32_16x16x32_bf16 v[212:215], a[252:255], a[36:39], v[212:215]
ds_read_b32 a81, v62
v_perm_b32 v61, v36, v19, s52
v_mfma_f32_16x16x32_bf16 v[216:219], a[252:255], a[40:43], v[216:219]
ds_read_b32 a82, v61
v_perm_b32 v60, v36, v19, s53
v_mfma_f32_16x16x32_bf16 v[220:223], a[252:255], a[44:47], v[220:223]
s_waitcnt lgkmcnt(4)
ds_read_b32 a83, v60
v_mfma_f32_16x16x32_bf16 v[160:163], a[224:227], a[48:51], v[160:163]
ds_read_b128 a[232:235], v14 offset:45056
v_perm_b32 v59, v32, v19, s54
v_mfma_f32_16x16x32_bf16 v[164:167], a[224:227], a[52:55], v[164:167]
ds_read_b32 a84, v59
v_perm_b32 v58, v32, v19, s55
v_mfma_f32_16x16x32_bf16 v[168:171], a[224:227], a[56:59], v[168:171]
ds_read_b32 a85, v58
v_perm_b32 v57, v36, v19, s54
v_mfma_f32_16x16x32_bf16 v[172:175], a[224:227], a[60:63], v[172:175]
s_waitcnt lgkmcnt(4)
ds_read_b32 a86, v57
buffer_load_dwordx4 v[80:83], v12, s[24:27], 0 offen offset:2048 sc1
v_mfma_f32_16x16x32_bf16 v[176:179], a[228:231], a[48:51], v[176:179]
ds_read_b128 a[236:239], v14 offset:47104
v_perm_b32 v56, v36, v19, s55
v_mfma_f32_16x16x32_bf16 v[180:183], a[228:231], a[52:55], v[180:183]
ds_read_b32 a87, v56
v_perm_b32 v63, v33, v19, s52
v_mfma_f32_16x16x32_bf16 v[184:187], a[228:231], a[56:59], v[184:187]
ds_read_b32 a88, v63
v_perm_b32 v62, v33, v19, s53
v_mfma_f32_16x16x32_bf16 v[188:191], a[228:231], a[60:63], v[188:191]
s_waitcnt lgkmcnt(4)
ds_read_b32 a89, v62
buffer_load_dwordx4 v[84:87], v12, s[24:27], 0 offen offset:3072 sc1
v_mfma_f32_16x16x32_bf16 v[128:131], a[232:235], a[64:67], v[128:131]
ds_read_b128 a[240:243], v15 offset:40960
v_perm_b32 v61, v37, v19, s52
v_mfma_f32_16x16x32_bf16 v[132:135], a[232:235], a[68:71], v[132:135]
ds_read_b32 a90, v61
v_perm_b32 v60, v37, v19, s53
v_mfma_f32_16x16x32_bf16 v[136:139], a[232:235], a[72:75], v[136:139]
s_add_u32 m0, s33, 150016
ds_read_b32 a91, v60
v_perm_b32 v59, v33, v19, s54
v_mfma_f32_16x16x32_bf16 v[140:143], a[232:235], a[76:79], v[140:143]
s_waitcnt vmcnt(11) lgkmcnt(4)
v_cmp_ne_u64 s[50:51], s[88:89], v[42:43]
v_cmp_ne_u64 s[44:45], s[88:89], v[46:47]
v_mfma_f32_16x16x32_bf16 v[144:147], a[236:239], a[64:67], v[144:147]
ds_read_b128 a[244:247], v15 offset:43008
buffer_load_dwordx4 v8, s[20:23], 0 offen offset:1536 lds
v_mfma_f32_16x16x32_bf16 v[148:151], a[236:239], a[68:71], v[148:151]
ds_read_b32 a92, v59
v_perm_b32 v58, v33, v19, s55
v_mfma_f32_16x16x32_bf16 v[152:155], a[236:239], a[72:75], v[152:155]
s_or_b64 s[50:51], s[44:45], s[50:51]
ds_read_b32 a93, v58
v_perm_b32 v57, v37, v19, s54
v_mfma_f32_16x16x32_bf16 v[156:159], a[236:239], a[76:79], v[156:159]
s_waitcnt lgkmcnt(3)
ds_read_b32 a94, v57
v_add_u32 v12, 49152, v13
v_mfma_f32_16x16x32_bf16 v[192:195], a[240:243], a[48:51], v[192:195]
s_barrier
ds_read_b128 a[248:251], v14 offset:49152
v_perm_b32 v56, v37, v19, s55
v_mfma_f32_16x16x32_bf16 v[196:199], a[240:243], a[52:55], v[196:199]
s_cbranch_scc1 L_SLOW20
L_BACK20:
v_mfma_f32_16x16x32_bf16 v[200:203], a[240:243], a[56:59], v[200:203]
ds_read_b32 a95, v56
v_perm_b32 v63, v40, v19, s52
v_mfma_f32_16x16x32_bf16 v[204:207], a[240:243], a[60:63], v[204:207]
s_waitcnt lgkmcnt(3)
ds_read_b32 a96, v63
v_mfma_f32_16x16x32_bf16 v[208:211], a[244:247], a[48:51], v[208:211]
ds_read_b128 a[252:255], v14 offset:51200
v_perm_b32 v62, v40, v19, s53
v_mfma_f32_16x16x32_bf16 v[212:215], a[244:247], a[52:55], v[212:215]
ds_read_b32 a97, v62
v_perm_b32 v61, v44, v19, s52
v_mfma_f32_16x16x32_bf16 v[216:219], a[244:247], a[56:59], v[216:219]
ds_read_b32 a98, v61
v_perm_b32 v60, v44, v19, s53
v_mfma_f32_16x16x32_bf16 v[220:223], a[244:247], a[60:63], v[220:223]
s_waitcnt lgkmcnt(4)
ds_read_b32 a99, v60
v_mfma_f32_16x16x32_bf16 v[224:227], a[248:251], a[32:35], v[224:227]
ds_read_b128 a[224:227], v14 offset:53248
v_perm_b32 v59, v40, v19, s54
v_mfma_f32_16x16x32_bf16 v[228:231], a[248:251], a[36:39], v[228:231]
ds_read_b32 a100, v59
v_perm_b32 v58, v40, v19, s55
v_mfma_f32_16x16x32_bf16 v[232:235], a[248:251], a[40:43], v[232:235]
s_add_u32 m0, s33, 154112
ds_read_b32 a101, v58
v_perm_b32 v57, v44, v19, s54
v_mfma_f32_16x16x32_bf16 v[236:239], a[248:251], a[44:47], v[236:239]
s_waitcnt lgkmcnt(4)
ds_read_b32 a102, v57
v_perm_b32 v56, v44, v19, s55
v_mfma_f32_16x16x32_bf16 v[240:243], a[252:255], a[32:35], v[240:243]
ds_read_b128 a[228:231], v14 offset:55296
buffer_load_dwordx4 v9, s[20:23], 0 offen offset:1536 lds
v_mfma_f32_16x16x32_bf16 v[244:247], a[252:255], a[36:39], v[244:247]
ds_read_b32 a103, v56
v_perm_b32 v63, v41, v19, s52
v_mfma_f32_16x16x32_bf16 v[248:251], a[252:255], a[40:43], v[248:251]
ds_read_b32 a104, v63
v_perm_b32 v62, v41, v19, s53
v_mfma_f32_16x16x32_bf16 v[252:255], a[252:255], a[44:47], v[252:255]
s_waitcnt lgkmcnt(4)
ds_read_b32 a105, v62
buffer_load_dwordx4 v[88:91], v12, s[24:27], 0 offen offset:0 sc1
v_mfma_f32_16x16x32_bf16 v[160:163], a[224:227], a[64:67], v[160:163]
ds_read_b128 a[232:235], v15 offset:45056
v_perm_b32 v61, v45, v19, s52
v_mfma_f32_16x16x32_bf16 v[164:167], a[224:227], a[68:71], v[164:167]
ds_read_b32 a106, v61
v_perm_b32 v60, v45, v19, s53
v_mfma_f32_16x16x32_bf16 v[168:171], a[224:227], a[72:75], v[168:171]
ds_read_b32 a107, v60
v_perm_b32 v59, v41, v19, s54
v_mfma_f32_16x16x32_bf16 v[172:175], a[224:227], a[76:79], v[172:175]
s_waitcnt lgkmcnt(4)
ds_read_b32 a108, v59
buffer_load_dwordx4 v[92:95], v12, s[24:27], 0 offen offset:1024 sc1
v_mfma_f32_16x16x32_bf16 v[176:179], a[228:231], a[64:67], v[176:179]
ds_read_b128 a[236:239], v15 offset:47104
v_perm_b32 v58, v41, v19, s55
v_mfma_f32_16x16x32_bf16 v[180:183], a[228:231], a[68:71], v[180:183]
ds_read_b32 a109, v58
v_perm_b32 v57, v45, v19, s54
v_mfma_f32_16x16x32_bf16 v[184:187], a[228:231], a[72:75], v[184:187]
s_waitcnt vmcnt(11)
s_add_u32 m0, s33, 158080
v_cmp_ne_u64 s[50:51], s[88:89], v[50:51]
v_cmp_ne_u64 s[44:45], s[88:89], v[54:55]
v_mfma_f32_16x16x32_bf16 v[188:191], a[228:231], a[76:79], v[188:191]
s_waitcnt lgkmcnt(3)
ds_read_b32 a110, v57
v_perm_b32 v56, v45, v19, s55
v_mfma_f32_16x16x32_bf16 v[128:131], a[232:235], a[80:83], v[128:131]
s_or_b64 s[50:51], s[44:45], s[50:51]
ds_read_b128 a[240:243], v15 offset:53248
buffer_load_dwordx4 v8, s[20:23], 0 offen offset:1664 lds
v_mfma_f32_16x16x32_bf16 v[132:135], a[232:235], a[84:87], v[132:135]
s_cbranch_scc1 L_SLOW21
L_BACK21:
v_mfma_f32_16x16x32_bf16 v[136:139], a[232:235], a[88:91], v[136:139]
ds_read_b32 a111, v56
v_perm_b32 v63, v48, v19, s52
v_mfma_f32_16x16x32_bf16 v[140:143], a[232:235], a[92:95], v[140:143]
s_waitcnt lgkmcnt(3)
ds_read_b32 a112, v63
v_mfma_f32_16x16x32_bf16 v[144:147], a[236:239], a[80:83], v[144:147]
ds_read_b128 a[244:247], v15 offset:55296
v_perm_b32 v62, v48, v19, s53
v_mfma_f32_16x16x32_bf16 v[148:151], a[236:239], a[84:87], v[148:151]
ds_read_b32 a113, v62
v_perm_b32 v61, v52, v19, s52
v_mfma_f32_16x16x32_bf16 v[152:155], a[236:239], a[88:91], v[152:155]
ds_read_b32 a114, v61
v_perm_b32 v60, v52, v19, s53
v_mfma_f32_16x16x32_bf16 v[156:159], a[236:239], a[92:95], v[156:159]
s_waitcnt lgkmcnt(4)
ds_read_b32 a115, v60
v_mfma_f32_16x16x32_bf16 v[160:163], a[240:243], a[80:83], v[160:163]
ds_read_b128 a[248:251], v14 offset:57344
v_perm_b32 v59, v48, v19, s54
v_mfma_f32_16x16x32_bf16 v[164:167], a[240:243], a[84:87], v[164:167]
ds_read_b32 a116, v59
v_perm_b32 v58, v48, v19, s55
v_mfma_f32_16x16x32_bf16 v[168:171], a[240:243], a[88:91], v[168:171]
s_add_u32 m0, s33, 64128
ds_read_b32 a117, v58
v_perm_b32 v57, v52, v19, s54
v_mfma_f32_16x16x32_bf16 v[172:175], a[240:243], a[92:95], v[172:175]
s_waitcnt lgkmcnt(4)
ds_read_b32 a118, v57
v_perm_b32 v56, v52, v19, s55
v_mfma_f32_16x16x32_bf16 v[176:179], a[244:247], a[80:83], v[176:179]
ds_read_b128 a[252:255], v14 offset:59392
buffer_load_dwordx4 v10, s[20:23], 0 offen offset:1408 lds
v_mfma_f32_16x16x32_bf16 v[180:183], a[244:247], a[84:87], v[180:183]
ds_read_b32 a119, v56
v_perm_b32 v63, v49, v19, s52
v_mfma_f32_16x16x32_bf16 v[184:187], a[244:247], a[88:91], v[184:187]
ds_read_b32 a120, v63
v_perm_b32 v62, v49, v19, s53
v_mfma_f32_16x16x32_bf16 v[188:191], a[244:247], a[92:95], v[188:191]
s_waitcnt lgkmcnt(4)
ds_read_b32 a121, v62
buffer_load_dwordx4 v[32:35], v12, s[24:27], 0 offen offset:2048 sc1
v_mfma_f32_16x16x32_bf16 v[128:131], a[248:251], a[96:99], v[128:131]
ds_read_b128 a[224:227], v14 offset:61440
v_perm_b32 v61, v53, v19, s52
v_mfma_f32_16x16x32_bf16 v[132:135], a[248:251], a[100:103], v[132:135]
ds_read_b32 a122, v61
v_perm_b32 v60, v53, v19, s53
v_mfma_f32_16x16x32_bf16 v[136:139], a[248:251], a[104:107], v[136:139]
ds_read_b32 a123, v60
v_perm_b32 v59, v49, v19, s54
v_mfma_f32_16x16x32_bf16 v[140:143], a[248:251], a[108:111], v[140:143]
s_waitcnt lgkmcnt(4)
ds_read_b32 a124, v59
buffer_load_dwordx4 v[36:39], v12, s[24:27], 0 offen offset:3072 sc1
v_mfma_f32_16x16x32_bf16 v[144:147], a[252:255], a[96:99], v[144:147]
ds_read_b128 a[228:231], v14 offset:63488
v_perm_b32 v58, v49, v19, s55
v_mfma_f32_16x16x32_bf16 v[148:151], a[252:255], a[100:103], v[148:151]
ds_read_b32 a125, v58
v_perm_b32 v57, v53, v19, s54
v_mfma_f32_16x16x32_bf16 v[152:155], a[252:255], a[104:107], v[152:155]
s_waitcnt vmcnt(11)
v_cmp_ne_u64 s[50:51], s[88:89], v[98:99]
v_cmp_ne_u64 s[44:45], s[88:89], v[102:103]
v_mfma_f32_16x16x32_bf16 v[156:159], a[252:255], a[108:111], v[156:159]
s_waitcnt lgkmcnt(3)
ds_read_b32 a126, v57
v_add_u32 v12, 53248, v13
v_mfma_f32_16x16x32_bf16 v[192:195], a[224:227], a[64:67], v[192:195]
s_or_b64 s[50:51], s[44:45], s[50:51]
ds_read_b128 a[232:235], v15 offset:49152
v_perm_b32 v56, v53, v19, s55
v_mfma_f32_16x16x32_bf16 v[196:199], a[224:227], a[68:71], v[196:199]
s_cbranch_scc1 L_SLOW22
L_BACK22:
v_mfma_f32_16x16x32_bf16 v[200:203], a[224:227], a[72:75], v[200:203]
ds_read_b32 a127, v56
v_perm_b32 v63, v96, v19, s52
v_mfma_f32_16x16x32_bf16 v[204:207], a[224:227], a[76:79], v[204:207]
s_waitcnt lgkmcnt(3)
ds_read_b32 a128, v63
v_mfma_f32_16x16x32_bf16 v[208:211], a[228:231], a[64:67], v[208:211]
ds_read_b128 a[236:239], v15 offset:51200
v_perm_b32 v62, v96, v19, s53
v_mfma_f32_16x16x32_bf16 v[212:215], a[228:231], a[68:71], v[212:215]
ds_read_b32 a129, v62
v_perm_b32 v61, v100, v19, s52
v_mfma_f32_16x16x32_bf16 v[216:219], a[228:231], a[72:75], v[216:219]
s_add_u32 m0, s33, 68352
ds_read_b32 a130, v61
v_perm_b32 v60, v100, v19, s53
v_mfma_f32_16x16x32_bf16 v[220:223], a[228:231], a[76:79], v[220:223]
s_waitcnt lgkmcnt(4)
ds_read_b32 a131, v60
v_perm_b32 v59, v96, v19, s54
v_mfma_f32_16x16x32_bf16 v[224:227], a[232:235], a[48:51], v[224:227]
ds_read_b128 a[240:243], v15 offset:57344
buffer_load_dwordx4 v11, s[20:23], 0 offen offset:1280 lds
v_mfma_f32_16x16x32_bf16 v[228:231], a[232:235], a[52:55], v[228:231]
ds_read_b32 a132, v59
v_perm_b32 v58, v96, v19, s55
v_mfma_f32_16x16x32_bf16 v[232:235], a[232:235], a[56:59], v[232:235]
ds_read_b32 a133, v58
v_perm_b32 v57, v100, v19, s54
v_mfma_f32_16x16x32_bf16 v[236:239], a[232:235], a[60:63], v[236:239]
s_waitcnt lgkmcnt(4)
ds_read_b32 a134, v57
buffer_load_dwordx4 v[40:43], v12, s[24:27], 0 offen offset:0 sc1
v_mfma_f32_16x16x32_bf16 v[240:243], a[236:239], a[48:51], v[240:243]
ds_read_b128 a[244:247], v15 offset:59392
v_perm_b32 v56, v100, v19, s55
v_mfma_f32_16x16x32_bf16 v[244:247], a[236:239], a[52:55], v[244:247]
ds_read_b32 a135, v56
v_perm_b32 v63, v97, v19, s52
v_mfma_f32_16x16x32_bf16 v[248:251], a[236:239], a[56:59], v[248:251]
ds_read_b32 a136, v63
v_perm_b32 v62, v97, v19, s53
v_mfma_f32_16x16x32_bf16 v[252:255], a[236:239], a[60:63], v[252:255]
s_waitcnt lgkmcnt(4)
ds_read_b32 a137, v62
buffer_load_dwordx4 v[44:47], v12, s[24:27], 0 offen offset:1024 sc1
v_mfma_f32_16x16x32_bf16 v[128:131], a[240:243], a[112:115], v[128:131]
s_waitcnt vmcnt(13)
s_barrier
ds_read_b128 a[248:251], v16 offset:0
v_perm_b32 v61, v101, v19, s52
v_mfma_f32_16x16x32_bf16 v[132:135], a[240:243], a[116:119], v[132:135]
ds_read_b32 a138, v61
v_perm_b32 v60, v101, v19, s53
v_mfma_f32_16x16x32_bf16 v[136:139], a[240:243], a[120:123], v[136:139]
s_add_u32 m0, s33, 71936
ds_read_b32 a139, v60
v_perm_b32 v59, v97, v19, s54
v_mfma_f32_16x16x32_bf16 v[140:143], a[240:243], a[124:127], v[140:143]
s_waitcnt lgkmcnt(4)
ds_read_b32 a140, v59
v_perm_b32 v58, v97, v19, s55
v_mfma_f32_16x16x32_bf16 v[144:147], a[244:247], a[112:115], v[144:147]
ds_read_b128 a[252:255], v16 offset:2048
buffer_load_dwordx4 v8, s[20:23], 0 offen offset:1792 lds
v_mfma_f32_16x16x32_bf16 v[148:151], a[244:247], a[116:119], v[148:151]
ds_read_b32 a141, v58
v_perm_b32 v57, v101, v19, s54
v_mfma_f32_16x16x32_bf16 v[152:155], a[244:247], a[120:123], v[152:155]
s_waitcnt vmcnt(12)
v_cmp_ne_u64 s[50:51], s[88:89], v[82:83]
v_cmp_ne_u64 s[44:45], s[88:89], v[86:87]
v_mfma_f32_16x16x32_bf16 v[156:159], a[244:247], a[124:127], v[156:159]
s_waitcnt lgkmcnt(3)
ds_read_b32 a142, v57
v_mfma_f32_16x16x32_bf16 v[160:163], a[248:251], a[96:99], v[160:163]
s_or_b64 s[50:51], s[44:45], s[50:51]
ds_read_b128 a[224:227], v15 offset:61440
v_perm_b32 v56, v101, v19, s55
v_mfma_f32_16x16x32_bf16 v[164:167], a[248:251], a[100:103], v[164:167]
s_cbranch_scc1 L_SLOW23
L_BACK23:
v_mfma_f32_16x16x32_bf16 v[168:171], a[248:251], a[104:107], v[168:171]
ds_read_b32 a143, v56
v_perm_b32 v63, v80, v19, s52
v_mfma_f32_16x16x32_bf16 v[172:175], a[248:251], a[108:111], v[172:175]
s_waitcnt lgkmcnt(3)
ds_read_b32 a144, v63
v_mfma_f32_16x16x32_bf16 v[176:179], a[252:255], a[96:99], v[176:179]
ds_read_b128 a[228:231], v15 offset:63488
v_perm_b32 v62, v80, v19, s53
v_mfma_f32_16x16x32_bf16 v[180:183], a[252:255], a[100:103], v[180:183]
ds_read_b32 a145, v62
v_perm_b32 v61, v84, v19, s52
v_mfma_f32_16x16x32_bf16 v[184:187], a[252:255], a[104:107], v[184:187]
s_add_u32 m0, s33, 76160
ds_read_b32 a146, v61
v_perm_b32 v60, v84, v19, s53
v_mfma_f32_16x16x32_bf16 v[188:191], a[252:255], a[108:111], v[188:191]
s_waitcnt lgkmcnt(4)
ds_read_b32 a147, v60
v_perm_b32 v59, v80, v19, s54
v_mfma_f32_16x16x32_bf16 v[192:195], a[224:227], a[80:83], v[192:195]
ds_read_b128 a[232:235], v16 offset:4096
buffer_load_dwordx4 v9, s[20:23], 0 offen offset:1664 lds
v_mfma_f32_16x16x32_bf16 v[196:199], a[224:227], a[84:87], v[196:199]
ds_read_b32 a148, v59
v_perm_b32 v58, v80, v19, s55
v_mfma_f32_16x16x32_bf16 v[200:203], a[224:227], a[88:91], v[200:203]
ds_read_b32 a149, v58
v_perm_b32 v57, v84, v19, s54
v_mfma_f32_16x16x32_bf16 v[204:207], a[224:227], a[92:95], v[204:207]
s_waitcnt lgkmcnt(4)
ds_read_b32 a150, v57
buffer_load_dwordx4 v[48:51], v12, s[24:27], 0 offen offset:2048 sc1
v_mfma_f32_16x16x32_bf16 v[208:211], a[228:231], a[80:83], v[208:211]
ds_read_b128 a[236:239], v16 offset:6144
v_perm_b32 v56, v84, v19, s55
v_mfma_f32_16x16x32_bf16 v[212:215], a[228:231], a[84:87], v[212:215]
ds_read_b32 a151, v56
v_perm_b32 v63, v81, v19, s52
v_mfma_f32_16x16x32_bf16 v[216:219], a[228:231], a[88:91], v[216:219]
ds_read_b32 a152, v63
v_perm_b32 v62, v81, v19, s53
v_mfma_f32_16x16x32_bf16 v[220:223], a[228:231], a[92:95], v[220:223]
s_waitcnt lgkmcnt(4)
ds_read_b32 a153, v62
buffer_load_dwordx4 v[52:55], v12, s[24:27], 0 offen offset:3072 sc1
v_mfma_f32_16x16x32_bf16 v[128:131], a[232:235], a[128:131], v[128:131]
ds_read_b128 a[240:243], v17 offset:0
v_perm_b32 v61, v85, v19, s52
v_mfma_f32_16x16x32_bf16 v[132:135], a[232:235], a[132:135], v[132:135]
ds_read_b32 a154, v61
v_perm_b32 v60, v85, v19, s53
v_mfma_f32_16x16x32_bf16 v[136:139], a[232:235], a[136:139], v[136:139]
s_add_u32 m0, s33, 80384
ds_read_b32 a155, v60
v_perm_b32 v59, v81, v19, s54
v_mfma_f32_16x16x32_bf16 v[140:143], a[232:235], a[140:143], v[140:143]
s_waitcnt lgkmcnt(4)
ds_read_b32 a156, v59
v_perm_b32 v58, v81, v19, s55
v_mfma_f32_16x16x32_bf16 v[144:147], a[236:239], a[128:131], v[144:147]
ds_read_b128 a[244:247], v17 offset:2048
buffer_load_dwordx4 v10, s[20:23], 0 offen offset:1536 lds
v_mfma_f32_16x16x32_bf16 v[148:151], a[236:239], a[132:135], v[148:151]
ds_read_b32 a157, v58
v_perm_b32 v57, v85, v19, s54
v_mfma_f32_16x16x32_bf16 v[152:155], a[236:239], a[136:139], v[152:155]
s_waitcnt vmcnt(12)
v_cmp_ne_u64 s[50:51], s[88:89], v[90:91]
v_cmp_ne_u64 s[44:45], s[88:89], v[94:95]
v_mfma_f32_16x16x32_bf16 v[156:159], a[236:239], a[140:143], v[156:159]
s_waitcnt lgkmcnt(3)
ds_read_b32 a158, v57
v_add_u32 v12, 57344, v13
v_mfma_f32_16x16x32_bf16 v[160:163], a[240:243], a[112:115], v[160:163]
s_or_b64 s[50:51], s[44:45], s[50:51]
ds_read_b128 a[248:251], v17 offset:4096
v_perm_b32 v56, v85, v19, s55
v_mfma_f32_16x16x32_bf16 v[164:167], a[240:243], a[116:119], v[164:167]
s_cbranch_scc1 L_SLOW24
L_BACK24:
v_mfma_f32_16x16x32_bf16 v[168:171], a[240:243], a[120:123], v[168:171]
ds_read_b32 a159, v56
v_perm_b32 v63, v88, v19, s52
v_mfma_f32_16x16x32_bf16 v[172:175], a[240:243], a[124:127], v[172:175]
s_waitcnt lgkmcnt(3)
ds_read_b32 a160, v63
v_mfma_f32_16x16x32_bf16 v[176:179], a[244:247], a[112:115], v[176:179]
ds_read_b128 a[252:255], v17 offset:6144
v_perm_b32 v62, v88, v19, s53
v_mfma_f32_16x16x32_bf16 v[180:183], a[244:247], a[116:119], v[180:183]
ds_read_b32 a161, v62
v_perm_b32 v61, v92, v19, s52
v_mfma_f32_16x16x32_bf16 v[184:187], a[244:247], a[120:123], v[184:187]
s_add_u32 m0, s33, 84096
ds_read_b32 a162, v61
v_perm_b32 v60, v92, v19, s53
v_mfma_f32_16x16x32_bf16 v[188:191], a[244:247], a[124:127], v[188:191]
s_waitcnt lgkmcnt(4)
ds_read_b32 a163, v60
v_perm_b32 v59, v88, v19, s54
v_mfma_f32_16x16x32_bf16 v[128:131], a[248:251], a[144:147], v[128:131]
ds_read_b128 a[224:227], v16 offset:8192
buffer_load_dwordx4 v8, s[20:23], 0 offen offset:1920 lds
v_mfma_f32_16x16x32_bf16 v[132:135], a[248:251], a[148:151], v[132:135]
ds_read_b32 a164, v59
v_perm_b32 v58, v88, v19, s55
v_mfma_f32_16x16x32_bf16 v[136:139], a[248:251], a[152:155], v[136:139]
ds_read_b32 a165, v58
v_perm_b32 v57, v92, v19, s54
v_mfma_f32_16x16x32_bf16 v[140:143], a[248:251], a[156:159], v[140:143]
s_waitcnt lgkmcnt(4)
ds_read_b32 a166, v57
buffer_load_dwordx4 v[96:99], v12, s[24:27], 0 offen offset:0 sc1
v_mfma_f32_16x16x32_bf16 v[144:147], a[252:255], a[144:147], v[144:147]
ds_read_b128 a[228:231], v16 offset:10240
v_perm_b32 v56, v92, v19, s55
v_mfma_f32_16x16x32_bf16 v[148:151], a[252:255], a[148:151], v[148:151]
ds_read_b32 a167, v56
v_perm_b32 v63, v89, v19, s52
v_mfma_f32_16x16x32_bf16 v[152:155], a[252:255], a[152:155], v[152:155]
ds_read_b32 a168, v63
v_perm_b32 v62, v89, v19, s53
v_mfma_f32_16x16x32_bf16 v[156:159], a[252:255], a[156:159], v[156:159]
s_waitcnt lgkmcnt(4)
ds_read_b32 a169, v62
buffer_load_dwordx4 v[100:103], v12, s[24:27], 0 offen offset:1024 sc1
v_mfma_f32_16x16x32_bf16 v[192:195], a[224:227], a[96:99], v[192:195]
ds_read_b128 a[232:235], v16 offset:12288
v_perm_b32 v61, v93, v19, s52
v_mfma_f32_16x16x32_bf16 v[196:199], a[224:227], a[100:103], v[196:199]
ds_read_b32 a170, v61
v_perm_b32 v60, v93, v19, s53
v_mfma_f32_16x16x32_bf16 v[200:203], a[224:227], a[104:107], v[200:203]
s_add_u32 m0, s33, 88320
ds_read_b32 a171, v60
v_perm_b32 v59, v89, v19, s54
v_mfma_f32_16x16x32_bf16 v[204:207], a[224:227], a[108:111], v[204:207]
s_waitcnt lgkmcnt(4)
ds_read_b32 a172, v59
v_perm_b32 v58, v89, v19, s55
v_mfma_f32_16x16x32_bf16 v[208:211], a[228:231], a[96:99], v[208:211]
ds_read_b128 a[236:239], v16 offset:14336
buffer_load_dwordx4 v9, s[20:23], 0 offen offset:1792 lds
v_mfma_f32_16x16x32_bf16 v[212:215], a[228:231], a[100:103], v[212:215]
ds_read_b32 a173, v58
v_perm_b32 v57, v93, v19, s54
v_mfma_f32_16x16x32_bf16 v[216:219], a[228:231], a[104:107], v[216:219]
s_waitcnt vmcnt(12)
v_cmp_ne_u64 s[50:51], s[88:89], v[34:35]
v_cmp_ne_u64 s[44:45], s[88:89], v[38:39]
v_mfma_f32_16x16x32_bf16 v[220:223], a[228:231], a[108:111], v[220:223]
s_waitcnt lgkmcnt(3)
ds_read_b32 a174, v57
v_mfma_f32_16x16x32_bf16 v[224:227], a[232:235], a[64:67], v[224:227]
s_or_b64 s[50:51], s[44:45], s[50:51]
ds_read_b128 a[240:243], v16 offset:16384
v_perm_b32 v56, v93, v19, s55
v_mfma_f32_16x16x32_bf16 v[228:231], a[232:235], a[68:71], v[228:231]
s_cbranch_scc1 L_SLOW25
L_BACK25:
v_mfma_f32_16x16x32_bf16 v[232:235], a[232:235], a[72:75], v[232:235]
s_add_u32 m0, s33, 92544
ds_read_b32 a175, v56
v_perm_b32 v63, v32, v19, s52
v_mfma_f32_16x16x32_bf16 v[236:239], a[232:235], a[76:79], v[236:239]
L_PAD4:
s_cbranch_vccnz L_PADRET
s_waitcnt lgkmcnt(3)
ds_read_b32 a176, v63
v_perm_b32 v62, v32, v19, s53
v_mfma_f32_16x16x32_bf16 v[240:243], a[236:239], a[64:67], v[240:243]
ds_read_b128 a[244:247], v16 offset:18432
buffer_load_dwordx4 v10, s[20:23], 0 offen offset:1664 lds
v_mfma_f32_16x16x32_bf16 v[244:247], a[236:239], a[68:71], v[244:247]
ds_read_b32 a177, v62
v_perm_b32 v61, v36, v19, s52
v_mfma_f32_16x16x32_bf16 v[248:251], a[236:239], a[72:75], v[248:251]
ds_read_b32 a178, v61
v_perm_b32 v60, v36, v19, s53
v_mfma_f32_16x16x32_bf16 v[252:255], a[236:239], a[76:79], v[252:255]
s_waitcnt lgkmcnt(4)
ds_read_b32 a179, v60
v_mfma_f32_16x16x32_bf16 v[160:163], a[240:243], a[128:131], v[160:163]
s_barrier
ds_read_b128 a[248:251], v16 offset:20480
v_perm_b32 v59, v32, v19, s54
v_mfma_f32_16x16x32_bf16 v[164:167], a[240:243], a[132:135], v[164:167]
ds_read_b32 a180, v59
v_perm_b32 v58, v32, v19, s55
v_mfma_f32_16x16x32_bf16 v[168:171], a[240:243], a[136:139], v[168:171]
ds_read_b32 a181, v58
v_perm_b32 v57, v36, v19, s54
v_mfma_f32_16x16x32_bf16 v[172:175], a[240:243], a[140:143], v[172:175]
s_waitcnt lgkmcnt(4)
ds_read_b32 a182, v57
buffer_load_dwordx4 v[80:83], v12, s[24:27], 0 offen offset:2048 sc1
v_mfma_f32_16x16x32_bf16 v[176:179], a[244:247], a[128:131], v[176:179]
ds_read_b128 a[252:255], v16 offset:22528
v_perm_b32 v56, v36, v19, s55
v_mfma_f32_16x16x32_bf16 v[180:183], a[244:247], a[132:135], v[180:183]
ds_read_b32 a183, v56
v_perm_b32 v63, v33, v19, s52
v_mfma_f32_16x16x32_bf16 v[184:187], a[244:247], a[136:139], v[184:187]
ds_read_b32 a184, v63
v_perm_b32 v62, v33, v19, s53
v_mfma_f32_16x16x32_bf16 v[188:191], a[244:247], a[140:143], v[188:191]
s_waitcnt lgkmcnt(4)
ds_read_b32 a185, v62
buffer_load_dwordx4 v[84:87], v12, s[24:27], 0 offen offset:3072 sc1
v_mfma_f32_16x16x32_bf16 v[128:131], a[248:251], a[160:163], v[128:131]
ds_read_b128 a[224:227], v17 offset:16384
v_perm_b32 v61, v37, v19, s52
v_mfma_f32_16x16x32_bf16 v[132:135], a[248:251], a[164:167], v[132:135]
ds_read_b32 a186, v61
v_perm_b32 v60, v37, v19, s53
v_mfma_f32_16x16x32_bf16 v[136:139], a[248:251], a[168:171], v[136:139]
s_add_u32 m0, s33, 96896
ds_read_b32 a187, v60
v_perm_b32 v59, v33, v19, s54
v_mfma_f32_16x16x32_bf16 v[140:143], a[248:251], a[172:175], v[140:143]
s_waitcnt lgkmcnt(4)
ds_read_b32 a188, v59
v_perm_b32 v58, v33, v19, s55
v_mfma_f32_16x16x32_bf16 v[144:147], a[252:255], a[160:163], v[144:147]
ds_read_b128 a[228:231], v17 offset:18432
buffer_load_dwordx4 v11, s[20:23], 0 offen offset:1408 lds
v_mfma_f32_16x16x32_bf16 v[148:151], a[252:255], a[164:167], v[148:151]
ds_read_b32 a189, v58
v_perm_b32 v57, v37, v19, s54
v_mfma_f32_16x16x32_bf16 v[152:155], a[252:255], a[168:171], v[152:155]
s_waitcnt vmcnt(13)
v_cmp_ne_u64 s[50:51], s[88:89], v[42:43]
v_cmp_ne_u64 s[44:45], s[88:89], v[46:47]
v_mfma_f32_16x16x32_bf16 v[156:159], a[252:255], a[172:175], v[156:159]
s_waitcnt lgkmcnt(3)
ds_read_b32 a190, v57
v_add_u32 v12, 61440, v13
v_mfma_f32_16x16x32_bf16 v[160:163], a[224:227], a[144:147], v[160:163]
s_or_b64 s[50:51], s[44:45], s[50:51]
ds_read_b128 a[232:235], v17 offset:8192
v_perm_b32 v56, v37, v19, s55
v_mfma_f32_16x16x32_bf16 v[164:167], a[224:227], a[148:151], v[164:167]
s_cbranch_scc1 L_SLOW26
L_BACK26:
v_mfma_f32_16x16x32_bf16 v[168:171], a[224:227], a[152:155], v[168:171]
ds_read_b32 a191, v56
v_perm_b32 v63, v40, v19, s52
v_mfma_f32_16x16x32_bf16 v[172:175], a[224:227], a[156:159], v[172:175]
s_waitcnt lgkmcnt(3)
ds_read_b32 a192, v63
v_mfma_f32_16x16x32_bf16 v[176:179], a[228:231], a[144:147], v[176:179]
ds_read_b128 a[236:239], v17 offset:10240
v_perm_b32 v62, v40, v19, s53
v_mfma_f32_16x16x32_bf16 v[180:183], a[228:231], a[148:151], v[180:183]
ds_read_b32 a193, v62
v_perm_b32 v61, v44, v19, s52
v_mfma_f32_16x16x32_bf16 v[184:187], a[228:231], a[152:155], v[184:187]
s_add_u32 m0, s33, 100480
ds_read_b32 a194, v61
v_perm_b32 v60, v44, v19, s53
v_mfma_f32_16x16x32_bf16 v[188:191], a[228:231], a[156:159], v[188:191]
s_waitcnt lgkmcnt(4)
ds_read_b32 a195, v60
v_perm_b32 v59, v40, v19, s54
v_mfma_f32_16x16x32_bf16 v[192:195], a[232:235], a[112:115], v[192:195]
ds_read_b128 a[240:243], v17 offset:20480
buffer_load_dwordx4 v9, s[20:23], 0 offen offset:1920 lds
v_mfma_f32_16x16x32_bf16 v[196:199], a[232:235], a[116:119], v[196:199]
ds_read_b32 a196, v59
v_perm_b32 v58, v40, v19, s55
v_mfma_f32_16x16x32_bf16 v[200:203], a[232:235], a[120:123], v[200:203]
ds_read_b32 a197, v58
v_perm_b32 v57, v44, v19, s54
v_mfma_f32_16x16x32_bf16 v[204:207], a[232:235], a[124:127], v[204:207]
s_waitcnt lgkmcnt(4)
ds_read_b32 a198, v57
buffer_load_dwordx4 v[88:91], v12, s[24:27], 0 offen offset:0 sc1
v_mfma_f32_16x16x32_bf16 v[208:211], a[236:239], a[112:115], v[208:211]
ds_read_b128 a[244:247], v17 offset:22528
v_perm_b32 v56, v44, v19, s55
v_mfma_f32_16x16x32_bf16 v[212:215], a[236:239], a[116:119], v[212:215]
ds_read_b32 a199, v56
v_perm_b32 v63, v41, v19, s52
v_mfma_f32_16x16x32_bf16 v[216:219], a[236:239], a[120:123], v[216:219]
ds_read_b32 a200, v63
v_perm_b32 v62, v41, v19, s53
v_mfma_f32_16x16x32_bf16 v[220:223], a[236:239], a[124:127], v[220:223]
s_waitcnt lgkmcnt(4)
ds_read_b32 a201, v62
buffer_load_dwordx4 v[92:95], v12, s[24:27], 0 offen offset:1024 sc1
v_mfma_f32_16x16x32_bf16 v[128:131], a[240:243], a[176:179], v[128:131]
ds_read_b128 a[248:251], v17 offset:12288
v_perm_b32 v61, v45, v19, s52
v_mfma_f32_16x16x32_bf16 v[132:135], a[240:243], a[180:183], v[132:135]
ds_read_b32 a202, v61
v_perm_b32 v60, v45, v19, s53
v_mfma_f32_16x16x32_bf16 v[136:139], a[240:243], a[184:187], v[136:139]
s_add_u32 m0, s33, 104704
ds_read_b32 a203, v60
v_perm_b32 v59, v41, v19, s54
v_mfma_f32_16x16x32_bf16 v[140:143], a[240:243], a[188:191], v[140:143]
s_waitcnt lgkmcnt(4)
ds_read_b32 a204, v59
v_perm_b32 v58, v41, v19, s55
v_mfma_f32_16x16x32_bf16 v[144:147], a[244:247], a[176:179], v[144:147]
ds_read_b128 a[252:255], v17 offset:14336
buffer_load_dwordx4 v10, s[20:23], 0 offen offset:1792 lds
v_mfma_f32_16x16x32_bf16 v[148:151], a[244:247], a[180:183], v[148:151]
ds_read_b32 a205, v58
v_perm_b32 v57, v45, v19, s54
v_mfma_f32_16x16x32_bf16 v[152:155], a[244:247], a[184:187], v[152:155]
s_waitcnt vmcnt(13)
v_cmp_ne_u64 s[50:51], s[88:89], v[50:51]
v_cmp_ne_u64 s[44:45], s[88:89], v[54:55]
v_mfma_f32_16x16x32_bf16 v[156:159], a[244:247], a[188:191], v[156:159]
s_waitcnt lgkmcnt(3)
ds_read_b32 a206, v57
v_mfma_f32_16x16x32_bf16 v[224:227], a[248:251], a[80:83], v[224:227]
s_or_b64 s[50:51], s[44:45], s[50:51]
ds_read_b128 a[224:227], v16 offset:24576
v_perm_b32 v56, v45, v19, s55
v_mfma_f32_16x16x32_bf16 v[228:231], a[248:251], a[84:87], v[228:231]
s_cbranch_scc1 L_SLOW27
L_BACK27:
v_mfma_f32_16x16x32_bf16 v[232:235], a[248:251], a[88:91], v[232:235]
ds_read_b32 a207, v56
v_perm_b32 v63, v48, v19, s52
v_mfma_f32_16x16x32_bf16 v[236:239], a[248:251], a[92:95], v[236:239]
s_waitcnt lgkmcnt(3)
ds_read_b32 a208, v63
v_mfma_f32_16x16x32_bf16 v[240:243], a[252:255], a[80:83], v[240:243]
ds_read_b128 a[228:231], v16 offset:26624
v_perm_b32 v62, v48, v19, s53
v_mfma_f32_16x16x32_bf16 v[244:247], a[252:255], a[84:87], v[244:247]
ds_read_b32 a209, v62
v_perm_b32 v61, v52, v19, s52
v_mfma_f32_16x16x32_bf16 v[248:251], a[252:255], a[88:91], v[248:251]
s_add_u32 m0, s33, 109056
ds_read_b32 a210, v61
v_perm_b32 v60, v52, v19, s53
v_mfma_f32_16x16x32_bf16 v[252:255], a[252:255], a[92:95], v[252:255]
s_waitcnt lgkmcnt(4)
ds_read_b32 a211, v60
v_perm_b32 v59, v48, v19, s54
v_mfma_f32_16x16x32_bf16 v[160:163], a[224:227], a[160:163], v[160:163]
ds_read_b128 a[232:235], v16 offset:28672
buffer_load_dwordx4 v11, s[20:23], 0 offen offset:1536 lds
v_mfma_f32_16x16x32_bf16 v[164:167], a[224:227], a[164:167], v[164:167]
ds_read_b32 a212, v59
v_perm_b32 v58, v48, v19, s55
v_mfma_f32_16x16x32_bf16 v[168:171], a[224:227], a[168:171], v[168:171]
ds_read_b32 a213, v58
v_perm_b32 v57, v52, v19, s54
v_mfma_f32_16x16x32_bf16 v[172:175], a[224:227], a[172:175], v[172:175]
s_waitcnt lgkmcnt(4)
ds_read_b32 a214, v57
v_mfma_f32_16x16x32_bf16 v[176:179], a[228:231], a[160:163], v[176:179]
ds_read_b128 a[236:239], v16 offset:30720
v_perm_b32 v56, v52, v19, s55
v_mfma_f32_16x16x32_bf16 v[180:183], a[228:231], a[164:167], v[180:183]
ds_read_b32 a215, v56
v_perm_b32 v63, v49, v19, s52
v_mfma_f32_16x16x32_bf16 v[184:187], a[228:231], a[168:171], v[184:187]
ds_read_b32 a216, v63
v_perm_b32 v62, v49, v19, s53
v_mfma_f32_16x16x32_bf16 v[188:191], a[228:231], a[172:175], v[188:191]
s_waitcnt lgkmcnt(4)
ds_read_b32 a217, v62
v_mfma_f32_16x16x32_bf16 v[128:131], a[232:235], a[192:195], v[128:131]
ds_read_b128 a[240:243], v14 offset:0
v_perm_b32 v61, v53, v19, s52
v_mfma_f32_16x16x32_bf16 v[132:135], a[232:235], a[196:199], v[132:135]
ds_read_b32 a218, v61
v_perm_b32 v60, v53, v19, s53
v_mfma_f32_16x16x32_bf16 v[136:139], a[232:235], a[200:203], v[136:139]
s_add_u32 m0, s33, 112768
ds_read_b32 a219, v60
v_perm_b32 v59, v49, v19, s54
v_mfma_f32_16x16x32_bf16 v[140:143], a[232:235], a[204:207], v[140:143]
s_waitcnt vmcnt(10) lgkmcnt(4)
v_cmp_ne_u64 s[50:51], s[88:89], v[98:99]
v_cmp_ne_u64 s[44:45], s[88:89], v[102:103]
v_mfma_f32_16x16x32_bf16 v[144:147], a[236:239], a[192:195], v[144:147]
ds_read_b128 a[244:247], v14 offset:2048
buffer_load_dwordx4 v10, s[20:23], 0 offen offset:1920 lds
v_mfma_f32_16x16x32_bf16 v[148:151], a[236:239], a[196:199], v[148:151]
ds_read_b32 a220, v59
v_perm_b32 v58, v49, v19, s55
v_mfma_f32_16x16x32_bf16 v[152:155], a[236:239], a[200:203], v[152:155]
s_or_b64 s[50:51], s[44:45], s[50:51]
ds_read_b32 a221, v58
v_perm_b32 v57, v53, v19, s54
v_mfma_f32_16x16x32_bf16 v[156:159], a[236:239], a[204:207], v[156:159]
s_waitcnt lgkmcnt(3)
ds_read_b32 a222, v57
buffer_load_dwordx4 v[32:35], v12, s[24:27], 0 offen offset:2048 sc1
v_mfma_f32_16x16x32_bf16 v[192:195], a[240:243], a[128:131], v[192:195]
s_barrier
ds_read_b128 a[248:251], v17 offset:24576
v_perm_b32 v56, v53, v19, s55
v_mfma_f32_16x16x32_bf16 v[196:199], a[240:243], a[132:135], v[196:199]
s_cbranch_scc1 L_SLOW28
L_BACK28:
v_mfma_f32_16x16x32_bf16 v[200:203], a[240:243], a[136:139], v[200:203]
ds_read_b32 a223, v56
v_perm_b32 v63, v96, v19, s52
v_mfma_f32_16x16x32_bf16 v[204:207], a[240:243], a[140:143], v[204:207]
s_waitcnt lgkmcnt(3)
ds_read_b32 a0, v63
buffer_load_dwordx4 v[36:39], v12, s[24:27], 0 offen offset:3072 sc1
v_mfma_f32_16x16x32_bf16 v[208:211], a[244:247], a[128:131], v[208:211]
ds_read_b128 a[252:255], v17 offset:26624
v_perm_b32 v62, v96, v19, s53
v_mfma_f32_16x16x32_bf16 v[212:215], a[244:247], a[132:135], v[212:215]
ds_read_b32 a1, v62
v_perm_b32 v61, v100, v19, s52
v_mfma_f32_16x16x32_bf16 v[216:219], a[244:247], a[136:139], v[216:219]
s_add_u32 m0, s33, 117120
ds_read_b32 a2, v61
v_perm_b32 v60, v100, v19, s53
v_mfma_f32_16x16x32_bf16 v[220:223], a[244:247], a[140:143], v[220:223]
s_waitcnt lgkmcnt(4)
ds_read_b32 a3, v60
v_perm_b32 v59, v96, v19, s54
v_mfma_f32_16x16x32_bf16 v[160:163], a[248:251], a[176:179], v[160:163]
ds_read_b128 a[224:227], v17 offset:28672
buffer_load_dwordx4 v11, s[20:23], 0 offen offset:1664 lds
v_mfma_f32_16x16x32_bf16 v[164:167], a[248:251], a[180:183], v[164:167]
ds_read_b32 a4, v59
v_perm_b32 v58, v96, v19, s55
v_mfma_f32_16x16x32_bf16 v[168:171], a[248:251], a[184:187], v[168:171]
ds_read_b32 a5, v58
v_perm_b32 v57, v100, v19, s54
v_mfma_f32_16x16x32_bf16 v[172:175], a[248:251], a[188:191], v[172:175]
s_waitcnt lgkmcnt(4)
ds_read_b32 a6, v57
v_mfma_f32_16x16x32_bf16 v[176:179], a[252:255], a[176:179], v[176:179]
ds_read_b128 a[228:231], v17 offset:30720
v_perm_b32 v56, v100, v19, s55
v_mfma_f32_16x16x32_bf16 v[180:183], a[252:255], a[180:183], v[180:183]
ds_read_b32 a7, v56
v_perm_b32 v63, v97, v19, s52
v_mfma_f32_16x16x32_bf16 v[184:187], a[252:255], a[184:187], v[184:187]
ds_read_b32 a8, v63
v_perm_b32 v62, v97, v19, s53
v_mfma_f32_16x16x32_bf16 v[188:191], a[252:255], a[188:191], v[188:191]
s_waitcnt lgkmcnt(4)
ds_read_b32 a9, v62
v_mfma_f32_16x16x32_bf16 v[128:131], a[224:227], a[208:211], v[128:131]
ds_read_b128 a[232:235], v15 offset:0
v_perm_b32 v61, v101, v19, s52
v_mfma_f32_16x16x32_bf16 v[132:135], a[224:227], a[212:215], v[132:135]
ds_read_b32 a10, v61
v_perm_b32 v60, v101, v19, s53
v_mfma_f32_16x16x32_bf16 v[136:139], a[224:227], a[216:219], v[136:139]
s_add_u32 m0, s33, 121088
ds_read_b32 a11, v60
v_perm_b32 v59, v97, v19, s54
v_mfma_f32_16x16x32_bf16 v[140:143], a[224:227], a[220:223], v[140:143]
s_waitcnt lgkmcnt(4)
ds_read_b32 a12, v59
v_perm_b32 v58, v97, v19, s55
v_mfma_f32_16x16x32_bf16 v[144:147], a[228:231], a[208:211], v[144:147]
ds_read_b128 a[236:239], v15 offset:2048
buffer_load_dwordx4 v11, s[20:23], 0 offen offset:1792 lds
v_mfma_f32_16x16x32_bf16 v[148:151], a[228:231], a[212:215], v[148:151]
ds_read_b32 a13, v58
v_perm_b32 v57, v101, v19, s54
v_mfma_f32_16x16x32_bf16 v[152:155], a[228:231], a[216:219], v[152:155]
s_waitcnt vmcnt(11)
v_cmp_ne_u64 s[50:51], s[88:89], v[82:83]
v_cmp_ne_u64 s[44:45], s[88:89], v[86:87]
v_mfma_f32_16x16x32_bf16 v[156:159], a[228:231], a[220:223], v[156:159]
s_waitcnt lgkmcnt(3)
ds_read_b32 a14, v57
v_mfma_f32_16x16x32_bf16 v[192:195], a[232:235], a[144:147], v[192:195]
s_or_b64 s[50:51], s[44:45], s[50:51]
ds_read_b128 a[240:243], v14 offset:4096
v_perm_b32 v56, v101, v19, s55
v_mfma_f32_16x16x32_bf16 v[196:199], a[232:235], a[148:151], v[196:199]
s_cbranch_scc1 L_SLOW29
L_BACK29:
v_mfma_f32_16x16x32_bf16 v[200:203], a[232:235], a[152:155], v[200:203]
ds_read_b32 a15, v56
v_perm_b32 v63, v80, v19, s52
v_mfma_f32_16x16x32_bf16 v[204:207], a[232:235], a[156:159], v[204:207]
s_waitcnt lgkmcnt(3)
ds_read_b32 a16, v63
v_mfma_f32_16x16x32_bf16 v[208:211], a[236:239], a[144:147], v[208:211]
ds_read_b128 a[244:247], v14 offset:6144
v_perm_b32 v62, v80, v19, s53
v_mfma_f32_16x16x32_bf16 v[212:215], a[236:239], a[148:151], v[212:215]
ds_read_b32 a17, v62
v_perm_b32 v61, v84, v19, s52
v_mfma_f32_16x16x32_bf16 v[216:219], a[236:239], a[152:155], v[216:219]
s_add_u32 m0, s33, 125056
ds_read_b32 a18, v61
v_perm_b32 v60, v84, v19, s53
v_mfma_f32_16x16x32_bf16 v[220:223], a[236:239], a[156:159], v[220:223]
s_waitcnt lgkmcnt(4)
ds_read_b32 a19, v60
v_perm_b32 v59, v80, v19, s54
v_mfma_f32_16x16x32_bf16 v[224:227], a[240:243], a[96:99], v[224:227]
ds_read_b128 a[248:251], v14 offset:8192
buffer_load_dwordx4 v11, s[20:23], 0 offen offset:1920 lds
v_mfma_f32_16x16x32_bf16 v[228:231], a[240:243], a[100:103], v[228:231]
ds_read_b32 a20, v59
v_perm_b32 v58, v80, v19, s55
v_mfma_f32_16x16x32_bf16 v[232:235], a[240:243], a[104:107], v[232:235]
ds_read_b32 a21, v58
v_perm_b32 v57, v84, v19, s54
v_mfma_f32_16x16x32_bf16 v[236:239], a[240:243], a[108:111], v[236:239]
s_waitcnt lgkmcnt(4)
ds_read_b32 a22, v57
v_mfma_f32_16x16x32_bf16 v[240:243], a[244:247], a[96:99], v[240:243]
ds_read_b128 a[252:255], v14 offset:10240
v_perm_b32 v56, v84, v19, s55
v_mfma_f32_16x16x32_bf16 v[244:247], a[244:247], a[100:103], v[244:247]
ds_read_b32 a23, v56
v_perm_b32 v63, v81, v19, s52
v_mfma_f32_16x16x32_bf16 v[248:251], a[244:247], a[104:107], v[248:251]
ds_read_b32 a24, v63
v_perm_b32 v62, v81, v19, s53
v_mfma_f32_16x16x32_bf16 v[252:255], a[244:247], a[108:111], v[252:255]
s_waitcnt lgkmcnt(4)
ds_read_b32 a25, v62
v_mfma_f32_16x16x32_bf16 v[128:131], a[248:251], a[0:3], v[128:131]
ds_read_b128 a[224:227], v14 offset:12288
v_perm_b32 v61, v85, v19, s52
v_mfma_f32_16x16x32_bf16 v[132:135], a[248:251], a[4:7], v[132:135]
ds_read_b32 a26, v61
v_perm_b32 v60, v85, v19, s53
v_mfma_f32_16x16x32_bf16 v[136:139], a[248:251], a[8:11], v[136:139]
ds_read_b32 a27, v60
v_perm_b32 v59, v81, v19, s54
v_mfma_f32_16x16x32_bf16 v[140:143], a[248:251], a[12:15], v[140:143]
s_waitcnt lgkmcnt(4)
ds_read_b32 a28, v59
v_mfma_f32_16x16x32_bf16 v[144:147], a[252:255], a[0:3], v[144:147]
ds_read_b128 a[228:231], v14 offset:14336
v_perm_b32 v58, v81, v19, s55
v_mfma_f32_16x16x32_bf16 v[148:151], a[252:255], a[4:7], v[148:151]
ds_read_b32 a29, v58
v_perm_b32 v57, v85, v19, s54
v_mfma_f32_16x16x32_bf16 v[152:155], a[252:255], a[8:11], v[152:155]
ds_read_b32 a30, v57
v_mfma_f32_16x16x32_bf16 v[156:159], a[252:255], a[12:15], v[156:159]
s_waitcnt vmcnt(8) lgkmcnt(4)
v_cmp_ne_u64 s[50:51], s[88:89], v[90:91]
v_cmp_ne_u64 s[44:45], s[88:89], v[94:95]
v_mfma_f32_16x16x32_bf16 v[160:163], a[224:227], a[192:195], v[160:163]
ds_read_b128 a[232:235], v15 offset:8192
v_perm_b32 v56, v85, v19, s55
v_mfma_f32_16x16x32_bf16 v[164:167], a[224:227], a[196:199], v[164:167]
s_or_b64 s[50:51], s[44:45], s[50:51]
ds_read_b32 a31, v56
v_mfma_f32_16x16x32_bf16 v[168:171], a[224:227], a[200:203], v[168:171]
s_cbranch_scc1 L_SLOW30
L_BACK30:
v_mfma_f32_16x16x32_bf16 v[172:175], a[224:227], a[204:207], v[172:175]
s_waitcnt lgkmcnt(2)
v_mfma_f32_16x16x32_bf16 v[176:179], a[228:231], a[192:195], v[176:179]
ds_read_b128 a[236:239], v15 offset:10240
v_mfma_f32_16x16x32_bf16 v[180:183], a[228:231], a[196:199], v[180:183]
v_perm_b32 v63, v88, v19, s52
v_mfma_f32_16x16x32_bf16 v[184:187], a[228:231], a[200:203], v[184:187]
ds_read_b32 a32, v63
v_perm_b32 v62, v88, v19, s53
v_mfma_f32_16x16x32_bf16 v[188:191], a[228:231], a[204:207], v[188:191]
s_waitcnt lgkmcnt(2)
ds_read_b32 a33, v62
v_mfma_f32_16x16x32_bf16 v[128:131], a[232:235], a[16:19], v[128:131]
ds_read_b128 a[240:243], v15 offset:12288
v_perm_b32 v61, v92, v19, s52
v_mfma_f32_16x16x32_bf16 v[132:135], a[232:235], a[20:23], v[132:135]
ds_read_b32 a34, v61
v_perm_b32 v60, v92, v19, s53
v_mfma_f32_16x16x32_bf16 v[136:139], a[232:235], a[24:27], v[136:139]
ds_read_b32 a35, v60
v_perm_b32 v59, v88, v19, s54
v_mfma_f32_16x16x32_bf16 v[140:143], a[232:235], a[28:31], v[140:143]
s_waitcnt lgkmcnt(4)
ds_read_b32 a36, v59
v_mfma_f32_16x16x32_bf16 v[144:147], a[236:239], a[16:19], v[144:147]
ds_read_b128 a[244:247], v15 offset:14336
v_perm_b32 v58, v88, v19, s55
v_mfma_f32_16x16x32_bf16 v[148:151], a[236:239], a[20:23], v[148:151]
ds_read_b32 a37, v58
v_perm_b32 v57, v92, v19, s54
v_mfma_f32_16x16x32_bf16 v[152:155], a[236:239], a[24:27], v[152:155]
ds_read_b32 a38, v57
v_perm_b32 v56, v92, v19, s55
v_mfma_f32_16x16x32_bf16 v[156:159], a[236:239], a[28:31], v[156:159]
s_waitcnt lgkmcnt(4)
ds_read_b32 a39, v56
v_mfma_f32_16x16x32_bf16 v[160:163], a[240:243], a[208:211], v[160:163]
s_barrier
ds_read_b128 a[248:251], v14 offset:16384
v_perm_b32 v63, v89, v19, s52
v_mfma_f32_16x16x32_bf16 v[164:167], a[240:243], a[212:215], v[164:167]
ds_read_b32 a40, v63
v_perm_b32 v62, v89, v19, s53
v_mfma_f32_16x16x32_bf16 v[168:171], a[240:243], a[216:219], v[168:171]
ds_read_b32 a41, v62
v_perm_b32 v61, v93, v19, s52
v_mfma_f32_16x16x32_bf16 v[172:175], a[240:243], a[220:223], v[172:175]
s_waitcnt lgkmcnt(4)
ds_read_b32 a42, v61
v_mfma_f32_16x16x32_bf16 v[176:179], a[244:247], a[208:211], v[176:179]
ds_read_b128 a[252:255], v14 offset:18432
v_perm_b32 v60, v93, v19, s53
v_mfma_f32_16x16x32_bf16 v[180:183], a[244:247], a[212:215], v[180:183]
ds_read_b32 a43, v60
v_perm_b32 v59, v89, v19, s54
v_mfma_f32_16x16x32_bf16 v[184:187], a[244:247], a[216:219], v[184:187]
ds_read_b32 a44, v59
v_perm_b32 v58, v89, v19, s55
v_mfma_f32_16x16x32_bf16 v[188:191], a[244:247], a[220:223], v[188:191]
s_waitcnt lgkmcnt(4)
ds_read_b32 a45, v58
v_mfma_f32_16x16x32_bf16 v[192:195], a[248:251], a[160:163], v[192:195]
ds_read_b128 a[224:227], v14 offset:20480
v_perm_b32 v57, v93, v19, s54
v_mfma_f32_16x16x32_bf16 v[196:199], a[248:251], a[164:167], v[196:199]
ds_read_b32 a46, v57
v_perm_b32 v56, v93, v19, s55
v_mfma_f32_16x16x32_bf16 v[200:203], a[248:251], a[168:171], v[200:203]
ds_read_b32 a47, v56
v_mfma_f32_16x16x32_bf16 v[204:207], a[248:251], a[172:175], v[204:207]
s_waitcnt lgkmcnt(4)
v_mfma_f32_16x16x32_bf16 v[208:211], a[252:255], a[160:163], v[208:211]
ds_read_b128 a[228:231], v14 offset:22528
v_mfma_f32_16x16x32_bf16 v[212:215], a[252:255], a[164:167], v[212:215]
v_mfma_f32_16x16x32_bf16 v[216:219], a[252:255], a[168:171], v[216:219]
v_mfma_f32_16x16x32_bf16 v[220:223], a[252:255], a[172:175], v[220:223]
s_waitcnt vmcnt(3) lgkmcnt(1)
v_cmp_ne_u64 s[50:51], s[88:89], v[34:35]
v_cmp_ne_u64 s[44:45], s[88:89], v[38:39]
v_mfma_f32_16x16x32_bf16 v[128:131], a[224:227], a[32:35], v[128:131]
ds_read_b128 a[232:235], v15 offset:4096
v_mfma_f32_16x16x32_bf16 v[132:135], a[224:227], a[36:39], v[132:135]
s_or_b64 s[50:51], s[44:45], s[50:51]
v_mfma_f32_16x16x32_bf16 v[136:139], a[224:227], a[40:43], v[136:139]
s_cbranch_scc1 L_SLOW31
L_BACK31:
v_mfma_f32_16x16x32_bf16 v[140:143], a[224:227], a[44:47], v[140:143]
s_waitcnt lgkmcnt(1)
v_mfma_f32_16x16x32_bf16 v[144:147], a[228:231], a[32:35], v[144:147]
ds_read_b128 a[236:239], v15 offset:6144
v_mfma_f32_16x16x32_bf16 v[148:151], a[228:231], a[36:39], v[148:151]
v_perm_b32 v63, v32, v19, s52
v_mfma_f32_16x16x32_bf16 v[152:155], a[228:231], a[40:43], v[152:155]
ds_read_b32 a48, v63
v_perm_b32 v62, v32, v19, s53
v_mfma_f32_16x16x32_bf16 v[156:159], a[228:231], a[44:47], v[156:159]
s_waitcnt lgkmcnt(2)
ds_read_b32 a49, v62
v_mfma_f32_16x16x32_bf16 v[224:227], a[232:235], a[112:115], v[224:227]
ds_read_b128 a[240:243], v14 offset:24576
v_perm_b32 v61, v36, v19, s52
v_mfma_f32_16x16x32_bf16 v[228:231], a[232:235], a[116:119], v[228:231]
ds_read_b32 a50, v61
v_perm_b32 v60, v36, v19, s53
v_mfma_f32_16x16x32_bf16 v[232:235], a[232:235], a[120:123], v[232:235]
ds_read_b32 a51, v60
v_perm_b32 v59, v32, v19, s54
v_mfma_f32_16x16x32_bf16 v[236:239], a[232:235], a[124:127], v[236:239]
s_waitcnt lgkmcnt(4)
ds_read_b32 a52, v59
v_mfma_f32_16x16x32_bf16 v[240:243], a[236:239], a[112:115], v[240:243]
ds_read_b128 a[244:247], v14 offset:26624
v_perm_b32 v58, v32, v19, s55
v_mfma_f32_16x16x32_bf16 v[244:247], a[236:239], a[116:119], v[244:247]
ds_read_b32 a53, v58
v_perm_b32 v57, v36, v19, s54
v_mfma_f32_16x16x32_bf16 v[248:251], a[236:239], a[120:123], v[248:251]
ds_read_b32 a54, v57
v_perm_b32 v56, v36, v19, s55
v_mfma_f32_16x16x32_bf16 v[252:255], a[236:239], a[124:127], v[252:255]
s_waitcnt lgkmcnt(4)
ds_read_b32 a55, v56
v_mfma_f32_16x16x32_bf16 v[160:163], a[240:243], a[0:3], v[160:163]
ds_read_b128 a[248:251], v15 offset:16384
v_perm_b32 v63, v33, v19, s52
v_mfma_f32_16x16x32_bf16 v[164:167], a[240:243], a[4:7], v[164:167]
ds_read_b32 a56, v63
v_perm_b32 v62, v33, v19, s53
v_mfma_f32_16x16x32_bf16 v[168:171], a[240:243], a[8:11], v[168:171]
ds_read_b32 a57, v62
v_perm_b32 v61, v37, v19, s52
v_mfma_f32_16x16x32_bf16 v[172:175], a[240:243], a[12:15], v[172:175]
s_waitcnt lgkmcnt(4)
ds_read_b32 a58, v61
v_mfma_f32_16x16x32_bf16 v[176:179], a[244:247], a[0:3], v[176:179]
ds_read_b128 a[252:255], v15 offset:18432
v_perm_b32 v60, v37, v19, s53
v_mfma_f32_16x16x32_bf16 v[180:183], a[244:247], a[4:7], v[180:183]
ds_read_b32 a59, v60
v_perm_b32 v59, v33, v19, s54
v_mfma_f32_16x16x32_bf16 v[184:187], a[244:247], a[8:11], v[184:187]
ds_read_b32 a60, v59
v_perm_b32 v58, v33, v19, s55
v_mfma_f32_16x16x32_bf16 v[188:191], a[244:247], a[12:15], v[188:191]
s_waitcnt lgkmcnt(4)
ds_read_b32 a61, v58
v_mfma_f32_16x16x32_bf16 v[192:195], a[248:251], a[176:179], v[192:195]
ds_read_b128 a[224:227], v15 offset:20480
v_perm_b32 v57, v37, v19, s54
v_mfma_f32_16x16x32_bf16 v[196:199], a[248:251], a[180:183], v[196:199]
ds_read_b32 a62, v57
v_perm_b32 v56, v37, v19, s55
v_mfma_f32_16x16x32_bf16 v[200:203], a[248:251], a[184:187], v[200:203]
ds_read_b32 a63, v56
v_mfma_f32_16x16x32_bf16 v[204:207], a[248:251], a[188:191], v[204:207]
s_waitcnt lgkmcnt(4)
v_mfma_f32_16x16x32_bf16 v[208:211], a[252:255], a[176:179], v[208:211]
L_PAD5:
s_cbranch_vccnz L_PADRET
ds_read_b128 a[228:231], v15 offset:22528
v_mfma_f32_16x16x32_bf16 v[212:215], a[252:255], a[180:183], v[212:215]
v_mfma_f32_16x16x32_bf16 v[216:219], a[252:255], a[184:187], v[216:219]
v_mfma_f32_16x16x32_bf16 v[220:223], a[252:255], a[188:191], v[220:223]
s_waitcnt lgkmcnt(1)
v_mfma_f32_16x16x32_bf16 v[128:131], a[224:227], a[48:51], v[128:131]
ds_read_b128 a[232:235], v15 offset:24576
v_mfma_f32_16x16x32_bf16 v[132:135], a[224:227], a[52:55], v[132:135]
v_mfma_f32_16x16x32_bf16 v[136:139], a[224:227], a[56:59], v[136:139]
v_mfma_f32_16x16x32_bf16 v[140:143], a[224:227], a[60:63], v[140:143]
s_waitcnt lgkmcnt(1)
v_mfma_f32_16x16x32_bf16 v[144:147], a[228:231], a[48:51], v[144:147]
ds_read_b128 a[236:239], v15 offset:26624
v_mfma_f32_16x16x32_bf16 v[148:151], a[228:231], a[52:55], v[148:151]
v_mfma_f32_16x16x32_bf16 v[152:155], a[228:231], a[56:59], v[152:155]
v_mfma_f32_16x16x32_bf16 v[156:159], a[228:231], a[60:63], v[156:159]
s_waitcnt lgkmcnt(1)
v_mfma_f32_16x16x32_bf16 v[160:163], a[232:235], a[16:19], v[160:163]
ds_read_b128 a[240:243], v14 offset:28672
v_mfma_f32_16x16x32_bf16 v[164:167], a[232:235], a[20:23], v[164:167]
v_mfma_f32_16x16x32_bf16 v[168:171], a[232:235], a[24:27], v[168:171]
v_mfma_f32_16x16x32_bf16 v[172:175], a[232:235], a[28:31], v[172:175]
s_waitcnt lgkmcnt(1)
v_mul_f32 v128, v128, v24
v_mul_f32 v132, v132, v25
v_mfma_f32_16x16x32_bf16 v[176:179], a[236:239], a[16:19], v[176:179]
s_waitcnt vmcnt(0)
s_barrier
ds_read_b128 a[244:247], v14 offset:30720
v_mul_f32 v136, v136, v26
v_mfma_f32_16x16x32_bf16 v[180:183], a[236:239], a[20:23], v[180:183]
v_mul_f32 v140, v140, v27
v_cvt_pk_bf16_f32 v120, v128, v132
v_mfma_f32_16x16x32_bf16 v[184:187], a[236:239], a[24:27], v[184:187]
v_cvt_pk_bf16_f32 v121, v136, v140
v_mfma_f32_16x16x32_bf16 v[188:191], a[236:239], a[28:31], v[188:191]
s_waitcnt lgkmcnt(1)
v_mfma_f32_16x16x32_bf16 v[192:195], a[240:243], a[192:195], v[192:195]
ds_read_b128 a[248:251], v14 offset:32768
v_mfma_f32_16x16x32_bf16 v[196:199], a[240:243], a[196:199], v[196:199]
buffer_store_dwordx2 v[120:121], v18, s[28:31], 0 offen nt
v_mul_f32 v129, v129, v24
v_mfma_f32_16x16x32_bf16 v[200:203], a[240:243], a[200:203], v[200:203]
s_add_u32 s28, s28, 7168
v_mul_f32 v133, v133, v25
v_mul_f32 v137, v137, v26
v_mfma_f32_16x16x32_bf16 v[204:207], a[240:243], a[204:207], v[204:207]
s_waitcnt lgkmcnt(1)
v_mul_f32 v141, v141, v27
v_cvt_pk_bf16_f32 v122, v129, v133
v_mfma_f32_16x16x32_bf16 v[208:211], a[244:247], a[192:195], v[208:211]
s_addc_u32 s29, s29, 0
ds_read_b128 a[252:255], v14 offset:34816
v_cvt_pk_bf16_f32 v123, v137, v141
v_mfma_f32_16x16x32_bf16 v[212:215], a[244:247], a[196:199], v[212:215]
buffer_store_dwordx2 v[122:123], v18, s[28:31], 0 offen nt
v_mul_f32 v130, v130, v24
v_mfma_f32_16x16x32_bf16 v[216:219], a[244:247], a[200:203], v[216:219]
s_add_u32 s28, s28, 7168
v_mul_f32 v134, v134, v25
v_mul_f32 v138, v138, v26
v_mfma_f32_16x16x32_bf16 v[220:223], a[244:247], a[204:207], v[220:223]
s_waitcnt lgkmcnt(1)
v_mul_f32 v142, v142, v27
v_cvt_pk_bf16_f32 v124, v130, v134
v_mfma_f32_16x16x32_bf16 v[224:227], a[248:251], a[128:131], v[224:227]
s_addc_u32 s29, s29, 0
ds_read_b128 a[224:227], v14 offset:36864
v_cvt_pk_bf16_f32 v125, v138, v142
v_mfma_f32_16x16x32_bf16 v[228:231], a[248:251], a[132:135], v[228:231]
buffer_store_dwordx2 v[124:125], v18, s[28:31], 0 offen nt
v_mul_f32 v131, v131, v24
v_mfma_f32_16x16x32_bf16 v[232:235], a[248:251], a[136:139], v[232:235]
s_add_u32 s28, s28, 7168
v_mul_f32 v135, v135, v25
v_mul_f32 v139, v139, v26
v_mfma_f32_16x16x32_bf16 v[236:239], a[248:251], a[140:143], v[236:239]
s_waitcnt lgkmcnt(1)
v_mul_f32 v143, v143, v27
v_cvt_pk_bf16_f32 v126, v131, v135
v_mfma_f32_16x16x32_bf16 v[240:243], a[252:255], a[128:131], v[240:243]
s_addc_u32 s29, s29, 0
ds_read_b128 a[228:231], v14 offset:38912
v_cvt_pk_bf16_f32 v127, v139, v143
v_mfma_f32_16x16x32_bf16 v[244:247], a[252:255], a[132:135], v[244:247]
buffer_store_dwordx2 v[126:127], v18, s[28:31], 0 offen nt
v_mul_f32 v144, v144, v24
v_mfma_f32_16x16x32_bf16 v[248:251], a[252:255], a[136:139], v[248:251]
s_add_u32 s28, s28, 93184
v_mul_f32 v148, v148, v25
v_mul_f32 v152, v152, v26
v_mfma_f32_16x16x32_bf16 v[252:255], a[252:255], a[140:143], v[252:255]
s_waitcnt lgkmcnt(1)
v_mul_f32 v156, v156, v27
v_cvt_pk_bf16_f32 v120, v144, v148
v_mfma_f32_16x16x32_bf16 v[160:163], a[224:227], a[32:35], v[160:163]
s_addc_u32 s29, s29, 0
ds_read_b128 a[232:235], v15 offset:28672
v_cvt_pk_bf16_f32 v121, v152, v156
v_mfma_f32_16x16x32_bf16 v[164:167], a[224:227], a[36:39], v[164:167]
buffer_store_dwordx2 v[120:121], v18, s[28:31], 0 offen nt
v_mul_f32 v145, v145, v24
v_mfma_f32_16x16x32_bf16 v[168:171], a[224:227], a[40:43], v[168:171]
s_add_u32 s28, s28, 7168
v_mul_f32 v149, v149, v25
v_mul_f32 v153, v153, v26
v_mfma_f32_16x16x32_bf16 v[172:175], a[224:227], a[44:47], v[172:175]
s_waitcnt lgkmcnt(1)
v_mul_f32 v157, v157, v27
v_cvt_pk_bf16_f32 v122, v145, v149
v_mfma_f32_16x16x32_bf16 v[176:179], a[228:231], a[32:35], v[176:179]
s_addc_u32 s29, s29, 0
ds_read_b128 a[236:239], v15 offset:30720
v_cvt_pk_bf16_f32 v123, v153, v157
v_mfma_f32_16x16x32_bf16 v[180:183], a[228:231], a[36:39], v[180:183]
buffer_store_dwordx2 v[122:123], v18, s[28:31], 0 offen nt
v_mul_f32 v146, v146, v24
v_mfma_f32_16x16x32_bf16 v[184:187], a[228:231], a[40:43], v[184:187]
s_add_u32 s28, s28, 7168
v_mul_f32 v150, v150, v25
v_mul_f32 v154, v154, v26
v_mfma_f32_16x16x32_bf16 v[188:191], a[228:231], a[44:47], v[188:191]
s_waitcnt lgkmcnt(1)
v_mul_f32 v158, v158, v27
v_cvt_pk_bf16_f32 v124, v146, v150
v_mfma_f32_16x16x32_bf16 v[192:195], a[232:235], a[208:211], v[192:195]
s_addc_u32 s29, s29, 0
ds_read_b128 a[240:243], v15 offset:36864
v_cvt_pk_bf16_f32 v125, v154, v158
v_mfma_f32_16x16x32_bf16 v[196:199], a[232:235], a[212:215], v[196:199]
buffer_store_dwordx2 v[124:125], v18, s[28:31], 0 offen nt
v_mul_f32 v147, v147, v24
v_mfma_f32_16x16x32_bf16 v[200:203], a[232:235], a[216:219], v[200:203]
s_add_u32 s28, s28, 7168
v_mul_f32 v151, v151, v25
v_mul_f32 v155, v155, v26
v_mfma_f32_16x16x32_bf16 v[204:207], a[232:235], a[220:223], v[204:207]
s_waitcnt lgkmcnt(1)
v_mul_f32 v159, v159, v27
v_cvt_pk_bf16_f32 v126, v147, v151
v_mfma_f32_16x16x32_bf16 v[208:211], a[236:239], a[208:211], v[208:211]
s_addc_u32 s29, s29, 0
ds_read_b128 a[244:247], v15 offset:38912
v_cvt_pk_bf16_f32 v127, v155, v159
v_mfma_f32_16x16x32_bf16 v[212:215], a[236:239], a[212:215], v[212:215]
buffer_store_dwordx2 v[126:127], v18, s[28:31], 0 offen nt
v_mfma_f32_16x16x32_bf16 v[216:219], a[236:239], a[216:219], v[216:219]
v_mfma_f32_16x16x32_bf16 v[220:223], a[236:239], a[220:223], v[220:223]
s_waitcnt lgkmcnt(1)
v_mfma_f32_16x16x32_bf16 v[160:163], a[240:243], a[48:51], v[160:163]
ds_read_b128 a[248:251], v15 offset:32768
v_mfma_f32_16x16x32_bf16 v[164:167], a[240:243], a[52:55], v[164:167]
v_mfma_f32_16x16x32_bf16 v[168:171], a[240:243], a[56:59], v[168:171]
v_mfma_f32_16x16x32_bf16 v[172:175], a[240:243], a[60:63], v[172:175]
s_waitcnt lgkmcnt(1)
v_mfma_f32_16x16x32_bf16 v[176:179], a[244:247], a[48:51], v[176:179]
ds_read_b128 a[252:255], v15 offset:34816
v_mfma_f32_16x16x32_bf16 v[180:183], a[244:247], a[52:55], v[180:183]
v_mfma_f32_16x16x32_bf16 v[184:187], a[244:247], a[56:59], v[184:187]
v_mfma_f32_16x16x32_bf16 v[188:191], a[244:247], a[60:63], v[188:191]
s_waitcnt lgkmcnt(1)
v_mfma_f32_16x16x32_bf16 v[224:227], a[248:251], a[144:147], v[224:227]
ds_read_b128 a[224:227], v14 offset:40960
v_mfma_f32_16x16x32_bf16 v[228:231], a[248:251], a[148:151], v[228:231]
v_mfma_f32_16x16x32_bf16 v[232:235], a[248:251], a[152:155], v[232:235]
v_mfma_f32_16x16x32_bf16 v[236:239], a[248:251], a[156:159], v[236:239]
s_waitcnt lgkmcnt(1)
v_mul_f32 v160, v160, v24
v_mul_f32 v164, v164, v25
v_mfma_f32_16x16x32_bf16 v[240:243], a[252:255], a[144:147], v[240:243]
s_add_u32 s28, s28, 93184
ds_read_b128 a[228:231], v14 offset:43008
v_mul_f32 v168, v168, v26
v_mfma_f32_16x16x32_bf16 v[244:247], a[252:255], a[148:151], v[244:247]
s_addc_u32 s29, s29, 0
v_mul_f32 v172, v172, v27
v_cvt_pk_bf16_f32 v120, v160, v164
v_mfma_f32_16x16x32_bf16 v[248:251], a[252:255], a[152:155], v[248:251]
v_cvt_pk_bf16_f32 v121, v168, v172
v_mfma_f32_16x16x32_bf16 v[252:255], a[252:255], a[156:159], v[252:255]
s_waitcnt lgkmcnt(1)
v_mfma_f32_16x16x32_bf16 v[192:195], a[224:227], a[0:3], v[192:195]
ds_read_b128 a[232:235], v15 offset:40960
v_mfma_f32_16x16x32_bf16 v[196:199], a[224:227], a[4:7], v[196:199]
buffer_store_dwordx2 v[120:121], v18, s[28:31], 0 offen nt
v_mul_f32 v161, v161, v24
v_mfma_f32_16x16x32_bf16 v[200:203], a[224:227], a[8:11], v[200:203]
s_add_u32 s28, s28, 7168
v_mul_f32 v165, v165, v25
v_mul_f32 v169, v169, v26
v_mfma_f32_16x16x32_bf16 v[204:207], a[224:227], a[12:15], v[204:207]
s_waitcnt lgkmcnt(1)
v_mul_f32 v173, v173, v27
v_cvt_pk_bf16_f32 v122, v161, v165
v_mfma_f32_16x16x32_bf16 v[208:211], a[228:231], a[0:3], v[208:211]
s_addc_u32 s29, s29, 0
ds_read_b128 a[236:239], v15 offset:43008
v_cvt_pk_bf16_f32 v123, v169, v173
v_mfma_f32_16x16x32_bf16 v[212:215], a[228:231], a[4:7], v[212:215]
buffer_store_dwordx2 v[122:123], v18, s[28:31], 0 offen nt
v_mul_f32 v162, v162, v24
v_mfma_f32_16x16x32_bf16 v[216:219], a[228:231], a[8:11], v[216:219]
s_add_u32 s28, s28, 7168
v_mul_f32 v166, v166, v25
v_mul_f32 v170, v170, v26
v_mfma_f32_16x16x32_bf16 v[220:223], a[228:231], a[12:15], v[220:223]
s_waitcnt lgkmcnt(1)
v_mul_f32 v174, v174, v27
v_cvt_pk_bf16_f32 v124, v162, v166
v_mfma_f32_16x16x32_bf16 v[192:195], a[232:235], a[16:19], v[192:195]
s_addc_u32 s29, s29, 0
ds_read_b128 a[240:243], v14 offset:45056
v_cvt_pk_bf16_f32 v125, v170, v174
v_mfma_f32_16x16x32_bf16 v[196:199], a[232:235], a[20:23], v[196:199]
buffer_store_dwordx2 v[124:125], v18, s[28:31], 0 offen nt
v_mul_f32 v163, v163, v24
v_mfma_f32_16x16x32_bf16 v[200:203], a[232:235], a[24:27], v[200:203]
s_add_u32 s28, s28, 7168
v_mul_f32 v167, v167, v25
v_mul_f32 v171, v171, v26
v_mfma_f32_16x16x32_bf16 v[204:207], a[232:235], a[28:31], v[204:207]
s_waitcnt lgkmcnt(1)
v_mul_f32 v175, v175, v27
v_cvt_pk_bf16_f32 v126, v163, v167
v_mfma_f32_16x16x32_bf16 v[208:211], a[236:239], a[16:19], v[208:211]
s_addc_u32 s29, s29, 0
ds_read_b128 a[244:247], v14 offset:47104
v_cvt_pk_bf16_f32 v127, v171, v175
v_mfma_f32_16x16x32_bf16 v[212:215], a[236:239], a[20:23], v[212:215]
buffer_store_dwordx2 v[126:127], v18, s[28:31], 0 offen nt
v_mul_f32 v176, v176, v24
v_mfma_f32_16x16x32_bf16 v[216:219], a[236:239], a[24:27], v[216:219]
s_add_u32 s28, s28, 93184
v_mul_f32 v180, v180, v25
v_mul_f32 v184, v184, v26
v_mfma_f32_16x16x32_bf16 v[220:223], a[236:239], a[28:31], v[220:223]
s_waitcnt lgkmcnt(1)
v_mul_f32 v188, v188, v27
v_cvt_pk_bf16_f32 v120, v176, v180
v_mfma_f32_16x16x32_bf16 v[224:227], a[240:243], a[160:163], v[224:227]
s_addc_u32 s29, s29, 0
ds_read_b128 a[248:251], v14 offset:49152
v_cvt_pk_bf16_f32 v121, v184, v188
v_mfma_f32_16x16x32_bf16 v[228:231], a[240:243], a[164:167], v[228:231]
buffer_store_dwordx2 v[120:121], v18, s[28:31], 0 offen nt
v_mul_f32 v177, v177, v24
v_mfma_f32_16x16x32_bf16 v[232:235], a[240:243], a[168:171], v[232:235]
s_add_u32 s28, s28, 7168
v_mul_f32 v181, v181, v25
v_mul_f32 v185, v185, v26
v_mfma_f32_16x16x32_bf16 v[236:239], a[240:243], a[172:175], v[236:239]
s_waitcnt lgkmcnt(1)
v_mul_f32 v189, v189, v27
v_cvt_pk_bf16_f32 v122, v177, v181
v_mfma_f32_16x16x32_bf16 v[240:243], a[244:247], a[160:163], v[240:243]
s_addc_u32 s29, s29, 0
ds_read_b128 a[252:255], v14 offset:51200
v_cvt_pk_bf16_f32 v123, v185, v189
v_mfma_f32_16x16x32_bf16 v[244:247], a[244:247], a[164:167], v[244:247]
buffer_store_dwordx2 v[122:123], v18, s[28:31], 0 offen nt
v_mul_f32 v178, v178, v24
v_mfma_f32_16x16x32_bf16 v[248:251], a[244:247], a[168:171], v[248:251]
s_add_u32 s28, s28, 7168
v_mul_f32 v182, v182, v25
v_mul_f32 v186, v186, v26
v_mfma_f32_16x16x32_bf16 v[252:255], a[244:247], a[172:175], v[252:255]
s_waitcnt lgkmcnt(1)
v_mul_f32 v190, v190, v27
v_cvt_pk_bf16_f32 v124, v178, v182
v_mfma_f32_16x16x32_bf16 v[192:195], a[248:251], a[32:35], v[192:195]
s_addc_u32 s29, s29, 0
ds_read_b128 a[224:227], v15 offset:45056
v_cvt_pk_bf16_f32 v125, v186, v190
v_mfma_f32_16x16x32_bf16 v[196:199], a[248:251], a[36:39], v[196:199]
buffer_store_dwordx2 v[124:125], v18, s[28:31], 0 offen nt
v_mul_f32 v179, v179, v24
v_mfma_f32_16x16x32_bf16 v[200:203], a[248:251], a[40:43], v[200:203]
s_add_u32 s28, s28, 7168
v_mul_f32 v183, v183, v25
v_mul_f32 v187, v187, v26
v_mfma_f32_16x16x32_bf16 v[204:207], a[248:251], a[44:47], v[204:207]
s_waitcnt lgkmcnt(1)
v_mul_f32 v191, v191, v27
v_cvt_pk_bf16_f32 v126, v179, v183
v_mfma_f32_16x16x32_bf16 v[208:211], a[252:255], a[32:35], v[208:211]
s_addc_u32 s29, s29, 0
ds_read_b128 a[228:231], v15 offset:47104
v_cvt_pk_bf16_f32 v127, v187, v191
v_mfma_f32_16x16x32_bf16 v[212:215], a[252:255], a[36:39], v[212:215]
buffer_store_dwordx2 v[126:127], v18, s[28:31], 0 offen nt
v_mfma_f32_16x16x32_bf16 v[216:219], a[252:255], a[40:43], v[216:219]
v_mfma_f32_16x16x32_bf16 v[220:223], a[252:255], a[44:47], v[220:223]
s_waitcnt lgkmcnt(1)
v_mfma_f32_16x16x32_bf16 v[224:227], a[224:227], a[176:179], v[224:227]
ds_read_b128 a[232:235], v15 offset:49152
v_mfma_f32_16x16x32_bf16 v[228:231], a[224:227], a[180:183], v[228:231]
v_mfma_f32_16x16x32_bf16 v[232:235], a[224:227], a[184:187], v[232:235]
v_mfma_f32_16x16x32_bf16 v[236:239], a[224:227], a[188:191], v[236:239]
s_waitcnt lgkmcnt(1)
v_mfma_f32_16x16x32_bf16 v[240:243], a[228:231], a[176:179], v[240:243]
ds_read_b128 a[236:239], v15 offset:51200
v_mfma_f32_16x16x32_bf16 v[244:247], a[228:231], a[180:183], v[244:247]
v_mfma_f32_16x16x32_bf16 v[248:251], a[228:231], a[184:187], v[248:251]
v_mfma_f32_16x16x32_bf16 v[252:255], a[228:231], a[188:191], v[252:255]
s_waitcnt lgkmcnt(1)
v_mfma_f32_16x16x32_bf16 v[192:195], a[232:235], a[48:51], v[192:195]
ds_read_b128 a[240:243], v14 offset:53248
v_mfma_f32_16x16x32_bf16 v[196:199], a[232:235], a[52:55], v[196:199]
v_mfma_f32_16x16x32_bf16 v[200:203], a[232:235], a[56:59], v[200:203]
v_mfma_f32_16x16x32_bf16 v[204:207], a[232:235], a[60:63], v[204:207]
s_waitcnt lgkmcnt(1)
v_mfma_f32_16x16x32_bf16 v[208:211], a[236:239], a[48:51], v[208:211]
ds_read_b128 a[244:247], v14 offset:55296
v_mfma_f32_16x16x32_bf16 v[212:215], a[236:239], a[52:55], v[212:215]
v_mfma_f32_16x16x32_bf16 v[216:219], a[236:239], a[56:59], v[216:219]
v_mfma_f32_16x16x32_bf16 v[220:223], a[236:239], a[60:63], v[220:223]
s_waitcnt lgkmcnt(1)
v_mfma_f32_16x16x32_bf16 v[224:227], a[240:243], a[192:195], v[224:227]
ds_read_b128 a[248:251], v15 offset:53248
v_mfma_f32_16x16x32_bf16 v[228:231], a[240:243], a[196:199], v[228:231]
v_mfma_f32_16x16x32_bf16 v[232:235], a[240:243], a[200:203], v[232:235]
v_mfma_f32_16x16x32_bf16 v[236:239], a[240:243], a[204:207], v[236:239]
s_waitcnt lgkmcnt(1)
v_mul_f32 v192, v192, v24
v_mul_f32 v196, v196, v25
v_mfma_f32_16x16x32_bf16 v[240:243], a[244:247], a[192:195], v[240:243]
s_add_u32 s28, s28, 93184
ds_read_b128 a[252:255], v15 offset:55296
v_mul_f32 v200, v200, v26
v_mfma_f32_16x16x32_bf16 v[244:247], a[244:247], a[196:199], v[244:247]
s_addc_u32 s29, s29, 0
v_mul_f32 v204, v204, v27
v_cvt_pk_bf16_f32 v120, v192, v196
v_mfma_f32_16x16x32_bf16 v[248:251], a[244:247], a[200:203], v[248:251]
v_cvt_pk_bf16_f32 v121, v200, v204
v_mfma_f32_16x16x32_bf16 v[252:255], a[244:247], a[204:207], v[252:255]
s_waitcnt lgkmcnt(1)
v_mfma_f32_16x16x32_bf16 v[224:227], a[248:251], a[208:211], v[224:227]
ds_read_b128 a[224:227], v14 offset:57344
v_mfma_f32_16x16x32_bf16 v[228:231], a[248:251], a[212:215], v[228:231]
buffer_store_dwordx2 v[120:121], v18, s[28:31], 0 offen nt
v_mul_f32 v193, v193, v24
v_mfma_f32_16x16x32_bf16 v[232:235], a[248:251], a[216:219], v[232:235]
s_add_u32 s28, s28, 7168
v_mul_f32 v197, v197, v25
v_mul_f32 v201, v201, v26
v_mfma_f32_16x16x32_bf16 v[236:239], a[248:251], a[220:223], v[236:239]
s_waitcnt lgkmcnt(1)
v_mul_f32 v205, v205, v27
v_cvt_pk_bf16_f32 v122, v193, v197
v_mfma_f32_16x16x32_bf16 v[240:243], a[252:255], a[208:211], v[240:243]
s_addc_u32 s29, s29, 0
ds_read_b128 a[228:231], v14 offset:59392
v_cvt_pk_bf16_f32 v123, v201, v205
v_mfma_f32_16x16x32_bf16 v[244:247], a[252:255], a[212:215], v[244:247]
buffer_store_dwordx2 v[122:123], v18, s[28:31], 0 offen nt
v_mul_f32 v194, v194, v24
v_mfma_f32_16x16x32_bf16 v[248:251], a[252:255], a[216:219], v[248:251]
s_add_u32 s28, s28, 7168
v_mul_f32 v198, v198, v25
v_mul_f32 v202, v202, v26
v_mfma_f32_16x16x32_bf16 v[252:255], a[252:255], a[220:223], v[252:255]
s_waitcnt lgkmcnt(1)
v_mul_f32 v206, v206, v27
v_cvt_pk_bf16_f32 v124, v194, v198
v_mfma_f32_16x16x32_bf16 v[224:227], a[224:227], a[0:3], v[224:227]
s_addc_u32 s29, s29, 0
ds_read_b128 a[232:235], v15 offset:57344
v_cvt_pk_bf16_f32 v125, v202, v206
v_mfma_f32_16x16x32_bf16 v[228:231], a[224:227], a[4:7], v[228:231]
buffer_store_dwordx2 v[124:125], v18, s[28:31], 0 offen nt
v_mul_f32 v195, v195, v24
v_mfma_f32_16x16x32_bf16 v[232:235], a[224:227], a[8:11], v[232:235]
s_add_u32 s28, s28, 7168
v_mul_f32 v199, v199, v25
v_mul_f32 v203, v203, v26
v_mfma_f32_16x16x32_bf16 v[236:239], a[224:227], a[12:15], v[236:239]
s_waitcnt lgkmcnt(1)
v_mul_f32 v207, v207, v27
v_cvt_pk_bf16_f32 v126, v195, v199
v_mfma_f32_16x16x32_bf16 v[240:243], a[228:231], a[0:3], v[240:243]
s_addc_u32 s29, s29, 0
ds_read_b128 a[236:239], v15 offset:59392
v_cvt_pk_bf16_f32 v127, v203, v207
v_mfma_f32_16x16x32_bf16 v[244:247], a[228:231], a[4:7], v[244:247]
buffer_store_dwordx2 v[126:127], v18, s[28:31], 0 offen nt
v_mul_f32 v208, v208, v24
v_mfma_f32_16x16x32_bf16 v[248:251], a[228:231], a[8:11], v[248:251]
s_add_u32 s28, s28, 93184
v_mul_f32 v212, v212, v25
v_mul_f32 v216, v216, v26
v_mfma_f32_16x16x32_bf16 v[252:255], a[228:231], a[12:15], v[252:255]
s_waitcnt lgkmcnt(1)
v_mul_f32 v220, v220, v27
v_cvt_pk_bf16_f32 v120, v208, v212
v_mfma_f32_16x16x32_bf16 v[224:227], a[232:235], a[16:19], v[224:227]
s_addc_u32 s29, s29, 0
ds_read_b128 a[240:243], v14 offset:61440
v_cvt_pk_bf16_f32 v121, v216, v220
v_mfma_f32_16x16x32_bf16 v[228:231], a[232:235], a[20:23], v[228:231]
buffer_store_dwordx2 v[120:121], v18, s[28:31], 0 offen nt
v_mul_f32 v209, v209, v24
v_mfma_f32_16x16x32_bf16 v[232:235], a[232:235], a[24:27], v[232:235]
s_add_u32 s28, s28, 7168
v_mul_f32 v213, v213, v25
v_mul_f32 v217, v217, v26
v_mfma_f32_16x16x32_bf16 v[236:239], a[232:235], a[28:31], v[236:239]
s_waitcnt lgkmcnt(1)
v_mul_f32 v221, v221, v27
v_cvt_pk_bf16_f32 v122, v209, v213
v_mfma_f32_16x16x32_bf16 v[240:243], a[236:239], a[16:19], v[240:243]
s_addc_u32 s29, s29, 0
ds_read_b128 a[244:247], v14 offset:63488
v_cvt_pk_bf16_f32 v123, v217, v221
v_mfma_f32_16x16x32_bf16 v[244:247], a[236:239], a[20:23], v[244:247]
buffer_store_dwordx2 v[122:123], v18, s[28:31], 0 offen nt
v_mul_f32 v210, v210, v24
v_mfma_f32_16x16x32_bf16 v[248:251], a[236:239], a[24:27], v[248:251]
s_add_u32 s28, s28, 7168
v_mul_f32 v214, v214, v25
v_mul_f32 v218, v218, v26
v_mfma_f32_16x16x32_bf16 v[252:255], a[236:239], a[28:31], v[252:255]
s_waitcnt lgkmcnt(1)
v_mul_f32 v222, v222, v27
v_cvt_pk_bf16_f32 v124, v210, v214
v_mfma_f32_16x16x32_bf16 v[224:227], a[240:243], a[32:35], v[224:227]
s_addc_u32 s29, s29, 0
ds_read_b128 a[248:251], v15 offset:61440
v_cvt_pk_bf16_f32 v125, v218, v222
v_mfma_f32_16x16x32_bf16 v[228:231], a[240:243], a[36:39], v[228:231]
buffer_store_dwordx2 v[124:125], v18, s[28:31], 0 offen nt
v_mul_f32 v211, v211, v24
v_mfma_f32_16x16x32_bf16 v[232:235], a[240:243], a[40:43], v[232:235]
s_add_u32 s28, s28, 7168
v_mul_f32 v215, v215, v25
v_mul_f32 v219, v219, v26
v_mfma_f32_16x16x32_bf16 v[236:239], a[240:243], a[44:47], v[236:239]
s_waitcnt lgkmcnt(1)
v_mul_f32 v223, v223, v27
v_cvt_pk_bf16_f32 v126, v211, v215
v_mfma_f32_16x16x32_bf16 v[240:243], a[244:247], a[32:35], v[240:243]
s_addc_u32 s29, s29, 0
ds_read_b128 a[252:255], v15 offset:63488
v_cvt_pk_bf16_f32 v127, v219, v223
v_mfma_f32_16x16x32_bf16 v[244:247], a[244:247], a[36:39], v[244:247]
buffer_store_dwordx2 v[126:127], v18, s[28:31], 0 offen nt
v_mfma_f32_16x16x32_bf16 v[248:251], a[244:247], a[40:43], v[248:251]
v_mfma_f32_16x16x32_bf16 v[252:255], a[244:247], a[44:47], v[252:255]
s_waitcnt lgkmcnt(1)
v_mfma_f32_16x16x32_bf16 v[224:227], a[248:251], a[48:51], v[224:227]
v_mfma_f32_16x16x32_bf16 v[228:231], a[248:251], a[52:55], v[228:231]
v_mfma_f32_16x16x32_bf16 v[232:235], a[248:251], a[56:59], v[232:235]
v_mfma_f32_16x16x32_bf16 v[236:239], a[248:251], a[60:63], v[236:239]
s_waitcnt lgkmcnt(0)
v_mfma_f32_16x16x32_bf16 v[240:243], a[252:255], a[48:51], v[240:243]
v_mfma_f32_16x16x32_bf16 v[244:247], a[252:255], a[52:55], v[244:247]
v_mfma_f32_16x16x32_bf16 v[248:251], a[252:255], a[56:59], v[248:251]
v_mfma_f32_16x16x32_bf16 v[252:255], a[252:255], a[60:63], v[252:255]
s_nop 7
v_pk_mul_f32 v[224:225], v[224:225], v[24:25] op_sel:[0,0] op_sel_hi:[1,0]
v_pk_mul_f32 v[228:229], v[228:229], v[24:25] op_sel:[0,1] op_sel_hi:[1,1]
v_pk_mul_f32 v[232:233], v[232:233], v[26:27] op_sel:[0,0] op_sel_hi:[1,0]
v_pk_mul_f32 v[236:237], v[236:237], v[26:27] op_sel:[0,1] op_sel_hi:[1,1]
v_cvt_pk_bf16_f32 v120, v224, v228
v_cvt_pk_bf16_f32 v121, v232, v236
s_add_u32 s28, s28, 93184
s_addc_u32 s29, s29, 0
buffer_store_dwordx2 v[120:121], v18, s[28:31], 0 offen nt
v_cvt_pk_bf16_f32 v122, v225, v229
v_cvt_pk_bf16_f32 v123, v233, v237
s_add_u32 s28, s28, 7168
s_addc_u32 s29, s29, 0
buffer_store_dwordx2 v[122:123], v18, s[28:31], 0 offen nt
v_pk_mul_f32 v[226:227], v[226:227], v[24:25] op_sel:[0,0] op_sel_hi:[1,0]
v_pk_mul_f32 v[230:231], v[230:231], v[24:25] op_sel:[0,1] op_sel_hi:[1,1]
v_pk_mul_f32 v[234:235], v[234:235], v[26:27] op_sel:[0,0] op_sel_hi:[1,0]
v_pk_mul_f32 v[238:239], v[238:239], v[26:27] op_sel:[0,1] op_sel_hi:[1,1]
v_cvt_pk_bf16_f32 v124, v226, v230
v_cvt_pk_bf16_f32 v125, v234, v238
s_add_u32 s28, s28, 7168
s_addc_u32 s29, s29, 0
buffer_store_dwordx2 v[124:125], v18, s[28:31], 0 offen nt
v_cvt_pk_bf16_f32 v126, v227, v231
v_cvt_pk_bf16_f32 v127, v235, v239
s_add_u32 s28, s28, 7168
s_addc_u32 s29, s29, 0
buffer_store_dwordx2 v[126:127], v18, s[28:31], 0 offen nt
v_pk_mul_f32 v[240:241], v[240:241], v[24:25] op_sel:[0,0] op_sel_hi:[1,0]
v_pk_mul_f32 v[244:245], v[244:245], v[24:25] op_sel:[0,1] op_sel_hi:[1,1]
v_pk_mul_f32 v[248:249], v[248:249], v[26:27] op_sel:[0,0] op_sel_hi:[1,0]
v_pk_mul_f32 v[252:253], v[252:253], v[26:27] op_sel:[0,1] op_sel_hi:[1,1]
v_cvt_pk_bf16_f32 v120, v240, v244
v_cvt_pk_bf16_f32 v121, v248, v252
s_add_u32 s28, s28, 93184
s_addc_u32 s29, s29, 0
buffer_store_dwordx2 v[120:121], v18, s[28:31], 0 offen nt
v_cvt_pk_bf16_f32 v122, v241, v245
v_cvt_pk_bf16_f32 v123, v249, v253
s_add_u32 s28, s28, 7168
s_addc_u32 s29, s29, 0
buffer_store_dwordx2 v[122:123], v18, s[28:31], 0 offen nt
v_pk_mul_f32 v[242:243], v[242:243], v[24:25] op_sel:[0,0] op_sel_hi:[1,0]
v_pk_mul_f32 v[246:247], v[246:247], v[24:25] op_sel:[0,1] op_sel_hi:[1,1]
v_pk_mul_f32 v[250:251], v[250:251], v[26:27] op_sel:[0,0] op_sel_hi:[1,0]
v_pk_mul_f32 v[254:255], v[254:255], v[26:27] op_sel:[0,1] op_sel_hi:[1,1]
v_cvt_pk_bf16_f32 v124, v242, v246
v_cvt_pk_bf16_f32 v125, v250, v254
s_add_u32 s28, s28, 7168
s_addc_u32 s29, s29, 0
buffer_store_dwordx2 v[124:125], v18, s[28:31], 0 offen nt
v_cvt_pk_bf16_f32 v126, v243, v247
v_cvt_pk_bf16_f32 v127, v251, v255
s_add_u32 s28, s28, 7168
s_addc_u32 s29, s29, 0
buffer_store_dwordx2 v[126:127], v18, s[28:31], 0 offen nt
s_endpgm
L_NOTAG:
buffer_load_dwordx2 v[22:23], off, s[80:83], 0 sc1
s_waitcnt vmcnt(0)
v_readfirstlane_b32 s88, v22
v_readfirstlane_b32 s89, v23
s_sub_u32 s90, s90, 1
s_nop 0
s_cmp_eq_u64 s[88:89], 0
s_cbranch_scc0 L_TAGOK
s_cmp_gt_i32 s90, 0
s_cbranch_scc1 L_NOTAG
s_mov_b32 s26, 0
s_mov_b32 s78, 0
s_mov_b64 s[88:89], 1
s_branch L_TAGOK
L_SLOW1:
s_lshr_b32 s47, s41, 6
s_add_u32 s47, s47, 0
s_lshl_b32 s47, s47, 11
buffer_load_dwordx4 v[40:43], v13, s[24:27], s47 offen offset:0 sc1
buffer_load_dwordx4 v[44:47], v13, s[24:27], s47 offen offset:1024 sc1
s_mov_b32 s91, s35
s_call_b64 s[100:101], L_WAIT
v_mov_b64 v[32:33], v[120:121]
v_mov_b64 v[36:37], v[124:125]
s_branch L_BACK1
L_SLOW2:
s_lshr_b32 s47, s41, 6
s_add_u32 s47, s47, 1
s_lshl_b32 s47, s47, 11
buffer_load_dwordx4 v[48:51], v13, s[24:27], s47 offen offset:0 sc1
buffer_load_dwordx4 v[52:55], v13, s[24:27], s47 offen offset:1024 sc1
s_lshr_b32 s47, s42, 6
s_add_u32 s47, s47, 0
s_lshl_b32 s47, s47, 11
buffer_load_dwordx4 v[96:99], v13, s[24:27], s47 offen offset:0 sc1
buffer_load_dwordx4 v[100:103], v13, s[24:27], s47 offen offset:1024 sc1
s_lshr_b32 s91, s41, 6
s_add_u32 s91, s91, 0
s_call_b64 s[100:101], L_WAIT
v_mov_b64 v[40:41], v[120:121]
v_mov_b64 v[44:45], v[124:125]
s_branch L_BACK2
L_SLOW3:
s_lshr_b32 s47, s42, 6
s_add_u32 s47, s47, 0
s_lshl_b32 s47, s47, 11
buffer_load_dwordx4 v[96:99], v13, s[24:27], s47 offen offset:0 sc1
buffer_load_dwordx4 v[100:103], v13, s[24:27], s47 offen offset:1024 sc1
s_lshr_b32 s47, s42, 6
s_add_u32 s47, s47, 1
s_lshl_b32 s47, s47, 11
buffer_load_dwordx4 v[80:83], v13, s[24:27], s47 offen offset:0 sc1
buffer_load_dwordx4 v[84:87], v13, s[24:27], s47 offen offset:1024 sc1
s_lshr_b32 s91, s41, 6
s_add_u32 s91, s91, 1
s_call_b64 s[100:101], L_WAIT
v_mov_b64 v[48:49], v[120:121]
v_mov_b64 v[52:53], v[124:125]
s_branch L_BACK3
L_SLOW4:
s_lshr_b32 s47, s42, 6
s_add_u32 s47, s47, 1
s_lshl_b32 s47, s47, 11
buffer_load_dwordx4 v[80:83], v13, s[24:27], s47 offen offset:0 sc1
buffer_load_dwordx4 v[84:87], v13, s[24:27], s47 offen offset:1024 sc1
s_lshr_b32 s47, s43, 6
s_add_u32 s47, s47, 0
s_lshl_b32 s47, s47, 11
buffer_load_dwordx4 v[88:91], v13, s[24:27], s47 offen offset:0 sc1
buffer_load_dwordx4 v[92:95], v13, s[24:27], s47 offen offset:1024 sc1
s_lshr_b32 s91, s42, 6
s_add_u32 s91, s91, 0
s_call_b64 s[100:101], L_WAIT
v_mov_b64 v[96:97], v[120:121]
v_mov_b64 v[100:101], v[124:125]
s_branch L_BACK4
L_SLOW5:
s_lshr_b32 s47, s43, 6
s_add_u32 s47, s47, 0
s_lshl_b32 s47, s47, 11
buffer_load_dwordx4 v[88:91], v13, s[24:27], s47 offen offset:0 sc1
buffer_load_dwordx4 v[92:95], v13, s[24:27], s47 offen offset:1024 sc1
s_lshr_b32 s47, s43, 6
s_add_u32 s47, s47, 1
s_lshl_b32 s47, s47, 11
buffer_load_dwordx4 v[32:35], v13, s[24:27], s47 offen offset:0 sc1
buffer_load_dwordx4 v[36:39], v13, s[24:27], s47 offen offset:1024 sc1
s_lshr_b32 s91, s42, 6
s_add_u32 s91, s91, 1
s_call_b64 s[100:101], L_WAIT
v_mov_b64 v[80:81], v[120:121]
v_mov_b64 v[84:85], v[124:125]
s_branch L_BACK5
L_SLOW6:
s_lshr_b32 s47, s43, 6
s_add_u32 s47, s47, 1
s_lshl_b32 s47, s47, 11
buffer_load_dwordx4 v[32:35], v13, s[24:27], s47 offen offset:0 sc1
buffer_load_dwordx4 v[36:39], v13, s[24:27], s47 offen offset:1024 sc1
s_movk_i32 s47, 8
s_lshl_b32 s47, s47, 11
buffer_load_dwordx4 v[40:43], v13, s[24:27], s47 offen offset:0 sc1
buffer_load_dwordx4 v[44:47], v13, s[24:27], s47 offen offset:1024 sc1
s_lshr_b32 s91, s43, 6
s_add_u32 s91, s91, 0
s_call_b64 s[100:101], L_WAIT
v_mov_b64 v[88:89], v[120:121]
v_mov_b64 v[92:93], v[124:125]
s_branch L_BACK6
L_SLOW7:
s_movk_i32 s47, 8
s_lshl_b32 s47, s47, 11
buffer_load_dwordx4 v[40:43], v13, s[24:27], s47 offen offset:0 sc1
buffer_load_dwordx4 v[44:47], v13, s[24:27], s47 offen offset:1024 sc1
s_movk_i32 s47, 9
s_lshl_b32 s47, s47, 11
buffer_load_dwordx4 v[48:51], v13, s[24:27], s47 offen offset:0 sc1
buffer_load_dwordx4 v[52:55], v13, s[24:27], s47 offen offset:1024 sc1
s_lshr_b32 s91, s43, 6
s_add_u32 s91, s91, 1
s_call_b64 s[100:101], L_WAIT
v_mov_b64 v[32:33], v[120:121]
v_mov_b64 v[36:37], v[124:125]
s_branch L_BACK7
L_SLOW8:
s_movk_i32 s47, 9
s_lshl_b32 s47, s47, 11
buffer_load_dwordx4 v[48:51], v13, s[24:27], s47 offen offset:0 sc1
buffer_load_dwordx4 v[52:55], v13, s[24:27], s47 offen offset:1024 sc1
s_movk_i32 s47, 10
s_lshl_b32 s47, s47, 11
buffer_load_dwordx4 v[96:99], v13, s[24:27], s47 offen offset:0 sc1
buffer_load_dwordx4 v[100:103], v13, s[24:27], s47 offen offset:1024 sc1
s_movk_i32 s91, 8
s_call_b64 s[100:101], L_WAIT
v_mov_b64 v[40:41], v[120:121]
v_mov_b64 v[44:45], v[124:125]
s_branch L_BACK8
L_SLOW9:
s_movk_i32 s47, 10
s_lshl_b32 s47, s47, 11
buffer_load_dwordx4 v[96:99], v13, s[24:27], s47 offen offset:0 sc1
buffer_load_dwordx4 v[100:103], v13, s[24:27], s47 offen offset:1024 sc1
s_movk_i32 s47, 11
s_lshl_b32 s47, s47, 11
buffer_load_dwordx4 v[80:83], v13, s[24:27], s47 offen offset:0 sc1
buffer_load_dwordx4 v[84:87], v13, s[24:27], s47 offen offset:1024 sc1
s_movk_i32 s91, 9
s_call_b64 s[100:101], L_WAIT
v_mov_b64 v[48:49], v[120:121]
v_mov_b64 v[52:53], v[124:125]
s_branch L_BACK9
L_SLOW10:
s_movk_i32 s47, 11
s_lshl_b32 s47, s47, 11
buffer_load_dwordx4 v[80:83], v13, s[24:27], s47 offen offset:0 sc1
buffer_load_dwordx4 v[84:87], v13, s[24:27], s47 offen offset:1024 sc1
s_movk_i32 s47, 12
s_lshl_b32 s47, s47, 11
buffer_load_dwordx4 v[88:91], v13, s[24:27], s47 offen offset:0 sc1
buffer_load_dwordx4 v[92:95], v13, s[24:27], s47 offen offset:1024 sc1
s_movk_i32 s91, 10
s_call_b64 s[100:101], L_WAIT
v_mov_b64 v[96:97], v[120:121]
v_mov_b64 v[100:101], v[124:125]
s_branch L_BACK10
L_SLOW11:
s_movk_i32 s47, 12
s_lshl_b32 s47, s47, 11
buffer_load_dwordx4 v[88:91], v13, s[24:27], s47 offen offset:0 sc1
buffer_load_dwordx4 v[92:95], v13, s[24:27], s47 offen offset:1024 sc1
s_movk_i32 s47, 13
s_lshl_b32 s47, s47, 11
buffer_load_dwordx4 v[32:35], v13, s[24:27], s47 offen offset:0 sc1
buffer_load_dwordx4 v[36:39], v13, s[24:27], s47 offen offset:1024 sc1
s_movk_i32 s91, 11
s_call_b64 s[100:101], L_WAIT
v_mov_b64 v[80:81], v[120:121]
v_mov_b64 v[84:85], v[124:125]
s_branch L_BACK11
L_SLOW12:
s_movk_i32 s47, 13
s_lshl_b32 s47, s47, 11
buffer_load_dwordx4 v[32:35], v13, s[24:27], s47 offen offset:0 sc1
buffer_load_dwordx4 v[36:39], v13, s[24:27], s47 offen offset:1024 sc1
s_movk_i32 s47, 14
s_lshl_b32 s47, s47, 11
buffer_load_dwordx4 v[40:43], v13, s[24:27], s47 offen offset:0 sc1
buffer_load_dwordx4 v[44:47], v13, s[24:27], s47 offen offset:1024 sc1
s_movk_i32 s91, 12
s_call_b64 s[100:101], L_WAIT
v_mov_b64 v[88:89], v[120:121]
v_mov_b64 v[92:93], v[124:125]
s_branch L_BACK12
L_SLOW13:
s_movk_i32 s47, 14
s_lshl_b32 s47, s47, 11
buffer_load_dwordx4 v[40:43], v13, s[24:27], s47 offen offset:0 sc1
buffer_load_dwordx4 v[44:47], v13, s[24:27], s47 offen offset:1024 sc1
s_movk_i32 s47, 15
s_lshl_b32 s47, s47, 11
buffer_load_dwordx4 v[48:51], v13, s[24:27], s47 offen offset:0 sc1
buffer_load_dwordx4 v[52:55], v13, s[24:27], s47 offen offset:1024 sc1
s_movk_i32 s91, 13
s_call_b64 s[100:101], L_WAIT
v_mov_b64 v[32:33], v[120:121]
v_mov_b64 v[36:37], v[124:125]
s_branch L_BACK13
L_SLOW14:
s_movk_i32 s47, 15
s_lshl_b32 s47, s47, 11
buffer_load_dwordx4 v[48:51], v13, s[24:27], s47 offen offset:0 sc1
buffer_load_dwordx4 v[52:55], v13, s[24:27], s47 offen offset:1024 sc1
s_movk_i32 s47, 16
s_lshl_b32 s47, s47, 11
buffer_load_dwordx4 v[96:99], v13, s[24:27], s47 offen offset:0 sc1
buffer_load_dwordx4 v[100:103], v13, s[24:27], s47 offen offset:1024 sc1
s_movk_i32 s91, 14
s_call_b64 s[100:101], L_WAIT
v_mov_b64 v[40:41], v[120:121]
v_mov_b64 v[44:45], v[124:125]
s_branch L_BACK14
L_SLOW15:
s_movk_i32 s47, 16
s_lshl_b32 s47, s47, 11
buffer_load_dwordx4 v[96:99], v13, s[24:27], s47 offen offset:0 sc1
buffer_load_dwordx4 v[100:103], v13, s[24:27], s47 offen offset:1024 sc1
s_movk_i32 s47, 17
s_lshl_b32 s47, s47, 11
buffer_load_dwordx4 v[80:83], v13, s[24:27], s47 offen offset:0 sc1
buffer_load_dwordx4 v[84:87], v13, s[24:27], s47 offen offset:1024 sc1
s_movk_i32 s91, 15
s_call_b64 s[100:101], L_WAIT
v_mov_b64 v[48:49], v[120:121]
v_mov_b64 v[52:53], v[124:125]
s_branch L_BACK15
L_SLOW16:
s_movk_i32 s47, 17
s_lshl_b32 s47, s47, 11
buffer_load_dwordx4 v[80:83], v13, s[24:27], s47 offen offset:0 sc1
buffer_load_dwordx4 v[84:87], v13, s[24:27], s47 offen offset:1024 sc1
s_movk_i32 s47, 18
s_lshl_b32 s47, s47, 11
buffer_load_dwordx4 v[88:91], v13, s[24:27], s47 offen offset:0 sc1
buffer_load_dwordx4 v[92:95], v13, s[24:27], s47 offen offset:1024 sc1
s_movk_i32 s91, 16
s_call_b64 s[100:101], L_WAIT
v_mov_b64 v[96:97], v[120:121]
v_mov_b64 v[100:101], v[124:125]
s_branch L_BACK16
L_SLOW17:
s_movk_i32 s47, 18
s_lshl_b32 s47, s47, 11
buffer_load_dwordx4 v[88:91], v13, s[24:27], s47 offen offset:0 sc1
buffer_load_dwordx4 v[92:95], v13, s[24:27], s47 offen offset:1024 sc1
s_movk_i32 s47, 19
s_lshl_b32 s47, s47, 11
buffer_load_dwordx4 v[32:35], v13, s[24:27], s47 offen offset:0 sc1
buffer_load_dwordx4 v[36:39], v13, s[24:27], s47 offen offset:1024 sc1
s_movk_i32 s91, 17
s_call_b64 s[100:101], L_WAIT
v_mov_b64 v[80:81], v[120:121]
v_mov_b64 v[84:85], v[124:125]
s_branch L_BACK17
L_SLOW18:
s_movk_i32 s47, 19
s_lshl_b32 s47, s47, 11
buffer_load_dwordx4 v[32:35], v13, s[24:27], s47 offen offset:0 sc1
buffer_load_dwordx4 v[36:39], v13, s[24:27], s47 offen offset:1024 sc1
s_movk_i32 s47, 20
s_lshl_b32 s47, s47, 11
buffer_load_dwordx4 v[40:43], v13, s[24:27], s47 offen offset:0 sc1
buffer_load_dwordx4 v[44:47], v13, s[24:27], s47 offen offset:1024 sc1
s_movk_i32 s91, 18
s_call_b64 s[100:101], L_WAIT
v_mov_b64 v[88:89], v[120:121]
v_mov_b64 v[92:93], v[124:125]
s_branch L_BACK18
L_SLOW19:
s_movk_i32 s47, 20
s_lshl_b32 s47, s47, 11
buffer_load_dwordx4 v[40:43], v13, s[24:27], s47 offen offset:0 sc1
buffer_load_dwordx4 v[44:47], v13, s[24:27], s47 offen offset:1024 sc1
s_movk_i32 s47, 21
s_lshl_b32 s47, s47, 11
buffer_load_dwordx4 v[48:51], v13, s[24:27], s47 offen offset:0 sc1
buffer_load_dwordx4 v[52:55], v13, s[24:27], s47 offen offset:1024 sc1
s_movk_i32 s91, 19
s_call_b64 s[100:101], L_WAIT
v_mov_b64 v[32:33], v[120:121]
v_mov_b64 v[36:37], v[124:125]
s_branch L_BACK19
L_SLOW20:
s_movk_i32 s47, 21
s_lshl_b32 s47, s47, 11
buffer_load_dwordx4 v[48:51], v13, s[24:27], s47 offen offset:0 sc1
buffer_load_dwordx4 v[52:55], v13, s[24:27], s47 offen offset:1024 sc1
s_movk_i32 s47, 22
s_lshl_b32 s47, s47, 11
buffer_load_dwordx4 v[96:99], v13, s[24:27], s47 offen offset:0 sc1
buffer_load_dwordx4 v[100:103], v13, s[24:27], s47 offen offset:1024 sc1
s_movk_i32 s91, 20
s_call_b64 s[100:101], L_WAIT
v_mov_b64 v[40:41], v[120:121]
v_mov_b64 v[44:45], v[124:125]
s_branch L_BACK20
L_SLOW21:
s_movk_i32 s47, 22
s_lshl_b32 s47, s47, 11
buffer_load_dwordx4 v[96:99], v13, s[24:27], s47 offen offset:0 sc1
buffer_load_dwordx4 v[100:103], v13, s[24:27], s47 offen offset:1024 sc1
s_movk_i32 s47, 23
s_lshl_b32 s47, s47, 11
buffer_load_dwordx4 v[80:83], v13, s[24:27], s47 offen offset:0 sc1
buffer_load_dwordx4 v[84:87], v13, s[24:27], s47 offen offset:1024 sc1
s_movk_i32 s91, 21
s_call_b64 s[100:101], L_WAIT
v_mov_b64 v[48:49], v[120:121]
v_mov_b64 v[52:53], v[124:125]
s_branch L_BACK21
L_SLOW22:
s_movk_i32 s47, 23
s_lshl_b32 s47, s47, 11
buffer_load_dwordx4 v[80:83], v13, s[24:27], s47 offen offset:0 sc1
buffer_load_dwordx4 v[84:87], v13, s[24:27], s47 offen offset:1024 sc1
s_movk_i32 s47, 24
s_lshl_b32 s47, s47, 11
buffer_load_dwordx4 v[88:91], v13, s[24:27], s47 offen offset:0 sc1
buffer_load_dwordx4 v[92:95], v13, s[24:27], s47 offen offset:1024 sc1
s_movk_i32 s91, 22
s_call_b64 s[100:101], L_WAIT
v_mov_b64 v[96:97], v[120:121]
v_mov_b64 v[100:101], v[124:125]
s_branch L_BACK22
L_SLOW23:
s_movk_i32 s47, 24
s_lshl_b32 s47, s47, 11
buffer_load_dwordx4 v[88:91], v13, s[24:27], s47 offen offset:0 sc1
buffer_load_dwordx4 v[92:95], v13, s[24:27], s47 offen offset:1024 sc1
s_movk_i32 s47, 25
s_lshl_b32 s47, s47, 11
buffer_load_dwordx4 v[32:35], v13, s[24:27], s47 offen offset:0 sc1
buffer_load_dwordx4 v[36:39], v13, s[24:27], s47 offen offset:1024 sc1
s_movk_i32 s91, 23
s_call_b64 s[100:101], L_WAIT
v_mov_b64 v[80:81], v[120:121]
v_mov_b64 v[84:85], v[124:125]
s_branch L_BACK23
L_SLOW24:
s_movk_i32 s47, 25
s_lshl_b32 s47, s47, 11
buffer_load_dwordx4 v[32:35], v13, s[24:27], s47 offen offset:0 sc1
buffer_load_dwordx4 v[36:39], v13, s[24:27], s47 offen offset:1024 sc1
s_movk_i32 s47, 26
s_lshl_b32 s47, s47, 11
buffer_load_dwordx4 v[40:43], v13, s[24:27], s47 offen offset:0 sc1
buffer_load_dwordx4 v[44:47], v13, s[24:27], s47 offen offset:1024 sc1
s_movk_i32 s91, 24
s_call_b64 s[100:101], L_WAIT
v_mov_b64 v[88:89], v[120:121]
v_mov_b64 v[92:93], v[124:125]
s_branch L_BACK24
L_SLOW25:
s_movk_i32 s47, 26
s_lshl_b32 s47, s47, 11
buffer_load_dwordx4 v[40:43], v13, s[24:27], s47 offen offset:0 sc1
buffer_load_dwordx4 v[44:47], v13, s[24:27], s47 offen offset:1024 sc1
s_movk_i32 s47, 27
s_lshl_b32 s47, s47, 11
buffer_load_dwordx4 v[48:51], v13, s[24:27], s47 offen offset:0 sc1
buffer_load_dwordx4 v[52:55], v13, s[24:27], s47 offen offset:1024 sc1
s_movk_i32 s91, 25
s_call_b64 s[100:101], L_WAIT
v_mov_b64 v[32:33], v[120:121]
v_mov_b64 v[36:37], v[124:125]
s_branch L_BACK25
L_SLOW26:
s_movk_i32 s47, 27
s_lshl_b32 s47, s47, 11
buffer_load_dwordx4 v[48:51], v13, s[24:27], s47 offen offset:0 sc1
buffer_load_dwordx4 v[52:55], v13, s[24:27], s47 offen offset:1024 sc1
s_movk_i32 s47, 28
s_lshl_b32 s47, s47, 11
buffer_load_dwordx4 v[96:99], v13, s[24:27], s47 offen offset:0 sc1
buffer_load_dwordx4 v[100:103], v13, s[24:27], s47 offen offset:1024 sc1
s_movk_i32 s91, 26
s_call_b64 s[100:101], L_WAIT
v_mov_b64 v[40:41], v[120:121]
v_mov_b64 v[44:45], v[124:125]
s_branch L_BACK26
L_SLOW27:
s_movk_i32 s47, 28
s_lshl_b32 s47, s47, 11
buffer_load_dwordx4 v[96:99], v13, s[24:27], s47 offen offset:0 sc1
buffer_load_dwordx4 v[100:103], v13, s[24:27], s47 offen offset:1024 sc1
s_movk_i32 s47, 29
s_lshl_b32 s47, s47, 11
buffer_load_dwordx4 v[80:83], v13, s[24:27], s47 offen offset:0 sc1
buffer_load_dwordx4 v[84:87], v13, s[24:27], s47 offen offset:1024 sc1
s_movk_i32 s91, 27
s_call_b64 s[100:101], L_WAIT
v_mov_b64 v[48:49], v[120:121]
v_mov_b64 v[52:53], v[124:125]
s_branch L_BACK27
L_SLOW28:
s_movk_i32 s47, 29
s_lshl_b32 s47, s47, 11
buffer_load_dwordx4 v[80:83], v13, s[24:27], s47 offen offset:0 sc1
buffer_load_dwordx4 v[84:87], v13, s[24:27], s47 offen offset:1024 sc1
s_movk_i32 s47, 30
s_lshl_b32 s47, s47, 11
buffer_load_dwordx4 v[88:91], v13, s[24:27], s47 offen offset:0 sc1
buffer_load_dwordx4 v[92:95], v13, s[24:27], s47 offen offset:1024 sc1
s_movk_i32 s91, 28
s_call_b64 s[100:101], L_WAIT
v_mov_b64 v[96:97], v[120:121]
v_mov_b64 v[100:101], v[124:125]
s_branch L_BACK28
L_SLOW29:
s_movk_i32 s47, 30
s_lshl_b32 s47, s47, 11
buffer_load_dwordx4 v[88:91], v13, s[24:27], s47 offen offset:0 sc1
buffer_load_dwordx4 v[92:95], v13, s[24:27], s47 offen offset:1024 sc1
s_movk_i32 s47, 31
s_lshl_b32 s47, s47, 11
buffer_load_dwordx4 v[32:35], v13, s[24:27], s47 offen offset:0 sc1
buffer_load_dwordx4 v[36:39], v13, s[24:27], s47 offen offset:1024 sc1
s_movk_i32 s91, 29
s_call_b64 s[100:101], L_WAIT
v_mov_b64 v[80:81], v[120:121]
v_mov_b64 v[84:85], v[124:125]
s_branch L_BACK29
L_SLOW30:
s_movk_i32 s47, 31
s_lshl_b32 s47, s47, 11
buffer_load_dwordx4 v[32:35], v13, s[24:27], s47 offen offset:0 sc1
buffer_load_dwordx4 v[36:39], v13, s[24:27], s47 offen offset:1024 sc1
s_movk_i32 s91, 30
s_call_b64 s[100:101], L_WAIT
v_mov_b64 v[88:89], v[120:121]
v_mov_b64 v[92:93], v[124:125]
s_branch L_BACK30
L_SLOW31:
s_movk_i32 s91, 31
s_call_b64 s[100:101], L_WAIT
v_mov_b64 v[32:33], v[120:121]
v_mov_b64 v[36:37], v[124:125]
s_branch L_BACK31
L_WAIT:
s_lshl_b32 s47, s91, 11
buffer_load_dwordx4 v[120:123], v13, s[24:27], s47 offen offset:0 sc1
buffer_load_dwordx4 v[124:127], v13, s[24:27], s47 offen offset:1024 sc1
s_waitcnt vmcnt(0)
v_cmp_ne_u64 s[50:51], s[88:89], v[122:123]
v_cmp_ne_u64 s[44:45], s[88:89], v[126:127]
s_sub_u32 s90, s90, 1
s_nop 0
s_or_b64 s[50:51], s[44:45], s[50:51]
s_cbranch_scc0 L_WRET
s_cmp_gt_i32 s90, 0
s_cbranch_scc1 L_WAIT
s_mul_i32 s47, s91, 458752
s_lshl_b32 s46, s39, 8
s_add_u32 s47, s47, s46
s_add_u32 s84, s6, s47
s_addc_u32 s85, s7, 0
s_mov_b32 s86, 387328
s_mov_b32 s87, 0x20000
buffer_load_dwordx4 v[64:67], v30, s[84:87], 0 offen
buffer_load_dwordx4 v[68:71], v30, s[84:87], s92 offen
buffer_load_dwordx4 v[72:75], v30, s[84:87], s93 offen
buffer_load_dwordx4 v[76:79], v30, s[84:87], s94 offen
s_waitcnt vmcnt(0)
v_lshl_add_u64 v[64:65], v[68:69], 4, v[64:65]
v_lshl_add_u64 v[66:67], v[70:71], 4, v[66:67]
v_lshl_add_u64 v[72:73], v[76:77], 4, v[72:73]
v_lshl_add_u64 v[74:75], v[78:79], 4, v[74:75]
v_lshl_or_b32 v76, v72, 8, v64
v_lshl_or_b32 v77, v73, 8, v65
v_lshl_or_b32 v78, v74, 8, v66
v_lshl_or_b32 v79, v75, 8, v67
v_lshl_or_b32 v120, v77, 16, v76
v_lshl_or_b32 v121, v79, 16, v78
s_add_u32 s84, s84, 57344
s_addc_u32 s85, s85, 0
buffer_load_dwordx4 v[64:67], v30, s[84:87], 0 offen
buffer_load_dwordx4 v[68:71], v30, s[84:87], s92 offen
buffer_load_dwordx4 v[72:75], v30, s[84:87], s93 offen
buffer_load_dwordx4 v[76:79], v30, s[84:87], s94 offen
s_waitcnt vmcnt(0)
v_lshl_add_u64 v[64:65], v[68:69], 4, v[64:65]
v_lshl_add_u64 v[66:67], v[70:71], 4, v[66:67]
v_lshl_add_u64 v[72:73], v[76:77], 4, v[72:73]
v_lshl_add_u64 v[74:75], v[78:79], 4, v[74:75]
v_lshl_or_b32 v76, v72, 8, v64
v_lshl_or_b32 v77, v73, 8, v65
v_lshl_or_b32 v78, v74, 8, v66
v_lshl_or_b32 v79, v75, 8, v67
v_lshl_or_b32 v124, v77, 16, v76
v_lshl_or_b32 v125, v79, 16, v78
L_WRET:
s_setpc_b64 s[100:101]
L_END:
s_endpgm
.section .rodata,"a"
.p2align 6
.amdhsa_kernel standalone__normalfloat_lut_af4__prompt_kernel
  .amdhsa_next_free_vgpr 512
  .amdhsa_next_free_sgpr 102
  .amdhsa_accum_offset 256
  .amdhsa_group_segment_fixed_size 0
  .amdhsa_kernarg_size 56
  .amdhsa_user_sgpr_count 2
  .amdhsa_user_sgpr_kernarg_segment_ptr 1
  .amdhsa_system_sgpr_workgroup_id_x 1
.end_amdhsa_kernel
```

```asm
; @launch grid=(256,1,1) block=(256,1,1) lds=163840
.amdgcn_target "amdgcn-amd-amdhsa--gfx950"
.text
.globl standalone__normalfloat_lut_af4__prompt_kernel
.p2align 12
.p2align 8
.type standalone__normalfloat_lut_af4__prompt_kernel,@function
standalone__normalfloat_lut_af4__prompt_kernel:
s_load_dwordx4 s[4:7], s[0:1], 0
s_load_dwordx4 s[12:15], s[0:1], 40
s_load_dwordx4 s[8:11], s[0:1], 24
s_memrealtime s[56:57]
s_cmp_ge_u32 s2, 256
s_cbranch_scc1 L_END
s_getpc_b64 s[48:49]
L_PC0:
v_bfi_b32 v2, 7, v0, s2
v_lshlrev_b32 v2, 7, v2
v_min_u32 v2, L_END-L_PC0, v2
global_load_dword v7, v2, s[48:49]
v_lshrrev_b32 v1, 6, v0
s_cmp_lt_u32 s2, 32
v_readfirstlane_b32 s36, v1
s_cbranch_scc1 L_PACK
s_bfe_u32 s34, s2, 0x20001
s_bfe_u32 s37, s2, 0x20003
s_lshl2_add_u32 s37, s34, s37
s_and_b32 s43, s2, 1
s_mul_i32 s43, s43, 7
s_lshr_b32 s38, s2, 5
s_add_u32 s38, s38, s43
s_lshl2_add_u32 s39, s38, s36
s_sub_u32 s39, s39, 4
v_bfe_u32 v6, v0, 4, 2
v_and_b32 v3, 15, v0
v_mul_u32_u24 v2, 114688, v6
v_lshl_add_u32 v30, v3, 4, v2
s_lshr_b32 s46, s37, 1
s_and_b32 s45, s37, 1
s_lshl3_add_u32 s46, s46, s45
s_mul_i32 s46, s46, 57344
s_lshl_b32 s47, s39, 8
s_add_u32 s44, s46, s47
s_mov_b32 s18, 387328
s_mov_b32 s19, 0x20000
s_mov_b32 s92, 14336
s_mov_b32 s93, 28672
s_mov_b32 s94, 43008
s_waitcnt lgkmcnt(0)
s_add_u32 s16, s6, s44
s_addc_u32 s17, s7, 0
buffer_load_dwordx4 v[104:107], v30, s[16:19], 0 offen
buffer_load_dwordx4 v[108:111], v30, s[16:19], s92 offen
buffer_load_dwordx4 v[112:115], v30, s[16:19], s93 offen
buffer_load_dwordx4 v[116:119], v30, s[16:19], s94 offen
s_branch L_MAIN
L_PACK:
v_lshrrev_b32 v2, 2, v0
v_and_b32 v3, 3, v0
s_lshl_b32 s45, s2, 17
v_lshl_add_u32 v2, v2, 11, s45
v_lshl_add_u32 v17, v3, 7, v2
s_mov_b32 s30, 4194304
s_mov_b32 s31, 0x20000
v_lshlrev_b32 v16, 3, v0
s_cmp_lt_u32 s2, 2
s_cselect_b32 s34, 8, 0
s_mov_b32 s35, 0x20000
v_mov_b64 v[22:23], 0
s_waitcnt lgkmcnt(0)
s_mov_b64 s[32:33], s[12:13]
v_mov_b64 v[20:21], s[56:57]
buffer_atomic_cmpswap_x2 v[20:23], v16, s[32:35], 0 offen sc1
s_mov_b64 s[28:29], s[4:5]
buffer_load_dword v19, v17, s[28:31], 0 offen offset:0
s_branch L_PACK1
L_MAIN:
s_mov_b64 s[20:21], s[4:5]
s_mov_b32 s22, 4194304
s_mov_b32 s23, 0x20000
s_lshl_b32 s46, s37, 18
v_lshrrev_b32 v5, 3, v0
v_lshl_add_u32 v2, v5, 11, s46
v_lshrrev_b32 v4, 4, v0
v_xor_b32 v4, v4, v0
v_and_b32 v4, 7, v4
v_lshl_add_u32 v8, v4, 4, v2
v_add_u32 v9, 65536, v8
v_add_u32 v10, 131072, v8
v_add_u32 v11, 196608, v8
s_lshl_b32 s33, s36, 10
s_mul_i32 s47, s45, 114688
s_sub_u32 s47, s44, s47
s_add_u32 s47, s47, 57344
s_add_u32 s84, s6, s47
s_addc_u32 s85, s7, 0
s_mov_b32 s86, 387328
s_mov_b32 s87, 0x20000
s_lshl_b32 s40, s34, 7
s_add_u32 m0, s33, 65536
s_nop 0
buffer_load_dwordx4 v8, s[20:23], s40 offen lds
s_add_u32 m0, s33, 69632
s_nop 0
buffer_load_dwordx4 v9, s[20:23], s40 offen lds
s_add_u32 m0, s33, 73728
s_nop 0
buffer_load_dwordx4 v10, s[20:23], s40 offen lds
s_add_u32 m0, s33, 77824
s_nop 0
buffer_load_dwordx4 v11, s[20:23], s40 offen lds
v_mov_b32 v2, 0x3da3bf80
s_lshl_b64 exec, exec, 8
v_mov_b32 v2, 0x3e25bf32
s_lshl_b64 exec, exec, 8
v_mov_b32 v2, 0x3e7cbf06
s_lshl_b64 exec, exec, 8
v_mov_b32 v2, 0x3eadbeca
s_lshl_b64 exec, exec, 8
v_mov_b32 v2, 0x3ee2be92
s_lshl_b64 exec, exec, 8
v_mov_b32 v2, 0x3f10be3d
s_lshl_b64 exec, exec, 8
v_mov_b32 v2, 0x3f39bdba
s_lshl_b64 exec, exec, 8
v_mov_b32 v2, 0x3f800000
s_mov_b64 exec, -1
s_and_b32 s45, s36, 1
s_mul_i32 s45, s45, 0x0202
s_lshr_b32 s46, s36, 1
s_mul_i32 s46, s46, 0x02020000
s_add_u32 s45, s45, s46
s_add_u32 s45, s45, 0x05040100
v_mov_b32 v4, s45
v_lshlrev_b32 v5, 8, v5
v_and_b32 v31, 7, v0
v_lshl_add_u32 v31, v31, 4, v5
s_mov_b32 s45, 0xbf32bf80
v_perm_b32 v128, s45, v2, v4
v_mov_b32 v129, v128
v_mov_b64 v[130:131], v[128:129]
ds_write_b128 v31, v[128:131] offset:0
s_mov_b32 s45, 0xbecabf06
v_perm_b32 v132, s45, v2, v4
v_mov_b32 v133, v132
v_mov_b64 v[134:135], v[132:133]
v_and_b32 v5, 31, v0
v_lshlrev_b32 v19, 2, v5
v_and_b32 v0, 63, v0
s_lshl_b32 s46, s39, 7
ds_write_b128 v31, v[132:135] offset:8192
s_mov_b32 s45, 0xbe3dbe92
v_perm_b32 v136, s45, v2, v4
v_mov_b32 v137, v136
v_mov_b64 v[138:139], v[136:137]
v_lshl_add_u32 v28, v3, 3, s46
s_mul_i32 s47, s37, 917504
s_add_u32 s47, s47, s46
s_add_u32 s28, s10, s47
s_addc_u32 s29, s11, 0
ds_write_b128 v31, v[136:139] offset:16384
s_mov_b32 s45, 0xbdba
v_perm_b32 v140, s45, v2, v4
v_mov_b32 v141, v140
v_mov_b64 v[142:143], v[140:141]
s_mov_b32 s30, 86144
s_mov_b32 s31, 0x20000
v_mul_u32_u24 v29, 28672, v6
v_lshl_add_u32 v18, v3, 3, v29
ds_write_b128 v31, v[140:143] offset:24576
s_mov_b32 s45, 0x3e253da3
v_perm_b32 v144, s45, v2, v4
v_mov_b32 v145, v144
v_mov_b64 v[146:147], v[144:145]
v_lshlrev_b32 v29, 7, v3
v_bfe_u32 v5, v0, 1, 3
v_xor_b32 v5, v5, v6
v_lshl_add_u32 v29, v5, 4, v29
s_load_dwordx2 s[88:89], s[12:13], 0
ds_write_b128 v31, v[144:147] offset:32768
s_mov_b32 s45, 0x3ead3e7c
v_perm_b32 v148, s45, v2, v4
v_mov_b32 v149, v148
v_mov_b64 v[150:151], v[148:149]
v_add_u32 v14, 65536, v29
v_xor_b32 v15, 64, v14
v_add_u32 v16, 0x10000, v14
v_add_u32 v17, 0x10000, v15
ds_write_b128 v31, v[148:151] offset:40960
s_mov_b32 s45, 0x3f103ee2
v_perm_b32 v152, s45, v2, v4
v_mov_b32 v153, v152
v_mov_b64 v[154:155], v[152:153]
s_mov_b32 s52, 0x0c0c0400
s_mov_b32 s53, 0x0c0c0500
s_mov_b32 s54, 0x0c0c0600
s_mov_b32 s55, 0x0c0c0700
ds_write_b128 v31, v[152:155] offset:49152
s_mov_b32 s45, 0x3f803f39
v_perm_b32 v156, s45, v2, v4
v_mov_b32 v157, v156
v_mov_b64 v[158:159], v[156:157]
v_lshlrev_b32 v13, 4, v0
s_lshl_b32 s47, s39, 16
s_add_u32 s24, s14, s47
s_addc_u32 s25, s15, 0
s_lshl_b32 s47, s37, 10
ds_write_b128 v31, v[156:159] offset:57344
s_add_u32 s76, s24, s47
s_addc_u32 s77, s25, 0
s_movk_i32 s78, 1024
s_mov_b32 s79, 0x20000
s_lshl_b32 s47, s34, 3
s_lshr_b32 s47, 0x90d0b2d, s47
s_bfe_u32 s41, s47, 0x20000
s_lshl_b32 s41, s41, 7
s_bfe_u32 s42, s47, 0x20002
s_lshl_b32 s42, s42, 7
s_bfe_u32 s43, s47, 0x20004
s_lshl_b32 s43, s43, 7
s_lshl_b32 s47, s34, 1
s_lshr_b32 s47, 0x63, s47
s_and_b32 s47, s47, 3
s_sub_u32 s47, s47, s34
s_lshl1_add_u32 s3, s47, 14
s_mul_i32 s47, s3, 458752
s_add_u32 s16, s16, s47
s_addc_u32 s17, s17, 0
s_lshl_b32 s3, s3, 11
s_lshr_b32 s35, s37, 1
s_xor_b32 s35, s35, 1
v_lshl_add_u32 v12, s41, 5, v13
s_mul_i32 s47, s35, 458752
s_lshl_b32 s46, s39, 8
s_add_u32 s47, s47, s46
s_add_u32 s72, s6, s47
s_addc_u32 s73, s7, 0
s_mov_b32 s74, 444672
s_mov_b32 s75, 0x20000
v_add_u32 v31, 57344, v30
s_and_b32 s47, s37, 2
s_lshl_b32 s47, s47, 5
v_xor_b32 v2, s47, v14
v_xor_b32 v4, 64, v2
s_mov_b32 s26, 65536
s_mov_b32 s27, 0x20000
s_mov_b64 s[80:81], s[12:13]
s_movk_i32 s82, 128
s_mov_b32 s83, 0x20000
s_movk_i32 s90, 4096
buffer_load_dwordx4 v[64:67], v30, s[84:87], 0 offen
buffer_load_dwordx4 v[68:71], v30, s[84:87], s92 offen
buffer_load_dwordx4 v[72:75], v30, s[84:87], s93 offen
buffer_load_dwordx4 v[76:79], v30, s[84:87], s94 offen
s_mov_b64 vcc, -1
s_cmp_eq_u32 s36, 0
s_cbranch_scc1 L_PAD0
s_cmp_eq_u32 s36, 1
s_cbranch_scc1 L_PAD2
s_cmp_eq_u32 s36, 2
s_cbranch_scc1 L_PAD4
s_cmp_eq_u32 s36, 3
s_cbranch_scc1 L_PADRET
L_PADRET:
s_mov_b64 vcc, 0
s_waitcnt vmcnt(8)
v_lshl_add_u64 v[104:105], v[108:109], 4, v[104:105]
v_lshl_add_u64 v[106:107], v[110:111], 4, v[106:107]
v_lshl_add_u64 v[112:113], v[116:117], 4, v[112:113]
v_lshl_add_u64 v[114:115], v[118:119], 4, v[114:115]
v_lshl_or_b32 v116, v112, 8, v104
v_lshl_or_b32 v117, v113, 8, v105
v_lshl_or_b32 v118, v114, 8, v106
v_lshl_or_b32 v119, v115, 8, v107
v_lshl_or_b32 v108, v117, 16, v116
v_lshl_or_b32 v109, v119, 16, v118
s_waitcnt lgkmcnt(0)
s_cmp_eq_u64 s[88:89], 0
s_cbranch_scc1 L_NOTAG
L_TAGOK:
v_mov_b64 v[110:111], s[88:89]
buffer_store_dwordx4 v[108:111], v13, s[76:79], 0 offen sc1
s_add_u32 s76, s76, s3
s_addc_u32 s77, s77, 0
s_waitcnt lgkmcnt(0)
s_nop 0
s_branch L_STREAM
L_PACK1:
v_and_b32 v0, 63, v0
v_lshrrev_b32 v2, 4, v0
v_and_b32 v3, 15, v0
v_mul_u32_u24 v2, 114688, v2
v_lshl_add_u32 v8, v3, 4, v2
s_movk_i32 s47, 0x3800
v_add_u32 v9, s47, v8
v_add_u32 v10, s47, v9
v_add_u32 v11, s47, v10
v_add_u32 v12, s47, v11
v_add_u32 v13, s47, v12
v_add_u32 v14, s47, v13
v_add_u32 v15, s47, v14
s_sub_u32 s3, s2, 1
s_and_b32 s3, s3, 7
s_lshr_b32 s45, s2, 3
s_lshl2_add_u32 s3, s3, s45
s_mul_i32 s40, s3, 4682
s_lshr_b32 s40, s40, 16
s_mul_i32 s41, s40, 14
s_sub_u32 s41, s3, s41
s_add_u32 s40, s40, 8
s_mov_b32 s22, 14680064
s_mov_b32 s23, 0x20000
s_mov_b64 s[20:21], s[6:7]
s_cmp_ge_u32 s40, 14
s_cselect_b32 s45, 8, 0
s_add_u32 s45, s45, s40
s_lshl2_add_u32 s42, s41, s36
s_mul_i32 s43, s45, 458752
s_lshl_b32 s44, s42, 8
s_add_u32 s43, s43, s44
s_lshl_b32 s44, s42, 5
s_add_u32 s44, s44, s45
s_lshl_b32 s52, s44, 11
s_cmp_lt_u32 s45, 32
s_cselect_b32 s52, s52, 0x1000000
s_cselect_b32 s22, 14680064, 0
s_add_u32 s41, s41, 4
s_add_u32 s40, s40, 2
s_cmp_ge_u32 s41, 14
s_cselect_b32 s48, 14, 0
s_addc_u32 s40, s40, 0
s_sub_u32 s41, s41, s48
s_load_dwordx2 s[50:51], s[12:13], 0
buffer_load_dwordx4 v[32:35], v8, s[20:23], s43 offen
buffer_load_dwordx4 v[36:39], v9, s[20:23], s43 offen
buffer_load_dwordx4 v[40:43], v10, s[20:23], s43 offen
buffer_load_dwordx4 v[44:47], v11, s[20:23], s43 offen
buffer_load_dwordx4 v[48:51], v12, s[20:23], s43 offen
buffer_load_dwordx4 v[52:55], v13, s[20:23], s43 offen
buffer_load_dwordx4 v[56:59], v14, s[20:23], s43 offen
buffer_load_dwordx4 v[60:63], v15, s[20:23], s43 offen
s_mov_b64 s[24:25], s[14:15]
s_mov_b32 s26, 3670016
s_mov_b32 s27, 0x20000
s_movk_i32 s34, 128
v_mov_b32 v16, 0
v_lshlrev_b32 v18, 4, v0
s_movk_i32 s46, 4096
s_waitcnt vmcnt(4) lgkmcnt(0)
v_mov_b64 v[22:23], s[50:51]
s_nop 0
L_PKN:
v_cmp_ne_u64 vcc, 0, v[22:23]
s_sub_u32 s46, s46, 1
s_cmp_gt_i32 s46, 0
s_cbranch_vccnz L_PKGO
s_cbranch_scc0 L_END
buffer_load_dwordx2 v[22:23], v16, s[32:35], 0 offen sc1
s_waitcnt vmcnt(0)
s_branch L_PKN
L_PKGO:
s_call_b64 s[100:101], L_PK0
buffer_store_dwordx4 v[20:23], v18, s[24:27], s52 offen offset:0 sc1
s_waitcnt lgkmcnt(0)
s_call_b64 s[100:101], L_UNIT
s_mov_b32 s53, s49
buffer_load_dwordx4 v[64:67], v8, s[20:23], s43 offen
buffer_load_dwordx4 v[68:71], v9, s[20:23], s43 offen
buffer_load_dwordx4 v[72:75], v10, s[20:23], s43 offen
buffer_load_dwordx4 v[76:79], v11, s[20:23], s43 offen
s_waitcnt vmcnt(5)
s_call_b64 s[100:101], L_PK1
buffer_store_dwordx4 v[20:23], v18, s[24:27], s52 offen offset:1024 sc1
buffer_load_dwordx4 v[80:83], v12, s[20:23], s43 offen
buffer_load_dwordx4 v[84:87], v13, s[20:23], s43 offen
buffer_load_dwordx4 v[88:91], v14, s[20:23], s43 offen
buffer_load_dwordx4 v[92:95], v15, s[20:23], s43 offen
s_waitcnt vmcnt(5)
s_call_b64 s[100:101], L_PK2
buffer_store_dwordx4 v[20:23], v18, s[24:27], s53 offen offset:0 sc1
s_call_b64 s[100:101], L_UNIT
s_mov_b32 s54, s49
buffer_load_dwordx4 v[32:35], v8, s[20:23], s43 offen
buffer_load_dwordx4 v[36:39], v9, s[20:23], s43 offen
buffer_load_dwordx4 v[40:43], v10, s[20:23], s43 offen
buffer_load_dwordx4 v[44:47], v11, s[20:23], s43 offen
s_waitcnt vmcnt(5)
s_call_b64 s[100:101], L_PK3
buffer_store_dwordx4 v[20:23], v18, s[24:27], s53 offen offset:1024 sc1
buffer_load_dwordx4 v[48:51], v12, s[20:23], s43 offen
buffer_load_dwordx4 v[52:55], v13, s[20:23], s43 offen
buffer_load_dwordx4 v[56:59], v14, s[20:23], s43 offen
buffer_load_dwordx4 v[60:63], v15, s[20:23], s43 offen
s_waitcnt vmcnt(5)
s_call_b64 s[100:101], L_PK0
buffer_store_dwordx4 v[20:23], v18, s[24:27], s54 offen offset:0 sc1
s_call_b64 s[100:101], L_UNIT
s_mov_b32 s55, s49
buffer_load_dwordx4 v[64:67], v8, s[20:23], s43 offen
buffer_load_dwordx4 v[68:71], v9, s[20:23], s43 offen
buffer_load_dwordx4 v[72:75], v10, s[20:23], s43 offen
buffer_load_dwordx4 v[76:79], v11, s[20:23], s43 offen
s_waitcnt vmcnt(5)
s_call_b64 s[100:101], L_PK1
buffer_store_dwordx4 v[20:23], v18, s[24:27], s54 offen offset:1024 sc1
buffer_load_dwordx4 v[80:83], v12, s[20:23], s43 offen
buffer_load_dwordx4 v[84:87], v13, s[20:23], s43 offen
buffer_load_dwordx4 v[88:91], v14, s[20:23], s43 offen
buffer_load_dwordx4 v[92:95], v15, s[20:23], s43 offen
s_waitcnt vmcnt(5)
s_call_b64 s[100:101], L_PK2
buffer_store_dwordx4 v[20:23], v18, s[24:27], s55 offen offset:0 sc1
s_call_b64 s[100:101], L_UNIT
s_mov_b32 s52, s49
buffer_load_dwordx4 v[32:35], v8, s[20:23], s43 offen
buffer_load_dwordx4 v[36:39], v9, s[20:23], s43 offen
buffer_load_dwordx4 v[40:43], v10, s[20:23], s43 offen
buffer_load_dwordx4 v[44:47], v11, s[20:23], s43 offen
s_waitcnt vmcnt(5)
s_call_b64 s[100:101], L_PK3
buffer_store_dwordx4 v[20:23], v18, s[24:27], s55 offen offset:1024 sc1
buffer_load_dwordx4 v[48:51], v12, s[20:23], s43 offen
buffer_load_dwordx4 v[52:55], v13, s[20:23], s43 offen
buffer_load_dwordx4 v[56:59], v14, s[20:23], s43 offen
buffer_load_dwordx4 v[60:63], v15, s[20:23], s43 offen
s_waitcnt vmcnt(5)
s_call_b64 s[100:101], L_PK0
buffer_store_dwordx4 v[20:23], v18, s[24:27], s52 offen offset:0 sc1
s_call_b64 s[100:101], L_UNIT
s_mov_b32 s53, s49
buffer_load_dwordx4 v[64:67], v8, s[20:23], s43 offen
buffer_load_dwordx4 v[68:71], v9, s[20:23], s43 offen
buffer_load_dwordx4 v[72:75], v10, s[20:23], s43 offen
buffer_load_dwordx4 v[76:79], v11, s[20:23], s43 offen
s_waitcnt vmcnt(5)
s_call_b64 s[100:101], L_PK1
buffer_store_dwordx4 v[20:23], v18, s[24:27], s52 offen offset:1024 sc1
buffer_load_dwordx4 v[80:83], v12, s[20:23], s43 offen
buffer_load_dwordx4 v[84:87], v13, s[20:23], s43 offen
buffer_load_dwordx4 v[88:91], v14, s[20:23], s43 offen
buffer_load_dwordx4 v[92:95], v15, s[20:23], s43 offen
s_waitcnt vmcnt(5)
s_call_b64 s[100:101], L_PK2
buffer_store_dwordx4 v[20:23], v18, s[24:27], s53 offen offset:0 sc1
s_call_b64 s[100:101], L_UNIT
s_mov_b32 s54, s49
buffer_load_dwordx4 v[32:35], v8, s[20:23], s43 offen
buffer_load_dwordx4 v[36:39], v9, s[20:23], s43 offen
buffer_load_dwordx4 v[40:43], v10, s[20:23], s43 offen
buffer_load_dwordx4 v[44:47], v11, s[20:23], s43 offen
s_waitcnt vmcnt(5)
s_call_b64 s[100:101], L_PK3
buffer_store_dwordx4 v[20:23], v18, s[24:27], s53 offen offset:1024 sc1
buffer_load_dwordx4 v[48:51], v12, s[20:23], s43 offen
buffer_load_dwordx4 v[52:55], v13, s[20:23], s43 offen
buffer_load_dwordx4 v[56:59], v14, s[20:23], s43 offen
buffer_load_dwordx4 v[60:63], v15, s[20:23], s43 offen
s_waitcnt vmcnt(5)
s_call_b64 s[100:101], L_PK0
buffer_store_dwordx4 v[20:23], v18, s[24:27], s54 offen offset:0 sc1
s_waitcnt vmcnt(1)
s_call_b64 s[100:101], L_PK1
buffer_store_dwordx4 v[20:23], v18, s[24:27], s54 offen offset:1024 sc1
s_endpgm
L_UNIT:
s_cmp_ge_u32 s40, 14
s_cselect_b32 s45, 8, 0
s_add_u32 s45, s45, s40
s_lshl2_add_u32 s42, s41, s36
s_mul_i32 s43, s45, 458752
s_lshl_b32 s44, s42, 8
s_add_u32 s43, s43, s44
s_lshl_b32 s44, s42, 5
s_add_u32 s44, s44, s45
s_lshl_b32 s49, s44, 11
s_cmp_lt_u32 s45, 32
s_cselect_b32 s49, s49, 0x1000000
s_cselect_b32 s22, 14680064, 0
s_add_u32 s41, s41, 4
s_add_u32 s40, s40, 2
s_cmp_ge_u32 s41, 14
s_cselect_b32 s48, 14, 0
s_addc_u32 s40, s40, 0
s_sub_u32 s41, s41, s48
s_setpc_b64 s[100:101]
L_PK0:
v_lshl_add_u64 v[32:33], v[36:37], 4, v[32:33]
v_lshl_add_u64 v[34:35], v[38:39], 4, v[34:35]
v_lshl_add_u64 v[40:41], v[44:45], 4, v[40:41]
v_lshl_add_u64 v[42:43], v[46:47], 4, v[42:43]
v_lshl_or_b32 v44, v40, 8, v32
v_lshl_or_b32 v45, v41, 8, v33
v_lshl_or_b32 v46, v42, 8, v34
v_lshl_or_b32 v47, v43, 8, v35
v_lshl_or_b32 v20, v45, 16, v44
v_lshl_or_b32 v21, v47, 16, v46
s_setpc_b64 s[100:101]
L_PK1:
v_lshl_add_u64 v[48:49], v[52:53], 4, v[48:49]
v_lshl_add_u64 v[50:51], v[54:55], 4, v[50:51]
v_lshl_add_u64 v[56:57], v[60:61], 4, v[56:57]
v_lshl_add_u64 v[58:59], v[62:63], 4, v[58:59]
v_lshl_or_b32 v60, v56, 8, v48
v_lshl_or_b32 v61, v57, 8, v49
v_lshl_or_b32 v62, v58, 8, v50
v_lshl_or_b32 v63, v59, 8, v51
v_lshl_or_b32 v20, v61, 16, v60
v_lshl_or_b32 v21, v63, 16, v62
s_setpc_b64 s[100:101]
L_PK2:
v_lshl_add_u64 v[64:65], v[68:69], 4, v[64:65]
v_lshl_add_u64 v[66:67], v[70:71], 4, v[66:67]
v_lshl_add_u64 v[72:73], v[76:77], 4, v[72:73]
v_lshl_add_u64 v[74:75], v[78:79], 4, v[74:75]
v_lshl_or_b32 v76, v72, 8, v64
v_lshl_or_b32 v77, v73, 8, v65
v_lshl_or_b32 v78, v74, 8, v66
v_lshl_or_b32 v79, v75, 8, v67
v_lshl_or_b32 v20, v77, 16, v76
v_lshl_or_b32 v21, v79, 16, v78
s_setpc_b64 s[100:101]
L_PK3:
v_lshl_add_u64 v[80:81], v[84:85], 4, v[80:81]
v_lshl_add_u64 v[82:83], v[86:87], 4, v[82:83]
v_lshl_add_u64 v[88:89], v[92:93], 4, v[88:89]
v_lshl_add_u64 v[90:91], v[94:95], 4, v[90:91]
v_lshl_or_b32 v92, v88, 8, v80
v_lshl_or_b32 v93, v89, 8, v81
v_lshl_or_b32 v94, v90, 8, v82
v_lshl_or_b32 v95, v91, 8, v83
v_lshl_or_b32 v20, v93, 16, v92
v_lshl_or_b32 v21, v95, 16, v94
s_setpc_b64 s[100:101]
.p2align 12
L_STREAM:
L_PAD0:
s_cbranch_vccnz L_PAD1
buffer_load_dwordx4 v[80:83], v30, s[72:75], 0 offen
buffer_load_dwordx4 v[84:87], v30, s[72:75], s92 offen
buffer_load_dwordx4 v[88:91], v30, s[72:75], s93 offen
buffer_load_dwordx4 v[92:95], v30, s[72:75], s94 offen
buffer_load_dwordx4 v[40:43], v31, s[72:75], 0 offen
buffer_load_dwordx4 v[44:47], v31, s[72:75], s92 offen
buffer_load_dwordx4 v[48:51], v31, s[72:75], s93 offen
buffer_load_dwordx4 v[52:55], v31, s[72:75], s94 offen
s_waitcnt vmcnt(13)
s_barrier
ds_read_b128 a[224:227], v2 offset:0
ds_read_b128 a[228:231], v2 offset:2048
v_lshl_add_u32 v104, v104, 8, v19
v_lshl_add_u32 v105, v105, 8, v19
v_lshl_add_u32 v106, v106, 8, v19
v_lshl_add_u32 v107, v107, 8, v19
v_lshl_add_u32 v112, v112, 8, v19
v_lshl_add_u32 v113, v113, 8, v19
v_lshl_add_u32 v114, v114, 8, v19
v_lshl_add_u32 v115, v115, 8, v19
s_waitcnt vmcnt(9)
v_lshl_add_u64 v[64:65], v[68:69], 4, v[64:65]
v_lshl_add_u64 v[66:67], v[70:71], 4, v[66:67]
v_lshl_add_u64 v[72:73], v[76:77], 4, v[72:73]
v_lshl_add_u64 v[74:75], v[78:79], 4, v[74:75]
v_lshl_add_u32 v64, v64, 8, v19
v_lshl_add_u32 v65, v65, 8, v19
v_lshl_add_u32 v66, v66, 8, v19
v_lshl_add_u32 v67, v67, 8, v19
v_lshl_add_u32 v72, v72, 8, v19
v_lshl_add_u32 v73, v73, 8, v19
v_lshl_add_u32 v74, v74, 8, v19
v_lshl_add_u32 v75, v75, 8, v19
s_bitcmp1_b32 s37, 0
s_cbranch_scc0 L_NOSWAP
v_swap_b32 v104, v64
v_swap_b32 v105, v65
v_swap_b32 v106, v66
v_swap_b32 v107, v67
v_swap_b32 v112, v72
v_swap_b32 v113, v73
v_swap_b32 v114, v74
v_swap_b32 v115, v75
L_NOSWAP:
ds_read_b32 a0, v104
ds_read_b32 a1, v112
ds_read_b32 a2, v64
ds_read_b32 a3, v72
ds_read_b32 a4, v105
ds_read_b32 a5, v113
ds_read_b32 a6, v65
ds_read_b32 a7, v73
ds_read_b32 a8, v106
ds_read_b32 a9, v114
ds_read_b32 a10, v66
ds_read_b32 a11, v74
ds_read_b32 a12, v107
ds_read_b32 a13, v115
ds_read_b32 a14, v67
ds_read_b32 a15, v75
s_waitcnt lgkmcnt(12)
v_mfma_f32_16x16x32_bf16 v[128:131], a[224:227], a[0:3], 0
s_waitcnt lgkmcnt(8)
ds_read_b128 a[232:235], v2 offset:4096
v_mfma_f32_16x16x32_bf16 v[132:135], a[224:227], a[4:7], 0
s_waitcnt lgkmcnt(5)
v_mfma_f32_16x16x32_bf16 v[136:139], a[224:227], a[8:11], 0
s_waitcnt lgkmcnt(1)
s_add_u32 m0, s33, 81920
v_mfma_f32_16x16x32_bf16 v[140:143], a[224:227], a[12:15], 0
v_mfma_f32_16x16x32_bf16 v[144:147], a[228:231], a[0:3], 0
ds_read_b128 a[236:239], v2 offset:6144
buffer_load_dwordx4 v8, s[20:23], s41 offen lds
v_mfma_f32_16x16x32_bf16 v[148:151], a[228:231], a[4:7], 0
v_mfma_f32_16x16x32_bf16 v[152:155], a[228:231], a[8:11], 0
s_add_u32 m0, s33, 86016
v_mfma_f32_16x16x32_bf16 v[156:159], a[228:231], a[12:15], 0
s_waitcnt lgkmcnt(1)
v_mfma_f32_16x16x32_bf16 v[160:163], a[232:235], a[0:3], 0
ds_read_b128 a[240:243], v2 offset:8192
buffer_load_dwordx4 v9, s[20:23], s41 offen lds
v_mfma_f32_16x16x32_bf16 v[164:167], a[232:235], a[4:7], 0
v_mfma_f32_16x16x32_bf16 v[168:171], a[232:235], a[8:11], 0
s_add_u32 m0, s33, 90112
v_mfma_f32_16x16x32_bf16 v[172:175], a[232:235], a[12:15], 0
s_waitcnt lgkmcnt(1)
v_mfma_f32_16x16x32_bf16 v[176:179], a[236:239], a[0:3], 0
ds_read_b128 a[244:247], v2 offset:10240
buffer_load_dwordx4 v10, s[20:23], s41 offen lds
v_mfma_f32_16x16x32_bf16 v[180:183], a[236:239], a[4:7], 0
v_mfma_f32_16x16x32_bf16 v[184:187], a[236:239], a[8:11], 0
s_add_u32 m0, s33, 94208
v_mfma_f32_16x16x32_bf16 v[188:191], a[236:239], a[12:15], 0
s_waitcnt lgkmcnt(1)
v_mfma_f32_16x16x32_bf16 v[192:195], a[240:243], a[0:3], 0
buffer_load_dwordx4 v11, s[20:23], s41 offen lds
v_mfma_f32_16x16x32_bf16 v[196:199], a[240:243], a[4:7], 0
v_mfma_f32_16x16x32_bf16 v[200:203], a[240:243], a[8:11], 0
v_mfma_f32_16x16x32_bf16 v[204:207], a[240:243], a[12:15], 0
s_waitcnt lgkmcnt(0)
v_mfma_f32_16x16x32_bf16 v[208:211], a[244:247], a[0:3], 0
ds_read_b128 a[248:251], v2 offset:12288
v_mfma_f32_16x16x32_bf16 v[212:215], a[244:247], a[4:7], 0
v_mfma_f32_16x16x32_bf16 v[216:219], a[244:247], a[8:11], 0
buffer_load_dwordx4 v[32:35], v12, s[24:27], 0 offen offset:0 sc1
v_mfma_f32_16x16x32_bf16 v[220:223], a[244:247], a[12:15], 0
buffer_load_dwordx4 v[36:39], v12, s[24:27], 0 offen offset:1024 sc1
s_waitcnt vmcnt(12)
ds_read_b128 a[252:255], v2 offset:14336
v_lshl_add_u64 v[80:81], v[84:85], 4, v[80:81]
v_lshl_add_u64 v[82:83], v[86:87], 4, v[82:83]
v_lshl_add_u32 v80, v80, 8, v19
v_lshl_add_u32 v81, v81, 8, v19
v_lshl_add_u32 v82, v82, 8, v19
v_lshl_add_u32 v83, v83, 8, v19
ds_read_b32 a16, v80
ds_read_b32 a20, v81
ds_read_b32 a24, v82
ds_read_b32 a28, v83
s_waitcnt vmcnt(10)
v_lshl_add_u64 v[88:89], v[92:93], 4, v[88:89]
v_lshl_add_u64 v[90:91], v[94:95], 4, v[90:91]
v_lshl_add_u32 v88, v88, 8, v19
v_lshl_add_u32 v89, v89, 8, v19
v_lshl_add_u32 v90, v90, 8, v19
v_lshl_add_u32 v91, v91, 8, v19
ds_read_b32 a17, v88
ds_read_b32 a21, v89
ds_read_b32 a25, v90
ds_read_b32 a29, v91
s_waitcnt vmcnt(8)
v_lshl_add_u64 v[40:41], v[44:45], 4, v[40:41]
v_lshl_add_u64 v[42:43], v[46:47], 4, v[42:43]
v_lshl_add_u32 v40, v40, 8, v19
v_lshl_add_u32 v41, v41, 8, v19
v_lshl_add_u32 v42, v42, 8, v19
v_lshl_add_u32 v43, v43, 8, v19
ds_read_b32 a18, v40
ds_read_b32 a22, v41
ds_read_b32 a26, v42
ds_read_b32 a30, v43
s_waitcnt vmcnt(6) lgkmcnt(13)
v_lshl_add_u64 v[48:49], v[52:53], 4, v[48:49]
v_lshl_add_u64 v[50:51], v[54:55], 4, v[50:51]
v_lshl_add_u32 v48, v48, 8, v19
v_lshl_add_u32 v49, v49, 8, v19
v_lshl_add_u32 v50, v50, 8, v19
v_lshl_add_u32 v51, v51, 8, v19
ds_read_b32 a19, v48
ds_read_b32 a23, v49
ds_read_b32 a27, v50
ds_read_b32 a31, v51
v_mfma_f32_16x16x32_bf16 v[224:227], a[248:251], a[0:3], 0
ds_read_b128 a[224:227], v4 offset:0
v_mfma_f32_16x16x32_bf16 v[228:231], a[248:251], a[4:7], 0
v_mfma_f32_16x16x32_bf16 v[232:235], a[248:251], a[8:11], 0
global_load_dwordx2 v[20:21], v28, s[8:9]
v_mfma_f32_16x16x32_bf16 v[236:239], a[248:251], a[12:15], 0
s_waitcnt lgkmcnt(5)
v_mfma_f32_16x16x32_bf16 v[240:243], a[252:255], a[0:3], 0
ds_read_b128 a[228:231], v4 offset:2048
v_mfma_f32_16x16x32_bf16 v[244:247], a[252:255], a[4:7], 0
v_mfma_f32_16x16x32_bf16 v[248:251], a[252:255], a[8:11], 0
v_mfma_f32_16x16x32_bf16 v[252:255], a[252:255], a[12:15], 0
s_waitcnt lgkmcnt(1)
v_mfma_f32_16x16x32_bf16 v[128:131], a[224:227], a[16:19], v[128:131]
ds_read_b128 a[232:235], v4 offset:4096
v_mfma_f32_16x16x32_bf16 v[132:135], a[224:227], a[20:23], v[132:135]
v_mfma_f32_16x16x32_bf16 v[136:139], a[224:227], a[24:27], v[136:139]
v_mfma_f32_16x16x32_bf16 v[140:143], a[224:227], a[28:31], v[140:143]
s_waitcnt lgkmcnt(1)
v_mfma_f32_16x16x32_bf16 v[144:147], a[228:231], a[16:19], v[144:147]
ds_read_b128 a[236:239], v4 offset:6144
v_mfma_f32_16x16x32_bf16 v[148:151], a[228:231], a[20:23], v[148:151]
v_mfma_f32_16x16x32_bf16 v[152:155], a[228:231], a[24:27], v[152:155]
v_mfma_f32_16x16x32_bf16 v[156:159], a[228:231], a[28:31], v[156:159]
s_waitcnt lgkmcnt(1)
v_mfma_f32_16x16x32_bf16 v[160:163], a[232:235], a[16:19], v[160:163]
ds_read_b128 a[240:243], v4 offset:8192
buffer_load_dwordx4 v[40:43], v12, s[24:27], 0 offen offset:2048 sc1
v_mfma_f32_16x16x32_bf16 v[164:167], a[232:235], a[20:23], v[164:167]
buffer_load_dwordx4 v[44:47], v12, s[24:27], 0 offen offset:3072 sc1
v_lshl_add_u32 v12, s42, 5, v13
v_mfma_f32_16x16x32_bf16 v[168:171], a[232:235], a[24:27], v[168:171]
v_mfma_f32_16x16x32_bf16 v[172:175], a[232:235], a[28:31], v[172:175]
s_waitcnt lgkmcnt(1)
v_mfma_f32_16x16x32_bf16 v[176:179], a[236:239], a[16:19], v[176:179]
ds_read_b128 a[244:247], v4 offset:10240
v_mfma_f32_16x16x32_bf16 v[180:183], a[236:239], a[20:23], v[180:183]
v_mfma_f32_16x16x32_bf16 v[184:187], a[236:239], a[24:27], v[184:187]
s_add_u32 m0, s33, 98304
v_mfma_f32_16x16x32_bf16 v[188:191], a[236:239], a[28:31], v[188:191]
s_waitcnt lgkmcnt(1)
v_mfma_f32_16x16x32_bf16 v[192:195], a[240:243], a[16:19], v[192:195]
buffer_load_dwordx4 v8, s[20:23], s42 offen lds
v_mfma_f32_16x16x32_bf16 v[196:199], a[240:243], a[20:23], v[196:199]
v_mfma_f32_16x16x32_bf16 v[200:203], a[240:243], a[24:27], v[200:203]
s_add_u32 m0, s33, 102400
v_mfma_f32_16x16x32_bf16 v[204:207], a[240:243], a[28:31], v[204:207]
s_waitcnt lgkmcnt(0)
v_mfma_f32_16x16x32_bf16 v[208:211], a[244:247], a[16:19], v[208:211]
s_waitcnt vmcnt(6)
s_barrier
ds_read_b128 a[248:251], v4 offset:12288
buffer_load_dwordx4 v9, s[20:23], s42 offen lds
v_mfma_f32_16x16x32_bf16 v[212:215], a[244:247], a[20:23], v[212:215]
buffer_load_dwordx4 v[48:51], v12, s[24:27], 0 offen offset:0 sc1
v_mfma_f32_16x16x32_bf16 v[216:219], a[244:247], a[24:27], v[216:219]
s_add_u32 m0, s33, 106496
buffer_load_dwordx4 v[52:55], v12, s[24:27], 0 offen offset:1024 sc1
v_mfma_f32_16x16x32_bf16 v[220:223], a[244:247], a[28:31], v[220:223]
ds_read_b128 a[252:255], v4 offset:14336
buffer_load_dwordx4 v10, s[20:23], s42 offen lds
s_waitcnt vmcnt(8)
v_cmp_ne_u64 s[50:51], s[88:89], v[34:35]
v_cmp_ne_u64 s[44:45], s[88:89], v[38:39]
s_or_b64 s[50:51], s[44:45], s[50:51]
s_cbranch_scc1 L_SLOW2
L_BACK2:
v_perm_b32 v64, v32, v19, s52
v_perm_b32 v65, v32, v19, s53
v_perm_b32 v66, v36, v19, s52
v_perm_b32 v67, v36, v19, s53
v_perm_b32 v68, v32, v19, s54
v_perm_b32 v69, v32, v19, s55
v_perm_b32 v70, v36, v19, s54
v_perm_b32 v71, v36, v19, s55
ds_read_b32 a32, v64
ds_read_b32 a33, v65
ds_read_b32 a34, v66
ds_read_b32 a35, v67
ds_read_b32 a36, v68
ds_read_b32 a37, v69
ds_read_b32 a38, v70
ds_read_b32 a39, v71
v_perm_b32 v72, v33, v19, s52
v_perm_b32 v73, v33, v19, s53
v_perm_b32 v74, v37, v19, s52
v_perm_b32 v75, v37, v19, s53
v_perm_b32 v76, v33, v19, s54
v_perm_b32 v77, v33, v19, s55
v_perm_b32 v78, v37, v19, s54
v_perm_b32 v79, v37, v19, s55
ds_read_b32 a40, v72
ds_read_b32 a41, v73
ds_read_b32 a42, v74
ds_read_b32 a43, v75
ds_read_b32 a44, v76
ds_read_b32 a45, v77
ds_read_b32 a46, v78
ds_read_b32 a47, v79
s_add_u32 m0, s33, 110592
s_waitcnt lgkmcnt(15)
v_mfma_f32_16x16x32_bf16 v[224:227], a[248:251], a[16:19], v[224:227]
ds_read_b128 a[224:227], v14 offset:16384
buffer_load_dwordx4 v11, s[20:23], s42 offen lds
v_mfma_f32_16x16x32_bf16 v[228:231], a[248:251], a[20:23], v[228:231]
v_mfma_f32_16x16x32_bf16 v[232:235], a[248:251], a[24:27], v[232:235]
s_add_u32 m0, s33, 114688
v_mfma_f32_16x16x32_bf16 v[236:239], a[248:251], a[28:31], v[236:239]
v_mfma_f32_16x16x32_bf16 v[240:243], a[252:255], a[16:19], v[240:243]
ds_read_b128 a[228:231], v14 offset:18432
buffer_load_dwordx4 v8, s[20:23], s43 offen lds
v_mfma_f32_16x16x32_bf16 v[244:247], a[252:255], a[20:23], v[244:247]
v_mfma_f32_16x16x32_bf16 v[248:251], a[252:255], a[24:27], v[248:251]
s_add_u32 m0, s33, 118784
v_mfma_f32_16x16x32_bf16 v[252:255], a[252:255], a[28:31], v[252:255]
s_waitcnt lgkmcnt(1)
v_mfma_f32_16x16x32_bf16 v[128:131], a[224:227], a[32:35], v[128:131]
ds_read_b128 a[232:235], v14 offset:20480
buffer_load_dwordx4 v9, s[20:23], s43 offen lds
v_mfma_f32_16x16x32_bf16 v[132:135], a[224:227], a[36:39], v[132:135]
v_mfma_f32_16x16x32_bf16 v[136:139], a[224:227], a[40:43], v[136:139]
v_mfma_f32_16x16x32_bf16 v[140:143], a[224:227], a[44:47], v[140:143]
s_waitcnt lgkmcnt(1)
v_mfma_f32_16x16x32_bf16 v[144:147], a[228:231], a[32:35], v[144:147]
ds_read_b128 a[236:239], v14 offset:22528
v_mfma_f32_16x16x32_bf16 v[148:151], a[228:231], a[36:39], v[148:151]
v_mfma_f32_16x16x32_bf16 v[152:155], a[228:231], a[40:43], v[152:155]
s_add_u32 m0, s33, 122880
v_mfma_f32_16x16x32_bf16 v[156:159], a[228:231], a[44:47], v[156:159]
s_waitcnt lgkmcnt(1)
v_mfma_f32_16x16x32_bf16 v[160:163], a[232:235], a[32:35], v[160:163]
ds_read_b128 a[240:243], v14 offset:24576
buffer_load_dwordx4 v10, s[20:23], s43 offen lds
v_mfma_f32_16x16x32_bf16 v[164:167], a[232:235], a[36:39], v[164:167]
buffer_load_dwordx4 v[104:107], v30, s[16:19], 0 offen
v_mfma_f32_16x16x32_bf16 v[168:171], a[232:235], a[40:43], v[168:171]
v_mfma_f32_16x16x32_bf16 v[172:175], a[232:235], a[44:47], v[172:175]
s_waitcnt lgkmcnt(1)
v_mfma_f32_16x16x32_bf16 v[176:179], a[236:239], a[32:35], v[176:179]
ds_read_b128 a[244:247], v14 offset:26624
v_mfma_f32_16x16x32_bf16 v[180:183], a[236:239], a[36:39], v[180:183]
v_mfma_f32_16x16x32_bf16 v[184:187], a[236:239], a[40:43], v[184:187]
v_mfma_f32_16x16x32_bf16 v[188:191], a[236:239], a[44:47], v[188:191]
s_waitcnt lgkmcnt(1)
v_mfma_f32_16x16x32_bf16 v[192:195], a[240:243], a[32:35], v[192:195]
buffer_load_dwordx4 v[108:111], v30, s[16:19], s92 offen
v_mfma_f32_16x16x32_bf16 v[196:199], a[240:243], a[36:39], v[196:199]
v_mfma_f32_16x16x32_bf16 v[200:203], a[240:243], a[40:43], v[200:203]
s_add_u32 m0, s33, 126976
v_mfma_f32_16x16x32_bf16 v[204:207], a[240:243], a[44:47], v[204:207]
s_waitcnt lgkmcnt(0)
v_mfma_f32_16x16x32_bf16 v[208:211], a[244:247], a[32:35], v[208:211]
ds_read_b128 a[248:251], v14 offset:28672
buffer_load_dwordx4 v11, s[20:23], s43 offen lds
v_mfma_f32_16x16x32_bf16 v[212:215], a[244:247], a[36:39], v[212:215]
v_mfma_f32_16x16x32_bf16 v[216:219], a[244:247], a[40:43], v[216:219]
buffer_load_dwordx4 v[112:115], v30, s[16:19], s93 offen
v_mfma_f32_16x16x32_bf16 v[220:223], a[244:247], a[44:47], v[220:223]
buffer_load_dwordx4 v[96:99], v12, s[24:27], 0 offen offset:2048 sc1
ds_read_b128 a[252:255], v14 offset:30720
buffer_load_dwordx4 v[100:103], v12, s[24:27], 0 offen offset:3072 sc1
s_waitcnt vmcnt(15)
v_lshl_add_u32 v12, s43, 5, v13
v_cmp_ne_u64 s[50:51], s[88:89], v[42:43]
v_cmp_ne_u64 s[44:45], s[88:89], v[46:47]
s_or_b64 s[50:51], s[44:45], s[50:51]
s_cbranch_scc1 L_SLOW3
L_BACK3:
v_perm_b32 v64, v40, v19, s52
v_perm_b32 v65, v40, v19, s53
v_perm_b32 v66, v44, v19, s52
v_perm_b32 v67, v44, v19, s53
v_perm_b32 v68, v40, v19, s54
v_perm_b32 v69, v40, v19, s55
v_perm_b32 v70, v44, v19, s54
v_perm_b32 v71, v44, v19, s55
ds_read_b32 a48, v64
ds_read_b32 a49, v65
ds_read_b32 a50, v66
ds_read_b32 a51, v67
ds_read_b32 a52, v68
ds_read_b32 a53, v69
ds_read_b32 a54, v70
ds_read_b32 a55, v71
v_perm_b32 v72, v41, v19, s52
v_perm_b32 v73, v41, v19, s53
v_perm_b32 v74, v45, v19, s52
v_perm_b32 v75, v45, v19, s53
v_perm_b32 v76, v41, v19, s54
v_perm_b32 v77, v41, v19, s55
v_perm_b32 v78, v45, v19, s54
v_perm_b32 v79, v45, v19, s55
ds_read_b32 a56, v72
ds_read_b32 a57, v73
ds_read_b32 a58, v74
ds_read_b32 a59, v75
ds_read_b32 a60, v76
ds_read_b32 a61, v77
ds_read_b32 a62, v78
ds_read_b32 a63, v79
buffer_load_dwordx4 v[80:83], v12, s[24:27], 0 offen offset:0 sc1
s_waitcnt lgkmcnt(15)
buffer_load_dwordx4 v[84:87], v12, s[24:27], 0 offen offset:1024 sc1
v_mfma_f32_16x16x32_bf16 v[224:227], a[248:251], a[32:35], v[224:227]
ds_read_b128 a[224:227], v15 offset:16384
v_lshlrev_b32 v24, 16, v20
v_mfma_f32_16x16x32_bf16 v[228:231], a[248:251], a[36:39], v[228:231]
buffer_load_dwordx4 v[116:119], v30, s[16:19], s94 offen
v_mfma_f32_16x16x32_bf16 v[232:235], a[248:251], a[40:43], v[232:235]
v_and_b32 v25, 0xffff0000, v20
v_lshlrev_b32 v26, 16, v21
v_mfma_f32_16x16x32_bf16 v[236:239], a[248:251], a[44:47], v[236:239]
v_and_b32 v27, 0xffff0000, v21
v_mfma_f32_16x16x32_bf16 v[240:243], a[252:255], a[32:35], v[240:243]
ds_read_b128 a[228:231], v15 offset:18432
v_mfma_f32_16x16x32_bf16 v[244:247], a[252:255], a[36:39], v[244:247]
v_mfma_f32_16x16x32_bf16 v[248:251], a[252:255], a[40:43], v[248:251]
v_mfma_f32_16x16x32_bf16 v[252:255], a[252:255], a[44:47], v[252:255]
s_waitcnt vmcnt(14) lgkmcnt(1)
v_cmp_ne_u64 s[50:51], s[88:89], v[50:51]
v_cmp_ne_u64 s[44:45], s[88:89], v[54:55]
v_mfma_f32_16x16x32_bf16 v[128:131], a[224:227], a[48:51], v[128:131]
ds_read_b128 a[232:235], v15 offset:20480
v_mfma_f32_16x16x32_bf16 v[132:135], a[224:227], a[52:55], v[132:135]
s_or_b64 s[50:51], s[44:45], s[50:51]
v_mfma_f32_16x16x32_bf16 v[136:139], a[224:227], a[56:59], v[136:139]
s_cbranch_scc1 L_SLOW4
L_BACK4:
v_mfma_f32_16x16x32_bf16 v[140:143], a[224:227], a[60:63], v[140:143]
s_waitcnt lgkmcnt(1)
v_mfma_f32_16x16x32_bf16 v[144:147], a[228:231], a[48:51], v[144:147]
ds_read_b128 a[236:239], v15 offset:22528
v_mfma_f32_16x16x32_bf16 v[148:151], a[228:231], a[52:55], v[148:151]
v_perm_b32 v63, v48, v19, s52
v_mfma_f32_16x16x32_bf16 v[152:155], a[228:231], a[56:59], v[152:155]
s_add_u32 m0, s33, 130560
ds_read_b32 a64, v63
v_perm_b32 v62, v48, v19, s53
v_mfma_f32_16x16x32_bf16 v[156:159], a[228:231], a[60:63], v[156:159]
s_waitcnt lgkmcnt(2)
ds_read_b32 a65, v62
v_perm_b32 v61, v52, v19, s52
v_mfma_f32_16x16x32_bf16 v[160:163], a[232:235], a[48:51], v[160:163]
ds_read_b128 a[240:243], v15 offset:24576
buffer_load_dwordx4 v8, s[20:23], 0 offen offset:512 lds
v_mfma_f32_16x16x32_bf16 v[164:167], a[232:235], a[52:55], v[164:167]
ds_read_b32 a66, v61
v_perm_b32 v60, v52, v19, s53
v_mfma_f32_16x16x32_bf16 v[168:171], a[232:235], a[56:59], v[168:171]
ds_read_b32 a67, v60
v_perm_b32 v59, v48, v19, s54
v_mfma_f32_16x16x32_bf16 v[172:175], a[232:235], a[60:63], v[172:175]
s_waitcnt lgkmcnt(4)
ds_read_b32 a68, v59
v_mfma_f32_16x16x32_bf16 v[176:179], a[236:239], a[48:51], v[176:179]
s_waitcnt vmcnt(13)
s_barrier
ds_read_b128 a[244:247], v15 offset:26624
v_perm_b32 v58, v48, v19, s55
v_mfma_f32_16x16x32_bf16 v[180:183], a[236:239], a[52:55], v[180:183]
ds_read_b32 a69, v58
v_perm_b32 v57, v52, v19, s54
v_mfma_f32_16x16x32_bf16 v[184:187], a[236:239], a[56:59], v[184:187]
ds_read_b32 a70, v57
v_perm_b32 v56, v52, v19, s55
v_mfma_f32_16x16x32_bf16 v[188:191], a[236:239], a[60:63], v[188:191]
s_waitcnt lgkmcnt(4)
ds_read_b32 a71, v56
buffer_load_dwordx4 v[88:91], v12, s[24:27], 0 offen offset:2048 sc1
v_mfma_f32_16x16x32_bf16 v[192:195], a[240:243], a[48:51], v[192:195]
ds_read_b128 a[248:251], v15 offset:28672
v_perm_b32 v63, v49, v19, s52
v_mfma_f32_16x16x32_bf16 v[196:199], a[240:243], a[52:55], v[196:199]
ds_read_b32 a72, v63
v_perm_b32 v62, v49, v19, s53
v_mfma_f32_16x16x32_bf16 v[200:203], a[240:243], a[56:59], v[200:203]
ds_read_b32 a73, v62
v_perm_b32 v61, v53, v19, s52
v_mfma_f32_16x16x32_bf16 v[204:207], a[240:243], a[60:63], v[204:207]
s_waitcnt lgkmcnt(4)
ds_read_b32 a74, v61
buffer_load_dwordx4 v[92:95], v12, s[24:27], 0 offen offset:3072 sc1
v_mfma_f32_16x16x32_bf16 v[208:211], a[244:247], a[48:51], v[208:211]
ds_read_b128 a[252:255], v15 offset:30720
v_perm_b32 v60, v53, v19, s53
v_mfma_f32_16x16x32_bf16 v[212:215], a[244:247], a[52:55], v[212:215]
ds_read_b32 a75, v60
v_perm_b32 v59, v49, v19, s54
v_mfma_f32_16x16x32_bf16 v[216:219], a[244:247], a[56:59], v[216:219]
s_add_u32 m0, s33, 134656
ds_read_b32 a76, v59
v_perm_b32 v58, v49, v19, s55
v_mfma_f32_16x16x32_bf16 v[220:223], a[244:247], a[60:63], v[220:223]
s_waitcnt lgkmcnt(4)
ds_read_b32 a77, v58
v_perm_b32 v57, v53, v19, s54
v_mfma_f32_16x16x32_bf16 v[224:227], a[248:251], a[48:51], v[224:227]
ds_read_b128 a[224:227], v14 offset:32768
buffer_load_dwordx4 v9, s[20:23], 0 offen offset:512 lds
v_mfma_f32_16x16x32_bf16 v[228:231], a[248:251], a[52:55], v[228:231]
ds_read_b32 a78, v57
v_perm_b32 v56, v53, v19, s55
v_mfma_f32_16x16x32_bf16 v[232:235], a[248:251], a[56:59], v[232:235]
ds_read_b32 a79, v56
v_add_u32 v12, 16384, v13
v_mfma_f32_16x16x32_bf16 v[236:239], a[248:251], a[60:63], v[236:239]
s_waitcnt lgkmcnt(4)
v_mfma_f32_16x16x32_bf16 v[240:243], a[252:255], a[48:51], v[240:243]
ds_read_b128 a[228:231], v14 offset:34816
v_mfma_f32_16x16x32_bf16 v[244:247], a[252:255], a[52:55], v[244:247]
v_mfma_f32_16x16x32_bf16 v[248:251], a[252:255], a[56:59], v[248:251]
v_mfma_f32_16x16x32_bf16 v[252:255], a[252:255], a[60:63], v[252:255]
s_waitcnt lgkmcnt(1)
v_mfma_f32_16x16x32_bf16 v[128:131], a[224:227], a[64:67], v[128:131]
ds_read_b128 a[232:235], v14 offset:36864
v_mfma_f32_16x16x32_bf16 v[132:135], a[224:227], a[68:71], v[132:135]
v_mfma_f32_16x16x32_bf16 v[136:139], a[224:227], a[72:75], v[136:139]
s_add_u32 m0, s33, 138752
v_mfma_f32_16x16x32_bf16 v[140:143], a[224:227], a[76:79], v[140:143]
s_waitcnt lgkmcnt(1)
v_mfma_f32_16x16x32_bf16 v[144:147], a[228:231], a[64:67], v[144:147]
ds_read_b128 a[236:239], v14 offset:38912
buffer_load_dwordx4 v10, s[20:23], 0 offen offset:512 lds
v_mfma_f32_16x16x32_bf16 v[148:151], a[228:231], a[68:71], v[148:151]
v_mfma_f32_16x16x32_bf16 v[152:155], a[228:231], a[72:75], v[152:155]
v_mfma_f32_16x16x32_bf16 v[156:159], a[228:231], a[76:79], v[156:159]
s_waitcnt lgkmcnt(1)
v_mfma_f32_16x16x32_bf16 v[160:163], a[232:235], a[64:67], v[160:163]
ds_read_b128 a[240:243], v14 offset:40960
v_mfma_f32_16x16x32_bf16 v[164:167], a[232:235], a[68:71], v[164:167]
v_mfma_f32_16x16x32_bf16 v[168:171], a[232:235], a[72:75], v[168:171]
v_mfma_f32_16x16x32_bf16 v[172:175], a[232:235], a[76:79], v[172:175]
s_waitcnt lgkmcnt(1)
v_mfma_f32_16x16x32_bf16 v[176:179], a[236:239], a[64:67], v[176:179]
ds_read_b128 a[244:247], v14 offset:43008
v_mfma_f32_16x16x32_bf16 v[180:183], a[236:239], a[68:71], v[180:183]
v_mfma_f32_16x16x32_bf16 v[184:187], a[236:239], a[72:75], v[184:187]
s_add_u32 m0, s33, 142848
buffer_load_dwordx4 v[32:35], v12, s[24:27], 0 offen offset:0 sc1
v_mfma_f32_16x16x32_bf16 v[188:191], a[236:239], a[76:79], v[188:191]
s_waitcnt lgkmcnt(1)
buffer_load_dwordx4 v[36:39], v12, s[24:27], 0 offen offset:1024 sc1
v_mfma_f32_16x16x32_bf16 v[192:195], a[240:243], a[64:67], v[192:195]
buffer_load_dwordx4 v11, s[20:23], 0 offen offset:512 lds
v_mfma_f32_16x16x32_bf16 v[196:199], a[240:243], a[68:71], v[196:199]
v_mfma_f32_16x16x32_bf16 v[200:203], a[240:243], a[72:75], v[200:203]
v_mfma_f32_16x16x32_bf16 v[204:207], a[240:243], a[76:79], v[204:207]
s_waitcnt lgkmcnt(0)
v_mfma_f32_16x16x32_bf16 v[208:211], a[244:247], a[64:67], v[208:211]
ds_read_b128 a[248:251], v14 offset:45056
v_mfma_f32_16x16x32_bf16 v[212:215], a[244:247], a[68:71], v[212:215]
v_mfma_f32_16x16x32_bf16 v[216:219], a[244:247], a[72:75], v[216:219]
v_mfma_f32_16x16x32_bf16 v[220:223], a[244:247], a[76:79], v[220:223]
ds_read_b128 a[252:255], v14 offset:47104
s_waitcnt vmcnt(11)
v_cmp_ne_u64 s[50:51], s[88:89], v[98:99]
v_cmp_ne_u64 s[44:45], s[88:89], v[102:103]
s_or_b64 s[50:51], s[44:45], s[50:51]
s_cbranch_scc1 L_SLOW5
L_BACK5:
v_perm_b32 v64, v96, v19, s52
v_perm_b32 v65, v96, v19, s53
v_perm_b32 v66, v100, v19, s52
v_perm_b32 v67, v100, v19, s53
v_perm_b32 v68, v96, v19, s54
v_perm_b32 v69, v96, v19, s55
v_perm_b32 v70, v100, v19, s54
v_perm_b32 v71, v100, v19, s55
ds_read_b32 a80, v64
ds_read_b32 a81, v65
ds_read_b32 a82, v66
ds_read_b32 a83, v67
ds_read_b32 a84, v68
ds_read_b32 a85, v69
ds_read_b32 a86, v70
ds_read_b32 a87, v71
v_perm_b32 v72, v97, v19, s52
v_perm_b32 v73, v97, v19, s53
v_perm_b32 v74, v101, v19, s52
v_perm_b32 v75, v101, v19, s53
v_perm_b32 v76, v97, v19, s54
v_perm_b32 v77, v97, v19, s55
v_perm_b32 v78, v101, v19, s54
v_perm_b32 v79, v101, v19, s55
ds_read_b32 a88, v72
ds_read_b32 a89, v73
ds_read_b32 a90, v74
ds_read_b32 a91, v75
ds_read_b32 a92, v76
ds_read_b32 a93, v77
ds_read_b32 a94, v78
ds_read_b32 a95, v79
s_waitcnt lgkmcnt(15)
v_mfma_f32_16x16x32_bf16 v[224:227], a[248:251], a[64:67], v[224:227]
ds_read_b128 a[224:227], v15 offset:32768
v_mfma_f32_16x16x32_bf16 v[228:231], a[248:251], a[68:71], v[228:231]
v_mfma_f32_16x16x32_bf16 v[232:235], a[248:251], a[72:75], v[232:235]
v_mfma_f32_16x16x32_bf16 v[236:239], a[248:251], a[76:79], v[236:239]
s_waitcnt vmcnt(9)
v_cmp_ne_u64 s[50:51], s[88:89], v[82:83]
v_cmp_ne_u64 s[44:45], s[88:89], v[86:87]
v_mfma_f32_16x16x32_bf16 v[240:243], a[252:255], a[64:67], v[240:243]
L_PAD1:
s_cbranch_vccnz L_PADRET
ds_read_b128 a[228:231], v15 offset:34816
v_mfma_f32_16x16x32_bf16 v[244:247], a[252:255], a[68:71], v[244:247]
s_or_b64 s[50:51], s[44:45], s[50:51]
v_mfma_f32_16x16x32_bf16 v[248:251], a[252:255], a[72:75], v[248:251]
s_cbranch_scc1 L_SLOW6
L_BACK6:
v_mfma_f32_16x16x32_bf16 v[252:255], a[252:255], a[76:79], v[252:255]
s_waitcnt lgkmcnt(1)
v_mfma_f32_16x16x32_bf16 v[128:131], a[224:227], a[80:83], v[128:131]
ds_read_b128 a[232:235], v15 offset:36864
v_perm_b32 v63, v80, v19, s52
v_mfma_f32_16x16x32_bf16 v[132:135], a[224:227], a[84:87], v[132:135]
ds_read_b32 a96, v63
v_perm_b32 v62, v80, v19, s53
v_mfma_f32_16x16x32_bf16 v[136:139], a[224:227], a[88:91], v[136:139]
s_add_u32 m0, s33, 146816
ds_read_b32 a97, v62
v_perm_b32 v61, v84, v19, s52
v_mfma_f32_16x16x32_bf16 v[140:143], a[224:227], a[92:95], v[140:143]
s_waitcnt lgkmcnt(3)
ds_read_b32 a98, v61
v_mfma_f32_16x16x32_bf16 v[144:147], a[228:231], a[80:83], v[144:147]
ds_read_b128 a[236:239], v15 offset:38912
buffer_load_dwordx4 v8, s[20:23], 0 offen offset:640 lds
v_mfma_f32_16x16x32_bf16 v[148:151], a[228:231], a[84:87], v[148:151]
s_waitcnt vmcnt(9)
v_perm_b32 v60, v84, v19, s53
v_lshl_add_u64 v[104:105], v[108:109], 4, v[104:105]
v_mfma_f32_16x16x32_bf16 v[152:155], a[228:231], a[88:91], v[152:155]
ds_read_b32 a99, v60
v_perm_b32 v59, v80, v19, s54
v_mfma_f32_16x16x32_bf16 v[156:159], a[228:231], a[92:95], v[156:159]
s_waitcnt lgkmcnt(3)
ds_read_b32 a100, v59
v_perm_b32 v58, v80, v19, s55
v_mfma_f32_16x16x32_bf16 v[160:163], a[232:235], a[80:83], v[160:163]
s_barrier
ds_read_b128 a[240:243], v15 offset:40960
v_lshl_add_u64 v[106:107], v[110:111], 4, v[106:107]
v_mfma_f32_16x16x32_bf16 v[164:167], a[232:235], a[84:87], v[164:167]
ds_read_b32 a101, v58
v_perm_b32 v57, v84, v19, s54
v_mfma_f32_16x16x32_bf16 v[168:171], a[232:235], a[88:91], v[168:171]
ds_read_b32 a102, v57
v_perm_b32 v56, v84, v19, s55
v_mfma_f32_16x16x32_bf16 v[172:175], a[232:235], a[92:95], v[172:175]
s_waitcnt lgkmcnt(4)
ds_read_b32 a103, v56
v_lshl_add_u64 v[112:113], v[116:117], 4, v[112:113]
v_mfma_f32_16x16x32_bf16 v[176:179], a[236:239], a[80:83], v[176:179]
ds_read_b128 a[244:247], v15 offset:43008
v_perm_b32 v63, v81, v19, s52
v_mfma_f32_16x16x32_bf16 v[180:183], a[236:239], a[84:87], v[180:183]
ds_read_b32 a104, v63
buffer_load_dwordx4 v[40:43], v12, s[24:27], 0 offen offset:2048 sc1
v_mfma_f32_16x16x32_bf16 v[184:187], a[236:239], a[88:91], v[184:187]
v_perm_b32 v62, v81, v19, s53
v_lshl_add_u64 v[114:115], v[118:119], 4, v[114:115]
v_mfma_f32_16x16x32_bf16 v[188:191], a[236:239], a[92:95], v[188:191]
s_waitcnt lgkmcnt(3)
ds_read_b32 a105, v62
buffer_load_dwordx4 v[44:47], v12, s[24:27], 0 offen offset:3072 sc1
v_mfma_f32_16x16x32_bf16 v[192:195], a[240:243], a[80:83], v[192:195]
ds_read_b128 a[248:251], v15 offset:45056
v_add_u32 v12, 20480, v13
v_mfma_f32_16x16x32_bf16 v[196:199], a[240:243], a[84:87], v[196:199]
v_perm_b32 v61, v85, v19, s52
v_lshl_or_b32 v116, v112, 8, v104
v_mfma_f32_16x16x32_bf16 v[200:203], a[240:243], a[88:91], v[200:203]
s_add_u32 m0, s33, 150912
ds_read_b32 a106, v61
v_perm_b32 v60, v85, v19, s53
v_mfma_f32_16x16x32_bf16 v[204:207], a[240:243], a[92:95], v[204:207]
s_waitcnt lgkmcnt(3)
ds_read_b32 a107, v60
v_mfma_f32_16x16x32_bf16 v[208:211], a[244:247], a[80:83], v[208:211]
ds_read_b128 a[252:255], v15 offset:47104
buffer_load_dwordx4 v9, s[20:23], 0 offen offset:640 lds
v_mfma_f32_16x16x32_bf16 v[212:215], a[244:247], a[84:87], v[212:215]
v_perm_b32 v59, v81, v19, s54
v_lshl_or_b32 v117, v113, 8, v105
v_mfma_f32_16x16x32_bf16 v[216:219], a[244:247], a[88:91], v[216:219]
ds_read_b32 a108, v59
v_perm_b32 v58, v81, v19, s55
v_mfma_f32_16x16x32_bf16 v[220:223], a[244:247], a[92:95], v[220:223]
s_waitcnt lgkmcnt(3)
ds_read_b32 a109, v58
v_perm_b32 v57, v85, v19, s54
v_mfma_f32_16x16x32_bf16 v[224:227], a[248:251], a[80:83], v[224:227]
ds_read_b128 a[224:227], v14 offset:49152
v_lshl_or_b32 v118, v114, 8, v106
v_mfma_f32_16x16x32_bf16 v[228:231], a[248:251], a[84:87], v[228:231]
ds_read_b32 a110, v57
v_perm_b32 v56, v85, v19, s55
v_mfma_f32_16x16x32_bf16 v[232:235], a[248:251], a[88:91], v[232:235]
ds_read_b32 a111, v56
v_mfma_f32_16x16x32_bf16 v[236:239], a[248:251], a[92:95], v[236:239]
s_waitcnt lgkmcnt(4)
v_lshl_or_b32 v119, v115, 8, v107
v_mfma_f32_16x16x32_bf16 v[240:243], a[252:255], a[80:83], v[240:243]
ds_read_b128 a[228:231], v14 offset:51200
v_mfma_f32_16x16x32_bf16 v[244:247], a[252:255], a[84:87], v[244:247]
v_mfma_f32_16x16x32_bf16 v[248:251], a[252:255], a[88:91], v[248:251]
s_add_u32 m0, s33, 155008
v_lshl_or_b32 v108, v117, 16, v116
v_mfma_f32_16x16x32_bf16 v[252:255], a[252:255], a[92:95], v[252:255]
s_waitcnt vmcnt(9) lgkmcnt(1)
v_cmp_ne_u64 s[50:51], s[88:89], v[90:91]
v_cmp_ne_u64 s[44:45], s[88:89], v[94:95]
v_mfma_f32_16x16x32_bf16 v[128:131], a[224:227], a[96:99], v[128:131]
ds_read_b128 a[232:235], v14 offset:53248
buffer_load_dwordx4 v10, s[20:23], 0 offen offset:640 lds
v_mfma_f32_16x16x32_bf16 v[132:135], a[224:227], a[100:103], v[132:135]
s_or_b64 s[50:51], s[44:45], s[50:51]
v_lshl_or_b32 v109, v119, 16, v118
v_mfma_f32_16x16x32_bf16 v[136:139], a[224:227], a[104:107], v[136:139]
s_cbranch_scc1 L_SLOW7
L_BACK7:
v_mfma_f32_16x16x32_bf16 v[140:143], a[224:227], a[108:111], v[140:143]
s_waitcnt lgkmcnt(1)
v_perm_b32 v63, v88, v19, s52
v_mfma_f32_16x16x32_bf16 v[144:147], a[228:231], a[96:99], v[144:147]
ds_read_b128 a[236:239], v14 offset:55296
v_mov_b64 v[110:111], s[88:89]
v_mfma_f32_16x16x32_bf16 v[148:151], a[228:231], a[100:103], v[148:151]
ds_read_b32 a112, v63
v_perm_b32 v62, v88, v19, s53
v_mfma_f32_16x16x32_bf16 v[152:155], a[228:231], a[104:107], v[152:155]
ds_read_b32 a113, v62
v_perm_b32 v61, v92, v19, s52
v_mfma_f32_16x16x32_bf16 v[156:159], a[228:231], a[108:111], v[156:159]
s_waitcnt lgkmcnt(3)
ds_read_b32 a114, v61
v_mfma_f32_16x16x32_bf16 v[160:163], a[232:235], a[96:99], v[160:163]
ds_read_b128 a[240:243], v14 offset:57344
v_perm_b32 v60, v92, v19, s53
v_mfma_f32_16x16x32_bf16 v[164:167], a[232:235], a[100:103], v[164:167]
buffer_store_dwordx4 v[108:111], v13, s[76:79], 0 offen sc1
v_mfma_f32_16x16x32_bf16 v[168:171], a[232:235], a[104:107], v[168:171]
s_add_u32 m0, s33, 159104
ds_read_b32 a115, v60
v_perm_b32 v59, v88, v19, s54
v_mfma_f32_16x16x32_bf16 v[172:175], a[232:235], a[108:111], v[172:175]
s_waitcnt lgkmcnt(3)
ds_read_b32 a116, v59
v_perm_b32 v58, v88, v19, s55
v_mfma_f32_16x16x32_bf16 v[176:179], a[236:239], a[96:99], v[176:179]
ds_read_b128 a[244:247], v14 offset:59392
buffer_load_dwordx4 v11, s[20:23], 0 offen offset:640 lds
v_mfma_f32_16x16x32_bf16 v[180:183], a[236:239], a[100:103], v[180:183]
ds_read_b32 a117, v58
v_perm_b32 v57, v92, v19, s54
v_mfma_f32_16x16x32_bf16 v[184:187], a[236:239], a[104:107], v[184:187]
ds_read_b32 a118, v57
v_perm_b32 v56, v92, v19, s55
v_mfma_f32_16x16x32_bf16 v[188:191], a[236:239], a[108:111], v[188:191]
s_waitcnt lgkmcnt(4)
ds_read_b32 a119, v56
buffer_load_dwordx4 v[48:51], v12, s[24:27], 0 offen offset:0 sc1
v_mfma_f32_16x16x32_bf16 v[192:195], a[240:243], a[96:99], v[192:195]
ds_read_b128 a[248:251], v14 offset:61440
v_perm_b32 v63, v89, v19, s52
v_mfma_f32_16x16x32_bf16 v[196:199], a[240:243], a[100:103], v[196:199]
ds_read_b32 a120, v63
v_perm_b32 v62, v89, v19, s53
v_mfma_f32_16x16x32_bf16 v[200:203], a[240:243], a[104:107], v[200:203]
ds_read_b32 a121, v62
v_perm_b32 v61, v93, v19, s52
v_mfma_f32_16x16x32_bf16 v[204:207], a[240:243], a[108:111], v[204:207]
s_waitcnt lgkmcnt(4)
ds_read_b32 a122, v61
buffer_load_dwordx4 v[52:55], v12, s[24:27], 0 offen offset:1024 sc1
v_mfma_f32_16x16x32_bf16 v[208:211], a[244:247], a[96:99], v[208:211]
ds_read_b128 a[252:255], v14 offset:63488
v_perm_b32 v60, v93, v19, s53
v_mfma_f32_16x16x32_bf16 v[212:215], a[244:247], a[100:103], v[212:215]
ds_read_b32 a123, v60
v_perm_b32 v59, v89, v19, s54
v_mfma_f32_16x16x32_bf16 v[216:219], a[244:247], a[104:107], v[216:219]
ds_read_b32 a124, v59
v_perm_b32 v58, v89, v19, s55
v_mfma_f32_16x16x32_bf16 v[220:223], a[244:247], a[108:111], v[220:223]
s_waitcnt lgkmcnt(4)
ds_read_b32 a125, v58
v_mfma_f32_16x16x32_bf16 v[224:227], a[248:251], a[96:99], v[224:227]
ds_read_b128 a[224:227], v15 offset:49152
v_perm_b32 v57, v93, v19, s54
v_mfma_f32_16x16x32_bf16 v[228:231], a[248:251], a[100:103], v[228:231]
ds_read_b32 a126, v57
v_perm_b32 v56, v93, v19, s55
v_mfma_f32_16x16x32_bf16 v[232:235], a[248:251], a[104:107], v[232:235]
ds_read_b32 a127, v56
v_mfma_f32_16x16x32_bf16 v[236:239], a[248:251], a[108:111], v[236:239]
s_waitcnt lgkmcnt(4)
v_mfma_f32_16x16x32_bf16 v[240:243], a[252:255], a[96:99], v[240:243]
ds_read_b128 a[228:231], v15 offset:51200
v_mfma_f32_16x16x32_bf16 v[244:247], a[252:255], a[100:103], v[244:247]
v_mfma_f32_16x16x32_bf16 v[248:251], a[252:255], a[104:107], v[248:251]
s_waitcnt vmcnt(10)
v_cmp_ne_u64 s[50:51], s[88:89], v[34:35]
v_cmp_ne_u64 s[44:45], s[88:89], v[38:39]
v_mfma_f32_16x16x32_bf16 v[252:255], a[252:255], a[108:111], v[252:255]
s_waitcnt lgkmcnt(1)
v_mfma_f32_16x16x32_bf16 v[128:131], a[224:227], a[112:115], v[128:131]
s_or_b64 s[50:51], s[44:45], s[50:51]
ds_read_b128 a[232:235], v15 offset:53248
v_mfma_f32_16x16x32_bf16 v[132:135], a[224:227], a[116:119], v[132:135]
s_cbranch_scc1 L_SLOW8
L_BACK8:
v_mfma_f32_16x16x32_bf16 v[136:139], a[224:227], a[120:123], v[136:139]
s_add_u32 m0, s33, 64768
v_mfma_f32_16x16x32_bf16 v[140:143], a[224:227], a[124:127], v[140:143]
s_waitcnt lgkmcnt(1)
v_mfma_f32_16x16x32_bf16 v[144:147], a[228:231], a[112:115], v[144:147]
ds_read_b128 a[236:239], v15 offset:55296
buffer_load_dwordx4 v8, s[20:23], 0 offen offset:768 lds
v_mfma_f32_16x16x32_bf16 v[148:151], a[228:231], a[116:119], v[148:151]
v_perm_b32 v63, v32, v19, s52
v_mfma_f32_16x16x32_bf16 v[152:155], a[228:231], a[120:123], v[152:155]
ds_read_b32 a128, v63
v_perm_b32 v62, v32, v19, s53
v_mfma_f32_16x16x32_bf16 v[156:159], a[228:231], a[124:127], v[156:159]
s_waitcnt lgkmcnt(2)
ds_read_b32 a129, v62
v_mfma_f32_16x16x32_bf16 v[160:163], a[232:235], a[112:115], v[160:163]
s_waitcnt vmcnt(10)
s_barrier
ds_read_b128 a[240:243], v15 offset:57344
v_perm_b32 v61, v36, v19, s52
v_mfma_f32_16x16x32_bf16 v[164:167], a[232:235], a[116:119], v[164:167]
ds_read_b32 a130, v61
v_perm_b32 v60, v36, v19, s53
v_mfma_f32_16x16x32_bf16 v[168:171], a[232:235], a[120:123], v[168:171]
ds_read_b32 a131, v60
v_perm_b32 v59, v32, v19, s54
v_mfma_f32_16x16x32_bf16 v[172:175], a[232:235], a[124:127], v[172:175]
s_waitcnt lgkmcnt(4)
ds_read_b32 a132, v59
buffer_load_dwordx4 v[96:99], v12, s[24:27], 0 offen offset:2048 sc1
v_mfma_f32_16x16x32_bf16 v[176:179], a[236:239], a[112:115], v[176:179]
ds_read_b128 a[244:247], v15 offset:59392
v_perm_b32 v58, v32, v19, s55
v_mfma_f32_16x16x32_bf16 v[180:183], a[236:239], a[116:119], v[180:183]
ds_read_b32 a133, v58
v_perm_b32 v57, v36, v19, s54
v_mfma_f32_16x16x32_bf16 v[184:187], a[236:239], a[120:123], v[184:187]
ds_read_b32 a134, v57
v_perm_b32 v56, v36, v19, s55
v_mfma_f32_16x16x32_bf16 v[188:191], a[236:239], a[124:127], v[188:191]
s_waitcnt lgkmcnt(4)
ds_read_b32 a135, v56
buffer_load_dwordx4 v[100:103], v12, s[24:27], 0 offen offset:3072 sc1
v_mfma_f32_16x16x32_bf16 v[192:195], a[240:243], a[112:115], v[192:195]
ds_read_b128 a[248:251], v15 offset:61440
v_perm_b32 v63, v33, v19, s52
v_mfma_f32_16x16x32_bf16 v[196:199], a[240:243], a[116:119], v[196:199]
ds_read_b32 a136, v63
v_perm_b32 v62, v33, v19, s53
v_mfma_f32_16x16x32_bf16 v[200:203], a[240:243], a[120:123], v[200:203]
s_add_u32 m0, s33, 68864
ds_read_b32 a137, v62
v_perm_b32 v61, v37, v19, s52
v_mfma_f32_16x16x32_bf16 v[204:207], a[240:243], a[124:127], v[204:207]
s_waitcnt lgkmcnt(4)
ds_read_b32 a138, v61
v_perm_b32 v60, v37, v19, s53
v_mfma_f32_16x16x32_bf16 v[208:211], a[244:247], a[112:115], v[208:211]
ds_read_b128 a[252:255], v15 offset:63488
buffer_load_dwordx4 v9, s[20:23], 0 offen offset:768 lds
v_mfma_f32_16x16x32_bf16 v[212:215], a[244:247], a[116:119], v[212:215]
ds_read_b32 a139, v60
v_perm_b32 v59, v33, v19, s54
v_mfma_f32_16x16x32_bf16 v[216:219], a[244:247], a[120:123], v[216:219]
ds_read_b32 a140, v59
v_perm_b32 v58, v33, v19, s55
v_mfma_f32_16x16x32_bf16 v[220:223], a[244:247], a[124:127], v[220:223]
s_waitcnt lgkmcnt(4)
ds_read_b32 a141, v58
v_add_u32 v12, 24576, v13
v_mfma_f32_16x16x32_bf16 v[224:227], a[248:251], a[112:115], v[224:227]
ds_read_b128 a[224:227], v16 offset:0
v_perm_b32 v57, v37, v19, s54
v_mfma_f32_16x16x32_bf16 v[228:231], a[248:251], a[116:119], v[228:231]
ds_read_b32 a142, v57
v_perm_b32 v56, v37, v19, s55
v_mfma_f32_16x16x32_bf16 v[232:235], a[248:251], a[120:123], v[232:235]
ds_read_b32 a143, v56
v_mfma_f32_16x16x32_bf16 v[236:239], a[248:251], a[124:127], v[236:239]
s_waitcnt lgkmcnt(4)
v_mfma_f32_16x16x32_bf16 v[240:243], a[252:255], a[112:115], v[240:243]
ds_read_b128 a[228:231], v16 offset:2048
v_mfma_f32_16x16x32_bf16 v[244:247], a[252:255], a[116:119], v[244:247]
v_mfma_f32_16x16x32_bf16 v[248:251], a[252:255], a[120:123], v[248:251]
s_add_u32 m0, s33, 72960
v_mfma_f32_16x16x32_bf16 v[252:255], a[252:255], a[124:127], v[252:255]
s_waitcnt vmcnt(10) lgkmcnt(1)
v_cmp_ne_u64 s[50:51], s[88:89], v[42:43]
v_cmp_ne_u64 s[44:45], s[88:89], v[46:47]
v_mfma_f32_16x16x32_bf16 v[128:131], a[224:227], a[128:131], v[128:131]
ds_read_b128 a[232:235], v16 offset:4096
buffer_load_dwordx4 v10, s[20:23], 0 offen offset:768 lds
v_mfma_f32_16x16x32_bf16 v[132:135], a[224:227], a[132:135], v[132:135]
s_or_b64 s[50:51], s[44:45], s[50:51]
v_mfma_f32_16x16x32_bf16 v[136:139], a[224:227], a[136:139], v[136:139]
s_cbranch_scc1 L_SLOW9
L_BACK9:
v_mfma_f32_16x16x32_bf16 v[140:143], a[224:227], a[140:143], v[140:143]
s_waitcnt lgkmcnt(1)
v_mfma_f32_16x16x32_bf16 v[144:147], a[228:231], a[128:131], v[144:147]
ds_read_b128 a[236:239], v16 offset:6144
v_mfma_f32_16x16x32_bf16 v[148:151], a[228:231], a[132:135], v[148:151]
v_perm_b32 v63, v40, v19, s52
v_mfma_f32_16x16x32_bf16 v[152:155], a[228:231], a[136:139], v[152:155]
ds_read_b32 a144, v63
v_perm_b32 v62, v40, v19, s53
v_mfma_f32_16x16x32_bf16 v[156:159], a[228:231], a[140:143], v[156:159]
s_waitcnt lgkmcnt(2)
ds_read_b32 a145, v62
v_mfma_f32_16x16x32_bf16 v[160:163], a[232:235], a[128:131], v[160:163]
ds_read_b128 a[240:243], v16 offset:8192
v_perm_b32 v61, v44, v19, s52
v_mfma_f32_16x16x32_bf16 v[164:167], a[232:235], a[132:135], v[164:167]
ds_read_b32 a146, v61
v_perm_b32 v60, v44, v19, s53
v_mfma_f32_16x16x32_bf16 v[168:171], a[232:235], a[136:139], v[168:171]
s_add_u32 m0, s33, 77056
ds_read_b32 a147, v60
v_perm_b32 v59, v40, v19, s54
v_mfma_f32_16x16x32_bf16 v[172:175], a[232:235], a[140:143], v[172:175]
s_waitcnt lgkmcnt(4)
ds_read_b32 a148, v59
v_perm_b32 v58, v40, v19, s55
v_mfma_f32_16x16x32_bf16 v[176:179], a[236:239], a[128:131], v[176:179]
ds_read_b128 a[244:247], v16 offset:10240
buffer_load_dwordx4 v11, s[20:23], 0 offen offset:768 lds
v_mfma_f32_16x16x32_bf16 v[180:183], a[236:239], a[132:135], v[180:183]
ds_read_b32 a149, v58
v_perm_b32 v57, v44, v19, s54
v_mfma_f32_16x16x32_bf16 v[184:187], a[236:239], a[136:139], v[184:187]
ds_read_b32 a150, v57
v_perm_b32 v56, v44, v19, s55
v_mfma_f32_16x16x32_bf16 v[188:191], a[236:239], a[140:143], v[188:191]
s_waitcnt lgkmcnt(4)
ds_read_b32 a151, v56
buffer_load_dwordx4 v[80:83], v12, s[24:27], 0 offen offset:0 sc1
v_mfma_f32_16x16x32_bf16 v[192:195], a[240:243], a[128:131], v[192:195]
ds_read_b128 a[248:251], v16 offset:12288
v_perm_b32 v63, v41, v19, s52
v_mfma_f32_16x16x32_bf16 v[196:199], a[240:243], a[132:135], v[196:199]
ds_read_b32 a152, v63
v_perm_b32 v62, v41, v19, s53
v_mfma_f32_16x16x32_bf16 v[200:203], a[240:243], a[136:139], v[200:203]
ds_read_b32 a153, v62
v_perm_b32 v61, v45, v19, s52
v_mfma_f32_16x16x32_bf16 v[204:207], a[240:243], a[140:143], v[204:207]
s_waitcnt lgkmcnt(4)
ds_read_b32 a154, v61
buffer_load_dwordx4 v[84:87], v12, s[24:27], 0 offen offset:1024 sc1
v_mfma_f32_16x16x32_bf16 v[208:211], a[244:247], a[128:131], v[208:211]
ds_read_b128 a[252:255], v16 offset:14336
v_perm_b32 v60, v45, v19, s53
v_mfma_f32_16x16x32_bf16 v[212:215], a[244:247], a[132:135], v[212:215]
ds_read_b32 a155, v60
v_perm_b32 v59, v41, v19, s54
v_mfma_f32_16x16x32_bf16 v[216:219], a[244:247], a[136:139], v[216:219]
ds_read_b32 a156, v59
v_perm_b32 v58, v41, v19, s55
v_mfma_f32_16x16x32_bf16 v[220:223], a[244:247], a[140:143], v[220:223]
s_waitcnt lgkmcnt(4)
ds_read_b32 a157, v58
v_mfma_f32_16x16x32_bf16 v[224:227], a[248:251], a[128:131], v[224:227]
ds_read_b128 a[224:227], v17 offset:0
v_perm_b32 v57, v45, v19, s54
v_mfma_f32_16x16x32_bf16 v[228:231], a[248:251], a[132:135], v[228:231]
ds_read_b32 a158, v57
v_perm_b32 v56, v45, v19, s55
v_mfma_f32_16x16x32_bf16 v[232:235], a[248:251], a[136:139], v[232:235]
ds_read_b32 a159, v56
v_mfma_f32_16x16x32_bf16 v[236:239], a[248:251], a[140:143], v[236:239]
s_waitcnt lgkmcnt(4)
v_mfma_f32_16x16x32_bf16 v[240:243], a[252:255], a[128:131], v[240:243]
ds_read_b128 a[228:231], v17 offset:2048
v_mfma_f32_16x16x32_bf16 v[244:247], a[252:255], a[132:135], v[244:247]
v_mfma_f32_16x16x32_bf16 v[248:251], a[252:255], a[136:139], v[248:251]
s_waitcnt vmcnt(8)
v_cmp_ne_u64 s[50:51], s[88:89], v[50:51]
v_cmp_ne_u64 s[44:45], s[88:89], v[54:55]
v_mfma_f32_16x16x32_bf16 v[252:255], a[252:255], a[140:143], v[252:255]
s_waitcnt lgkmcnt(1)
v_mfma_f32_16x16x32_bf16 v[128:131], a[224:227], a[144:147], v[128:131]
s_or_b64 s[50:51], s[44:45], s[50:51]
ds_read_b128 a[232:235], v17 offset:4096
v_mfma_f32_16x16x32_bf16 v[132:135], a[224:227], a[148:151], v[132:135]
s_cbranch_scc1 L_SLOW10
L_BACK10:
v_mfma_f32_16x16x32_bf16 v[136:139], a[224:227], a[152:155], v[136:139]
s_add_u32 m0, s33, 81024
v_mfma_f32_16x16x32_bf16 v[140:143], a[224:227], a[156:159], v[140:143]
s_waitcnt lgkmcnt(1)
v_mfma_f32_16x16x32_bf16 v[144:147], a[228:231], a[144:147], v[144:147]
ds_read_b128 a[236:239], v17 offset:6144
buffer_load_dwordx4 v8, s[20:23], 0 offen offset:896 lds
v_mfma_f32_16x16x32_bf16 v[148:151], a[228:231], a[148:151], v[148:151]
v_perm_b32 v63, v48, v19, s52
v_mfma_f32_16x16x32_bf16 v[152:155], a[228:231], a[152:155], v[152:155]
ds_read_b32 a160, v63
v_perm_b32 v62, v48, v19, s53
v_mfma_f32_16x16x32_bf16 v[156:159], a[228:231], a[156:159], v[156:159]
s_waitcnt lgkmcnt(2)
ds_read_b32 a161, v62
v_mfma_f32_16x16x32_bf16 v[160:163], a[232:235], a[144:147], v[160:163]
s_barrier
ds_read_b128 a[240:243], v17 offset:8192
v_perm_b32 v61, v52, v19, s52
v_mfma_f32_16x16x32_bf16 v[164:167], a[232:235], a[148:151], v[164:167]
ds_read_b32 a162, v61
v_perm_b32 v60, v52, v19, s53
v_mfma_f32_16x16x32_bf16 v[168:171], a[232:235], a[152:155], v[168:171]
ds_read_b32 a163, v60
v_perm_b32 v59, v48, v19, s54
v_mfma_f32_16x16x32_bf16 v[172:175], a[232:235], a[156:159], v[172:175]
s_waitcnt lgkmcnt(4)
ds_read_b32 a164, v59
buffer_load_dwordx4 v[88:91], v12, s[24:27], 0 offen offset:2048 sc1
v_mfma_f32_16x16x32_bf16 v[176:179], a[236:239], a[144:147], v[176:179]
ds_read_b128 a[244:247], v17 offset:10240
v_perm_b32 v58, v48, v19, s55
v_mfma_f32_16x16x32_bf16 v[180:183], a[236:239], a[148:151], v[180:183]
ds_read_b32 a165, v58
v_perm_b32 v57, v52, v19, s54
v_mfma_f32_16x16x32_bf16 v[184:187], a[236:239], a[152:155], v[184:187]
ds_read_b32 a166, v57
v_perm_b32 v56, v52, v19, s55
v_mfma_f32_16x16x32_bf16 v[188:191], a[236:239], a[156:159], v[188:191]
s_waitcnt lgkmcnt(4)
ds_read_b32 a167, v56
buffer_load_dwordx4 v[92:95], v12, s[24:27], 0 offen offset:3072 sc1
v_mfma_f32_16x16x32_bf16 v[192:195], a[240:243], a[144:147], v[192:195]
ds_read_b128 a[248:251], v17 offset:12288
v_perm_b32 v63, v49, v19, s52
v_mfma_f32_16x16x32_bf16 v[196:199], a[240:243], a[148:151], v[196:199]
ds_read_b32 a168, v63
v_perm_b32 v62, v49, v19, s53
v_mfma_f32_16x16x32_bf16 v[200:203], a[240:243], a[152:155], v[200:203]
s_add_u32 m0, s33, 85120
ds_read_b32 a169, v62
v_perm_b32 v61, v53, v19, s52
v_mfma_f32_16x16x32_bf16 v[204:207], a[240:243], a[156:159], v[204:207]
s_waitcnt lgkmcnt(4)
ds_read_b32 a170, v61
v_perm_b32 v60, v53, v19, s53
v_mfma_f32_16x16x32_bf16 v[208:211], a[244:247], a[144:147], v[208:211]
ds_read_b128 a[252:255], v17 offset:14336
buffer_load_dwordx4 v9, s[20:23], 0 offen offset:896 lds
v_mfma_f32_16x16x32_bf16 v[212:215], a[244:247], a[148:151], v[212:215]
ds_read_b32 a171, v60
v_perm_b32 v59, v49, v19, s54
v_mfma_f32_16x16x32_bf16 v[216:219], a[244:247], a[152:155], v[216:219]
ds_read_b32 a172, v59
v_perm_b32 v58, v49, v19, s55
v_mfma_f32_16x16x32_bf16 v[220:223], a[244:247], a[156:159], v[220:223]
s_waitcnt lgkmcnt(4)
ds_read_b32 a173, v58
v_add_u32 v12, 28672, v13
v_mfma_f32_16x16x32_bf16 v[224:227], a[248:251], a[144:147], v[224:227]
ds_read_b128 a[224:227], v16 offset:16384
v_perm_b32 v57, v53, v19, s54
v_mfma_f32_16x16x32_bf16 v[228:231], a[248:251], a[148:151], v[228:231]
ds_read_b32 a174, v57
v_perm_b32 v56, v53, v19, s55
v_mfma_f32_16x16x32_bf16 v[232:235], a[248:251], a[152:155], v[232:235]
ds_read_b32 a175, v56
v_mfma_f32_16x16x32_bf16 v[236:239], a[248:251], a[156:159], v[236:239]
s_waitcnt lgkmcnt(4)
v_mfma_f32_16x16x32_bf16 v[240:243], a[252:255], a[144:147], v[240:243]
ds_read_b128 a[228:231], v16 offset:18432
v_mfma_f32_16x16x32_bf16 v[244:247], a[252:255], a[148:151], v[244:247]
v_mfma_f32_16x16x32_bf16 v[248:251], a[252:255], a[152:155], v[248:251]
s_add_u32 m0, s33, 89216
v_mfma_f32_16x16x32_bf16 v[252:255], a[252:255], a[156:159], v[252:255]
s_waitcnt vmcnt(9) lgkmcnt(1)
v_cmp_ne_u64 s[50:51], s[88:89], v[98:99]
v_cmp_ne_u64 s[44:45], s[88:89], v[102:103]
v_mfma_f32_16x16x32_bf16 v[128:131], a[224:227], a[160:163], v[128:131]
ds_read_b128 a[232:235], v16 offset:20480
buffer_load_dwordx4 v10, s[20:23], 0 offen offset:896 lds
v_mfma_f32_16x16x32_bf16 v[132:135], a[224:227], a[164:167], v[132:135]
s_or_b64 s[50:51], s[44:45], s[50:51]
v_mfma_f32_16x16x32_bf16 v[136:139], a[224:227], a[168:171], v[136:139]
s_cbranch_scc1 L_SLOW11
L_BACK11:
v_mfma_f32_16x16x32_bf16 v[140:143], a[224:227], a[172:175], v[140:143]
s_waitcnt lgkmcnt(1)
v_mfma_f32_16x16x32_bf16 v[144:147], a[228:231], a[160:163], v[144:147]
ds_read_b128 a[236:239], v16 offset:22528
v_mfma_f32_16x16x32_bf16 v[148:151], a[228:231], a[164:167], v[148:151]
v_perm_b32 v63, v96, v19, s52
v_mfma_f32_16x16x32_bf16 v[152:155], a[228:231], a[168:171], v[152:155]
ds_read_b32 a176, v63
v_perm_b32 v62, v96, v19, s53
v_mfma_f32_16x16x32_bf16 v[156:159], a[228:231], a[172:175], v[156:159]
s_waitcnt lgkmcnt(2)
ds_read_b32 a177, v62
v_mfma_f32_16x16x32_bf16 v[160:163], a[232:235], a[160:163], v[160:163]
ds_read_b128 a[240:243], v16 offset:24576
v_perm_b32 v61, v100, v19, s52
v_mfma_f32_16x16x32_bf16 v[164:167], a[232:235], a[164:167], v[164:167]
ds_read_b32 a178, v61
v_perm_b32 v60, v100, v19, s53
v_mfma_f32_16x16x32_bf16 v[168:171], a[232:235], a[168:171], v[168:171]
s_add_u32 m0, s33, 93312
ds_read_b32 a179, v60
v_perm_b32 v59, v96, v19, s54
v_mfma_f32_16x16x32_bf16 v[172:175], a[232:235], a[172:175], v[172:175]
s_waitcnt lgkmcnt(4)
ds_read_b32 a180, v59
v_perm_b32 v58, v96, v19, s55
v_mfma_f32_16x16x32_bf16 v[176:179], a[236:239], a[160:163], v[176:179]
ds_read_b128 a[244:247], v16 offset:26624
buffer_load_dwordx4 v11, s[20:23], 0 offen offset:896 lds
v_mfma_f32_16x16x32_bf16 v[180:183], a[236:239], a[164:167], v[180:183]
ds_read_b32 a181, v58
v_perm_b32 v57, v100, v19, s54
v_mfma_f32_16x16x32_bf16 v[184:187], a[236:239], a[168:171], v[184:187]
ds_read_b32 a182, v57
v_perm_b32 v56, v100, v19, s55
v_mfma_f32_16x16x32_bf16 v[188:191], a[236:239], a[172:175], v[188:191]
s_waitcnt lgkmcnt(4)
ds_read_b32 a183, v56
buffer_load_dwordx4 v[32:35], v12, s[24:27], 0 offen offset:0 sc1
v_mfma_f32_16x16x32_bf16 v[192:195], a[240:243], a[160:163], v[192:195]
ds_read_b128 a[248:251], v16 offset:28672
v_perm_b32 v63, v97, v19, s52
v_mfma_f32_16x16x32_bf16 v[196:199], a[240:243], a[164:167], v[196:199]
ds_read_b32 a184, v63
v_perm_b32 v62, v97, v19, s53
v_mfma_f32_16x16x32_bf16 v[200:203], a[240:243], a[168:171], v[200:203]
ds_read_b32 a185, v62
v_perm_b32 v61, v101, v19, s52
v_mfma_f32_16x16x32_bf16 v[204:207], a[240:243], a[172:175], v[204:207]
s_waitcnt lgkmcnt(4)
ds_read_b32 a186, v61
buffer_load_dwordx4 v[36:39], v12, s[24:27], 0 offen offset:1024 sc1
v_mfma_f32_16x16x32_bf16 v[208:211], a[244:247], a[160:163], v[208:211]
ds_read_b128 a[252:255], v16 offset:30720
v_perm_b32 v60, v101, v19, s53
v_mfma_f32_16x16x32_bf16 v[212:215], a[244:247], a[164:167], v[212:215]
ds_read_b32 a187, v60
v_perm_b32 v59, v97, v19, s54
v_mfma_f32_16x16x32_bf16 v[216:219], a[244:247], a[168:171], v[216:219]
L_PAD2:
s_cbranch_vccnz L_PAD3
ds_read_b32 a188, v59
v_perm_b32 v58, v97, v19, s55
v_mfma_f32_16x16x32_bf16 v[220:223], a[244:247], a[172:175], v[220:223]
s_waitcnt lgkmcnt(4)
ds_read_b32 a189, v58
v_mfma_f32_16x16x32_bf16 v[224:227], a[248:251], a[160:163], v[224:227]
ds_read_b128 a[224:227], v17 offset:16384
v_perm_b32 v57, v101, v19, s54
v_mfma_f32_16x16x32_bf16 v[228:231], a[248:251], a[164:167], v[228:231]
ds_read_b32 a190, v57
v_perm_b32 v56, v101, v19, s55
v_mfma_f32_16x16x32_bf16 v[232:235], a[248:251], a[168:171], v[232:235]
ds_read_b32 a191, v56
v_mfma_f32_16x16x32_bf16 v[236:239], a[248:251], a[172:175], v[236:239]
s_waitcnt lgkmcnt(4)
v_mfma_f32_16x16x32_bf16 v[240:243], a[252:255], a[160:163], v[240:243]
ds_read_b128 a[228:231], v17 offset:18432
v_mfma_f32_16x16x32_bf16 v[244:247], a[252:255], a[164:167], v[244:247]
v_mfma_f32_16x16x32_bf16 v[248:251], a[252:255], a[168:171], v[248:251]
s_waitcnt vmcnt(8)
v_cmp_ne_u64 s[50:51], s[88:89], v[82:83]
v_cmp_ne_u64 s[44:45], s[88:89], v[86:87]
v_mfma_f32_16x16x32_bf16 v[252:255], a[252:255], a[172:175], v[252:255]
s_waitcnt lgkmcnt(1)
v_mfma_f32_16x16x32_bf16 v[128:131], a[224:227], a[176:179], v[128:131]
s_or_b64 s[50:51], s[44:45], s[50:51]
ds_read_b128 a[232:235], v17 offset:20480
v_mfma_f32_16x16x32_bf16 v[132:135], a[224:227], a[180:183], v[132:135]
s_cbranch_scc1 L_SLOW12
L_BACK12:
v_mfma_f32_16x16x32_bf16 v[136:139], a[224:227], a[184:187], v[136:139]
s_add_u32 m0, s33, 97280
buffer_load_dwordx4 v[40:43], v12, s[24:27], 0 offen offset:2048 sc1
v_mfma_f32_16x16x32_bf16 v[140:143], a[224:227], a[188:191], v[140:143]
s_waitcnt lgkmcnt(1)
buffer_load_dwordx4 v[44:47], v12, s[24:27], 0 offen offset:3072 sc1
v_mfma_f32_16x16x32_bf16 v[144:147], a[228:231], a[176:179], v[144:147]
ds_read_b128 a[236:239], v17 offset:22528
buffer_load_dwordx4 v8, s[20:23], 0 offen offset:1024 lds
v_mfma_f32_16x16x32_bf16 v[148:151], a[228:231], a[180:183], v[148:151]
v_perm_b32 v63, v80, v19, s52
v_add_u32 v12, 32768, v13
v_mfma_f32_16x16x32_bf16 v[152:155], a[228:231], a[184:187], v[152:155]
ds_read_b32 a192, v63
v_perm_b32 v62, v80, v19, s53
v_mfma_f32_16x16x32_bf16 v[156:159], a[228:231], a[188:191], v[156:159]
s_waitcnt lgkmcnt(2)
ds_read_b32 a193, v62
v_mfma_f32_16x16x32_bf16 v[160:163], a[232:235], a[176:179], v[160:163]
s_barrier
ds_read_b128 a[240:243], v17 offset:24576
v_perm_b32 v61, v84, v19, s52
v_mfma_f32_16x16x32_bf16 v[164:167], a[232:235], a[180:183], v[164:167]
ds_read_b32 a194, v61
v_perm_b32 v60, v84, v19, s53
v_mfma_f32_16x16x32_bf16 v[168:171], a[232:235], a[184:187], v[168:171]
ds_read_b32 a195, v60
v_perm_b32 v59, v80, v19, s54
v_mfma_f32_16x16x32_bf16 v[172:175], a[232:235], a[188:191], v[172:175]
s_waitcnt lgkmcnt(4)
ds_read_b32 a196, v59
v_mfma_f32_16x16x32_bf16 v[176:179], a[236:239], a[176:179], v[176:179]
ds_read_b128 a[244:247], v17 offset:26624
v_perm_b32 v58, v80, v19, s55
v_mfma_f32_16x16x32_bf16 v[180:183], a[236:239], a[180:183], v[180:183]
ds_read_b32 a197, v58
v_perm_b32 v57, v84, v19, s54
v_mfma_f32_16x16x32_bf16 v[184:187], a[236:239], a[184:187], v[184:187]
ds_read_b32 a198, v57
v_perm_b32 v56, v84, v19, s55
v_mfma_f32_16x16x32_bf16 v[188:191], a[236:239], a[188:191], v[188:191]
s_waitcnt lgkmcnt(4)
ds_read_b32 a199, v56
v_mfma_f32_16x16x32_bf16 v[192:195], a[240:243], a[176:179], v[192:195]
ds_read_b128 a[248:251], v17 offset:28672
v_perm_b32 v63, v81, v19, s52
v_mfma_f32_16x16x32_bf16 v[196:199], a[240:243], a[180:183], v[196:199]
ds_read_b32 a200, v63
v_perm_b32 v62, v81, v19, s53
v_mfma_f32_16x16x32_bf16 v[200:203], a[240:243], a[184:187], v[200:203]
s_add_u32 m0, s33, 101376
ds_read_b32 a201, v62
v_perm_b32 v61, v85, v19, s52
v_mfma_f32_16x16x32_bf16 v[204:207], a[240:243], a[188:191], v[204:207]
s_waitcnt lgkmcnt(4)
ds_read_b32 a202, v61
v_perm_b32 v60, v85, v19, s53
v_mfma_f32_16x16x32_bf16 v[208:211], a[244:247], a[176:179], v[208:211]
ds_read_b128 a[252:255], v17 offset:30720
buffer_load_dwordx4 v9, s[20:23], 0 offen offset:1024 lds
v_mfma_f32_16x16x32_bf16 v[212:215], a[244:247], a[180:183], v[212:215]
ds_read_b32 a203, v60
v_perm_b32 v59, v81, v19, s54
v_mfma_f32_16x16x32_bf16 v[216:219], a[244:247], a[184:187], v[216:219]
ds_read_b32 a204, v59
v_perm_b32 v58, v81, v19, s55
v_mfma_f32_16x16x32_bf16 v[220:223], a[244:247], a[188:191], v[220:223]
s_waitcnt lgkmcnt(4)
ds_read_b32 a205, v58
v_mfma_f32_16x16x32_bf16 v[224:227], a[248:251], a[176:179], v[224:227]
ds_read_b128 a[224:227], v14 offset:0
v_perm_b32 v57, v85, v19, s54
v_mfma_f32_16x16x32_bf16 v[228:231], a[248:251], a[180:183], v[228:231]
ds_read_b32 a206, v57
v_perm_b32 v56, v85, v19, s55
v_mfma_f32_16x16x32_bf16 v[232:235], a[248:251], a[184:187], v[232:235]
ds_read_b32 a207, v56
buffer_load_dwordx4 v[48:51], v12, s[24:27], 0 offen offset:0 sc1
v_mfma_f32_16x16x32_bf16 v[236:239], a[248:251], a[188:191], v[236:239]
s_waitcnt lgkmcnt(4)
buffer_load_dwordx4 v[52:55], v12, s[24:27], 0 offen offset:1024 sc1
v_mfma_f32_16x16x32_bf16 v[240:243], a[252:255], a[176:179], v[240:243]
ds_read_b128 a[228:231], v14 offset:2048
v_mfma_f32_16x16x32_bf16 v[244:247], a[252:255], a[180:183], v[244:247]
v_mfma_f32_16x16x32_bf16 v[248:251], a[252:255], a[184:187], v[248:251]
s_add_u32 m0, s33, 105472
v_mfma_f32_16x16x32_bf16 v[252:255], a[252:255], a[188:191], v[252:255]
s_waitcnt vmcnt(11) lgkmcnt(1)
v_cmp_ne_u64 s[50:51], s[88:89], v[90:91]
v_cmp_ne_u64 s[44:45], s[88:89], v[94:95]
v_mfma_f32_16x16x32_bf16 v[128:131], a[224:227], a[192:195], v[128:131]
ds_read_b128 a[232:235], v14 offset:4096
buffer_load_dwordx4 v10, s[20:23], 0 offen offset:1024 lds
v_mfma_f32_16x16x32_bf16 v[132:135], a[224:227], a[196:199], v[132:135]
s_or_b64 s[50:51], s[44:45], s[50:51]
v_mfma_f32_16x16x32_bf16 v[136:139], a[224:227], a[200:203], v[136:139]
s_cbranch_scc1 L_SLOW13
L_BACK13:
v_mfma_f32_16x16x32_bf16 v[140:143], a[224:227], a[204:207], v[140:143]
s_waitcnt lgkmcnt(1)
v_mfma_f32_16x16x32_bf16 v[144:147], a[228:231], a[192:195], v[144:147]
ds_read_b128 a[236:239], v14 offset:6144
v_mfma_f32_16x16x32_bf16 v[148:151], a[228:231], a[196:199], v[148:151]
v_perm_b32 v63, v88, v19, s52
v_mfma_f32_16x16x32_bf16 v[152:155], a[228:231], a[200:203], v[152:155]
ds_read_b32 a208, v63
v_perm_b32 v62, v88, v19, s53
v_mfma_f32_16x16x32_bf16 v[156:159], a[228:231], a[204:207], v[156:159]
s_waitcnt lgkmcnt(2)
ds_read_b32 a209, v62
v_mfma_f32_16x16x32_bf16 v[160:163], a[232:235], a[192:195], v[160:163]
ds_read_b128 a[240:243], v14 offset:8192
v_perm_b32 v61, v92, v19, s52
v_mfma_f32_16x16x32_bf16 v[164:167], a[232:235], a[196:199], v[164:167]
ds_read_b32 a210, v61
v_perm_b32 v60, v92, v19, s53
v_mfma_f32_16x16x32_bf16 v[168:171], a[232:235], a[200:203], v[168:171]
s_add_u32 m0, s33, 109440
ds_read_b32 a211, v60
v_perm_b32 v59, v88, v19, s54
v_mfma_f32_16x16x32_bf16 v[172:175], a[232:235], a[204:207], v[172:175]
s_waitcnt lgkmcnt(4)
ds_read_b32 a212, v59
v_perm_b32 v58, v88, v19, s55
v_mfma_f32_16x16x32_bf16 v[176:179], a[236:239], a[192:195], v[176:179]
ds_read_b128 a[244:247], v14 offset:10240
buffer_load_dwordx4 v8, s[20:23], 0 offen offset:1152 lds
v_mfma_f32_16x16x32_bf16 v[180:183], a[236:239], a[196:199], v[180:183]
ds_read_b32 a213, v58
v_perm_b32 v57, v92, v19, s54
v_mfma_f32_16x16x32_bf16 v[184:187], a[236:239], a[200:203], v[184:187]
ds_read_b32 a214, v57
v_perm_b32 v56, v92, v19, s55
v_mfma_f32_16x16x32_bf16 v[188:191], a[236:239], a[204:207], v[188:191]
s_waitcnt lgkmcnt(4)
ds_read_b32 a215, v56
buffer_load_dwordx4 v[96:99], v12, s[24:27], 0 offen offset:2048 sc1
v_mfma_f32_16x16x32_bf16 v[192:195], a[240:243], a[192:195], v[192:195]
ds_read_b128 a[248:251], v14 offset:12288
v_perm_b32 v63, v89, v19, s52
v_mfma_f32_16x16x32_bf16 v[196:199], a[240:243], a[196:199], v[196:199]
ds_read_b32 a216, v63
v_perm_b32 v62, v89, v19, s53
v_mfma_f32_16x16x32_bf16 v[200:203], a[240:243], a[200:203], v[200:203]
ds_read_b32 a217, v62
v_perm_b32 v61, v93, v19, s52
v_mfma_f32_16x16x32_bf16 v[204:207], a[240:243], a[204:207], v[204:207]
s_waitcnt lgkmcnt(4)
ds_read_b32 a218, v61
buffer_load_dwordx4 v[100:103], v12, s[24:27], 0 offen offset:3072 sc1
v_mfma_f32_16x16x32_bf16 v[208:211], a[244:247], a[192:195], v[208:211]
ds_read_b128 a[252:255], v14 offset:14336
v_perm_b32 v60, v93, v19, s53
v_mfma_f32_16x16x32_bf16 v[212:215], a[244:247], a[196:199], v[212:215]
ds_read_b32 a219, v60
v_perm_b32 v59, v89, v19, s54
v_mfma_f32_16x16x32_bf16 v[216:219], a[244:247], a[200:203], v[216:219]
ds_read_b32 a220, v59
v_perm_b32 v58, v89, v19, s55
v_mfma_f32_16x16x32_bf16 v[220:223], a[244:247], a[204:207], v[220:223]
s_waitcnt lgkmcnt(4)
ds_read_b32 a221, v58
v_add_u32 v12, 36864, v13
v_mfma_f32_16x16x32_bf16 v[224:227], a[248:251], a[192:195], v[224:227]
ds_read_b128 a[224:227], v15 offset:0
v_perm_b32 v57, v93, v19, s54
v_mfma_f32_16x16x32_bf16 v[228:231], a[248:251], a[196:199], v[228:231]
ds_read_b32 a222, v57
v_perm_b32 v56, v93, v19, s55
v_mfma_f32_16x16x32_bf16 v[232:235], a[248:251], a[200:203], v[232:235]
ds_read_b32 a223, v56
v_mfma_f32_16x16x32_bf16 v[236:239], a[248:251], a[204:207], v[236:239]
s_waitcnt lgkmcnt(4)
v_mfma_f32_16x16x32_bf16 v[240:243], a[252:255], a[192:195], v[240:243]
ds_read_b128 a[228:231], v15 offset:2048
v_mfma_f32_16x16x32_bf16 v[244:247], a[252:255], a[196:199], v[244:247]
v_mfma_f32_16x16x32_bf16 v[248:251], a[252:255], a[200:203], v[248:251]
s_waitcnt vmcnt(10)
v_cmp_ne_u64 s[50:51], s[88:89], v[34:35]
v_cmp_ne_u64 s[44:45], s[88:89], v[38:39]
v_mfma_f32_16x16x32_bf16 v[252:255], a[252:255], a[204:207], v[252:255]
s_waitcnt lgkmcnt(1)
v_mfma_f32_16x16x32_bf16 v[128:131], a[224:227], a[208:211], v[128:131]
s_or_b64 s[50:51], s[44:45], s[50:51]
ds_read_b128 a[232:235], v15 offset:4096
v_mfma_f32_16x16x32_bf16 v[132:135], a[224:227], a[212:215], v[132:135]
s_cbranch_scc1 L_SLOW14
L_BACK14:
v_mfma_f32_16x16x32_bf16 v[136:139], a[224:227], a[216:219], v[136:139]
s_add_u32 m0, s33, 113664
v_perm_b32 v63, v32, v19, s52
v_mfma_f32_16x16x32_bf16 v[140:143], a[224:227], a[220:223], v[140:143]
s_waitcnt lgkmcnt(1)
ds_read_b32 a0, v63
v_perm_b32 v62, v32, v19, s53
v_mfma_f32_16x16x32_bf16 v[144:147], a[228:231], a[208:211], v[144:147]
ds_read_b128 a[236:239], v15 offset:6144
buffer_load_dwordx4 v11, s[20:23], 0 offen offset:1024 lds
v_mfma_f32_16x16x32_bf16 v[148:151], a[228:231], a[212:215], v[148:151]
ds_read_b32 a1, v62
v_perm_b32 v61, v36, v19, s52
v_mfma_f32_16x16x32_bf16 v[152:155], a[228:231], a[216:219], v[152:155]
ds_read_b32 a2, v61
v_perm_b32 v60, v36, v19, s53
v_mfma_f32_16x16x32_bf16 v[156:159], a[228:231], a[220:223], v[156:159]
s_waitcnt lgkmcnt(4)
ds_read_b32 a3, v60
v_mfma_f32_16x16x32_bf16 v[160:163], a[232:235], a[208:211], v[160:163]
s_barrier
ds_read_b128 a[240:243], v15 offset:8192
v_perm_b32 v59, v32, v19, s54
v_mfma_f32_16x16x32_bf16 v[164:167], a[232:235], a[212:215], v[164:167]
ds_read_b32 a4, v59
v_perm_b32 v58, v32, v19, s55
v_mfma_f32_16x16x32_bf16 v[168:171], a[232:235], a[216:219], v[168:171]
ds_read_b32 a5, v58
v_perm_b32 v57, v36, v19, s54
v_mfma_f32_16x16x32_bf16 v[172:175], a[232:235], a[220:223], v[172:175]
s_waitcnt lgkmcnt(4)
ds_read_b32 a6, v57
buffer_load_dwordx4 v[80:83], v12, s[24:27], 0 offen offset:0 sc1
v_mfma_f32_16x16x32_bf16 v[176:179], a[236:239], a[208:211], v[176:179]
ds_read_b128 a[244:247], v15 offset:10240
v_perm_b32 v56, v36, v19, s55
v_mfma_f32_16x16x32_bf16 v[180:183], a[236:239], a[212:215], v[180:183]
ds_read_b32 a7, v56
v_perm_b32 v63, v33, v19, s52
v_mfma_f32_16x16x32_bf16 v[184:187], a[236:239], a[216:219], v[184:187]
ds_read_b32 a8, v63
v_perm_b32 v62, v33, v19, s53
v_mfma_f32_16x16x32_bf16 v[188:191], a[236:239], a[220:223], v[188:191]
s_waitcnt lgkmcnt(4)
ds_read_b32 a9, v62
buffer_load_dwordx4 v[84:87], v12, s[24:27], 0 offen offset:1024 sc1
v_mfma_f32_16x16x32_bf16 v[192:195], a[240:243], a[208:211], v[192:195]
ds_read_b128 a[248:251], v15 offset:12288
v_perm_b32 v61, v37, v19, s52
v_mfma_f32_16x16x32_bf16 v[196:199], a[240:243], a[212:215], v[196:199]
ds_read_b32 a10, v61
v_perm_b32 v60, v37, v19, s53
v_mfma_f32_16x16x32_bf16 v[200:203], a[240:243], a[216:219], v[200:203]
s_add_u32 m0, s33, 117632
ds_read_b32 a11, v60
v_perm_b32 v59, v33, v19, s54
v_mfma_f32_16x16x32_bf16 v[204:207], a[240:243], a[220:223], v[204:207]
s_waitcnt lgkmcnt(4)
ds_read_b32 a12, v59
v_perm_b32 v58, v33, v19, s55
v_mfma_f32_16x16x32_bf16 v[208:211], a[244:247], a[208:211], v[208:211]
ds_read_b128 a[252:255], v15 offset:14336
buffer_load_dwordx4 v9, s[20:23], 0 offen offset:1152 lds
v_mfma_f32_16x16x32_bf16 v[212:215], a[244:247], a[212:215], v[212:215]
ds_read_b32 a13, v58
v_perm_b32 v57, v37, v19, s54
v_mfma_f32_16x16x32_bf16 v[216:219], a[244:247], a[216:219], v[216:219]
s_waitcnt vmcnt(12)
v_cmp_ne_u64 s[50:51], s[88:89], v[42:43]
v_cmp_ne_u64 s[44:45], s[88:89], v[46:47]
v_mfma_f32_16x16x32_bf16 v[220:223], a[244:247], a[220:223], v[220:223]
s_waitcnt lgkmcnt(3)
ds_read_b32 a14, v57
v_mfma_f32_16x16x32_bf16 v[224:227], a[248:251], a[208:211], v[224:227]
s_or_b64 s[50:51], s[44:45], s[50:51]
ds_read_b128 a[224:227], v14 offset:16384
v_perm_b32 v56, v37, v19, s55
v_mfma_f32_16x16x32_bf16 v[228:231], a[248:251], a[212:215], v[228:231]
s_cbranch_scc1 L_SLOW15
L_BACK15:
v_mfma_f32_16x16x32_bf16 v[232:235], a[248:251], a[216:219], v[232:235]
ds_read_b32 a15, v56
v_perm_b32 v63, v40, v19, s52
v_mfma_f32_16x16x32_bf16 v[236:239], a[248:251], a[220:223], v[236:239]
s_waitcnt lgkmcnt(3)
ds_read_b32 a16, v63
v_mfma_f32_16x16x32_bf16 v[240:243], a[252:255], a[208:211], v[240:243]
ds_read_b128 a[228:231], v14 offset:18432
v_perm_b32 v62, v40, v19, s53
v_mfma_f32_16x16x32_bf16 v[244:247], a[252:255], a[212:215], v[244:247]
ds_read_b32 a17, v62
v_perm_b32 v61, v44, v19, s52
v_mfma_f32_16x16x32_bf16 v[248:251], a[252:255], a[216:219], v[248:251]
s_add_u32 m0, s33, 121600
ds_read_b32 a18, v61
v_perm_b32 v60, v44, v19, s53
v_mfma_f32_16x16x32_bf16 v[252:255], a[252:255], a[220:223], v[252:255]
s_waitcnt lgkmcnt(4)
ds_read_b32 a19, v60
v_perm_b32 v59, v40, v19, s54
v_mfma_f32_16x16x32_bf16 v[128:131], a[224:227], a[0:3], v[128:131]
ds_read_b128 a[232:235], v14 offset:20480
buffer_load_dwordx4 v8, s[20:23], 0 offen offset:1280 lds
v_mfma_f32_16x16x32_bf16 v[132:135], a[224:227], a[4:7], v[132:135]
ds_read_b32 a20, v59
v_perm_b32 v58, v40, v19, s55
v_mfma_f32_16x16x32_bf16 v[136:139], a[224:227], a[8:11], v[136:139]
ds_read_b32 a21, v58
v_perm_b32 v57, v44, v19, s54
v_mfma_f32_16x16x32_bf16 v[140:143], a[224:227], a[12:15], v[140:143]
s_waitcnt lgkmcnt(4)
ds_read_b32 a22, v57
buffer_load_dwordx4 v[88:91], v12, s[24:27], 0 offen offset:2048 sc1
v_mfma_f32_16x16x32_bf16 v[144:147], a[228:231], a[0:3], v[144:147]
ds_read_b128 a[236:239], v14 offset:22528
v_perm_b32 v56, v44, v19, s55
v_mfma_f32_16x16x32_bf16 v[148:151], a[228:231], a[4:7], v[148:151]
ds_read_b32 a23, v56
v_perm_b32 v63, v41, v19, s52
v_mfma_f32_16x16x32_bf16 v[152:155], a[228:231], a[8:11], v[152:155]
ds_read_b32 a24, v63
v_perm_b32 v62, v41, v19, s53
v_mfma_f32_16x16x32_bf16 v[156:159], a[228:231], a[12:15], v[156:159]
s_waitcnt lgkmcnt(4)
ds_read_b32 a25, v62
buffer_load_dwordx4 v[92:95], v12, s[24:27], 0 offen offset:3072 sc1
v_mfma_f32_16x16x32_bf16 v[160:163], a[232:235], a[0:3], v[160:163]
ds_read_b128 a[240:243], v14 offset:24576
v_perm_b32 v61, v45, v19, s52
v_mfma_f32_16x16x32_bf16 v[164:167], a[232:235], a[4:7], v[164:167]
ds_read_b32 a26, v61
v_perm_b32 v60, v45, v19, s53
v_mfma_f32_16x16x32_bf16 v[168:171], a[232:235], a[8:11], v[168:171]
s_add_u32 m0, s33, 125824
ds_read_b32 a27, v60
v_perm_b32 v59, v41, v19, s54
v_mfma_f32_16x16x32_bf16 v[172:175], a[232:235], a[12:15], v[172:175]
s_waitcnt lgkmcnt(4)
ds_read_b32 a28, v59
v_perm_b32 v58, v41, v19, s55
v_mfma_f32_16x16x32_bf16 v[176:179], a[236:239], a[0:3], v[176:179]
ds_read_b128 a[244:247], v14 offset:26624
buffer_load_dwordx4 v10, s[20:23], 0 offen offset:1152 lds
v_mfma_f32_16x16x32_bf16 v[180:183], a[236:239], a[4:7], v[180:183]
ds_read_b32 a29, v58
v_perm_b32 v57, v45, v19, s54
v_mfma_f32_16x16x32_bf16 v[184:187], a[236:239], a[8:11], v[184:187]
s_waitcnt vmcnt(12)
v_cmp_ne_u64 s[50:51], s[88:89], v[50:51]
v_cmp_ne_u64 s[44:45], s[88:89], v[54:55]
v_mfma_f32_16x16x32_bf16 v[188:191], a[236:239], a[12:15], v[188:191]
s_waitcnt lgkmcnt(3)
ds_read_b32 a30, v57
v_add_u32 v12, 40960, v13
v_mfma_f32_16x16x32_bf16 v[192:195], a[240:243], a[0:3], v[192:195]
s_or_b64 s[50:51], s[44:45], s[50:51]
ds_read_b128 a[248:251], v14 offset:28672
v_perm_b32 v56, v45, v19, s55
v_mfma_f32_16x16x32_bf16 v[196:199], a[240:243], a[4:7], v[196:199]
s_cbranch_scc1 L_SLOW16
L_BACK16:
v_mfma_f32_16x16x32_bf16 v[200:203], a[240:243], a[8:11], v[200:203]
ds_read_b32 a31, v56
v_perm_b32 v63, v48, v19, s52
v_mfma_f32_16x16x32_bf16 v[204:207], a[240:243], a[12:15], v[204:207]
s_waitcnt lgkmcnt(3)
ds_read_b32 a32, v63
v_mfma_f32_16x16x32_bf16 v[208:211], a[244:247], a[0:3], v[208:211]
ds_read_b128 a[252:255], v14 offset:30720
v_perm_b32 v62, v48, v19, s53
v_mfma_f32_16x16x32_bf16 v[212:215], a[244:247], a[4:7], v[212:215]
ds_read_b32 a33, v62
v_perm_b32 v61, v52, v19, s52
v_mfma_f32_16x16x32_bf16 v[216:219], a[244:247], a[8:11], v[216:219]
ds_read_b32 a34, v61
v_perm_b32 v60, v52, v19, s53
v_mfma_f32_16x16x32_bf16 v[220:223], a[244:247], a[12:15], v[220:223]
s_waitcnt lgkmcnt(4)
ds_read_b32 a35, v60
v_mfma_f32_16x16x32_bf16 v[224:227], a[248:251], a[0:3], v[224:227]
ds_read_b128 a[224:227], v15 offset:16384
v_perm_b32 v59, v48, v19, s54
v_mfma_f32_16x16x32_bf16 v[228:231], a[248:251], a[4:7], v[228:231]
ds_read_b32 a36, v59
v_perm_b32 v58, v48, v19, s55
v_mfma_f32_16x16x32_bf16 v[232:235], a[248:251], a[8:11], v[232:235]
ds_read_b32 a37, v58
v_perm_b32 v57, v52, v19, s54
v_mfma_f32_16x16x32_bf16 v[236:239], a[248:251], a[12:15], v[236:239]
s_waitcnt lgkmcnt(4)
ds_read_b32 a38, v57
buffer_load_dwordx4 v[32:35], v12, s[24:27], 0 offen offset:0 sc1
v_mfma_f32_16x16x32_bf16 v[240:243], a[252:255], a[0:3], v[240:243]
ds_read_b128 a[228:231], v15 offset:18432
v_perm_b32 v56, v52, v19, s55
v_mfma_f32_16x16x32_bf16 v[244:247], a[252:255], a[4:7], v[244:247]
ds_read_b32 a39, v56
v_perm_b32 v63, v49, v19, s52
v_mfma_f32_16x16x32_bf16 v[248:251], a[252:255], a[8:11], v[248:251]
ds_read_b32 a40, v63
v_perm_b32 v62, v49, v19, s53
v_mfma_f32_16x16x32_bf16 v[252:255], a[252:255], a[12:15], v[252:255]
s_waitcnt lgkmcnt(4)
ds_read_b32 a41, v62
buffer_load_dwordx4 v[36:39], v12, s[24:27], 0 offen offset:1024 sc1
v_mfma_f32_16x16x32_bf16 v[128:131], a[224:227], a[16:19], v[128:131]
ds_read_b128 a[232:235], v15 offset:20480
v_perm_b32 v61, v53, v19, s52
v_mfma_f32_16x16x32_bf16 v[132:135], a[224:227], a[20:23], v[132:135]
ds_read_b32 a42, v61
v_perm_b32 v60, v53, v19, s53
v_mfma_f32_16x16x32_bf16 v[136:139], a[224:227], a[24:27], v[136:139]
s_add_u32 m0, s33, 129792
ds_read_b32 a43, v60
v_perm_b32 v59, v49, v19, s54
v_mfma_f32_16x16x32_bf16 v[140:143], a[224:227], a[28:31], v[140:143]
s_waitcnt vmcnt(10) lgkmcnt(4)
v_cmp_ne_u64 s[50:51], s[88:89], v[98:99]
v_cmp_ne_u64 s[44:45], s[88:89], v[102:103]
v_mfma_f32_16x16x32_bf16 v[144:147], a[228:231], a[16:19], v[144:147]
ds_read_b128 a[236:239], v15 offset:22528
buffer_load_dwordx4 v9, s[20:23], 0 offen offset:1280 lds
v_mfma_f32_16x16x32_bf16 v[148:151], a[228:231], a[20:23], v[148:151]
ds_read_b32 a44, v59
v_perm_b32 v58, v49, v19, s55
v_mfma_f32_16x16x32_bf16 v[152:155], a[228:231], a[24:27], v[152:155]
s_or_b64 s[50:51], s[44:45], s[50:51]
ds_read_b32 a45, v58
v_perm_b32 v57, v53, v19, s54
v_mfma_f32_16x16x32_bf16 v[156:159], a[228:231], a[28:31], v[156:159]
s_waitcnt lgkmcnt(3)
ds_read_b32 a46, v57
v_mfma_f32_16x16x32_bf16 v[160:163], a[232:235], a[16:19], v[160:163]
s_barrier
ds_read_b128 a[240:243], v15 offset:24576
v_perm_b32 v56, v53, v19, s55
v_mfma_f32_16x16x32_bf16 v[164:167], a[232:235], a[20:23], v[164:167]
s_cbranch_scc1 L_SLOW17
L_BACK17:
v_mfma_f32_16x16x32_bf16 v[168:171], a[232:235], a[24:27], v[168:171]
ds_read_b32 a47, v56
v_perm_b32 v63, v96, v19, s52
v_mfma_f32_16x16x32_bf16 v[172:175], a[232:235], a[28:31], v[172:175]
s_waitcnt lgkmcnt(3)
ds_read_b32 a48, v63
v_mfma_f32_16x16x32_bf16 v[176:179], a[236:239], a[16:19], v[176:179]
ds_read_b128 a[244:247], v15 offset:26624
v_perm_b32 v62, v96, v19, s53
v_mfma_f32_16x16x32_bf16 v[180:183], a[236:239], a[20:23], v[180:183]
ds_read_b32 a49, v62
v_perm_b32 v61, v100, v19, s52
v_mfma_f32_16x16x32_bf16 v[184:187], a[236:239], a[24:27], v[184:187]
ds_read_b32 a50, v61
v_perm_b32 v60, v100, v19, s53
v_mfma_f32_16x16x32_bf16 v[188:191], a[236:239], a[28:31], v[188:191]
s_waitcnt lgkmcnt(4)
ds_read_b32 a51, v60
v_mfma_f32_16x16x32_bf16 v[192:195], a[240:243], a[16:19], v[192:195]
ds_read_b128 a[248:251], v14 offset:32768
v_perm_b32 v59, v96, v19, s54
v_mfma_f32_16x16x32_bf16 v[196:199], a[240:243], a[20:23], v[196:199]
ds_read_b32 a52, v59
v_perm_b32 v58, v96, v19, s55
v_mfma_f32_16x16x32_bf16 v[200:203], a[240:243], a[24:27], v[200:203]
s_add_u32 m0, s33, 133760
ds_read_b32 a53, v58
v_perm_b32 v57, v100, v19, s54
v_mfma_f32_16x16x32_bf16 v[204:207], a[240:243], a[28:31], v[204:207]
s_waitcnt lgkmcnt(4)
ds_read_b32 a54, v57
v_perm_b32 v56, v100, v19, s55
v_mfma_f32_16x16x32_bf16 v[208:211], a[244:247], a[16:19], v[208:211]
ds_read_b128 a[252:255], v14 offset:34816
buffer_load_dwordx4 v8, s[20:23], 0 offen offset:1408 lds
v_mfma_f32_16x16x32_bf16 v[212:215], a[244:247], a[20:23], v[212:215]
ds_read_b32 a55, v56
v_perm_b32 v63, v97, v19, s52
v_mfma_f32_16x16x32_bf16 v[216:219], a[244:247], a[24:27], v[216:219]
ds_read_b32 a56, v63
v_perm_b32 v62, v97, v19, s53
v_mfma_f32_16x16x32_bf16 v[220:223], a[244:247], a[28:31], v[220:223]
s_waitcnt lgkmcnt(4)
ds_read_b32 a57, v62
buffer_load_dwordx4 v[40:43], v12, s[24:27], 0 offen offset:2048 sc1
v_mfma_f32_16x16x32_bf16 v[128:131], a[248:251], a[32:35], v[128:131]
ds_read_b128 a[224:227], v15 offset:28672
v_perm_b32 v61, v101, v19, s52
v_mfma_f32_16x16x32_bf16 v[132:135], a[248:251], a[36:39], v[132:135]
ds_read_b32 a58, v61
v_perm_b32 v60, v101, v19, s53
v_mfma_f32_16x16x32_bf16 v[136:139], a[248:251], a[40:43], v[136:139]
ds_read_b32 a59, v60
v_perm_b32 v59, v97, v19, s54
v_mfma_f32_16x16x32_bf16 v[140:143], a[248:251], a[44:47], v[140:143]
s_waitcnt lgkmcnt(4)
ds_read_b32 a60, v59
buffer_load_dwordx4 v[44:47], v12, s[24:27], 0 offen offset:3072 sc1
v_mfma_f32_16x16x32_bf16 v[144:147], a[252:255], a[32:35], v[144:147]
ds_read_b128 a[228:231], v15 offset:30720
v_perm_b32 v58, v97, v19, s55
v_mfma_f32_16x16x32_bf16 v[148:151], a[252:255], a[36:39], v[148:151]
ds_read_b32 a61, v58
v_perm_b32 v57, v101, v19, s54
v_mfma_f32_16x16x32_bf16 v[152:155], a[252:255], a[40:43], v[152:155]
s_waitcnt vmcnt(11)
s_add_u32 m0, s33, 137984
v_cmp_ne_u64 s[50:51], s[88:89], v[82:83]
v_cmp_ne_u64 s[44:45], s[88:89], v[86:87]
v_mfma_f32_16x16x32_bf16 v[156:159], a[252:255], a[44:47], v[156:159]
s_waitcnt lgkmcnt(3)
ds_read_b32 a62, v57
v_perm_b32 v56, v101, v19, s55
v_mfma_f32_16x16x32_bf16 v[224:227], a[224:227], a[16:19], v[224:227]
s_or_b64 s[50:51], s[44:45], s[50:51]
ds_read_b128 a[232:235], v14 offset:36864
buffer_load_dwordx4 v10, s[20:23], 0 offen offset:1280 lds
v_mfma_f32_16x16x32_bf16 v[228:231], a[224:227], a[20:23], v[228:231]
s_cbranch_scc1 L_SLOW18
L_BACK18:
v_mfma_f32_16x16x32_bf16 v[232:235], a[224:227], a[24:27], v[232:235]
ds_read_b32 a63, v56
v_perm_b32 v63, v80, v19, s52
v_mfma_f32_16x16x32_bf16 v[236:239], a[224:227], a[28:31], v[236:239]
s_waitcnt lgkmcnt(3)
ds_read_b32 a64, v63
v_add_u32 v12, 45056, v13
v_mfma_f32_16x16x32_bf16 v[240:243], a[228:231], a[16:19], v[240:243]
ds_read_b128 a[236:239], v14 offset:38912
v_perm_b32 v62, v80, v19, s53
v_mfma_f32_16x16x32_bf16 v[244:247], a[228:231], a[20:23], v[244:247]
ds_read_b32 a65, v62
v_perm_b32 v61, v84, v19, s52
v_mfma_f32_16x16x32_bf16 v[248:251], a[228:231], a[24:27], v[248:251]
L_PAD3:
s_cbranch_vccnz L_PADRET
ds_read_b32 a66, v61
v_perm_b32 v60, v84, v19, s53
v_mfma_f32_16x16x32_bf16 v[252:255], a[228:231], a[28:31], v[252:255]
s_waitcnt lgkmcnt(4)
ds_read_b32 a67, v60
v_mfma_f32_16x16x32_bf16 v[160:163], a[232:235], a[32:35], v[160:163]
ds_read_b128 a[240:243], v15 offset:32768
v_perm_b32 v59, v80, v19, s54
v_mfma_f32_16x16x32_bf16 v[164:167], a[232:235], a[36:39], v[164:167]
ds_read_b32 a68, v59
v_perm_b32 v58, v80, v19, s55
v_mfma_f32_16x16x32_bf16 v[168:171], a[232:235], a[40:43], v[168:171]
s_add_u32 m0, s33, 142208
ds_read_b32 a69, v58
v_perm_b32 v57, v84, v19, s54
v_mfma_f32_16x16x32_bf16 v[172:175], a[232:235], a[44:47], v[172:175]
s_waitcnt lgkmcnt(4)
ds_read_b32 a70, v57
v_perm_b32 v56, v84, v19, s55
v_mfma_f32_16x16x32_bf16 v[176:179], a[236:239], a[32:35], v[176:179]
ds_read_b128 a[244:247], v15 offset:34816
buffer_load_dwordx4 v11, s[20:23], 0 offen offset:1152 lds
v_mfma_f32_16x16x32_bf16 v[180:183], a[236:239], a[36:39], v[180:183]
ds_read_b32 a71, v56
v_perm_b32 v63, v81, v19, s52
v_mfma_f32_16x16x32_bf16 v[184:187], a[236:239], a[40:43], v[184:187]
ds_read_b32 a72, v63
v_perm_b32 v62, v81, v19, s53
v_mfma_f32_16x16x32_bf16 v[188:191], a[236:239], a[44:47], v[188:191]
s_waitcnt lgkmcnt(4)
ds_read_b32 a73, v62
buffer_load_dwordx4 v[48:51], v12, s[24:27], 0 offen offset:0 sc1
v_mfma_f32_16x16x32_bf16 v[128:131], a[240:243], a[48:51], v[128:131]
ds_read_b128 a[248:251], v14 offset:40960
v_perm_b32 v61, v85, v19, s52
v_mfma_f32_16x16x32_bf16 v[132:135], a[240:243], a[52:55], v[132:135]
ds_read_b32 a74, v61
v_perm_b32 v60, v85, v19, s53
v_mfma_f32_16x16x32_bf16 v[136:139], a[240:243], a[56:59], v[136:139]
ds_read_b32 a75, v60
v_perm_b32 v59, v81, v19, s54
v_mfma_f32_16x16x32_bf16 v[140:143], a[240:243], a[60:63], v[140:143]
s_waitcnt lgkmcnt(4)
ds_read_b32 a76, v59
buffer_load_dwordx4 v[52:55], v12, s[24:27], 0 offen offset:1024 sc1
v_mfma_f32_16x16x32_bf16 v[144:147], a[244:247], a[48:51], v[144:147]
ds_read_b128 a[252:255], v14 offset:43008
v_perm_b32 v58, v81, v19, s55
v_mfma_f32_16x16x32_bf16 v[148:151], a[244:247], a[52:55], v[148:151]
ds_read_b32 a77, v58
v_perm_b32 v57, v85, v19, s54
v_mfma_f32_16x16x32_bf16 v[152:155], a[244:247], a[56:59], v[152:155]
s_waitcnt vmcnt(11)
v_cmp_ne_u64 s[50:51], s[88:89], v[90:91]
v_cmp_ne_u64 s[44:45], s[88:89], v[94:95]
v_mfma_f32_16x16x32_bf16 v[156:159], a[244:247], a[60:63], v[156:159]
s_waitcnt lgkmcnt(3)
ds_read_b32 a78, v57
v_mfma_f32_16x16x32_bf16 v[192:195], a[248:251], a[32:35], v[192:195]
s_or_b64 s[50:51], s[44:45], s[50:51]
ds_read_b128 a[224:227], v15 offset:36864
v_perm_b32 v56, v85, v19, s55
v_mfma_f32_16x16x32_bf16 v[196:199], a[248:251], a[36:39], v[196:199]
s_cbranch_scc1 L_SLOW19
L_BACK19:
v_mfma_f32_16x16x32_bf16 v[200:203], a[248:251], a[40:43], v[200:203]
ds_read_b32 a79, v56
v_perm_b32 v63, v88, v19, s52
v_mfma_f32_16x16x32_bf16 v[204:207], a[248:251], a[44:47], v[204:207]
s_waitcnt lgkmcnt(3)
ds_read_b32 a80, v63
v_mfma_f32_16x16x32_bf16 v[208:211], a[252:255], a[32:35], v[208:211]
ds_read_b128 a[228:231], v15 offset:38912
v_perm_b32 v62, v88, v19, s53
v_mfma_f32_16x16x32_bf16 v[212:215], a[252:255], a[36:39], v[212:215]
ds_read_b32 a81, v62
v_perm_b32 v61, v92, v19, s52
v_mfma_f32_16x16x32_bf16 v[216:219], a[252:255], a[40:43], v[216:219]
ds_read_b32 a82, v61
v_perm_b32 v60, v92, v19, s53
v_mfma_f32_16x16x32_bf16 v[220:223], a[252:255], a[44:47], v[220:223]
s_waitcnt lgkmcnt(4)
ds_read_b32 a83, v60
v_mfma_f32_16x16x32_bf16 v[160:163], a[224:227], a[48:51], v[160:163]
ds_read_b128 a[232:235], v14 offset:45056
v_perm_b32 v59, v88, v19, s54
v_mfma_f32_16x16x32_bf16 v[164:167], a[224:227], a[52:55], v[164:167]
ds_read_b32 a84, v59
v_perm_b32 v58, v88, v19, s55
v_mfma_f32_16x16x32_bf16 v[168:171], a[224:227], a[56:59], v[168:171]
s_add_u32 m0, s33, 146048
ds_read_b32 a85, v58
v_perm_b32 v57, v92, v19, s54
v_mfma_f32_16x16x32_bf16 v[172:175], a[224:227], a[60:63], v[172:175]
s_waitcnt lgkmcnt(4)
ds_read_b32 a86, v57
v_perm_b32 v56, v92, v19, s55
v_mfma_f32_16x16x32_bf16 v[176:179], a[228:231], a[48:51], v[176:179]
ds_read_b128 a[236:239], v14 offset:47104
buffer_load_dwordx4 v9, s[20:23], 0 offen offset:1408 lds
v_mfma_f32_16x16x32_bf16 v[180:183], a[228:231], a[52:55], v[180:183]
ds_read_b32 a87, v56
v_perm_b32 v63, v89, v19, s52
v_mfma_f32_16x16x32_bf16 v[184:187], a[228:231], a[56:59], v[184:187]
ds_read_b32 a88, v63
v_perm_b32 v62, v89, v19, s53
v_mfma_f32_16x16x32_bf16 v[188:191], a[228:231], a[60:63], v[188:191]
s_waitcnt lgkmcnt(4)
ds_read_b32 a89, v62
buffer_load_dwordx4 v[96:99], v12, s[24:27], 0 offen offset:2048 sc1
v_mfma_f32_16x16x32_bf16 v[128:131], a[232:235], a[64:67], v[128:131]
s_waitcnt vmcnt(12)
s_barrier
ds_read_b128 a[240:243], v15 offset:40960
v_perm_b32 v61, v93, v19, s52
v_mfma_f32_16x16x32_bf16 v[132:135], a[232:235], a[68:71], v[132:135]
ds_read_b32 a90, v61
v_perm_b32 v60, v93, v19, s53
v_mfma_f32_16x16x32_bf16 v[136:139], a[232:235], a[72:75], v[136:139]
ds_read_b32 a91, v60
v_perm_b32 v59, v89, v19, s54
v_mfma_f32_16x16x32_bf16 v[140:143], a[232:235], a[76:79], v[140:143]
s_waitcnt lgkmcnt(4)
ds_read_b32 a92, v59
buffer_load_dwordx4 v[100:103], v12, s[24:27], 0 offen offset:3072 sc1
v_mfma_f32_16x16x32_bf16 v[144:147], a[236:239], a[64:67], v[144:147]
ds_read_b128 a[244:247], v15 offset:43008
v_perm_b32 v58, v89, v19, s55
v_mfma_f32_16x16x32_bf16 v[148:151], a[236:239], a[68:71], v[148:151]
ds_read_b32 a93, v58
v_perm_b32 v57, v93, v19, s54
v_mfma_f32_16x16x32_bf16 v[152:155], a[236:239], a[72:75], v[152:155]
s_waitcnt vmcnt(11)
v_cmp_ne_u64 s[50:51], s[88:89], v[34:35]
v_cmp_ne_u64 s[44:45], s[88:89], v[38:39]
v_mfma_f32_16x16x32_bf16 v[156:159], a[236:239], a[76:79], v[156:159]
s_waitcnt lgkmcnt(3)
ds_read_b32 a94, v57
v_add_u32 v12, 49152, v13
v_mfma_f32_16x16x32_bf16 v[192:195], a[240:243], a[48:51], v[192:195]
s_or_b64 s[50:51], s[44:45], s[50:51]
ds_read_b128 a[248:251], v14 offset:49152
v_perm_b32 v56, v93, v19, s55
v_mfma_f32_16x16x32_bf16 v[196:199], a[240:243], a[52:55], v[196:199]
s_cbranch_scc1 L_SLOW20
L_BACK20:
v_mfma_f32_16x16x32_bf16 v[200:203], a[240:243], a[56:59], v[200:203]
s_add_u32 m0, s33, 150016
ds_read_b32 a95, v56
v_perm_b32 v63, v32, v19, s52
v_mfma_f32_16x16x32_bf16 v[204:207], a[240:243], a[60:63], v[204:207]
s_waitcnt lgkmcnt(3)
ds_read_b32 a96, v63
v_perm_b32 v62, v32, v19, s53
v_mfma_f32_16x16x32_bf16 v[208:211], a[244:247], a[48:51], v[208:211]
ds_read_b128 a[252:255], v14 offset:51200
buffer_load_dwordx4 v8, s[20:23], 0 offen offset:1536 lds
v_mfma_f32_16x16x32_bf16 v[212:215], a[244:247], a[52:55], v[212:215]
ds_read_b32 a97, v62
v_perm_b32 v61, v36, v19, s52
v_mfma_f32_16x16x32_bf16 v[216:219], a[244:247], a[56:59], v[216:219]
ds_read_b32 a98, v61
v_perm_b32 v60, v36, v19, s53
v_mfma_f32_16x16x32_bf16 v[220:223], a[244:247], a[60:63], v[220:223]
s_waitcnt lgkmcnt(4)
ds_read_b32 a99, v60
v_mfma_f32_16x16x32_bf16 v[224:227], a[248:251], a[32:35], v[224:227]
ds_read_b128 a[224:227], v14 offset:53248
v_perm_b32 v59, v32, v19, s54
v_mfma_f32_16x16x32_bf16 v[228:231], a[248:251], a[36:39], v[228:231]
ds_read_b32 a100, v59
v_perm_b32 v58, v32, v19, s55
v_mfma_f32_16x16x32_bf16 v[232:235], a[248:251], a[40:43], v[232:235]
ds_read_b32 a101, v58
v_perm_b32 v57, v36, v19, s54
v_mfma_f32_16x16x32_bf16 v[236:239], a[248:251], a[44:47], v[236:239]
s_waitcnt lgkmcnt(4)
ds_read_b32 a102, v57
buffer_load_dwordx4 v[80:83], v12, s[24:27], 0 offen offset:0 sc1
v_mfma_f32_16x16x32_bf16 v[240:243], a[252:255], a[32:35], v[240:243]
ds_read_b128 a[228:231], v14 offset:55296
v_perm_b32 v56, v36, v19, s55
v_mfma_f32_16x16x32_bf16 v[244:247], a[252:255], a[36:39], v[244:247]
ds_read_b32 a103, v56
v_perm_b32 v63, v33, v19, s52
v_mfma_f32_16x16x32_bf16 v[248:251], a[252:255], a[40:43], v[248:251]
s_add_u32 m0, s33, 154112
ds_read_b32 a104, v63
v_perm_b32 v62, v33, v19, s53
v_mfma_f32_16x16x32_bf16 v[252:255], a[252:255], a[44:47], v[252:255]
s_waitcnt lgkmcnt(4)
ds_read_b32 a105, v62
v_perm_b32 v61, v37, v19, s52
v_mfma_f32_16x16x32_bf16 v[160:163], a[224:227], a[64:67], v[160:163]
ds_read_b128 a[232:235], v15 offset:45056
buffer_load_dwordx4 v9, s[20:23], 0 offen offset:1536 lds
v_mfma_f32_16x16x32_bf16 v[164:167], a[224:227], a[68:71], v[164:167]
ds_read_b32 a106, v61
v_perm_b32 v60, v37, v19, s53
v_mfma_f32_16x16x32_bf16 v[168:171], a[224:227], a[72:75], v[168:171]
ds_read_b32 a107, v60
v_perm_b32 v59, v33, v19, s54
v_mfma_f32_16x16x32_bf16 v[172:175], a[224:227], a[76:79], v[172:175]
s_waitcnt lgkmcnt(4)
ds_read_b32 a108, v59
buffer_load_dwordx4 v[84:87], v12, s[24:27], 0 offen offset:1024 sc1
v_mfma_f32_16x16x32_bf16 v[176:179], a[228:231], a[64:67], v[176:179]
ds_read_b128 a[236:239], v15 offset:47104
v_perm_b32 v58, v33, v19, s55
v_mfma_f32_16x16x32_bf16 v[180:183], a[228:231], a[68:71], v[180:183]
ds_read_b32 a109, v58
v_perm_b32 v57, v37, v19, s54
v_mfma_f32_16x16x32_bf16 v[184:187], a[228:231], a[72:75], v[184:187]
s_waitcnt vmcnt(11)
v_cmp_ne_u64 s[50:51], s[88:89], v[42:43]
v_cmp_ne_u64 s[44:45], s[88:89], v[46:47]
v_mfma_f32_16x16x32_bf16 v[188:191], a[228:231], a[76:79], v[188:191]
s_waitcnt lgkmcnt(3)
ds_read_b32 a110, v57
v_mfma_f32_16x16x32_bf16 v[128:131], a[232:235], a[80:83], v[128:131]
s_or_b64 s[50:51], s[44:45], s[50:51]
ds_read_b128 a[240:243], v15 offset:53248
v_perm_b32 v56, v37, v19, s55
v_mfma_f32_16x16x32_bf16 v[132:135], a[232:235], a[84:87], v[132:135]
s_cbranch_scc1 L_SLOW21
L_BACK21:
v_mfma_f32_16x16x32_bf16 v[136:139], a[232:235], a[88:91], v[136:139]
s_add_u32 m0, s33, 158080
ds_read_b32 a111, v56
v_perm_b32 v63, v40, v19, s52
v_mfma_f32_16x16x32_bf16 v[140:143], a[232:235], a[92:95], v[140:143]
s_waitcnt lgkmcnt(3)
ds_read_b32 a112, v63
v_perm_b32 v62, v40, v19, s53
v_mfma_f32_16x16x32_bf16 v[144:147], a[236:239], a[80:83], v[144:147]
ds_read_b128 a[244:247], v15 offset:55296
buffer_load_dwordx4 v8, s[20:23], 0 offen offset:1664 lds
v_mfma_f32_16x16x32_bf16 v[148:151], a[236:239], a[84:87], v[148:151]
ds_read_b32 a113, v62
v_perm_b32 v61, v44, v19, s52
v_mfma_f32_16x16x32_bf16 v[152:155], a[236:239], a[88:91], v[152:155]
ds_read_b32 a114, v61
v_perm_b32 v60, v44, v19, s53
v_mfma_f32_16x16x32_bf16 v[156:159], a[236:239], a[92:95], v[156:159]
s_waitcnt lgkmcnt(4)
ds_read_b32 a115, v60
buffer_load_dwordx4 v[88:91], v12, s[24:27], 0 offen offset:2048 sc1
v_mfma_f32_16x16x32_bf16 v[160:163], a[240:243], a[80:83], v[160:163]
ds_read_b128 a[248:251], v14 offset:57344
v_perm_b32 v59, v40, v19, s54
v_mfma_f32_16x16x32_bf16 v[164:167], a[240:243], a[84:87], v[164:167]
ds_read_b32 a116, v59
v_perm_b32 v58, v40, v19, s55
v_mfma_f32_16x16x32_bf16 v[168:171], a[240:243], a[88:91], v[168:171]
ds_read_b32 a117, v58
v_perm_b32 v57, v44, v19, s54
v_mfma_f32_16x16x32_bf16 v[172:175], a[240:243], a[92:95], v[172:175]
s_waitcnt lgkmcnt(4)
ds_read_b32 a118, v57
buffer_load_dwordx4 v[92:95], v12, s[24:27], 0 offen offset:3072 sc1
v_mfma_f32_16x16x32_bf16 v[176:179], a[244:247], a[80:83], v[176:179]
ds_read_b128 a[252:255], v14 offset:59392
v_perm_b32 v56, v44, v19, s55
v_mfma_f32_16x16x32_bf16 v[180:183], a[244:247], a[84:87], v[180:183]
ds_read_b32 a119, v56
v_perm_b32 v63, v41, v19, s52
v_mfma_f32_16x16x32_bf16 v[184:187], a[244:247], a[88:91], v[184:187]
ds_read_b32 a120, v63
v_perm_b32 v62, v41, v19, s53
v_mfma_f32_16x16x32_bf16 v[188:191], a[244:247], a[92:95], v[188:191]
s_waitcnt lgkmcnt(4)
ds_read_b32 a121, v62
v_add_u32 v12, 53248, v13
v_mfma_f32_16x16x32_bf16 v[128:131], a[248:251], a[96:99], v[128:131]
ds_read_b128 a[224:227], v14 offset:61440
v_perm_b32 v61, v45, v19, s52
v_mfma_f32_16x16x32_bf16 v[132:135], a[248:251], a[100:103], v[132:135]
ds_read_b32 a122, v61
v_perm_b32 v60, v45, v19, s53
v_mfma_f32_16x16x32_bf16 v[136:139], a[248:251], a[104:107], v[136:139]
s_add_u32 m0, s33, 64128
ds_read_b32 a123, v60
v_perm_b32 v59, v41, v19, s54
v_mfma_f32_16x16x32_bf16 v[140:143], a[248:251], a[108:111], v[140:143]
s_waitcnt lgkmcnt(4)
ds_read_b32 a124, v59
v_perm_b32 v58, v41, v19, s55
v_mfma_f32_16x16x32_bf16 v[144:147], a[252:255], a[96:99], v[144:147]
ds_read_b128 a[228:231], v14 offset:63488
buffer_load_dwordx4 v10, s[20:23], 0 offen offset:1408 lds
v_mfma_f32_16x16x32_bf16 v[148:151], a[252:255], a[100:103], v[148:151]
ds_read_b32 a125, v58
v_perm_b32 v57, v45, v19, s54
v_mfma_f32_16x16x32_bf16 v[152:155], a[252:255], a[104:107], v[152:155]
s_waitcnt vmcnt(11)
v_cmp_ne_u64 s[50:51], s[88:89], v[50:51]
v_cmp_ne_u64 s[44:45], s[88:89], v[54:55]
v_mfma_f32_16x16x32_bf16 v[156:159], a[252:255], a[108:111], v[156:159]
s_waitcnt lgkmcnt(3)
ds_read_b32 a126, v57
v_mfma_f32_16x16x32_bf16 v[192:195], a[224:227], a[64:67], v[192:195]
s_or_b64 s[50:51], s[44:45], s[50:51]
ds_read_b128 a[232:235], v15 offset:49152
v_perm_b32 v56, v45, v19, s55
v_mfma_f32_16x16x32_bf16 v[196:199], a[224:227], a[68:71], v[196:199]
s_cbranch_scc1 L_SLOW22
L_BACK22:
v_mfma_f32_16x16x32_bf16 v[200:203], a[224:227], a[72:75], v[200:203]
s_add_u32 m0, s33, 68352
ds_read_b32 a127, v56
v_perm_b32 v63, v48, v19, s52
v_mfma_f32_16x16x32_bf16 v[204:207], a[224:227], a[76:79], v[204:207]
s_waitcnt lgkmcnt(3)
ds_read_b32 a128, v63
v_perm_b32 v62, v48, v19, s53
v_mfma_f32_16x16x32_bf16 v[208:211], a[228:231], a[64:67], v[208:211]
ds_read_b128 a[236:239], v15 offset:51200
buffer_load_dwordx4 v11, s[20:23], 0 offen offset:1280 lds
v_mfma_f32_16x16x32_bf16 v[212:215], a[228:231], a[68:71], v[212:215]
ds_read_b32 a129, v62
v_perm_b32 v61, v52, v19, s52
v_mfma_f32_16x16x32_bf16 v[216:219], a[228:231], a[72:75], v[216:219]
ds_read_b32 a130, v61
v_perm_b32 v60, v52, v19, s53
v_mfma_f32_16x16x32_bf16 v[220:223], a[228:231], a[76:79], v[220:223]
s_waitcnt lgkmcnt(4)
ds_read_b32 a131, v60
v_mfma_f32_16x16x32_bf16 v[224:227], a[232:235], a[48:51], v[224:227]
s_barrier
ds_read_b128 a[240:243], v15 offset:57344
v_perm_b32 v59, v48, v19, s54
v_mfma_f32_16x16x32_bf16 v[228:231], a[232:235], a[52:55], v[228:231]
ds_read_b32 a132, v59
v_perm_b32 v58, v48, v19, s55
v_mfma_f32_16x16x32_bf16 v[232:235], a[232:235], a[56:59], v[232:235]
ds_read_b32 a133, v58
v_perm_b32 v57, v52, v19, s54
v_mfma_f32_16x16x32_bf16 v[236:239], a[232:235], a[60:63], v[236:239]
s_waitcnt lgkmcnt(4)
ds_read_b32 a134, v57
buffer_load_dwordx4 v[32:35], v12, s[24:27], 0 offen offset:0 sc1
v_mfma_f32_16x16x32_bf16 v[240:243], a[236:239], a[48:51], v[240:243]
ds_read_b128 a[244:247], v15 offset:59392
v_perm_b32 v56, v52, v19, s55
v_mfma_f32_16x16x32_bf16 v[244:247], a[236:239], a[52:55], v[244:247]
ds_read_b32 a135, v56
v_perm_b32 v63, v49, v19, s52
v_mfma_f32_16x16x32_bf16 v[248:251], a[236:239], a[56:59], v[248:251]
ds_read_b32 a136, v63
v_perm_b32 v62, v49, v19, s53
v_mfma_f32_16x16x32_bf16 v[252:255], a[236:239], a[60:63], v[252:255]
s_waitcnt lgkmcnt(4)
ds_read_b32 a137, v62
buffer_load_dwordx4 v[36:39], v12, s[24:27], 0 offen offset:1024 sc1
v_mfma_f32_16x16x32_bf16 v[128:131], a[240:243], a[112:115], v[128:131]
ds_read_b128 a[248:251], v16 offset:0
v_perm_b32 v61, v53, v19, s52
v_mfma_f32_16x16x32_bf16 v[132:135], a[240:243], a[116:119], v[132:135]
ds_read_b32 a138, v61
v_perm_b32 v60, v53, v19, s53
v_mfma_f32_16x16x32_bf16 v[136:139], a[240:243], a[120:123], v[136:139]
s_add_u32 m0, s33, 71936
ds_read_b32 a139, v60
v_perm_b32 v59, v49, v19, s54
v_mfma_f32_16x16x32_bf16 v[140:143], a[240:243], a[124:127], v[140:143]
s_waitcnt lgkmcnt(4)
ds_read_b32 a140, v59
v_perm_b32 v58, v49, v19, s55
v_mfma_f32_16x16x32_bf16 v[144:147], a[244:247], a[112:115], v[144:147]
ds_read_b128 a[252:255], v16 offset:2048
buffer_load_dwordx4 v8, s[20:23], 0 offen offset:1792 lds
v_mfma_f32_16x16x32_bf16 v[148:151], a[244:247], a[116:119], v[148:151]
ds_read_b32 a141, v58
v_perm_b32 v57, v53, v19, s54
v_mfma_f32_16x16x32_bf16 v[152:155], a[244:247], a[120:123], v[152:155]
s_waitcnt vmcnt(12)
v_cmp_ne_u64 s[50:51], s[88:89], v[98:99]
v_cmp_ne_u64 s[44:45], s[88:89], v[102:103]
v_mfma_f32_16x16x32_bf16 v[156:159], a[244:247], a[124:127], v[156:159]
s_waitcnt lgkmcnt(3)
ds_read_b32 a142, v57
v_mfma_f32_16x16x32_bf16 v[160:163], a[248:251], a[96:99], v[160:163]
s_or_b64 s[50:51], s[44:45], s[50:51]
ds_read_b128 a[224:227], v15 offset:61440
v_perm_b32 v56, v53, v19, s55
v_mfma_f32_16x16x32_bf16 v[164:167], a[248:251], a[100:103], v[164:167]
s_cbranch_scc1 L_SLOW23
L_BACK23:
v_mfma_f32_16x16x32_bf16 v[168:171], a[248:251], a[104:107], v[168:171]
ds_read_b32 a143, v56
v_perm_b32 v63, v96, v19, s52
v_mfma_f32_16x16x32_bf16 v[172:175], a[248:251], a[108:111], v[172:175]
s_waitcnt lgkmcnt(3)
ds_read_b32 a144, v63
v_mfma_f32_16x16x32_bf16 v[176:179], a[252:255], a[96:99], v[176:179]
ds_read_b128 a[228:231], v15 offset:63488
v_perm_b32 v62, v96, v19, s53
v_mfma_f32_16x16x32_bf16 v[180:183], a[252:255], a[100:103], v[180:183]
ds_read_b32 a145, v62
v_perm_b32 v61, v100, v19, s52
v_mfma_f32_16x16x32_bf16 v[184:187], a[252:255], a[104:107], v[184:187]
s_add_u32 m0, s33, 76160
ds_read_b32 a146, v61
v_perm_b32 v60, v100, v19, s53
v_mfma_f32_16x16x32_bf16 v[188:191], a[252:255], a[108:111], v[188:191]
s_waitcnt lgkmcnt(4)
ds_read_b32 a147, v60
v_perm_b32 v59, v96, v19, s54
v_mfma_f32_16x16x32_bf16 v[192:195], a[224:227], a[80:83], v[192:195]
ds_read_b128 a[232:235], v16 offset:4096
buffer_load_dwordx4 v9, s[20:23], 0 offen offset:1664 lds
v_mfma_f32_16x16x32_bf16 v[196:199], a[224:227], a[84:87], v[196:199]
ds_read_b32 a148, v59
v_perm_b32 v58, v96, v19, s55
v_mfma_f32_16x16x32_bf16 v[200:203], a[224:227], a[88:91], v[200:203]
ds_read_b32 a149, v58
v_perm_b32 v57, v100, v19, s54
v_mfma_f32_16x16x32_bf16 v[204:207], a[224:227], a[92:95], v[204:207]
s_waitcnt lgkmcnt(4)
ds_read_b32 a150, v57
buffer_load_dwordx4 v[40:43], v12, s[24:27], 0 offen offset:2048 sc1
v_mfma_f32_16x16x32_bf16 v[208:211], a[228:231], a[80:83], v[208:211]
ds_read_b128 a[236:239], v16 offset:6144
v_perm_b32 v56, v100, v19, s55
v_mfma_f32_16x16x32_bf16 v[212:215], a[228:231], a[84:87], v[212:215]
ds_read_b32 a151, v56
v_perm_b32 v63, v97, v19, s52
v_mfma_f32_16x16x32_bf16 v[216:219], a[228:231], a[88:91], v[216:219]
ds_read_b32 a152, v63
v_perm_b32 v62, v97, v19, s53
v_mfma_f32_16x16x32_bf16 v[220:223], a[228:231], a[92:95], v[220:223]
s_waitcnt lgkmcnt(4)
ds_read_b32 a153, v62
buffer_load_dwordx4 v[44:47], v12, s[24:27], 0 offen offset:3072 sc1
v_mfma_f32_16x16x32_bf16 v[128:131], a[232:235], a[128:131], v[128:131]
ds_read_b128 a[240:243], v17 offset:0
v_perm_b32 v61, v101, v19, s52
v_mfma_f32_16x16x32_bf16 v[132:135], a[232:235], a[132:135], v[132:135]
ds_read_b32 a154, v61
v_perm_b32 v60, v101, v19, s53
v_mfma_f32_16x16x32_bf16 v[136:139], a[232:235], a[136:139], v[136:139]
s_add_u32 m0, s33, 80384
ds_read_b32 a155, v60
v_perm_b32 v59, v97, v19, s54
v_mfma_f32_16x16x32_bf16 v[140:143], a[232:235], a[140:143], v[140:143]
s_waitcnt lgkmcnt(4)
ds_read_b32 a156, v59
v_perm_b32 v58, v97, v19, s55
v_mfma_f32_16x16x32_bf16 v[144:147], a[236:239], a[128:131], v[144:147]
ds_read_b128 a[244:247], v17 offset:2048
buffer_load_dwordx4 v10, s[20:23], 0 offen offset:1536 lds
v_mfma_f32_16x16x32_bf16 v[148:151], a[236:239], a[132:135], v[148:151]
ds_read_b32 a157, v58
v_perm_b32 v57, v101, v19, s54
v_mfma_f32_16x16x32_bf16 v[152:155], a[236:239], a[136:139], v[152:155]
s_waitcnt vmcnt(12)
v_cmp_ne_u64 s[50:51], s[88:89], v[82:83]
v_cmp_ne_u64 s[44:45], s[88:89], v[86:87]
v_mfma_f32_16x16x32_bf16 v[156:159], a[236:239], a[140:143], v[156:159]
s_waitcnt lgkmcnt(3)
ds_read_b32 a158, v57
v_add_u32 v12, 57344, v13
v_mfma_f32_16x16x32_bf16 v[160:163], a[240:243], a[112:115], v[160:163]
s_or_b64 s[50:51], s[44:45], s[50:51]
ds_read_b128 a[248:251], v17 offset:4096
v_perm_b32 v56, v101, v19, s55
v_mfma_f32_16x16x32_bf16 v[164:167], a[240:243], a[116:119], v[164:167]
s_cbranch_scc1 L_SLOW24
L_BACK24:
v_mfma_f32_16x16x32_bf16 v[168:171], a[240:243], a[120:123], v[168:171]
ds_read_b32 a159, v56
v_perm_b32 v63, v80, v19, s52
v_mfma_f32_16x16x32_bf16 v[172:175], a[240:243], a[124:127], v[172:175]
s_waitcnt lgkmcnt(3)
ds_read_b32 a160, v63
v_mfma_f32_16x16x32_bf16 v[176:179], a[244:247], a[112:115], v[176:179]
ds_read_b128 a[252:255], v17 offset:6144
v_perm_b32 v62, v80, v19, s53
v_mfma_f32_16x16x32_bf16 v[180:183], a[244:247], a[116:119], v[180:183]
ds_read_b32 a161, v62
v_perm_b32 v61, v84, v19, s52
v_mfma_f32_16x16x32_bf16 v[184:187], a[244:247], a[120:123], v[184:187]
s_add_u32 m0, s33, 84096
ds_read_b32 a162, v61
v_perm_b32 v60, v84, v19, s53
v_mfma_f32_16x16x32_bf16 v[188:191], a[244:247], a[124:127], v[188:191]
s_waitcnt lgkmcnt(4)
ds_read_b32 a163, v60
v_perm_b32 v59, v80, v19, s54
v_mfma_f32_16x16x32_bf16 v[128:131], a[248:251], a[144:147], v[128:131]
ds_read_b128 a[224:227], v16 offset:8192
buffer_load_dwordx4 v8, s[20:23], 0 offen offset:1920 lds
v_mfma_f32_16x16x32_bf16 v[132:135], a[248:251], a[148:151], v[132:135]
ds_read_b32 a164, v59
v_perm_b32 v58, v80, v19, s55
v_mfma_f32_16x16x32_bf16 v[136:139], a[248:251], a[152:155], v[136:139]
ds_read_b32 a165, v58
v_perm_b32 v57, v84, v19, s54
v_mfma_f32_16x16x32_bf16 v[140:143], a[248:251], a[156:159], v[140:143]
s_waitcnt lgkmcnt(4)
ds_read_b32 a166, v57
buffer_load_dwordx4 v[48:51], v12, s[24:27], 0 offen offset:0 sc1
v_mfma_f32_16x16x32_bf16 v[144:147], a[252:255], a[144:147], v[144:147]
ds_read_b128 a[228:231], v16 offset:10240
v_perm_b32 v56, v84, v19, s55
v_mfma_f32_16x16x32_bf16 v[148:151], a[252:255], a[148:151], v[148:151]
ds_read_b32 a167, v56
v_perm_b32 v63, v81, v19, s52
v_mfma_f32_16x16x32_bf16 v[152:155], a[252:255], a[152:155], v[152:155]
ds_read_b32 a168, v63
v_perm_b32 v62, v81, v19, s53
v_mfma_f32_16x16x32_bf16 v[156:159], a[252:255], a[156:159], v[156:159]
s_waitcnt lgkmcnt(4)
ds_read_b32 a169, v62
buffer_load_dwordx4 v[52:55], v12, s[24:27], 0 offen offset:1024 sc1
v_mfma_f32_16x16x32_bf16 v[192:195], a[224:227], a[96:99], v[192:195]
ds_read_b128 a[232:235], v16 offset:12288
v_perm_b32 v61, v85, v19, s52
v_mfma_f32_16x16x32_bf16 v[196:199], a[224:227], a[100:103], v[196:199]
ds_read_b32 a170, v61
v_perm_b32 v60, v85, v19, s53
v_mfma_f32_16x16x32_bf16 v[200:203], a[224:227], a[104:107], v[200:203]
s_add_u32 m0, s33, 88320
ds_read_b32 a171, v60
v_perm_b32 v59, v81, v19, s54
v_mfma_f32_16x16x32_bf16 v[204:207], a[224:227], a[108:111], v[204:207]
s_waitcnt vmcnt(12) lgkmcnt(4)
v_cmp_ne_u64 s[50:51], s[88:89], v[90:91]
v_cmp_ne_u64 s[44:45], s[88:89], v[94:95]
v_mfma_f32_16x16x32_bf16 v[208:211], a[228:231], a[96:99], v[208:211]
ds_read_b128 a[236:239], v16 offset:14336
buffer_load_dwordx4 v9, s[20:23], 0 offen offset:1792 lds
v_mfma_f32_16x16x32_bf16 v[212:215], a[228:231], a[100:103], v[212:215]
ds_read_b32 a172, v59
v_perm_b32 v58, v81, v19, s55
v_mfma_f32_16x16x32_bf16 v[216:219], a[228:231], a[104:107], v[216:219]
s_or_b64 s[50:51], s[44:45], s[50:51]
ds_read_b32 a173, v58
v_perm_b32 v57, v85, v19, s54
v_mfma_f32_16x16x32_bf16 v[220:223], a[228:231], a[108:111], v[220:223]
s_waitcnt lgkmcnt(3)
ds_read_b32 a174, v57
v_mfma_f32_16x16x32_bf16 v[224:227], a[232:235], a[64:67], v[224:227]
s_barrier
ds_read_b128 a[240:243], v16 offset:16384
v_perm_b32 v56, v85, v19, s55
v_mfma_f32_16x16x32_bf16 v[228:231], a[232:235], a[68:71], v[228:231]
s_cbranch_scc1 L_SLOW25
L_BACK25:
v_mfma_f32_16x16x32_bf16 v[232:235], a[232:235], a[72:75], v[232:235]
ds_read_b32 a175, v56
v_perm_b32 v63, v88, v19, s52
v_mfma_f32_16x16x32_bf16 v[236:239], a[232:235], a[76:79], v[236:239]
L_PAD4:
s_cbranch_vccnz L_PAD5
s_waitcnt lgkmcnt(3)
ds_read_b32 a176, v63
v_mfma_f32_16x16x32_bf16 v[240:243], a[236:239], a[64:67], v[240:243]
ds_read_b128 a[244:247], v16 offset:18432
v_perm_b32 v62, v88, v19, s53
v_mfma_f32_16x16x32_bf16 v[244:247], a[236:239], a[68:71], v[244:247]
ds_read_b32 a177, v62
v_perm_b32 v61, v92, v19, s52
v_mfma_f32_16x16x32_bf16 v[248:251], a[236:239], a[72:75], v[248:251]
s_add_u32 m0, s33, 92544
ds_read_b32 a178, v61
v_perm_b32 v60, v92, v19, s53
v_mfma_f32_16x16x32_bf16 v[252:255], a[236:239], a[76:79], v[252:255]
s_waitcnt lgkmcnt(4)
ds_read_b32 a179, v60
v_perm_b32 v59, v88, v19, s54
v_mfma_f32_16x16x32_bf16 v[160:163], a[240:243], a[128:131], v[160:163]
ds_read_b128 a[248:251], v16 offset:20480
buffer_load_dwordx4 v10, s[20:23], 0 offen offset:1664 lds
v_mfma_f32_16x16x32_bf16 v[164:167], a[240:243], a[132:135], v[164:167]
ds_read_b32 a180, v59
v_perm_b32 v58, v88, v19, s55
v_mfma_f32_16x16x32_bf16 v[168:171], a[240:243], a[136:139], v[168:171]
ds_read_b32 a181, v58
v_perm_b32 v57, v92, v19, s54
v_mfma_f32_16x16x32_bf16 v[172:175], a[240:243], a[140:143], v[172:175]
s_waitcnt lgkmcnt(4)
ds_read_b32 a182, v57
buffer_load_dwordx4 v[96:99], v12, s[24:27], 0 offen offset:2048 sc1
v_mfma_f32_16x16x32_bf16 v[176:179], a[244:247], a[128:131], v[176:179]
ds_read_b128 a[252:255], v16 offset:22528
v_perm_b32 v56, v92, v19, s55
v_mfma_f32_16x16x32_bf16 v[180:183], a[244:247], a[132:135], v[180:183]
ds_read_b32 a183, v56
v_perm_b32 v63, v89, v19, s52
v_mfma_f32_16x16x32_bf16 v[184:187], a[244:247], a[136:139], v[184:187]
ds_read_b32 a184, v63
v_perm_b32 v62, v89, v19, s53
v_mfma_f32_16x16x32_bf16 v[188:191], a[244:247], a[140:143], v[188:191]
s_waitcnt lgkmcnt(4)
ds_read_b32 a185, v62
buffer_load_dwordx4 v[100:103], v12, s[24:27], 0 offen offset:3072 sc1
v_mfma_f32_16x16x32_bf16 v[128:131], a[248:251], a[160:163], v[128:131]
ds_read_b128 a[224:227], v17 offset:16384
v_perm_b32 v61, v93, v19, s52
v_mfma_f32_16x16x32_bf16 v[132:135], a[248:251], a[164:167], v[132:135]
ds_read_b32 a186, v61
v_perm_b32 v60, v93, v19, s53
v_mfma_f32_16x16x32_bf16 v[136:139], a[248:251], a[168:171], v[136:139]
s_add_u32 m0, s33, 96896
ds_read_b32 a187, v60
v_perm_b32 v59, v89, v19, s54
v_mfma_f32_16x16x32_bf16 v[140:143], a[248:251], a[172:175], v[140:143]
s_waitcnt lgkmcnt(4)
ds_read_b32 a188, v59
v_perm_b32 v58, v89, v19, s55
v_mfma_f32_16x16x32_bf16 v[144:147], a[252:255], a[160:163], v[144:147]
ds_read_b128 a[228:231], v17 offset:18432
buffer_load_dwordx4 v11, s[20:23], 0 offen offset:1408 lds
v_mfma_f32_16x16x32_bf16 v[148:151], a[252:255], a[164:167], v[148:151]
ds_read_b32 a189, v58
v_perm_b32 v57, v93, v19, s54
v_mfma_f32_16x16x32_bf16 v[152:155], a[252:255], a[168:171], v[152:155]
s_waitcnt vmcnt(13)
v_cmp_ne_u64 s[50:51], s[88:89], v[34:35]
v_cmp_ne_u64 s[44:45], s[88:89], v[38:39]
v_mfma_f32_16x16x32_bf16 v[156:159], a[252:255], a[172:175], v[156:159]
s_waitcnt lgkmcnt(3)
ds_read_b32 a190, v57
v_add_u32 v12, 61440, v13
v_mfma_f32_16x16x32_bf16 v[160:163], a[224:227], a[144:147], v[160:163]
s_or_b64 s[50:51], s[44:45], s[50:51]
ds_read_b128 a[232:235], v17 offset:8192
v_perm_b32 v56, v93, v19, s55
v_mfma_f32_16x16x32_bf16 v[164:167], a[224:227], a[148:151], v[164:167]
s_cbranch_scc1 L_SLOW26
L_BACK26:
v_mfma_f32_16x16x32_bf16 v[168:171], a[224:227], a[152:155], v[168:171]
ds_read_b32 a191, v56
v_perm_b32 v63, v32, v19, s52
v_mfma_f32_16x16x32_bf16 v[172:175], a[224:227], a[156:159], v[172:175]
s_waitcnt lgkmcnt(3)
ds_read_b32 a192, v63
v_mfma_f32_16x16x32_bf16 v[176:179], a[228:231], a[144:147], v[176:179]
ds_read_b128 a[236:239], v17 offset:10240
v_perm_b32 v62, v32, v19, s53
v_mfma_f32_16x16x32_bf16 v[180:183], a[228:231], a[148:151], v[180:183]
ds_read_b32 a193, v62
v_perm_b32 v61, v36, v19, s52
v_mfma_f32_16x16x32_bf16 v[184:187], a[228:231], a[152:155], v[184:187]
s_add_u32 m0, s33, 100480
ds_read_b32 a194, v61
v_perm_b32 v60, v36, v19, s53
v_mfma_f32_16x16x32_bf16 v[188:191], a[228:231], a[156:159], v[188:191]
s_waitcnt lgkmcnt(4)
ds_read_b32 a195, v60
v_perm_b32 v59, v32, v19, s54
v_mfma_f32_16x16x32_bf16 v[192:195], a[232:235], a[112:115], v[192:195]
ds_read_b128 a[240:243], v17 offset:20480
buffer_load_dwordx4 v9, s[20:23], 0 offen offset:1920 lds
v_mfma_f32_16x16x32_bf16 v[196:199], a[232:235], a[116:119], v[196:199]
ds_read_b32 a196, v59
v_perm_b32 v58, v32, v19, s55
v_mfma_f32_16x16x32_bf16 v[200:203], a[232:235], a[120:123], v[200:203]
ds_read_b32 a197, v58
v_perm_b32 v57, v36, v19, s54
v_mfma_f32_16x16x32_bf16 v[204:207], a[232:235], a[124:127], v[204:207]
s_waitcnt lgkmcnt(4)
ds_read_b32 a198, v57
buffer_load_dwordx4 v[80:83], v12, s[24:27], 0 offen offset:0 sc1
v_mfma_f32_16x16x32_bf16 v[208:211], a[236:239], a[112:115], v[208:211]
ds_read_b128 a[244:247], v17 offset:22528
v_perm_b32 v56, v36, v19, s55
v_mfma_f32_16x16x32_bf16 v[212:215], a[236:239], a[116:119], v[212:215]
ds_read_b32 a199, v56
v_perm_b32 v63, v33, v19, s52
v_mfma_f32_16x16x32_bf16 v[216:219], a[236:239], a[120:123], v[216:219]
ds_read_b32 a200, v63
v_perm_b32 v62, v33, v19, s53
v_mfma_f32_16x16x32_bf16 v[220:223], a[236:239], a[124:127], v[220:223]
s_waitcnt lgkmcnt(4)
ds_read_b32 a201, v62
buffer_load_dwordx4 v[84:87], v12, s[24:27], 0 offen offset:1024 sc1
v_mfma_f32_16x16x32_bf16 v[128:131], a[240:243], a[176:179], v[128:131]
ds_read_b128 a[248:251], v17 offset:12288
v_perm_b32 v61, v37, v19, s52
v_mfma_f32_16x16x32_bf16 v[132:135], a[240:243], a[180:183], v[132:135]
ds_read_b32 a202, v61
v_perm_b32 v60, v37, v19, s53
v_mfma_f32_16x16x32_bf16 v[136:139], a[240:243], a[184:187], v[136:139]
s_add_u32 m0, s33, 104704
ds_read_b32 a203, v60
v_perm_b32 v59, v33, v19, s54
v_mfma_f32_16x16x32_bf16 v[140:143], a[240:243], a[188:191], v[140:143]
s_waitcnt lgkmcnt(4)
ds_read_b32 a204, v59
v_perm_b32 v58, v33, v19, s55
v_mfma_f32_16x16x32_bf16 v[144:147], a[244:247], a[176:179], v[144:147]
ds_read_b128 a[252:255], v17 offset:14336
buffer_load_dwordx4 v10, s[20:23], 0 offen offset:1792 lds
v_mfma_f32_16x16x32_bf16 v[148:151], a[244:247], a[180:183], v[148:151]
ds_read_b32 a205, v58
v_perm_b32 v57, v37, v19, s54
v_mfma_f32_16x16x32_bf16 v[152:155], a[244:247], a[184:187], v[152:155]
s_waitcnt vmcnt(13)
v_cmp_ne_u64 s[50:51], s[88:89], v[42:43]
v_cmp_ne_u64 s[44:45], s[88:89], v[46:47]
v_mfma_f32_16x16x32_bf16 v[156:159], a[244:247], a[188:191], v[156:159]
s_waitcnt lgkmcnt(3)
ds_read_b32 a206, v57
v_mfma_f32_16x16x32_bf16 v[224:227], a[248:251], a[80:83], v[224:227]
s_or_b64 s[50:51], s[44:45], s[50:51]
ds_read_b128 a[224:227], v16 offset:24576
v_perm_b32 v56, v37, v19, s55
v_mfma_f32_16x16x32_bf16 v[228:231], a[248:251], a[84:87], v[228:231]
s_cbranch_scc1 L_SLOW27
L_BACK27:
v_mfma_f32_16x16x32_bf16 v[232:235], a[248:251], a[88:91], v[232:235]
ds_read_b32 a207, v56
v_perm_b32 v63, v40, v19, s52
v_mfma_f32_16x16x32_bf16 v[236:239], a[248:251], a[92:95], v[236:239]
s_waitcnt lgkmcnt(3)
ds_read_b32 a208, v63
v_mfma_f32_16x16x32_bf16 v[240:243], a[252:255], a[80:83], v[240:243]
ds_read_b128 a[228:231], v16 offset:26624
v_perm_b32 v62, v40, v19, s53
v_mfma_f32_16x16x32_bf16 v[244:247], a[252:255], a[84:87], v[244:247]
ds_read_b32 a209, v62
v_perm_b32 v61, v44, v19, s52
v_mfma_f32_16x16x32_bf16 v[248:251], a[252:255], a[88:91], v[248:251]
s_add_u32 m0, s33, 109056
ds_read_b32 a210, v61
v_perm_b32 v60, v44, v19, s53
v_mfma_f32_16x16x32_bf16 v[252:255], a[252:255], a[92:95], v[252:255]
s_waitcnt lgkmcnt(4)
ds_read_b32 a211, v60
v_perm_b32 v59, v40, v19, s54
v_mfma_f32_16x16x32_bf16 v[160:163], a[224:227], a[160:163], v[160:163]
ds_read_b128 a[232:235], v16 offset:28672
buffer_load_dwordx4 v11, s[20:23], 0 offen offset:1536 lds
v_mfma_f32_16x16x32_bf16 v[164:167], a[224:227], a[164:167], v[164:167]
ds_read_b32 a212, v59
v_perm_b32 v58, v40, v19, s55
v_mfma_f32_16x16x32_bf16 v[168:171], a[224:227], a[168:171], v[168:171]
ds_read_b32 a213, v58
v_perm_b32 v57, v44, v19, s54
v_mfma_f32_16x16x32_bf16 v[172:175], a[224:227], a[172:175], v[172:175]
s_waitcnt lgkmcnt(4)
ds_read_b32 a214, v57
v_mfma_f32_16x16x32_bf16 v[176:179], a[228:231], a[160:163], v[176:179]
ds_read_b128 a[236:239], v16 offset:30720
v_perm_b32 v56, v44, v19, s55
v_mfma_f32_16x16x32_bf16 v[180:183], a[228:231], a[164:167], v[180:183]
ds_read_b32 a215, v56
v_perm_b32 v63, v41, v19, s52
v_mfma_f32_16x16x32_bf16 v[184:187], a[228:231], a[168:171], v[184:187]
ds_read_b32 a216, v63
v_perm_b32 v62, v41, v19, s53
v_mfma_f32_16x16x32_bf16 v[188:191], a[228:231], a[172:175], v[188:191]
s_waitcnt lgkmcnt(4)
ds_read_b32 a217, v62
v_mfma_f32_16x16x32_bf16 v[128:131], a[232:235], a[192:195], v[128:131]
s_barrier
ds_read_b128 a[240:243], v14 offset:0
v_perm_b32 v61, v45, v19, s52
v_mfma_f32_16x16x32_bf16 v[132:135], a[232:235], a[196:199], v[132:135]
ds_read_b32 a218, v61
v_perm_b32 v60, v45, v19, s53
v_mfma_f32_16x16x32_bf16 v[136:139], a[232:235], a[200:203], v[136:139]
s_add_u32 m0, s33, 112768
ds_read_b32 a219, v60
v_perm_b32 v59, v41, v19, s54
v_mfma_f32_16x16x32_bf16 v[140:143], a[232:235], a[204:207], v[140:143]
s_waitcnt lgkmcnt(4)
ds_read_b32 a220, v59
v_perm_b32 v58, v41, v19, s55
v_mfma_f32_16x16x32_bf16 v[144:147], a[236:239], a[192:195], v[144:147]
ds_read_b128 a[244:247], v14 offset:2048
buffer_load_dwordx4 v10, s[20:23], 0 offen offset:1920 lds
v_mfma_f32_16x16x32_bf16 v[148:151], a[236:239], a[196:199], v[148:151]
ds_read_b32 a221, v58
v_perm_b32 v57, v45, v19, s54
v_mfma_f32_16x16x32_bf16 v[152:155], a[236:239], a[200:203], v[152:155]
s_waitcnt vmcnt(11)
v_cmp_ne_u64 s[50:51], s[88:89], v[50:51]
v_cmp_ne_u64 s[44:45], s[88:89], v[54:55]
v_mfma_f32_16x16x32_bf16 v[156:159], a[236:239], a[204:207], v[156:159]
s_waitcnt lgkmcnt(3)
ds_read_b32 a222, v57
buffer_load_dwordx4 v[88:91], v12, s[24:27], 0 offen offset:2048 sc1
v_mfma_f32_16x16x32_bf16 v[192:195], a[240:243], a[128:131], v[192:195]
s_or_b64 s[50:51], s[44:45], s[50:51]
ds_read_b128 a[248:251], v17 offset:24576
v_perm_b32 v56, v45, v19, s55
v_mfma_f32_16x16x32_bf16 v[196:199], a[240:243], a[132:135], v[196:199]
s_cbranch_scc1 L_SLOW28
L_BACK28:
v_mfma_f32_16x16x32_bf16 v[200:203], a[240:243], a[136:139], v[200:203]
ds_read_b32 a223, v56
v_perm_b32 v63, v48, v19, s52
v_mfma_f32_16x16x32_bf16 v[204:207], a[240:243], a[140:143], v[204:207]
s_waitcnt lgkmcnt(3)
ds_read_b32 a0, v63
buffer_load_dwordx4 v[92:95], v12, s[24:27], 0 offen offset:3072 sc1
v_mfma_f32_16x16x32_bf16 v[208:211], a[244:247], a[128:131], v[208:211]
ds_read_b128 a[252:255], v17 offset:26624
v_perm_b32 v62, v48, v19, s53
v_mfma_f32_16x16x32_bf16 v[212:215], a[244:247], a[132:135], v[212:215]
ds_read_b32 a1, v62
v_perm_b32 v61, v52, v19, s52
v_mfma_f32_16x16x32_bf16 v[216:219], a[244:247], a[136:139], v[216:219]
s_add_u32 m0, s33, 117120
ds_read_b32 a2, v61
v_perm_b32 v60, v52, v19, s53
v_mfma_f32_16x16x32_bf16 v[220:223], a[244:247], a[140:143], v[220:223]
s_waitcnt lgkmcnt(4)
ds_read_b32 a3, v60
v_perm_b32 v59, v48, v19, s54
v_mfma_f32_16x16x32_bf16 v[160:163], a[248:251], a[176:179], v[160:163]
ds_read_b128 a[224:227], v17 offset:28672
buffer_load_dwordx4 v11, s[20:23], 0 offen offset:1664 lds
v_mfma_f32_16x16x32_bf16 v[164:167], a[248:251], a[180:183], v[164:167]
ds_read_b32 a4, v59
v_perm_b32 v58, v48, v19, s55
v_mfma_f32_16x16x32_bf16 v[168:171], a[248:251], a[184:187], v[168:171]
ds_read_b32 a5, v58
v_perm_b32 v57, v52, v19, s54
v_mfma_f32_16x16x32_bf16 v[172:175], a[248:251], a[188:191], v[172:175]
s_waitcnt lgkmcnt(4)
ds_read_b32 a6, v57
v_mfma_f32_16x16x32_bf16 v[176:179], a[252:255], a[176:179], v[176:179]
ds_read_b128 a[228:231], v17 offset:30720
v_perm_b32 v56, v52, v19, s55
v_mfma_f32_16x16x32_bf16 v[180:183], a[252:255], a[180:183], v[180:183]
ds_read_b32 a7, v56
v_perm_b32 v63, v49, v19, s52
v_mfma_f32_16x16x32_bf16 v[184:187], a[252:255], a[184:187], v[184:187]
ds_read_b32 a8, v63
v_perm_b32 v62, v49, v19, s53
v_mfma_f32_16x16x32_bf16 v[188:191], a[252:255], a[188:191], v[188:191]
s_waitcnt lgkmcnt(4)
ds_read_b32 a9, v62
v_mfma_f32_16x16x32_bf16 v[128:131], a[224:227], a[208:211], v[128:131]
ds_read_b128 a[232:235], v15 offset:0
v_perm_b32 v61, v53, v19, s52
v_mfma_f32_16x16x32_bf16 v[132:135], a[224:227], a[212:215], v[132:135]
ds_read_b32 a10, v61
v_perm_b32 v60, v53, v19, s53
v_mfma_f32_16x16x32_bf16 v[136:139], a[224:227], a[216:219], v[136:139]
s_add_u32 m0, s33, 121088
ds_read_b32 a11, v60
v_perm_b32 v59, v49, v19, s54
v_mfma_f32_16x16x32_bf16 v[140:143], a[224:227], a[220:223], v[140:143]
s_waitcnt lgkmcnt(4)
ds_read_b32 a12, v59
v_perm_b32 v58, v49, v19, s55
v_mfma_f32_16x16x32_bf16 v[144:147], a[228:231], a[208:211], v[144:147]
ds_read_b128 a[236:239], v15 offset:2048
buffer_load_dwordx4 v11, s[20:23], 0 offen offset:1792 lds
v_mfma_f32_16x16x32_bf16 v[148:151], a[228:231], a[212:215], v[148:151]
ds_read_b32 a13, v58
v_perm_b32 v57, v53, v19, s54
v_mfma_f32_16x16x32_bf16 v[152:155], a[228:231], a[216:219], v[152:155]
s_waitcnt vmcnt(11)
v_cmp_ne_u64 s[50:51], s[88:89], v[98:99]
v_cmp_ne_u64 s[44:45], s[88:89], v[102:103]
v_mfma_f32_16x16x32_bf16 v[156:159], a[228:231], a[220:223], v[156:159]
s_waitcnt lgkmcnt(3)
ds_read_b32 a14, v57
v_mfma_f32_16x16x32_bf16 v[192:195], a[232:235], a[144:147], v[192:195]
s_or_b64 s[50:51], s[44:45], s[50:51]
ds_read_b128 a[240:243], v14 offset:4096
v_perm_b32 v56, v53, v19, s55
v_mfma_f32_16x16x32_bf16 v[196:199], a[232:235], a[148:151], v[196:199]
s_cbranch_scc1 L_SLOW29
L_BACK29:
v_mfma_f32_16x16x32_bf16 v[200:203], a[232:235], a[152:155], v[200:203]
ds_read_b32 a15, v56
v_perm_b32 v63, v96, v19, s52
v_mfma_f32_16x16x32_bf16 v[204:207], a[232:235], a[156:159], v[204:207]
s_waitcnt lgkmcnt(3)
ds_read_b32 a16, v63
v_mfma_f32_16x16x32_bf16 v[208:211], a[236:239], a[144:147], v[208:211]
ds_read_b128 a[244:247], v14 offset:6144
v_perm_b32 v62, v96, v19, s53
v_mfma_f32_16x16x32_bf16 v[212:215], a[236:239], a[148:151], v[212:215]
ds_read_b32 a17, v62
v_perm_b32 v61, v100, v19, s52
v_mfma_f32_16x16x32_bf16 v[216:219], a[236:239], a[152:155], v[216:219]
s_add_u32 m0, s33, 125056
ds_read_b32 a18, v61
v_perm_b32 v60, v100, v19, s53
v_mfma_f32_16x16x32_bf16 v[220:223], a[236:239], a[156:159], v[220:223]
s_waitcnt lgkmcnt(4)
ds_read_b32 a19, v60
v_perm_b32 v59, v96, v19, s54
v_mfma_f32_16x16x32_bf16 v[224:227], a[240:243], a[96:99], v[224:227]
ds_read_b128 a[248:251], v14 offset:8192
buffer_load_dwordx4 v11, s[20:23], 0 offen offset:1920 lds
v_mfma_f32_16x16x32_bf16 v[228:231], a[240:243], a[100:103], v[228:231]
ds_read_b32 a20, v59
v_perm_b32 v58, v96, v19, s55
v_mfma_f32_16x16x32_bf16 v[232:235], a[240:243], a[104:107], v[232:235]
ds_read_b32 a21, v58
v_perm_b32 v57, v100, v19, s54
v_mfma_f32_16x16x32_bf16 v[236:239], a[240:243], a[108:111], v[236:239]
s_waitcnt lgkmcnt(4)
ds_read_b32 a22, v57
v_mfma_f32_16x16x32_bf16 v[240:243], a[244:247], a[96:99], v[240:243]
ds_read_b128 a[252:255], v14 offset:10240
v_perm_b32 v56, v100, v19, s55
v_mfma_f32_16x16x32_bf16 v[244:247], a[244:247], a[100:103], v[244:247]
ds_read_b32 a23, v56
v_perm_b32 v63, v97, v19, s52
v_mfma_f32_16x16x32_bf16 v[248:251], a[244:247], a[104:107], v[248:251]
ds_read_b32 a24, v63
v_perm_b32 v62, v97, v19, s53
v_mfma_f32_16x16x32_bf16 v[252:255], a[244:247], a[108:111], v[252:255]
s_waitcnt lgkmcnt(4)
ds_read_b32 a25, v62
v_mfma_f32_16x16x32_bf16 v[128:131], a[248:251], a[0:3], v[128:131]
ds_read_b128 a[224:227], v14 offset:12288
v_perm_b32 v61, v101, v19, s52
v_mfma_f32_16x16x32_bf16 v[132:135], a[248:251], a[4:7], v[132:135]
ds_read_b32 a26, v61
v_perm_b32 v60, v101, v19, s53
v_mfma_f32_16x16x32_bf16 v[136:139], a[248:251], a[8:11], v[136:139]
ds_read_b32 a27, v60
v_perm_b32 v59, v97, v19, s54
v_mfma_f32_16x16x32_bf16 v[140:143], a[248:251], a[12:15], v[140:143]
s_waitcnt lgkmcnt(4)
ds_read_b32 a28, v59
v_mfma_f32_16x16x32_bf16 v[144:147], a[252:255], a[0:3], v[144:147]
ds_read_b128 a[228:231], v14 offset:14336
v_perm_b32 v58, v97, v19, s55
v_mfma_f32_16x16x32_bf16 v[148:151], a[252:255], a[4:7], v[148:151]
ds_read_b32 a29, v58
v_perm_b32 v57, v101, v19, s54
v_mfma_f32_16x16x32_bf16 v[152:155], a[252:255], a[8:11], v[152:155]
ds_read_b32 a30, v57
v_mfma_f32_16x16x32_bf16 v[156:159], a[252:255], a[12:15], v[156:159]
s_waitcnt vmcnt(8) lgkmcnt(4)
v_cmp_ne_u64 s[50:51], s[88:89], v[82:83]
v_cmp_ne_u64 s[44:45], s[88:89], v[86:87]
v_mfma_f32_16x16x32_bf16 v[160:163], a[224:227], a[192:195], v[160:163]
ds_read_b128 a[232:235], v15 offset:8192
v_perm_b32 v56, v101, v19, s55
v_mfma_f32_16x16x32_bf16 v[164:167], a[224:227], a[196:199], v[164:167]
s_or_b64 s[50:51], s[44:45], s[50:51]
ds_read_b32 a31, v56
v_mfma_f32_16x16x32_bf16 v[168:171], a[224:227], a[200:203], v[168:171]
s_cbranch_scc1 L_SLOW30
L_BACK30:
v_mfma_f32_16x16x32_bf16 v[172:175], a[224:227], a[204:207], v[172:175]
s_waitcnt lgkmcnt(2)
v_mfma_f32_16x16x32_bf16 v[176:179], a[228:231], a[192:195], v[176:179]
ds_read_b128 a[236:239], v15 offset:10240
v_mfma_f32_16x16x32_bf16 v[180:183], a[228:231], a[196:199], v[180:183]
v_perm_b32 v63, v80, v19, s52
v_mfma_f32_16x16x32_bf16 v[184:187], a[228:231], a[200:203], v[184:187]
ds_read_b32 a32, v63
v_perm_b32 v62, v80, v19, s53
v_mfma_f32_16x16x32_bf16 v[188:191], a[228:231], a[204:207], v[188:191]
s_waitcnt lgkmcnt(2)
ds_read_b32 a33, v62
v_mfma_f32_16x16x32_bf16 v[128:131], a[232:235], a[16:19], v[128:131]
s_barrier
ds_read_b128 a[240:243], v15 offset:12288
v_perm_b32 v61, v84, v19, s52
v_mfma_f32_16x16x32_bf16 v[132:135], a[232:235], a[20:23], v[132:135]
ds_read_b32 a34, v61
v_perm_b32 v60, v84, v19, s53
v_mfma_f32_16x16x32_bf16 v[136:139], a[232:235], a[24:27], v[136:139]
ds_read_b32 a35, v60
v_perm_b32 v59, v80, v19, s54
v_mfma_f32_16x16x32_bf16 v[140:143], a[232:235], a[28:31], v[140:143]
s_waitcnt lgkmcnt(4)
ds_read_b32 a36, v59
v_mfma_f32_16x16x32_bf16 v[144:147], a[236:239], a[16:19], v[144:147]
ds_read_b128 a[244:247], v15 offset:14336
v_perm_b32 v58, v80, v19, s55
v_mfma_f32_16x16x32_bf16 v[148:151], a[236:239], a[20:23], v[148:151]
ds_read_b32 a37, v58
v_perm_b32 v57, v84, v19, s54
v_mfma_f32_16x16x32_bf16 v[152:155], a[236:239], a[24:27], v[152:155]
ds_read_b32 a38, v57
v_perm_b32 v56, v84, v19, s55
v_mfma_f32_16x16x32_bf16 v[156:159], a[236:239], a[28:31], v[156:159]
s_waitcnt lgkmcnt(4)
ds_read_b32 a39, v56
v_mfma_f32_16x16x32_bf16 v[160:163], a[240:243], a[208:211], v[160:163]
ds_read_b128 a[248:251], v14 offset:16384
v_perm_b32 v63, v81, v19, s52
v_mfma_f32_16x16x32_bf16 v[164:167], a[240:243], a[212:215], v[164:167]
ds_read_b32 a40, v63
v_perm_b32 v62, v81, v19, s53
v_mfma_f32_16x16x32_bf16 v[168:171], a[240:243], a[216:219], v[168:171]
ds_read_b32 a41, v62
v_perm_b32 v61, v85, v19, s52
v_mfma_f32_16x16x32_bf16 v[172:175], a[240:243], a[220:223], v[172:175]
s_waitcnt lgkmcnt(4)
ds_read_b32 a42, v61
v_mfma_f32_16x16x32_bf16 v[176:179], a[244:247], a[208:211], v[176:179]
ds_read_b128 a[252:255], v14 offset:18432
v_perm_b32 v60, v85, v19, s53
v_mfma_f32_16x16x32_bf16 v[180:183], a[244:247], a[212:215], v[180:183]
ds_read_b32 a43, v60
v_perm_b32 v59, v81, v19, s54
v_mfma_f32_16x16x32_bf16 v[184:187], a[244:247], a[216:219], v[184:187]
ds_read_b32 a44, v59
v_perm_b32 v58, v81, v19, s55
v_mfma_f32_16x16x32_bf16 v[188:191], a[244:247], a[220:223], v[188:191]
s_waitcnt lgkmcnt(4)
ds_read_b32 a45, v58
v_mfma_f32_16x16x32_bf16 v[192:195], a[248:251], a[160:163], v[192:195]
ds_read_b128 a[224:227], v14 offset:20480
v_perm_b32 v57, v85, v19, s54
v_mfma_f32_16x16x32_bf16 v[196:199], a[248:251], a[164:167], v[196:199]
ds_read_b32 a46, v57
v_perm_b32 v56, v85, v19, s55
v_mfma_f32_16x16x32_bf16 v[200:203], a[248:251], a[168:171], v[200:203]
ds_read_b32 a47, v56
v_mfma_f32_16x16x32_bf16 v[204:207], a[248:251], a[172:175], v[204:207]
s_waitcnt lgkmcnt(4)
v_mfma_f32_16x16x32_bf16 v[208:211], a[252:255], a[160:163], v[208:211]
ds_read_b128 a[228:231], v14 offset:22528
v_mfma_f32_16x16x32_bf16 v[212:215], a[252:255], a[164:167], v[212:215]
v_mfma_f32_16x16x32_bf16 v[216:219], a[252:255], a[168:171], v[216:219]
v_mfma_f32_16x16x32_bf16 v[220:223], a[252:255], a[172:175], v[220:223]
s_waitcnt vmcnt(3) lgkmcnt(1)
v_cmp_ne_u64 s[50:51], s[88:89], v[90:91]
v_cmp_ne_u64 s[44:45], s[88:89], v[94:95]
v_mfma_f32_16x16x32_bf16 v[128:131], a[224:227], a[32:35], v[128:131]
ds_read_b128 a[232:235], v15 offset:4096
v_mfma_f32_16x16x32_bf16 v[132:135], a[224:227], a[36:39], v[132:135]
s_or_b64 s[50:51], s[44:45], s[50:51]
v_mfma_f32_16x16x32_bf16 v[136:139], a[224:227], a[40:43], v[136:139]
s_cbranch_scc1 L_SLOW31
L_BACK31:
v_mfma_f32_16x16x32_bf16 v[140:143], a[224:227], a[44:47], v[140:143]
s_waitcnt lgkmcnt(1)
v_mfma_f32_16x16x32_bf16 v[144:147], a[228:231], a[32:35], v[144:147]
ds_read_b128 a[236:239], v15 offset:6144
v_mfma_f32_16x16x32_bf16 v[148:151], a[228:231], a[36:39], v[148:151]
v_perm_b32 v63, v88, v19, s52
v_mfma_f32_16x16x32_bf16 v[152:155], a[228:231], a[40:43], v[152:155]
ds_read_b32 a48, v63
v_perm_b32 v62, v88, v19, s53
v_mfma_f32_16x16x32_bf16 v[156:159], a[228:231], a[44:47], v[156:159]
s_waitcnt lgkmcnt(2)
ds_read_b32 a49, v62
v_mfma_f32_16x16x32_bf16 v[224:227], a[232:235], a[112:115], v[224:227]
ds_read_b128 a[240:243], v14 offset:24576
v_perm_b32 v61, v92, v19, s52
v_mfma_f32_16x16x32_bf16 v[228:231], a[232:235], a[116:119], v[228:231]
ds_read_b32 a50, v61
v_perm_b32 v60, v92, v19, s53
v_mfma_f32_16x16x32_bf16 v[232:235], a[232:235], a[120:123], v[232:235]
ds_read_b32 a51, v60
v_perm_b32 v59, v88, v19, s54
v_mfma_f32_16x16x32_bf16 v[236:239], a[232:235], a[124:127], v[236:239]
s_waitcnt lgkmcnt(4)
ds_read_b32 a52, v59
v_mfma_f32_16x16x32_bf16 v[240:243], a[236:239], a[112:115], v[240:243]
ds_read_b128 a[244:247], v14 offset:26624
v_perm_b32 v58, v88, v19, s55
v_mfma_f32_16x16x32_bf16 v[244:247], a[236:239], a[116:119], v[244:247]
ds_read_b32 a53, v58
v_perm_b32 v57, v92, v19, s54
v_mfma_f32_16x16x32_bf16 v[248:251], a[236:239], a[120:123], v[248:251]
ds_read_b32 a54, v57
v_perm_b32 v56, v92, v19, s55
v_mfma_f32_16x16x32_bf16 v[252:255], a[236:239], a[124:127], v[252:255]
s_waitcnt lgkmcnt(4)
ds_read_b32 a55, v56
v_mfma_f32_16x16x32_bf16 v[160:163], a[240:243], a[0:3], v[160:163]
ds_read_b128 a[248:251], v15 offset:16384
v_perm_b32 v63, v89, v19, s52
v_mfma_f32_16x16x32_bf16 v[164:167], a[240:243], a[4:7], v[164:167]
ds_read_b32 a56, v63
v_perm_b32 v62, v89, v19, s53
v_mfma_f32_16x16x32_bf16 v[168:171], a[240:243], a[8:11], v[168:171]
ds_read_b32 a57, v62
v_perm_b32 v61, v93, v19, s52
v_mfma_f32_16x16x32_bf16 v[172:175], a[240:243], a[12:15], v[172:175]
s_waitcnt lgkmcnt(4)
ds_read_b32 a58, v61
v_mfma_f32_16x16x32_bf16 v[176:179], a[244:247], a[0:3], v[176:179]
ds_read_b128 a[252:255], v15 offset:18432
v_perm_b32 v60, v93, v19, s53
v_mfma_f32_16x16x32_bf16 v[180:183], a[244:247], a[4:7], v[180:183]
ds_read_b32 a59, v60
v_perm_b32 v59, v89, v19, s54
v_mfma_f32_16x16x32_bf16 v[184:187], a[244:247], a[8:11], v[184:187]
ds_read_b32 a60, v59
v_perm_b32 v58, v89, v19, s55
v_mfma_f32_16x16x32_bf16 v[188:191], a[244:247], a[12:15], v[188:191]
s_waitcnt lgkmcnt(4)
ds_read_b32 a61, v58
v_mfma_f32_16x16x32_bf16 v[192:195], a[248:251], a[176:179], v[192:195]
ds_read_b128 a[224:227], v15 offset:20480
v_perm_b32 v57, v93, v19, s54
v_mfma_f32_16x16x32_bf16 v[196:199], a[248:251], a[180:183], v[196:199]
ds_read_b32 a62, v57
v_perm_b32 v56, v93, v19, s55
v_mfma_f32_16x16x32_bf16 v[200:203], a[248:251], a[184:187], v[200:203]
ds_read_b32 a63, v56
v_mfma_f32_16x16x32_bf16 v[204:207], a[248:251], a[188:191], v[204:207]
L_PAD5:
s_cbranch_vccnz L_PADRET
s_waitcnt lgkmcnt(4)
v_mfma_f32_16x16x32_bf16 v[208:211], a[252:255], a[176:179], v[208:211]
ds_read_b128 a[228:231], v15 offset:22528
v_mfma_f32_16x16x32_bf16 v[212:215], a[252:255], a[180:183], v[212:215]
v_mfma_f32_16x16x32_bf16 v[216:219], a[252:255], a[184:187], v[216:219]
v_mfma_f32_16x16x32_bf16 v[220:223], a[252:255], a[188:191], v[220:223]
s_waitcnt lgkmcnt(1)
v_mfma_f32_16x16x32_bf16 v[128:131], a[224:227], a[48:51], v[128:131]
ds_read_b128 a[232:235], v15 offset:24576
v_mfma_f32_16x16x32_bf16 v[132:135], a[224:227], a[52:55], v[132:135]
v_mfma_f32_16x16x32_bf16 v[136:139], a[224:227], a[56:59], v[136:139]
v_mfma_f32_16x16x32_bf16 v[140:143], a[224:227], a[60:63], v[140:143]
s_waitcnt lgkmcnt(1)
v_mfma_f32_16x16x32_bf16 v[144:147], a[228:231], a[48:51], v[144:147]
ds_read_b128 a[236:239], v15 offset:26624
v_mfma_f32_16x16x32_bf16 v[148:151], a[228:231], a[52:55], v[148:151]
v_mfma_f32_16x16x32_bf16 v[152:155], a[228:231], a[56:59], v[152:155]
v_mfma_f32_16x16x32_bf16 v[156:159], a[228:231], a[60:63], v[156:159]
s_waitcnt lgkmcnt(1)
v_mfma_f32_16x16x32_bf16 v[160:163], a[232:235], a[16:19], v[160:163]
ds_read_b128 a[240:243], v14 offset:28672
v_mfma_f32_16x16x32_bf16 v[164:167], a[232:235], a[20:23], v[164:167]
v_mfma_f32_16x16x32_bf16 v[168:171], a[232:235], a[24:27], v[168:171]
v_mfma_f32_16x16x32_bf16 v[172:175], a[232:235], a[28:31], v[172:175]
s_waitcnt lgkmcnt(1)
v_mul_f32 v128, v128, v24
v_mul_f32 v132, v132, v25
v_mfma_f32_16x16x32_bf16 v[176:179], a[236:239], a[16:19], v[176:179]
s_waitcnt vmcnt(0)
s_barrier
ds_read_b128 a[244:247], v14 offset:30720
v_mul_f32 v136, v136, v26
v_mfma_f32_16x16x32_bf16 v[180:183], a[236:239], a[20:23], v[180:183]
v_mul_f32 v140, v140, v27
v_cvt_pk_bf16_f32 v120, v128, v132
v_mfma_f32_16x16x32_bf16 v[184:187], a[236:239], a[24:27], v[184:187]
v_cvt_pk_bf16_f32 v121, v136, v140
v_mfma_f32_16x16x32_bf16 v[188:191], a[236:239], a[28:31], v[188:191]
s_waitcnt lgkmcnt(1)
v_mfma_f32_16x16x32_bf16 v[192:195], a[240:243], a[192:195], v[192:195]
ds_read_b128 a[248:251], v14 offset:32768
v_mfma_f32_16x16x32_bf16 v[196:199], a[240:243], a[196:199], v[196:199]
buffer_store_dwordx2 v[120:121], v18, s[28:31], 0 offen nt
v_mul_f32 v129, v129, v24
v_mfma_f32_16x16x32_bf16 v[200:203], a[240:243], a[200:203], v[200:203]
s_add_u32 s28, s28, 7168
v_mul_f32 v133, v133, v25
v_mul_f32 v137, v137, v26
v_mfma_f32_16x16x32_bf16 v[204:207], a[240:243], a[204:207], v[204:207]
s_waitcnt lgkmcnt(1)
v_mul_f32 v141, v141, v27
v_cvt_pk_bf16_f32 v122, v129, v133
v_mfma_f32_16x16x32_bf16 v[208:211], a[244:247], a[192:195], v[208:211]
s_addc_u32 s29, s29, 0
ds_read_b128 a[252:255], v14 offset:34816
v_cvt_pk_bf16_f32 v123, v137, v141
v_mfma_f32_16x16x32_bf16 v[212:215], a[244:247], a[196:199], v[212:215]
buffer_store_dwordx2 v[122:123], v18, s[28:31], 0 offen nt
v_mul_f32 v130, v130, v24
v_mfma_f32_16x16x32_bf16 v[216:219], a[244:247], a[200:203], v[216:219]
s_add_u32 s28, s28, 7168
v_mul_f32 v134, v134, v25
v_mul_f32 v138, v138, v26
v_mfma_f32_16x16x32_bf16 v[220:223], a[244:247], a[204:207], v[220:223]
s_waitcnt lgkmcnt(1)
v_mul_f32 v142, v142, v27
v_cvt_pk_bf16_f32 v124, v130, v134
v_mfma_f32_16x16x32_bf16 v[224:227], a[248:251], a[128:131], v[224:227]
s_addc_u32 s29, s29, 0
ds_read_b128 a[224:227], v14 offset:36864
v_cvt_pk_bf16_f32 v125, v138, v142
v_mfma_f32_16x16x32_bf16 v[228:231], a[248:251], a[132:135], v[228:231]
buffer_store_dwordx2 v[124:125], v18, s[28:31], 0 offen nt
v_mul_f32 v131, v131, v24
v_mfma_f32_16x16x32_bf16 v[232:235], a[248:251], a[136:139], v[232:235]
s_add_u32 s28, s28, 7168
v_mul_f32 v135, v135, v25
v_mul_f32 v139, v139, v26
v_mfma_f32_16x16x32_bf16 v[236:239], a[248:251], a[140:143], v[236:239]
s_waitcnt lgkmcnt(1)
v_mul_f32 v143, v143, v27
v_cvt_pk_bf16_f32 v126, v131, v135
v_mfma_f32_16x16x32_bf16 v[240:243], a[252:255], a[128:131], v[240:243]
s_addc_u32 s29, s29, 0
ds_read_b128 a[228:231], v14 offset:38912
v_cvt_pk_bf16_f32 v127, v139, v143
v_mfma_f32_16x16x32_bf16 v[244:247], a[252:255], a[132:135], v[244:247]
buffer_store_dwordx2 v[126:127], v18, s[28:31], 0 offen nt
v_mul_f32 v144, v144, v24
v_mfma_f32_16x16x32_bf16 v[248:251], a[252:255], a[136:139], v[248:251]
s_add_u32 s28, s28, 93184
v_mul_f32 v148, v148, v25
v_mul_f32 v152, v152, v26
v_mfma_f32_16x16x32_bf16 v[252:255], a[252:255], a[140:143], v[252:255]
s_waitcnt lgkmcnt(1)
v_mul_f32 v156, v156, v27
v_cvt_pk_bf16_f32 v120, v144, v148
v_mfma_f32_16x16x32_bf16 v[160:163], a[224:227], a[32:35], v[160:163]
s_addc_u32 s29, s29, 0
ds_read_b128 a[232:235], v15 offset:28672
v_cvt_pk_bf16_f32 v121, v152, v156
v_mfma_f32_16x16x32_bf16 v[164:167], a[224:227], a[36:39], v[164:167]
buffer_store_dwordx2 v[120:121], v18, s[28:31], 0 offen nt
v_mul_f32 v145, v145, v24
v_mfma_f32_16x16x32_bf16 v[168:171], a[224:227], a[40:43], v[168:171]
s_add_u32 s28, s28, 7168
v_mul_f32 v149, v149, v25
v_mul_f32 v153, v153, v26
v_mfma_f32_16x16x32_bf16 v[172:175], a[224:227], a[44:47], v[172:175]
s_waitcnt lgkmcnt(1)
v_mul_f32 v157, v157, v27
v_cvt_pk_bf16_f32 v122, v145, v149
v_mfma_f32_16x16x32_bf16 v[176:179], a[228:231], a[32:35], v[176:179]
s_addc_u32 s29, s29, 0
ds_read_b128 a[236:239], v15 offset:30720
v_cvt_pk_bf16_f32 v123, v153, v157
v_mfma_f32_16x16x32_bf16 v[180:183], a[228:231], a[36:39], v[180:183]
buffer_store_dwordx2 v[122:123], v18, s[28:31], 0 offen nt
v_mul_f32 v146, v146, v24
v_mfma_f32_16x16x32_bf16 v[184:187], a[228:231], a[40:43], v[184:187]
s_add_u32 s28, s28, 7168
v_mul_f32 v150, v150, v25
v_mul_f32 v154, v154, v26
v_mfma_f32_16x16x32_bf16 v[188:191], a[228:231], a[44:47], v[188:191]
s_waitcnt lgkmcnt(1)
v_mul_f32 v158, v158, v27
v_cvt_pk_bf16_f32 v124, v146, v150
v_mfma_f32_16x16x32_bf16 v[192:195], a[232:235], a[208:211], v[192:195]
s_addc_u32 s29, s29, 0
ds_read_b128 a[240:243], v15 offset:36864
v_cvt_pk_bf16_f32 v125, v154, v158
v_mfma_f32_16x16x32_bf16 v[196:199], a[232:235], a[212:215], v[196:199]
buffer_store_dwordx2 v[124:125], v18, s[28:31], 0 offen nt
v_mul_f32 v147, v147, v24
v_mfma_f32_16x16x32_bf16 v[200:203], a[232:235], a[216:219], v[200:203]
s_add_u32 s28, s28, 7168
v_mul_f32 v151, v151, v25
v_mul_f32 v155, v155, v26
v_mfma_f32_16x16x32_bf16 v[204:207], a[232:235], a[220:223], v[204:207]
s_waitcnt lgkmcnt(1)
v_mul_f32 v159, v159, v27
v_cvt_pk_bf16_f32 v126, v147, v151
v_mfma_f32_16x16x32_bf16 v[208:211], a[236:239], a[208:211], v[208:211]
s_addc_u32 s29, s29, 0
ds_read_b128 a[244:247], v15 offset:38912
v_cvt_pk_bf16_f32 v127, v155, v159
v_mfma_f32_16x16x32_bf16 v[212:215], a[236:239], a[212:215], v[212:215]
buffer_store_dwordx2 v[126:127], v18, s[28:31], 0 offen nt
v_mfma_f32_16x16x32_bf16 v[216:219], a[236:239], a[216:219], v[216:219]
v_mfma_f32_16x16x32_bf16 v[220:223], a[236:239], a[220:223], v[220:223]
s_waitcnt lgkmcnt(1)
v_mfma_f32_16x16x32_bf16 v[160:163], a[240:243], a[48:51], v[160:163]
ds_read_b128 a[248:251], v15 offset:32768
v_mfma_f32_16x16x32_bf16 v[164:167], a[240:243], a[52:55], v[164:167]
v_mfma_f32_16x16x32_bf16 v[168:171], a[240:243], a[56:59], v[168:171]
v_mfma_f32_16x16x32_bf16 v[172:175], a[240:243], a[60:63], v[172:175]
s_waitcnt lgkmcnt(1)
v_mfma_f32_16x16x32_bf16 v[176:179], a[244:247], a[48:51], v[176:179]
ds_read_b128 a[252:255], v15 offset:34816
v_mfma_f32_16x16x32_bf16 v[180:183], a[244:247], a[52:55], v[180:183]
v_mfma_f32_16x16x32_bf16 v[184:187], a[244:247], a[56:59], v[184:187]
v_mfma_f32_16x16x32_bf16 v[188:191], a[244:247], a[60:63], v[188:191]
s_waitcnt lgkmcnt(1)
v_mfma_f32_16x16x32_bf16 v[224:227], a[248:251], a[144:147], v[224:227]
ds_read_b128 a[224:227], v14 offset:40960
v_mfma_f32_16x16x32_bf16 v[228:231], a[248:251], a[148:151], v[228:231]
v_mfma_f32_16x16x32_bf16 v[232:235], a[248:251], a[152:155], v[232:235]
v_mfma_f32_16x16x32_bf16 v[236:239], a[248:251], a[156:159], v[236:239]
s_waitcnt lgkmcnt(1)
v_mul_f32 v160, v160, v24
v_mul_f32 v164, v164, v25
v_mfma_f32_16x16x32_bf16 v[240:243], a[252:255], a[144:147], v[240:243]
s_add_u32 s28, s28, 93184
ds_read_b128 a[228:231], v14 offset:43008
v_mul_f32 v168, v168, v26
v_mfma_f32_16x16x32_bf16 v[244:247], a[252:255], a[148:151], v[244:247]
s_addc_u32 s29, s29, 0
v_mul_f32 v172, v172, v27
v_cvt_pk_bf16_f32 v120, v160, v164
v_mfma_f32_16x16x32_bf16 v[248:251], a[252:255], a[152:155], v[248:251]
v_cvt_pk_bf16_f32 v121, v168, v172
v_mfma_f32_16x16x32_bf16 v[252:255], a[252:255], a[156:159], v[252:255]
s_waitcnt lgkmcnt(1)
v_mfma_f32_16x16x32_bf16 v[192:195], a[224:227], a[0:3], v[192:195]
ds_read_b128 a[232:235], v15 offset:40960
v_mfma_f32_16x16x32_bf16 v[196:199], a[224:227], a[4:7], v[196:199]
buffer_store_dwordx2 v[120:121], v18, s[28:31], 0 offen nt
v_mul_f32 v161, v161, v24
v_mfma_f32_16x16x32_bf16 v[200:203], a[224:227], a[8:11], v[200:203]
s_add_u32 s28, s28, 7168
v_mul_f32 v165, v165, v25
v_mul_f32 v169, v169, v26
v_mfma_f32_16x16x32_bf16 v[204:207], a[224:227], a[12:15], v[204:207]
s_waitcnt lgkmcnt(1)
v_mul_f32 v173, v173, v27
v_cvt_pk_bf16_f32 v122, v161, v165
v_mfma_f32_16x16x32_bf16 v[208:211], a[228:231], a[0:3], v[208:211]
s_addc_u32 s29, s29, 0
ds_read_b128 a[236:239], v15 offset:43008
v_cvt_pk_bf16_f32 v123, v169, v173
v_mfma_f32_16x16x32_bf16 v[212:215], a[228:231], a[4:7], v[212:215]
buffer_store_dwordx2 v[122:123], v18, s[28:31], 0 offen nt
v_mul_f32 v162, v162, v24
v_mfma_f32_16x16x32_bf16 v[216:219], a[228:231], a[8:11], v[216:219]
s_add_u32 s28, s28, 7168
v_mul_f32 v166, v166, v25
v_mul_f32 v170, v170, v26
v_mfma_f32_16x16x32_bf16 v[220:223], a[228:231], a[12:15], v[220:223]
s_waitcnt lgkmcnt(1)
v_mul_f32 v174, v174, v27
v_cvt_pk_bf16_f32 v124, v162, v166
v_mfma_f32_16x16x32_bf16 v[192:195], a[232:235], a[16:19], v[192:195]
s_addc_u32 s29, s29, 0
ds_read_b128 a[240:243], v14 offset:45056
v_cvt_pk_bf16_f32 v125, v170, v174
v_mfma_f32_16x16x32_bf16 v[196:199], a[232:235], a[20:23], v[196:199]
buffer_store_dwordx2 v[124:125], v18, s[28:31], 0 offen nt
v_mul_f32 v163, v163, v24
v_mfma_f32_16x16x32_bf16 v[200:203], a[232:235], a[24:27], v[200:203]
s_add_u32 s28, s28, 7168
v_mul_f32 v167, v167, v25
v_mul_f32 v171, v171, v26
v_mfma_f32_16x16x32_bf16 v[204:207], a[232:235], a[28:31], v[204:207]
s_waitcnt lgkmcnt(1)
v_mul_f32 v175, v175, v27
v_cvt_pk_bf16_f32 v126, v163, v167
v_mfma_f32_16x16x32_bf16 v[208:211], a[236:239], a[16:19], v[208:211]
s_addc_u32 s29, s29, 0
ds_read_b128 a[244:247], v14 offset:47104
v_cvt_pk_bf16_f32 v127, v171, v175
v_mfma_f32_16x16x32_bf16 v[212:215], a[236:239], a[20:23], v[212:215]
buffer_store_dwordx2 v[126:127], v18, s[28:31], 0 offen nt
v_mul_f32 v176, v176, v24
v_mfma_f32_16x16x32_bf16 v[216:219], a[236:239], a[24:27], v[216:219]
s_add_u32 s28, s28, 93184
v_mul_f32 v180, v180, v25
v_mul_f32 v184, v184, v26
v_mfma_f32_16x16x32_bf16 v[220:223], a[236:239], a[28:31], v[220:223]
s_waitcnt lgkmcnt(1)
v_mul_f32 v188, v188, v27
v_cvt_pk_bf16_f32 v120, v176, v180
v_mfma_f32_16x16x32_bf16 v[224:227], a[240:243], a[160:163], v[224:227]
s_addc_u32 s29, s29, 0
ds_read_b128 a[248:251], v14 offset:49152
v_cvt_pk_bf16_f32 v121, v184, v188
v_mfma_f32_16x16x32_bf16 v[228:231], a[240:243], a[164:167], v[228:231]
buffer_store_dwordx2 v[120:121], v18, s[28:31], 0 offen nt
v_mul_f32 v177, v177, v24
v_mfma_f32_16x16x32_bf16 v[232:235], a[240:243], a[168:171], v[232:235]
s_add_u32 s28, s28, 7168
v_mul_f32 v181, v181, v25
v_mul_f32 v185, v185, v26
v_mfma_f32_16x16x32_bf16 v[236:239], a[240:243], a[172:175], v[236:239]
s_waitcnt lgkmcnt(1)
v_mul_f32 v189, v189, v27
v_cvt_pk_bf16_f32 v122, v177, v181
v_mfma_f32_16x16x32_bf16 v[240:243], a[244:247], a[160:163], v[240:243]
s_addc_u32 s29, s29, 0
ds_read_b128 a[252:255], v14 offset:51200
v_cvt_pk_bf16_f32 v123, v185, v189
v_mfma_f32_16x16x32_bf16 v[244:247], a[244:247], a[164:167], v[244:247]
buffer_store_dwordx2 v[122:123], v18, s[28:31], 0 offen nt
v_mul_f32 v178, v178, v24
v_mfma_f32_16x16x32_bf16 v[248:251], a[244:247], a[168:171], v[248:251]
s_add_u32 s28, s28, 7168
v_mul_f32 v182, v182, v25
v_mul_f32 v186, v186, v26
v_mfma_f32_16x16x32_bf16 v[252:255], a[244:247], a[172:175], v[252:255]
s_waitcnt lgkmcnt(1)
v_mul_f32 v190, v190, v27
v_cvt_pk_bf16_f32 v124, v178, v182
v_mfma_f32_16x16x32_bf16 v[192:195], a[248:251], a[32:35], v[192:195]
s_addc_u32 s29, s29, 0
ds_read_b128 a[224:227], v15 offset:45056
v_cvt_pk_bf16_f32 v125, v186, v190
v_mfma_f32_16x16x32_bf16 v[196:199], a[248:251], a[36:39], v[196:199]
buffer_store_dwordx2 v[124:125], v18, s[28:31], 0 offen nt
v_mul_f32 v179, v179, v24
v_mfma_f32_16x16x32_bf16 v[200:203], a[248:251], a[40:43], v[200:203]
s_add_u32 s28, s28, 7168
v_mul_f32 v183, v183, v25
v_mul_f32 v187, v187, v26
v_mfma_f32_16x16x32_bf16 v[204:207], a[248:251], a[44:47], v[204:207]
s_waitcnt lgkmcnt(1)
v_mul_f32 v191, v191, v27
v_cvt_pk_bf16_f32 v126, v179, v183
v_mfma_f32_16x16x32_bf16 v[208:211], a[252:255], a[32:35], v[208:211]
s_addc_u32 s29, s29, 0
ds_read_b128 a[228:231], v15 offset:47104
v_cvt_pk_bf16_f32 v127, v187, v191
v_mfma_f32_16x16x32_bf16 v[212:215], a[252:255], a[36:39], v[212:215]
buffer_store_dwordx2 v[126:127], v18, s[28:31], 0 offen nt
v_mfma_f32_16x16x32_bf16 v[216:219], a[252:255], a[40:43], v[216:219]
v_mfma_f32_16x16x32_bf16 v[220:223], a[252:255], a[44:47], v[220:223]
s_waitcnt lgkmcnt(1)
v_mfma_f32_16x16x32_bf16 v[224:227], a[224:227], a[176:179], v[224:227]
ds_read_b128 a[232:235], v15 offset:49152
v_mfma_f32_16x16x32_bf16 v[228:231], a[224:227], a[180:183], v[228:231]
v_mfma_f32_16x16x32_bf16 v[232:235], a[224:227], a[184:187], v[232:235]
v_mfma_f32_16x16x32_bf16 v[236:239], a[224:227], a[188:191], v[236:239]
s_waitcnt lgkmcnt(1)
v_mfma_f32_16x16x32_bf16 v[240:243], a[228:231], a[176:179], v[240:243]
ds_read_b128 a[236:239], v15 offset:51200
v_mfma_f32_16x16x32_bf16 v[244:247], a[228:231], a[180:183], v[244:247]
v_mfma_f32_16x16x32_bf16 v[248:251], a[228:231], a[184:187], v[248:251]
v_mfma_f32_16x16x32_bf16 v[252:255], a[228:231], a[188:191], v[252:255]
s_waitcnt lgkmcnt(1)
v_mfma_f32_16x16x32_bf16 v[192:195], a[232:235], a[48:51], v[192:195]
ds_read_b128 a[240:243], v14 offset:53248
v_mfma_f32_16x16x32_bf16 v[196:199], a[232:235], a[52:55], v[196:199]
v_mfma_f32_16x16x32_bf16 v[200:203], a[232:235], a[56:59], v[200:203]
v_mfma_f32_16x16x32_bf16 v[204:207], a[232:235], a[60:63], v[204:207]
s_waitcnt lgkmcnt(1)
v_mfma_f32_16x16x32_bf16 v[208:211], a[236:239], a[48:51], v[208:211]
ds_read_b128 a[244:247], v14 offset:55296
v_mfma_f32_16x16x32_bf16 v[212:215], a[236:239], a[52:55], v[212:215]
v_mfma_f32_16x16x32_bf16 v[216:219], a[236:239], a[56:59], v[216:219]
v_mfma_f32_16x16x32_bf16 v[220:223], a[236:239], a[60:63], v[220:223]
s_waitcnt lgkmcnt(1)
v_mfma_f32_16x16x32_bf16 v[224:227], a[240:243], a[192:195], v[224:227]
ds_read_b128 a[248:251], v15 offset:53248
v_mfma_f32_16x16x32_bf16 v[228:231], a[240:243], a[196:199], v[228:231]
v_mfma_f32_16x16x32_bf16 v[232:235], a[240:243], a[200:203], v[232:235]
v_mfma_f32_16x16x32_bf16 v[236:239], a[240:243], a[204:207], v[236:239]
s_waitcnt lgkmcnt(1)
v_mul_f32 v192, v192, v24
v_mul_f32 v196, v196, v25
v_mfma_f32_16x16x32_bf16 v[240:243], a[244:247], a[192:195], v[240:243]
s_add_u32 s28, s28, 93184
ds_read_b128 a[252:255], v15 offset:55296
v_mul_f32 v200, v200, v26
v_mfma_f32_16x16x32_bf16 v[244:247], a[244:247], a[196:199], v[244:247]
s_addc_u32 s29, s29, 0
v_mul_f32 v204, v204, v27
v_cvt_pk_bf16_f32 v120, v192, v196
v_mfma_f32_16x16x32_bf16 v[248:251], a[244:247], a[200:203], v[248:251]
v_cvt_pk_bf16_f32 v121, v200, v204
v_mfma_f32_16x16x32_bf16 v[252:255], a[244:247], a[204:207], v[252:255]
s_waitcnt lgkmcnt(1)
v_mfma_f32_16x16x32_bf16 v[224:227], a[248:251], a[208:211], v[224:227]
ds_read_b128 a[224:227], v14 offset:57344
v_mfma_f32_16x16x32_bf16 v[228:231], a[248:251], a[212:215], v[228:231]
buffer_store_dwordx2 v[120:121], v18, s[28:31], 0 offen nt
v_mul_f32 v193, v193, v24
v_mfma_f32_16x16x32_bf16 v[232:235], a[248:251], a[216:219], v[232:235]
s_add_u32 s28, s28, 7168
v_mul_f32 v197, v197, v25
v_mul_f32 v201, v201, v26
v_mfma_f32_16x16x32_bf16 v[236:239], a[248:251], a[220:223], v[236:239]
s_waitcnt lgkmcnt(1)
v_mul_f32 v205, v205, v27
v_cvt_pk_bf16_f32 v122, v193, v197
v_mfma_f32_16x16x32_bf16 v[240:243], a[252:255], a[208:211], v[240:243]
s_addc_u32 s29, s29, 0
ds_read_b128 a[228:231], v14 offset:59392
v_cvt_pk_bf16_f32 v123, v201, v205
v_mfma_f32_16x16x32_bf16 v[244:247], a[252:255], a[212:215], v[244:247]
buffer_store_dwordx2 v[122:123], v18, s[28:31], 0 offen nt
v_mul_f32 v194, v194, v24
v_mfma_f32_16x16x32_bf16 v[248:251], a[252:255], a[216:219], v[248:251]
s_add_u32 s28, s28, 7168
v_mul_f32 v198, v198, v25
v_mul_f32 v202, v202, v26
v_mfma_f32_16x16x32_bf16 v[252:255], a[252:255], a[220:223], v[252:255]
s_waitcnt lgkmcnt(1)
v_mul_f32 v206, v206, v27
v_cvt_pk_bf16_f32 v124, v194, v198
v_mfma_f32_16x16x32_bf16 v[224:227], a[224:227], a[0:3], v[224:227]
s_addc_u32 s29, s29, 0
ds_read_b128 a[232:235], v15 offset:57344
v_cvt_pk_bf16_f32 v125, v202, v206
v_mfma_f32_16x16x32_bf16 v[228:231], a[224:227], a[4:7], v[228:231]
buffer_store_dwordx2 v[124:125], v18, s[28:31], 0 offen nt
v_mul_f32 v195, v195, v24
v_mfma_f32_16x16x32_bf16 v[232:235], a[224:227], a[8:11], v[232:235]
s_add_u32 s28, s28, 7168
v_mul_f32 v199, v199, v25
v_mul_f32 v203, v203, v26
v_mfma_f32_16x16x32_bf16 v[236:239], a[224:227], a[12:15], v[236:239]
s_waitcnt lgkmcnt(1)
v_mul_f32 v207, v207, v27
v_cvt_pk_bf16_f32 v126, v195, v199
v_mfma_f32_16x16x32_bf16 v[240:243], a[228:231], a[0:3], v[240:243]
s_addc_u32 s29, s29, 0
ds_read_b128 a[236:239], v15 offset:59392
v_cvt_pk_bf16_f32 v127, v203, v207
v_mfma_f32_16x16x32_bf16 v[244:247], a[228:231], a[4:7], v[244:247]
buffer_store_dwordx2 v[126:127], v18, s[28:31], 0 offen nt
v_mul_f32 v208, v208, v24
v_mfma_f32_16x16x32_bf16 v[248:251], a[228:231], a[8:11], v[248:251]
s_add_u32 s28, s28, 93184
v_mul_f32 v212, v212, v25
v_mul_f32 v216, v216, v26
v_mfma_f32_16x16x32_bf16 v[252:255], a[228:231], a[12:15], v[252:255]
s_waitcnt lgkmcnt(1)
v_mul_f32 v220, v220, v27
v_cvt_pk_bf16_f32 v120, v208, v212
v_mfma_f32_16x16x32_bf16 v[224:227], a[232:235], a[16:19], v[224:227]
s_addc_u32 s29, s29, 0
ds_read_b128 a[240:243], v14 offset:61440
v_cvt_pk_bf16_f32 v121, v216, v220
v_mfma_f32_16x16x32_bf16 v[228:231], a[232:235], a[20:23], v[228:231]
buffer_store_dwordx2 v[120:121], v18, s[28:31], 0 offen nt
v_mul_f32 v209, v209, v24
v_mfma_f32_16x16x32_bf16 v[232:235], a[232:235], a[24:27], v[232:235]
s_add_u32 s28, s28, 7168
v_mul_f32 v213, v213, v25
v_mul_f32 v217, v217, v26
v_mfma_f32_16x16x32_bf16 v[236:239], a[232:235], a[28:31], v[236:239]
s_waitcnt lgkmcnt(1)
v_mul_f32 v221, v221, v27
v_cvt_pk_bf16_f32 v122, v209, v213
v_mfma_f32_16x16x32_bf16 v[240:243], a[236:239], a[16:19], v[240:243]
s_addc_u32 s29, s29, 0
ds_read_b128 a[244:247], v14 offset:63488
v_cvt_pk_bf16_f32 v123, v217, v221
v_mfma_f32_16x16x32_bf16 v[244:247], a[236:239], a[20:23], v[244:247]
buffer_store_dwordx2 v[122:123], v18, s[28:31], 0 offen nt
v_mul_f32 v210, v210, v24
v_mfma_f32_16x16x32_bf16 v[248:251], a[236:239], a[24:27], v[248:251]
s_add_u32 s28, s28, 7168
v_mul_f32 v214, v214, v25
v_mul_f32 v218, v218, v26
v_mfma_f32_16x16x32_bf16 v[252:255], a[236:239], a[28:31], v[252:255]
s_waitcnt lgkmcnt(1)
v_mul_f32 v222, v222, v27
v_cvt_pk_bf16_f32 v124, v210, v214
v_mfma_f32_16x16x32_bf16 v[224:227], a[240:243], a[32:35], v[224:227]
s_addc_u32 s29, s29, 0
ds_read_b128 a[248:251], v15 offset:61440
v_cvt_pk_bf16_f32 v125, v218, v222
v_mfma_f32_16x16x32_bf16 v[228:231], a[240:243], a[36:39], v[228:231]
buffer_store_dwordx2 v[124:125], v18, s[28:31], 0 offen nt
v_mul_f32 v211, v211, v24
v_mfma_f32_16x16x32_bf16 v[232:235], a[240:243], a[40:43], v[232:235]
s_add_u32 s28, s28, 7168
v_mul_f32 v215, v215, v25
v_mul_f32 v219, v219, v26
v_mfma_f32_16x16x32_bf16 v[236:239], a[240:243], a[44:47], v[236:239]
s_waitcnt lgkmcnt(1)
v_mul_f32 v223, v223, v27
v_cvt_pk_bf16_f32 v126, v211, v215
v_mfma_f32_16x16x32_bf16 v[240:243], a[244:247], a[32:35], v[240:243]
s_addc_u32 s29, s29, 0
ds_read_b128 a[252:255], v15 offset:63488
v_cvt_pk_bf16_f32 v127, v219, v223
v_mfma_f32_16x16x32_bf16 v[244:247], a[244:247], a[36:39], v[244:247]
buffer_store_dwordx2 v[126:127], v18, s[28:31], 0 offen nt
v_mfma_f32_16x16x32_bf16 v[248:251], a[244:247], a[40:43], v[248:251]
v_mfma_f32_16x16x32_bf16 v[252:255], a[244:247], a[44:47], v[252:255]
s_waitcnt lgkmcnt(1)
v_mfma_f32_16x16x32_bf16 v[224:227], a[248:251], a[48:51], v[224:227]
v_mfma_f32_16x16x32_bf16 v[228:231], a[248:251], a[52:55], v[228:231]
v_mfma_f32_16x16x32_bf16 v[232:235], a[248:251], a[56:59], v[232:235]
v_mfma_f32_16x16x32_bf16 v[236:239], a[248:251], a[60:63], v[236:239]
s_waitcnt lgkmcnt(0)
v_mfma_f32_16x16x32_bf16 v[240:243], a[252:255], a[48:51], v[240:243]
v_mfma_f32_16x16x32_bf16 v[244:247], a[252:255], a[52:55], v[244:247]
v_mfma_f32_16x16x32_bf16 v[248:251], a[252:255], a[56:59], v[248:251]
v_mfma_f32_16x16x32_bf16 v[252:255], a[252:255], a[60:63], v[252:255]
s_nop 7
v_pk_mul_f32 v[224:225], v[224:225], v[24:25] op_sel:[0,0] op_sel_hi:[1,0]
v_pk_mul_f32 v[228:229], v[228:229], v[24:25] op_sel:[0,1] op_sel_hi:[1,1]
v_pk_mul_f32 v[232:233], v[232:233], v[26:27] op_sel:[0,0] op_sel_hi:[1,0]
v_pk_mul_f32 v[236:237], v[236:237], v[26:27] op_sel:[0,1] op_sel_hi:[1,1]
v_cvt_pk_bf16_f32 v120, v224, v228
v_cvt_pk_bf16_f32 v121, v232, v236
s_add_u32 s28, s28, 93184
s_addc_u32 s29, s29, 0
buffer_store_dwordx2 v[120:121], v18, s[28:31], 0 offen nt
v_cvt_pk_bf16_f32 v122, v225, v229
v_cvt_pk_bf16_f32 v123, v233, v237
s_add_u32 s28, s28, 7168
s_addc_u32 s29, s29, 0
buffer_store_dwordx2 v[122:123], v18, s[28:31], 0 offen nt
v_pk_mul_f32 v[226:227], v[226:227], v[24:25] op_sel:[0,0] op_sel_hi:[1,0]
v_pk_mul_f32 v[230:231], v[230:231], v[24:25] op_sel:[0,1] op_sel_hi:[1,1]
v_pk_mul_f32 v[234:235], v[234:235], v[26:27] op_sel:[0,0] op_sel_hi:[1,0]
v_pk_mul_f32 v[238:239], v[238:239], v[26:27] op_sel:[0,1] op_sel_hi:[1,1]
v_cvt_pk_bf16_f32 v124, v226, v230
v_cvt_pk_bf16_f32 v125, v234, v238
s_add_u32 s28, s28, 7168
s_addc_u32 s29, s29, 0
buffer_store_dwordx2 v[124:125], v18, s[28:31], 0 offen nt
v_cvt_pk_bf16_f32 v126, v227, v231
v_cvt_pk_bf16_f32 v127, v235, v239
s_add_u32 s28, s28, 7168
s_addc_u32 s29, s29, 0
buffer_store_dwordx2 v[126:127], v18, s[28:31], 0 offen nt
v_pk_mul_f32 v[240:241], v[240:241], v[24:25] op_sel:[0,0] op_sel_hi:[1,0]
v_pk_mul_f32 v[244:245], v[244:245], v[24:25] op_sel:[0,1] op_sel_hi:[1,1]
v_pk_mul_f32 v[248:249], v[248:249], v[26:27] op_sel:[0,0] op_sel_hi:[1,0]
v_pk_mul_f32 v[252:253], v[252:253], v[26:27] op_sel:[0,1] op_sel_hi:[1,1]
v_cvt_pk_bf16_f32 v120, v240, v244
v_cvt_pk_bf16_f32 v121, v248, v252
s_add_u32 s28, s28, 93184
s_addc_u32 s29, s29, 0
buffer_store_dwordx2 v[120:121], v18, s[28:31], 0 offen nt
v_cvt_pk_bf16_f32 v122, v241, v245
v_cvt_pk_bf16_f32 v123, v249, v253
s_add_u32 s28, s28, 7168
s_addc_u32 s29, s29, 0
buffer_store_dwordx2 v[122:123], v18, s[28:31], 0 offen nt
v_pk_mul_f32 v[242:243], v[242:243], v[24:25] op_sel:[0,0] op_sel_hi:[1,0]
v_pk_mul_f32 v[246:247], v[246:247], v[24:25] op_sel:[0,1] op_sel_hi:[1,1]
v_pk_mul_f32 v[250:251], v[250:251], v[26:27] op_sel:[0,0] op_sel_hi:[1,0]
v_pk_mul_f32 v[254:255], v[254:255], v[26:27] op_sel:[0,1] op_sel_hi:[1,1]
v_cvt_pk_bf16_f32 v124, v242, v246
v_cvt_pk_bf16_f32 v125, v250, v254
s_add_u32 s28, s28, 7168
s_addc_u32 s29, s29, 0
buffer_store_dwordx2 v[124:125], v18, s[28:31], 0 offen nt
v_cvt_pk_bf16_f32 v126, v243, v247
v_cvt_pk_bf16_f32 v127, v251, v255
s_add_u32 s28, s28, 7168
s_addc_u32 s29, s29, 0
buffer_store_dwordx2 v[126:127], v18, s[28:31], 0 offen nt
s_endpgm
L_NOTAG:
buffer_load_dwordx2 v[22:23], off, s[80:83], 0 sc1
s_waitcnt vmcnt(0)
v_readfirstlane_b32 s88, v22
v_readfirstlane_b32 s89, v23
s_sub_u32 s90, s90, 1
s_nop 0
s_cmp_eq_u64 s[88:89], 0
s_cbranch_scc0 L_TAGOK
s_cmp_gt_i32 s90, 0
s_cbranch_scc1 L_NOTAG
s_mov_b32 s26, 0
s_mov_b32 s78, 0
s_mov_b64 s[88:89], 1
s_branch L_TAGOK
L_SLOW2:
s_lshr_b32 s47, s41, 6
s_add_u32 s47, s47, 1
s_lshl_b32 s47, s47, 11
buffer_load_dwordx4 v[40:43], v13, s[24:27], s47 offen offset:0 sc1
buffer_load_dwordx4 v[44:47], v13, s[24:27], s47 offen offset:1024 sc1
s_lshr_b32 s47, s42, 6
s_add_u32 s47, s47, 0
s_lshl_b32 s47, s47, 11
buffer_load_dwordx4 v[48:51], v13, s[24:27], s47 offen offset:0 sc1
buffer_load_dwordx4 v[52:55], v13, s[24:27], s47 offen offset:1024 sc1
s_lshr_b32 s91, s41, 6
s_add_u32 s91, s91, 0
s_call_b64 s[100:101], L_WAIT
v_mov_b64 v[32:33], v[120:121]
v_mov_b64 v[36:37], v[124:125]
s_branch L_BACK2
L_SLOW3:
s_lshr_b32 s47, s42, 6
s_add_u32 s47, s47, 0
s_lshl_b32 s47, s47, 11
buffer_load_dwordx4 v[48:51], v13, s[24:27], s47 offen offset:0 sc1
buffer_load_dwordx4 v[52:55], v13, s[24:27], s47 offen offset:1024 sc1
s_lshr_b32 s47, s42, 6
s_add_u32 s47, s47, 1
s_lshl_b32 s47, s47, 11
buffer_load_dwordx4 v[96:99], v13, s[24:27], s47 offen offset:0 sc1
buffer_load_dwordx4 v[100:103], v13, s[24:27], s47 offen offset:1024 sc1
s_lshr_b32 s91, s41, 6
s_add_u32 s91, s91, 1
s_call_b64 s[100:101], L_WAIT
v_mov_b64 v[40:41], v[120:121]
v_mov_b64 v[44:45], v[124:125]
s_branch L_BACK3
L_SLOW4:
s_lshr_b32 s47, s42, 6
s_add_u32 s47, s47, 1
s_lshl_b32 s47, s47, 11
buffer_load_dwordx4 v[96:99], v13, s[24:27], s47 offen offset:0 sc1
buffer_load_dwordx4 v[100:103], v13, s[24:27], s47 offen offset:1024 sc1
s_lshr_b32 s47, s43, 6
s_add_u32 s47, s47, 0
s_lshl_b32 s47, s47, 11
buffer_load_dwordx4 v[80:83], v13, s[24:27], s47 offen offset:0 sc1
buffer_load_dwordx4 v[84:87], v13, s[24:27], s47 offen offset:1024 sc1
s_lshr_b32 s91, s42, 6
s_add_u32 s91, s91, 0
s_call_b64 s[100:101], L_WAIT
v_mov_b64 v[48:49], v[120:121]
v_mov_b64 v[52:53], v[124:125]
s_branch L_BACK4
L_SLOW5:
s_lshr_b32 s47, s43, 6
s_add_u32 s47, s47, 0
s_lshl_b32 s47, s47, 11
buffer_load_dwordx4 v[80:83], v13, s[24:27], s47 offen offset:0 sc1
buffer_load_dwordx4 v[84:87], v13, s[24:27], s47 offen offset:1024 sc1
s_lshr_b32 s47, s43, 6
s_add_u32 s47, s47, 1
s_lshl_b32 s47, s47, 11
buffer_load_dwordx4 v[88:91], v13, s[24:27], s47 offen offset:0 sc1
buffer_load_dwordx4 v[92:95], v13, s[24:27], s47 offen offset:1024 sc1
s_lshr_b32 s91, s42, 6
s_add_u32 s91, s91, 1
s_call_b64 s[100:101], L_WAIT
v_mov_b64 v[96:97], v[120:121]
v_mov_b64 v[100:101], v[124:125]
s_branch L_BACK5
L_SLOW6:
s_lshr_b32 s47, s43, 6
s_add_u32 s47, s47, 1
s_lshl_b32 s47, s47, 11
buffer_load_dwordx4 v[88:91], v13, s[24:27], s47 offen offset:0 sc1
buffer_load_dwordx4 v[92:95], v13, s[24:27], s47 offen offset:1024 sc1
s_movk_i32 s47, 8
s_lshl_b32 s47, s47, 11
buffer_load_dwordx4 v[32:35], v13, s[24:27], s47 offen offset:0 sc1
buffer_load_dwordx4 v[36:39], v13, s[24:27], s47 offen offset:1024 sc1
s_lshr_b32 s91, s43, 6
s_add_u32 s91, s91, 0
s_call_b64 s[100:101], L_WAIT
v_mov_b64 v[80:81], v[120:121]
v_mov_b64 v[84:85], v[124:125]
s_branch L_BACK6
L_SLOW7:
s_movk_i32 s47, 8
s_lshl_b32 s47, s47, 11
buffer_load_dwordx4 v[32:35], v13, s[24:27], s47 offen offset:0 sc1
buffer_load_dwordx4 v[36:39], v13, s[24:27], s47 offen offset:1024 sc1
s_movk_i32 s47, 9
s_lshl_b32 s47, s47, 11
buffer_load_dwordx4 v[40:43], v13, s[24:27], s47 offen offset:0 sc1
buffer_load_dwordx4 v[44:47], v13, s[24:27], s47 offen offset:1024 sc1
s_lshr_b32 s91, s43, 6
s_add_u32 s91, s91, 1
s_call_b64 s[100:101], L_WAIT
v_mov_b64 v[88:89], v[120:121]
v_mov_b64 v[92:93], v[124:125]
s_branch L_BACK7
L_SLOW8:
s_movk_i32 s47, 9
s_lshl_b32 s47, s47, 11
buffer_load_dwordx4 v[40:43], v13, s[24:27], s47 offen offset:0 sc1
buffer_load_dwordx4 v[44:47], v13, s[24:27], s47 offen offset:1024 sc1
s_movk_i32 s47, 10
s_lshl_b32 s47, s47, 11
buffer_load_dwordx4 v[48:51], v13, s[24:27], s47 offen offset:0 sc1
buffer_load_dwordx4 v[52:55], v13, s[24:27], s47 offen offset:1024 sc1
s_movk_i32 s91, 8
s_call_b64 s[100:101], L_WAIT
v_mov_b64 v[32:33], v[120:121]
v_mov_b64 v[36:37], v[124:125]
s_branch L_BACK8
L_SLOW9:
s_movk_i32 s47, 10
s_lshl_b32 s47, s47, 11
buffer_load_dwordx4 v[48:51], v13, s[24:27], s47 offen offset:0 sc1
buffer_load_dwordx4 v[52:55], v13, s[24:27], s47 offen offset:1024 sc1
s_movk_i32 s47, 11
s_lshl_b32 s47, s47, 11
buffer_load_dwordx4 v[96:99], v13, s[24:27], s47 offen offset:0 sc1
buffer_load_dwordx4 v[100:103], v13, s[24:27], s47 offen offset:1024 sc1
s_movk_i32 s91, 9
s_call_b64 s[100:101], L_WAIT
v_mov_b64 v[40:41], v[120:121]
v_mov_b64 v[44:45], v[124:125]
s_branch L_BACK9
L_SLOW10:
s_movk_i32 s47, 11
s_lshl_b32 s47, s47, 11
buffer_load_dwordx4 v[96:99], v13, s[24:27], s47 offen offset:0 sc1
buffer_load_dwordx4 v[100:103], v13, s[24:27], s47 offen offset:1024 sc1
s_movk_i32 s47, 12
s_lshl_b32 s47, s47, 11
buffer_load_dwordx4 v[80:83], v13, s[24:27], s47 offen offset:0 sc1
buffer_load_dwordx4 v[84:87], v13, s[24:27], s47 offen offset:1024 sc1
s_movk_i32 s91, 10
s_call_b64 s[100:101], L_WAIT
v_mov_b64 v[48:49], v[120:121]
v_mov_b64 v[52:53], v[124:125]
s_branch L_BACK10
L_SLOW11:
s_movk_i32 s47, 12
s_lshl_b32 s47, s47, 11
buffer_load_dwordx4 v[80:83], v13, s[24:27], s47 offen offset:0 sc1
buffer_load_dwordx4 v[84:87], v13, s[24:27], s47 offen offset:1024 sc1
s_movk_i32 s47, 13
s_lshl_b32 s47, s47, 11
buffer_load_dwordx4 v[88:91], v13, s[24:27], s47 offen offset:0 sc1
buffer_load_dwordx4 v[92:95], v13, s[24:27], s47 offen offset:1024 sc1
s_movk_i32 s91, 11
s_call_b64 s[100:101], L_WAIT
v_mov_b64 v[96:97], v[120:121]
v_mov_b64 v[100:101], v[124:125]
s_branch L_BACK11
L_SLOW12:
s_movk_i32 s47, 13
s_lshl_b32 s47, s47, 11
buffer_load_dwordx4 v[88:91], v13, s[24:27], s47 offen offset:0 sc1
buffer_load_dwordx4 v[92:95], v13, s[24:27], s47 offen offset:1024 sc1
s_movk_i32 s47, 14
s_lshl_b32 s47, s47, 11
buffer_load_dwordx4 v[32:35], v13, s[24:27], s47 offen offset:0 sc1
buffer_load_dwordx4 v[36:39], v13, s[24:27], s47 offen offset:1024 sc1
s_movk_i32 s91, 12
s_call_b64 s[100:101], L_WAIT
v_mov_b64 v[80:81], v[120:121]
v_mov_b64 v[84:85], v[124:125]
s_branch L_BACK12
L_SLOW13:
s_movk_i32 s47, 14
s_lshl_b32 s47, s47, 11
buffer_load_dwordx4 v[32:35], v13, s[24:27], s47 offen offset:0 sc1
buffer_load_dwordx4 v[36:39], v13, s[24:27], s47 offen offset:1024 sc1
s_movk_i32 s47, 15
s_lshl_b32 s47, s47, 11
buffer_load_dwordx4 v[40:43], v13, s[24:27], s47 offen offset:0 sc1
buffer_load_dwordx4 v[44:47], v13, s[24:27], s47 offen offset:1024 sc1
s_movk_i32 s91, 13
s_call_b64 s[100:101], L_WAIT
v_mov_b64 v[88:89], v[120:121]
v_mov_b64 v[92:93], v[124:125]
s_branch L_BACK13
L_SLOW14:
s_movk_i32 s47, 15
s_lshl_b32 s47, s47, 11
buffer_load_dwordx4 v[40:43], v13, s[24:27], s47 offen offset:0 sc1
buffer_load_dwordx4 v[44:47], v13, s[24:27], s47 offen offset:1024 sc1
s_movk_i32 s47, 16
s_lshl_b32 s47, s47, 11
buffer_load_dwordx4 v[48:51], v13, s[24:27], s47 offen offset:0 sc1
buffer_load_dwordx4 v[52:55], v13, s[24:27], s47 offen offset:1024 sc1
s_movk_i32 s91, 14
s_call_b64 s[100:101], L_WAIT
v_mov_b64 v[32:33], v[120:121]
v_mov_b64 v[36:37], v[124:125]
s_branch L_BACK14
L_SLOW15:
s_movk_i32 s47, 16
s_lshl_b32 s47, s47, 11
buffer_load_dwordx4 v[48:51], v13, s[24:27], s47 offen offset:0 sc1
buffer_load_dwordx4 v[52:55], v13, s[24:27], s47 offen offset:1024 sc1
s_movk_i32 s47, 17
s_lshl_b32 s47, s47, 11
buffer_load_dwordx4 v[96:99], v13, s[24:27], s47 offen offset:0 sc1
buffer_load_dwordx4 v[100:103], v13, s[24:27], s47 offen offset:1024 sc1
s_movk_i32 s91, 15
s_call_b64 s[100:101], L_WAIT
v_mov_b64 v[40:41], v[120:121]
v_mov_b64 v[44:45], v[124:125]
s_branch L_BACK15
L_SLOW16:
s_movk_i32 s47, 17
s_lshl_b32 s47, s47, 11
buffer_load_dwordx4 v[96:99], v13, s[24:27], s47 offen offset:0 sc1
buffer_load_dwordx4 v[100:103], v13, s[24:27], s47 offen offset:1024 sc1
s_movk_i32 s47, 18
s_lshl_b32 s47, s47, 11
buffer_load_dwordx4 v[80:83], v13, s[24:27], s47 offen offset:0 sc1
buffer_load_dwordx4 v[84:87], v13, s[24:27], s47 offen offset:1024 sc1
s_movk_i32 s91, 16
s_call_b64 s[100:101], L_WAIT
v_mov_b64 v[48:49], v[120:121]
v_mov_b64 v[52:53], v[124:125]
s_branch L_BACK16
L_SLOW17:
s_movk_i32 s47, 18
s_lshl_b32 s47, s47, 11
buffer_load_dwordx4 v[80:83], v13, s[24:27], s47 offen offset:0 sc1
buffer_load_dwordx4 v[84:87], v13, s[24:27], s47 offen offset:1024 sc1
s_movk_i32 s47, 19
s_lshl_b32 s47, s47, 11
buffer_load_dwordx4 v[88:91], v13, s[24:27], s47 offen offset:0 sc1
buffer_load_dwordx4 v[92:95], v13, s[24:27], s47 offen offset:1024 sc1
s_movk_i32 s91, 17
s_call_b64 s[100:101], L_WAIT
v_mov_b64 v[96:97], v[120:121]
v_mov_b64 v[100:101], v[124:125]
s_branch L_BACK17
L_SLOW18:
s_movk_i32 s47, 19
s_lshl_b32 s47, s47, 11
buffer_load_dwordx4 v[88:91], v13, s[24:27], s47 offen offset:0 sc1
buffer_load_dwordx4 v[92:95], v13, s[24:27], s47 offen offset:1024 sc1
s_movk_i32 s47, 20
s_lshl_b32 s47, s47, 11
buffer_load_dwordx4 v[32:35], v13, s[24:27], s47 offen offset:0 sc1
buffer_load_dwordx4 v[36:39], v13, s[24:27], s47 offen offset:1024 sc1
s_movk_i32 s91, 18
s_call_b64 s[100:101], L_WAIT
v_mov_b64 v[80:81], v[120:121]
v_mov_b64 v[84:85], v[124:125]
s_branch L_BACK18
L_SLOW19:
s_movk_i32 s47, 20
s_lshl_b32 s47, s47, 11
buffer_load_dwordx4 v[32:35], v13, s[24:27], s47 offen offset:0 sc1
buffer_load_dwordx4 v[36:39], v13, s[24:27], s47 offen offset:1024 sc1
s_movk_i32 s47, 21
s_lshl_b32 s47, s47, 11
buffer_load_dwordx4 v[40:43], v13, s[24:27], s47 offen offset:0 sc1
buffer_load_dwordx4 v[44:47], v13, s[24:27], s47 offen offset:1024 sc1
s_movk_i32 s91, 19
s_call_b64 s[100:101], L_WAIT
v_mov_b64 v[88:89], v[120:121]
v_mov_b64 v[92:93], v[124:125]
s_branch L_BACK19
L_SLOW20:
s_movk_i32 s47, 21
s_lshl_b32 s47, s47, 11
buffer_load_dwordx4 v[40:43], v13, s[24:27], s47 offen offset:0 sc1
buffer_load_dwordx4 v[44:47], v13, s[24:27], s47 offen offset:1024 sc1
s_movk_i32 s47, 22
s_lshl_b32 s47, s47, 11
buffer_load_dwordx4 v[48:51], v13, s[24:27], s47 offen offset:0 sc1
buffer_load_dwordx4 v[52:55], v13, s[24:27], s47 offen offset:1024 sc1
s_movk_i32 s91, 20
s_call_b64 s[100:101], L_WAIT
v_mov_b64 v[32:33], v[120:121]
v_mov_b64 v[36:37], v[124:125]
s_branch L_BACK20
L_SLOW21:
s_movk_i32 s47, 22
s_lshl_b32 s47, s47, 11
buffer_load_dwordx4 v[48:51], v13, s[24:27], s47 offen offset:0 sc1
buffer_load_dwordx4 v[52:55], v13, s[24:27], s47 offen offset:1024 sc1
s_movk_i32 s47, 23
s_lshl_b32 s47, s47, 11
buffer_load_dwordx4 v[96:99], v13, s[24:27], s47 offen offset:0 sc1
buffer_load_dwordx4 v[100:103], v13, s[24:27], s47 offen offset:1024 sc1
s_movk_i32 s91, 21
s_call_b64 s[100:101], L_WAIT
v_mov_b64 v[40:41], v[120:121]
v_mov_b64 v[44:45], v[124:125]
s_branch L_BACK21
L_SLOW22:
s_movk_i32 s47, 23
s_lshl_b32 s47, s47, 11
buffer_load_dwordx4 v[96:99], v13, s[24:27], s47 offen offset:0 sc1
buffer_load_dwordx4 v[100:103], v13, s[24:27], s47 offen offset:1024 sc1
s_movk_i32 s47, 24
s_lshl_b32 s47, s47, 11
buffer_load_dwordx4 v[80:83], v13, s[24:27], s47 offen offset:0 sc1
buffer_load_dwordx4 v[84:87], v13, s[24:27], s47 offen offset:1024 sc1
s_movk_i32 s91, 22
s_call_b64 s[100:101], L_WAIT
v_mov_b64 v[48:49], v[120:121]
v_mov_b64 v[52:53], v[124:125]
s_branch L_BACK22
L_SLOW23:
s_movk_i32 s47, 24
s_lshl_b32 s47, s47, 11
buffer_load_dwordx4 v[80:83], v13, s[24:27], s47 offen offset:0 sc1
buffer_load_dwordx4 v[84:87], v13, s[24:27], s47 offen offset:1024 sc1
s_movk_i32 s47, 25
s_lshl_b32 s47, s47, 11
buffer_load_dwordx4 v[88:91], v13, s[24:27], s47 offen offset:0 sc1
buffer_load_dwordx4 v[92:95], v13, s[24:27], s47 offen offset:1024 sc1
s_movk_i32 s91, 23
s_call_b64 s[100:101], L_WAIT
v_mov_b64 v[96:97], v[120:121]
v_mov_b64 v[100:101], v[124:125]
s_branch L_BACK23
L_SLOW24:
s_movk_i32 s47, 25
s_lshl_b32 s47, s47, 11
buffer_load_dwordx4 v[88:91], v13, s[24:27], s47 offen offset:0 sc1
buffer_load_dwordx4 v[92:95], v13, s[24:27], s47 offen offset:1024 sc1
s_movk_i32 s47, 26
s_lshl_b32 s47, s47, 11
buffer_load_dwordx4 v[32:35], v13, s[24:27], s47 offen offset:0 sc1
buffer_load_dwordx4 v[36:39], v13, s[24:27], s47 offen offset:1024 sc1
s_movk_i32 s91, 24
s_call_b64 s[100:101], L_WAIT
v_mov_b64 v[80:81], v[120:121]
v_mov_b64 v[84:85], v[124:125]
s_branch L_BACK24
L_SLOW25:
s_movk_i32 s47, 26
s_lshl_b32 s47, s47, 11
buffer_load_dwordx4 v[32:35], v13, s[24:27], s47 offen offset:0 sc1
buffer_load_dwordx4 v[36:39], v13, s[24:27], s47 offen offset:1024 sc1
s_movk_i32 s47, 27
s_lshl_b32 s47, s47, 11
buffer_load_dwordx4 v[40:43], v13, s[24:27], s47 offen offset:0 sc1
buffer_load_dwordx4 v[44:47], v13, s[24:27], s47 offen offset:1024 sc1
s_movk_i32 s91, 25
s_call_b64 s[100:101], L_WAIT
v_mov_b64 v[88:89], v[120:121]
v_mov_b64 v[92:93], v[124:125]
s_branch L_BACK25
L_SLOW26:
s_movk_i32 s47, 27
s_lshl_b32 s47, s47, 11
buffer_load_dwordx4 v[40:43], v13, s[24:27], s47 offen offset:0 sc1
buffer_load_dwordx4 v[44:47], v13, s[24:27], s47 offen offset:1024 sc1
s_movk_i32 s47, 28
s_lshl_b32 s47, s47, 11
buffer_load_dwordx4 v[48:51], v13, s[24:27], s47 offen offset:0 sc1
buffer_load_dwordx4 v[52:55], v13, s[24:27], s47 offen offset:1024 sc1
s_movk_i32 s91, 26
s_call_b64 s[100:101], L_WAIT
v_mov_b64 v[32:33], v[120:121]
v_mov_b64 v[36:37], v[124:125]
s_branch L_BACK26
L_SLOW27:
s_movk_i32 s47, 28
s_lshl_b32 s47, s47, 11
buffer_load_dwordx4 v[48:51], v13, s[24:27], s47 offen offset:0 sc1
buffer_load_dwordx4 v[52:55], v13, s[24:27], s47 offen offset:1024 sc1
s_movk_i32 s47, 29
s_lshl_b32 s47, s47, 11
buffer_load_dwordx4 v[96:99], v13, s[24:27], s47 offen offset:0 sc1
buffer_load_dwordx4 v[100:103], v13, s[24:27], s47 offen offset:1024 sc1
s_movk_i32 s91, 27
s_call_b64 s[100:101], L_WAIT
v_mov_b64 v[40:41], v[120:121]
v_mov_b64 v[44:45], v[124:125]
s_branch L_BACK27
L_SLOW28:
s_movk_i32 s47, 29
s_lshl_b32 s47, s47, 11
buffer_load_dwordx4 v[96:99], v13, s[24:27], s47 offen offset:0 sc1
buffer_load_dwordx4 v[100:103], v13, s[24:27], s47 offen offset:1024 sc1
s_movk_i32 s47, 30
s_lshl_b32 s47, s47, 11
buffer_load_dwordx4 v[80:83], v13, s[24:27], s47 offen offset:0 sc1
buffer_load_dwordx4 v[84:87], v13, s[24:27], s47 offen offset:1024 sc1
s_movk_i32 s91, 28
s_call_b64 s[100:101], L_WAIT
v_mov_b64 v[48:49], v[120:121]
v_mov_b64 v[52:53], v[124:125]
s_branch L_BACK28
L_SLOW29:
s_movk_i32 s47, 30
s_lshl_b32 s47, s47, 11
buffer_load_dwordx4 v[80:83], v13, s[24:27], s47 offen offset:0 sc1
buffer_load_dwordx4 v[84:87], v13, s[24:27], s47 offen offset:1024 sc1
s_movk_i32 s47, 31
s_lshl_b32 s47, s47, 11
buffer_load_dwordx4 v[88:91], v13, s[24:27], s47 offen offset:0 sc1
buffer_load_dwordx4 v[92:95], v13, s[24:27], s47 offen offset:1024 sc1
s_movk_i32 s91, 29
s_call_b64 s[100:101], L_WAIT
v_mov_b64 v[96:97], v[120:121]
v_mov_b64 v[100:101], v[124:125]
s_branch L_BACK29
L_SLOW30:
s_movk_i32 s47, 31
s_lshl_b32 s47, s47, 11
buffer_load_dwordx4 v[88:91], v13, s[24:27], s47 offen offset:0 sc1
buffer_load_dwordx4 v[92:95], v13, s[24:27], s47 offen offset:1024 sc1
s_movk_i32 s91, 30
s_call_b64 s[100:101], L_WAIT
v_mov_b64 v[80:81], v[120:121]
v_mov_b64 v[84:85], v[124:125]
s_branch L_BACK30
L_SLOW31:
s_movk_i32 s91, 31
s_call_b64 s[100:101], L_WAIT
v_mov_b64 v[88:89], v[120:121]
v_mov_b64 v[92:93], v[124:125]
s_branch L_BACK31
L_WAIT:
s_lshl_b32 s47, s91, 11
buffer_load_dwordx4 v[120:123], v13, s[24:27], s47 offen offset:0 sc1
buffer_load_dwordx4 v[124:127], v13, s[24:27], s47 offen offset:1024 sc1
s_waitcnt vmcnt(0)
v_cmp_ne_u64 s[50:51], s[88:89], v[122:123]
v_cmp_ne_u64 s[44:45], s[88:89], v[126:127]
s_sub_u32 s90, s90, 1
s_nop 0
s_or_b64 s[50:51], s[44:45], s[50:51]
s_cbranch_scc0 L_WRET
s_cmp_gt_i32 s90, 0
s_cbranch_scc1 L_WAIT
s_mul_i32 s47, s91, 458752
s_lshl_b32 s46, s39, 8
s_add_u32 s47, s47, s46
s_add_u32 s84, s6, s47
s_addc_u32 s85, s7, 0
s_mov_b32 s86, 387328
s_mov_b32 s87, 0x20000
buffer_load_dwordx4 v[64:67], v30, s[84:87], 0 offen
buffer_load_dwordx4 v[68:71], v30, s[84:87], s92 offen
buffer_load_dwordx4 v[72:75], v30, s[84:87], s93 offen
buffer_load_dwordx4 v[76:79], v30, s[84:87], s94 offen
s_waitcnt vmcnt(0)
v_lshl_add_u64 v[64:65], v[68:69], 4, v[64:65]
v_lshl_add_u64 v[66:67], v[70:71], 4, v[66:67]
v_lshl_add_u64 v[72:73], v[76:77], 4, v[72:73]
v_lshl_add_u64 v[74:75], v[78:79], 4, v[74:75]
v_lshl_or_b32 v76, v72, 8, v64
v_lshl_or_b32 v77, v73, 8, v65
v_lshl_or_b32 v78, v74, 8, v66
v_lshl_or_b32 v79, v75, 8, v67
v_lshl_or_b32 v120, v77, 16, v76
v_lshl_or_b32 v121, v79, 16, v78
s_add_u32 s84, s84, 57344
s_addc_u32 s85, s85, 0
buffer_load_dwordx4 v[64:67], v30, s[84:87], 0 offen
buffer_load_dwordx4 v[68:71], v30, s[84:87], s92 offen
buffer_load_dwordx4 v[72:75], v30, s[84:87], s93 offen
buffer_load_dwordx4 v[76:79], v30, s[84:87], s94 offen
s_waitcnt vmcnt(0)
v_lshl_add_u64 v[64:65], v[68:69], 4, v[64:65]
v_lshl_add_u64 v[66:67], v[70:71], 4, v[66:67]
v_lshl_add_u64 v[72:73], v[76:77], 4, v[72:73]
v_lshl_add_u64 v[74:75], v[78:79], 4, v[74:75]
v_lshl_or_b32 v76, v72, 8, v64
v_lshl_or_b32 v77, v73, 8, v65
v_lshl_or_b32 v78, v74, 8, v66
v_lshl_or_b32 v79, v75, 8, v67
v_lshl_or_b32 v124, v77, 16, v76
v_lshl_or_b32 v125, v79, 16, v78
L_WRET:
s_setpc_b64 s[100:101]
L_END:
s_endpgm
.section .rodata,"a"
.p2align 6
.amdhsa_kernel standalone__normalfloat_lut_af4__prompt_kernel
  .amdhsa_next_free_vgpr 512
  .amdhsa_next_free_sgpr 102
  .amdhsa_accum_offset 256
  .amdhsa_group_segment_fixed_size 0
  .amdhsa_kernarg_size 56
  .amdhsa_user_sgpr_count 2
  .amdhsa_user_sgpr_kernarg_segment_ptr 1
  .amdhsa_system_sgpr_workgroup_id_x 1
.end_amdhsa_kernel
```

```asm
; @launch grid=(256,1,1) block=(256,1,1) lds=163840
.amdgcn_target "amdgcn-amd-amdhsa--gfx950"
.text
.globl standalone__normalfloat_lut_af4__prompt_kernel
.p2align 12
.p2align 8
.type standalone__normalfloat_lut_af4__prompt_kernel,@function
standalone__normalfloat_lut_af4__prompt_kernel:
s_load_dwordx4 s[4:7], s[0:1], 0
s_load_dwordx4 s[12:15], s[0:1], 40
s_load_dwordx4 s[8:11], s[0:1], 24
s_memrealtime s[56:57]
s_cmp_ge_u32 s2, 256
s_cbranch_scc1 L_END
s_getpc_b64 s[48:49]
L_PC0:
v_bfi_b32 v2, 7, v0, s2
v_lshlrev_b32 v2, 7, v2
v_min_u32 v2, L_END-L_PC0, v2
global_load_dword v7, v2, s[48:49]
v_lshrrev_b32 v1, 6, v0
s_cmp_lt_u32 s2, 32
v_readfirstlane_b32 s36, v1
s_cbranch_scc1 L_PACK
s_bfe_u32 s34, s2, 0x20001
s_bfe_u32 s37, s2, 0x20003
s_lshl2_add_u32 s37, s34, s37
s_and_b32 s43, s2, 1
s_mul_i32 s43, s43, 7
s_lshr_b32 s38, s2, 5
s_add_u32 s38, s38, s43
s_lshl2_add_u32 s39, s38, s36
s_sub_u32 s39, s39, 4
v_bfe_u32 v6, v0, 4, 2
v_and_b32 v3, 15, v0
v_mul_u32_u24 v2, 114688, v6
v_lshl_add_u32 v30, v3, 4, v2
s_lshr_b32 s46, s37, 1
s_and_b32 s45, s37, 1
s_lshl3_add_u32 s46, s46, s45
s_mul_i32 s46, s46, 57344
s_lshl_b32 s47, s39, 8
s_add_u32 s44, s46, s47
s_mov_b32 s18, 387328
s_mov_b32 s19, 0x20000
s_mov_b32 s92, 14336
s_mov_b32 s93, 28672
s_mov_b32 s94, 43008
s_waitcnt lgkmcnt(0)
s_add_u32 s16, s6, s44
s_addc_u32 s17, s7, 0
buffer_load_dwordx4 v[104:107], v30, s[16:19], 0 offen
buffer_load_dwordx4 v[108:111], v30, s[16:19], s92 offen
buffer_load_dwordx4 v[112:115], v30, s[16:19], s93 offen
buffer_load_dwordx4 v[116:119], v30, s[16:19], s94 offen
s_branch L_MAIN
L_PACK:
v_lshrrev_b32 v2, 2, v0
v_and_b32 v3, 3, v0
s_lshl_b32 s45, s2, 17
v_lshl_add_u32 v2, v2, 11, s45
v_lshl_add_u32 v17, v3, 7, v2
s_mov_b32 s30, 4194304
s_mov_b32 s31, 0x20000
v_lshlrev_b32 v16, 3, v0
s_cmp_lt_u32 s2, 2
s_cselect_b32 s34, 8, 0
s_mov_b32 s35, 0x20000
v_mov_b64 v[22:23], 0
s_waitcnt lgkmcnt(0)
s_mov_b64 s[32:33], s[12:13]
v_mov_b64 v[20:21], s[56:57]
buffer_atomic_cmpswap_x2 v[20:23], v16, s[32:35], 0 offen sc1
s_mov_b64 s[28:29], s[4:5]
buffer_load_dword v19, v17, s[28:31], 0 offen offset:0
s_branch L_PACK1
L_MAIN:
s_mov_b64 s[20:21], s[4:5]
s_mov_b32 s22, 4194304
s_mov_b32 s23, 0x20000
s_lshl_b32 s46, s37, 18
v_lshrrev_b32 v5, 3, v0
v_lshl_add_u32 v2, v5, 11, s46
v_lshrrev_b32 v4, 4, v0
v_xor_b32 v4, v4, v0
v_and_b32 v4, 7, v4
v_lshl_add_u32 v8, v4, 4, v2
v_add_u32 v9, 65536, v8
v_add_u32 v10, 131072, v8
v_add_u32 v11, 196608, v8
s_lshl_b32 s33, s36, 10
s_mul_i32 s47, s45, 114688
s_sub_u32 s47, s44, s47
s_add_u32 s47, s47, 57344
s_add_u32 s84, s6, s47
s_addc_u32 s85, s7, 0
s_mov_b32 s86, 387328
s_mov_b32 s87, 0x20000
s_lshl_b32 s40, s34, 7
s_add_u32 m0, s33, 65536
s_nop 0
buffer_load_dwordx4 v8, s[20:23], s40 offen lds
s_add_u32 m0, s33, 69632
s_nop 0
buffer_load_dwordx4 v9, s[20:23], s40 offen lds
s_add_u32 m0, s33, 73728
s_nop 0
buffer_load_dwordx4 v10, s[20:23], s40 offen lds
s_add_u32 m0, s33, 77824
s_nop 0
buffer_load_dwordx4 v11, s[20:23], s40 offen lds
v_mov_b32 v2, 0x3da3bf80
s_lshl_b64 exec, exec, 8
v_mov_b32 v2, 0x3e25bf32
s_lshl_b64 exec, exec, 8
v_mov_b32 v2, 0x3e7cbf06
s_lshl_b64 exec, exec, 8
v_mov_b32 v2, 0x3eadbeca
s_lshl_b64 exec, exec, 8
v_mov_b32 v2, 0x3ee2be92
s_lshl_b64 exec, exec, 8
v_mov_b32 v2, 0x3f10be3d
s_lshl_b64 exec, exec, 8
v_mov_b32 v2, 0x3f39bdba
s_lshl_b64 exec, exec, 8
v_mov_b32 v2, 0x3f800000
s_mov_b64 exec, -1
s_and_b32 s45, s36, 1
s_mul_i32 s45, s45, 0x0202
s_lshr_b32 s46, s36, 1
s_mul_i32 s46, s46, 0x02020000
s_add_u32 s45, s45, s46
s_add_u32 s45, s45, 0x05040100
v_mov_b32 v4, s45
v_lshlrev_b32 v5, 8, v5
v_and_b32 v31, 7, v0
v_lshl_add_u32 v31, v31, 4, v5
s_mov_b32 s45, 0xbf32bf80
v_perm_b32 v128, s45, v2, v4
v_mov_b32 v129, v128
v_mov_b64 v[130:131], v[128:129]
ds_write_b128 v31, v[128:131] offset:0
s_mov_b32 s45, 0xbecabf06
v_perm_b32 v132, s45, v2, v4
v_mov_b32 v133, v132
v_mov_b64 v[134:135], v[132:133]
v_and_b32 v5, 31, v0
v_lshlrev_b32 v19, 2, v5
v_and_b32 v0, 63, v0
s_lshl_b32 s46, s39, 7
ds_write_b128 v31, v[132:135] offset:8192
s_mov_b32 s45, 0xbe3dbe92
v_perm_b32 v136, s45, v2, v4
v_mov_b32 v137, v136
v_mov_b64 v[138:139], v[136:137]
v_lshl_add_u32 v28, v3, 3, s46
s_mul_i32 s47, s37, 917504
s_add_u32 s47, s47, s46
s_add_u32 s28, s10, s47
s_addc_u32 s29, s11, 0
ds_write_b128 v31, v[136:139] offset:16384
s_mov_b32 s45, 0xbdba
v_perm_b32 v140, s45, v2, v4
v_mov_b32 v141, v140
v_mov_b64 v[142:143], v[140:141]
s_mov_b32 s30, 86144
s_mov_b32 s31, 0x20000
v_mul_u32_u24 v29, 28672, v6
v_lshl_add_u32 v18, v3, 3, v29
ds_write_b128 v31, v[140:143] offset:24576
s_mov_b32 s45, 0x3e253da3
v_perm_b32 v144, s45, v2, v4
v_mov_b32 v145, v144
v_mov_b64 v[146:147], v[144:145]
v_lshlrev_b32 v29, 7, v3
v_bfe_u32 v5, v0, 1, 3
v_xor_b32 v5, v5, v6
v_lshl_add_u32 v29, v5, 4, v29
s_load_dwordx2 s[88:89], s[12:13], 0
ds_write_b128 v31, v[144:147] offset:32768
s_mov_b32 s45, 0x3ead3e7c
v_perm_b32 v148, s45, v2, v4
v_mov_b32 v149, v148
v_mov_b64 v[150:151], v[148:149]
v_add_u32 v14, 65536, v29
v_xor_b32 v15, 64, v14
v_add_u32 v16, 0x10000, v14
v_add_u32 v17, 0x10000, v15
ds_write_b128 v31, v[148:151] offset:40960
s_mov_b32 s45, 0x3f103ee2
v_perm_b32 v152, s45, v2, v4
v_mov_b32 v153, v152
v_mov_b64 v[154:155], v[152:153]
s_mov_b32 s52, 0x0c0c0400
s_mov_b32 s53, 0x0c0c0500
s_mov_b32 s54, 0x0c0c0600
s_mov_b32 s55, 0x0c0c0700
ds_write_b128 v31, v[152:155] offset:49152
s_mov_b32 s45, 0x3f803f39
v_perm_b32 v156, s45, v2, v4
v_mov_b32 v157, v156
v_mov_b64 v[158:159], v[156:157]
v_lshlrev_b32 v13, 4, v0
s_lshl_b32 s47, s39, 16
s_add_u32 s24, s14, s47
s_addc_u32 s25, s15, 0
s_lshl_b32 s47, s37, 10
ds_write_b128 v31, v[156:159] offset:57344
s_add_u32 s76, s24, s47
s_addc_u32 s77, s25, 0
s_movk_i32 s78, 1024
s_mov_b32 s79, 0x20000
s_lshl_b32 s47, s34, 3
s_lshr_b32 s47, 0x90d0b2d, s47
s_bfe_u32 s41, s47, 0x20000
s_lshl_b32 s41, s41, 7
s_bfe_u32 s42, s47, 0x20002
s_lshl_b32 s42, s42, 7
s_bfe_u32 s43, s47, 0x20004
s_lshl_b32 s43, s43, 7
s_lshl_b32 s47, s34, 1
s_lshr_b32 s47, 0x63, s47
s_and_b32 s47, s47, 3
s_sub_u32 s47, s47, s34
s_lshl1_add_u32 s3, s47, 14
s_mul_i32 s47, s3, 458752
s_add_u32 s16, s16, s47
s_addc_u32 s17, s17, 0
s_lshl_b32 s3, s3, 11
s_lshr_b32 s35, s37, 1
s_xor_b32 s35, s35, 1
v_lshl_add_u32 v12, s41, 5, v13
s_mul_i32 s47, s35, 458752
s_lshl_b32 s46, s39, 8
s_add_u32 s47, s47, s46
s_add_u32 s72, s6, s47
s_addc_u32 s73, s7, 0
s_mov_b32 s74, 444672
s_mov_b32 s75, 0x20000
v_add_u32 v31, 57344, v30
s_and_b32 s47, s37, 2
s_lshl_b32 s47, s47, 5
v_xor_b32 v2, s47, v14
v_xor_b32 v4, 64, v2
s_mov_b32 s26, 65536
s_mov_b32 s27, 0x20000
s_mov_b64 s[80:81], s[12:13]
s_movk_i32 s82, 128
s_mov_b32 s83, 0x20000
s_movk_i32 s90, 4096
buffer_load_dwordx4 v[64:67], v30, s[84:87], 0 offen
buffer_load_dwordx4 v[68:71], v30, s[84:87], s92 offen
buffer_load_dwordx4 v[72:75], v30, s[84:87], s93 offen
buffer_load_dwordx4 v[76:79], v30, s[84:87], s94 offen
s_mov_b64 vcc, -1
s_cmp_eq_u32 s36, 0
s_cbranch_scc1 L_PAD0
s_cmp_eq_u32 s36, 1
s_cbranch_scc1 L_PAD2
s_cmp_eq_u32 s36, 2
s_cbranch_scc1 L_PAD4
s_cmp_eq_u32 s36, 3
s_cbranch_scc1 L_PADRET
L_PADRET:
s_mov_b64 vcc, 0
s_waitcnt vmcnt(8)
v_lshl_add_u64 v[104:105], v[108:109], 4, v[104:105]
v_lshl_add_u64 v[106:107], v[110:111], 4, v[106:107]
v_lshl_add_u64 v[112:113], v[116:117], 4, v[112:113]
v_lshl_add_u64 v[114:115], v[118:119], 4, v[114:115]
v_lshl_or_b32 v116, v112, 8, v104
v_lshl_or_b32 v117, v113, 8, v105
v_lshl_or_b32 v118, v114, 8, v106
v_lshl_or_b32 v119, v115, 8, v107
v_lshl_or_b32 v108, v117, 16, v116
v_lshl_or_b32 v109, v119, 16, v118
s_waitcnt lgkmcnt(0)
s_cmp_eq_u64 s[88:89], 0
s_cbranch_scc1 L_NOTAG
L_TAGOK:
v_mov_b64 v[110:111], s[88:89]
buffer_store_dwordx4 v[108:111], v13, s[76:79], 0 offen sc1
s_add_u32 s76, s76, s3
s_addc_u32 s77, s77, 0
s_waitcnt lgkmcnt(0)
s_nop 0
s_branch L_STREAM
L_PACK1:
v_and_b32 v0, 63, v0
v_lshrrev_b32 v2, 4, v0
v_and_b32 v3, 15, v0
v_mul_u32_u24 v2, 114688, v2
v_lshl_add_u32 v8, v3, 4, v2
s_movk_i32 s47, 0x3800
v_add_u32 v9, s47, v8
v_add_u32 v10, s47, v9
v_add_u32 v11, s47, v10
v_add_u32 v12, s47, v11
v_add_u32 v13, s47, v12
v_add_u32 v14, s47, v13
v_add_u32 v15, s47, v14
s_sub_u32 s3, s2, 1
s_and_b32 s3, s3, 7
s_lshr_b32 s45, s2, 3
s_lshl2_add_u32 s3, s3, s45
s_mul_i32 s40, s3, 4682
s_lshr_b32 s40, s40, 16
s_mul_i32 s41, s40, 14
s_sub_u32 s41, s3, s41
s_add_u32 s40, s40, 8
s_mov_b32 s22, 14680064
s_mov_b32 s23, 0x20000
s_mov_b64 s[20:21], s[6:7]
s_cmp_ge_u32 s40, 14
s_cselect_b32 s45, 8, 0
s_add_u32 s45, s45, s40
s_lshl2_add_u32 s42, s41, s36
s_mul_i32 s43, s45, 458752
s_lshl_b32 s44, s42, 8
s_add_u32 s43, s43, s44
s_lshl_b32 s44, s42, 5
s_add_u32 s44, s44, s45
s_lshl_b32 s52, s44, 11
s_cmp_lt_u32 s45, 32
s_cselect_b32 s52, s52, 0x1000000
s_cselect_b32 s22, 14680064, 0
s_add_u32 s41, s41, 4
s_add_u32 s40, s40, 2
s_cmp_ge_u32 s41, 14
s_cselect_b32 s48, 14, 0
s_addc_u32 s40, s40, 0
s_sub_u32 s41, s41, s48
s_load_dwordx2 s[50:51], s[12:13], 0
buffer_load_dwordx4 v[32:35], v8, s[20:23], s43 offen
buffer_load_dwordx4 v[36:39], v9, s[20:23], s43 offen
buffer_load_dwordx4 v[40:43], v10, s[20:23], s43 offen
buffer_load_dwordx4 v[44:47], v11, s[20:23], s43 offen
buffer_load_dwordx4 v[48:51], v12, s[20:23], s43 offen
buffer_load_dwordx4 v[52:55], v13, s[20:23], s43 offen
buffer_load_dwordx4 v[56:59], v14, s[20:23], s43 offen
buffer_load_dwordx4 v[60:63], v15, s[20:23], s43 offen
s_mov_b64 s[24:25], s[14:15]
s_mov_b32 s26, 3670016
s_mov_b32 s27, 0x20000
s_movk_i32 s34, 128
v_mov_b32 v16, 0
v_lshlrev_b32 v18, 4, v0
s_movk_i32 s46, 4096
s_waitcnt vmcnt(4) lgkmcnt(0)
v_mov_b64 v[22:23], s[50:51]
s_nop 0
L_PKN:
v_cmp_ne_u64 vcc, 0, v[22:23]
s_sub_u32 s46, s46, 1
s_cmp_gt_i32 s46, 0
s_cbranch_vccnz L_PKGO
s_cbranch_scc0 L_END
buffer_load_dwordx2 v[22:23], v16, s[32:35], 0 offen sc1
s_waitcnt vmcnt(0)
s_branch L_PKN
L_PKGO:
s_call_b64 s[100:101], L_PK0
buffer_store_dwordx4 v[20:23], v18, s[24:27], s52 offen offset:0 sc1
s_waitcnt lgkmcnt(0)
s_call_b64 s[100:101], L_UNIT
s_mov_b32 s53, s49
buffer_load_dwordx4 v[64:67], v8, s[20:23], s43 offen
buffer_load_dwordx4 v[68:71], v9, s[20:23], s43 offen
buffer_load_dwordx4 v[72:75], v10, s[20:23], s43 offen
buffer_load_dwordx4 v[76:79], v11, s[20:23], s43 offen
s_waitcnt vmcnt(5)
s_call_b64 s[100:101], L_PK1
buffer_store_dwordx4 v[20:23], v18, s[24:27], s52 offen offset:1024 sc1
buffer_load_dwordx4 v[80:83], v12, s[20:23], s43 offen
buffer_load_dwordx4 v[84:87], v13, s[20:23], s43 offen
buffer_load_dwordx4 v[88:91], v14, s[20:23], s43 offen
buffer_load_dwordx4 v[92:95], v15, s[20:23], s43 offen
s_waitcnt vmcnt(5)
s_call_b64 s[100:101], L_PK2
buffer_store_dwordx4 v[20:23], v18, s[24:27], s53 offen offset:0 sc1
s_call_b64 s[100:101], L_UNIT
s_mov_b32 s54, s49
buffer_load_dwordx4 v[32:35], v8, s[20:23], s43 offen
buffer_load_dwordx4 v[36:39], v9, s[20:23], s43 offen
buffer_load_dwordx4 v[40:43], v10, s[20:23], s43 offen
buffer_load_dwordx4 v[44:47], v11, s[20:23], s43 offen
s_waitcnt vmcnt(5)
s_call_b64 s[100:101], L_PK3
buffer_store_dwordx4 v[20:23], v18, s[24:27], s53 offen offset:1024 sc1
buffer_load_dwordx4 v[48:51], v12, s[20:23], s43 offen
buffer_load_dwordx4 v[52:55], v13, s[20:23], s43 offen
buffer_load_dwordx4 v[56:59], v14, s[20:23], s43 offen
buffer_load_dwordx4 v[60:63], v15, s[20:23], s43 offen
s_waitcnt vmcnt(5)
s_call_b64 s[100:101], L_PK0
buffer_store_dwordx4 v[20:23], v18, s[24:27], s54 offen offset:0 sc1
s_call_b64 s[100:101], L_UNIT
s_mov_b32 s55, s49
buffer_load_dwordx4 v[64:67], v8, s[20:23], s43 offen
buffer_load_dwordx4 v[68:71], v9, s[20:23], s43 offen
buffer_load_dwordx4 v[72:75], v10, s[20:23], s43 offen
buffer_load_dwordx4 v[76:79], v11, s[20:23], s43 offen
s_waitcnt vmcnt(5)
s_call_b64 s[100:101], L_PK1
buffer_store_dwordx4 v[20:23], v18, s[24:27], s54 offen offset:1024 sc1
buffer_load_dwordx4 v[80:83], v12, s[20:23], s43 offen
buffer_load_dwordx4 v[84:87], v13, s[20:23], s43 offen
buffer_load_dwordx4 v[88:91], v14, s[20:23], s43 offen
buffer_load_dwordx4 v[92:95], v15, s[20:23], s43 offen
s_waitcnt vmcnt(5)
s_call_b64 s[100:101], L_PK2
buffer_store_dwordx4 v[20:23], v18, s[24:27], s55 offen offset:0 sc1
s_call_b64 s[100:101], L_UNIT
s_mov_b32 s52, s49
buffer_load_dwordx4 v[32:35], v8, s[20:23], s43 offen
buffer_load_dwordx4 v[36:39], v9, s[20:23], s43 offen
buffer_load_dwordx4 v[40:43], v10, s[20:23], s43 offen
buffer_load_dwordx4 v[44:47], v11, s[20:23], s43 offen
s_waitcnt vmcnt(5)
s_call_b64 s[100:101], L_PK3
buffer_store_dwordx4 v[20:23], v18, s[24:27], s55 offen offset:1024 sc1
buffer_load_dwordx4 v[48:51], v12, s[20:23], s43 offen
buffer_load_dwordx4 v[52:55], v13, s[20:23], s43 offen
buffer_load_dwordx4 v[56:59], v14, s[20:23], s43 offen
buffer_load_dwordx4 v[60:63], v15, s[20:23], s43 offen
s_waitcnt vmcnt(5)
s_call_b64 s[100:101], L_PK0
buffer_store_dwordx4 v[20:23], v18, s[24:27], s52 offen offset:0 sc1
buffer_load_dword v19, v17, s[28:31], 0 offen offset:1536
s_waitcnt vmcnt(2)
s_call_b64 s[100:101], L_PK1
buffer_store_dwordx4 v[20:23], v18, s[24:27], s52 offen offset:1024 sc1
s_call_b64 s[100:101], L_UNIT
s_mov_b32 s53, s49
buffer_load_dwordx4 v[64:67], v8, s[20:23], s43 offen
buffer_load_dwordx4 v[68:71], v9, s[20:23], s43 offen
buffer_load_dwordx4 v[72:75], v10, s[20:23], s43 offen
buffer_load_dwordx4 v[76:79], v11, s[20:23], s43 offen
buffer_load_dwordx4 v[80:83], v12, s[20:23], s43 offen
buffer_load_dwordx4 v[84:87], v13, s[20:23], s43 offen
buffer_load_dwordx4 v[88:91], v14, s[20:23], s43 offen
buffer_load_dwordx4 v[92:95], v15, s[20:23], s43 offen
s_waitcnt vmcnt(4)
s_call_b64 s[100:101], L_PK2
buffer_store_dwordx4 v[20:23], v18, s[24:27], s53 offen offset:0 sc1
s_call_b64 s[100:101], L_UNIT
s_mov_b32 s54, s49
buffer_load_dwordx4 v[32:35], v8, s[20:23], s43 offen
buffer_load_dwordx4 v[36:39], v9, s[20:23], s43 offen
buffer_load_dwordx4 v[40:43], v10, s[20:23], s43 offen
buffer_load_dwordx4 v[44:47], v11, s[20:23], s43 offen
s_waitcnt vmcnt(5)
s_call_b64 s[100:101], L_PK3
buffer_store_dwordx4 v[20:23], v18, s[24:27], s53 offen offset:1024 sc1
buffer_load_dwordx4 v[48:51], v12, s[20:23], s43 offen
buffer_load_dwordx4 v[52:55], v13, s[20:23], s43 offen
buffer_load_dwordx4 v[56:59], v14, s[20:23], s43 offen
buffer_load_dwordx4 v[60:63], v15, s[20:23], s43 offen
s_waitcnt vmcnt(5)
s_call_b64 s[100:101], L_PK0
buffer_store_dwordx4 v[20:23], v18, s[24:27], s54 offen offset:0 sc1
s_waitcnt vmcnt(1)
s_call_b64 s[100:101], L_PK1
buffer_store_dwordx4 v[20:23], v18, s[24:27], s54 offen offset:1024 sc1
s_endpgm
L_UNIT:
s_cmp_ge_u32 s40, 14
s_cselect_b32 s45, 8, 0
s_add_u32 s45, s45, s40
s_lshl2_add_u32 s42, s41, s36
s_mul_i32 s43, s45, 458752
s_lshl_b32 s44, s42, 8
s_add_u32 s43, s43, s44
s_lshl_b32 s44, s42, 5
s_add_u32 s44, s44, s45
s_lshl_b32 s49, s44, 11
s_cmp_lt_u32 s45, 32
s_cselect_b32 s49, s49, 0x1000000
s_cselect_b32 s22, 14680064, 0
s_add_u32 s41, s41, 4
s_add_u32 s40, s40, 2
s_cmp_ge_u32 s41, 14
s_cselect_b32 s48, 14, 0
s_addc_u32 s40, s40, 0
s_sub_u32 s41, s41, s48
s_setpc_b64 s[100:101]
L_PK0:
v_lshl_add_u64 v[32:33], v[36:37], 4, v[32:33]
v_lshl_add_u64 v[34:35], v[38:39], 4, v[34:35]
v_lshl_add_u64 v[40:41], v[44:45], 4, v[40:41]
v_lshl_add_u64 v[42:43], v[46:47], 4, v[42:43]
v_lshl_or_b32 v44, v40, 8, v32
v_lshl_or_b32 v45, v41, 8, v33
v_lshl_or_b32 v46, v42, 8, v34
v_lshl_or_b32 v47, v43, 8, v35
v_lshl_or_b32 v20, v45, 16, v44
v_lshl_or_b32 v21, v47, 16, v46
s_setpc_b64 s[100:101]
L_PK1:
v_lshl_add_u64 v[48:49], v[52:53], 4, v[48:49]
v_lshl_add_u64 v[50:51], v[54:55], 4, v[50:51]
v_lshl_add_u64 v[56:57], v[60:61], 4, v[56:57]
v_lshl_add_u64 v[58:59], v[62:63], 4, v[58:59]
v_lshl_or_b32 v60, v56, 8, v48
v_lshl_or_b32 v61, v57, 8, v49
v_lshl_or_b32 v62, v58, 8, v50
v_lshl_or_b32 v63, v59, 8, v51
v_lshl_or_b32 v20, v61, 16, v60
v_lshl_or_b32 v21, v63, 16, v62
s_setpc_b64 s[100:101]
L_PK2:
v_lshl_add_u64 v[64:65], v[68:69], 4, v[64:65]
v_lshl_add_u64 v[66:67], v[70:71], 4, v[66:67]
v_lshl_add_u64 v[72:73], v[76:77], 4, v[72:73]
v_lshl_add_u64 v[74:75], v[78:79], 4, v[74:75]
v_lshl_or_b32 v76, v72, 8, v64
v_lshl_or_b32 v77, v73, 8, v65
v_lshl_or_b32 v78, v74, 8, v66
v_lshl_or_b32 v79, v75, 8, v67
v_lshl_or_b32 v20, v77, 16, v76
v_lshl_or_b32 v21, v79, 16, v78
s_setpc_b64 s[100:101]
L_PK3:
v_lshl_add_u64 v[80:81], v[84:85], 4, v[80:81]
v_lshl_add_u64 v[82:83], v[86:87], 4, v[82:83]
v_lshl_add_u64 v[88:89], v[92:93], 4, v[88:89]
v_lshl_add_u64 v[90:91], v[94:95], 4, v[90:91]
v_lshl_or_b32 v92, v88, 8, v80
v_lshl_or_b32 v93, v89, 8, v81
v_lshl_or_b32 v94, v90, 8, v82
v_lshl_or_b32 v95, v91, 8, v83
v_lshl_or_b32 v20, v93, 16, v92
v_lshl_or_b32 v21, v95, 16, v94
s_setpc_b64 s[100:101]
.p2align 12
L_STREAM:
L_PAD0:
s_cbranch_vccnz L_PAD1
buffer_load_dwordx4 v[80:83], v30, s[72:75], 0 offen
buffer_load_dwordx4 v[84:87], v30, s[72:75], s92 offen
buffer_load_dwordx4 v[88:91], v30, s[72:75], s93 offen
buffer_load_dwordx4 v[92:95], v30, s[72:75], s94 offen
buffer_load_dwordx4 v[40:43], v31, s[72:75], 0 offen
buffer_load_dwordx4 v[44:47], v31, s[72:75], s92 offen
buffer_load_dwordx4 v[48:51], v31, s[72:75], s93 offen
buffer_load_dwordx4 v[52:55], v31, s[72:75], s94 offen
s_waitcnt vmcnt(13)
s_barrier
ds_read_b128 a[240:243], v2 offset:0
ds_read_b128 a[244:247], v2 offset:2048
v_lshl_add_u32 v104, v104, 8, v19
v_lshl_add_u32 v105, v105, 8, v19
v_lshl_add_u32 v106, v106, 8, v19
v_lshl_add_u32 v107, v107, 8, v19
v_lshl_add_u32 v112, v112, 8, v19
v_lshl_add_u32 v113, v113, 8, v19
v_lshl_add_u32 v114, v114, 8, v19
v_lshl_add_u32 v115, v115, 8, v19
s_waitcnt vmcnt(9)
v_lshl_add_u64 v[64:65], v[68:69], 4, v[64:65]
v_lshl_add_u64 v[66:67], v[70:71], 4, v[66:67]
v_lshl_add_u64 v[72:73], v[76:77], 4, v[72:73]
v_lshl_add_u64 v[74:75], v[78:79], 4, v[74:75]
v_lshl_add_u32 v64, v64, 8, v19
v_lshl_add_u32 v65, v65, 8, v19
v_lshl_add_u32 v66, v66, 8, v19
v_lshl_add_u32 v67, v67, 8, v19
v_lshl_add_u32 v72, v72, 8, v19
v_lshl_add_u32 v73, v73, 8, v19
v_lshl_add_u32 v74, v74, 8, v19
v_lshl_add_u32 v75, v75, 8, v19
s_bitcmp1_b32 s37, 0
s_cbranch_scc0 L_NOSWAP
v_swap_b32 v104, v64
v_swap_b32 v105, v65
v_swap_b32 v106, v66
v_swap_b32 v107, v67
v_swap_b32 v112, v72
v_swap_b32 v113, v73
v_swap_b32 v114, v74
v_swap_b32 v115, v75
L_NOSWAP:
ds_read_b32 a0, v104
ds_read_b32 a1, v112
ds_read_b32 a2, v64
ds_read_b32 a3, v72
ds_read_b32 a4, v105
ds_read_b32 a5, v113
ds_read_b32 a6, v65
ds_read_b32 a7, v73
ds_read_b32 a8, v106
ds_read_b32 a9, v114
ds_read_b32 a10, v66
ds_read_b32 a11, v74
ds_read_b32 a12, v107
ds_read_b32 a13, v115
ds_read_b32 a14, v67
ds_read_b32 a15, v75
s_waitcnt lgkmcnt(12)
v_mfma_f32_16x16x32_bf16 v[128:131], a[240:243], a[0:3], 0
s_waitcnt lgkmcnt(8)
ds_read_b128 a[248:251], v2 offset:4096
v_mfma_f32_16x16x32_bf16 v[132:135], a[240:243], a[4:7], 0
s_waitcnt lgkmcnt(5)
v_mfma_f32_16x16x32_bf16 v[136:139], a[240:243], a[8:11], 0
s_waitcnt lgkmcnt(1)
s_add_u32 m0, s33, 81920
v_mfma_f32_16x16x32_bf16 v[140:143], a[240:243], a[12:15], 0
v_mfma_f32_16x16x32_bf16 v[144:147], a[244:247], a[0:3], 0
ds_read_b128 a[252:255], v2 offset:6144
buffer_load_dwordx4 v8, s[20:23], s41 offen lds
v_mfma_f32_16x16x32_bf16 v[148:151], a[244:247], a[4:7], 0
v_mfma_f32_16x16x32_bf16 v[152:155], a[244:247], a[8:11], 0
s_add_u32 m0, s33, 86016
v_mfma_f32_16x16x32_bf16 v[156:159], a[244:247], a[12:15], 0
s_waitcnt lgkmcnt(1)
v_mfma_f32_16x16x32_bf16 v[160:163], a[248:251], a[0:3], 0
ds_read_b128 a[240:243], v2 offset:8192
buffer_load_dwordx4 v9, s[20:23], s41 offen lds
v_mfma_f32_16x16x32_bf16 v[164:167], a[248:251], a[4:7], 0
v_mfma_f32_16x16x32_bf16 v[168:171], a[248:251], a[8:11], 0
s_add_u32 m0, s33, 90112
v_mfma_f32_16x16x32_bf16 v[172:175], a[248:251], a[12:15], 0
s_waitcnt lgkmcnt(1)
v_mfma_f32_16x16x32_bf16 v[176:179], a[252:255], a[0:3], 0
ds_read_b128 a[244:247], v2 offset:10240
buffer_load_dwordx4 v10, s[20:23], s41 offen lds
v_mfma_f32_16x16x32_bf16 v[180:183], a[252:255], a[4:7], 0
v_mfma_f32_16x16x32_bf16 v[184:187], a[252:255], a[8:11], 0
s_add_u32 m0, s33, 94208
v_mfma_f32_16x16x32_bf16 v[188:191], a[252:255], a[12:15], 0
s_waitcnt lgkmcnt(1)
v_mfma_f32_16x16x32_bf16 v[192:195], a[240:243], a[0:3], 0
buffer_load_dwordx4 v11, s[20:23], s41 offen lds
v_mfma_f32_16x16x32_bf16 v[196:199], a[240:243], a[4:7], 0
v_mfma_f32_16x16x32_bf16 v[200:203], a[240:243], a[8:11], 0
v_mfma_f32_16x16x32_bf16 v[204:207], a[240:243], a[12:15], 0
s_waitcnt lgkmcnt(0)
v_mfma_f32_16x16x32_bf16 v[208:211], a[244:247], a[0:3], 0
ds_read_b128 a[248:251], v2 offset:12288
v_mfma_f32_16x16x32_bf16 v[212:215], a[244:247], a[4:7], 0
v_mfma_f32_16x16x32_bf16 v[216:219], a[244:247], a[8:11], 0
buffer_load_dwordx4 v[32:35], v12, s[24:27], 0 offen offset:0 sc1
v_mfma_f32_16x16x32_bf16 v[220:223], a[244:247], a[12:15], 0
buffer_load_dwordx4 v[36:39], v12, s[24:27], 0 offen offset:1024 sc1
s_waitcnt vmcnt(12)
ds_read_b128 a[252:255], v2 offset:14336
v_lshl_add_u64 v[80:81], v[84:85], 4, v[80:81]
v_lshl_add_u64 v[82:83], v[86:87], 4, v[82:83]
v_lshl_add_u32 v80, v80, 8, v19
v_lshl_add_u32 v81, v81, 8, v19
v_lshl_add_u32 v82, v82, 8, v19
v_lshl_add_u32 v83, v83, 8, v19
ds_read_b32 a16, v80
ds_read_b32 a20, v81
ds_read_b32 a24, v82
ds_read_b32 a28, v83
s_waitcnt vmcnt(10)
v_lshl_add_u64 v[88:89], v[92:93], 4, v[88:89]
v_lshl_add_u64 v[90:91], v[94:95], 4, v[90:91]
v_lshl_add_u32 v88, v88, 8, v19
v_lshl_add_u32 v89, v89, 8, v19
v_lshl_add_u32 v90, v90, 8, v19
v_lshl_add_u32 v91, v91, 8, v19
ds_read_b32 a17, v88
ds_read_b32 a21, v89
ds_read_b32 a25, v90
ds_read_b32 a29, v91
s_waitcnt vmcnt(8)
v_lshl_add_u64 v[40:41], v[44:45], 4, v[40:41]
v_lshl_add_u64 v[42:43], v[46:47], 4, v[42:43]
v_lshl_add_u32 v40, v40, 8, v19
v_lshl_add_u32 v41, v41, 8, v19
v_lshl_add_u32 v42, v42, 8, v19
v_lshl_add_u32 v43, v43, 8, v19
ds_read_b32 a18, v40
ds_read_b32 a22, v41
ds_read_b32 a26, v42
ds_read_b32 a30, v43
s_waitcnt vmcnt(6) lgkmcnt(13)
v_lshl_add_u64 v[48:49], v[52:53], 4, v[48:49]
v_lshl_add_u64 v[50:51], v[54:55], 4, v[50:51]
v_lshl_add_u32 v48, v48, 8, v19
v_lshl_add_u32 v49, v49, 8, v19
v_lshl_add_u32 v50, v50, 8, v19
v_lshl_add_u32 v51, v51, 8, v19
ds_read_b32 a19, v48
ds_read_b32 a23, v49
ds_read_b32 a27, v50
ds_read_b32 a31, v51
v_mfma_f32_16x16x32_bf16 v[224:227], a[248:251], a[0:3], 0
ds_read_b128 a[240:243], v4 offset:0
v_mfma_f32_16x16x32_bf16 v[228:231], a[248:251], a[4:7], 0
v_mfma_f32_16x16x32_bf16 v[232:235], a[248:251], a[8:11], 0
global_load_dwordx2 v[20:21], v28, s[8:9]
v_mfma_f32_16x16x32_bf16 v[236:239], a[248:251], a[12:15], 0
s_waitcnt lgkmcnt(5)
v_mfma_f32_16x16x32_bf16 v[240:243], a[252:255], a[0:3], 0
ds_read_b128 a[244:247], v4 offset:2048
v_mfma_f32_16x16x32_bf16 v[244:247], a[252:255], a[4:7], 0
v_mfma_f32_16x16x32_bf16 v[248:251], a[252:255], a[8:11], 0
v_mfma_f32_16x16x32_bf16 v[252:255], a[252:255], a[12:15], 0
s_waitcnt lgkmcnt(1)
v_mfma_f32_16x16x32_bf16 v[128:131], a[240:243], a[16:19], v[128:131]
ds_read_b128 a[248:251], v4 offset:4096
v_mfma_f32_16x16x32_bf16 v[132:135], a[240:243], a[20:23], v[132:135]
v_mfma_f32_16x16x32_bf16 v[136:139], a[240:243], a[24:27], v[136:139]
v_mfma_f32_16x16x32_bf16 v[140:143], a[240:243], a[28:31], v[140:143]
s_waitcnt lgkmcnt(1)
v_mfma_f32_16x16x32_bf16 v[144:147], a[244:247], a[16:19], v[144:147]
ds_read_b128 a[252:255], v4 offset:6144
v_mfma_f32_16x16x32_bf16 v[148:151], a[244:247], a[20:23], v[148:151]
v_mfma_f32_16x16x32_bf16 v[152:155], a[244:247], a[24:27], v[152:155]
v_mfma_f32_16x16x32_bf16 v[156:159], a[244:247], a[28:31], v[156:159]
s_waitcnt lgkmcnt(1)
v_mfma_f32_16x16x32_bf16 v[160:163], a[248:251], a[16:19], v[160:163]
ds_read_b128 a[240:243], v4 offset:8192
buffer_load_dwordx4 v[40:43], v12, s[24:27], 0 offen offset:2048 sc1
v_mfma_f32_16x16x32_bf16 v[164:167], a[248:251], a[20:23], v[164:167]
buffer_load_dwordx4 v[44:47], v12, s[24:27], 0 offen offset:3072 sc1
v_lshl_add_u32 v12, s42, 5, v13
v_mfma_f32_16x16x32_bf16 v[168:171], a[248:251], a[24:27], v[168:171]
v_mfma_f32_16x16x32_bf16 v[172:175], a[248:251], a[28:31], v[172:175]
s_waitcnt lgkmcnt(1)
v_mfma_f32_16x16x32_bf16 v[176:179], a[252:255], a[16:19], v[176:179]
ds_read_b128 a[244:247], v4 offset:10240
v_mfma_f32_16x16x32_bf16 v[180:183], a[252:255], a[20:23], v[180:183]
v_mfma_f32_16x16x32_bf16 v[184:187], a[252:255], a[24:27], v[184:187]
s_add_u32 m0, s33, 98304
v_mfma_f32_16x16x32_bf16 v[188:191], a[252:255], a[28:31], v[188:191]
s_waitcnt lgkmcnt(1)
v_mfma_f32_16x16x32_bf16 v[192:195], a[240:243], a[16:19], v[192:195]
buffer_load_dwordx4 v8, s[20:23], s42 offen lds
v_mfma_f32_16x16x32_bf16 v[196:199], a[240:243], a[20:23], v[196:199]
v_mfma_f32_16x16x32_bf16 v[200:203], a[240:243], a[24:27], v[200:203]
s_add_u32 m0, s33, 102400
v_mfma_f32_16x16x32_bf16 v[204:207], a[240:243], a[28:31], v[204:207]
s_waitcnt lgkmcnt(0)
v_mfma_f32_16x16x32_bf16 v[208:211], a[244:247], a[16:19], v[208:211]
s_waitcnt vmcnt(6)
s_barrier
ds_read_b128 a[248:251], v4 offset:12288
buffer_load_dwordx4 v9, s[20:23], s42 offen lds
v_mfma_f32_16x16x32_bf16 v[212:215], a[244:247], a[20:23], v[212:215]
buffer_load_dwordx4 v[48:51], v12, s[24:27], 0 offen offset:0 sc1
v_mfma_f32_16x16x32_bf16 v[216:219], a[244:247], a[24:27], v[216:219]
s_add_u32 m0, s33, 106496
buffer_load_dwordx4 v[52:55], v12, s[24:27], 0 offen offset:1024 sc1
v_mfma_f32_16x16x32_bf16 v[220:223], a[244:247], a[28:31], v[220:223]
ds_read_b128 a[252:255], v4 offset:14336
buffer_load_dwordx4 v10, s[20:23], s42 offen lds
s_waitcnt vmcnt(8)
v_cmp_ne_u64 s[50:51], s[88:89], v[34:35]
v_cmp_ne_u64 s[44:45], s[88:89], v[38:39]
s_or_b64 s[50:51], s[44:45], s[50:51]
s_cbranch_scc1 L_SLOW2
L_BACK2:
v_perm_b32 v64, v32, v19, s52
v_perm_b32 v65, v32, v19, s53
v_perm_b32 v66, v36, v19, s52
v_perm_b32 v67, v36, v19, s53
v_perm_b32 v68, v32, v19, s54
v_perm_b32 v69, v32, v19, s55
v_perm_b32 v70, v36, v19, s54
v_perm_b32 v71, v36, v19, s55
ds_read_b32 a32, v64
ds_read_b32 a33, v65
ds_read_b32 a34, v66
ds_read_b32 a35, v67
ds_read_b32 a36, v68
ds_read_b32 a37, v69
ds_read_b32 a38, v70
ds_read_b32 a39, v71
v_perm_b32 v72, v33, v19, s52
v_perm_b32 v73, v33, v19, s53
v_perm_b32 v74, v37, v19, s52
v_perm_b32 v75, v37, v19, s53
v_perm_b32 v76, v33, v19, s54
v_perm_b32 v77, v33, v19, s55
v_perm_b32 v78, v37, v19, s54
v_perm_b32 v79, v37, v19, s55
ds_read_b32 a40, v72
ds_read_b32 a41, v73
ds_read_b32 a42, v74
ds_read_b32 a43, v75
ds_read_b32 a44, v76
ds_read_b32 a45, v77
ds_read_b32 a46, v78
ds_read_b32 a47, v79
s_add_u32 m0, s33, 110592
s_waitcnt lgkmcnt(15)
v_mfma_f32_16x16x32_bf16 v[224:227], a[248:251], a[16:19], v[224:227]
ds_read_b128 a[240:243], v14 offset:16384
buffer_load_dwordx4 v11, s[20:23], s42 offen lds
v_mfma_f32_16x16x32_bf16 v[228:231], a[248:251], a[20:23], v[228:231]
v_mfma_f32_16x16x32_bf16 v[232:235], a[248:251], a[24:27], v[232:235]
s_add_u32 m0, s33, 114688
v_mfma_f32_16x16x32_bf16 v[236:239], a[248:251], a[28:31], v[236:239]
v_mfma_f32_16x16x32_bf16 v[240:243], a[252:255], a[16:19], v[240:243]
ds_read_b128 a[244:247], v14 offset:18432
buffer_load_dwordx4 v8, s[20:23], s43 offen lds
v_mfma_f32_16x16x32_bf16 v[244:247], a[252:255], a[20:23], v[244:247]
v_mfma_f32_16x16x32_bf16 v[248:251], a[252:255], a[24:27], v[248:251]
s_add_u32 m0, s33, 118784
v_mfma_f32_16x16x32_bf16 v[252:255], a[252:255], a[28:31], v[252:255]
s_waitcnt lgkmcnt(1)
v_mfma_f32_16x16x32_bf16 v[128:131], a[240:243], a[32:35], v[128:131]
ds_read_b128 a[248:251], v14 offset:20480
buffer_load_dwordx4 v9, s[20:23], s43 offen lds
v_mfma_f32_16x16x32_bf16 v[132:135], a[240:243], a[36:39], v[132:135]
v_mfma_f32_16x16x32_bf16 v[136:139], a[240:243], a[40:43], v[136:139]
v_mfma_f32_16x16x32_bf16 v[140:143], a[240:243], a[44:47], v[140:143]
s_waitcnt lgkmcnt(1)
v_mfma_f32_16x16x32_bf16 v[144:147], a[244:247], a[32:35], v[144:147]
ds_read_b128 a[252:255], v14 offset:22528
v_mfma_f32_16x16x32_bf16 v[148:151], a[244:247], a[36:39], v[148:151]
v_mfma_f32_16x16x32_bf16 v[152:155], a[244:247], a[40:43], v[152:155]
s_add_u32 m0, s33, 122880
v_mfma_f32_16x16x32_bf16 v[156:159], a[244:247], a[44:47], v[156:159]
s_waitcnt lgkmcnt(1)
v_mfma_f32_16x16x32_bf16 v[160:163], a[248:251], a[32:35], v[160:163]
ds_read_b128 a[240:243], v14 offset:24576
buffer_load_dwordx4 v10, s[20:23], s43 offen lds
v_mfma_f32_16x16x32_bf16 v[164:167], a[248:251], a[36:39], v[164:167]
buffer_load_dwordx4 v[104:107], v30, s[16:19], 0 offen
v_mfma_f32_16x16x32_bf16 v[168:171], a[248:251], a[40:43], v[168:171]
v_mfma_f32_16x16x32_bf16 v[172:175], a[248:251], a[44:47], v[172:175]
s_waitcnt lgkmcnt(1)
v_mfma_f32_16x16x32_bf16 v[176:179], a[252:255], a[32:35], v[176:179]
ds_read_b128 a[244:247], v14 offset:26624
v_mfma_f32_16x16x32_bf16 v[180:183], a[252:255], a[36:39], v[180:183]
v_mfma_f32_16x16x32_bf16 v[184:187], a[252:255], a[40:43], v[184:187]
v_mfma_f32_16x16x32_bf16 v[188:191], a[252:255], a[44:47], v[188:191]
s_waitcnt lgkmcnt(1)
v_mfma_f32_16x16x32_bf16 v[192:195], a[240:243], a[32:35], v[192:195]
buffer_load_dwordx4 v[108:111], v30, s[16:19], s92 offen
v_mfma_f32_16x16x32_bf16 v[196:199], a[240:243], a[36:39], v[196:199]
v_mfma_f32_16x16x32_bf16 v[200:203], a[240:243], a[40:43], v[200:203]
s_add_u32 m0, s33, 126976
v_mfma_f32_16x16x32_bf16 v[204:207], a[240:243], a[44:47], v[204:207]
s_waitcnt lgkmcnt(0)
v_mfma_f32_16x16x32_bf16 v[208:211], a[244:247], a[32:35], v[208:211]
ds_read_b128 a[248:251], v14 offset:28672
buffer_load_dwordx4 v11, s[20:23], s43 offen lds
v_mfma_f32_16x16x32_bf16 v[212:215], a[244:247], a[36:39], v[212:215]
v_mfma_f32_16x16x32_bf16 v[216:219], a[244:247], a[40:43], v[216:219]
buffer_load_dwordx4 v[112:115], v30, s[16:19], s93 offen
v_mfma_f32_16x16x32_bf16 v[220:223], a[244:247], a[44:47], v[220:223]
buffer_load_dwordx4 v[96:99], v12, s[24:27], 0 offen offset:2048 sc1
ds_read_b128 a[252:255], v14 offset:30720
buffer_load_dwordx4 v[100:103], v12, s[24:27], 0 offen offset:3072 sc1
s_waitcnt vmcnt(15)
v_lshl_add_u32 v12, s43, 5, v13
v_cmp_ne_u64 s[50:51], s[88:89], v[42:43]
v_cmp_ne_u64 s[44:45], s[88:89], v[46:47]
s_or_b64 s[50:51], s[44:45], s[50:51]
s_cbranch_scc1 L_SLOW3
L_BACK3:
v_perm_b32 v64, v40, v19, s52
v_perm_b32 v65, v40, v19, s53
v_perm_b32 v66, v44, v19, s52
v_perm_b32 v67, v44, v19, s53
v_perm_b32 v68, v40, v19, s54
v_perm_b32 v69, v40, v19, s55
v_perm_b32 v70, v44, v19, s54
v_perm_b32 v71, v44, v19, s55
ds_read_b32 a48, v64
ds_read_b32 a49, v65
ds_read_b32 a50, v66
ds_read_b32 a51, v67
ds_read_b32 a52, v68
ds_read_b32 a53, v69
ds_read_b32 a54, v70
ds_read_b32 a55, v71
v_perm_b32 v72, v41, v19, s52
v_perm_b32 v73, v41, v19, s53
v_perm_b32 v74, v45, v19, s52
v_perm_b32 v75, v45, v19, s53
v_perm_b32 v76, v41, v19, s54
v_perm_b32 v77, v41, v19, s55
v_perm_b32 v78, v45, v19, s54
v_perm_b32 v79, v45, v19, s55
ds_read_b32 a56, v72
ds_read_b32 a57, v73
ds_read_b32 a58, v74
ds_read_b32 a59, v75
ds_read_b32 a60, v76
ds_read_b32 a61, v77
ds_read_b32 a62, v78
ds_read_b32 a63, v79
buffer_load_dwordx4 v[80:83], v12, s[24:27], 0 offen offset:0 sc1
s_waitcnt lgkmcnt(15)
buffer_load_dwordx4 v[84:87], v12, s[24:27], 0 offen offset:1024 sc1
v_mfma_f32_16x16x32_bf16 v[224:227], a[248:251], a[32:35], v[224:227]
ds_read_b128 a[240:243], v15 offset:16384
v_lshlrev_b32 v24, 16, v20
v_mfma_f32_16x16x32_bf16 v[228:231], a[248:251], a[36:39], v[228:231]
buffer_load_dwordx4 v[116:119], v30, s[16:19], s94 offen
v_mfma_f32_16x16x32_bf16 v[232:235], a[248:251], a[40:43], v[232:235]
v_and_b32 v25, 0xffff0000, v20
v_lshlrev_b32 v26, 16, v21
v_mfma_f32_16x16x32_bf16 v[236:239], a[248:251], a[44:47], v[236:239]
v_and_b32 v27, 0xffff0000, v21
v_mfma_f32_16x16x32_bf16 v[240:243], a[252:255], a[32:35], v[240:243]
ds_read_b128 a[244:247], v15 offset:18432
v_mfma_f32_16x16x32_bf16 v[244:247], a[252:255], a[36:39], v[244:247]
v_mfma_f32_16x16x32_bf16 v[248:251], a[252:255], a[40:43], v[248:251]
v_mfma_f32_16x16x32_bf16 v[252:255], a[252:255], a[44:47], v[252:255]
s_waitcnt vmcnt(14) lgkmcnt(1)
v_cmp_ne_u64 s[50:51], s[88:89], v[50:51]
v_cmp_ne_u64 s[44:45], s[88:89], v[54:55]
v_mfma_f32_16x16x32_bf16 v[128:131], a[240:243], a[48:51], v[128:131]
ds_read_b128 a[248:251], v15 offset:20480
v_mfma_f32_16x16x32_bf16 v[132:135], a[240:243], a[52:55], v[132:135]
s_or_b64 s[50:51], s[44:45], s[50:51]
v_mfma_f32_16x16x32_bf16 v[136:139], a[240:243], a[56:59], v[136:139]
s_cbranch_scc1 L_SLOW4
L_BACK4:
v_mfma_f32_16x16x32_bf16 v[140:143], a[240:243], a[60:63], v[140:143]
s_waitcnt lgkmcnt(1)
v_mfma_f32_16x16x32_bf16 v[144:147], a[244:247], a[48:51], v[144:147]
ds_read_b128 a[252:255], v15 offset:22528
v_mfma_f32_16x16x32_bf16 v[148:151], a[244:247], a[52:55], v[148:151]
v_perm_b32 v63, v48, v19, s52
v_mfma_f32_16x16x32_bf16 v[152:155], a[244:247], a[56:59], v[152:155]
s_add_u32 m0, s33, 130560
ds_read_b32 a64, v63
v_perm_b32 v62, v48, v19, s53
v_mfma_f32_16x16x32_bf16 v[156:159], a[244:247], a[60:63], v[156:159]
s_waitcnt lgkmcnt(2)
ds_read_b32 a65, v62
v_perm_b32 v61, v52, v19, s52
v_mfma_f32_16x16x32_bf16 v[160:163], a[248:251], a[48:51], v[160:163]
ds_read_b128 a[240:243], v15 offset:24576
buffer_load_dwordx4 v8, s[20:23], 0 offen offset:512 lds
v_mfma_f32_16x16x32_bf16 v[164:167], a[248:251], a[52:55], v[164:167]
ds_read_b32 a66, v61
v_perm_b32 v60, v52, v19, s53
v_mfma_f32_16x16x32_bf16 v[168:171], a[248:251], a[56:59], v[168:171]
ds_read_b32 a67, v60
v_perm_b32 v59, v48, v19, s54
v_mfma_f32_16x16x32_bf16 v[172:175], a[248:251], a[60:63], v[172:175]
s_waitcnt lgkmcnt(4)
ds_read_b32 a68, v59
v_mfma_f32_16x16x32_bf16 v[176:179], a[252:255], a[48:51], v[176:179]
s_waitcnt vmcnt(13)
s_barrier
ds_read_b128 a[244:247], v15 offset:26624
v_perm_b32 v58, v48, v19, s55
v_mfma_f32_16x16x32_bf16 v[180:183], a[252:255], a[52:55], v[180:183]
ds_read_b32 a69, v58
v_perm_b32 v57, v52, v19, s54
v_mfma_f32_16x16x32_bf16 v[184:187], a[252:255], a[56:59], v[184:187]
ds_read_b32 a70, v57
v_perm_b32 v56, v52, v19, s55
v_mfma_f32_16x16x32_bf16 v[188:191], a[252:255], a[60:63], v[188:191]
s_waitcnt lgkmcnt(4)
ds_read_b32 a71, v56
buffer_load_dwordx4 v[88:91], v12, s[24:27], 0 offen offset:2048 sc1
v_mfma_f32_16x16x32_bf16 v[192:195], a[240:243], a[48:51], v[192:195]
ds_read_b128 a[248:251], v15 offset:28672
v_perm_b32 v63, v49, v19, s52
v_mfma_f32_16x16x32_bf16 v[196:199], a[240:243], a[52:55], v[196:199]
ds_read_b32 a72, v63
v_perm_b32 v62, v49, v19, s53
v_mfma_f32_16x16x32_bf16 v[200:203], a[240:243], a[56:59], v[200:203]
ds_read_b32 a73, v62
v_perm_b32 v61, v53, v19, s52
v_mfma_f32_16x16x32_bf16 v[204:207], a[240:243], a[60:63], v[204:207]
s_waitcnt lgkmcnt(4)
ds_read_b32 a74, v61
buffer_load_dwordx4 v[92:95], v12, s[24:27], 0 offen offset:3072 sc1
v_mfma_f32_16x16x32_bf16 v[208:211], a[244:247], a[48:51], v[208:211]
ds_read_b128 a[252:255], v15 offset:30720
v_perm_b32 v60, v53, v19, s53
v_mfma_f32_16x16x32_bf16 v[212:215], a[244:247], a[52:55], v[212:215]
ds_read_b32 a75, v60
v_perm_b32 v59, v49, v19, s54
v_mfma_f32_16x16x32_bf16 v[216:219], a[244:247], a[56:59], v[216:219]
s_add_u32 m0, s33, 134656
ds_read_b32 a76, v59
v_perm_b32 v58, v49, v19, s55
v_mfma_f32_16x16x32_bf16 v[220:223], a[244:247], a[60:63], v[220:223]
s_waitcnt lgkmcnt(4)
ds_read_b32 a77, v58
v_perm_b32 v57, v53, v19, s54
v_mfma_f32_16x16x32_bf16 v[224:227], a[248:251], a[48:51], v[224:227]
ds_read_b128 a[240:243], v14 offset:32768
buffer_load_dwordx4 v9, s[20:23], 0 offen offset:512 lds
v_mfma_f32_16x16x32_bf16 v[228:231], a[248:251], a[52:55], v[228:231]
ds_read_b32 a78, v57
v_perm_b32 v56, v53, v19, s55
v_mfma_f32_16x16x32_bf16 v[232:235], a[248:251], a[56:59], v[232:235]
ds_read_b32 a79, v56
v_add_u32 v12, 16384, v13
v_mfma_f32_16x16x32_bf16 v[236:239], a[248:251], a[60:63], v[236:239]
s_waitcnt lgkmcnt(4)
v_mfma_f32_16x16x32_bf16 v[240:243], a[252:255], a[48:51], v[240:243]
ds_read_b128 a[244:247], v14 offset:34816
v_mfma_f32_16x16x32_bf16 v[244:247], a[252:255], a[52:55], v[244:247]
v_mfma_f32_16x16x32_bf16 v[248:251], a[252:255], a[56:59], v[248:251]
v_mfma_f32_16x16x32_bf16 v[252:255], a[252:255], a[60:63], v[252:255]
s_waitcnt lgkmcnt(1)
v_mfma_f32_16x16x32_bf16 v[128:131], a[240:243], a[64:67], v[128:131]
ds_read_b128 a[248:251], v14 offset:36864
v_mfma_f32_16x16x32_bf16 v[132:135], a[240:243], a[68:71], v[132:135]
v_mfma_f32_16x16x32_bf16 v[136:139], a[240:243], a[72:75], v[136:139]
s_add_u32 m0, s33, 138752
v_mfma_f32_16x16x32_bf16 v[140:143], a[240:243], a[76:79], v[140:143]
s_waitcnt lgkmcnt(1)
v_mfma_f32_16x16x32_bf16 v[144:147], a[244:247], a[64:67], v[144:147]
ds_read_b128 a[252:255], v14 offset:38912
buffer_load_dwordx4 v10, s[20:23], 0 offen offset:512 lds
v_mfma_f32_16x16x32_bf16 v[148:151], a[244:247], a[68:71], v[148:151]
v_mfma_f32_16x16x32_bf16 v[152:155], a[244:247], a[72:75], v[152:155]
v_mfma_f32_16x16x32_bf16 v[156:159], a[244:247], a[76:79], v[156:159]
s_waitcnt lgkmcnt(1)
v_mfma_f32_16x16x32_bf16 v[160:163], a[248:251], a[64:67], v[160:163]
ds_read_b128 a[240:243], v14 offset:40960
v_mfma_f32_16x16x32_bf16 v[164:167], a[248:251], a[68:71], v[164:167]
v_mfma_f32_16x16x32_bf16 v[168:171], a[248:251], a[72:75], v[168:171]
v_mfma_f32_16x16x32_bf16 v[172:175], a[248:251], a[76:79], v[172:175]
s_waitcnt lgkmcnt(1)
v_mfma_f32_16x16x32_bf16 v[176:179], a[252:255], a[64:67], v[176:179]
ds_read_b128 a[244:247], v14 offset:43008
v_mfma_f32_16x16x32_bf16 v[180:183], a[252:255], a[68:71], v[180:183]
v_mfma_f32_16x16x32_bf16 v[184:187], a[252:255], a[72:75], v[184:187]
s_add_u32 m0, s33, 142848
buffer_load_dwordx4 v[32:35], v12, s[24:27], 0 offen offset:0 sc1
v_mfma_f32_16x16x32_bf16 v[188:191], a[252:255], a[76:79], v[188:191]
s_waitcnt lgkmcnt(1)
buffer_load_dwordx4 v[36:39], v12, s[24:27], 0 offen offset:1024 sc1
v_mfma_f32_16x16x32_bf16 v[192:195], a[240:243], a[64:67], v[192:195]
buffer_load_dwordx4 v11, s[20:23], 0 offen offset:512 lds
v_mfma_f32_16x16x32_bf16 v[196:199], a[240:243], a[68:71], v[196:199]
v_mfma_f32_16x16x32_bf16 v[200:203], a[240:243], a[72:75], v[200:203]
v_mfma_f32_16x16x32_bf16 v[204:207], a[240:243], a[76:79], v[204:207]
s_waitcnt lgkmcnt(0)
v_mfma_f32_16x16x32_bf16 v[208:211], a[244:247], a[64:67], v[208:211]
ds_read_b128 a[248:251], v14 offset:45056
v_mfma_f32_16x16x32_bf16 v[212:215], a[244:247], a[68:71], v[212:215]
v_mfma_f32_16x16x32_bf16 v[216:219], a[244:247], a[72:75], v[216:219]
v_mfma_f32_16x16x32_bf16 v[220:223], a[244:247], a[76:79], v[220:223]
ds_read_b128 a[252:255], v14 offset:47104
s_waitcnt vmcnt(11)
v_cmp_ne_u64 s[50:51], s[88:89], v[98:99]
v_cmp_ne_u64 s[44:45], s[88:89], v[102:103]
s_or_b64 s[50:51], s[44:45], s[50:51]
s_cbranch_scc1 L_SLOW5
L_BACK5:
v_perm_b32 v64, v96, v19, s52
v_perm_b32 v65, v96, v19, s53
v_perm_b32 v66, v100, v19, s52
v_perm_b32 v67, v100, v19, s53
v_perm_b32 v68, v96, v19, s54
v_perm_b32 v69, v96, v19, s55
v_perm_b32 v70, v100, v19, s54
v_perm_b32 v71, v100, v19, s55
ds_read_b32 a80, v64
ds_read_b32 a81, v65
ds_read_b32 a82, v66
ds_read_b32 a83, v67
ds_read_b32 a84, v68
ds_read_b32 a85, v69
ds_read_b32 a86, v70
ds_read_b32 a87, v71
v_perm_b32 v72, v97, v19, s52
v_perm_b32 v73, v97, v19, s53
v_perm_b32 v74, v101, v19, s52
v_perm_b32 v75, v101, v19, s53
v_perm_b32 v76, v97, v19, s54
v_perm_b32 v77, v97, v19, s55
v_perm_b32 v78, v101, v19, s54
v_perm_b32 v79, v101, v19, s55
ds_read_b32 a88, v72
ds_read_b32 a89, v73
ds_read_b32 a90, v74
ds_read_b32 a91, v75
ds_read_b32 a92, v76
ds_read_b32 a93, v77
ds_read_b32 a94, v78
ds_read_b32 a95, v79
s_waitcnt lgkmcnt(15)
v_mfma_f32_16x16x32_bf16 v[224:227], a[248:251], a[64:67], v[224:227]
ds_read_b128 a[240:243], v15 offset:32768
v_mfma_f32_16x16x32_bf16 v[228:231], a[248:251], a[68:71], v[228:231]
v_mfma_f32_16x16x32_bf16 v[232:235], a[248:251], a[72:75], v[232:235]
v_mfma_f32_16x16x32_bf16 v[236:239], a[248:251], a[76:79], v[236:239]
s_waitcnt vmcnt(9)
v_cmp_ne_u64 s[50:51], s[88:89], v[82:83]
v_cmp_ne_u64 s[44:45], s[88:89], v[86:87]
v_mfma_f32_16x16x32_bf16 v[240:243], a[252:255], a[64:67], v[240:243]
L_PAD1:
s_cbranch_vccnz L_PADRET
ds_read_b128 a[244:247], v15 offset:34816
v_mfma_f32_16x16x32_bf16 v[244:247], a[252:255], a[68:71], v[244:247]
s_or_b64 s[50:51], s[44:45], s[50:51]
v_mfma_f32_16x16x32_bf16 v[248:251], a[252:255], a[72:75], v[248:251]
s_cbranch_scc1 L_SLOW6
L_BACK6:
v_mfma_f32_16x16x32_bf16 v[252:255], a[252:255], a[76:79], v[252:255]
s_waitcnt lgkmcnt(1)
v_mfma_f32_16x16x32_bf16 v[128:131], a[240:243], a[80:83], v[128:131]
ds_read_b128 a[248:251], v15 offset:36864
v_perm_b32 v63, v80, v19, s52
v_mfma_f32_16x16x32_bf16 v[132:135], a[240:243], a[84:87], v[132:135]
ds_read_b32 a96, v63
v_perm_b32 v62, v80, v19, s53
v_mfma_f32_16x16x32_bf16 v[136:139], a[240:243], a[88:91], v[136:139]
s_add_u32 m0, s33, 146816
ds_read_b32 a97, v62
v_perm_b32 v61, v84, v19, s52
v_mfma_f32_16x16x32_bf16 v[140:143], a[240:243], a[92:95], v[140:143]
s_waitcnt lgkmcnt(3)
ds_read_b32 a98, v61
v_mfma_f32_16x16x32_bf16 v[144:147], a[244:247], a[80:83], v[144:147]
ds_read_b128 a[252:255], v15 offset:38912
buffer_load_dwordx4 v8, s[20:23], 0 offen offset:640 lds
v_mfma_f32_16x16x32_bf16 v[148:151], a[244:247], a[84:87], v[148:151]
s_waitcnt vmcnt(9)
v_perm_b32 v60, v84, v19, s53
v_lshl_add_u64 v[104:105], v[108:109], 4, v[104:105]
v_mfma_f32_16x16x32_bf16 v[152:155], a[244:247], a[88:91], v[152:155]
ds_read_b32 a99, v60
v_perm_b32 v59, v80, v19, s54
v_mfma_f32_16x16x32_bf16 v[156:159], a[244:247], a[92:95], v[156:159]
s_waitcnt lgkmcnt(3)
ds_read_b32 a100, v59
v_perm_b32 v58, v80, v19, s55
v_mfma_f32_16x16x32_bf16 v[160:163], a[248:251], a[80:83], v[160:163]
s_barrier
ds_read_b128 a[240:243], v15 offset:40960
v_lshl_add_u64 v[106:107], v[110:111], 4, v[106:107]
v_mfma_f32_16x16x32_bf16 v[164:167], a[248:251], a[84:87], v[164:167]
ds_read_b32 a101, v58
v_perm_b32 v57, v84, v19, s54
v_mfma_f32_16x16x32_bf16 v[168:171], a[248:251], a[88:91], v[168:171]
ds_read_b32 a102, v57
v_perm_b32 v56, v84, v19, s55
v_mfma_f32_16x16x32_bf16 v[172:175], a[248:251], a[92:95], v[172:175]
s_waitcnt lgkmcnt(4)
ds_read_b32 a103, v56
v_lshl_add_u64 v[112:113], v[116:117], 4, v[112:113]
v_mfma_f32_16x16x32_bf16 v[176:179], a[252:255], a[80:83], v[176:179]
ds_read_b128 a[244:247], v15 offset:43008
v_perm_b32 v63, v81, v19, s52
v_mfma_f32_16x16x32_bf16 v[180:183], a[252:255], a[84:87], v[180:183]
ds_read_b32 a104, v63
buffer_load_dwordx4 v[40:43], v12, s[24:27], 0 offen offset:2048 sc1
v_mfma_f32_16x16x32_bf16 v[184:187], a[252:255], a[88:91], v[184:187]
v_perm_b32 v62, v81, v19, s53
v_lshl_add_u64 v[114:115], v[118:119], 4, v[114:115]
v_mfma_f32_16x16x32_bf16 v[188:191], a[252:255], a[92:95], v[188:191]
s_waitcnt lgkmcnt(3)
ds_read_b32 a105, v62
buffer_load_dwordx4 v[44:47], v12, s[24:27], 0 offen offset:3072 sc1
v_mfma_f32_16x16x32_bf16 v[192:195], a[240:243], a[80:83], v[192:195]
ds_read_b128 a[248:251], v15 offset:45056
v_add_u32 v12, 20480, v13
v_mfma_f32_16x16x32_bf16 v[196:199], a[240:243], a[84:87], v[196:199]
v_perm_b32 v61, v85, v19, s52
v_lshl_or_b32 v116, v112, 8, v104
v_mfma_f32_16x16x32_bf16 v[200:203], a[240:243], a[88:91], v[200:203]
s_add_u32 m0, s33, 150912
ds_read_b32 a106, v61
v_perm_b32 v60, v85, v19, s53
v_mfma_f32_16x16x32_bf16 v[204:207], a[240:243], a[92:95], v[204:207]
s_waitcnt lgkmcnt(3)
ds_read_b32 a107, v60
v_mfma_f32_16x16x32_bf16 v[208:211], a[244:247], a[80:83], v[208:211]
ds_read_b128 a[252:255], v15 offset:47104
buffer_load_dwordx4 v9, s[20:23], 0 offen offset:640 lds
v_mfma_f32_16x16x32_bf16 v[212:215], a[244:247], a[84:87], v[212:215]
v_perm_b32 v59, v81, v19, s54
v_lshl_or_b32 v117, v113, 8, v105
v_mfma_f32_16x16x32_bf16 v[216:219], a[244:247], a[88:91], v[216:219]
ds_read_b32 a108, v59
v_perm_b32 v58, v81, v19, s55
v_mfma_f32_16x16x32_bf16 v[220:223], a[244:247], a[92:95], v[220:223]
s_waitcnt lgkmcnt(3)
ds_read_b32 a109, v58
v_perm_b32 v57, v85, v19, s54
v_mfma_f32_16x16x32_bf16 v[224:227], a[248:251], a[80:83], v[224:227]
ds_read_b128 a[240:243], v14 offset:49152
v_lshl_or_b32 v118, v114, 8, v106
v_mfma_f32_16x16x32_bf16 v[228:231], a[248:251], a[84:87], v[228:231]
ds_read_b32 a110, v57
v_perm_b32 v56, v85, v19, s55
v_mfma_f32_16x16x32_bf16 v[232:235], a[248:251], a[88:91], v[232:235]
ds_read_b32 a111, v56
v_mfma_f32_16x16x32_bf16 v[236:239], a[248:251], a[92:95], v[236:239]
s_waitcnt lgkmcnt(4)
v_lshl_or_b32 v119, v115, 8, v107
v_mfma_f32_16x16x32_bf16 v[240:243], a[252:255], a[80:83], v[240:243]
ds_read_b128 a[244:247], v14 offset:51200
v_mfma_f32_16x16x32_bf16 v[244:247], a[252:255], a[84:87], v[244:247]
v_mfma_f32_16x16x32_bf16 v[248:251], a[252:255], a[88:91], v[248:251]
s_add_u32 m0, s33, 155008
v_lshl_or_b32 v108, v117, 16, v116
v_mfma_f32_16x16x32_bf16 v[252:255], a[252:255], a[92:95], v[252:255]
s_waitcnt vmcnt(9) lgkmcnt(1)
v_cmp_ne_u64 s[50:51], s[88:89], v[90:91]
v_cmp_ne_u64 s[44:45], s[88:89], v[94:95]
v_mfma_f32_16x16x32_bf16 v[128:131], a[240:243], a[96:99], v[128:131]
ds_read_b128 a[248:251], v14 offset:53248
buffer_load_dwordx4 v10, s[20:23], 0 offen offset:640 lds
v_mfma_f32_16x16x32_bf16 v[132:135], a[240:243], a[100:103], v[132:135]
s_or_b64 s[50:51], s[44:45], s[50:51]
v_lshl_or_b32 v109, v119, 16, v118
v_mfma_f32_16x16x32_bf16 v[136:139], a[240:243], a[104:107], v[136:139]
s_cbranch_scc1 L_SLOW7
L_BACK7:
v_mfma_f32_16x16x32_bf16 v[140:143], a[240:243], a[108:111], v[140:143]
s_waitcnt lgkmcnt(1)
v_perm_b32 v63, v88, v19, s52
v_mfma_f32_16x16x32_bf16 v[144:147], a[244:247], a[96:99], v[144:147]
ds_read_b128 a[252:255], v14 offset:55296
v_mov_b64 v[110:111], s[88:89]
v_mfma_f32_16x16x32_bf16 v[148:151], a[244:247], a[100:103], v[148:151]
ds_read_b32 a112, v63
v_perm_b32 v62, v88, v19, s53
v_mfma_f32_16x16x32_bf16 v[152:155], a[244:247], a[104:107], v[152:155]
ds_read_b32 a113, v62
v_perm_b32 v61, v92, v19, s52
v_mfma_f32_16x16x32_bf16 v[156:159], a[244:247], a[108:111], v[156:159]
s_waitcnt lgkmcnt(3)
ds_read_b32 a114, v61
v_mfma_f32_16x16x32_bf16 v[160:163], a[248:251], a[96:99], v[160:163]
ds_read_b128 a[240:243], v14 offset:57344
v_perm_b32 v60, v92, v19, s53
v_mfma_f32_16x16x32_bf16 v[164:167], a[248:251], a[100:103], v[164:167]
buffer_store_dwordx4 v[108:111], v13, s[76:79], 0 offen sc1
v_mfma_f32_16x16x32_bf16 v[168:171], a[248:251], a[104:107], v[168:171]
s_add_u32 m0, s33, 159104
ds_read_b32 a115, v60
v_perm_b32 v59, v88, v19, s54
v_mfma_f32_16x16x32_bf16 v[172:175], a[248:251], a[108:111], v[172:175]
s_waitcnt lgkmcnt(3)
ds_read_b32 a116, v59
v_perm_b32 v58, v88, v19, s55
v_mfma_f32_16x16x32_bf16 v[176:179], a[252:255], a[96:99], v[176:179]
ds_read_b128 a[244:247], v14 offset:59392
buffer_load_dwordx4 v11, s[20:23], 0 offen offset:640 lds
v_mfma_f32_16x16x32_bf16 v[180:183], a[252:255], a[100:103], v[180:183]
ds_read_b32 a117, v58
v_perm_b32 v57, v92, v19, s54
v_mfma_f32_16x16x32_bf16 v[184:187], a[252:255], a[104:107], v[184:187]
ds_read_b32 a118, v57
v_perm_b32 v56, v92, v19, s55
v_mfma_f32_16x16x32_bf16 v[188:191], a[252:255], a[108:111], v[188:191]
s_waitcnt lgkmcnt(4)
ds_read_b32 a119, v56
buffer_load_dwordx4 v[48:51], v12, s[24:27], 0 offen offset:0 sc1
v_mfma_f32_16x16x32_bf16 v[192:195], a[240:243], a[96:99], v[192:195]
ds_read_b128 a[248:251], v14 offset:61440
v_perm_b32 v63, v89, v19, s52
v_mfma_f32_16x16x32_bf16 v[196:199], a[240:243], a[100:103], v[196:199]
ds_read_b32 a120, v63
v_perm_b32 v62, v89, v19, s53
v_mfma_f32_16x16x32_bf16 v[200:203], a[240:243], a[104:107], v[200:203]
ds_read_b32 a121, v62
v_perm_b32 v61, v93, v19, s52
v_mfma_f32_16x16x32_bf16 v[204:207], a[240:243], a[108:111], v[204:207]
s_waitcnt lgkmcnt(4)
ds_read_b32 a122, v61
buffer_load_dwordx4 v[52:55], v12, s[24:27], 0 offen offset:1024 sc1
v_mfma_f32_16x16x32_bf16 v[208:211], a[244:247], a[96:99], v[208:211]
ds_read_b128 a[252:255], v14 offset:63488
v_perm_b32 v60, v93, v19, s53
v_mfma_f32_16x16x32_bf16 v[212:215], a[244:247], a[100:103], v[212:215]
ds_read_b32 a123, v60
v_perm_b32 v59, v89, v19, s54
v_mfma_f32_16x16x32_bf16 v[216:219], a[244:247], a[104:107], v[216:219]
ds_read_b32 a124, v59
v_perm_b32 v58, v89, v19, s55
v_mfma_f32_16x16x32_bf16 v[220:223], a[244:247], a[108:111], v[220:223]
s_waitcnt lgkmcnt(4)
ds_read_b32 a125, v58
v_mfma_f32_16x16x32_bf16 v[224:227], a[248:251], a[96:99], v[224:227]
ds_read_b128 a[240:243], v15 offset:49152
v_perm_b32 v57, v93, v19, s54
v_mfma_f32_16x16x32_bf16 v[228:231], a[248:251], a[100:103], v[228:231]
ds_read_b32 a126, v57
v_perm_b32 v56, v93, v19, s55
v_mfma_f32_16x16x32_bf16 v[232:235], a[248:251], a[104:107], v[232:235]
ds_read_b32 a127, v56
v_mfma_f32_16x16x32_bf16 v[236:239], a[248:251], a[108:111], v[236:239]
s_waitcnt lgkmcnt(4)
v_mfma_f32_16x16x32_bf16 v[240:243], a[252:255], a[96:99], v[240:243]
ds_read_b128 a[244:247], v15 offset:51200
v_mfma_f32_16x16x32_bf16 v[244:247], a[252:255], a[100:103], v[244:247]
v_mfma_f32_16x16x32_bf16 v[248:251], a[252:255], a[104:107], v[248:251]
s_waitcnt vmcnt(10)
v_cmp_ne_u64 s[50:51], s[88:89], v[34:35]
v_cmp_ne_u64 s[44:45], s[88:89], v[38:39]
v_mfma_f32_16x16x32_bf16 v[252:255], a[252:255], a[108:111], v[252:255]
s_waitcnt lgkmcnt(1)
v_mfma_f32_16x16x32_bf16 v[128:131], a[240:243], a[112:115], v[128:131]
s_or_b64 s[50:51], s[44:45], s[50:51]
ds_read_b128 a[248:251], v15 offset:53248
v_mfma_f32_16x16x32_bf16 v[132:135], a[240:243], a[116:119], v[132:135]
s_cbranch_scc1 L_SLOW8
L_BACK8:
v_mfma_f32_16x16x32_bf16 v[136:139], a[240:243], a[120:123], v[136:139]
s_add_u32 m0, s33, 64768
v_mfma_f32_16x16x32_bf16 v[140:143], a[240:243], a[124:127], v[140:143]
s_waitcnt lgkmcnt(1)
v_mfma_f32_16x16x32_bf16 v[144:147], a[244:247], a[112:115], v[144:147]
ds_read_b128 a[252:255], v15 offset:55296
buffer_load_dwordx4 v8, s[20:23], 0 offen offset:768 lds
v_mfma_f32_16x16x32_bf16 v[148:151], a[244:247], a[116:119], v[148:151]
v_perm_b32 v63, v32, v19, s52
v_mfma_f32_16x16x32_bf16 v[152:155], a[244:247], a[120:123], v[152:155]
ds_read_b32 a128, v63
v_perm_b32 v62, v32, v19, s53
v_mfma_f32_16x16x32_bf16 v[156:159], a[244:247], a[124:127], v[156:159]
s_waitcnt lgkmcnt(2)
ds_read_b32 a129, v62
v_mfma_f32_16x16x32_bf16 v[160:163], a[248:251], a[112:115], v[160:163]
s_waitcnt vmcnt(10)
s_barrier
ds_read_b128 a[240:243], v15 offset:57344
v_perm_b32 v61, v36, v19, s52
v_mfma_f32_16x16x32_bf16 v[164:167], a[248:251], a[116:119], v[164:167]
ds_read_b32 a130, v61
v_perm_b32 v60, v36, v19, s53
v_mfma_f32_16x16x32_bf16 v[168:171], a[248:251], a[120:123], v[168:171]
ds_read_b32 a131, v60
v_perm_b32 v59, v32, v19, s54
v_mfma_f32_16x16x32_bf16 v[172:175], a[248:251], a[124:127], v[172:175]
s_waitcnt lgkmcnt(4)
ds_read_b32 a132, v59
buffer_load_dwordx4 v[96:99], v12, s[24:27], 0 offen offset:2048 sc1
v_mfma_f32_16x16x32_bf16 v[176:179], a[252:255], a[112:115], v[176:179]
ds_read_b128 a[244:247], v15 offset:59392
v_perm_b32 v58, v32, v19, s55
v_mfma_f32_16x16x32_bf16 v[180:183], a[252:255], a[116:119], v[180:183]
ds_read_b32 a133, v58
v_perm_b32 v57, v36, v19, s54
v_mfma_f32_16x16x32_bf16 v[184:187], a[252:255], a[120:123], v[184:187]
ds_read_b32 a134, v57
v_perm_b32 v56, v36, v19, s55
v_mfma_f32_16x16x32_bf16 v[188:191], a[252:255], a[124:127], v[188:191]
s_waitcnt lgkmcnt(4)
ds_read_b32 a135, v56
buffer_load_dwordx4 v[100:103], v12, s[24:27], 0 offen offset:3072 sc1
v_mfma_f32_16x16x32_bf16 v[192:195], a[240:243], a[112:115], v[192:195]
ds_read_b128 a[248:251], v15 offset:61440
v_perm_b32 v63, v33, v19, s52
v_mfma_f32_16x16x32_bf16 v[196:199], a[240:243], a[116:119], v[196:199]
ds_read_b32 a136, v63
v_perm_b32 v62, v33, v19, s53
v_mfma_f32_16x16x32_bf16 v[200:203], a[240:243], a[120:123], v[200:203]
s_add_u32 m0, s33, 68864
ds_read_b32 a137, v62
v_perm_b32 v61, v37, v19, s52
v_mfma_f32_16x16x32_bf16 v[204:207], a[240:243], a[124:127], v[204:207]
s_waitcnt lgkmcnt(4)
ds_read_b32 a138, v61
v_perm_b32 v60, v37, v19, s53
v_mfma_f32_16x16x32_bf16 v[208:211], a[244:247], a[112:115], v[208:211]
ds_read_b128 a[252:255], v15 offset:63488
buffer_load_dwordx4 v9, s[20:23], 0 offen offset:768 lds
v_mfma_f32_16x16x32_bf16 v[212:215], a[244:247], a[116:119], v[212:215]
ds_read_b32 a139, v60
v_perm_b32 v59, v33, v19, s54
v_mfma_f32_16x16x32_bf16 v[216:219], a[244:247], a[120:123], v[216:219]
ds_read_b32 a140, v59
v_perm_b32 v58, v33, v19, s55
v_mfma_f32_16x16x32_bf16 v[220:223], a[244:247], a[124:127], v[220:223]
s_waitcnt lgkmcnt(4)
ds_read_b32 a141, v58
v_add_u32 v12, 24576, v13
v_mfma_f32_16x16x32_bf16 v[224:227], a[248:251], a[112:115], v[224:227]
ds_read_b128 a[240:243], v16 offset:0
v_perm_b32 v57, v37, v19, s54
v_mfma_f32_16x16x32_bf16 v[228:231], a[248:251], a[116:119], v[228:231]
ds_read_b32 a142, v57
v_perm_b32 v56, v37, v19, s55
v_mfma_f32_16x16x32_bf16 v[232:235], a[248:251], a[120:123], v[232:235]
ds_read_b32 a143, v56
v_mfma_f32_16x16x32_bf16 v[236:239], a[248:251], a[124:127], v[236:239]
s_waitcnt lgkmcnt(4)
v_mfma_f32_16x16x32_bf16 v[240:243], a[252:255], a[112:115], v[240:243]
ds_read_b128 a[244:247], v16 offset:2048
v_mfma_f32_16x16x32_bf16 v[244:247], a[252:255], a[116:119], v[244:247]
v_mfma_f32_16x16x32_bf16 v[248:251], a[252:255], a[120:123], v[248:251]
s_add_u32 m0, s33, 72960
v_mfma_f32_16x16x32_bf16 v[252:255], a[252:255], a[124:127], v[252:255]
s_waitcnt vmcnt(10) lgkmcnt(1)
v_cmp_ne_u64 s[50:51], s[88:89], v[42:43]
v_cmp_ne_u64 s[44:45], s[88:89], v[46:47]
v_mfma_f32_16x16x32_bf16 v[128:131], a[240:243], a[128:131], v[128:131]
ds_read_b128 a[248:251], v16 offset:4096
buffer_load_dwordx4 v10, s[20:23], 0 offen offset:768 lds
v_mfma_f32_16x16x32_bf16 v[132:135], a[240:243], a[132:135], v[132:135]
s_or_b64 s[50:51], s[44:45], s[50:51]
v_mfma_f32_16x16x32_bf16 v[136:139], a[240:243], a[136:139], v[136:139]
s_cbranch_scc1 L_SLOW9
L_BACK9:
v_mfma_f32_16x16x32_bf16 v[140:143], a[240:243], a[140:143], v[140:143]
s_waitcnt lgkmcnt(1)
v_mfma_f32_16x16x32_bf16 v[144:147], a[244:247], a[128:131], v[144:147]
ds_read_b128 a[252:255], v16 offset:6144
v_mfma_f32_16x16x32_bf16 v[148:151], a[244:247], a[132:135], v[148:151]
v_perm_b32 v63, v40, v19, s52
v_mfma_f32_16x16x32_bf16 v[152:155], a[244:247], a[136:139], v[152:155]
ds_read_b32 a144, v63
v_perm_b32 v62, v40, v19, s53
v_mfma_f32_16x16x32_bf16 v[156:159], a[244:247], a[140:143], v[156:159]
s_waitcnt lgkmcnt(2)
ds_read_b32 a145, v62
v_mfma_f32_16x16x32_bf16 v[160:163], a[248:251], a[128:131], v[160:163]
ds_read_b128 a[240:243], v16 offset:8192
v_perm_b32 v61, v44, v19, s52
v_mfma_f32_16x16x32_bf16 v[164:167], a[248:251], a[132:135], v[164:167]
ds_read_b32 a146, v61
v_perm_b32 v60, v44, v19, s53
v_mfma_f32_16x16x32_bf16 v[168:171], a[248:251], a[136:139], v[168:171]
s_add_u32 m0, s33, 77056
ds_read_b32 a147, v60
v_perm_b32 v59, v40, v19, s54
v_mfma_f32_16x16x32_bf16 v[172:175], a[248:251], a[140:143], v[172:175]
s_waitcnt lgkmcnt(4)
ds_read_b32 a148, v59
v_perm_b32 v58, v40, v19, s55
v_mfma_f32_16x16x32_bf16 v[176:179], a[252:255], a[128:131], v[176:179]
ds_read_b128 a[244:247], v16 offset:10240
buffer_load_dwordx4 v11, s[20:23], 0 offen offset:768 lds
v_mfma_f32_16x16x32_bf16 v[180:183], a[252:255], a[132:135], v[180:183]
ds_read_b32 a149, v58
v_perm_b32 v57, v44, v19, s54
v_mfma_f32_16x16x32_bf16 v[184:187], a[252:255], a[136:139], v[184:187]
ds_read_b32 a150, v57
v_perm_b32 v56, v44, v19, s55
v_mfma_f32_16x16x32_bf16 v[188:191], a[252:255], a[140:143], v[188:191]
s_waitcnt lgkmcnt(4)
ds_read_b32 a151, v56
buffer_load_dwordx4 v[80:83], v12, s[24:27], 0 offen offset:0 sc1
v_mfma_f32_16x16x32_bf16 v[192:195], a[240:243], a[128:131], v[192:195]
ds_read_b128 a[248:251], v16 offset:12288
v_perm_b32 v63, v41, v19, s52
v_mfma_f32_16x16x32_bf16 v[196:199], a[240:243], a[132:135], v[196:199]
ds_read_b32 a152, v63
v_perm_b32 v62, v41, v19, s53
v_mfma_f32_16x16x32_bf16 v[200:203], a[240:243], a[136:139], v[200:203]
ds_read_b32 a153, v62
v_perm_b32 v61, v45, v19, s52
v_mfma_f32_16x16x32_bf16 v[204:207], a[240:243], a[140:143], v[204:207]
s_waitcnt lgkmcnt(4)
ds_read_b32 a154, v61
buffer_load_dwordx4 v[84:87], v12, s[24:27], 0 offen offset:1024 sc1
v_mfma_f32_16x16x32_bf16 v[208:211], a[244:247], a[128:131], v[208:211]
ds_read_b128 a[252:255], v16 offset:14336
v_perm_b32 v60, v45, v19, s53
v_mfma_f32_16x16x32_bf16 v[212:215], a[244:247], a[132:135], v[212:215]
ds_read_b32 a155, v60
v_perm_b32 v59, v41, v19, s54
v_mfma_f32_16x16x32_bf16 v[216:219], a[244:247], a[136:139], v[216:219]
ds_read_b32 a156, v59
v_perm_b32 v58, v41, v19, s55
v_mfma_f32_16x16x32_bf16 v[220:223], a[244:247], a[140:143], v[220:223]
s_waitcnt lgkmcnt(4)
ds_read_b32 a157, v58
v_mfma_f32_16x16x32_bf16 v[224:227], a[248:251], a[128:131], v[224:227]
ds_read_b128 a[240:243], v17 offset:0
v_perm_b32 v57, v45, v19, s54
v_mfma_f32_16x16x32_bf16 v[228:231], a[248:251], a[132:135], v[228:231]
ds_read_b32 a158, v57
v_perm_b32 v56, v45, v19, s55
v_mfma_f32_16x16x32_bf16 v[232:235], a[248:251], a[136:139], v[232:235]
ds_read_b32 a159, v56
v_mfma_f32_16x16x32_bf16 v[236:239], a[248:251], a[140:143], v[236:239]
s_waitcnt lgkmcnt(4)
v_mfma_f32_16x16x32_bf16 v[240:243], a[252:255], a[128:131], v[240:243]
ds_read_b128 a[244:247], v17 offset:2048
v_mfma_f32_16x16x32_bf16 v[244:247], a[252:255], a[132:135], v[244:247]
v_mfma_f32_16x16x32_bf16 v[248:251], a[252:255], a[136:139], v[248:251]
s_waitcnt vmcnt(8)
v_cmp_ne_u64 s[50:51], s[88:89], v[50:51]
v_cmp_ne_u64 s[44:45], s[88:89], v[54:55]
v_mfma_f32_16x16x32_bf16 v[252:255], a[252:255], a[140:143], v[252:255]
s_waitcnt lgkmcnt(1)
v_mfma_f32_16x16x32_bf16 v[128:131], a[240:243], a[144:147], v[128:131]
s_or_b64 s[50:51], s[44:45], s[50:51]
ds_read_b128 a[248:251], v17 offset:4096
v_mfma_f32_16x16x32_bf16 v[132:135], a[240:243], a[148:151], v[132:135]
s_cbranch_scc1 L_SLOW10
L_BACK10:
v_mfma_f32_16x16x32_bf16 v[136:139], a[240:243], a[152:155], v[136:139]
s_add_u32 m0, s33, 81024
v_mfma_f32_16x16x32_bf16 v[140:143], a[240:243], a[156:159], v[140:143]
s_waitcnt lgkmcnt(1)
v_mfma_f32_16x16x32_bf16 v[144:147], a[244:247], a[144:147], v[144:147]
ds_read_b128 a[252:255], v17 offset:6144
buffer_load_dwordx4 v8, s[20:23], 0 offen offset:896 lds
v_mfma_f32_16x16x32_bf16 v[148:151], a[244:247], a[148:151], v[148:151]
v_perm_b32 v63, v48, v19, s52
v_mfma_f32_16x16x32_bf16 v[152:155], a[244:247], a[152:155], v[152:155]
ds_read_b32 a160, v63
v_perm_b32 v62, v48, v19, s53
v_mfma_f32_16x16x32_bf16 v[156:159], a[244:247], a[156:159], v[156:159]
s_waitcnt lgkmcnt(2)
ds_read_b32 a161, v62
v_mfma_f32_16x16x32_bf16 v[160:163], a[248:251], a[144:147], v[160:163]
s_barrier
ds_read_b128 a[240:243], v17 offset:8192
v_perm_b32 v61, v52, v19, s52
v_mfma_f32_16x16x32_bf16 v[164:167], a[248:251], a[148:151], v[164:167]
ds_read_b32 a162, v61
v_perm_b32 v60, v52, v19, s53
v_mfma_f32_16x16x32_bf16 v[168:171], a[248:251], a[152:155], v[168:171]
ds_read_b32 a163, v60
v_perm_b32 v59, v48, v19, s54
v_mfma_f32_16x16x32_bf16 v[172:175], a[248:251], a[156:159], v[172:175]
s_waitcnt lgkmcnt(4)
ds_read_b32 a164, v59
buffer_load_dwordx4 v[88:91], v12, s[24:27], 0 offen offset:2048 sc1
v_mfma_f32_16x16x32_bf16 v[176:179], a[252:255], a[144:147], v[176:179]
ds_read_b128 a[244:247], v17 offset:10240
v_perm_b32 v58, v48, v19, s55
v_mfma_f32_16x16x32_bf16 v[180:183], a[252:255], a[148:151], v[180:183]
ds_read_b32 a165, v58
v_perm_b32 v57, v52, v19, s54
v_mfma_f32_16x16x32_bf16 v[184:187], a[252:255], a[152:155], v[184:187]
ds_read_b32 a166, v57
v_perm_b32 v56, v52, v19, s55
v_mfma_f32_16x16x32_bf16 v[188:191], a[252:255], a[156:159], v[188:191]
s_waitcnt lgkmcnt(4)
ds_read_b32 a167, v56
buffer_load_dwordx4 v[92:95], v12, s[24:27], 0 offen offset:3072 sc1
v_mfma_f32_16x16x32_bf16 v[192:195], a[240:243], a[144:147], v[192:195]
ds_read_b128 a[248:251], v17 offset:12288
v_perm_b32 v63, v49, v19, s52
v_mfma_f32_16x16x32_bf16 v[196:199], a[240:243], a[148:151], v[196:199]
ds_read_b32 a168, v63
v_perm_b32 v62, v49, v19, s53
v_mfma_f32_16x16x32_bf16 v[200:203], a[240:243], a[152:155], v[200:203]
s_add_u32 m0, s33, 85120
ds_read_b32 a169, v62
v_perm_b32 v61, v53, v19, s52
v_mfma_f32_16x16x32_bf16 v[204:207], a[240:243], a[156:159], v[204:207]
s_waitcnt lgkmcnt(4)
ds_read_b32 a170, v61
v_perm_b32 v60, v53, v19, s53
v_mfma_f32_16x16x32_bf16 v[208:211], a[244:247], a[144:147], v[208:211]
ds_read_b128 a[252:255], v17 offset:14336
buffer_load_dwordx4 v9, s[20:23], 0 offen offset:896 lds
v_mfma_f32_16x16x32_bf16 v[212:215], a[244:247], a[148:151], v[212:215]
ds_read_b32 a171, v60
v_perm_b32 v59, v49, v19, s54
v_mfma_f32_16x16x32_bf16 v[216:219], a[244:247], a[152:155], v[216:219]
ds_read_b32 a172, v59
v_perm_b32 v58, v49, v19, s55
v_mfma_f32_16x16x32_bf16 v[220:223], a[244:247], a[156:159], v[220:223]
s_waitcnt lgkmcnt(4)
ds_read_b32 a173, v58
v_add_u32 v12, 28672, v13
v_mfma_f32_16x16x32_bf16 v[224:227], a[248:251], a[144:147], v[224:227]
ds_read_b128 a[240:243], v16 offset:16384
v_perm_b32 v57, v53, v19, s54
v_mfma_f32_16x16x32_bf16 v[228:231], a[248:251], a[148:151], v[228:231]
ds_read_b32 a174, v57
v_perm_b32 v56, v53, v19, s55
v_mfma_f32_16x16x32_bf16 v[232:235], a[248:251], a[152:155], v[232:235]
ds_read_b32 a175, v56
v_mfma_f32_16x16x32_bf16 v[236:239], a[248:251], a[156:159], v[236:239]
s_waitcnt lgkmcnt(4)
v_mfma_f32_16x16x32_bf16 v[240:243], a[252:255], a[144:147], v[240:243]
ds_read_b128 a[244:247], v16 offset:18432
v_mfma_f32_16x16x32_bf16 v[244:247], a[252:255], a[148:151], v[244:247]
v_mfma_f32_16x16x32_bf16 v[248:251], a[252:255], a[152:155], v[248:251]
s_add_u32 m0, s33, 89216
v_mfma_f32_16x16x32_bf16 v[252:255], a[252:255], a[156:159], v[252:255]
s_waitcnt vmcnt(9) lgkmcnt(1)
v_cmp_ne_u64 s[50:51], s[88:89], v[98:99]
v_cmp_ne_u64 s[44:45], s[88:89], v[102:103]
v_mfma_f32_16x16x32_bf16 v[128:131], a[240:243], a[160:163], v[128:131]
ds_read_b128 a[248:251], v16 offset:20480
buffer_load_dwordx4 v10, s[20:23], 0 offen offset:896 lds
v_mfma_f32_16x16x32_bf16 v[132:135], a[240:243], a[164:167], v[132:135]
s_or_b64 s[50:51], s[44:45], s[50:51]
v_mfma_f32_16x16x32_bf16 v[136:139], a[240:243], a[168:171], v[136:139]
s_cbranch_scc1 L_SLOW11
L_BACK11:
v_mfma_f32_16x16x32_bf16 v[140:143], a[240:243], a[172:175], v[140:143]
s_waitcnt lgkmcnt(1)
v_mfma_f32_16x16x32_bf16 v[144:147], a[244:247], a[160:163], v[144:147]
ds_read_b128 a[252:255], v16 offset:22528
v_mfma_f32_16x16x32_bf16 v[148:151], a[244:247], a[164:167], v[148:151]
v_perm_b32 v63, v96, v19, s52
v_mfma_f32_16x16x32_bf16 v[152:155], a[244:247], a[168:171], v[152:155]
ds_read_b32 a176, v63
v_perm_b32 v62, v96, v19, s53
v_mfma_f32_16x16x32_bf16 v[156:159], a[244:247], a[172:175], v[156:159]
s_waitcnt lgkmcnt(2)
ds_read_b32 a177, v62
buffer_load_dwordx4 v[32:35], v12, s[24:27], 0 offen offset:0 sc1
v_mfma_f32_16x16x32_bf16 v[160:163], a[248:251], a[160:163], v[160:163]
ds_read_b128 a[240:243], v16 offset:24576
v_perm_b32 v61, v100, v19, s52
v_mfma_f32_16x16x32_bf16 v[164:167], a[248:251], a[164:167], v[164:167]
ds_read_b32 a178, v61
v_perm_b32 v60, v100, v19, s53
v_mfma_f32_16x16x32_bf16 v[168:171], a[248:251], a[168:171], v[168:171]
s_add_u32 m0, s33, 93312
ds_read_b32 a179, v60
v_perm_b32 v59, v96, v19, s54
v_mfma_f32_16x16x32_bf16 v[172:175], a[248:251], a[172:175], v[172:175]
s_waitcnt lgkmcnt(4)
ds_read_b32 a180, v59
v_perm_b32 v58, v96, v19, s55
v_mfma_f32_16x16x32_bf16 v[176:179], a[252:255], a[160:163], v[176:179]
ds_read_b128 a[244:247], v16 offset:26624
buffer_load_dwordx4 v11, s[20:23], 0 offen offset:896 lds
v_mfma_f32_16x16x32_bf16 v[180:183], a[252:255], a[164:167], v[180:183]
ds_read_b32 a181, v58
v_perm_b32 v57, v100, v19, s54
v_mfma_f32_16x16x32_bf16 v[184:187], a[252:255], a[168:171], v[184:187]
ds_read_b32 a182, v57
v_perm_b32 v56, v100, v19, s55
v_mfma_f32_16x16x32_bf16 v[188:191], a[252:255], a[172:175], v[188:191]
s_waitcnt lgkmcnt(4)
ds_read_b32 a183, v56
buffer_load_dwordx4 v[36:39], v12, s[24:27], 0 offen offset:1024 sc1
v_mfma_f32_16x16x32_bf16 v[192:195], a[240:243], a[160:163], v[192:195]
ds_read_b128 a[248:251], v16 offset:28672
v_perm_b32 v63, v97, v19, s52
v_mfma_f32_16x16x32_bf16 v[196:199], a[240:243], a[164:167], v[196:199]
ds_read_b32 a184, v63
v_perm_b32 v62, v97, v19, s53
v_mfma_f32_16x16x32_bf16 v[200:203], a[240:243], a[168:171], v[200:203]
ds_read_b32 a185, v62
v_perm_b32 v61, v101, v19, s52
v_mfma_f32_16x16x32_bf16 v[204:207], a[240:243], a[172:175], v[204:207]
s_waitcnt lgkmcnt(4)
ds_read_b32 a186, v61
v_mfma_f32_16x16x32_bf16 v[208:211], a[244:247], a[160:163], v[208:211]
ds_read_b128 a[252:255], v16 offset:30720
v_perm_b32 v60, v101, v19, s53
v_mfma_f32_16x16x32_bf16 v[212:215], a[244:247], a[164:167], v[212:215]
ds_read_b32 a187, v60
v_perm_b32 v59, v97, v19, s54
v_mfma_f32_16x16x32_bf16 v[216:219], a[244:247], a[168:171], v[216:219]
L_PAD2:
s_cbranch_vccnz L_PAD3
ds_read_b32 a188, v59
v_perm_b32 v58, v97, v19, s55
v_mfma_f32_16x16x32_bf16 v[220:223], a[244:247], a[172:175], v[220:223]
s_waitcnt lgkmcnt(4)
ds_read_b32 a189, v58
v_mfma_f32_16x16x32_bf16 v[224:227], a[248:251], a[160:163], v[224:227]
ds_read_b128 a[240:243], v17 offset:16384
v_perm_b32 v57, v101, v19, s54
v_mfma_f32_16x16x32_bf16 v[228:231], a[248:251], a[164:167], v[228:231]
ds_read_b32 a190, v57
v_perm_b32 v56, v101, v19, s55
v_mfma_f32_16x16x32_bf16 v[232:235], a[248:251], a[168:171], v[232:235]
s_add_u32 m0, s33, 97280
ds_read_b32 a191, v56
v_mfma_f32_16x16x32_bf16 v[236:239], a[248:251], a[172:175], v[236:239]
s_waitcnt lgkmcnt(4)
v_mfma_f32_16x16x32_bf16 v[240:243], a[252:255], a[160:163], v[240:243]
ds_read_b128 a[244:247], v17 offset:18432
buffer_load_dwordx4 v8, s[20:23], 0 offen offset:1024 lds
v_mfma_f32_16x16x32_bf16 v[244:247], a[252:255], a[164:167], v[244:247]
v_mfma_f32_16x16x32_bf16 v[248:251], a[252:255], a[168:171], v[248:251]
s_waitcnt vmcnt(9)
v_cmp_ne_u64 s[50:51], s[88:89], v[82:83]
v_cmp_ne_u64 s[44:45], s[88:89], v[86:87]
v_mfma_f32_16x16x32_bf16 v[252:255], a[252:255], a[172:175], v[252:255]
s_waitcnt lgkmcnt(1)
v_mfma_f32_16x16x32_bf16 v[128:131], a[240:243], a[176:179], v[128:131]
s_or_b64 s[50:51], s[44:45], s[50:51]
ds_read_b128 a[248:251], v17 offset:20480
v_mfma_f32_16x16x32_bf16 v[132:135], a[240:243], a[180:183], v[132:135]
s_cbranch_scc1 L_SLOW12
L_BACK12:
v_mfma_f32_16x16x32_bf16 v[136:139], a[240:243], a[184:187], v[136:139]
s_add_u32 m0, s33, 101376
buffer_load_dwordx4 v[40:43], v12, s[24:27], 0 offen offset:2048 sc1
v_mfma_f32_16x16x32_bf16 v[140:143], a[240:243], a[188:191], v[140:143]
s_waitcnt lgkmcnt(1)
buffer_load_dwordx4 v[44:47], v12, s[24:27], 0 offen offset:3072 sc1
v_mfma_f32_16x16x32_bf16 v[144:147], a[244:247], a[176:179], v[144:147]
ds_read_b128 a[252:255], v17 offset:22528
buffer_load_dwordx4 v9, s[20:23], 0 offen offset:1024 lds
v_mfma_f32_16x16x32_bf16 v[148:151], a[244:247], a[180:183], v[148:151]
v_perm_b32 v63, v80, v19, s52
v_add_u32 v12, 32768, v13
v_mfma_f32_16x16x32_bf16 v[152:155], a[244:247], a[184:187], v[152:155]
ds_read_b32 a192, v63
v_perm_b32 v62, v80, v19, s53
v_mfma_f32_16x16x32_bf16 v[156:159], a[244:247], a[188:191], v[156:159]
s_waitcnt lgkmcnt(2)
ds_read_b32 a193, v62
v_mfma_f32_16x16x32_bf16 v[160:163], a[248:251], a[176:179], v[160:163]
s_barrier
ds_read_b128 a[240:243], v17 offset:24576
v_perm_b32 v61, v84, v19, s52
v_mfma_f32_16x16x32_bf16 v[164:167], a[248:251], a[180:183], v[164:167]
ds_read_b32 a194, v61
v_perm_b32 v60, v84, v19, s53
v_mfma_f32_16x16x32_bf16 v[168:171], a[248:251], a[184:187], v[168:171]
ds_read_b32 a195, v60
v_perm_b32 v59, v80, v19, s54
v_mfma_f32_16x16x32_bf16 v[172:175], a[248:251], a[188:191], v[172:175]
s_waitcnt lgkmcnt(4)
ds_read_b32 a196, v59
v_mfma_f32_16x16x32_bf16 v[176:179], a[252:255], a[176:179], v[176:179]
ds_read_b128 a[244:247], v17 offset:26624
v_perm_b32 v58, v80, v19, s55
v_mfma_f32_16x16x32_bf16 v[180:183], a[252:255], a[180:183], v[180:183]
ds_read_b32 a197, v58
v_perm_b32 v57, v84, v19, s54
v_mfma_f32_16x16x32_bf16 v[184:187], a[252:255], a[184:187], v[184:187]
ds_read_b32 a198, v57
v_perm_b32 v56, v84, v19, s55
v_mfma_f32_16x16x32_bf16 v[188:191], a[252:255], a[188:191], v[188:191]
s_waitcnt lgkmcnt(4)
ds_read_b32 a199, v56
v_mfma_f32_16x16x32_bf16 v[192:195], a[240:243], a[176:179], v[192:195]
ds_read_b128 a[248:251], v17 offset:28672
v_perm_b32 v63, v81, v19, s52
v_mfma_f32_16x16x32_bf16 v[196:199], a[240:243], a[180:183], v[196:199]
ds_read_b32 a200, v63
v_perm_b32 v62, v81, v19, s53
v_mfma_f32_16x16x32_bf16 v[200:203], a[240:243], a[184:187], v[200:203]
s_add_u32 m0, s33, 105472
ds_read_b32 a201, v62
v_perm_b32 v61, v85, v19, s52
v_mfma_f32_16x16x32_bf16 v[204:207], a[240:243], a[188:191], v[204:207]
s_waitcnt lgkmcnt(4)
ds_read_b32 a202, v61
v_perm_b32 v60, v85, v19, s53
v_mfma_f32_16x16x32_bf16 v[208:211], a[244:247], a[176:179], v[208:211]
ds_read_b128 a[252:255], v17 offset:30720
buffer_load_dwordx4 v10, s[20:23], 0 offen offset:1024 lds
v_mfma_f32_16x16x32_bf16 v[212:215], a[244:247], a[180:183], v[212:215]
ds_read_b32 a203, v60
v_perm_b32 v59, v81, v19, s54
v_mfma_f32_16x16x32_bf16 v[216:219], a[244:247], a[184:187], v[216:219]
ds_read_b32 a204, v59
v_perm_b32 v58, v81, v19, s55
v_mfma_f32_16x16x32_bf16 v[220:223], a[244:247], a[188:191], v[220:223]
s_waitcnt lgkmcnt(4)
ds_read_b32 a205, v58
v_mfma_f32_16x16x32_bf16 v[224:227], a[248:251], a[176:179], v[224:227]
ds_read_b128 a[240:243], v14 offset:0
v_perm_b32 v57, v85, v19, s54
v_mfma_f32_16x16x32_bf16 v[228:231], a[248:251], a[180:183], v[228:231]
ds_read_b32 a206, v57
v_perm_b32 v56, v85, v19, s55
v_mfma_f32_16x16x32_bf16 v[232:235], a[248:251], a[184:187], v[232:235]
ds_read_b32 a207, v56
v_mfma_f32_16x16x32_bf16 v[236:239], a[248:251], a[188:191], v[236:239]
s_waitcnt lgkmcnt(4)
buffer_load_dwordx4 v[48:51], v12, s[24:27], 0 offen offset:0 sc1
v_mfma_f32_16x16x32_bf16 v[240:243], a[252:255], a[176:179], v[240:243]
ds_read_b128 a[244:247], v14 offset:2048
buffer_load_dwordx4 v[52:55], v12, s[24:27], 0 offen offset:1024 sc1
v_mfma_f32_16x16x32_bf16 v[244:247], a[252:255], a[180:183], v[244:247]
v_mfma_f32_16x16x32_bf16 v[248:251], a[252:255], a[184:187], v[248:251]
s_add_u32 m0, s33, 109440
v_mfma_f32_16x16x32_bf16 v[252:255], a[252:255], a[188:191], v[252:255]
s_waitcnt vmcnt(12) lgkmcnt(1)
v_cmp_ne_u64 s[50:51], s[88:89], v[90:91]
v_cmp_ne_u64 s[44:45], s[88:89], v[94:95]
v_mfma_f32_16x16x32_bf16 v[128:131], a[240:243], a[192:195], v[128:131]
ds_read_b128 a[248:251], v14 offset:4096
buffer_load_dwordx4 v8, s[20:23], 0 offen offset:1152 lds
v_mfma_f32_16x16x32_bf16 v[132:135], a[240:243], a[196:199], v[132:135]
s_or_b64 s[50:51], s[44:45], s[50:51]
v_mfma_f32_16x16x32_bf16 v[136:139], a[240:243], a[200:203], v[136:139]
s_cbranch_scc1 L_SLOW13
L_BACK13:
v_mfma_f32_16x16x32_bf16 v[140:143], a[240:243], a[204:207], v[140:143]
s_waitcnt lgkmcnt(1)
v_mfma_f32_16x16x32_bf16 v[144:147], a[244:247], a[192:195], v[144:147]
ds_read_b128 a[252:255], v14 offset:6144
v_mfma_f32_16x16x32_bf16 v[148:151], a[244:247], a[196:199], v[148:151]
v_perm_b32 v63, v88, v19, s52
v_mfma_f32_16x16x32_bf16 v[152:155], a[244:247], a[200:203], v[152:155]
ds_read_b32 a208, v63
v_perm_b32 v62, v88, v19, s53
v_mfma_f32_16x16x32_bf16 v[156:159], a[244:247], a[204:207], v[156:159]
s_waitcnt lgkmcnt(2)
ds_read_b32 a209, v62
v_mfma_f32_16x16x32_bf16 v[160:163], a[248:251], a[192:195], v[160:163]
ds_read_b128 a[240:243], v14 offset:8192
v_perm_b32 v61, v92, v19, s52
v_mfma_f32_16x16x32_bf16 v[164:167], a[248:251], a[196:199], v[164:167]
ds_read_b32 a210, v61
v_perm_b32 v60, v92, v19, s53
v_mfma_f32_16x16x32_bf16 v[168:171], a[248:251], a[200:203], v[168:171]
s_add_u32 m0, s33, 113664
ds_read_b32 a211, v60
v_perm_b32 v59, v88, v19, s54
v_mfma_f32_16x16x32_bf16 v[172:175], a[248:251], a[204:207], v[172:175]
s_waitcnt lgkmcnt(4)
ds_read_b32 a212, v59
v_perm_b32 v58, v88, v19, s55
v_mfma_f32_16x16x32_bf16 v[176:179], a[252:255], a[192:195], v[176:179]
ds_read_b128 a[244:247], v14 offset:10240
buffer_load_dwordx4 v11, s[20:23], 0 offen offset:1024 lds
v_mfma_f32_16x16x32_bf16 v[180:183], a[252:255], a[196:199], v[180:183]
ds_read_b32 a213, v58
v_perm_b32 v57, v92, v19, s54
v_mfma_f32_16x16x32_bf16 v[184:187], a[252:255], a[200:203], v[184:187]
ds_read_b32 a214, v57
v_perm_b32 v56, v92, v19, s55
v_mfma_f32_16x16x32_bf16 v[188:191], a[252:255], a[204:207], v[188:191]
s_waitcnt lgkmcnt(4)
ds_read_b32 a215, v56
v_mfma_f32_16x16x32_bf16 v[192:195], a[240:243], a[192:195], v[192:195]
ds_read_b128 a[248:251], v14 offset:12288
v_perm_b32 v63, v89, v19, s52
v_mfma_f32_16x16x32_bf16 v[196:199], a[240:243], a[196:199], v[196:199]
ds_read_b32 a216, v63
v_perm_b32 v62, v89, v19, s53
v_mfma_f32_16x16x32_bf16 v[200:203], a[240:243], a[200:203], v[200:203]
ds_read_b32 a217, v62
v_perm_b32 v61, v93, v19, s52
v_mfma_f32_16x16x32_bf16 v[204:207], a[240:243], a[204:207], v[204:207]
s_waitcnt lgkmcnt(4)
ds_read_b32 a218, v61
v_mfma_f32_16x16x32_bf16 v[208:211], a[244:247], a[192:195], v[208:211]
ds_read_b128 a[252:255], v14 offset:14336
v_perm_b32 v60, v93, v19, s53
v_mfma_f32_16x16x32_bf16 v[212:215], a[244:247], a[196:199], v[212:215]
ds_read_b32 a219, v60
v_perm_b32 v59, v89, v19, s54
v_mfma_f32_16x16x32_bf16 v[216:219], a[244:247], a[200:203], v[216:219]
ds_read_b32 a220, v59
v_perm_b32 v58, v89, v19, s55
v_mfma_f32_16x16x32_bf16 v[220:223], a[244:247], a[204:207], v[220:223]
s_waitcnt lgkmcnt(4)
ds_read_b32 a221, v58
buffer_load_dwordx4 v[96:99], v12, s[24:27], 0 offen offset:2048 sc1
v_mfma_f32_16x16x32_bf16 v[224:227], a[248:251], a[192:195], v[224:227]
ds_read_b128 a[240:243], v15 offset:0
v_perm_b32 v57, v93, v19, s54
v_mfma_f32_16x16x32_bf16 v[228:231], a[248:251], a[196:199], v[228:231]
ds_read_b32 a222, v57
v_perm_b32 v56, v93, v19, s55
v_mfma_f32_16x16x32_bf16 v[232:235], a[248:251], a[200:203], v[232:235]
ds_read_b32 a223, v56
buffer_load_dwordx4 v[100:103], v12, s[24:27], 0 offen offset:3072 sc1
v_mfma_f32_16x16x32_bf16 v[236:239], a[248:251], a[204:207], v[236:239]
s_waitcnt vmcnt(11) lgkmcnt(4)
v_cmp_ne_u64 s[50:51], s[88:89], v[34:35]
v_cmp_ne_u64 s[44:45], s[88:89], v[38:39]
v_mfma_f32_16x16x32_bf16 v[240:243], a[252:255], a[192:195], v[240:243]
ds_read_b128 a[244:247], v15 offset:2048
v_add_u32 v12, 36864, v13
v_mfma_f32_16x16x32_bf16 v[244:247], a[252:255], a[196:199], v[244:247]
s_or_b64 s[50:51], s[44:45], s[50:51]
v_mfma_f32_16x16x32_bf16 v[248:251], a[252:255], a[200:203], v[248:251]
s_cbranch_scc1 L_SLOW14
L_BACK14:
v_mfma_f32_16x16x32_bf16 v[252:255], a[252:255], a[204:207], v[252:255]
s_waitcnt lgkmcnt(1)
v_mfma_f32_16x16x32_bf16 v[128:131], a[240:243], a[208:211], v[128:131]
ds_read_b128 a[248:251], v15 offset:4096
v_perm_b32 v63, v32, v19, s52
v_mfma_f32_16x16x32_bf16 v[132:135], a[240:243], a[212:215], v[132:135]
ds_read_b32 a224, v63
v_perm_b32 v62, v32, v19, s53
v_mfma_f32_16x16x32_bf16 v[136:139], a[240:243], a[216:219], v[136:139]
s_add_u32 m0, s33, 117632
ds_read_b32 a225, v62
v_perm_b32 v61, v36, v19, s52
v_mfma_f32_16x16x32_bf16 v[140:143], a[240:243], a[220:223], v[140:143]
s_waitcnt lgkmcnt(3)
ds_read_b32 a226, v61
v_perm_b32 v60, v36, v19, s53
v_mfma_f32_16x16x32_bf16 v[144:147], a[244:247], a[208:211], v[144:147]
ds_read_b128 a[252:255], v15 offset:6144
buffer_load_dwordx4 v9, s[20:23], 0 offen offset:1152 lds
v_mfma_f32_16x16x32_bf16 v[148:151], a[244:247], a[212:215], v[148:151]
ds_read_b32 a227, v60
v_perm_b32 v59, v32, v19, s54
v_mfma_f32_16x16x32_bf16 v[152:155], a[244:247], a[216:219], v[152:155]
ds_read_b32 a228, v59
v_perm_b32 v58, v32, v19, s55
v_mfma_f32_16x16x32_bf16 v[156:159], a[244:247], a[220:223], v[156:159]
s_waitcnt lgkmcnt(4)
ds_read_b32 a229, v58
v_mfma_f32_16x16x32_bf16 v[160:163], a[248:251], a[208:211], v[160:163]
s_barrier
ds_read_b128 a[240:243], v15 offset:8192
v_perm_b32 v57, v36, v19, s54
v_mfma_f32_16x16x32_bf16 v[164:167], a[248:251], a[212:215], v[164:167]
ds_read_b32 a230, v57
v_perm_b32 v56, v36, v19, s55
v_mfma_f32_16x16x32_bf16 v[168:171], a[248:251], a[216:219], v[168:171]
ds_read_b32 a231, v56
v_perm_b32 v63, v33, v19, s52
v_mfma_f32_16x16x32_bf16 v[172:175], a[248:251], a[220:223], v[172:175]
s_waitcnt lgkmcnt(4)
ds_read_b32 a232, v63
v_mfma_f32_16x16x32_bf16 v[176:179], a[252:255], a[208:211], v[176:179]
ds_read_b128 a[244:247], v15 offset:10240
v_perm_b32 v62, v33, v19, s53
v_mfma_f32_16x16x32_bf16 v[180:183], a[252:255], a[212:215], v[180:183]
ds_read_b32 a233, v62
v_perm_b32 v61, v37, v19, s52
v_mfma_f32_16x16x32_bf16 v[184:187], a[252:255], a[216:219], v[184:187]
ds_read_b32 a234, v61
v_perm_b32 v60, v37, v19, s53
v_mfma_f32_16x16x32_bf16 v[188:191], a[252:255], a[220:223], v[188:191]
s_waitcnt lgkmcnt(4)
ds_read_b32 a235, v60
buffer_load_dwordx4 v[80:83], v12, s[24:27], 0 offen offset:0 sc1
v_mfma_f32_16x16x32_bf16 v[192:195], a[240:243], a[208:211], v[192:195]
ds_read_b128 a[248:251], v15 offset:12288
v_perm_b32 v59, v33, v19, s54
v_mfma_f32_16x16x32_bf16 v[196:199], a[240:243], a[212:215], v[196:199]
ds_read_b32 a236, v59
v_perm_b32 v58, v33, v19, s55
v_mfma_f32_16x16x32_bf16 v[200:203], a[240:243], a[216:219], v[200:203]
s_add_u32 m0, s33, 121728
ds_read_b32 a237, v58
v_perm_b32 v57, v37, v19, s54
v_mfma_f32_16x16x32_bf16 v[204:207], a[240:243], a[220:223], v[204:207]
s_waitcnt lgkmcnt(4)
ds_read_b32 a238, v57
v_perm_b32 v56, v37, v19, s55
v_mfma_f32_16x16x32_bf16 v[208:211], a[244:247], a[208:211], v[208:211]
ds_read_b128 a[252:255], v14 offset:16384
buffer_load_dwordx4 v10, s[20:23], 0 offen offset:1152 lds
v_mfma_f32_16x16x32_bf16 v[212:215], a[244:247], a[212:215], v[212:215]
ds_read_b32 a239, v56
buffer_load_dwordx4 v[84:87], v12, s[24:27], 0 offen offset:1024 sc1
v_mfma_f32_16x16x32_bf16 v[216:219], a[244:247], a[216:219], v[216:219]
s_waitcnt vmcnt(12)
v_cmp_ne_u64 s[50:51], s[88:89], v[42:43]
v_cmp_ne_u64 s[44:45], s[88:89], v[46:47]
v_mfma_f32_16x16x32_bf16 v[220:223], a[244:247], a[220:223], v[220:223]
s_waitcnt lgkmcnt(3)
v_mfma_f32_16x16x32_bf16 v[224:227], a[248:251], a[208:211], v[224:227]
s_or_b64 s[50:51], s[44:45], s[50:51]
ds_read_b128 a[240:243], v14 offset:18432
v_mfma_f32_16x16x32_bf16 v[228:231], a[248:251], a[212:215], v[228:231]
s_cbranch_scc1 L_SLOW15
L_BACK15:
v_mfma_f32_16x16x32_bf16 v[232:235], a[248:251], a[216:219], v[232:235]
v_perm_b32 v63, v40, v19, s52
v_mfma_f32_16x16x32_bf16 v[236:239], a[248:251], a[220:223], v[236:239]
s_waitcnt lgkmcnt(1)
ds_read_b32 a0, v63
v_mfma_f32_16x16x32_bf16 v[128:131], a[252:255], a[224:227], v[128:131]
ds_read_b128 a[244:247], v14 offset:20480
v_perm_b32 v62, v40, v19, s53
v_mfma_f32_16x16x32_bf16 v[132:135], a[252:255], a[228:231], v[132:135]
ds_read_b32 a1, v62
v_perm_b32 v61, v44, v19, s52
v_mfma_f32_16x16x32_bf16 v[136:139], a[252:255], a[232:235], v[136:139]
s_add_u32 m0, s33, 125696
ds_read_b32 a2, v61
v_perm_b32 v60, v44, v19, s53
v_mfma_f32_16x16x32_bf16 v[140:143], a[252:255], a[236:239], v[140:143]
s_waitcnt lgkmcnt(4)
ds_read_b32 a3, v60
v_perm_b32 v59, v40, v19, s54
v_mfma_f32_16x16x32_bf16 v[144:147], a[240:243], a[224:227], v[144:147]
ds_read_b128 a[248:251], v14 offset:22528
buffer_load_dwordx4 v8, s[20:23], 0 offen offset:1280 lds
v_mfma_f32_16x16x32_bf16 v[148:151], a[240:243], a[228:231], v[148:151]
ds_read_b32 a4, v59
v_perm_b32 v58, v40, v19, s55
v_mfma_f32_16x16x32_bf16 v[152:155], a[240:243], a[232:235], v[152:155]
ds_read_b32 a5, v58
v_perm_b32 v57, v44, v19, s54
v_mfma_f32_16x16x32_bf16 v[156:159], a[240:243], a[236:239], v[156:159]
s_waitcnt lgkmcnt(4)
ds_read_b32 a6, v57
v_mfma_f32_16x16x32_bf16 v[160:163], a[244:247], a[224:227], v[160:163]
ds_read_b128 a[252:255], v14 offset:24576
v_perm_b32 v56, v44, v19, s55
v_mfma_f32_16x16x32_bf16 v[164:167], a[244:247], a[228:231], v[164:167]
ds_read_b32 a7, v56
v_perm_b32 v63, v41, v19, s52
v_mfma_f32_16x16x32_bf16 v[168:171], a[244:247], a[232:235], v[168:171]
ds_read_b32 a8, v63
v_perm_b32 v62, v41, v19, s53
v_mfma_f32_16x16x32_bf16 v[172:175], a[244:247], a[236:239], v[172:175]
s_waitcnt lgkmcnt(4)
ds_read_b32 a9, v62
v_mfma_f32_16x16x32_bf16 v[176:179], a[248:251], a[224:227], v[176:179]
ds_read_b128 a[240:243], v15 offset:14336
v_perm_b32 v61, v45, v19, s52
v_mfma_f32_16x16x32_bf16 v[180:183], a[248:251], a[228:231], v[180:183]
ds_read_b32 a10, v61
v_perm_b32 v60, v45, v19, s53
v_mfma_f32_16x16x32_bf16 v[184:187], a[248:251], a[232:235], v[184:187]
s_add_u32 m0, s33, 129792
ds_read_b32 a11, v60
v_perm_b32 v59, v41, v19, s54
v_mfma_f32_16x16x32_bf16 v[188:191], a[248:251], a[236:239], v[188:191]
s_waitcnt lgkmcnt(4)
ds_read_b32 a12, v59
v_perm_b32 v58, v41, v19, s55
v_mfma_f32_16x16x32_bf16 v[192:195], a[252:255], a[224:227], v[192:195]
ds_read_b128 a[244:247], v14 offset:26624
buffer_load_dwordx4 v9, s[20:23], 0 offen offset:1280 lds
v_mfma_f32_16x16x32_bf16 v[196:199], a[252:255], a[228:231], v[196:199]
ds_read_b32 a13, v58
v_perm_b32 v57, v45, v19, s54
v_mfma_f32_16x16x32_bf16 v[200:203], a[252:255], a[232:235], v[200:203]
ds_read_b32 a14, v57
buffer_load_dwordx4 v[88:91], v12, s[24:27], 0 offen offset:2048 sc1
v_mfma_f32_16x16x32_bf16 v[204:207], a[252:255], a[236:239], v[204:207]
s_waitcnt vmcnt(11) lgkmcnt(4)
v_cmp_ne_u64 s[50:51], s[88:89], v[50:51]
v_cmp_ne_u64 s[44:45], s[88:89], v[54:55]
v_mfma_f32_16x16x32_bf16 v[240:243], a[240:243], a[208:211], v[240:243]
ds_read_b128 a[248:251], v15 offset:16384
v_perm_b32 v56, v45, v19, s55
v_mfma_f32_16x16x32_bf16 v[244:247], a[240:243], a[212:215], v[244:247]
s_or_b64 s[50:51], s[44:45], s[50:51]
ds_read_b32 a15, v56
buffer_load_dwordx4 v[92:95], v12, s[24:27], 0 offen offset:3072 sc1
v_mfma_f32_16x16x32_bf16 v[248:251], a[240:243], a[216:219], v[248:251]
s_cbranch_scc1 L_SLOW16
L_BACK16:
v_mfma_f32_16x16x32_bf16 v[252:255], a[240:243], a[220:223], v[252:255]
s_waitcnt lgkmcnt(2)
v_add_u32 v12, 40960, v13
v_mfma_f32_16x16x32_bf16 v[208:211], a[244:247], a[224:227], v[208:211]
ds_read_b128 a[252:255], v14 offset:28672
v_perm_b32 v63, v48, v19, s52
v_mfma_f32_16x16x32_bf16 v[212:215], a[244:247], a[228:231], v[212:215]
ds_read_b32 a16, v63
v_perm_b32 v62, v48, v19, s53
v_mfma_f32_16x16x32_bf16 v[216:219], a[244:247], a[232:235], v[216:219]
ds_read_b32 a17, v62
v_perm_b32 v61, v52, v19, s52
v_mfma_f32_16x16x32_bf16 v[220:223], a[244:247], a[236:239], v[220:223]
s_waitcnt lgkmcnt(3)
ds_read_b32 a18, v61
v_mfma_f32_16x16x32_bf16 v[128:131], a[248:251], a[0:3], v[128:131]
ds_read_b128 a[240:243], v15 offset:18432
v_perm_b32 v60, v52, v19, s53
v_mfma_f32_16x16x32_bf16 v[132:135], a[248:251], a[4:7], v[132:135]
ds_read_b32 a19, v60
v_perm_b32 v59, v48, v19, s54
v_mfma_f32_16x16x32_bf16 v[136:139], a[248:251], a[8:11], v[136:139]
ds_read_b32 a20, v59
v_perm_b32 v58, v48, v19, s55
v_mfma_f32_16x16x32_bf16 v[140:143], a[248:251], a[12:15], v[140:143]
s_waitcnt lgkmcnt(4)
ds_read_b32 a21, v58
v_mfma_f32_16x16x32_bf16 v[224:227], a[252:255], a[224:227], v[224:227]
ds_read_b128 a[244:247], v15 offset:20480
v_perm_b32 v57, v52, v19, s54
v_mfma_f32_16x16x32_bf16 v[228:231], a[252:255], a[228:231], v[228:231]
ds_read_b32 a22, v57
v_perm_b32 v56, v52, v19, s55
v_mfma_f32_16x16x32_bf16 v[232:235], a[252:255], a[232:235], v[232:235]
ds_read_b32 a23, v56
v_perm_b32 v63, v49, v19, s52
v_mfma_f32_16x16x32_bf16 v[236:239], a[252:255], a[236:239], v[236:239]
s_waitcnt lgkmcnt(4)
ds_read_b32 a24, v63
v_mfma_f32_16x16x32_bf16 v[144:147], a[240:243], a[0:3], v[144:147]
ds_read_b128 a[248:251], v15 offset:22528
v_perm_b32 v62, v49, v19, s53
v_mfma_f32_16x16x32_bf16 v[148:151], a[240:243], a[4:7], v[148:151]
ds_read_b32 a25, v62
v_perm_b32 v61, v53, v19, s52
v_mfma_f32_16x16x32_bf16 v[152:155], a[240:243], a[8:11], v[152:155]
s_add_u32 m0, s33, 134016
ds_read_b32 a26, v61
v_perm_b32 v60, v53, v19, s53
v_mfma_f32_16x16x32_bf16 v[156:159], a[240:243], a[12:15], v[156:159]
s_waitcnt lgkmcnt(4)
ds_read_b32 a27, v60
v_perm_b32 v59, v49, v19, s54
v_mfma_f32_16x16x32_bf16 v[160:163], a[244:247], a[0:3], v[160:163]
ds_read_b128 a[252:255], v15 offset:24576
buffer_load_dwordx4 v11, s[20:23], 0 offen offset:1152 lds
v_mfma_f32_16x16x32_bf16 v[164:167], a[244:247], a[4:7], v[164:167]
ds_read_b32 a28, v59
v_perm_b32 v58, v49, v19, s55
v_mfma_f32_16x16x32_bf16 v[168:171], a[244:247], a[8:11], v[168:171]
ds_read_b32 a29, v58
v_perm_b32 v57, v53, v19, s54
v_mfma_f32_16x16x32_bf16 v[172:175], a[244:247], a[12:15], v[172:175]
s_waitcnt lgkmcnt(4)
ds_read_b32 a30, v57
buffer_load_dwordx4 v[32:35], v12, s[24:27], 0 offen offset:0 sc1
v_mfma_f32_16x16x32_bf16 v[176:179], a[248:251], a[0:3], v[176:179]
s_waitcnt vmcnt(12)
s_barrier
ds_read_b128 a[240:243], v14 offset:32768
v_perm_b32 v56, v53, v19, s55
v_mfma_f32_16x16x32_bf16 v[180:183], a[248:251], a[4:7], v[180:183]
ds_read_b32 a31, v56
buffer_load_dwordx4 v[36:39], v12, s[24:27], 0 offen offset:1024 sc1
v_mfma_f32_16x16x32_bf16 v[184:187], a[248:251], a[8:11], v[184:187]
s_waitcnt vmcnt(11)
v_cmp_ne_u64 s[50:51], s[88:89], v[98:99]
v_cmp_ne_u64 s[44:45], s[88:89], v[102:103]
v_mfma_f32_16x16x32_bf16 v[188:191], a[248:251], a[12:15], v[188:191]
s_waitcnt lgkmcnt(3)
v_mfma_f32_16x16x32_bf16 v[192:195], a[252:255], a[0:3], v[192:195]
s_or_b64 s[50:51], s[44:45], s[50:51]
ds_read_b128 a[244:247], v15 offset:26624
v_mfma_f32_16x16x32_bf16 v[196:199], a[252:255], a[4:7], v[196:199]
s_cbranch_scc1 L_SLOW17
L_BACK17:
v_mfma_f32_16x16x32_bf16 v[200:203], a[252:255], a[8:11], v[200:203]
v_perm_b32 v63, v96, v19, s52
v_mfma_f32_16x16x32_bf16 v[204:207], a[252:255], a[12:15], v[204:207]
s_waitcnt lgkmcnt(1)
ds_read_b32 a32, v63
v_mfma_f32_16x16x32_bf16 v[128:131], a[240:243], a[16:19], v[128:131]
ds_read_b128 a[248:251], v14 offset:34816
v_perm_b32 v62, v96, v19, s53
v_mfma_f32_16x16x32_bf16 v[132:135], a[240:243], a[20:23], v[132:135]
ds_read_b32 a33, v62
v_perm_b32 v61, v100, v19, s52
v_mfma_f32_16x16x32_bf16 v[136:139], a[240:243], a[24:27], v[136:139]
s_add_u32 m0, s33, 137984
ds_read_b32 a34, v61
v_perm_b32 v60, v100, v19, s53
v_mfma_f32_16x16x32_bf16 v[140:143], a[240:243], a[28:31], v[140:143]
s_waitcnt lgkmcnt(4)
ds_read_b32 a35, v60
v_perm_b32 v59, v96, v19, s54
v_mfma_f32_16x16x32_bf16 v[208:211], a[244:247], a[0:3], v[208:211]
ds_read_b128 a[252:255], v14 offset:36864
buffer_load_dwordx4 v10, s[20:23], 0 offen offset:1280 lds
v_mfma_f32_16x16x32_bf16 v[212:215], a[244:247], a[4:7], v[212:215]
ds_read_b32 a36, v59
v_perm_b32 v58, v96, v19, s55
v_mfma_f32_16x16x32_bf16 v[216:219], a[244:247], a[8:11], v[216:219]
ds_read_b32 a37, v58
v_perm_b32 v57, v100, v19, s54
v_mfma_f32_16x16x32_bf16 v[220:223], a[244:247], a[12:15], v[220:223]
s_waitcnt lgkmcnt(4)
ds_read_b32 a38, v57
v_mfma_f32_16x16x32_bf16 v[144:147], a[248:251], a[16:19], v[144:147]
ds_read_b128 a[240:243], v14 offset:38912
v_perm_b32 v56, v100, v19, s55
v_mfma_f32_16x16x32_bf16 v[148:151], a[248:251], a[20:23], v[148:151]
ds_read_b32 a39, v56
v_perm_b32 v63, v97, v19, s52
v_mfma_f32_16x16x32_bf16 v[152:155], a[248:251], a[24:27], v[152:155]
ds_read_b32 a40, v63
v_perm_b32 v62, v97, v19, s53
v_mfma_f32_16x16x32_bf16 v[156:159], a[248:251], a[28:31], v[156:159]
s_waitcnt lgkmcnt(4)
ds_read_b32 a41, v62
buffer_load_dwordx4 v[40:43], v12, s[24:27], 0 offen offset:2048 sc1
v_mfma_f32_16x16x32_bf16 v[160:163], a[252:255], a[16:19], v[160:163]
ds_read_b128 a[244:247], v15 offset:28672
v_perm_b32 v61, v101, v19, s52
v_mfma_f32_16x16x32_bf16 v[164:167], a[252:255], a[20:23], v[164:167]
ds_read_b32 a42, v61
v_perm_b32 v60, v101, v19, s53
v_mfma_f32_16x16x32_bf16 v[168:171], a[252:255], a[24:27], v[168:171]
s_add_u32 m0, s33, 141952
ds_read_b32 a43, v60
v_perm_b32 v59, v97, v19, s54
v_mfma_f32_16x16x32_bf16 v[172:175], a[252:255], a[28:31], v[172:175]
s_waitcnt lgkmcnt(4)
ds_read_b32 a44, v59
v_perm_b32 v58, v97, v19, s55
v_mfma_f32_16x16x32_bf16 v[176:179], a[240:243], a[16:19], v[176:179]
ds_read_b128 a[248:251], v14 offset:40960
buffer_load_dwordx4 v8, s[20:23], 0 offen offset:1408 lds
v_mfma_f32_16x16x32_bf16 v[180:183], a[240:243], a[20:23], v[180:183]
ds_read_b32 a45, v58
v_perm_b32 v57, v101, v19, s54
v_mfma_f32_16x16x32_bf16 v[184:187], a[240:243], a[24:27], v[184:187]
ds_read_b32 a46, v57
buffer_load_dwordx4 v[44:47], v12, s[24:27], 0 offen offset:3072 sc1
v_mfma_f32_16x16x32_bf16 v[188:191], a[240:243], a[28:31], v[188:191]
s_waitcnt vmcnt(11) lgkmcnt(4)
v_cmp_ne_u64 s[50:51], s[88:89], v[82:83]
v_cmp_ne_u64 s[44:45], s[88:89], v[86:87]
v_mfma_f32_16x16x32_bf16 v[224:227], a[244:247], a[0:3], v[224:227]
ds_read_b128 a[252:255], v15 offset:32768
v_perm_b32 v56, v101, v19, s55
v_mfma_f32_16x16x32_bf16 v[228:231], a[244:247], a[4:7], v[228:231]
s_or_b64 s[50:51], s[44:45], s[50:51]
ds_read_b32 a47, v56
v_add_u32 v12, 45056, v13
v_mfma_f32_16x16x32_bf16 v[232:235], a[244:247], a[8:11], v[232:235]
s_cbranch_scc1 L_SLOW18
L_BACK18:
v_mfma_f32_16x16x32_bf16 v[236:239], a[244:247], a[12:15], v[236:239]
s_waitcnt lgkmcnt(2)
v_mfma_f32_16x16x32_bf16 v[192:195], a[248:251], a[16:19], v[192:195]
ds_read_b128 a[240:243], v14 offset:30720
v_perm_b32 v63, v80, v19, s52
v_mfma_f32_16x16x32_bf16 v[196:199], a[248:251], a[20:23], v[196:199]
L_PAD3:
s_cbranch_vccnz L_PADRET
ds_read_b32 a48, v63
v_perm_b32 v62, v80, v19, s53
v_mfma_f32_16x16x32_bf16 v[200:203], a[248:251], a[24:27], v[200:203]
s_add_u32 m0, s33, 146048
ds_read_b32 a49, v62
v_perm_b32 v61, v84, v19, s52
v_mfma_f32_16x16x32_bf16 v[204:207], a[248:251], a[28:31], v[204:207]
s_waitcnt lgkmcnt(3)
ds_read_b32 a50, v61
v_perm_b32 v60, v84, v19, s53
v_mfma_f32_16x16x32_bf16 v[128:131], a[252:255], a[32:35], v[128:131]
ds_read_b128 a[244:247], v15 offset:34816
buffer_load_dwordx4 v9, s[20:23], 0 offen offset:1408 lds
v_mfma_f32_16x16x32_bf16 v[132:135], a[252:255], a[36:39], v[132:135]
ds_read_b32 a51, v60
v_perm_b32 v59, v80, v19, s54
v_mfma_f32_16x16x32_bf16 v[136:139], a[252:255], a[40:43], v[136:139]
ds_read_b32 a52, v59
v_perm_b32 v58, v80, v19, s55
v_mfma_f32_16x16x32_bf16 v[140:143], a[252:255], a[44:47], v[140:143]
s_waitcnt lgkmcnt(4)
ds_read_b32 a53, v58
v_mfma_f32_16x16x32_bf16 v[240:243], a[240:243], a[224:227], v[240:243]
ds_read_b128 a[248:251], v15 offset:36864
v_perm_b32 v57, v84, v19, s54
v_mfma_f32_16x16x32_bf16 v[244:247], a[240:243], a[228:231], v[244:247]
ds_read_b32 a54, v57
v_perm_b32 v56, v84, v19, s55
v_mfma_f32_16x16x32_bf16 v[248:251], a[240:243], a[232:235], v[248:251]
ds_read_b32 a55, v56
v_perm_b32 v63, v81, v19, s52
v_mfma_f32_16x16x32_bf16 v[252:255], a[240:243], a[236:239], v[252:255]
s_waitcnt lgkmcnt(4)
ds_read_b32 a56, v63
buffer_load_dwordx4 v[48:51], v12, s[24:27], 0 offen offset:0 sc1
v_mfma_f32_16x16x32_bf16 v[144:147], a[244:247], a[32:35], v[144:147]
ds_read_b128 a[252:255], v14 offset:43008
v_perm_b32 v62, v81, v19, s53
v_mfma_f32_16x16x32_bf16 v[148:151], a[244:247], a[36:39], v[148:151]
ds_read_b32 a57, v62
v_perm_b32 v61, v85, v19, s52
v_mfma_f32_16x16x32_bf16 v[152:155], a[244:247], a[40:43], v[152:155]
ds_read_b32 a58, v61
v_perm_b32 v60, v85, v19, s53
v_mfma_f32_16x16x32_bf16 v[156:159], a[244:247], a[44:47], v[156:159]
s_waitcnt lgkmcnt(4)
ds_read_b32 a59, v60
buffer_load_dwordx4 v[52:55], v12, s[24:27], 0 offen offset:1024 sc1
v_mfma_f32_16x16x32_bf16 v[160:163], a[248:251], a[32:35], v[160:163]
ds_read_b128 a[240:243], v15 offset:38912
v_perm_b32 v59, v81, v19, s54
v_mfma_f32_16x16x32_bf16 v[164:167], a[248:251], a[36:39], v[164:167]
ds_read_b32 a60, v59
v_perm_b32 v58, v81, v19, s55
v_mfma_f32_16x16x32_bf16 v[168:171], a[248:251], a[40:43], v[168:171]
ds_read_b32 a61, v58
v_perm_b32 v57, v85, v19, s54
v_mfma_f32_16x16x32_bf16 v[172:175], a[248:251], a[44:47], v[172:175]
s_waitcnt lgkmcnt(4)
ds_read_b32 a62, v57
v_mfma_f32_16x16x32_bf16 v[208:211], a[252:255], a[16:19], v[208:211]
ds_read_b128 a[244:247], v14 offset:45056
v_perm_b32 v56, v85, v19, s55
v_mfma_f32_16x16x32_bf16 v[212:215], a[252:255], a[20:23], v[212:215]
ds_read_b32 a63, v56
v_mfma_f32_16x16x32_bf16 v[216:219], a[252:255], a[24:27], v[216:219]
s_waitcnt vmcnt(10)
v_cmp_ne_u64 s[50:51], s[88:89], v[90:91]
v_cmp_ne_u64 s[44:45], s[88:89], v[94:95]
v_mfma_f32_16x16x32_bf16 v[220:223], a[252:255], a[28:31], v[220:223]
s_waitcnt lgkmcnt(3)
v_mfma_f32_16x16x32_bf16 v[176:179], a[240:243], a[32:35], v[176:179]
s_or_b64 s[50:51], s[44:45], s[50:51]
ds_read_b128 a[248:251], v15 offset:40960
v_mfma_f32_16x16x32_bf16 v[180:183], a[240:243], a[36:39], v[180:183]
s_cbranch_scc1 L_SLOW19
L_BACK19:
v_mfma_f32_16x16x32_bf16 v[184:187], a[240:243], a[40:43], v[184:187]
s_add_u32 m0, s33, 150016
v_perm_b32 v63, v88, v19, s52
v_mfma_f32_16x16x32_bf16 v[188:191], a[240:243], a[44:47], v[188:191]
s_waitcnt lgkmcnt(1)
ds_read_b32 a64, v63
v_perm_b32 v62, v88, v19, s53
v_mfma_f32_16x16x32_bf16 v[128:131], a[244:247], a[48:51], v[128:131]
ds_read_b128 a[252:255], v14 offset:49152
buffer_load_dwordx4 v8, s[20:23], 0 offen offset:1536 lds
v_mfma_f32_16x16x32_bf16 v[132:135], a[244:247], a[52:55], v[132:135]
ds_read_b32 a65, v62
v_perm_b32 v61, v92, v19, s52
v_mfma_f32_16x16x32_bf16 v[136:139], a[244:247], a[56:59], v[136:139]
ds_read_b32 a66, v61
v_perm_b32 v60, v92, v19, s53
v_mfma_f32_16x16x32_bf16 v[140:143], a[244:247], a[60:63], v[140:143]
s_waitcnt lgkmcnt(4)
ds_read_b32 a67, v60
v_mfma_f32_16x16x32_bf16 v[192:195], a[248:251], a[32:35], v[192:195]
s_barrier
ds_read_b128 a[240:243], v14 offset:47104
v_perm_b32 v59, v88, v19, s54
v_mfma_f32_16x16x32_bf16 v[196:199], a[248:251], a[36:39], v[196:199]
ds_read_b32 a68, v59
v_perm_b32 v58, v88, v19, s55
v_mfma_f32_16x16x32_bf16 v[200:203], a[248:251], a[40:43], v[200:203]
ds_read_b32 a69, v58
v_perm_b32 v57, v92, v19, s54
v_mfma_f32_16x16x32_bf16 v[204:207], a[248:251], a[44:47], v[204:207]
s_waitcnt lgkmcnt(4)
ds_read_b32 a70, v57
buffer_load_dwordx4 v[96:99], v12, s[24:27], 0 offen offset:2048 sc1
v_mfma_f32_16x16x32_bf16 v[224:227], a[252:255], a[16:19], v[224:227]
ds_read_b128 a[244:247], v14 offset:53248
v_perm_b32 v56, v92, v19, s55
v_mfma_f32_16x16x32_bf16 v[228:231], a[252:255], a[20:23], v[228:231]
ds_read_b32 a71, v56
v_perm_b32 v63, v89, v19, s52
v_mfma_f32_16x16x32_bf16 v[232:235], a[252:255], a[24:27], v[232:235]
ds_read_b32 a72, v63
v_perm_b32 v62, v89, v19, s53
v_mfma_f32_16x16x32_bf16 v[236:239], a[252:255], a[28:31], v[236:239]
s_waitcnt lgkmcnt(4)
ds_read_b32 a73, v62
buffer_load_dwordx4 v[100:103], v12, s[24:27], 0 offen offset:3072 sc1
v_mfma_f32_16x16x32_bf16 v[144:147], a[240:243], a[48:51], v[144:147]
ds_read_b128 a[248:251], v15 offset:43008
v_perm_b32 v61, v93, v19, s52
v_mfma_f32_16x16x32_bf16 v[148:151], a[240:243], a[52:55], v[148:151]
ds_read_b32 a74, v61
v_perm_b32 v60, v93, v19, s53
v_mfma_f32_16x16x32_bf16 v[152:155], a[240:243], a[56:59], v[152:155]
s_add_u32 m0, s33, 154240
ds_read_b32 a75, v60
v_perm_b32 v59, v89, v19, s54
v_mfma_f32_16x16x32_bf16 v[156:159], a[240:243], a[60:63], v[156:159]
s_waitcnt lgkmcnt(4)
ds_read_b32 a76, v59
v_perm_b32 v58, v89, v19, s55
v_mfma_f32_16x16x32_bf16 v[160:163], a[244:247], a[48:51], v[160:163]
ds_read_b128 a[252:255], v14 offset:55296
buffer_load_dwordx4 v10, s[20:23], 0 offen offset:1408 lds
v_mfma_f32_16x16x32_bf16 v[164:167], a[244:247], a[52:55], v[164:167]
ds_read_b32 a77, v58
v_perm_b32 v57, v93, v19, s54
v_mfma_f32_16x16x32_bf16 v[168:171], a[244:247], a[56:59], v[168:171]
s_waitcnt vmcnt(11)
v_cmp_ne_u64 s[50:51], s[88:89], v[34:35]
v_cmp_ne_u64 s[44:45], s[88:89], v[38:39]
v_mfma_f32_16x16x32_bf16 v[172:175], a[244:247], a[60:63], v[172:175]
s_waitcnt lgkmcnt(3)
ds_read_b32 a78, v57
v_add_u32 v12, 49152, v13
v_mfma_f32_16x16x32_bf16 v[208:211], a[248:251], a[32:35], v[208:211]
s_or_b64 s[50:51], s[44:45], s[50:51]
ds_read_b128 a[240:243], v15 offset:45056
v_perm_b32 v56, v93, v19, s55
v_mfma_f32_16x16x32_bf16 v[212:215], a[248:251], a[36:39], v[212:215]
s_cbranch_scc1 L_SLOW20
L_BACK20:
v_mfma_f32_16x16x32_bf16 v[216:219], a[248:251], a[40:43], v[216:219]
ds_read_b32 a79, v56
v_perm_b32 v63, v32, v19, s52
v_mfma_f32_16x16x32_bf16 v[220:223], a[248:251], a[44:47], v[220:223]
s_waitcnt lgkmcnt(3)
ds_read_b32 a80, v63
v_mfma_f32_16x16x32_bf16 v[176:179], a[252:255], a[48:51], v[176:179]
ds_read_b128 a[244:247], v15 offset:47104
v_perm_b32 v62, v32, v19, s53
v_mfma_f32_16x16x32_bf16 v[180:183], a[252:255], a[52:55], v[180:183]
ds_read_b32 a81, v62
v_perm_b32 v61, v36, v19, s52
v_mfma_f32_16x16x32_bf16 v[184:187], a[252:255], a[56:59], v[184:187]
s_add_u32 m0, s33, 158464
ds_read_b32 a82, v61
v_perm_b32 v60, v36, v19, s53
v_mfma_f32_16x16x32_bf16 v[188:191], a[252:255], a[60:63], v[188:191]
s_waitcnt lgkmcnt(4)
ds_read_b32 a83, v60
v_perm_b32 v59, v32, v19, s54
v_mfma_f32_16x16x32_bf16 v[128:131], a[240:243], a[64:67], v[128:131]
ds_read_b128 a[248:251], v14 offset:57344
buffer_load_dwordx4 v11, s[20:23], 0 offen offset:1280 lds
v_mfma_f32_16x16x32_bf16 v[132:135], a[240:243], a[68:71], v[132:135]
ds_read_b32 a84, v59
v_perm_b32 v58, v32, v19, s55
v_mfma_f32_16x16x32_bf16 v[136:139], a[240:243], a[72:75], v[136:139]
ds_read_b32 a85, v58
v_perm_b32 v57, v36, v19, s54
v_mfma_f32_16x16x32_bf16 v[140:143], a[240:243], a[76:79], v[140:143]
s_waitcnt lgkmcnt(4)
ds_read_b32 a86, v57
buffer_load_dwordx4 v[80:83], v12, s[24:27], 0 offen offset:0 sc1
v_mfma_f32_16x16x32_bf16 v[144:147], a[244:247], a[64:67], v[144:147]
ds_read_b128 a[252:255], v15 offset:53248
v_perm_b32 v56, v36, v19, s55
v_mfma_f32_16x16x32_bf16 v[148:151], a[244:247], a[68:71], v[148:151]
ds_read_b32 a87, v56
v_perm_b32 v63, v33, v19, s52
v_mfma_f32_16x16x32_bf16 v[152:155], a[244:247], a[72:75], v[152:155]
ds_read_b32 a88, v63
v_perm_b32 v62, v33, v19, s53
v_mfma_f32_16x16x32_bf16 v[156:159], a[244:247], a[76:79], v[156:159]
s_waitcnt lgkmcnt(4)
ds_read_b32 a89, v62
buffer_load_dwordx4 v[84:87], v12, s[24:27], 0 offen offset:1024 sc1
v_mfma_f32_16x16x32_bf16 v[192:195], a[248:251], a[48:51], v[192:195]
ds_read_b128 a[240:243], v15 offset:30720
v_perm_b32 v61, v37, v19, s52
v_mfma_f32_16x16x32_bf16 v[196:199], a[248:251], a[52:55], v[196:199]
ds_read_b32 a90, v61
v_perm_b32 v60, v37, v19, s53
v_mfma_f32_16x16x32_bf16 v[200:203], a[248:251], a[56:59], v[200:203]
s_add_u32 m0, s33, 64000
ds_read_b32 a91, v60
v_perm_b32 v59, v33, v19, s54
v_mfma_f32_16x16x32_bf16 v[204:207], a[248:251], a[60:63], v[204:207]
s_waitcnt lgkmcnt(4)
ds_read_b32 a92, v59
v_perm_b32 v58, v33, v19, s55
v_mfma_f32_16x16x32_bf16 v[160:163], a[252:255], a[64:67], v[160:163]
ds_read_b128 a[244:247], v15 offset:49152
buffer_load_dwordx4 v9, s[20:23], 0 offen offset:1536 lds
v_mfma_f32_16x16x32_bf16 v[164:167], a[252:255], a[68:71], v[164:167]
ds_read_b32 a93, v58
v_perm_b32 v57, v37, v19, s54
v_mfma_f32_16x16x32_bf16 v[168:171], a[252:255], a[72:75], v[168:171]
s_waitcnt vmcnt(11)
v_cmp_ne_u64 s[50:51], s[88:89], v[42:43]
v_cmp_ne_u64 s[44:45], s[88:89], v[46:47]
v_mfma_f32_16x16x32_bf16 v[172:175], a[252:255], a[76:79], v[172:175]
s_waitcnt lgkmcnt(3)
ds_read_b32 a94, v57
v_mfma_f32_16x16x32_bf16 v[240:243], a[240:243], a[0:3], v[240:243]
s_or_b64 s[50:51], s[44:45], s[50:51]
ds_read_b128 a[248:251], v14 offset:61440
v_perm_b32 v56, v37, v19, s55
v_mfma_f32_16x16x32_bf16 v[244:247], a[240:243], a[4:7], v[244:247]
s_cbranch_scc1 L_SLOW21
L_BACK21:
v_mfma_f32_16x16x32_bf16 v[248:251], a[240:243], a[8:11], v[248:251]
ds_read_b32 a95, v56
v_perm_b32 v63, v40, v19, s52
v_mfma_f32_16x16x32_bf16 v[252:255], a[240:243], a[12:15], v[252:255]
s_waitcnt lgkmcnt(3)
ds_read_b32 a96, v63
v_mfma_f32_16x16x32_bf16 v[224:227], a[244:247], a[32:35], v[224:227]
ds_read_b128 a[252:255], v15 offset:55296
v_perm_b32 v62, v40, v19, s53
v_mfma_f32_16x16x32_bf16 v[228:231], a[244:247], a[36:39], v[228:231]
ds_read_b32 a97, v62
v_perm_b32 v61, v44, v19, s52
v_mfma_f32_16x16x32_bf16 v[232:235], a[244:247], a[40:43], v[232:235]
ds_read_b32 a98, v61
v_perm_b32 v60, v44, v19, s53
v_mfma_f32_16x16x32_bf16 v[236:239], a[244:247], a[44:47], v[236:239]
s_waitcnt lgkmcnt(4)
ds_read_b32 a99, v60
v_mfma_f32_16x16x32_bf16 v[128:131], a[248:251], a[80:83], v[128:131]
ds_read_b128 a[240:243], v14 offset:59392
v_perm_b32 v59, v40, v19, s54
v_mfma_f32_16x16x32_bf16 v[132:135], a[248:251], a[84:87], v[132:135]
ds_read_b32 a100, v59
v_perm_b32 v58, v40, v19, s55
v_mfma_f32_16x16x32_bf16 v[136:139], a[248:251], a[88:91], v[136:139]
s_add_u32 m0, s33, 67968
ds_read_b32 a101, v58
v_perm_b32 v57, v44, v19, s54
v_mfma_f32_16x16x32_bf16 v[140:143], a[248:251], a[92:95], v[140:143]
s_waitcnt lgkmcnt(4)
ds_read_b32 a102, v57
v_perm_b32 v56, v44, v19, s55
v_mfma_f32_16x16x32_bf16 v[176:179], a[252:255], a[64:67], v[176:179]
ds_read_b128 a[244:247], v14 offset:63488
buffer_load_dwordx4 v8, s[20:23], 0 offen offset:1664 lds
v_mfma_f32_16x16x32_bf16 v[180:183], a[252:255], a[68:71], v[180:183]
ds_read_b32 a103, v56
v_perm_b32 v63, v41, v19, s52
v_mfma_f32_16x16x32_bf16 v[184:187], a[252:255], a[72:75], v[184:187]
ds_read_b32 a104, v63
v_perm_b32 v62, v41, v19, s53
v_mfma_f32_16x16x32_bf16 v[188:191], a[252:255], a[76:79], v[188:191]
s_waitcnt lgkmcnt(4)
ds_read_b32 a105, v62
buffer_load_dwordx4 v[88:91], v12, s[24:27], 0 offen offset:2048 sc1
v_mfma_f32_16x16x32_bf16 v[208:211], a[240:243], a[48:51], v[208:211]
ds_read_b128 a[248:251], v15 offset:57344
v_perm_b32 v61, v45, v19, s52
v_mfma_f32_16x16x32_bf16 v[212:215], a[240:243], a[52:55], v[212:215]
ds_read_b32 a106, v61
v_perm_b32 v60, v45, v19, s53
v_mfma_f32_16x16x32_bf16 v[216:219], a[240:243], a[56:59], v[216:219]
s_add_u32 m0, s33, 72192
ds_read_b32 a107, v60
v_perm_b32 v59, v41, v19, s54
v_mfma_f32_16x16x32_bf16 v[220:223], a[240:243], a[60:63], v[220:223]
s_waitcnt lgkmcnt(4)
ds_read_b32 a108, v59
v_perm_b32 v58, v41, v19, s55
v_mfma_f32_16x16x32_bf16 v[144:147], a[244:247], a[80:83], v[144:147]
ds_read_b128 a[252:255], v16 offset:0
buffer_load_dwordx4 v10, s[20:23], 0 offen offset:1536 lds
v_mfma_f32_16x16x32_bf16 v[148:151], a[244:247], a[84:87], v[148:151]
ds_read_b32 a109, v58
v_perm_b32 v57, v45, v19, s54
v_mfma_f32_16x16x32_bf16 v[152:155], a[244:247], a[88:91], v[152:155]
ds_read_b32 a110, v57
buffer_load_dwordx4 v[92:95], v12, s[24:27], 0 offen offset:3072 sc1
v_mfma_f32_16x16x32_bf16 v[156:159], a[244:247], a[92:95], v[156:159]
s_waitcnt vmcnt(12) lgkmcnt(4)
v_cmp_ne_u64 s[50:51], s[88:89], v[50:51]
v_cmp_ne_u64 s[44:45], s[88:89], v[54:55]
v_mfma_f32_16x16x32_bf16 v[192:195], a[248:251], a[64:67], v[192:195]
s_barrier
ds_read_b128 a[240:243], v15 offset:61440
v_perm_b32 v56, v45, v19, s55
v_mfma_f32_16x16x32_bf16 v[196:199], a[248:251], a[68:71], v[196:199]
s_or_b64 s[50:51], s[44:45], s[50:51]
ds_read_b32 a111, v56
v_add_u32 v12, 53248, v13
v_mfma_f32_16x16x32_bf16 v[200:203], a[248:251], a[72:75], v[200:203]
s_cbranch_scc1 L_SLOW22
L_BACK22:
v_mfma_f32_16x16x32_bf16 v[204:207], a[248:251], a[76:79], v[204:207]
s_waitcnt lgkmcnt(2)
v_mfma_f32_16x16x32_bf16 v[160:163], a[252:255], a[80:83], v[160:163]
ds_read_b128 a[244:247], v16 offset:2048
v_mfma_f32_16x16x32_bf16 v[164:167], a[252:255], a[84:87], v[164:167]
v_perm_b32 v63, v48, v19, s52
v_mfma_f32_16x16x32_bf16 v[168:171], a[252:255], a[88:91], v[168:171]
ds_read_b32 a112, v63
v_perm_b32 v62, v48, v19, s53
v_mfma_f32_16x16x32_bf16 v[172:175], a[252:255], a[92:95], v[172:175]
s_waitcnt lgkmcnt(2)
ds_read_b32 a113, v62
v_mfma_f32_16x16x32_bf16 v[128:131], a[240:243], a[96:99], v[128:131]
ds_read_b128 a[248:251], v16 offset:4096
v_perm_b32 v61, v52, v19, s52
v_mfma_f32_16x16x32_bf16 v[132:135], a[240:243], a[100:103], v[132:135]
ds_read_b32 a114, v61
v_perm_b32 v60, v52, v19, s53
v_mfma_f32_16x16x32_bf16 v[136:139], a[240:243], a[104:107], v[136:139]
s_add_u32 m0, s33, 76160
ds_read_b32 a115, v60
v_perm_b32 v59, v48, v19, s54
v_mfma_f32_16x16x32_bf16 v[140:143], a[240:243], a[108:111], v[140:143]
s_waitcnt lgkmcnt(4)
ds_read_b32 a116, v59
v_perm_b32 v58, v48, v19, s55
v_mfma_f32_16x16x32_bf16 v[176:179], a[244:247], a[80:83], v[176:179]
ds_read_b128 a[252:255], v15 offset:63488
buffer_load_dwordx4 v9, s[20:23], 0 offen offset:1664 lds
v_mfma_f32_16x16x32_bf16 v[180:183], a[244:247], a[84:87], v[180:183]
ds_read_b32 a117, v58
v_perm_b32 v57, v52, v19, s54
v_mfma_f32_16x16x32_bf16 v[184:187], a[244:247], a[88:91], v[184:187]
ds_read_b32 a118, v57
v_perm_b32 v56, v52, v19, s55
v_mfma_f32_16x16x32_bf16 v[188:191], a[244:247], a[92:95], v[188:191]
s_waitcnt lgkmcnt(4)
ds_read_b32 a119, v56
buffer_load_dwordx4 v[32:35], v12, s[24:27], 0 offen offset:0 sc1
v_mfma_f32_16x16x32_bf16 v[224:227], a[248:251], a[48:51], v[224:227]
ds_read_b128 a[240:243], v15 offset:59392
v_perm_b32 v63, v49, v19, s52
v_mfma_f32_16x16x32_bf16 v[228:231], a[248:251], a[52:55], v[228:231]
ds_read_b32 a120, v63
v_perm_b32 v62, v49, v19, s53
v_mfma_f32_16x16x32_bf16 v[232:235], a[248:251], a[56:59], v[232:235]
ds_read_b32 a121, v62
v_perm_b32 v61, v53, v19, s52
v_mfma_f32_16x16x32_bf16 v[236:239], a[248:251], a[60:63], v[236:239]
s_waitcnt lgkmcnt(4)
ds_read_b32 a122, v61
buffer_load_dwordx4 v[36:39], v12, s[24:27], 0 offen offset:1024 sc1
v_mfma_f32_16x16x32_bf16 v[144:147], a[252:255], a[96:99], v[144:147]
ds_read_b128 a[244:247], v17 offset:0
v_perm_b32 v60, v53, v19, s53
v_mfma_f32_16x16x32_bf16 v[148:151], a[252:255], a[100:103], v[148:151]
ds_read_b32 a123, v60
v_perm_b32 v59, v49, v19, s54
v_mfma_f32_16x16x32_bf16 v[152:155], a[252:255], a[104:107], v[152:155]
s_add_u32 m0, s33, 80512
ds_read_b32 a124, v59
v_perm_b32 v58, v49, v19, s55
v_mfma_f32_16x16x32_bf16 v[156:159], a[252:255], a[108:111], v[156:159]
s_waitcnt vmcnt(12) lgkmcnt(4)
v_cmp_ne_u64 s[50:51], s[88:89], v[98:99]
v_cmp_ne_u64 s[44:45], s[88:89], v[102:103]
v_mfma_f32_16x16x32_bf16 v[208:211], a[240:243], a[64:67], v[208:211]
ds_read_b128 a[248:251], v16 offset:8192
buffer_load_dwordx4 v11, s[20:23], 0 offen offset:1408 lds
v_mfma_f32_16x16x32_bf16 v[212:215], a[240:243], a[68:71], v[212:215]
s_or_b64 s[50:51], s[44:45], s[50:51]
ds_read_b32 a125, v58
v_perm_b32 v57, v53, v19, s54
v_mfma_f32_16x16x32_bf16 v[216:219], a[240:243], a[72:75], v[216:219]
s_cbranch_scc1 L_SLOW23
L_BACK23:
v_mfma_f32_16x16x32_bf16 v[220:223], a[240:243], a[76:79], v[220:223]
s_waitcnt lgkmcnt(2)
ds_read_b32 a126, v57
v_mfma_f32_16x16x32_bf16 v[160:163], a[244:247], a[96:99], v[160:163]
ds_read_b128 a[252:255], v16 offset:12288
v_perm_b32 v56, v53, v19, s55
v_mfma_f32_16x16x32_bf16 v[164:167], a[244:247], a[100:103], v[164:167]
ds_read_b32 a127, v56
v_perm_b32 v63, v96, v19, s52
v_mfma_f32_16x16x32_bf16 v[168:171], a[244:247], a[104:107], v[168:171]
ds_read_b32 a128, v63
v_perm_b32 v62, v96, v19, s53
v_mfma_f32_16x16x32_bf16 v[172:175], a[244:247], a[108:111], v[172:175]
s_waitcnt lgkmcnt(4)
ds_read_b32 a129, v62
v_mfma_f32_16x16x32_bf16 v[192:195], a[248:251], a[80:83], v[192:195]
ds_read_b128 a[240:243], v14 offset:51200
v_perm_b32 v61, v100, v19, s52
v_mfma_f32_16x16x32_bf16 v[196:199], a[248:251], a[84:87], v[196:199]
ds_read_b32 a130, v61
v_perm_b32 v60, v100, v19, s53
v_mfma_f32_16x16x32_bf16 v[200:203], a[248:251], a[88:91], v[200:203]
s_add_u32 m0, s33, 84224
ds_read_b32 a131, v60
v_perm_b32 v59, v96, v19, s54
v_mfma_f32_16x16x32_bf16 v[204:207], a[248:251], a[92:95], v[204:207]
s_waitcnt lgkmcnt(4)
ds_read_b32 a132, v59
v_perm_b32 v58, v96, v19, s55
v_mfma_f32_16x16x32_bf16 v[128:131], a[252:255], a[112:115], v[128:131]
ds_read_b128 a[244:247], v16 offset:14336
buffer_load_dwordx4 v8, s[20:23], 0 offen offset:1792 lds
v_mfma_f32_16x16x32_bf16 v[132:135], a[252:255], a[116:119], v[132:135]
ds_read_b32 a133, v58
v_perm_b32 v57, v100, v19, s54
v_mfma_f32_16x16x32_bf16 v[136:139], a[252:255], a[120:123], v[136:139]
ds_read_b32 a134, v57
v_perm_b32 v56, v100, v19, s55
v_mfma_f32_16x16x32_bf16 v[140:143], a[252:255], a[124:127], v[140:143]
s_waitcnt lgkmcnt(4)
ds_read_b32 a135, v56
buffer_load_dwordx4 v[40:43], v12, s[24:27], 0 offen offset:2048 sc1
v_mfma_f32_16x16x32_bf16 v[240:243], a[240:243], a[16:19], v[240:243]
ds_read_b128 a[248:251], v17 offset:2048
v_perm_b32 v63, v97, v19, s52
v_mfma_f32_16x16x32_bf16 v[244:247], a[240:243], a[20:23], v[244:247]
ds_read_b32 a136, v63
v_perm_b32 v62, v97, v19, s53
v_mfma_f32_16x16x32_bf16 v[248:251], a[240:243], a[24:27], v[248:251]
ds_read_b32 a137, v62
v_perm_b32 v61, v101, v19, s52
v_mfma_f32_16x16x32_bf16 v[252:255], a[240:243], a[28:31], v[252:255]
s_waitcnt lgkmcnt(4)
ds_read_b32 a138, v61
buffer_load_dwordx4 v[44:47], v12, s[24:27], 0 offen offset:3072 sc1
v_mfma_f32_16x16x32_bf16 v[144:147], a[244:247], a[112:115], v[144:147]
ds_read_b128 a[252:255], v17 offset:4096
v_perm_b32 v60, v101, v19, s53
v_mfma_f32_16x16x32_bf16 v[148:151], a[244:247], a[116:119], v[148:151]
ds_read_b32 a139, v60
v_perm_b32 v59, v97, v19, s54
v_mfma_f32_16x16x32_bf16 v[152:155], a[244:247], a[120:123], v[152:155]
s_waitcnt vmcnt(12)
v_cmp_ne_u64 s[50:51], s[88:89], v[82:83]
v_cmp_ne_u64 s[44:45], s[88:89], v[86:87]
v_mfma_f32_16x16x32_bf16 v[156:159], a[244:247], a[124:127], v[156:159]
s_waitcnt lgkmcnt(3)
ds_read_b32 a140, v59
v_add_u32 v12, 57344, v13
v_mfma_f32_16x16x32_bf16 v[176:179], a[248:251], a[96:99], v[176:179]
s_or_b64 s[50:51], s[44:45], s[50:51]
ds_read_b128 a[240:243], v16 offset:16384
v_perm_b32 v58, v97, v19, s55
v_mfma_f32_16x16x32_bf16 v[180:183], a[248:251], a[100:103], v[180:183]
s_cbranch_scc1 L_SLOW24
L_BACK24:
v_mfma_f32_16x16x32_bf16 v[184:187], a[248:251], a[104:107], v[184:187]
s_add_u32 m0, s33, 88448
ds_read_b32 a141, v58
v_perm_b32 v57, v101, v19, s54
v_mfma_f32_16x16x32_bf16 v[188:191], a[248:251], a[108:111], v[188:191]
s_waitcnt lgkmcnt(3)
ds_read_b32 a142, v57
v_perm_b32 v56, v101, v19, s55
v_mfma_f32_16x16x32_bf16 v[224:227], a[252:255], a[64:67], v[224:227]
ds_read_b128 a[244:247], v16 offset:10240
buffer_load_dwordx4 v10, s[20:23], 0 offen offset:1664 lds
v_mfma_f32_16x16x32_bf16 v[228:231], a[252:255], a[68:71], v[228:231]
ds_read_b32 a143, v56
v_perm_b32 v63, v80, v19, s52
v_mfma_f32_16x16x32_bf16 v[232:235], a[252:255], a[72:75], v[232:235]
ds_read_b32 a144, v63
v_perm_b32 v62, v80, v19, s53
v_mfma_f32_16x16x32_bf16 v[236:239], a[252:255], a[76:79], v[236:239]
s_waitcnt lgkmcnt(4)
ds_read_b32 a145, v62
v_mfma_f32_16x16x32_bf16 v[160:163], a[240:243], a[112:115], v[160:163]
ds_read_b128 a[248:251], v17 offset:12288
v_perm_b32 v61, v84, v19, s52
v_mfma_f32_16x16x32_bf16 v[164:167], a[240:243], a[116:119], v[164:167]
ds_read_b32 a146, v61
v_perm_b32 v60, v84, v19, s53
v_mfma_f32_16x16x32_bf16 v[168:171], a[240:243], a[120:123], v[168:171]
s_add_u32 m0, s33, 92416
ds_read_b32 a147, v60
v_perm_b32 v59, v80, v19, s54
v_mfma_f32_16x16x32_bf16 v[172:175], a[240:243], a[124:127], v[172:175]
s_waitcnt lgkmcnt(4)
ds_read_b32 a148, v59
v_perm_b32 v58, v80, v19, s55
v_mfma_f32_16x16x32_bf16 v[208:211], a[244:247], a[80:83], v[208:211]
ds_read_b128 a[252:255], v17 offset:8192
buffer_load_dwordx4 v9, s[20:23], 0 offen offset:1792 lds
v_mfma_f32_16x16x32_bf16 v[212:215], a[244:247], a[84:87], v[212:215]
ds_read_b32 a149, v58
v_perm_b32 v57, v84, v19, s54
v_mfma_f32_16x16x32_bf16 v[216:219], a[244:247], a[88:91], v[216:219]
ds_read_b32 a150, v57
v_perm_b32 v56, v84, v19, s55
v_mfma_f32_16x16x32_bf16 v[220:223], a[244:247], a[92:95], v[220:223]
s_waitcnt lgkmcnt(4)
ds_read_b32 a151, v56
v_mfma_f32_16x16x32_bf16 v[128:131], a[248:251], a[128:131], v[128:131]
s_waitcnt vmcnt(13)
s_barrier
ds_read_b128 a[240:243], v17 offset:14336
v_perm_b32 v63, v81, v19, s52
v_mfma_f32_16x16x32_bf16 v[132:135], a[248:251], a[132:135], v[132:135]
ds_read_b32 a152, v63
v_perm_b32 v62, v81, v19, s53
v_mfma_f32_16x16x32_bf16 v[136:139], a[248:251], a[136:139], v[136:139]
ds_read_b32 a153, v62
v_perm_b32 v61, v85, v19, s52
v_mfma_f32_16x16x32_bf16 v[140:143], a[248:251], a[140:143], v[140:143]
s_waitcnt lgkmcnt(4)
ds_read_b32 a154, v61
buffer_load_dwordx4 v[48:51], v12, s[24:27], 0 offen offset:0 sc1
v_mfma_f32_16x16x32_bf16 v[192:195], a[252:255], a[96:99], v[192:195]
ds_read_b128 a[244:247], v16 offset:18432
v_perm_b32 v60, v85, v19, s53
v_mfma_f32_16x16x32_bf16 v[196:199], a[252:255], a[100:103], v[196:199]
ds_read_b32 a155, v60
v_perm_b32 v59, v81, v19, s54
v_mfma_f32_16x16x32_bf16 v[200:203], a[252:255], a[104:107], v[200:203]
ds_read_b32 a156, v59
v_perm_b32 v58, v81, v19, s55
v_mfma_f32_16x16x32_bf16 v[204:207], a[252:255], a[108:111], v[204:207]
s_waitcnt lgkmcnt(4)
ds_read_b32 a157, v58
buffer_load_dwordx4 v[52:55], v12, s[24:27], 0 offen offset:1024 sc1
v_mfma_f32_16x16x32_bf16 v[144:147], a[240:243], a[128:131], v[144:147]
L_PAD4:
s_cbranch_vccnz L_PAD5
ds_read_b128 a[248:251], v16 offset:20480
v_perm_b32 v57, v85, v19, s54
v_mfma_f32_16x16x32_bf16 v[148:151], a[240:243], a[132:135], v[148:151]
ds_read_b32 a158, v57
v_perm_b32 v56, v85, v19, s55
v_mfma_f32_16x16x32_bf16 v[152:155], a[240:243], a[136:139], v[152:155]
s_add_u32 m0, s33, 96384
ds_read_b32 a159, v56
v_mfma_f32_16x16x32_bf16 v[156:159], a[240:243], a[140:143], v[156:159]
s_waitcnt vmcnt(11) lgkmcnt(4)
v_cmp_ne_u64 s[50:51], s[88:89], v[90:91]
v_cmp_ne_u64 s[44:45], s[88:89], v[94:95]
v_mfma_f32_16x16x32_bf16 v[176:179], a[244:247], a[112:115], v[176:179]
ds_read_b128 a[252:255], v17 offset:16384
buffer_load_dwordx4 v8, s[20:23], 0 offen offset:1920 lds
v_mfma_f32_16x16x32_bf16 v[180:183], a[244:247], a[116:119], v[180:183]
s_or_b64 s[50:51], s[44:45], s[50:51]
v_mfma_f32_16x16x32_bf16 v[184:187], a[244:247], a[120:123], v[184:187]
s_cbranch_scc1 L_SLOW25
L_BACK25:
v_mfma_f32_16x16x32_bf16 v[188:191], a[244:247], a[124:127], v[188:191]
s_waitcnt lgkmcnt(1)
v_mfma_f32_16x16x32_bf16 v[128:131], a[248:251], a[144:147], v[128:131]
ds_read_b128 a[240:243], v17 offset:10240
v_perm_b32 v63, v88, v19, s52
v_mfma_f32_16x16x32_bf16 v[132:135], a[248:251], a[148:151], v[132:135]
ds_read_b32 a160, v63
v_perm_b32 v62, v88, v19, s53
v_mfma_f32_16x16x32_bf16 v[136:139], a[248:251], a[152:155], v[136:139]
ds_read_b32 a161, v62
v_perm_b32 v61, v92, v19, s52
v_mfma_f32_16x16x32_bf16 v[140:143], a[248:251], a[156:159], v[140:143]
s_waitcnt lgkmcnt(3)
ds_read_b32 a162, v61
v_mfma_f32_16x16x32_bf16 v[160:163], a[252:255], a[128:131], v[160:163]
ds_read_b128 a[244:247], v16 offset:24576
v_perm_b32 v60, v92, v19, s53
v_mfma_f32_16x16x32_bf16 v[164:167], a[252:255], a[132:135], v[164:167]
ds_read_b32 a163, v60
v_perm_b32 v59, v88, v19, s54
v_mfma_f32_16x16x32_bf16 v[168:171], a[252:255], a[136:139], v[168:171]
s_add_u32 m0, s33, 100864
ds_read_b32 a164, v59
v_perm_b32 v58, v88, v19, s55
v_mfma_f32_16x16x32_bf16 v[172:175], a[252:255], a[140:143], v[172:175]
s_waitcnt lgkmcnt(4)
ds_read_b32 a165, v58
v_perm_b32 v57, v92, v19, s54
v_mfma_f32_16x16x32_bf16 v[208:211], a[240:243], a[96:99], v[208:211]
ds_read_b128 a[248:251], v16 offset:28672
buffer_load_dwordx4 v11, s[20:23], 0 offen offset:1536 lds
v_mfma_f32_16x16x32_bf16 v[212:215], a[240:243], a[100:103], v[212:215]
ds_read_b32 a166, v57
v_perm_b32 v56, v92, v19, s55
v_mfma_f32_16x16x32_bf16 v[216:219], a[240:243], a[104:107], v[216:219]
ds_read_b32 a167, v56
v_perm_b32 v63, v89, v19, s52
v_mfma_f32_16x16x32_bf16 v[220:223], a[240:243], a[108:111], v[220:223]
s_waitcnt lgkmcnt(4)
ds_read_b32 a168, v63
buffer_load_dwordx4 v[96:99], v12, s[24:27], 0 offen offset:2048 sc1
v_mfma_f32_16x16x32_bf16 v[192:195], a[244:247], a[112:115], v[192:195]
ds_read_b128 a[252:255], v16 offset:22528
v_perm_b32 v62, v89, v19, s53
v_mfma_f32_16x16x32_bf16 v[196:199], a[244:247], a[116:119], v[196:199]
ds_read_b32 a169, v62
v_perm_b32 v61, v93, v19, s52
v_mfma_f32_16x16x32_bf16 v[200:203], a[244:247], a[120:123], v[200:203]
ds_read_b32 a170, v61
v_perm_b32 v60, v93, v19, s53
v_mfma_f32_16x16x32_bf16 v[204:207], a[244:247], a[124:127], v[204:207]
s_waitcnt lgkmcnt(4)
ds_read_b32 a171, v60
buffer_load_dwordx4 v[100:103], v12, s[24:27], 0 offen offset:3072 sc1
v_mfma_f32_16x16x32_bf16 v[224:227], a[248:251], a[80:83], v[224:227]
ds_read_b128 a[240:243], v17 offset:18432
v_perm_b32 v59, v89, v19, s54
v_mfma_f32_16x16x32_bf16 v[228:231], a[248:251], a[84:87], v[228:231]
ds_read_b32 a172, v59
v_perm_b32 v58, v89, v19, s55
v_mfma_f32_16x16x32_bf16 v[232:235], a[248:251], a[88:91], v[232:235]
s_add_u32 m0, s33, 104576
ds_read_b32 a173, v58
v_perm_b32 v57, v93, v19, s54
v_mfma_f32_16x16x32_bf16 v[236:239], a[248:251], a[92:95], v[236:239]
s_waitcnt vmcnt(12) lgkmcnt(4)
v_cmp_ne_u64 s[50:51], s[88:89], v[34:35]
v_cmp_ne_u64 s[44:45], s[88:89], v[38:39]
v_mfma_f32_16x16x32_bf16 v[144:147], a[252:255], a[144:147], v[144:147]
ds_read_b128 a[244:247], v15 offset:51200
buffer_load_dwordx4 v9, s[20:23], 0 offen offset:1920 lds
v_mfma_f32_16x16x32_bf16 v[148:151], a[252:255], a[148:151], v[148:151]
s_or_b64 s[50:51], s[44:45], s[50:51]
ds_read_b32 a174, v57
v_perm_b32 v56, v93, v19, s55
v_mfma_f32_16x16x32_bf16 v[152:155], a[252:255], a[152:155], v[152:155]
s_cbranch_scc1 L_SLOW26
L_BACK26:
v_mfma_f32_16x16x32_bf16 v[156:159], a[252:255], a[156:159], v[156:159]
s_waitcnt lgkmcnt(2)
ds_read_b32 a175, v56
v_add_u32 v12, 61440, v13
v_mfma_f32_16x16x32_bf16 v[176:179], a[240:243], a[128:131], v[176:179]
ds_read_b128 a[248:251], v17 offset:20480
v_perm_b32 v63, v32, v19, s52
v_mfma_f32_16x16x32_bf16 v[180:183], a[240:243], a[132:135], v[180:183]
ds_read_b32 a176, v63
v_perm_b32 v62, v32, v19, s53
v_mfma_f32_16x16x32_bf16 v[184:187], a[240:243], a[136:139], v[184:187]
ds_read_b32 a177, v62
v_perm_b32 v61, v36, v19, s52
v_mfma_f32_16x16x32_bf16 v[188:191], a[240:243], a[140:143], v[188:191]
s_waitcnt lgkmcnt(4)
ds_read_b32 a178, v61
v_mfma_f32_16x16x32_bf16 v[240:243], a[244:247], a[32:35], v[240:243]
ds_read_b128 a[252:255], v14 offset:0
v_perm_b32 v60, v36, v19, s53
v_mfma_f32_16x16x32_bf16 v[244:247], a[244:247], a[36:39], v[244:247]
ds_read_b32 a179, v60
v_perm_b32 v59, v32, v19, s54
v_mfma_f32_16x16x32_bf16 v[248:251], a[244:247], a[40:43], v[248:251]
ds_read_b32 a180, v59
v_perm_b32 v58, v32, v19, s55
v_mfma_f32_16x16x32_bf16 v[252:255], a[244:247], a[44:47], v[252:255]
s_waitcnt lgkmcnt(4)
ds_read_b32 a181, v58
v_mfma_f32_16x16x32_bf16 v[128:131], a[248:251], a[160:163], v[128:131]
ds_read_b128 a[240:243], v17 offset:22528
v_perm_b32 v57, v36, v19, s54
v_mfma_f32_16x16x32_bf16 v[132:135], a[248:251], a[164:167], v[132:135]
ds_read_b32 a182, v57
v_perm_b32 v56, v36, v19, s55
v_mfma_f32_16x16x32_bf16 v[136:139], a[248:251], a[168:171], v[136:139]
ds_read_b32 a183, v56
v_perm_b32 v63, v33, v19, s52
v_mfma_f32_16x16x32_bf16 v[140:143], a[248:251], a[172:175], v[140:143]
s_waitcnt lgkmcnt(4)
ds_read_b32 a184, v63
v_mfma_f32_16x16x32_bf16 v[160:163], a[252:255], a[144:147], v[160:163]
ds_read_b128 a[244:247], v17 offset:24576
v_perm_b32 v62, v33, v19, s53
v_mfma_f32_16x16x32_bf16 v[164:167], a[252:255], a[148:151], v[164:167]
ds_read_b32 a185, v62
v_perm_b32 v61, v37, v19, s52
v_mfma_f32_16x16x32_bf16 v[168:171], a[252:255], a[152:155], v[168:171]
ds_read_b32 a186, v61
v_perm_b32 v60, v37, v19, s53
v_mfma_f32_16x16x32_bf16 v[172:175], a[252:255], a[156:159], v[172:175]
s_waitcnt lgkmcnt(4)
ds_read_b32 a187, v60
buffer_load_dwordx4 v[80:83], v12, s[24:27], 0 offen offset:0 sc1
v_mfma_f32_16x16x32_bf16 v[144:147], a[240:243], a[160:163], v[144:147]
ds_read_b128 a[248:251], v16 offset:26624
v_perm_b32 v59, v33, v19, s54
v_mfma_f32_16x16x32_bf16 v[148:151], a[240:243], a[164:167], v[148:151]
ds_read_b32 a188, v59
v_perm_b32 v58, v33, v19, s55
v_mfma_f32_16x16x32_bf16 v[152:155], a[240:243], a[168:171], v[152:155]
ds_read_b32 a189, v58
buffer_load_dwordx4 v[84:87], v12, s[24:27], 0 offen offset:1024 sc1
v_mfma_f32_16x16x32_bf16 v[156:159], a[240:243], a[172:175], v[156:159]
s_waitcnt vmcnt(11) lgkmcnt(4)
v_cmp_ne_u64 s[50:51], s[88:89], v[42:43]
v_cmp_ne_u64 s[44:45], s[88:89], v[46:47]
v_mfma_f32_16x16x32_bf16 v[192:195], a[244:247], a[128:131], v[192:195]
ds_read_b128 a[252:255], v14 offset:2048
v_perm_b32 v57, v37, v19, s54
v_mfma_f32_16x16x32_bf16 v[196:199], a[244:247], a[132:135], v[196:199]
s_or_b64 s[50:51], s[44:45], s[50:51]
ds_read_b32 a190, v57
v_perm_b32 v56, v37, v19, s55
v_mfma_f32_16x16x32_bf16 v[200:203], a[244:247], a[136:139], v[200:203]
s_cbranch_scc1 L_SLOW27
L_BACK27:
v_mfma_f32_16x16x32_bf16 v[204:207], a[244:247], a[140:143], v[204:207]
s_waitcnt lgkmcnt(2)
ds_read_b32 a191, v56
v_mfma_f32_16x16x32_bf16 v[208:211], a[248:251], a[112:115], v[208:211]
s_barrier
ds_read_b128 a[240:243], v17 offset:28672
v_perm_b32 v63, v40, v19, s52
v_mfma_f32_16x16x32_bf16 v[212:215], a[248:251], a[116:119], v[212:215]
ds_read_b32 a192, v63
v_perm_b32 v62, v40, v19, s53
v_mfma_f32_16x16x32_bf16 v[216:219], a[248:251], a[120:123], v[216:219]
s_add_u32 m0, s33, 108800
ds_read_b32 a193, v62
v_perm_b32 v61, v44, v19, s52
v_mfma_f32_16x16x32_bf16 v[220:223], a[248:251], a[124:127], v[220:223]
s_waitcnt lgkmcnt(4)
ds_read_b32 a194, v61
v_perm_b32 v60, v44, v19, s53
v_mfma_f32_16x16x32_bf16 v[176:179], a[252:255], a[144:147], v[176:179]
ds_read_b128 a[244:247], v14 offset:4096
buffer_load_dwordx4 v10, s[20:23], 0 offen offset:1792 lds
v_mfma_f32_16x16x32_bf16 v[180:183], a[252:255], a[148:151], v[180:183]
ds_read_b32 a195, v60
v_perm_b32 v59, v40, v19, s54
v_mfma_f32_16x16x32_bf16 v[184:187], a[252:255], a[152:155], v[184:187]
ds_read_b32 a196, v59
v_perm_b32 v58, v40, v19, s55
v_mfma_f32_16x16x32_bf16 v[188:191], a[252:255], a[156:159], v[188:191]
s_waitcnt lgkmcnt(4)
ds_read_b32 a197, v58
v_mfma_f32_16x16x32_bf16 v[224:227], a[240:243], a[96:99], v[224:227]
ds_read_b128 a[248:251], v15 offset:0
v_perm_b32 v57, v44, v19, s54
v_mfma_f32_16x16x32_bf16 v[228:231], a[240:243], a[100:103], v[228:231]
ds_read_b32 a198, v57
v_perm_b32 v56, v44, v19, s55
v_mfma_f32_16x16x32_bf16 v[232:235], a[240:243], a[104:107], v[232:235]
ds_read_b32 a199, v56
v_perm_b32 v63, v41, v19, s52
v_mfma_f32_16x16x32_bf16 v[236:239], a[240:243], a[108:111], v[236:239]
s_waitcnt lgkmcnt(4)
ds_read_b32 a200, v63
v_mfma_f32_16x16x32_bf16 v[128:131], a[244:247], a[176:179], v[128:131]
ds_read_b128 a[252:255], v14 offset:6144
v_perm_b32 v62, v41, v19, s53
v_mfma_f32_16x16x32_bf16 v[132:135], a[244:247], a[180:183], v[132:135]
ds_read_b32 a201, v62
v_perm_b32 v61, v45, v19, s52
v_mfma_f32_16x16x32_bf16 v[136:139], a[244:247], a[184:187], v[136:139]
s_add_u32 m0, s33, 113024
ds_read_b32 a202, v61
v_perm_b32 v60, v45, v19, s53
v_mfma_f32_16x16x32_bf16 v[140:143], a[244:247], a[188:191], v[140:143]
s_waitcnt lgkmcnt(4)
ds_read_b32 a203, v60
v_perm_b32 v59, v41, v19, s54
v_mfma_f32_16x16x32_bf16 v[160:163], a[248:251], a[160:163], v[160:163]
ds_read_b128 a[240:243], v14 offset:8192
buffer_load_dwordx4 v11, s[20:23], 0 offen offset:1664 lds
v_mfma_f32_16x16x32_bf16 v[164:167], a[248:251], a[164:167], v[164:167]
ds_read_b32 a204, v59
v_perm_b32 v58, v41, v19, s55
v_mfma_f32_16x16x32_bf16 v[168:171], a[248:251], a[168:171], v[168:171]
ds_read_b32 a205, v58
v_perm_b32 v57, v45, v19, s54
v_mfma_f32_16x16x32_bf16 v[172:175], a[248:251], a[172:175], v[172:175]
s_waitcnt lgkmcnt(4)
ds_read_b32 a206, v57
buffer_load_dwordx4 v[88:91], v12, s[24:27], 0 offen offset:2048 sc1
v_mfma_f32_16x16x32_bf16 v[144:147], a[252:255], a[176:179], v[144:147]
ds_read_b128 a[244:247], v15 offset:4096
v_perm_b32 v56, v45, v19, s55
v_mfma_f32_16x16x32_bf16 v[148:151], a[252:255], a[180:183], v[148:151]
ds_read_b32 a207, v56
buffer_load_dwordx4 v[92:95], v12, s[24:27], 0 offen offset:3072 sc1
v_mfma_f32_16x16x32_bf16 v[152:155], a[252:255], a[184:187], v[152:155]
s_waitcnt vmcnt(11)
v_cmp_ne_u64 s[50:51], s[88:89], v[50:51]
v_cmp_ne_u64 s[44:45], s[88:89], v[54:55]
v_mfma_f32_16x16x32_bf16 v[156:159], a[252:255], a[188:191], v[156:159]
s_waitcnt lgkmcnt(3)
v_mfma_f32_16x16x32_bf16 v[192:195], a[240:243], a[144:147], v[192:195]
s_or_b64 s[50:51], s[44:45], s[50:51]
ds_read_b128 a[248:251], v15 offset:2048
v_mfma_f32_16x16x32_bf16 v[196:199], a[240:243], a[148:151], v[196:199]
s_cbranch_scc1 L_SLOW28
L_BACK28:
v_mfma_f32_16x16x32_bf16 v[200:203], a[240:243], a[152:155], v[200:203]
s_add_u32 m0, s33, 116864
v_perm_b32 v63, v48, v19, s52
v_mfma_f32_16x16x32_bf16 v[204:207], a[240:243], a[156:159], v[204:207]
s_waitcnt lgkmcnt(1)
ds_read_b32 a208, v63
v_perm_b32 v62, v48, v19, s53
v_mfma_f32_16x16x32_bf16 v[128:131], a[244:247], a[192:195], v[128:131]
ds_read_b128 a[252:255], v17 offset:26624
buffer_load_dwordx4 v10, s[20:23], 0 offen offset:1920 lds
v_mfma_f32_16x16x32_bf16 v[132:135], a[244:247], a[196:199], v[132:135]
ds_read_b32 a209, v62
v_perm_b32 v61, v52, v19, s52
v_mfma_f32_16x16x32_bf16 v[136:139], a[244:247], a[200:203], v[136:139]
ds_read_b32 a210, v61
v_perm_b32 v60, v52, v19, s53
v_mfma_f32_16x16x32_bf16 v[140:143], a[244:247], a[204:207], v[140:143]
s_waitcnt lgkmcnt(4)
ds_read_b32 a211, v60
v_mfma_f32_16x16x32_bf16 v[176:179], a[248:251], a[160:163], v[176:179]
ds_read_b128 a[240:243], v14 offset:12288
v_perm_b32 v59, v48, v19, s54
v_mfma_f32_16x16x32_bf16 v[180:183], a[248:251], a[164:167], v[180:183]
ds_read_b32 a212, v59
v_perm_b32 v58, v48, v19, s55
v_mfma_f32_16x16x32_bf16 v[184:187], a[248:251], a[168:171], v[184:187]
ds_read_b32 a213, v58
v_perm_b32 v57, v52, v19, s54
v_mfma_f32_16x16x32_bf16 v[188:191], a[248:251], a[172:175], v[188:191]
s_waitcnt lgkmcnt(4)
ds_read_b32 a214, v57
v_mfma_f32_16x16x32_bf16 v[208:211], a[252:255], a[128:131], v[208:211]
ds_read_b128 a[244:247], v16 offset:6144
v_perm_b32 v56, v52, v19, s55
v_mfma_f32_16x16x32_bf16 v[212:215], a[252:255], a[132:135], v[212:215]
ds_read_b32 a215, v56
v_perm_b32 v63, v49, v19, s52
v_mfma_f32_16x16x32_bf16 v[216:219], a[252:255], a[136:139], v[216:219]
s_add_u32 m0, s33, 121088
ds_read_b32 a216, v63
v_perm_b32 v62, v49, v19, s53
v_mfma_f32_16x16x32_bf16 v[220:223], a[252:255], a[140:143], v[220:223]
s_waitcnt lgkmcnt(4)
ds_read_b32 a217, v62
v_perm_b32 v61, v53, v19, s52
v_mfma_f32_16x16x32_bf16 v[160:163], a[240:243], a[176:179], v[160:163]
ds_read_b128 a[248:251], v14 offset:16384
buffer_load_dwordx4 v11, s[20:23], 0 offen offset:1792 lds
v_mfma_f32_16x16x32_bf16 v[164:167], a[240:243], a[180:183], v[164:167]
ds_read_b32 a218, v61
v_perm_b32 v60, v53, v19, s53
v_mfma_f32_16x16x32_bf16 v[168:171], a[240:243], a[184:187], v[168:171]
ds_read_b32 a219, v60
v_perm_b32 v59, v49, v19, s54
v_mfma_f32_16x16x32_bf16 v[172:175], a[240:243], a[188:191], v[172:175]
s_waitcnt lgkmcnt(4)
ds_read_b32 a220, v59
v_mfma_f32_16x16x32_bf16 v[240:243], a[244:247], a[48:51], v[240:243]
ds_read_b128 a[252:255], v15 offset:6144
v_perm_b32 v58, v49, v19, s55
v_mfma_f32_16x16x32_bf16 v[244:247], a[244:247], a[52:55], v[244:247]
ds_read_b32 a221, v58
v_perm_b32 v57, v53, v19, s54
v_mfma_f32_16x16x32_bf16 v[248:251], a[244:247], a[56:59], v[248:251]
s_waitcnt vmcnt(9)
v_cmp_ne_u64 s[50:51], s[88:89], v[98:99]
v_cmp_ne_u64 s[44:45], s[88:89], v[102:103]
v_mfma_f32_16x16x32_bf16 v[252:255], a[244:247], a[60:63], v[252:255]
s_waitcnt lgkmcnt(3)
ds_read_b32 a222, v57
v_mfma_f32_16x16x32_bf16 v[224:227], a[248:251], a[112:115], v[224:227]
s_or_b64 s[50:51], s[44:45], s[50:51]
ds_read_b128 a[240:243], v14 offset:20480
v_perm_b32 v56, v53, v19, s55
v_mfma_f32_16x16x32_bf16 v[228:231], a[248:251], a[116:119], v[228:231]
s_cbranch_scc1 L_SLOW29
L_BACK29:
v_mfma_f32_16x16x32_bf16 v[232:235], a[248:251], a[120:123], v[232:235]
s_add_u32 m0, s33, 125056
ds_read_b32 a223, v56
v_mfma_f32_16x16x32_bf16 v[236:239], a[248:251], a[124:127], v[236:239]
s_waitcnt lgkmcnt(3)
v_mfma_f32_16x16x32_bf16 v[144:147], a[252:255], a[192:195], v[144:147]
ds_read_b128 a[244:247], v15 offset:8192
buffer_load_dwordx4 v11, s[20:23], 0 offen offset:1920 lds
v_mfma_f32_16x16x32_bf16 v[148:151], a[252:255], a[196:199], v[148:151]
v_perm_b32 v63, v96, v19, s52
v_mfma_f32_16x16x32_bf16 v[152:155], a[252:255], a[200:203], v[152:155]
ds_read_b32 a224, v63
v_perm_b32 v62, v96, v19, s53
v_mfma_f32_16x16x32_bf16 v[156:159], a[252:255], a[204:207], v[156:159]
s_waitcnt lgkmcnt(2)
ds_read_b32 a225, v62
v_mfma_f32_16x16x32_bf16 v[128:131], a[240:243], a[208:211], v[128:131]
ds_read_b128 a[248:251], v14 offset:14336
v_perm_b32 v61, v100, v19, s52
v_mfma_f32_16x16x32_bf16 v[132:135], a[240:243], a[212:215], v[132:135]
ds_read_b32 a226, v61
v_perm_b32 v60, v100, v19, s53
v_mfma_f32_16x16x32_bf16 v[136:139], a[240:243], a[216:219], v[136:139]
ds_read_b32 a227, v60
v_perm_b32 v59, v96, v19, s54
v_mfma_f32_16x16x32_bf16 v[140:143], a[240:243], a[220:223], v[140:143]
s_waitcnt lgkmcnt(4)
ds_read_b32 a228, v59
v_mfma_f32_16x16x32_bf16 v[192:195], a[244:247], a[160:163], v[192:195]
ds_read_b128 a[252:255], v15 offset:12288
v_perm_b32 v58, v96, v19, s55
v_mfma_f32_16x16x32_bf16 v[196:199], a[244:247], a[164:167], v[196:199]
ds_read_b32 a229, v58
v_perm_b32 v57, v100, v19, s54
v_mfma_f32_16x16x32_bf16 v[200:203], a[244:247], a[168:171], v[200:203]
ds_read_b32 a230, v57
v_perm_b32 v56, v100, v19, s55
v_mfma_f32_16x16x32_bf16 v[204:207], a[244:247], a[172:175], v[204:207]
s_waitcnt lgkmcnt(4)
ds_read_b32 a231, v56
v_mfma_f32_16x16x32_bf16 v[176:179], a[248:251], a[176:179], v[176:179]
s_waitcnt vmcnt(9)
s_barrier
ds_read_b128 a[240:243], v14 offset:10240
v_perm_b32 v63, v97, v19, s52
v_mfma_f32_16x16x32_bf16 v[180:183], a[248:251], a[180:183], v[180:183]
ds_read_b32 a232, v63
v_perm_b32 v62, v97, v19, s53
v_mfma_f32_16x16x32_bf16 v[184:187], a[248:251], a[184:187], v[184:187]
ds_read_b32 a233, v62
v_perm_b32 v61, v101, v19, s52
v_mfma_f32_16x16x32_bf16 v[188:191], a[248:251], a[188:191], v[188:191]
s_waitcnt lgkmcnt(4)
ds_read_b32 a234, v61
v_mfma_f32_16x16x32_bf16 v[160:163], a[252:255], a[192:195], v[160:163]
ds_read_b128 a[244:247], v14 offset:22528
v_perm_b32 v60, v101, v19, s53
v_mfma_f32_16x16x32_bf16 v[164:167], a[252:255], a[196:199], v[164:167]
ds_read_b32 a235, v60
v_perm_b32 v59, v97, v19, s54
v_mfma_f32_16x16x32_bf16 v[168:171], a[252:255], a[200:203], v[168:171]
ds_read_b32 a236, v59
v_perm_b32 v58, v97, v19, s55
v_mfma_f32_16x16x32_bf16 v[172:175], a[252:255], a[204:207], v[172:175]
s_waitcnt lgkmcnt(4)
ds_read_b32 a237, v58
v_mfma_f32_16x16x32_bf16 v[208:211], a[240:243], a[144:147], v[208:211]
ds_read_b128 a[248:251], v15 offset:20480
v_perm_b32 v57, v101, v19, s54
v_mfma_f32_16x16x32_bf16 v[212:215], a[240:243], a[148:151], v[212:215]
ds_read_b32 a238, v57
v_perm_b32 v56, v101, v19, s55
v_mfma_f32_16x16x32_bf16 v[216:219], a[240:243], a[152:155], v[216:219]
ds_read_b32 a239, v56
v_mfma_f32_16x16x32_bf16 v[220:223], a[240:243], a[156:159], v[220:223]
s_waitcnt vmcnt(7) lgkmcnt(4)
v_cmp_ne_u64 s[50:51], s[88:89], v[82:83]
v_cmp_ne_u64 s[44:45], s[88:89], v[86:87]
v_mfma_f32_16x16x32_bf16 v[144:147], a[244:247], a[208:211], v[144:147]
ds_read_b128 a[252:255], v15 offset:16384
v_mfma_f32_16x16x32_bf16 v[148:151], a[244:247], a[212:215], v[148:151]
s_or_b64 s[50:51], s[44:45], s[50:51]
v_mfma_f32_16x16x32_bf16 v[152:155], a[244:247], a[216:219], v[152:155]
s_cbranch_scc1 L_SLOW30
L_BACK30:
v_mfma_f32_16x16x32_bf16 v[156:159], a[244:247], a[220:223], v[156:159]
s_waitcnt lgkmcnt(1)
v_mfma_f32_16x16x32_bf16 v[128:131], a[248:251], a[224:227], v[128:131]
ds_read_b128 a[240:243], v15 offset:14336
v_mfma_f32_16x16x32_bf16 v[132:135], a[248:251], a[228:231], v[132:135]
v_perm_b32 v63, v80, v19, s52
v_mfma_f32_16x16x32_bf16 v[136:139], a[248:251], a[232:235], v[136:139]
ds_read_b32 a0, v63
v_perm_b32 v62, v80, v19, s53
v_mfma_f32_16x16x32_bf16 v[140:143], a[248:251], a[236:239], v[140:143]
s_waitcnt lgkmcnt(2)
ds_read_b32 a1, v62
v_mfma_f32_16x16x32_bf16 v[224:227], a[252:255], a[128:131], v[224:227]
ds_read_b128 a[244:247], v14 offset:24576
v_perm_b32 v61, v84, v19, s52
v_mfma_f32_16x16x32_bf16 v[228:231], a[252:255], a[132:135], v[228:231]
ds_read_b32 a2, v61
v_perm_b32 v60, v84, v19, s53
v_mfma_f32_16x16x32_bf16 v[232:235], a[252:255], a[136:139], v[232:235]
ds_read_b32 a3, v60
v_perm_b32 v59, v80, v19, s54
v_mfma_f32_16x16x32_bf16 v[236:239], a[252:255], a[140:143], v[236:239]
s_waitcnt lgkmcnt(4)
ds_read_b32 a4, v59
v_mfma_f32_16x16x32_bf16 v[176:179], a[240:243], a[192:195], v[176:179]
ds_read_b128 a[248:251], v14 offset:28672
v_perm_b32 v58, v80, v19, s55
v_mfma_f32_16x16x32_bf16 v[180:183], a[240:243], a[196:199], v[180:183]
ds_read_b32 a5, v58
v_perm_b32 v57, v84, v19, s54
v_mfma_f32_16x16x32_bf16 v[184:187], a[240:243], a[200:203], v[184:187]
ds_read_b32 a6, v57
v_perm_b32 v56, v84, v19, s55
v_mfma_f32_16x16x32_bf16 v[188:191], a[240:243], a[204:207], v[188:191]
s_waitcnt lgkmcnt(4)
ds_read_b32 a7, v56
v_mfma_f32_16x16x32_bf16 v[192:195], a[244:247], a[176:179], v[192:195]
ds_read_b128 a[252:255], v15 offset:22528
v_perm_b32 v63, v81, v19, s52
v_mfma_f32_16x16x32_bf16 v[196:199], a[244:247], a[180:183], v[196:199]
ds_read_b32 a8, v63
v_perm_b32 v62, v81, v19, s53
v_mfma_f32_16x16x32_bf16 v[200:203], a[244:247], a[184:187], v[200:203]
ds_read_b32 a9, v62
v_perm_b32 v61, v85, v19, s52
v_mfma_f32_16x16x32_bf16 v[204:207], a[244:247], a[188:191], v[204:207]
s_waitcnt lgkmcnt(4)
ds_read_b32 a10, v61
v_mfma_f32_16x16x32_bf16 v[160:163], a[248:251], a[208:211], v[160:163]
ds_read_b128 a[240:243], v15 offset:10240
v_perm_b32 v60, v85, v19, s53
v_mfma_f32_16x16x32_bf16 v[164:167], a[248:251], a[212:215], v[164:167]
ds_read_b32 a11, v60
v_perm_b32 v59, v81, v19, s54
v_mfma_f32_16x16x32_bf16 v[168:171], a[248:251], a[216:219], v[168:171]
ds_read_b32 a12, v59
v_perm_b32 v58, v81, v19, s55
v_mfma_f32_16x16x32_bf16 v[172:175], a[248:251], a[220:223], v[172:175]
s_waitcnt lgkmcnt(4)
ds_read_b32 a13, v58
v_mfma_f32_16x16x32_bf16 v[144:147], a[252:255], a[224:227], v[144:147]
ds_read_b128 a[244:247], v14 offset:32768
v_perm_b32 v57, v85, v19, s54
v_mfma_f32_16x16x32_bf16 v[148:151], a[252:255], a[228:231], v[148:151]
ds_read_b32 a14, v57
v_perm_b32 v56, v85, v19, s55
v_mfma_f32_16x16x32_bf16 v[152:155], a[252:255], a[232:235], v[152:155]
ds_read_b32 a15, v56
v_mfma_f32_16x16x32_bf16 v[156:159], a[252:255], a[236:239], v[156:159]
s_waitcnt vmcnt(3) lgkmcnt(4)
v_cmp_ne_u64 s[50:51], s[88:89], v[90:91]
v_cmp_ne_u64 s[44:45], s[88:89], v[94:95]
v_mfma_f32_16x16x32_bf16 v[208:211], a[240:243], a[160:163], v[208:211]
ds_read_b128 a[248:251], v17 offset:6144
v_mfma_f32_16x16x32_bf16 v[212:215], a[240:243], a[164:167], v[212:215]
s_or_b64 s[50:51], s[44:45], s[50:51]
v_mfma_f32_16x16x32_bf16 v[216:219], a[240:243], a[168:171], v[216:219]
s_cbranch_scc1 L_SLOW31
L_BACK31:
v_mfma_f32_16x16x32_bf16 v[220:223], a[240:243], a[172:175], v[220:223]
s_waitcnt lgkmcnt(1)
v_mfma_f32_16x16x32_bf16 v[128:131], a[244:247], a[0:3], v[128:131]
ds_read_b128 a[252:255], v14 offset:30720
v_mfma_f32_16x16x32_bf16 v[132:135], a[244:247], a[4:7], v[132:135]
v_perm_b32 v63, v88, v19, s52
v_mfma_f32_16x16x32_bf16 v[136:139], a[244:247], a[8:11], v[136:139]
ds_read_b32 a16, v63
v_perm_b32 v62, v88, v19, s53
v_mfma_f32_16x16x32_bf16 v[140:143], a[244:247], a[12:15], v[140:143]
s_waitcnt lgkmcnt(2)
ds_read_b32 a17, v62
v_mfma_f32_16x16x32_bf16 v[240:243], a[248:251], a[64:67], v[240:243]
ds_read_b128 a[240:243], v15 offset:28672
v_perm_b32 v61, v92, v19, s52
v_mfma_f32_16x16x32_bf16 v[244:247], a[248:251], a[68:71], v[244:247]
ds_read_b32 a18, v61
v_perm_b32 v60, v92, v19, s53
v_mfma_f32_16x16x32_bf16 v[248:251], a[248:251], a[72:75], v[248:251]
ds_read_b32 a19, v60
v_perm_b32 v59, v88, v19, s54
v_mfma_f32_16x16x32_bf16 v[252:255], a[248:251], a[76:79], v[252:255]
s_waitcnt lgkmcnt(4)
ds_read_b32 a20, v59
v_mfma_f32_16x16x32_bf16 v[176:179], a[252:255], a[208:211], v[176:179]
ds_read_b128 a[244:247], v15 offset:24576
v_perm_b32 v58, v88, v19, s55
v_mfma_f32_16x16x32_bf16 v[180:183], a[252:255], a[212:215], v[180:183]
ds_read_b32 a21, v58
v_perm_b32 v57, v92, v19, s54
v_mfma_f32_16x16x32_bf16 v[184:187], a[252:255], a[216:219], v[184:187]
ds_read_b32 a22, v57
v_perm_b32 v56, v92, v19, s55
v_mfma_f32_16x16x32_bf16 v[188:191], a[252:255], a[220:223], v[188:191]
s_waitcnt lgkmcnt(4)
ds_read_b32 a23, v56
v_mfma_f32_16x16x32_bf16 v[160:163], a[240:243], a[224:227], v[160:163]
ds_read_b128 a[248:251], v14 offset:36864
v_perm_b32 v63, v89, v19, s52
v_mfma_f32_16x16x32_bf16 v[164:167], a[240:243], a[228:231], v[164:167]
ds_read_b32 a24, v63
v_perm_b32 v62, v89, v19, s53
v_mfma_f32_16x16x32_bf16 v[168:171], a[240:243], a[232:235], v[168:171]
ds_read_b32 a25, v62
v_perm_b32 v61, v93, v19, s52
v_mfma_f32_16x16x32_bf16 v[172:175], a[240:243], a[236:239], v[172:175]
s_waitcnt lgkmcnt(4)
ds_read_b32 a26, v61
v_mfma_f32_16x16x32_bf16 v[192:195], a[244:247], a[192:195], v[192:195]
L_PAD5:
s_cbranch_vccnz L_PADRET
ds_read_b128 a[252:255], v14 offset:34816
v_perm_b32 v60, v93, v19, s53
v_mfma_f32_16x16x32_bf16 v[196:199], a[244:247], a[196:199], v[196:199]
ds_read_b32 a27, v60
v_perm_b32 v59, v89, v19, s54
v_mfma_f32_16x16x32_bf16 v[200:203], a[244:247], a[200:203], v[200:203]
ds_read_b32 a28, v59
v_perm_b32 v58, v89, v19, s55
v_mfma_f32_16x16x32_bf16 v[204:207], a[244:247], a[204:207], v[204:207]
s_waitcnt lgkmcnt(4)
ds_read_b32 a29, v58
v_mfma_f32_16x16x32_bf16 v[224:227], a[248:251], a[144:147], v[224:227]
ds_read_b128 a[240:243], v15 offset:32768
v_perm_b32 v57, v93, v19, s54
v_mfma_f32_16x16x32_bf16 v[228:231], a[248:251], a[148:151], v[228:231]
ds_read_b32 a30, v57
v_perm_b32 v56, v93, v19, s55
v_mfma_f32_16x16x32_bf16 v[232:235], a[248:251], a[152:155], v[232:235]
ds_read_b32 a31, v56
v_mfma_f32_16x16x32_bf16 v[236:239], a[248:251], a[156:159], v[236:239]
s_waitcnt lgkmcnt(4)
v_mfma_f32_16x16x32_bf16 v[144:147], a[252:255], a[0:3], v[144:147]
ds_read_b128 a[244:247], v14 offset:26624
v_mfma_f32_16x16x32_bf16 v[148:151], a[252:255], a[4:7], v[148:151]
v_mfma_f32_16x16x32_bf16 v[152:155], a[252:255], a[8:11], v[152:155]
v_mfma_f32_16x16x32_bf16 v[156:159], a[252:255], a[12:15], v[156:159]
s_waitcnt lgkmcnt(1)
v_mfma_f32_16x16x32_bf16 v[128:131], a[240:243], a[16:19], v[128:131]
ds_read_b128 a[248:251], v15 offset:30720
v_mfma_f32_16x16x32_bf16 v[132:135], a[240:243], a[20:23], v[132:135]
v_mfma_f32_16x16x32_bf16 v[136:139], a[240:243], a[24:27], v[136:139]
v_mfma_f32_16x16x32_bf16 v[140:143], a[240:243], a[28:31], v[140:143]
s_waitcnt lgkmcnt(1)
v_mfma_f32_16x16x32_bf16 v[208:211], a[244:247], a[176:179], v[208:211]
ds_read_b128 a[252:255], v14 offset:40960
v_mfma_f32_16x16x32_bf16 v[212:215], a[244:247], a[180:183], v[212:215]
v_mfma_f32_16x16x32_bf16 v[216:219], a[244:247], a[184:187], v[216:219]
v_mfma_f32_16x16x32_bf16 v[220:223], a[244:247], a[188:191], v[220:223]
s_waitcnt lgkmcnt(1)
v_mfma_f32_16x16x32_bf16 v[176:179], a[248:251], a[224:227], v[176:179]
s_waitcnt vmcnt(0)
s_barrier
ds_read_b128 a[240:243], v15 offset:34816
v_mfma_f32_16x16x32_bf16 v[180:183], a[248:251], a[228:231], v[180:183]
v_mfma_f32_16x16x32_bf16 v[184:187], a[248:251], a[232:235], v[184:187]
v_mfma_f32_16x16x32_bf16 v[188:191], a[248:251], a[236:239], v[188:191]
s_waitcnt lgkmcnt(1)
v_mul_f32 v128, v128, v24
v_mul_f32 v132, v132, v25
v_mfma_f32_16x16x32_bf16 v[160:163], a[252:255], a[0:3], v[160:163]
ds_read_b128 a[244:247], v14 offset:45056
v_mul_f32 v136, v136, v26
v_mfma_f32_16x16x32_bf16 v[164:167], a[252:255], a[4:7], v[164:167]
v_mul_f32 v140, v140, v27
v_cvt_pk_bf16_f32 v120, v128, v132
v_mfma_f32_16x16x32_bf16 v[168:171], a[252:255], a[8:11], v[168:171]
v_cvt_pk_bf16_f32 v121, v136, v140
v_mfma_f32_16x16x32_bf16 v[172:175], a[252:255], a[12:15], v[172:175]
s_waitcnt lgkmcnt(1)
v_mfma_f32_16x16x32_bf16 v[144:147], a[240:243], a[16:19], v[144:147]
ds_read_b128 a[248:251], v15 offset:36864
v_mfma_f32_16x16x32_bf16 v[148:151], a[240:243], a[20:23], v[148:151]
buffer_store_dwordx2 v[120:121], v18, s[28:31], 0 offen nt
v_mul_f32 v129, v129, v24
v_mfma_f32_16x16x32_bf16 v[152:155], a[240:243], a[24:27], v[152:155]
s_add_u32 s28, s28, 7168
v_mul_f32 v133, v133, v25
v_mul_f32 v137, v137, v26
v_mfma_f32_16x16x32_bf16 v[156:159], a[240:243], a[28:31], v[156:159]
s_waitcnt lgkmcnt(1)
v_mul_f32 v141, v141, v27
v_cvt_pk_bf16_f32 v122, v129, v133
v_mfma_f32_16x16x32_bf16 v[192:195], a[244:247], a[208:211], v[192:195]
s_addc_u32 s29, s29, 0
ds_read_b128 a[252:255], v15 offset:26624
v_cvt_pk_bf16_f32 v123, v137, v141
v_mfma_f32_16x16x32_bf16 v[196:199], a[244:247], a[212:215], v[196:199]
buffer_store_dwordx2 v[122:123], v18, s[28:31], 0 offen nt
v_mul_f32 v130, v130, v24
v_mfma_f32_16x16x32_bf16 v[200:203], a[244:247], a[216:219], v[200:203]
s_add_u32 s28, s28, 7168
v_mul_f32 v134, v134, v25
v_mul_f32 v138, v138, v26
v_mfma_f32_16x16x32_bf16 v[204:207], a[244:247], a[220:223], v[204:207]
s_waitcnt lgkmcnt(1)
v_mul_f32 v142, v142, v27
v_cvt_pk_bf16_f32 v124, v130, v134
v_mfma_f32_16x16x32_bf16 v[224:227], a[248:251], a[160:163], v[224:227]
s_addc_u32 s29, s29, 0
ds_read_b128 a[240:243], v16 offset:30720
v_cvt_pk_bf16_f32 v125, v138, v142
v_mfma_f32_16x16x32_bf16 v[228:231], a[248:251], a[164:167], v[228:231]
buffer_store_dwordx2 v[124:125], v18, s[28:31], 0 offen nt
v_mul_f32 v131, v131, v24
v_mfma_f32_16x16x32_bf16 v[232:235], a[248:251], a[168:171], v[232:235]
s_add_u32 s28, s28, 7168
v_mul_f32 v135, v135, v25
v_mul_f32 v139, v139, v26
v_mfma_f32_16x16x32_bf16 v[236:239], a[248:251], a[172:175], v[236:239]
s_waitcnt lgkmcnt(1)
v_mul_f32 v143, v143, v27
v_cvt_pk_bf16_f32 v126, v131, v135
v_mfma_f32_16x16x32_bf16 v[208:211], a[252:255], a[192:195], v[208:211]
s_addc_u32 s29, s29, 0
ds_read_b128 a[244:247], v15 offset:40960
v_cvt_pk_bf16_f32 v127, v139, v143
v_mfma_f32_16x16x32_bf16 v[212:215], a[252:255], a[196:199], v[212:215]
buffer_store_dwordx2 v[126:127], v18, s[28:31], 0 offen nt
v_mul_f32 v144, v144, v24
v_mfma_f32_16x16x32_bf16 v[216:219], a[252:255], a[200:203], v[216:219]
s_add_u32 s28, s28, 93184
v_mul_f32 v148, v148, v25
v_mul_f32 v152, v152, v26
v_mfma_f32_16x16x32_bf16 v[220:223], a[252:255], a[204:207], v[220:223]
s_waitcnt lgkmcnt(1)
v_mul_f32 v156, v156, v27
v_cvt_pk_bf16_f32 v120, v144, v148
v_mfma_f32_16x16x32_bf16 v[240:243], a[240:243], a[80:83], v[240:243]
s_addc_u32 s29, s29, 0
ds_read_b128 a[248:251], v14 offset:43008
v_cvt_pk_bf16_f32 v121, v152, v156
v_mfma_f32_16x16x32_bf16 v[244:247], a[240:243], a[84:87], v[244:247]
buffer_store_dwordx2 v[120:121], v18, s[28:31], 0 offen nt
v_mul_f32 v145, v145, v24
v_mfma_f32_16x16x32_bf16 v[248:251], a[240:243], a[88:91], v[248:251]
s_add_u32 s28, s28, 7168
v_mul_f32 v149, v149, v25
v_mul_f32 v153, v153, v26
v_mfma_f32_16x16x32_bf16 v[252:255], a[240:243], a[92:95], v[252:255]
s_waitcnt lgkmcnt(1)
v_mul_f32 v157, v157, v27
v_cvt_pk_bf16_f32 v122, v145, v149
v_mfma_f32_16x16x32_bf16 v[160:163], a[244:247], a[16:19], v[160:163]
s_addc_u32 s29, s29, 0
ds_read_b128 a[252:255], v15 offset:45056
v_cvt_pk_bf16_f32 v123, v153, v157
v_mfma_f32_16x16x32_bf16 v[164:167], a[244:247], a[20:23], v[164:167]
buffer_store_dwordx2 v[122:123], v18, s[28:31], 0 offen nt
v_mul_f32 v146, v146, v24
v_mfma_f32_16x16x32_bf16 v[168:171], a[244:247], a[24:27], v[168:171]
s_add_u32 s28, s28, 7168
v_mul_f32 v150, v150, v25
v_mul_f32 v154, v154, v26
v_mfma_f32_16x16x32_bf16 v[172:175], a[244:247], a[28:31], v[172:175]
s_waitcnt lgkmcnt(1)
v_mul_f32 v158, v158, v27
v_cvt_pk_bf16_f32 v124, v146, v150
v_mfma_f32_16x16x32_bf16 v[176:179], a[248:251], a[0:3], v[176:179]
s_addc_u32 s29, s29, 0
ds_read_b128 a[240:243], v14 offset:49152
v_cvt_pk_bf16_f32 v125, v154, v158
v_mfma_f32_16x16x32_bf16 v[180:183], a[248:251], a[4:7], v[180:183]
buffer_store_dwordx2 v[124:125], v18, s[28:31], 0 offen nt
v_mul_f32 v147, v147, v24
v_mfma_f32_16x16x32_bf16 v[184:187], a[248:251], a[8:11], v[184:187]
s_add_u32 s28, s28, 7168
v_mul_f32 v151, v151, v25
v_mul_f32 v155, v155, v26
v_mfma_f32_16x16x32_bf16 v[188:191], a[248:251], a[12:15], v[188:191]
s_waitcnt lgkmcnt(1)
v_mul_f32 v159, v159, v27
v_cvt_pk_bf16_f32 v126, v147, v151
v_mfma_f32_16x16x32_bf16 v[192:195], a[252:255], a[224:227], v[192:195]
s_addc_u32 s29, s29, 0
ds_read_b128 a[244:247], v14 offset:47104
v_cvt_pk_bf16_f32 v127, v155, v159
v_mfma_f32_16x16x32_bf16 v[196:199], a[252:255], a[228:231], v[196:199]
buffer_store_dwordx2 v[126:127], v18, s[28:31], 0 offen nt
v_mfma_f32_16x16x32_bf16 v[200:203], a[252:255], a[232:235], v[200:203]
v_mfma_f32_16x16x32_bf16 v[204:207], a[252:255], a[236:239], v[204:207]
s_waitcnt lgkmcnt(1)
v_mul_f32 v160, v160, v24
v_mul_f32 v164, v164, v25
v_mfma_f32_16x16x32_bf16 v[224:227], a[240:243], a[176:179], v[224:227]
s_add_u32 s28, s28, 93184
ds_read_b128 a[248:251], v15 offset:43008
v_mul_f32 v168, v168, v26
v_mfma_f32_16x16x32_bf16 v[228:231], a[240:243], a[180:183], v[228:231]
s_addc_u32 s29, s29, 0
v_mul_f32 v172, v172, v27
v_cvt_pk_bf16_f32 v120, v160, v164
v_mfma_f32_16x16x32_bf16 v[232:235], a[240:243], a[184:187], v[232:235]
v_cvt_pk_bf16_f32 v121, v168, v172
v_mfma_f32_16x16x32_bf16 v[236:239], a[240:243], a[188:191], v[236:239]
s_waitcnt lgkmcnt(1)
v_mfma_f32_16x16x32_bf16 v[208:211], a[244:247], a[208:211], v[208:211]
ds_read_b128 a[252:255], v14 offset:53248
v_mfma_f32_16x16x32_bf16 v[212:215], a[244:247], a[212:215], v[212:215]
buffer_store_dwordx2 v[120:121], v18, s[28:31], 0 offen nt
v_mul_f32 v161, v161, v24
v_mfma_f32_16x16x32_bf16 v[216:219], a[244:247], a[216:219], v[216:219]
s_add_u32 s28, s28, 7168
v_mul_f32 v165, v165, v25
v_mul_f32 v169, v169, v26
v_mfma_f32_16x16x32_bf16 v[220:223], a[244:247], a[220:223], v[220:223]
s_waitcnt lgkmcnt(1)
v_mul_f32 v173, v173, v27
v_cvt_pk_bf16_f32 v122, v161, v165
v_mfma_f32_16x16x32_bf16 v[176:179], a[248:251], a[16:19], v[176:179]
s_addc_u32 s29, s29, 0
ds_read_b128 a[240:243], v17 offset:30720
v_cvt_pk_bf16_f32 v123, v169, v173
v_mfma_f32_16x16x32_bf16 v[180:183], a[248:251], a[20:23], v[180:183]
buffer_store_dwordx2 v[122:123], v18, s[28:31], 0 offen nt
v_mul_f32 v162, v162, v24
v_mfma_f32_16x16x32_bf16 v[184:187], a[248:251], a[24:27], v[184:187]
s_add_u32 s28, s28, 7168
v_mul_f32 v166, v166, v25
v_mul_f32 v170, v170, v26
v_mfma_f32_16x16x32_bf16 v[188:191], a[248:251], a[28:31], v[188:191]
s_waitcnt lgkmcnt(1)
v_mul_f32 v174, v174, v27
v_cvt_pk_bf16_f32 v124, v162, v166
v_mfma_f32_16x16x32_bf16 v[192:195], a[252:255], a[0:3], v[192:195]
s_addc_u32 s29, s29, 0
ds_read_b128 a[244:247], v15 offset:47104
v_cvt_pk_bf16_f32 v125, v170, v174
v_mfma_f32_16x16x32_bf16 v[196:199], a[252:255], a[4:7], v[196:199]
buffer_store_dwordx2 v[124:125], v18, s[28:31], 0 offen nt
v_mul_f32 v163, v163, v24
v_mfma_f32_16x16x32_bf16 v[200:203], a[252:255], a[8:11], v[200:203]
s_add_u32 s28, s28, 7168
v_mul_f32 v167, v167, v25
v_mul_f32 v171, v171, v26
v_mfma_f32_16x16x32_bf16 v[204:207], a[252:255], a[12:15], v[204:207]
s_waitcnt lgkmcnt(1)
v_mul_f32 v175, v175, v27
v_cvt_pk_bf16_f32 v126, v163, v167
v_mfma_f32_16x16x32_bf16 v[240:243], a[240:243], a[96:99], v[240:243]
s_addc_u32 s29, s29, 0
ds_read_b128 a[248:251], v15 offset:49152
v_cvt_pk_bf16_f32 v127, v171, v175
v_mfma_f32_16x16x32_bf16 v[244:247], a[240:243], a[100:103], v[244:247]
buffer_store_dwordx2 v[126:127], v18, s[28:31], 0 offen nt
v_mfma_f32_16x16x32_bf16 v[248:251], a[240:243], a[104:107], v[248:251]
v_mfma_f32_16x16x32_bf16 v[252:255], a[240:243], a[108:111], v[252:255]
s_waitcnt lgkmcnt(1)
v_mul_f32 v176, v176, v24
v_mul_f32 v180, v180, v25
v_mfma_f32_16x16x32_bf16 v[208:211], a[244:247], a[224:227], v[208:211]
s_add_u32 s28, s28, 93184
ds_read_b128 a[252:255], v15 offset:53248
v_mul_f32 v184, v184, v26
v_mfma_f32_16x16x32_bf16 v[212:215], a[244:247], a[228:231], v[212:215]
s_addc_u32 s29, s29, 0
v_mul_f32 v188, v188, v27
v_cvt_pk_bf16_f32 v120, v176, v180
v_mfma_f32_16x16x32_bf16 v[216:219], a[244:247], a[232:235], v[216:219]
v_cvt_pk_bf16_f32 v121, v184, v188
v_mfma_f32_16x16x32_bf16 v[220:223], a[244:247], a[236:239], v[220:223]
s_waitcnt lgkmcnt(1)
v_mfma_f32_16x16x32_bf16 v[224:227], a[248:251], a[192:195], v[224:227]
ds_read_b128 a[240:243], v14 offset:55296
v_mfma_f32_16x16x32_bf16 v[228:231], a[248:251], a[196:199], v[228:231]
buffer_store_dwordx2 v[120:121], v18, s[28:31], 0 offen nt
v_mul_f32 v177, v177, v24
v_mfma_f32_16x16x32_bf16 v[232:235], a[248:251], a[200:203], v[232:235]
s_add_u32 s28, s28, 7168
v_mul_f32 v181, v181, v25
v_mul_f32 v185, v185, v26
v_mfma_f32_16x16x32_bf16 v[236:239], a[248:251], a[204:207], v[236:239]
s_waitcnt lgkmcnt(1)
v_mul_f32 v189, v189, v27
v_cvt_pk_bf16_f32 v122, v177, v181
v_mfma_f32_16x16x32_bf16 v[192:195], a[252:255], a[16:19], v[192:195]
s_addc_u32 s29, s29, 0
ds_read_b128 a[244:247], v14 offset:57344
v_cvt_pk_bf16_f32 v123, v185, v189
v_mfma_f32_16x16x32_bf16 v[196:199], a[252:255], a[20:23], v[196:199]
buffer_store_dwordx2 v[122:123], v18, s[28:31], 0 offen nt
v_mul_f32 v178, v178, v24
v_mfma_f32_16x16x32_bf16 v[200:203], a[252:255], a[24:27], v[200:203]
s_add_u32 s28, s28, 7168
v_mul_f32 v182, v182, v25
v_mul_f32 v186, v186, v26
v_mfma_f32_16x16x32_bf16 v[204:207], a[252:255], a[28:31], v[204:207]
s_waitcnt lgkmcnt(1)
v_mul_f32 v190, v190, v27
v_cvt_pk_bf16_f32 v124, v178, v182
v_mfma_f32_16x16x32_bf16 v[208:211], a[240:243], a[0:3], v[208:211]
s_addc_u32 s29, s29, 0
ds_read_b128 a[248:251], v14 offset:18432
v_cvt_pk_bf16_f32 v125, v186, v190
v_mfma_f32_16x16x32_bf16 v[212:215], a[240:243], a[4:7], v[212:215]
buffer_store_dwordx2 v[124:125], v18, s[28:31], 0 offen nt
v_mul_f32 v179, v179, v24
v_mfma_f32_16x16x32_bf16 v[216:219], a[240:243], a[8:11], v[216:219]
s_add_u32 s28, s28, 7168
v_mul_f32 v183, v183, v25
v_mul_f32 v187, v187, v26
v_mfma_f32_16x16x32_bf16 v[220:223], a[240:243], a[12:15], v[220:223]
s_waitcnt lgkmcnt(1)
v_mul_f32 v191, v191, v27
v_cvt_pk_bf16_f32 v126, v179, v183
v_mfma_f32_16x16x32_bf16 v[224:227], a[244:247], a[208:211], v[224:227]
s_addc_u32 s29, s29, 0
ds_read_b128 a[252:255], v15 offset:55296
v_cvt_pk_bf16_f32 v127, v187, v191
v_mfma_f32_16x16x32_bf16 v[228:231], a[244:247], a[212:215], v[228:231]
buffer_store_dwordx2 v[126:127], v18, s[28:31], 0 offen nt
v_mfma_f32_16x16x32_bf16 v[232:235], a[244:247], a[216:219], v[232:235]
v_mfma_f32_16x16x32_bf16 v[236:239], a[244:247], a[220:223], v[236:239]
s_waitcnt lgkmcnt(1)
v_mul_f32 v192, v192, v24
v_mul_f32 v196, v196, v25
v_mfma_f32_16x16x32_bf16 v[240:243], a[248:251], a[112:115], v[240:243]
s_add_u32 s28, s28, 93184
ds_read_b128 a[240:243], v15 offset:57344
v_mul_f32 v200, v200, v26
v_mfma_f32_16x16x32_bf16 v[244:247], a[248:251], a[116:119], v[244:247]
s_addc_u32 s29, s29, 0
v_mul_f32 v204, v204, v27
v_cvt_pk_bf16_f32 v120, v192, v196
v_mfma_f32_16x16x32_bf16 v[248:251], a[248:251], a[120:123], v[248:251]
v_cvt_pk_bf16_f32 v121, v200, v204
v_mfma_f32_16x16x32_bf16 v[252:255], a[248:251], a[124:127], v[252:255]
s_waitcnt lgkmcnt(1)
v_mfma_f32_16x16x32_bf16 v[208:211], a[252:255], a[16:19], v[208:211]
ds_read_b128 a[244:247], v14 offset:61440
v_mfma_f32_16x16x32_bf16 v[212:215], a[252:255], a[20:23], v[212:215]
buffer_store_dwordx2 v[120:121], v18, s[28:31], 0 offen nt
v_mul_f32 v193, v193, v24
v_mfma_f32_16x16x32_bf16 v[216:219], a[252:255], a[24:27], v[216:219]
s_add_u32 s28, s28, 7168
v_mul_f32 v197, v197, v25
v_mul_f32 v201, v201, v26
v_mfma_f32_16x16x32_bf16 v[220:223], a[252:255], a[28:31], v[220:223]
s_waitcnt lgkmcnt(1)
v_mul_f32 v205, v205, v27
v_cvt_pk_bf16_f32 v122, v193, v197
v_mfma_f32_16x16x32_bf16 v[224:227], a[240:243], a[224:227], v[224:227]
s_addc_u32 s29, s29, 0
ds_read_b128 a[248:251], v15 offset:18432
v_cvt_pk_bf16_f32 v123, v201, v205
v_mfma_f32_16x16x32_bf16 v[228:231], a[240:243], a[228:231], v[228:231]
buffer_store_dwordx2 v[122:123], v18, s[28:31], 0 offen nt
v_mul_f32 v194, v194, v24
v_mfma_f32_16x16x32_bf16 v[232:235], a[240:243], a[232:235], v[232:235]
s_add_u32 s28, s28, 7168
v_mul_f32 v198, v198, v25
v_mul_f32 v202, v202, v26
v_mfma_f32_16x16x32_bf16 v[236:239], a[240:243], a[236:239], v[236:239]
s_waitcnt lgkmcnt(1)
v_mul_f32 v206, v206, v27
v_cvt_pk_bf16_f32 v124, v194, v198
v_mfma_f32_16x16x32_bf16 v[224:227], a[244:247], a[0:3], v[224:227]
s_addc_u32 s29, s29, 0
ds_read_b128 a[252:255], v15 offset:61440
v_cvt_pk_bf16_f32 v125, v202, v206
v_mfma_f32_16x16x32_bf16 v[228:231], a[244:247], a[4:7], v[228:231]
buffer_store_dwordx2 v[124:125], v18, s[28:31], 0 offen nt
v_mul_f32 v195, v195, v24
v_mfma_f32_16x16x32_bf16 v[232:235], a[244:247], a[8:11], v[232:235]
s_add_u32 s28, s28, 7168
v_mul_f32 v199, v199, v25
v_mul_f32 v203, v203, v26
v_mfma_f32_16x16x32_bf16 v[236:239], a[244:247], a[12:15], v[236:239]
s_waitcnt lgkmcnt(1)
v_mul_f32 v207, v207, v27
v_cvt_pk_bf16_f32 v126, v195, v199
v_mfma_f32_16x16x32_bf16 v[240:243], a[248:251], a[128:131], v[240:243]
s_addc_u32 s29, s29, 0
ds_read_b128 a[240:243], v14 offset:38912
v_cvt_pk_bf16_f32 v127, v203, v207
v_mfma_f32_16x16x32_bf16 v[244:247], a[248:251], a[132:135], v[244:247]
buffer_store_dwordx2 v[126:127], v18, s[28:31], 0 offen nt
v_mul_f32 v208, v208, v24
v_mfma_f32_16x16x32_bf16 v[248:251], a[248:251], a[136:139], v[248:251]
s_add_u32 s28, s28, 93184
v_mul_f32 v212, v212, v25
v_mul_f32 v216, v216, v26
v_mfma_f32_16x16x32_bf16 v[252:255], a[248:251], a[140:143], v[252:255]
s_waitcnt lgkmcnt(1)
v_mul_f32 v220, v220, v27
v_cvt_pk_bf16_f32 v120, v208, v212
v_mfma_f32_16x16x32_bf16 v[224:227], a[252:255], a[16:19], v[224:227]
s_addc_u32 s29, s29, 0
ds_read_b128 a[244:247], v15 offset:38912
v_cvt_pk_bf16_f32 v121, v216, v220
v_mfma_f32_16x16x32_bf16 v[228:231], a[252:255], a[20:23], v[228:231]
buffer_store_dwordx2 v[120:121], v18, s[28:31], 0 offen nt
v_mul_f32 v209, v209, v24
v_mfma_f32_16x16x32_bf16 v[232:235], a[252:255], a[24:27], v[232:235]
s_add_u32 s28, s28, 7168
v_mul_f32 v213, v213, v25
v_mul_f32 v217, v217, v26
v_mfma_f32_16x16x32_bf16 v[236:239], a[252:255], a[28:31], v[236:239]
s_waitcnt lgkmcnt(1)
v_mul_f32 v221, v221, v27
v_cvt_pk_bf16_f32 v122, v209, v213
v_mfma_f32_16x16x32_bf16 v[240:243], a[240:243], a[144:147], v[240:243]
s_addc_u32 s29, s29, 0
ds_read_b128 a[248:251], v14 offset:51200
v_cvt_pk_bf16_f32 v123, v217, v221
v_mfma_f32_16x16x32_bf16 v[244:247], a[240:243], a[148:151], v[244:247]
buffer_store_dwordx2 v[122:123], v18, s[28:31], 0 offen nt
v_mul_f32 v210, v210, v24
v_mfma_f32_16x16x32_bf16 v[248:251], a[240:243], a[152:155], v[248:251]
s_add_u32 s28, s28, 7168
v_mul_f32 v214, v214, v25
v_mul_f32 v218, v218, v26
v_mfma_f32_16x16x32_bf16 v[252:255], a[240:243], a[156:159], v[252:255]
s_waitcnt lgkmcnt(1)
v_mul_f32 v222, v222, v27
v_cvt_pk_bf16_f32 v124, v210, v214
v_mfma_f32_16x16x32_bf16 v[240:243], a[244:247], a[160:163], v[240:243]
s_addc_u32 s29, s29, 0
ds_read_b128 a[252:255], v15 offset:51200
v_cvt_pk_bf16_f32 v125, v218, v222
v_mfma_f32_16x16x32_bf16 v[244:247], a[244:247], a[164:167], v[244:247]
buffer_store_dwordx2 v[124:125], v18, s[28:31], 0 offen nt
v_mul_f32 v211, v211, v24
v_mfma_f32_16x16x32_bf16 v[248:251], a[244:247], a[168:171], v[248:251]
s_add_u32 s28, s28, 7168
v_mul_f32 v215, v215, v25
v_mul_f32 v219, v219, v26
v_mfma_f32_16x16x32_bf16 v[252:255], a[244:247], a[172:175], v[252:255]
s_waitcnt lgkmcnt(1)
v_mul_f32 v223, v223, v27
v_cvt_pk_bf16_f32 v126, v211, v215
v_mfma_f32_16x16x32_bf16 v[240:243], a[248:251], a[176:179], v[240:243]
s_addc_u32 s29, s29, 0
ds_read_b128 a[240:243], v14 offset:59392
v_cvt_pk_bf16_f32 v127, v219, v223
v_mfma_f32_16x16x32_bf16 v[244:247], a[248:251], a[180:183], v[244:247]
buffer_store_dwordx2 v[126:127], v18, s[28:31], 0 offen nt
v_mul_f32 v224, v224, v24
v_mfma_f32_16x16x32_bf16 v[248:251], a[248:251], a[184:187], v[248:251]
s_add_u32 s28, s28, 93184
v_mul_f32 v228, v228, v25
v_mul_f32 v232, v232, v26
v_mfma_f32_16x16x32_bf16 v[252:255], a[248:251], a[188:191], v[252:255]
s_waitcnt lgkmcnt(1)
v_mul_f32 v236, v236, v27
v_cvt_pk_bf16_f32 v120, v224, v228
v_mfma_f32_16x16x32_bf16 v[240:243], a[252:255], a[192:195], v[240:243]
s_addc_u32 s29, s29, 0
ds_read_b128 a[244:247], v15 offset:59392
v_cvt_pk_bf16_f32 v121, v232, v236
v_mfma_f32_16x16x32_bf16 v[244:247], a[252:255], a[196:199], v[244:247]
buffer_store_dwordx2 v[120:121], v18, s[28:31], 0 offen nt
v_mul_f32 v225, v225, v24
v_mfma_f32_16x16x32_bf16 v[248:251], a[252:255], a[200:203], v[248:251]
s_add_u32 s28, s28, 7168
v_mul_f32 v229, v229, v25
v_mul_f32 v233, v233, v26
v_mfma_f32_16x16x32_bf16 v[252:255], a[252:255], a[204:207], v[252:255]
s_waitcnt lgkmcnt(1)
v_mul_f32 v237, v237, v27
v_cvt_pk_bf16_f32 v122, v225, v229
v_mfma_f32_16x16x32_bf16 v[240:243], a[240:243], a[208:211], v[240:243]
s_addc_u32 s29, s29, 0
ds_read_b128 a[248:251], v14 offset:63488
v_cvt_pk_bf16_f32 v123, v233, v237
v_mfma_f32_16x16x32_bf16 v[244:247], a[240:243], a[212:215], v[244:247]
buffer_store_dwordx2 v[122:123], v18, s[28:31], 0 offen nt
v_mul_f32 v226, v226, v24
v_mfma_f32_16x16x32_bf16 v[248:251], a[240:243], a[216:219], v[248:251]
s_add_u32 s28, s28, 7168
v_mul_f32 v230, v230, v25
v_mul_f32 v234, v234, v26
v_mfma_f32_16x16x32_bf16 v[252:255], a[240:243], a[220:223], v[252:255]
s_waitcnt lgkmcnt(1)
v_mul_f32 v238, v238, v27
v_cvt_pk_bf16_f32 v124, v226, v230
v_mfma_f32_16x16x32_bf16 v[240:243], a[244:247], a[224:227], v[240:243]
s_addc_u32 s29, s29, 0
ds_read_b128 a[252:255], v15 offset:63488
v_cvt_pk_bf16_f32 v125, v234, v238
v_mfma_f32_16x16x32_bf16 v[244:247], a[244:247], a[228:231], v[244:247]
buffer_store_dwordx2 v[124:125], v18, s[28:31], 0 offen nt
v_mul_f32 v227, v227, v24
v_mfma_f32_16x16x32_bf16 v[248:251], a[244:247], a[232:235], v[248:251]
s_add_u32 s28, s28, 7168
v_mul_f32 v231, v231, v25
v_mul_f32 v235, v235, v26
v_mfma_f32_16x16x32_bf16 v[252:255], a[244:247], a[236:239], v[252:255]
s_waitcnt lgkmcnt(1)
v_mul_f32 v239, v239, v27
v_cvt_pk_bf16_f32 v126, v227, v231
v_mfma_f32_16x16x32_bf16 v[240:243], a[248:251], a[0:3], v[240:243]
s_addc_u32 s29, s29, 0
v_cvt_pk_bf16_f32 v127, v235, v239
v_mfma_f32_16x16x32_bf16 v[244:247], a[248:251], a[4:7], v[244:247]
buffer_store_dwordx2 v[126:127], v18, s[28:31], 0 offen nt
v_mfma_f32_16x16x32_bf16 v[248:251], a[248:251], a[8:11], v[248:251]
v_mfma_f32_16x16x32_bf16 v[252:255], a[248:251], a[12:15], v[252:255]
s_waitcnt lgkmcnt(0)
v_mfma_f32_16x16x32_bf16 v[240:243], a[252:255], a[16:19], v[240:243]
v_mfma_f32_16x16x32_bf16 v[244:247], a[252:255], a[20:23], v[244:247]
v_mfma_f32_16x16x32_bf16 v[248:251], a[252:255], a[24:27], v[248:251]
v_mfma_f32_16x16x32_bf16 v[252:255], a[252:255], a[28:31], v[252:255]
s_nop 7
v_pk_mul_f32 v[240:241], v[240:241], v[24:25] op_sel:[0,0] op_sel_hi:[1,0]
v_pk_mul_f32 v[244:245], v[244:245], v[24:25] op_sel:[0,1] op_sel_hi:[1,1]
v_pk_mul_f32 v[248:249], v[248:249], v[26:27] op_sel:[0,0] op_sel_hi:[1,0]
v_pk_mul_f32 v[252:253], v[252:253], v[26:27] op_sel:[0,1] op_sel_hi:[1,1]
v_cvt_pk_bf16_f32 v120, v240, v244
v_cvt_pk_bf16_f32 v121, v248, v252
s_add_u32 s28, s28, 93184
s_addc_u32 s29, s29, 0
buffer_store_dwordx2 v[120:121], v18, s[28:31], 0 offen nt
v_cvt_pk_bf16_f32 v122, v241, v245
v_cvt_pk_bf16_f32 v123, v249, v253
s_add_u32 s28, s28, 7168
s_addc_u32 s29, s29, 0
buffer_store_dwordx2 v[122:123], v18, s[28:31], 0 offen nt
v_pk_mul_f32 v[242:243], v[242:243], v[24:25] op_sel:[0,0] op_sel_hi:[1,0]
v_pk_mul_f32 v[246:247], v[246:247], v[24:25] op_sel:[0,1] op_sel_hi:[1,1]
v_pk_mul_f32 v[250:251], v[250:251], v[26:27] op_sel:[0,0] op_sel_hi:[1,0]
v_pk_mul_f32 v[254:255], v[254:255], v[26:27] op_sel:[0,1] op_sel_hi:[1,1]
v_cvt_pk_bf16_f32 v124, v242, v246
v_cvt_pk_bf16_f32 v125, v250, v254
s_add_u32 s28, s28, 7168
s_addc_u32 s29, s29, 0
buffer_store_dwordx2 v[124:125], v18, s[28:31], 0 offen nt
v_cvt_pk_bf16_f32 v126, v243, v247
v_cvt_pk_bf16_f32 v127, v251, v255
s_add_u32 s28, s28, 7168
s_addc_u32 s29, s29, 0
buffer_store_dwordx2 v[126:127], v18, s[28:31], 0 offen nt
s_endpgm
L_NOTAG:
buffer_load_dwordx2 v[22:23], off, s[80:83], 0 sc1
s_waitcnt vmcnt(0)
v_readfirstlane_b32 s88, v22
v_readfirstlane_b32 s89, v23
s_sub_u32 s90, s90, 1
s_nop 0
s_cmp_eq_u64 s[88:89], 0
s_cbranch_scc0 L_TAGOK
s_cmp_gt_i32 s90, 0
s_cbranch_scc1 L_NOTAG
s_mov_b32 s26, 0
s_mov_b32 s78, 0
s_mov_b64 s[88:89], 1
s_branch L_TAGOK
L_SLOW2:
s_lshr_b32 s47, s41, 6
s_add_u32 s47, s47, 1
s_lshl_b32 s47, s47, 11
buffer_load_dwordx4 v[40:43], v13, s[24:27], s47 offen offset:0 sc1
buffer_load_dwordx4 v[44:47], v13, s[24:27], s47 offen offset:1024 sc1
s_lshr_b32 s47, s42, 6
s_add_u32 s47, s47, 0
s_lshl_b32 s47, s47, 11
buffer_load_dwordx4 v[48:51], v13, s[24:27], s47 offen offset:0 sc1
buffer_load_dwordx4 v[52:55], v13, s[24:27], s47 offen offset:1024 sc1
s_lshr_b32 s91, s41, 6
s_add_u32 s91, s91, 0
s_call_b64 s[100:101], L_WAIT
v_mov_b64 v[32:33], v[120:121]
v_mov_b64 v[36:37], v[124:125]
s_branch L_BACK2
L_SLOW3:
s_lshr_b32 s47, s42, 6
s_add_u32 s47, s47, 0
s_lshl_b32 s47, s47, 11
buffer_load_dwordx4 v[48:51], v13, s[24:27], s47 offen offset:0 sc1
buffer_load_dwordx4 v[52:55], v13, s[24:27], s47 offen offset:1024 sc1
s_lshr_b32 s47, s42, 6
s_add_u32 s47, s47, 1
s_lshl_b32 s47, s47, 11
buffer_load_dwordx4 v[96:99], v13, s[24:27], s47 offen offset:0 sc1
buffer_load_dwordx4 v[100:103], v13, s[24:27], s47 offen offset:1024 sc1
s_lshr_b32 s91, s41, 6
s_add_u32 s91, s91, 1
s_call_b64 s[100:101], L_WAIT
v_mov_b64 v[40:41], v[120:121]
v_mov_b64 v[44:45], v[124:125]
s_branch L_BACK3
L_SLOW4:
s_lshr_b32 s47, s42, 6
s_add_u32 s47, s47, 1
s_lshl_b32 s47, s47, 11
buffer_load_dwordx4 v[96:99], v13, s[24:27], s47 offen offset:0 sc1
buffer_load_dwordx4 v[100:103], v13, s[24:27], s47 offen offset:1024 sc1
s_lshr_b32 s47, s43, 6
s_add_u32 s47, s47, 0
s_lshl_b32 s47, s47, 11
buffer_load_dwordx4 v[80:83], v13, s[24:27], s47 offen offset:0 sc1
buffer_load_dwordx4 v[84:87], v13, s[24:27], s47 offen offset:1024 sc1
s_lshr_b32 s91, s42, 6
s_add_u32 s91, s91, 0
s_call_b64 s[100:101], L_WAIT
v_mov_b64 v[48:49], v[120:121]
v_mov_b64 v[52:53], v[124:125]
s_branch L_BACK4
L_SLOW5:
s_lshr_b32 s47, s43, 6
s_add_u32 s47, s47, 0
s_lshl_b32 s47, s47, 11
buffer_load_dwordx4 v[80:83], v13, s[24:27], s47 offen offset:0 sc1
buffer_load_dwordx4 v[84:87], v13, s[24:27], s47 offen offset:1024 sc1
s_lshr_b32 s47, s43, 6
s_add_u32 s47, s47, 1
s_lshl_b32 s47, s47, 11
buffer_load_dwordx4 v[88:91], v13, s[24:27], s47 offen offset:0 sc1
buffer_load_dwordx4 v[92:95], v13, s[24:27], s47 offen offset:1024 sc1
s_lshr_b32 s91, s42, 6
s_add_u32 s91, s91, 1
s_call_b64 s[100:101], L_WAIT
v_mov_b64 v[96:97], v[120:121]
v_mov_b64 v[100:101], v[124:125]
s_branch L_BACK5
L_SLOW6:
s_lshr_b32 s47, s43, 6
s_add_u32 s47, s47, 1
s_lshl_b32 s47, s47, 11
buffer_load_dwordx4 v[88:91], v13, s[24:27], s47 offen offset:0 sc1
buffer_load_dwordx4 v[92:95], v13, s[24:27], s47 offen offset:1024 sc1
s_movk_i32 s47, 8
s_lshl_b32 s47, s47, 11
buffer_load_dwordx4 v[32:35], v13, s[24:27], s47 offen offset:0 sc1
buffer_load_dwordx4 v[36:39], v13, s[24:27], s47 offen offset:1024 sc1
s_lshr_b32 s91, s43, 6
s_add_u32 s91, s91, 0
s_call_b64 s[100:101], L_WAIT
v_mov_b64 v[80:81], v[120:121]
v_mov_b64 v[84:85], v[124:125]
s_branch L_BACK6
L_SLOW7:
s_movk_i32 s47, 8
s_lshl_b32 s47, s47, 11
buffer_load_dwordx4 v[32:35], v13, s[24:27], s47 offen offset:0 sc1
buffer_load_dwordx4 v[36:39], v13, s[24:27], s47 offen offset:1024 sc1
s_movk_i32 s47, 9
s_lshl_b32 s47, s47, 11
buffer_load_dwordx4 v[40:43], v13, s[24:27], s47 offen offset:0 sc1
buffer_load_dwordx4 v[44:47], v13, s[24:27], s47 offen offset:1024 sc1
s_lshr_b32 s91, s43, 6
s_add_u32 s91, s91, 1
s_call_b64 s[100:101], L_WAIT
v_mov_b64 v[88:89], v[120:121]
v_mov_b64 v[92:93], v[124:125]
s_branch L_BACK7
L_SLOW8:
s_movk_i32 s47, 9
s_lshl_b32 s47, s47, 11
buffer_load_dwordx4 v[40:43], v13, s[24:27], s47 offen offset:0 sc1
buffer_load_dwordx4 v[44:47], v13, s[24:27], s47 offen offset:1024 sc1
s_movk_i32 s47, 10
s_lshl_b32 s47, s47, 11
buffer_load_dwordx4 v[48:51], v13, s[24:27], s47 offen offset:0 sc1
buffer_load_dwordx4 v[52:55], v13, s[24:27], s47 offen offset:1024 sc1
s_movk_i32 s91, 8
s_call_b64 s[100:101], L_WAIT
v_mov_b64 v[32:33], v[120:121]
v_mov_b64 v[36:37], v[124:125]
s_branch L_BACK8
L_SLOW9:
s_movk_i32 s47, 10
s_lshl_b32 s47, s47, 11
buffer_load_dwordx4 v[48:51], v13, s[24:27], s47 offen offset:0 sc1
buffer_load_dwordx4 v[52:55], v13, s[24:27], s47 offen offset:1024 sc1
s_movk_i32 s47, 11
s_lshl_b32 s47, s47, 11
buffer_load_dwordx4 v[96:99], v13, s[24:27], s47 offen offset:0 sc1
buffer_load_dwordx4 v[100:103], v13, s[24:27], s47 offen offset:1024 sc1
s_movk_i32 s91, 9
s_call_b64 s[100:101], L_WAIT
v_mov_b64 v[40:41], v[120:121]
v_mov_b64 v[44:45], v[124:125]
s_branch L_BACK9
L_SLOW10:
s_movk_i32 s47, 11
s_lshl_b32 s47, s47, 11
buffer_load_dwordx4 v[96:99], v13, s[24:27], s47 offen offset:0 sc1
buffer_load_dwordx4 v[100:103], v13, s[24:27], s47 offen offset:1024 sc1
s_movk_i32 s47, 12
s_lshl_b32 s47, s47, 11
buffer_load_dwordx4 v[80:83], v13, s[24:27], s47 offen offset:0 sc1
buffer_load_dwordx4 v[84:87], v13, s[24:27], s47 offen offset:1024 sc1
s_movk_i32 s91, 10
s_call_b64 s[100:101], L_WAIT
v_mov_b64 v[48:49], v[120:121]
v_mov_b64 v[52:53], v[124:125]
s_branch L_BACK10
L_SLOW11:
s_movk_i32 s47, 12
s_lshl_b32 s47, s47, 11
buffer_load_dwordx4 v[80:83], v13, s[24:27], s47 offen offset:0 sc1
buffer_load_dwordx4 v[84:87], v13, s[24:27], s47 offen offset:1024 sc1
s_movk_i32 s47, 13
s_lshl_b32 s47, s47, 11
buffer_load_dwordx4 v[88:91], v13, s[24:27], s47 offen offset:0 sc1
buffer_load_dwordx4 v[92:95], v13, s[24:27], s47 offen offset:1024 sc1
s_movk_i32 s91, 11
s_call_b64 s[100:101], L_WAIT
v_mov_b64 v[96:97], v[120:121]
v_mov_b64 v[100:101], v[124:125]
s_branch L_BACK11
L_SLOW12:
s_movk_i32 s47, 13
s_lshl_b32 s47, s47, 11
buffer_load_dwordx4 v[88:91], v13, s[24:27], s47 offen offset:0 sc1
buffer_load_dwordx4 v[92:95], v13, s[24:27], s47 offen offset:1024 sc1
s_movk_i32 s47, 14
s_lshl_b32 s47, s47, 11
buffer_load_dwordx4 v[32:35], v13, s[24:27], s47 offen offset:0 sc1
buffer_load_dwordx4 v[36:39], v13, s[24:27], s47 offen offset:1024 sc1
s_movk_i32 s91, 12
s_call_b64 s[100:101], L_WAIT
v_mov_b64 v[80:81], v[120:121]
v_mov_b64 v[84:85], v[124:125]
s_branch L_BACK12
L_SLOW13:
s_movk_i32 s47, 14
s_lshl_b32 s47, s47, 11
buffer_load_dwordx4 v[32:35], v13, s[24:27], s47 offen offset:0 sc1
buffer_load_dwordx4 v[36:39], v13, s[24:27], s47 offen offset:1024 sc1
s_movk_i32 s47, 15
s_lshl_b32 s47, s47, 11
buffer_load_dwordx4 v[40:43], v13, s[24:27], s47 offen offset:0 sc1
buffer_load_dwordx4 v[44:47], v13, s[24:27], s47 offen offset:1024 sc1
s_movk_i32 s91, 13
s_call_b64 s[100:101], L_WAIT
v_mov_b64 v[88:89], v[120:121]
v_mov_b64 v[92:93], v[124:125]
s_branch L_BACK13
L_SLOW14:
s_movk_i32 s47, 15
s_lshl_b32 s47, s47, 11
buffer_load_dwordx4 v[40:43], v13, s[24:27], s47 offen offset:0 sc1
buffer_load_dwordx4 v[44:47], v13, s[24:27], s47 offen offset:1024 sc1
s_movk_i32 s47, 16
s_lshl_b32 s47, s47, 11
buffer_load_dwordx4 v[48:51], v13, s[24:27], s47 offen offset:0 sc1
buffer_load_dwordx4 v[52:55], v13, s[24:27], s47 offen offset:1024 sc1
s_movk_i32 s91, 14
s_call_b64 s[100:101], L_WAIT
v_mov_b64 v[32:33], v[120:121]
v_mov_b64 v[36:37], v[124:125]
s_branch L_BACK14
L_SLOW15:
s_movk_i32 s47, 16
s_lshl_b32 s47, s47, 11
buffer_load_dwordx4 v[48:51], v13, s[24:27], s47 offen offset:0 sc1
buffer_load_dwordx4 v[52:55], v13, s[24:27], s47 offen offset:1024 sc1
s_movk_i32 s47, 17
s_lshl_b32 s47, s47, 11
buffer_load_dwordx4 v[96:99], v13, s[24:27], s47 offen offset:0 sc1
buffer_load_dwordx4 v[100:103], v13, s[24:27], s47 offen offset:1024 sc1
s_movk_i32 s91, 15
s_call_b64 s[100:101], L_WAIT
v_mov_b64 v[40:41], v[120:121]
v_mov_b64 v[44:45], v[124:125]
s_branch L_BACK15
L_SLOW16:
s_movk_i32 s47, 17
s_lshl_b32 s47, s47, 11
buffer_load_dwordx4 v[96:99], v13, s[24:27], s47 offen offset:0 sc1
buffer_load_dwordx4 v[100:103], v13, s[24:27], s47 offen offset:1024 sc1
s_movk_i32 s47, 18
s_lshl_b32 s47, s47, 11
buffer_load_dwordx4 v[80:83], v13, s[24:27], s47 offen offset:0 sc1
buffer_load_dwordx4 v[84:87], v13, s[24:27], s47 offen offset:1024 sc1
s_movk_i32 s91, 16
s_call_b64 s[100:101], L_WAIT
v_mov_b64 v[48:49], v[120:121]
v_mov_b64 v[52:53], v[124:125]
s_branch L_BACK16
L_SLOW17:
s_movk_i32 s47, 18
s_lshl_b32 s47, s47, 11
buffer_load_dwordx4 v[80:83], v13, s[24:27], s47 offen offset:0 sc1
buffer_load_dwordx4 v[84:87], v13, s[24:27], s47 offen offset:1024 sc1
s_movk_i32 s47, 19
s_lshl_b32 s47, s47, 11
buffer_load_dwordx4 v[88:91], v13, s[24:27], s47 offen offset:0 sc1
buffer_load_dwordx4 v[92:95], v13, s[24:27], s47 offen offset:1024 sc1
s_movk_i32 s91, 17
s_call_b64 s[100:101], L_WAIT
v_mov_b64 v[96:97], v[120:121]
v_mov_b64 v[100:101], v[124:125]
s_branch L_BACK17
L_SLOW18:
s_movk_i32 s47, 19
s_lshl_b32 s47, s47, 11
buffer_load_dwordx4 v[88:91], v13, s[24:27], s47 offen offset:0 sc1
buffer_load_dwordx4 v[92:95], v13, s[24:27], s47 offen offset:1024 sc1
s_movk_i32 s47, 20
s_lshl_b32 s47, s47, 11
buffer_load_dwordx4 v[32:35], v13, s[24:27], s47 offen offset:0 sc1
buffer_load_dwordx4 v[36:39], v13, s[24:27], s47 offen offset:1024 sc1
s_movk_i32 s91, 18
s_call_b64 s[100:101], L_WAIT
v_mov_b64 v[80:81], v[120:121]
v_mov_b64 v[84:85], v[124:125]
s_branch L_BACK18
L_SLOW19:
s_movk_i32 s47, 20
s_lshl_b32 s47, s47, 11
buffer_load_dwordx4 v[32:35], v13, s[24:27], s47 offen offset:0 sc1
buffer_load_dwordx4 v[36:39], v13, s[24:27], s47 offen offset:1024 sc1
s_movk_i32 s47, 21
s_lshl_b32 s47, s47, 11
buffer_load_dwordx4 v[40:43], v13, s[24:27], s47 offen offset:0 sc1
buffer_load_dwordx4 v[44:47], v13, s[24:27], s47 offen offset:1024 sc1
s_movk_i32 s91, 19
s_call_b64 s[100:101], L_WAIT
v_mov_b64 v[88:89], v[120:121]
v_mov_b64 v[92:93], v[124:125]
s_branch L_BACK19
L_SLOW20:
s_movk_i32 s47, 21
s_lshl_b32 s47, s47, 11
buffer_load_dwordx4 v[40:43], v13, s[24:27], s47 offen offset:0 sc1
buffer_load_dwordx4 v[44:47], v13, s[24:27], s47 offen offset:1024 sc1
s_movk_i32 s47, 22
s_lshl_b32 s47, s47, 11
buffer_load_dwordx4 v[48:51], v13, s[24:27], s47 offen offset:0 sc1
buffer_load_dwordx4 v[52:55], v13, s[24:27], s47 offen offset:1024 sc1
s_movk_i32 s91, 20
s_call_b64 s[100:101], L_WAIT
v_mov_b64 v[32:33], v[120:121]
v_mov_b64 v[36:37], v[124:125]
s_branch L_BACK20
L_SLOW21:
s_movk_i32 s47, 22
s_lshl_b32 s47, s47, 11
buffer_load_dwordx4 v[48:51], v13, s[24:27], s47 offen offset:0 sc1
buffer_load_dwordx4 v[52:55], v13, s[24:27], s47 offen offset:1024 sc1
s_movk_i32 s47, 23
s_lshl_b32 s47, s47, 11
buffer_load_dwordx4 v[96:99], v13, s[24:27], s47 offen offset:0 sc1
buffer_load_dwordx4 v[100:103], v13, s[24:27], s47 offen offset:1024 sc1
s_movk_i32 s91, 21
s_call_b64 s[100:101], L_WAIT
v_mov_b64 v[40:41], v[120:121]
v_mov_b64 v[44:45], v[124:125]
s_branch L_BACK21
L_SLOW22:
s_movk_i32 s47, 23
s_lshl_b32 s47, s47, 11
buffer_load_dwordx4 v[96:99], v13, s[24:27], s47 offen offset:0 sc1
buffer_load_dwordx4 v[100:103], v13, s[24:27], s47 offen offset:1024 sc1
s_movk_i32 s47, 24
s_lshl_b32 s47, s47, 11
buffer_load_dwordx4 v[80:83], v13, s[24:27], s47 offen offset:0 sc1
buffer_load_dwordx4 v[84:87], v13, s[24:27], s47 offen offset:1024 sc1
s_movk_i32 s91, 22
s_call_b64 s[100:101], L_WAIT
v_mov_b64 v[48:49], v[120:121]
v_mov_b64 v[52:53], v[124:125]
s_branch L_BACK22
L_SLOW23:
s_movk_i32 s47, 24
s_lshl_b32 s47, s47, 11
buffer_load_dwordx4 v[80:83], v13, s[24:27], s47 offen offset:0 sc1
buffer_load_dwordx4 v[84:87], v13, s[24:27], s47 offen offset:1024 sc1
s_movk_i32 s47, 25
s_lshl_b32 s47, s47, 11
buffer_load_dwordx4 v[88:91], v13, s[24:27], s47 offen offset:0 sc1
buffer_load_dwordx4 v[92:95], v13, s[24:27], s47 offen offset:1024 sc1
s_movk_i32 s91, 23
s_call_b64 s[100:101], L_WAIT
v_mov_b64 v[96:97], v[120:121]
v_mov_b64 v[100:101], v[124:125]
s_branch L_BACK23
L_SLOW24:
s_movk_i32 s47, 25
s_lshl_b32 s47, s47, 11
buffer_load_dwordx4 v[88:91], v13, s[24:27], s47 offen offset:0 sc1
buffer_load_dwordx4 v[92:95], v13, s[24:27], s47 offen offset:1024 sc1
s_movk_i32 s47, 26
s_lshl_b32 s47, s47, 11
buffer_load_dwordx4 v[32:35], v13, s[24:27], s47 offen offset:0 sc1
buffer_load_dwordx4 v[36:39], v13, s[24:27], s47 offen offset:1024 sc1
s_movk_i32 s91, 24
s_call_b64 s[100:101], L_WAIT
v_mov_b64 v[80:81], v[120:121]
v_mov_b64 v[84:85], v[124:125]
s_branch L_BACK24
L_SLOW25:
s_movk_i32 s47, 26
s_lshl_b32 s47, s47, 11
buffer_load_dwordx4 v[32:35], v13, s[24:27], s47 offen offset:0 sc1
buffer_load_dwordx4 v[36:39], v13, s[24:27], s47 offen offset:1024 sc1
s_movk_i32 s47, 27
s_lshl_b32 s47, s47, 11
buffer_load_dwordx4 v[40:43], v13, s[24:27], s47 offen offset:0 sc1
buffer_load_dwordx4 v[44:47], v13, s[24:27], s47 offen offset:1024 sc1
s_movk_i32 s91, 25
s_call_b64 s[100:101], L_WAIT
v_mov_b64 v[88:89], v[120:121]
v_mov_b64 v[92:93], v[124:125]
s_branch L_BACK25
L_SLOW26:
s_movk_i32 s47, 27
s_lshl_b32 s47, s47, 11
buffer_load_dwordx4 v[40:43], v13, s[24:27], s47 offen offset:0 sc1
buffer_load_dwordx4 v[44:47], v13, s[24:27], s47 offen offset:1024 sc1
s_movk_i32 s47, 28
s_lshl_b32 s47, s47, 11
buffer_load_dwordx4 v[48:51], v13, s[24:27], s47 offen offset:0 sc1
buffer_load_dwordx4 v[52:55], v13, s[24:27], s47 offen offset:1024 sc1
s_movk_i32 s91, 26
s_call_b64 s[100:101], L_WAIT
v_mov_b64 v[32:33], v[120:121]
v_mov_b64 v[36:37], v[124:125]
s_branch L_BACK26
L_SLOW27:
s_movk_i32 s47, 28
s_lshl_b32 s47, s47, 11
buffer_load_dwordx4 v[48:51], v13, s[24:27], s47 offen offset:0 sc1
buffer_load_dwordx4 v[52:55], v13, s[24:27], s47 offen offset:1024 sc1
s_movk_i32 s47, 29
s_lshl_b32 s47, s47, 11
buffer_load_dwordx4 v[96:99], v13, s[24:27], s47 offen offset:0 sc1
buffer_load_dwordx4 v[100:103], v13, s[24:27], s47 offen offset:1024 sc1
s_movk_i32 s91, 27
s_call_b64 s[100:101], L_WAIT
v_mov_b64 v[40:41], v[120:121]
v_mov_b64 v[44:45], v[124:125]
s_branch L_BACK27
L_SLOW28:
s_movk_i32 s47, 29
s_lshl_b32 s47, s47, 11
buffer_load_dwordx4 v[96:99], v13, s[24:27], s47 offen offset:0 sc1
buffer_load_dwordx4 v[100:103], v13, s[24:27], s47 offen offset:1024 sc1
s_movk_i32 s47, 30
s_lshl_b32 s47, s47, 11
buffer_load_dwordx4 v[80:83], v13, s[24:27], s47 offen offset:0 sc1
buffer_load_dwordx4 v[84:87], v13, s[24:27], s47 offen offset:1024 sc1
s_movk_i32 s91, 28
s_call_b64 s[100:101], L_WAIT
v_mov_b64 v[48:49], v[120:121]
v_mov_b64 v[52:53], v[124:125]
s_branch L_BACK28
L_SLOW29:
s_movk_i32 s47, 30
s_lshl_b32 s47, s47, 11
buffer_load_dwordx4 v[80:83], v13, s[24:27], s47 offen offset:0 sc1
buffer_load_dwordx4 v[84:87], v13, s[24:27], s47 offen offset:1024 sc1
s_movk_i32 s47, 31
s_lshl_b32 s47, s47, 11
buffer_load_dwordx4 v[88:91], v13, s[24:27], s47 offen offset:0 sc1
buffer_load_dwordx4 v[92:95], v13, s[24:27], s47 offen offset:1024 sc1
s_movk_i32 s91, 29
s_call_b64 s[100:101], L_WAIT
v_mov_b64 v[96:97], v[120:121]
v_mov_b64 v[100:101], v[124:125]
s_branch L_BACK29
L_SLOW30:
s_movk_i32 s47, 31
s_lshl_b32 s47, s47, 11
buffer_load_dwordx4 v[88:91], v13, s[24:27], s47 offen offset:0 sc1
buffer_load_dwordx4 v[92:95], v13, s[24:27], s47 offen offset:1024 sc1
s_movk_i32 s91, 30
s_call_b64 s[100:101], L_WAIT
v_mov_b64 v[80:81], v[120:121]
v_mov_b64 v[84:85], v[124:125]
s_branch L_BACK30
L_SLOW31:
s_movk_i32 s91, 31
s_call_b64 s[100:101], L_WAIT
v_mov_b64 v[88:89], v[120:121]
v_mov_b64 v[92:93], v[124:125]
s_branch L_BACK31
L_WAIT:
s_lshl_b32 s47, s91, 11
buffer_load_dwordx4 v[120:123], v13, s[24:27], s47 offen offset:0 sc1
buffer_load_dwordx4 v[124:127], v13, s[24:27], s47 offen offset:1024 sc1
s_waitcnt vmcnt(0)
v_cmp_ne_u64 s[50:51], s[88:89], v[122:123]
v_cmp_ne_u64 s[44:45], s[88:89], v[126:127]
s_sub_u32 s90, s90, 1
s_nop 0
s_or_b64 s[50:51], s[44:45], s[50:51]
s_cbranch_scc0 L_WRET
s_cmp_gt_i32 s90, 0
s_cbranch_scc1 L_WAIT
s_mul_i32 s47, s91, 458752
s_lshl_b32 s46, s39, 8
s_add_u32 s47, s47, s46
s_add_u32 s84, s6, s47
s_addc_u32 s85, s7, 0
s_mov_b32 s86, 387328
s_mov_b32 s87, 0x20000
buffer_load_dwordx4 v[64:67], v30, s[84:87], 0 offen
buffer_load_dwordx4 v[68:71], v30, s[84:87], s92 offen
buffer_load_dwordx4 v[72:75], v30, s[84:87], s93 offen
buffer_load_dwordx4 v[76:79], v30, s[84:87], s94 offen
s_waitcnt vmcnt(0)
v_lshl_add_u64 v[64:65], v[68:69], 4, v[64:65]
v_lshl_add_u64 v[66:67], v[70:71], 4, v[66:67]
v_lshl_add_u64 v[72:73], v[76:77], 4, v[72:73]
v_lshl_add_u64 v[74:75], v[78:79], 4, v[74:75]
v_lshl_or_b32 v76, v72, 8, v64
v_lshl_or_b32 v77, v73, 8, v65
v_lshl_or_b32 v78, v74, 8, v66
v_lshl_or_b32 v79, v75, 8, v67
v_lshl_or_b32 v120, v77, 16, v76
v_lshl_or_b32 v121, v79, 16, v78
s_add_u32 s84, s84, 57344
s_addc_u32 s85, s85, 0
buffer_load_dwordx4 v[64:67], v30, s[84:87], 0 offen
buffer_load_dwordx4 v[68:71], v30, s[84:87], s92 offen
buffer_load_dwordx4 v[72:75], v30, s[84:87], s93 offen
buffer_load_dwordx4 v[76:79], v30, s[84:87], s94 offen
s_waitcnt vmcnt(0)
v_lshl_add_u64 v[64:65], v[68:69], 4, v[64:65]
v_lshl_add_u64 v[66:67], v[70:71], 4, v[66:67]
v_lshl_add_u64 v[72:73], v[76:77], 4, v[72:73]
v_lshl_add_u64 v[74:75], v[78:79], 4, v[74:75]
v_lshl_or_b32 v76, v72, 8, v64
v_lshl_or_b32 v77, v73, 8, v65
v_lshl_or_b32 v78, v74, 8, v66
v_lshl_or_b32 v79, v75, 8, v67
v_lshl_or_b32 v124, v77, 16, v76
v_lshl_or_b32 v125, v79, 16, v78
L_WRET:
s_setpc_b64 s[100:101]
L_END:
s_endpgm
.section .rodata,"a"
.p2align 6
.amdhsa_kernel standalone__normalfloat_lut_af4__prompt_kernel
  .amdhsa_next_free_vgpr 512
  .amdhsa_next_free_sgpr 102
  .amdhsa_accum_offset 256
  .amdhsa_group_segment_fixed_size 0
  .amdhsa_kernarg_size 56
  .amdhsa_user_sgpr_count 2
  .amdhsa_user_sgpr_kernarg_segment_ptr 1
  .amdhsa_system_sgpr_workgroup_id_x 1
.end_amdhsa_kernel
```

```asm
; @launch grid=(256,1,1) block=(256,1,1) lds=163840
.amdgcn_target "amdgcn-amd-amdhsa--gfx950"
.text
.globl standalone__normalfloat_lut_af4__prompt_kernel
.p2align 12
.p2align 8
.type standalone__normalfloat_lut_af4__prompt_kernel,@function
standalone__normalfloat_lut_af4__prompt_kernel:
s_load_dwordx4 s[4:7], s[0:1], 0
s_load_dwordx4 s[12:15], s[0:1], 40
s_load_dwordx4 s[8:11], s[0:1], 24
s_memrealtime s[56:57]
s_cmp_ge_u32 s2, 256
s_cbranch_scc1 L_END
s_getpc_b64 s[48:49]
L_PC0:
v_bfi_b32 v2, 7, v0, s2
v_lshlrev_b32 v2, 7, v2
v_min_u32 v2, L_END-L_PC0, v2
global_load_dword v7, v2, s[48:49]
v_lshrrev_b32 v1, 6, v0
s_cmp_lt_u32 s2, 32
v_readfirstlane_b32 s36, v1
s_cbranch_scc1 L_PACK
s_bfe_u32 s34, s2, 0x20001
s_bfe_u32 s37, s2, 0x20003
s_lshl2_add_u32 s37, s34, s37
s_and_b32 s43, s2, 1
s_mul_i32 s43, s43, 7
s_lshr_b32 s38, s2, 5
s_add_u32 s38, s38, s43
s_lshl2_add_u32 s39, s38, s36
s_sub_u32 s39, s39, 4
v_bfe_u32 v6, v0, 4, 2
v_and_b32 v3, 15, v0
v_mul_u32_u24 v2, 114688, v6
v_lshl_add_u32 v30, v3, 4, v2
s_lshr_b32 s46, s37, 1
s_and_b32 s45, s37, 1
s_lshl3_add_u32 s46, s46, s45
s_mul_i32 s46, s46, 57344
s_lshl_b32 s47, s39, 8
s_add_u32 s44, s46, s47
s_mov_b32 s18, 387328
s_mov_b32 s19, 0x20000
s_mov_b32 s92, 14336
s_mov_b32 s93, 28672
s_mov_b32 s94, 43008
s_waitcnt lgkmcnt(0)
s_add_u32 s16, s6, s44
s_addc_u32 s17, s7, 0
buffer_load_dwordx4 v[104:107], v30, s[16:19], 0 offen
buffer_load_dwordx4 v[108:111], v30, s[16:19], s92 offen
buffer_load_dwordx4 v[112:115], v30, s[16:19], s93 offen
buffer_load_dwordx4 v[116:119], v30, s[16:19], s94 offen
s_branch L_MAIN
L_PACK:
v_lshrrev_b32 v2, 2, v0
v_and_b32 v3, 3, v0
s_lshl_b32 s45, s2, 17
v_lshl_add_u32 v2, v2, 11, s45
v_lshl_add_u32 v17, v3, 7, v2
s_mov_b32 s30, 4194304
s_mov_b32 s31, 0x20000
v_lshlrev_b32 v16, 3, v0
s_cmp_lt_u32 s2, 2
s_cselect_b32 s34, 8, 0
s_mov_b32 s35, 0x20000
v_mov_b64 v[22:23], 0
s_waitcnt lgkmcnt(0)
s_mov_b64 s[32:33], s[12:13]
v_mov_b64 v[20:21], s[56:57]
buffer_atomic_cmpswap_x2 v[20:23], v16, s[32:35], 0 offen sc1
s_mov_b64 s[28:29], s[4:5]
buffer_load_dword v19, v17, s[28:31], 0 offen offset:0
s_branch L_PACK1
L_MAIN:
s_mov_b64 s[20:21], s[4:5]
s_mov_b32 s22, 4194304
s_mov_b32 s23, 0x20000
s_lshl_b32 s46, s37, 18
v_lshrrev_b32 v5, 3, v0
v_lshl_add_u32 v2, v5, 11, s46
v_lshrrev_b32 v4, 4, v0
v_xor_b32 v4, v4, v0
v_and_b32 v4, 7, v4
v_lshl_add_u32 v8, v4, 4, v2
v_add_u32 v9, 65536, v8
v_add_u32 v10, 131072, v8
v_add_u32 v11, 196608, v8
s_lshl_b32 s33, s36, 10
s_mul_i32 s47, s45, 114688
s_sub_u32 s47, s44, s47
s_add_u32 s47, s47, 57344
s_add_u32 s84, s6, s47
s_addc_u32 s85, s7, 0
s_mov_b32 s86, 387328
s_mov_b32 s87, 0x20000
s_lshl_b32 s40, s34, 7
s_add_u32 m0, s33, 65536
s_nop 0
buffer_load_dwordx4 v8, s[20:23], s40 offen lds
s_add_u32 m0, s33, 69632
s_nop 0
buffer_load_dwordx4 v9, s[20:23], s40 offen lds
s_add_u32 m0, s33, 73728
s_nop 0
buffer_load_dwordx4 v10, s[20:23], s40 offen lds
s_add_u32 m0, s33, 77824
s_nop 0
buffer_load_dwordx4 v11, s[20:23], s40 offen lds
v_mov_b32 v2, 0x3da3bf80
s_lshl_b64 exec, exec, 8
v_mov_b32 v2, 0x3e25bf32
s_lshl_b64 exec, exec, 8
v_mov_b32 v2, 0x3e7cbf06
s_lshl_b64 exec, exec, 8
v_mov_b32 v2, 0x3eadbeca
s_lshl_b64 exec, exec, 8
v_mov_b32 v2, 0x3ee2be92
s_lshl_b64 exec, exec, 8
v_mov_b32 v2, 0x3f10be3d
s_lshl_b64 exec, exec, 8
v_mov_b32 v2, 0x3f39bdba
s_lshl_b64 exec, exec, 8
v_mov_b32 v2, 0x3f800000
s_mov_b64 exec, -1
s_and_b32 s45, s36, 1
s_mul_i32 s45, s45, 0x0202
s_lshr_b32 s46, s36, 1
s_mul_i32 s46, s46, 0x02020000
s_add_u32 s45, s45, s46
s_add_u32 s45, s45, 0x05040100
v_mov_b32 v4, s45
v_lshlrev_b32 v5, 8, v5
v_and_b32 v31, 7, v0
v_lshl_add_u32 v31, v31, 4, v5
s_mov_b32 s45, 0xbf32bf80
v_perm_b32 v128, s45, v2, v4
v_mov_b32 v129, v128
v_mov_b64 v[130:131], v[128:129]
ds_write_b128 v31, v[128:131] offset:0
s_mov_b32 s45, 0xbecabf06
v_perm_b32 v132, s45, v2, v4
v_mov_b32 v133, v132
v_mov_b64 v[134:135], v[132:133]
v_and_b32 v5, 31, v0
v_lshlrev_b32 v19, 2, v5
v_and_b32 v0, 63, v0
s_lshl_b32 s46, s39, 7
ds_write_b128 v31, v[132:135] offset:8192
s_mov_b32 s45, 0xbe3dbe92
v_perm_b32 v136, s45, v2, v4
v_mov_b32 v137, v136
v_mov_b64 v[138:139], v[136:137]
v_lshl_add_u32 v28, v3, 3, s46
s_mul_i32 s47, s37, 917504
s_add_u32 s47, s47, s46
s_add_u32 s28, s10, s47
s_addc_u32 s29, s11, 0
ds_write_b128 v31, v[136:139] offset:16384
s_mov_b32 s45, 0xbdba
v_perm_b32 v140, s45, v2, v4
v_mov_b32 v141, v140
v_mov_b64 v[142:143], v[140:141]
s_mov_b32 s30, 86144
s_mov_b32 s31, 0x20000
v_mul_u32_u24 v29, 28672, v6
v_lshl_add_u32 v18, v3, 3, v29
ds_write_b128 v31, v[140:143] offset:24576
s_mov_b32 s45, 0x3e253da3
v_perm_b32 v144, s45, v2, v4
v_mov_b32 v145, v144
v_mov_b64 v[146:147], v[144:145]
v_lshlrev_b32 v29, 7, v3
v_bfe_u32 v5, v0, 1, 3
v_xor_b32 v5, v5, v6
v_lshl_add_u32 v29, v5, 4, v29
s_load_dwordx2 s[88:89], s[12:13], 0
ds_write_b128 v31, v[144:147] offset:32768
s_mov_b32 s45, 0x3ead3e7c
v_perm_b32 v148, s45, v2, v4
v_mov_b32 v149, v148
v_mov_b64 v[150:151], v[148:149]
v_add_u32 v14, 65536, v29
v_xor_b32 v15, 64, v14
v_add_u32 v16, 0x10000, v14
v_add_u32 v17, 0x10000, v15
ds_write_b128 v31, v[148:151] offset:40960
s_mov_b32 s45, 0x3f103ee2
v_perm_b32 v152, s45, v2, v4
v_mov_b32 v153, v152
v_mov_b64 v[154:155], v[152:153]
s_mov_b32 s52, 0x0c0c0400
s_mov_b32 s53, 0x0c0c0500
s_mov_b32 s54, 0x0c0c0600
s_mov_b32 s55, 0x0c0c0700
ds_write_b128 v31, v[152:155] offset:49152
s_mov_b32 s45, 0x3f803f39
v_perm_b32 v156, s45, v2, v4
v_mov_b32 v157, v156
v_mov_b64 v[158:159], v[156:157]
v_lshlrev_b32 v13, 4, v0
s_lshl_b32 s47, s39, 16
s_add_u32 s24, s14, s47
s_addc_u32 s25, s15, 0
s_lshl_b32 s47, s37, 10
ds_write_b128 v31, v[156:159] offset:57344
s_add_u32 s76, s24, s47
s_addc_u32 s77, s25, 0
s_movk_i32 s78, 1024
s_mov_b32 s79, 0x20000
s_lshl_b32 s47, s34, 3
s_lshr_b32 s47, 0x90d0b2d, s47
s_bfe_u32 s41, s47, 0x20000
s_lshl_b32 s41, s41, 7
s_bfe_u32 s42, s47, 0x20002
s_lshl_b32 s42, s42, 7
s_bfe_u32 s43, s47, 0x20004
s_lshl_b32 s43, s43, 7
s_lshl_b32 s47, s34, 1
s_lshr_b32 s47, 0x63, s47
s_and_b32 s47, s47, 3
s_sub_u32 s47, s47, s34
s_lshl1_add_u32 s3, s47, 14
s_mul_i32 s47, s3, 458752
s_add_u32 s16, s16, s47
s_addc_u32 s17, s17, 0
s_lshl_b32 s3, s3, 11
s_lshr_b32 s35, s37, 1
s_xor_b32 s35, s35, 1
v_lshl_add_u32 v12, s41, 5, v13
s_mul_i32 s47, s35, 458752
s_lshl_b32 s46, s39, 8
s_add_u32 s47, s47, s46
s_add_u32 s72, s6, s47
s_addc_u32 s73, s7, 0
s_mov_b32 s74, 444672
s_mov_b32 s75, 0x20000
v_add_u32 v31, 57344, v30
s_and_b32 s47, s37, 2
s_lshl_b32 s47, s47, 5
v_xor_b32 v2, s47, v14
v_xor_b32 v4, 64, v2
s_mov_b32 s26, 65536
s_mov_b32 s27, 0x20000
s_mov_b64 s[80:81], s[12:13]
s_movk_i32 s82, 128
s_mov_b32 s83, 0x20000
s_movk_i32 s90, 4096
buffer_load_dwordx4 v[64:67], v30, s[84:87], 0 offen
buffer_load_dwordx4 v[68:71], v30, s[84:87], s92 offen
buffer_load_dwordx4 v[72:75], v30, s[84:87], s93 offen
buffer_load_dwordx4 v[76:79], v30, s[84:87], s94 offen
s_waitcnt vmcnt(8)
v_lshl_add_u64 v[104:105], v[108:109], 4, v[104:105]
v_lshl_add_u64 v[106:107], v[110:111], 4, v[106:107]
v_lshl_add_u64 v[112:113], v[116:117], 4, v[112:113]
v_lshl_add_u64 v[114:115], v[118:119], 4, v[114:115]
v_lshl_or_b32 v116, v112, 8, v104
v_lshl_or_b32 v117, v113, 8, v105
v_lshl_or_b32 v118, v114, 8, v106
v_lshl_or_b32 v119, v115, 8, v107
v_lshl_or_b32 v108, v117, 16, v116
v_lshl_or_b32 v109, v119, 16, v118
s_waitcnt lgkmcnt(0)
s_cmp_eq_u64 s[88:89], 0
s_cbranch_scc1 L_NOTAG
L_TAGOK:
v_mov_b64 v[110:111], s[88:89]
buffer_store_dwordx4 v[108:111], v13, s[76:79], 0 offen sc1
s_add_u32 s76, s76, s3
s_addc_u32 s77, s77, 0
s_waitcnt lgkmcnt(0)
s_nop 0
s_mov_b64 vcc, -1
s_cmp_eq_u32 s36, 0
s_cbranch_scc1 L_PAD0
s_cmp_eq_u32 s36, 1
s_cbranch_scc1 L_PAD2
s_cmp_eq_u32 s36, 2
s_cbranch_scc1 L_PAD4
s_cmp_eq_u32 s36, 3
s_cbranch_scc1 L_PADS
L_PADRET:
s_mov_b64 vcc, 0
s_branch L_STREAM
L_PACK1:
v_and_b32 v0, 63, v0
v_lshrrev_b32 v2, 4, v0
v_and_b32 v3, 15, v0
v_mul_u32_u24 v2, 114688, v2
v_lshl_add_u32 v8, v3, 4, v2
s_movk_i32 s47, 0x3800
v_add_u32 v9, s47, v8
v_add_u32 v10, s47, v9
v_add_u32 v11, s47, v10
v_add_u32 v12, s47, v11
v_add_u32 v13, s47, v12
v_add_u32 v14, s47, v13
v_add_u32 v15, s47, v14
s_sub_u32 s3, s2, 1
s_and_b32 s3, s3, 7
s_lshr_b32 s45, s2, 3
s_lshl2_add_u32 s3, s3, s45
s_mul_i32 s40, s3, 4682
s_lshr_b32 s40, s40, 16
s_mul_i32 s41, s40, 14
s_sub_u32 s41, s3, s41
s_add_u32 s40, s40, 8
s_mov_b32 s22, 14680064
s_mov_b32 s23, 0x20000
s_mov_b64 s[20:21], s[6:7]
s_cmp_ge_u32 s40, 14
s_cselect_b32 s45, 8, 0
s_add_u32 s45, s45, s40
s_lshl2_add_u32 s42, s41, s36
s_mul_i32 s43, s45, 458752
s_lshl_b32 s44, s42, 8
s_add_u32 s43, s43, s44
s_lshl_b32 s44, s42, 5
s_add_u32 s44, s44, s45
s_lshl_b32 s52, s44, 11
s_cmp_lt_u32 s45, 32
s_cselect_b32 s52, s52, 0x1000000
s_cselect_b32 s22, 14680064, 0
s_add_u32 s41, s41, 4
s_add_u32 s40, s40, 2
s_cmp_ge_u32 s41, 14
s_cselect_b32 s48, 14, 0
s_addc_u32 s40, s40, 0
s_sub_u32 s41, s41, s48
s_load_dwordx2 s[50:51], s[12:13], 0
buffer_load_dwordx4 v[32:35], v8, s[20:23], s43 offen
buffer_load_dwordx4 v[36:39], v9, s[20:23], s43 offen
buffer_load_dwordx4 v[40:43], v10, s[20:23], s43 offen
buffer_load_dwordx4 v[44:47], v11, s[20:23], s43 offen
buffer_load_dwordx4 v[48:51], v12, s[20:23], s43 offen
buffer_load_dwordx4 v[52:55], v13, s[20:23], s43 offen
buffer_load_dwordx4 v[56:59], v14, s[20:23], s43 offen
buffer_load_dwordx4 v[60:63], v15, s[20:23], s43 offen
s_mov_b64 s[24:25], s[14:15]
s_mov_b32 s26, 3670016
s_mov_b32 s27, 0x20000
s_movk_i32 s34, 128
v_mov_b32 v16, 0
v_lshlrev_b32 v18, 4, v0
s_movk_i32 s46, 4096
s_waitcnt vmcnt(4) lgkmcnt(0)
v_mov_b64 v[22:23], s[50:51]
s_nop 0
L_PKN:
v_cmp_ne_u64 vcc, 0, v[22:23]
s_sub_u32 s46, s46, 1
s_cmp_gt_i32 s46, 0
s_cbranch_vccnz L_PKGO
s_cbranch_scc0 L_END
buffer_load_dwordx2 v[22:23], v16, s[32:35], 0 offen sc1
s_waitcnt vmcnt(0)
s_branch L_PKN
L_PKGO:
s_call_b64 s[100:101], L_PK0
buffer_store_dwordx4 v[20:23], v18, s[24:27], s52 offen offset:0 sc1
s_waitcnt lgkmcnt(0)
s_call_b64 s[100:101], L_UNIT
s_mov_b32 s53, s49
buffer_load_dwordx4 v[64:67], v8, s[20:23], s43 offen
buffer_load_dwordx4 v[68:71], v9, s[20:23], s43 offen
buffer_load_dwordx4 v[72:75], v10, s[20:23], s43 offen
buffer_load_dwordx4 v[76:79], v11, s[20:23], s43 offen
s_waitcnt vmcnt(5)
s_call_b64 s[100:101], L_PK1
buffer_store_dwordx4 v[20:23], v18, s[24:27], s52 offen offset:1024 sc1
buffer_load_dwordx4 v[80:83], v12, s[20:23], s43 offen
buffer_load_dwordx4 v[84:87], v13, s[20:23], s43 offen
buffer_load_dwordx4 v[88:91], v14, s[20:23], s43 offen
buffer_load_dwordx4 v[92:95], v15, s[20:23], s43 offen
s_waitcnt vmcnt(5)
s_call_b64 s[100:101], L_PK2
buffer_store_dwordx4 v[20:23], v18, s[24:27], s53 offen offset:0 sc1
s_call_b64 s[100:101], L_UNIT
s_mov_b32 s54, s49
buffer_load_dwordx4 v[32:35], v8, s[20:23], s43 offen
buffer_load_dwordx4 v[36:39], v9, s[20:23], s43 offen
buffer_load_dwordx4 v[40:43], v10, s[20:23], s43 offen
buffer_load_dwordx4 v[44:47], v11, s[20:23], s43 offen
s_waitcnt vmcnt(5)
s_call_b64 s[100:101], L_PK3
buffer_store_dwordx4 v[20:23], v18, s[24:27], s53 offen offset:1024 sc1
buffer_load_dwordx4 v[48:51], v12, s[20:23], s43 offen
buffer_load_dwordx4 v[52:55], v13, s[20:23], s43 offen
buffer_load_dwordx4 v[56:59], v14, s[20:23], s43 offen
buffer_load_dwordx4 v[60:63], v15, s[20:23], s43 offen
s_waitcnt vmcnt(5)
s_call_b64 s[100:101], L_PK0
buffer_store_dwordx4 v[20:23], v18, s[24:27], s54 offen offset:0 sc1
s_call_b64 s[100:101], L_UNIT
s_mov_b32 s55, s49
buffer_load_dwordx4 v[64:67], v8, s[20:23], s43 offen
buffer_load_dwordx4 v[68:71], v9, s[20:23], s43 offen
buffer_load_dwordx4 v[72:75], v10, s[20:23], s43 offen
buffer_load_dwordx4 v[76:79], v11, s[20:23], s43 offen
s_waitcnt vmcnt(5)
s_call_b64 s[100:101], L_PK1
buffer_store_dwordx4 v[20:23], v18, s[24:27], s54 offen offset:1024 sc1
buffer_load_dwordx4 v[80:83], v12, s[20:23], s43 offen
buffer_load_dwordx4 v[84:87], v13, s[20:23], s43 offen
buffer_load_dwordx4 v[88:91], v14, s[20:23], s43 offen
buffer_load_dwordx4 v[92:95], v15, s[20:23], s43 offen
s_waitcnt vmcnt(5)
s_call_b64 s[100:101], L_PK2
buffer_store_dwordx4 v[20:23], v18, s[24:27], s55 offen offset:0 sc1
s_call_b64 s[100:101], L_UNIT
s_mov_b32 s52, s49
buffer_load_dwordx4 v[32:35], v8, s[20:23], s43 offen
buffer_load_dwordx4 v[36:39], v9, s[20:23], s43 offen
buffer_load_dwordx4 v[40:43], v10, s[20:23], s43 offen
buffer_load_dwordx4 v[44:47], v11, s[20:23], s43 offen
s_waitcnt vmcnt(5)
s_call_b64 s[100:101], L_PK3
buffer_store_dwordx4 v[20:23], v18, s[24:27], s55 offen offset:1024 sc1
buffer_load_dwordx4 v[48:51], v12, s[20:23], s43 offen
buffer_load_dwordx4 v[52:55], v13, s[20:23], s43 offen
buffer_load_dwordx4 v[56:59], v14, s[20:23], s43 offen
buffer_load_dwordx4 v[60:63], v15, s[20:23], s43 offen
s_waitcnt vmcnt(5)
s_call_b64 s[100:101], L_PK0
buffer_store_dwordx4 v[20:23], v18, s[24:27], s52 offen offset:0 sc1
buffer_load_dword v19, v17, s[28:31], 0 offen offset:1536
s_waitcnt vmcnt(2)
s_call_b64 s[100:101], L_PK1
buffer_store_dwordx4 v[20:23], v18, s[24:27], s52 offen offset:1024 sc1
s_call_b64 s[100:101], L_UNIT
s_mov_b32 s53, s49
buffer_load_dwordx4 v[64:67], v8, s[20:23], s43 offen
buffer_load_dwordx4 v[68:71], v9, s[20:23], s43 offen
buffer_load_dwordx4 v[72:75], v10, s[20:23], s43 offen
buffer_load_dwordx4 v[76:79], v11, s[20:23], s43 offen
buffer_load_dwordx4 v[80:83], v12, s[20:23], s43 offen
buffer_load_dwordx4 v[84:87], v13, s[20:23], s43 offen
buffer_load_dwordx4 v[88:91], v14, s[20:23], s43 offen
buffer_load_dwordx4 v[92:95], v15, s[20:23], s43 offen
s_waitcnt vmcnt(4)
s_call_b64 s[100:101], L_PK2
buffer_store_dwordx4 v[20:23], v18, s[24:27], s53 offen offset:0 sc1
s_call_b64 s[100:101], L_UNIT
s_mov_b32 s54, s49
buffer_load_dwordx4 v[32:35], v8, s[20:23], s43 offen
buffer_load_dwordx4 v[36:39], v9, s[20:23], s43 offen
buffer_load_dwordx4 v[40:43], v10, s[20:23], s43 offen
buffer_load_dwordx4 v[44:47], v11, s[20:23], s43 offen
s_waitcnt vmcnt(5)
s_call_b64 s[100:101], L_PK3
buffer_store_dwordx4 v[20:23], v18, s[24:27], s53 offen offset:1024 sc1
buffer_load_dwordx4 v[48:51], v12, s[20:23], s43 offen
buffer_load_dwordx4 v[52:55], v13, s[20:23], s43 offen
buffer_load_dwordx4 v[56:59], v14, s[20:23], s43 offen
buffer_load_dwordx4 v[60:63], v15, s[20:23], s43 offen
s_waitcnt vmcnt(5)
s_call_b64 s[100:101], L_PK0
buffer_store_dwordx4 v[20:23], v18, s[24:27], s54 offen offset:0 sc1
s_waitcnt vmcnt(1)
s_call_b64 s[100:101], L_PK1
buffer_store_dwordx4 v[20:23], v18, s[24:27], s54 offen offset:1024 sc1
s_endpgm
L_UNIT:
s_cmp_ge_u32 s40, 14
s_cselect_b32 s45, 8, 0
s_add_u32 s45, s45, s40
s_lshl2_add_u32 s42, s41, s36
s_mul_i32 s43, s45, 458752
s_lshl_b32 s44, s42, 8
s_add_u32 s43, s43, s44
s_lshl_b32 s44, s42, 5
s_add_u32 s44, s44, s45
s_lshl_b32 s49, s44, 11
s_cmp_lt_u32 s45, 32
s_cselect_b32 s49, s49, 0x1000000
s_cselect_b32 s22, 14680064, 0
s_add_u32 s41, s41, 4
s_add_u32 s40, s40, 2
s_cmp_ge_u32 s41, 14
s_cselect_b32 s48, 14, 0
s_addc_u32 s40, s40, 0
s_sub_u32 s41, s41, s48
s_setpc_b64 s[100:101]
L_PK0:
v_lshl_add_u64 v[32:33], v[36:37], 4, v[32:33]
v_lshl_add_u64 v[34:35], v[38:39], 4, v[34:35]
v_lshl_add_u64 v[40:41], v[44:45], 4, v[40:41]
v_lshl_add_u64 v[42:43], v[46:47], 4, v[42:43]
v_lshl_or_b32 v44, v40, 8, v32
v_lshl_or_b32 v45, v41, 8, v33
v_lshl_or_b32 v46, v42, 8, v34
v_lshl_or_b32 v47, v43, 8, v35
v_lshl_or_b32 v20, v45, 16, v44
v_lshl_or_b32 v21, v47, 16, v46
s_setpc_b64 s[100:101]
L_PK1:
v_lshl_add_u64 v[48:49], v[52:53], 4, v[48:49]
v_lshl_add_u64 v[50:51], v[54:55], 4, v[50:51]
v_lshl_add_u64 v[56:57], v[60:61], 4, v[56:57]
v_lshl_add_u64 v[58:59], v[62:63], 4, v[58:59]
v_lshl_or_b32 v60, v56, 8, v48
v_lshl_or_b32 v61, v57, 8, v49
v_lshl_or_b32 v62, v58, 8, v50
v_lshl_or_b32 v63, v59, 8, v51
v_lshl_or_b32 v20, v61, 16, v60
v_lshl_or_b32 v21, v63, 16, v62
s_setpc_b64 s[100:101]
L_PK2:
v_lshl_add_u64 v[64:65], v[68:69], 4, v[64:65]
v_lshl_add_u64 v[66:67], v[70:71], 4, v[66:67]
v_lshl_add_u64 v[72:73], v[76:77], 4, v[72:73]
v_lshl_add_u64 v[74:75], v[78:79], 4, v[74:75]
v_lshl_or_b32 v76, v72, 8, v64
v_lshl_or_b32 v77, v73, 8, v65
v_lshl_or_b32 v78, v74, 8, v66
v_lshl_or_b32 v79, v75, 8, v67
v_lshl_or_b32 v20, v77, 16, v76
v_lshl_or_b32 v21, v79, 16, v78
s_setpc_b64 s[100:101]
L_PK3:
v_lshl_add_u64 v[80:81], v[84:85], 4, v[80:81]
v_lshl_add_u64 v[82:83], v[86:87], 4, v[82:83]
v_lshl_add_u64 v[88:89], v[92:93], 4, v[88:89]
v_lshl_add_u64 v[90:91], v[94:95], 4, v[90:91]
v_lshl_or_b32 v92, v88, 8, v80
v_lshl_or_b32 v93, v89, 8, v81
v_lshl_or_b32 v94, v90, 8, v82
v_lshl_or_b32 v95, v91, 8, v83
v_lshl_or_b32 v20, v93, 16, v92
v_lshl_or_b32 v21, v95, 16, v94
s_setpc_b64 s[100:101]
.p2align 12
L_STREAM:
L_PAD0:
s_cbranch_vccnz L_PAD1
buffer_load_dwordx4 v[80:83], v30, s[72:75], 0 offen
buffer_load_dwordx4 v[84:87], v30, s[72:75], s92 offen
buffer_load_dwordx4 v[88:91], v30, s[72:75], s93 offen
buffer_load_dwordx4 v[92:95], v30, s[72:75], s94 offen
buffer_load_dwordx4 v[40:43], v31, s[72:75], 0 offen
buffer_load_dwordx4 v[44:47], v31, s[72:75], s92 offen
buffer_load_dwordx4 v[48:51], v31, s[72:75], s93 offen
buffer_load_dwordx4 v[52:55], v31, s[72:75], s94 offen
s_waitcnt vmcnt(13)
s_barrier
ds_read_b128 a[240:243], v2 offset:0
ds_read_b128 a[244:247], v2 offset:2048
v_lshl_add_u32 v104, v104, 8, v19
v_lshl_add_u32 v105, v105, 8, v19
v_lshl_add_u32 v106, v106, 8, v19
v_lshl_add_u32 v107, v107, 8, v19
v_lshl_add_u32 v112, v112, 8, v19
v_lshl_add_u32 v113, v113, 8, v19
v_lshl_add_u32 v114, v114, 8, v19
v_lshl_add_u32 v115, v115, 8, v19
s_waitcnt vmcnt(9)
v_lshl_add_u64 v[64:65], v[68:69], 4, v[64:65]
v_lshl_add_u64 v[66:67], v[70:71], 4, v[66:67]
v_lshl_add_u64 v[72:73], v[76:77], 4, v[72:73]
v_lshl_add_u64 v[74:75], v[78:79], 4, v[74:75]
v_lshl_add_u32 v64, v64, 8, v19
v_lshl_add_u32 v65, v65, 8, v19
v_lshl_add_u32 v66, v66, 8, v19
v_lshl_add_u32 v67, v67, 8, v19
v_lshl_add_u32 v72, v72, 8, v19
v_lshl_add_u32 v73, v73, 8, v19
v_lshl_add_u32 v74, v74, 8, v19
v_lshl_add_u32 v75, v75, 8, v19
s_bitcmp1_b32 s37, 0
s_cbranch_scc0 L_NOSWAP
v_swap_b32 v104, v64
v_swap_b32 v105, v65
v_swap_b32 v106, v66
v_swap_b32 v107, v67
v_swap_b32 v112, v72
v_swap_b32 v113, v73
v_swap_b32 v114, v74
v_swap_b32 v115, v75
L_NOSWAP:
ds_read_b32 a0, v104
ds_read_b32 a1, v112
ds_read_b32 a2, v64
ds_read_b32 a3, v72
ds_read_b32 a4, v105
ds_read_b32 a5, v113
ds_read_b32 a6, v65
ds_read_b32 a7, v73
ds_read_b32 a8, v106
ds_read_b32 a9, v114
ds_read_b32 a10, v66
ds_read_b32 a11, v74
ds_read_b32 a12, v107
ds_read_b32 a13, v115
ds_read_b32 a14, v67
ds_read_b32 a15, v75
s_waitcnt lgkmcnt(12)
v_mfma_f32_16x16x32_bf16 v[128:131], a[240:243], a[0:3], 0
s_waitcnt lgkmcnt(8)
ds_read_b128 a[248:251], v2 offset:4096
v_mfma_f32_16x16x32_bf16 v[132:135], a[240:243], a[4:7], 0
s_waitcnt lgkmcnt(5)
v_mfma_f32_16x16x32_bf16 v[136:139], a[240:243], a[8:11], 0
s_waitcnt lgkmcnt(1)
s_add_u32 m0, s33, 81920
v_mfma_f32_16x16x32_bf16 v[140:143], a[240:243], a[12:15], 0
v_mfma_f32_16x16x32_bf16 v[144:147], a[244:247], a[0:3], 0
ds_read_b128 a[252:255], v2 offset:6144
buffer_load_dwordx4 v8, s[20:23], s41 offen lds
v_mfma_f32_16x16x32_bf16 v[148:151], a[244:247], a[4:7], 0
v_mfma_f32_16x16x32_bf16 v[152:155], a[244:247], a[8:11], 0
s_add_u32 m0, s33, 86016
v_mfma_f32_16x16x32_bf16 v[156:159], a[244:247], a[12:15], 0
s_waitcnt lgkmcnt(1)
v_mfma_f32_16x16x32_bf16 v[160:163], a[248:251], a[0:3], 0
ds_read_b128 a[240:243], v2 offset:8192
buffer_load_dwordx4 v9, s[20:23], s41 offen lds
v_mfma_f32_16x16x32_bf16 v[164:167], a[248:251], a[4:7], 0
v_mfma_f32_16x16x32_bf16 v[168:171], a[248:251], a[8:11], 0
s_add_u32 m0, s33, 90112
v_mfma_f32_16x16x32_bf16 v[172:175], a[248:251], a[12:15], 0
s_waitcnt lgkmcnt(1)
v_mfma_f32_16x16x32_bf16 v[176:179], a[252:255], a[0:3], 0
ds_read_b128 a[244:247], v2 offset:10240
buffer_load_dwordx4 v10, s[20:23], s41 offen lds
v_mfma_f32_16x16x32_bf16 v[180:183], a[252:255], a[4:7], 0
v_mfma_f32_16x16x32_bf16 v[184:187], a[252:255], a[8:11], 0
s_add_u32 m0, s33, 94208
v_mfma_f32_16x16x32_bf16 v[188:191], a[252:255], a[12:15], 0
s_waitcnt lgkmcnt(1)
v_mfma_f32_16x16x32_bf16 v[192:195], a[240:243], a[0:3], 0
buffer_load_dwordx4 v11, s[20:23], s41 offen lds
v_mfma_f32_16x16x32_bf16 v[196:199], a[240:243], a[4:7], 0
v_mfma_f32_16x16x32_bf16 v[200:203], a[240:243], a[8:11], 0
v_mfma_f32_16x16x32_bf16 v[204:207], a[240:243], a[12:15], 0
s_waitcnt lgkmcnt(0)
v_mfma_f32_16x16x32_bf16 v[208:211], a[244:247], a[0:3], 0
ds_read_b128 a[248:251], v2 offset:12288
v_mfma_f32_16x16x32_bf16 v[212:215], a[244:247], a[4:7], 0
v_mfma_f32_16x16x32_bf16 v[216:219], a[244:247], a[8:11], 0
buffer_load_dwordx4 v[32:35], v12, s[24:27], 0 offen offset:0 sc1
v_mfma_f32_16x16x32_bf16 v[220:223], a[244:247], a[12:15], 0
buffer_load_dwordx4 v[36:39], v12, s[24:27], 0 offen offset:1024 sc1
s_waitcnt vmcnt(12)
ds_read_b128 a[252:255], v2 offset:14336
v_lshl_add_u64 v[80:81], v[84:85], 4, v[80:81]
v_lshl_add_u64 v[82:83], v[86:87], 4, v[82:83]
v_lshl_add_u32 v80, v80, 8, v19
v_lshl_add_u32 v81, v81, 8, v19
v_lshl_add_u32 v82, v82, 8, v19
v_lshl_add_u32 v83, v83, 8, v19
ds_read_b32 a16, v80
ds_read_b32 a20, v81
ds_read_b32 a24, v82
ds_read_b32 a28, v83
s_waitcnt vmcnt(10)
v_lshl_add_u64 v[88:89], v[92:93], 4, v[88:89]
v_lshl_add_u64 v[90:91], v[94:95], 4, v[90:91]
v_lshl_add_u32 v88, v88, 8, v19
v_lshl_add_u32 v89, v89, 8, v19
v_lshl_add_u32 v90, v90, 8, v19
v_lshl_add_u32 v91, v91, 8, v19
ds_read_b32 a17, v88
ds_read_b32 a21, v89
ds_read_b32 a25, v90
ds_read_b32 a29, v91
s_waitcnt vmcnt(8)
v_lshl_add_u64 v[40:41], v[44:45], 4, v[40:41]
v_lshl_add_u64 v[42:43], v[46:47], 4, v[42:43]
v_lshl_add_u32 v40, v40, 8, v19
v_lshl_add_u32 v41, v41, 8, v19
v_lshl_add_u32 v42, v42, 8, v19
v_lshl_add_u32 v43, v43, 8, v19
ds_read_b32 a18, v40
ds_read_b32 a22, v41
ds_read_b32 a26, v42
ds_read_b32 a30, v43
s_waitcnt vmcnt(6) lgkmcnt(13)
v_lshl_add_u64 v[48:49], v[52:53], 4, v[48:49]
v_lshl_add_u64 v[50:51], v[54:55], 4, v[50:51]
v_lshl_add_u32 v48, v48, 8, v19
v_lshl_add_u32 v49, v49, 8, v19
v_lshl_add_u32 v50, v50, 8, v19
v_lshl_add_u32 v51, v51, 8, v19
ds_read_b32 a19, v48
ds_read_b32 a23, v49
ds_read_b32 a27, v50
ds_read_b32 a31, v51
v_mfma_f32_16x16x32_bf16 v[224:227], a[248:251], a[0:3], 0
ds_read_b128 a[240:243], v4 offset:0
v_mfma_f32_16x16x32_bf16 v[228:231], a[248:251], a[4:7], 0
v_mfma_f32_16x16x32_bf16 v[232:235], a[248:251], a[8:11], 0
global_load_dwordx2 v[20:21], v28, s[8:9]
v_mfma_f32_16x16x32_bf16 v[236:239], a[248:251], a[12:15], 0
s_waitcnt lgkmcnt(5)
v_mfma_f32_16x16x32_bf16 v[240:243], a[252:255], a[0:3], 0
ds_read_b128 a[244:247], v4 offset:2048
v_mfma_f32_16x16x32_bf16 v[244:247], a[252:255], a[4:7], 0
v_mfma_f32_16x16x32_bf16 v[248:251], a[252:255], a[8:11], 0
v_mfma_f32_16x16x32_bf16 v[252:255], a[252:255], a[12:15], 0
s_waitcnt lgkmcnt(1)
v_mfma_f32_16x16x32_bf16 v[128:131], a[240:243], a[16:19], v[128:131]
ds_read_b128 a[248:251], v4 offset:4096
v_mfma_f32_16x16x32_bf16 v[132:135], a[240:243], a[20:23], v[132:135]
v_mfma_f32_16x16x32_bf16 v[136:139], a[240:243], a[24:27], v[136:139]
v_mfma_f32_16x16x32_bf16 v[140:143], a[240:243], a[28:31], v[140:143]
s_waitcnt lgkmcnt(1)
v_mfma_f32_16x16x32_bf16 v[144:147], a[244:247], a[16:19], v[144:147]
ds_read_b128 a[252:255], v4 offset:6144
v_mfma_f32_16x16x32_bf16 v[148:151], a[244:247], a[20:23], v[148:151]
v_mfma_f32_16x16x32_bf16 v[152:155], a[244:247], a[24:27], v[152:155]
v_mfma_f32_16x16x32_bf16 v[156:159], a[244:247], a[28:31], v[156:159]
s_waitcnt lgkmcnt(1)
v_mfma_f32_16x16x32_bf16 v[160:163], a[248:251], a[16:19], v[160:163]
ds_read_b128 a[240:243], v4 offset:8192
buffer_load_dwordx4 v[40:43], v12, s[24:27], 0 offen offset:2048 sc1
v_mfma_f32_16x16x32_bf16 v[164:167], a[248:251], a[20:23], v[164:167]
buffer_load_dwordx4 v[44:47], v12, s[24:27], 0 offen offset:3072 sc1
v_lshl_add_u32 v12, s42, 5, v13
v_mfma_f32_16x16x32_bf16 v[168:171], a[248:251], a[24:27], v[168:171]
v_mfma_f32_16x16x32_bf16 v[172:175], a[248:251], a[28:31], v[172:175]
s_waitcnt lgkmcnt(1)
v_mfma_f32_16x16x32_bf16 v[176:179], a[252:255], a[16:19], v[176:179]
ds_read_b128 a[244:247], v4 offset:10240
v_mfma_f32_16x16x32_bf16 v[180:183], a[252:255], a[20:23], v[180:183]
v_mfma_f32_16x16x32_bf16 v[184:187], a[252:255], a[24:27], v[184:187]
s_add_u32 m0, s33, 98304
v_mfma_f32_16x16x32_bf16 v[188:191], a[252:255], a[28:31], v[188:191]
s_waitcnt lgkmcnt(1)
v_mfma_f32_16x16x32_bf16 v[192:195], a[240:243], a[16:19], v[192:195]
buffer_load_dwordx4 v8, s[20:23], s42 offen lds
v_mfma_f32_16x16x32_bf16 v[196:199], a[240:243], a[20:23], v[196:199]
v_mfma_f32_16x16x32_bf16 v[200:203], a[240:243], a[24:27], v[200:203]
s_add_u32 m0, s33, 102400
v_mfma_f32_16x16x32_bf16 v[204:207], a[240:243], a[28:31], v[204:207]
s_waitcnt lgkmcnt(0)
v_mfma_f32_16x16x32_bf16 v[208:211], a[244:247], a[16:19], v[208:211]
s_waitcnt vmcnt(6)
s_barrier
ds_read_b128 a[248:251], v4 offset:12288
buffer_load_dwordx4 v9, s[20:23], s42 offen lds
v_mfma_f32_16x16x32_bf16 v[212:215], a[244:247], a[20:23], v[212:215]
buffer_load_dwordx4 v[48:51], v12, s[24:27], 0 offen offset:0 sc1
v_mfma_f32_16x16x32_bf16 v[216:219], a[244:247], a[24:27], v[216:219]
s_add_u32 m0, s33, 106496
buffer_load_dwordx4 v[52:55], v12, s[24:27], 0 offen offset:1024 sc1
v_mfma_f32_16x16x32_bf16 v[220:223], a[244:247], a[28:31], v[220:223]
ds_read_b128 a[252:255], v4 offset:14336
buffer_load_dwordx4 v10, s[20:23], s42 offen lds
s_waitcnt vmcnt(8)
v_cmp_ne_u64 s[50:51], s[88:89], v[34:35]
v_cmp_ne_u64 s[44:45], s[88:89], v[38:39]
s_or_b64 s[50:51], s[44:45], s[50:51]
s_cbranch_scc1 L_SLOW2
L_BACK2:
v_perm_b32 v64, v32, v19, s52
v_perm_b32 v65, v32, v19, s53
v_perm_b32 v66, v36, v19, s52
v_perm_b32 v67, v36, v19, s53
v_perm_b32 v68, v32, v19, s54
v_perm_b32 v69, v32, v19, s55
v_perm_b32 v70, v36, v19, s54
v_perm_b32 v71, v36, v19, s55
ds_read_b32 a32, v64
ds_read_b32 a33, v65
ds_read_b32 a34, v66
ds_read_b32 a35, v67
ds_read_b32 a36, v68
ds_read_b32 a37, v69
ds_read_b32 a38, v70
ds_read_b32 a39, v71
v_perm_b32 v72, v33, v19, s52
v_perm_b32 v73, v33, v19, s53
v_perm_b32 v74, v37, v19, s52
v_perm_b32 v75, v37, v19, s53
v_perm_b32 v76, v33, v19, s54
v_perm_b32 v77, v33, v19, s55
v_perm_b32 v78, v37, v19, s54
v_perm_b32 v79, v37, v19, s55
ds_read_b32 a40, v72
ds_read_b32 a41, v73
ds_read_b32 a42, v74
ds_read_b32 a43, v75
ds_read_b32 a44, v76
ds_read_b32 a45, v77
ds_read_b32 a46, v78
ds_read_b32 a47, v79
s_add_u32 m0, s33, 110592
s_waitcnt lgkmcnt(15)
v_mfma_f32_16x16x32_bf16 v[224:227], a[248:251], a[16:19], v[224:227]
ds_read_b128 a[240:243], v14 offset:16384
buffer_load_dwordx4 v11, s[20:23], s42 offen lds
v_mfma_f32_16x16x32_bf16 v[228:231], a[248:251], a[20:23], v[228:231]
v_mfma_f32_16x16x32_bf16 v[232:235], a[248:251], a[24:27], v[232:235]
s_add_u32 m0, s33, 114688
v_mfma_f32_16x16x32_bf16 v[236:239], a[248:251], a[28:31], v[236:239]
v_mfma_f32_16x16x32_bf16 v[240:243], a[252:255], a[16:19], v[240:243]
ds_read_b128 a[244:247], v14 offset:18432
buffer_load_dwordx4 v8, s[20:23], s43 offen lds
v_mfma_f32_16x16x32_bf16 v[244:247], a[252:255], a[20:23], v[244:247]
v_mfma_f32_16x16x32_bf16 v[248:251], a[252:255], a[24:27], v[248:251]
s_add_u32 m0, s33, 118784
v_mfma_f32_16x16x32_bf16 v[252:255], a[252:255], a[28:31], v[252:255]
s_waitcnt lgkmcnt(1)
v_mfma_f32_16x16x32_bf16 v[128:131], a[240:243], a[32:35], v[128:131]
ds_read_b128 a[248:251], v14 offset:20480
buffer_load_dwordx4 v9, s[20:23], s43 offen lds
v_mfma_f32_16x16x32_bf16 v[132:135], a[240:243], a[36:39], v[132:135]
v_mfma_f32_16x16x32_bf16 v[136:139], a[240:243], a[40:43], v[136:139]
v_mfma_f32_16x16x32_bf16 v[140:143], a[240:243], a[44:47], v[140:143]
s_waitcnt lgkmcnt(1)
v_mfma_f32_16x16x32_bf16 v[144:147], a[244:247], a[32:35], v[144:147]
ds_read_b128 a[252:255], v14 offset:22528
v_mfma_f32_16x16x32_bf16 v[148:151], a[244:247], a[36:39], v[148:151]
v_mfma_f32_16x16x32_bf16 v[152:155], a[244:247], a[40:43], v[152:155]
s_add_u32 m0, s33, 122880
v_mfma_f32_16x16x32_bf16 v[156:159], a[244:247], a[44:47], v[156:159]
s_waitcnt lgkmcnt(1)
v_mfma_f32_16x16x32_bf16 v[160:163], a[248:251], a[32:35], v[160:163]
ds_read_b128 a[240:243], v14 offset:24576
buffer_load_dwordx4 v10, s[20:23], s43 offen lds
v_mfma_f32_16x16x32_bf16 v[164:167], a[248:251], a[36:39], v[164:167]
buffer_load_dwordx4 v[104:107], v30, s[16:19], 0 offen
v_mfma_f32_16x16x32_bf16 v[168:171], a[248:251], a[40:43], v[168:171]
v_mfma_f32_16x16x32_bf16 v[172:175], a[248:251], a[44:47], v[172:175]
s_waitcnt lgkmcnt(1)
v_mfma_f32_16x16x32_bf16 v[176:179], a[252:255], a[32:35], v[176:179]
ds_read_b128 a[244:247], v14 offset:26624
v_mfma_f32_16x16x32_bf16 v[180:183], a[252:255], a[36:39], v[180:183]
v_mfma_f32_16x16x32_bf16 v[184:187], a[252:255], a[40:43], v[184:187]
v_mfma_f32_16x16x32_bf16 v[188:191], a[252:255], a[44:47], v[188:191]
s_waitcnt lgkmcnt(1)
v_mfma_f32_16x16x32_bf16 v[192:195], a[240:243], a[32:35], v[192:195]
buffer_load_dwordx4 v[108:111], v30, s[16:19], s92 offen
v_mfma_f32_16x16x32_bf16 v[196:199], a[240:243], a[36:39], v[196:199]
v_mfma_f32_16x16x32_bf16 v[200:203], a[240:243], a[40:43], v[200:203]
s_add_u32 m0, s33, 126976
v_mfma_f32_16x16x32_bf16 v[204:207], a[240:243], a[44:47], v[204:207]
s_waitcnt lgkmcnt(0)
v_mfma_f32_16x16x32_bf16 v[208:211], a[244:247], a[32:35], v[208:211]
ds_read_b128 a[248:251], v14 offset:28672
buffer_load_dwordx4 v11, s[20:23], s43 offen lds
v_mfma_f32_16x16x32_bf16 v[212:215], a[244:247], a[36:39], v[212:215]
v_mfma_f32_16x16x32_bf16 v[216:219], a[244:247], a[40:43], v[216:219]
buffer_load_dwordx4 v[112:115], v30, s[16:19], s93 offen
v_mfma_f32_16x16x32_bf16 v[220:223], a[244:247], a[44:47], v[220:223]
buffer_load_dwordx4 v[96:99], v12, s[24:27], 0 offen offset:2048 sc1
ds_read_b128 a[252:255], v14 offset:30720
buffer_load_dwordx4 v[100:103], v12, s[24:27], 0 offen offset:3072 sc1
s_waitcnt vmcnt(15)
v_lshl_add_u32 v12, s43, 5, v13
v_cmp_ne_u64 s[50:51], s[88:89], v[42:43]
v_cmp_ne_u64 s[44:45], s[88:89], v[46:47]
s_or_b64 s[50:51], s[44:45], s[50:51]
s_cbranch_scc1 L_SLOW3
L_BACK3:
v_perm_b32 v64, v40, v19, s52
v_perm_b32 v65, v40, v19, s53
v_perm_b32 v66, v44, v19, s52
v_perm_b32 v67, v44, v19, s53
v_perm_b32 v68, v40, v19, s54
v_perm_b32 v69, v40, v19, s55
v_perm_b32 v70, v44, v19, s54
v_perm_b32 v71, v44, v19, s55
ds_read_b32 a48, v64
ds_read_b32 a49, v65
ds_read_b32 a50, v66
ds_read_b32 a51, v67
ds_read_b32 a52, v68
ds_read_b32 a53, v69
ds_read_b32 a54, v70
ds_read_b32 a55, v71
v_perm_b32 v72, v41, v19, s52
v_perm_b32 v73, v41, v19, s53
v_perm_b32 v74, v45, v19, s52
v_perm_b32 v75, v45, v19, s53
v_perm_b32 v76, v41, v19, s54
v_perm_b32 v77, v41, v19, s55
v_perm_b32 v78, v45, v19, s54
v_perm_b32 v79, v45, v19, s55
ds_read_b32 a56, v72
ds_read_b32 a57, v73
ds_read_b32 a58, v74
ds_read_b32 a59, v75
ds_read_b32 a60, v76
ds_read_b32 a61, v77
ds_read_b32 a62, v78
ds_read_b32 a63, v79
buffer_load_dwordx4 v[80:83], v12, s[24:27], 0 offen offset:0 sc1
s_waitcnt lgkmcnt(15)
buffer_load_dwordx4 v[84:87], v12, s[24:27], 0 offen offset:1024 sc1
v_mfma_f32_16x16x32_bf16 v[224:227], a[248:251], a[32:35], v[224:227]
ds_read_b128 a[240:243], v15 offset:16384
v_lshlrev_b32 v24, 16, v20
v_mfma_f32_16x16x32_bf16 v[228:231], a[248:251], a[36:39], v[228:231]
buffer_load_dwordx4 v[116:119], v30, s[16:19], s94 offen
v_mfma_f32_16x16x32_bf16 v[232:235], a[248:251], a[40:43], v[232:235]
v_and_b32 v25, 0xffff0000, v20
v_lshlrev_b32 v26, 16, v21
v_mfma_f32_16x16x32_bf16 v[236:239], a[248:251], a[44:47], v[236:239]
v_and_b32 v27, 0xffff0000, v21
v_mfma_f32_16x16x32_bf16 v[240:243], a[252:255], a[32:35], v[240:243]
ds_read_b128 a[244:247], v15 offset:18432
v_mfma_f32_16x16x32_bf16 v[244:247], a[252:255], a[36:39], v[244:247]
v_mfma_f32_16x16x32_bf16 v[248:251], a[252:255], a[40:43], v[248:251]
v_mfma_f32_16x16x32_bf16 v[252:255], a[252:255], a[44:47], v[252:255]
s_waitcnt vmcnt(14) lgkmcnt(1)
v_cmp_ne_u64 s[50:51], s[88:89], v[50:51]
v_cmp_ne_u64 s[44:45], s[88:89], v[54:55]
v_mfma_f32_16x16x32_bf16 v[128:131], a[240:243], a[48:51], v[128:131]
ds_read_b128 a[248:251], v15 offset:20480
v_mfma_f32_16x16x32_bf16 v[132:135], a[240:243], a[52:55], v[132:135]
s_or_b64 s[50:51], s[44:45], s[50:51]
v_mfma_f32_16x16x32_bf16 v[136:139], a[240:243], a[56:59], v[136:139]
s_cbranch_scc1 L_SLOW4
L_BACK4:
v_mfma_f32_16x16x32_bf16 v[140:143], a[240:243], a[60:63], v[140:143]
s_waitcnt lgkmcnt(1)
v_mfma_f32_16x16x32_bf16 v[144:147], a[244:247], a[48:51], v[144:147]
ds_read_b128 a[252:255], v15 offset:22528
v_mfma_f32_16x16x32_bf16 v[148:151], a[244:247], a[52:55], v[148:151]
v_perm_b32 v63, v48, v19, s52
v_mfma_f32_16x16x32_bf16 v[152:155], a[244:247], a[56:59], v[152:155]
s_add_u32 m0, s33, 130560
ds_read_b32 a64, v63
v_perm_b32 v62, v48, v19, s53
v_mfma_f32_16x16x32_bf16 v[156:159], a[244:247], a[60:63], v[156:159]
s_waitcnt lgkmcnt(2)
ds_read_b32 a65, v62
v_perm_b32 v61, v52, v19, s52
v_mfma_f32_16x16x32_bf16 v[160:163], a[248:251], a[48:51], v[160:163]
ds_read_b128 a[240:243], v15 offset:24576
buffer_load_dwordx4 v8, s[20:23], 0 offen offset:512 lds
v_mfma_f32_16x16x32_bf16 v[164:167], a[248:251], a[52:55], v[164:167]
ds_read_b32 a66, v61
v_perm_b32 v60, v52, v19, s53
v_mfma_f32_16x16x32_bf16 v[168:171], a[248:251], a[56:59], v[168:171]
ds_read_b32 a67, v60
v_perm_b32 v59, v48, v19, s54
v_mfma_f32_16x16x32_bf16 v[172:175], a[248:251], a[60:63], v[172:175]
s_waitcnt lgkmcnt(4)
ds_read_b32 a68, v59
v_mfma_f32_16x16x32_bf16 v[176:179], a[252:255], a[48:51], v[176:179]
s_waitcnt vmcnt(13)
s_barrier
ds_read_b128 a[244:247], v15 offset:26624
v_perm_b32 v58, v48, v19, s55
v_mfma_f32_16x16x32_bf16 v[180:183], a[252:255], a[52:55], v[180:183]
ds_read_b32 a69, v58
v_perm_b32 v57, v52, v19, s54
v_mfma_f32_16x16x32_bf16 v[184:187], a[252:255], a[56:59], v[184:187]
ds_read_b32 a70, v57
v_perm_b32 v56, v52, v19, s55
v_mfma_f32_16x16x32_bf16 v[188:191], a[252:255], a[60:63], v[188:191]
s_waitcnt lgkmcnt(4)
ds_read_b32 a71, v56
buffer_load_dwordx4 v[88:91], v12, s[24:27], 0 offen offset:2048 sc1
v_mfma_f32_16x16x32_bf16 v[192:195], a[240:243], a[48:51], v[192:195]
ds_read_b128 a[248:251], v15 offset:28672
v_perm_b32 v63, v49, v19, s52
v_mfma_f32_16x16x32_bf16 v[196:199], a[240:243], a[52:55], v[196:199]
ds_read_b32 a72, v63
v_perm_b32 v62, v49, v19, s53
v_mfma_f32_16x16x32_bf16 v[200:203], a[240:243], a[56:59], v[200:203]
ds_read_b32 a73, v62
v_perm_b32 v61, v53, v19, s52
v_mfma_f32_16x16x32_bf16 v[204:207], a[240:243], a[60:63], v[204:207]
s_waitcnt lgkmcnt(4)
ds_read_b32 a74, v61
buffer_load_dwordx4 v[92:95], v12, s[24:27], 0 offen offset:3072 sc1
v_mfma_f32_16x16x32_bf16 v[208:211], a[244:247], a[48:51], v[208:211]
ds_read_b128 a[252:255], v15 offset:30720
v_perm_b32 v60, v53, v19, s53
v_mfma_f32_16x16x32_bf16 v[212:215], a[244:247], a[52:55], v[212:215]
ds_read_b32 a75, v60
v_perm_b32 v59, v49, v19, s54
v_mfma_f32_16x16x32_bf16 v[216:219], a[244:247], a[56:59], v[216:219]
s_add_u32 m0, s33, 134656
ds_read_b32 a76, v59
v_perm_b32 v58, v49, v19, s55
v_mfma_f32_16x16x32_bf16 v[220:223], a[244:247], a[60:63], v[220:223]
s_waitcnt lgkmcnt(4)
ds_read_b32 a77, v58
v_perm_b32 v57, v53, v19, s54
v_mfma_f32_16x16x32_bf16 v[224:227], a[248:251], a[48:51], v[224:227]
ds_read_b128 a[240:243], v14 offset:32768
buffer_load_dwordx4 v9, s[20:23], 0 offen offset:512 lds
v_mfma_f32_16x16x32_bf16 v[228:231], a[248:251], a[52:55], v[228:231]
ds_read_b32 a78, v57
v_perm_b32 v56, v53, v19, s55
v_mfma_f32_16x16x32_bf16 v[232:235], a[248:251], a[56:59], v[232:235]
ds_read_b32 a79, v56
v_add_u32 v12, 16384, v13
v_mfma_f32_16x16x32_bf16 v[236:239], a[248:251], a[60:63], v[236:239]
s_waitcnt lgkmcnt(4)
v_mfma_f32_16x16x32_bf16 v[240:243], a[252:255], a[48:51], v[240:243]
ds_read_b128 a[244:247], v14 offset:34816
v_mfma_f32_16x16x32_bf16 v[244:247], a[252:255], a[52:55], v[244:247]
v_mfma_f32_16x16x32_bf16 v[248:251], a[252:255], a[56:59], v[248:251]
v_mfma_f32_16x16x32_bf16 v[252:255], a[252:255], a[60:63], v[252:255]
s_waitcnt lgkmcnt(1)
v_mfma_f32_16x16x32_bf16 v[128:131], a[240:243], a[64:67], v[128:131]
ds_read_b128 a[248:251], v14 offset:36864
v_mfma_f32_16x16x32_bf16 v[132:135], a[240:243], a[68:71], v[132:135]
v_mfma_f32_16x16x32_bf16 v[136:139], a[240:243], a[72:75], v[136:139]
s_add_u32 m0, s33, 138752
v_mfma_f32_16x16x32_bf16 v[140:143], a[240:243], a[76:79], v[140:143]
s_waitcnt lgkmcnt(1)
v_mfma_f32_16x16x32_bf16 v[144:147], a[244:247], a[64:67], v[144:147]
ds_read_b128 a[252:255], v14 offset:38912
buffer_load_dwordx4 v10, s[20:23], 0 offen offset:512 lds
v_mfma_f32_16x16x32_bf16 v[148:151], a[244:247], a[68:71], v[148:151]
v_mfma_f32_16x16x32_bf16 v[152:155], a[244:247], a[72:75], v[152:155]
v_mfma_f32_16x16x32_bf16 v[156:159], a[244:247], a[76:79], v[156:159]
s_waitcnt lgkmcnt(1)
v_mfma_f32_16x16x32_bf16 v[160:163], a[248:251], a[64:67], v[160:163]
ds_read_b128 a[240:243], v14 offset:40960
v_mfma_f32_16x16x32_bf16 v[164:167], a[248:251], a[68:71], v[164:167]
v_mfma_f32_16x16x32_bf16 v[168:171], a[248:251], a[72:75], v[168:171]
v_mfma_f32_16x16x32_bf16 v[172:175], a[248:251], a[76:79], v[172:175]
s_waitcnt lgkmcnt(1)
v_mfma_f32_16x16x32_bf16 v[176:179], a[252:255], a[64:67], v[176:179]
ds_read_b128 a[244:247], v14 offset:43008
v_mfma_f32_16x16x32_bf16 v[180:183], a[252:255], a[68:71], v[180:183]
v_mfma_f32_16x16x32_bf16 v[184:187], a[252:255], a[72:75], v[184:187]
s_add_u32 m0, s33, 142848
buffer_load_dwordx4 v[32:35], v12, s[24:27], 0 offen offset:0 sc1
v_mfma_f32_16x16x32_bf16 v[188:191], a[252:255], a[76:79], v[188:191]
s_waitcnt lgkmcnt(1)
buffer_load_dwordx4 v[36:39], v12, s[24:27], 0 offen offset:1024 sc1
v_mfma_f32_16x16x32_bf16 v[192:195], a[240:243], a[64:67], v[192:195]
buffer_load_dwordx4 v11, s[20:23], 0 offen offset:512 lds
v_mfma_f32_16x16x32_bf16 v[196:199], a[240:243], a[68:71], v[196:199]
v_mfma_f32_16x16x32_bf16 v[200:203], a[240:243], a[72:75], v[200:203]
v_mfma_f32_16x16x32_bf16 v[204:207], a[240:243], a[76:79], v[204:207]
s_waitcnt lgkmcnt(0)
v_mfma_f32_16x16x32_bf16 v[208:211], a[244:247], a[64:67], v[208:211]
ds_read_b128 a[248:251], v14 offset:45056
v_mfma_f32_16x16x32_bf16 v[212:215], a[244:247], a[68:71], v[212:215]
v_mfma_f32_16x16x32_bf16 v[216:219], a[244:247], a[72:75], v[216:219]
v_mfma_f32_16x16x32_bf16 v[220:223], a[244:247], a[76:79], v[220:223]
ds_read_b128 a[252:255], v14 offset:47104
s_waitcnt vmcnt(11)
v_cmp_ne_u64 s[50:51], s[88:89], v[98:99]
v_cmp_ne_u64 s[44:45], s[88:89], v[102:103]
s_or_b64 s[50:51], s[44:45], s[50:51]
s_cbranch_scc1 L_SLOW5
L_BACK5:
v_perm_b32 v64, v96, v19, s52
v_perm_b32 v65, v96, v19, s53
v_perm_b32 v66, v100, v19, s52
v_perm_b32 v67, v100, v19, s53
v_perm_b32 v68, v96, v19, s54
v_perm_b32 v69, v96, v19, s55
v_perm_b32 v70, v100, v19, s54
v_perm_b32 v71, v100, v19, s55
ds_read_b32 a80, v64
ds_read_b32 a81, v65
ds_read_b32 a82, v66
ds_read_b32 a83, v67
ds_read_b32 a84, v68
ds_read_b32 a85, v69
ds_read_b32 a86, v70
ds_read_b32 a87, v71
v_perm_b32 v72, v97, v19, s52
v_perm_b32 v73, v97, v19, s53
v_perm_b32 v74, v101, v19, s52
v_perm_b32 v75, v101, v19, s53
v_perm_b32 v76, v97, v19, s54
v_perm_b32 v77, v97, v19, s55
v_perm_b32 v78, v101, v19, s54
v_perm_b32 v79, v101, v19, s55
ds_read_b32 a88, v72
ds_read_b32 a89, v73
ds_read_b32 a90, v74
ds_read_b32 a91, v75
ds_read_b32 a92, v76
ds_read_b32 a93, v77
ds_read_b32 a94, v78
ds_read_b32 a95, v79
s_waitcnt lgkmcnt(15)
v_mfma_f32_16x16x32_bf16 v[224:227], a[248:251], a[64:67], v[224:227]
ds_read_b128 a[240:243], v15 offset:32768
v_mfma_f32_16x16x32_bf16 v[228:231], a[248:251], a[68:71], v[228:231]
v_mfma_f32_16x16x32_bf16 v[232:235], a[248:251], a[72:75], v[232:235]
v_mfma_f32_16x16x32_bf16 v[236:239], a[248:251], a[76:79], v[236:239]
s_waitcnt vmcnt(9)
v_cmp_ne_u64 s[50:51], s[88:89], v[82:83]
v_cmp_ne_u64 s[44:45], s[88:89], v[86:87]
v_mfma_f32_16x16x32_bf16 v[240:243], a[252:255], a[64:67], v[240:243]
L_PAD1:
s_cbranch_vccnz L_PADRET
ds_read_b128 a[244:247], v15 offset:34816
v_mfma_f32_16x16x32_bf16 v[244:247], a[252:255], a[68:71], v[244:247]
s_or_b64 s[50:51], s[44:45], s[50:51]
v_mfma_f32_16x16x32_bf16 v[248:251], a[252:255], a[72:75], v[248:251]
s_cbranch_scc1 L_SLOW6
L_BACK6:
v_mfma_f32_16x16x32_bf16 v[252:255], a[252:255], a[76:79], v[252:255]
s_waitcnt lgkmcnt(1)
v_mfma_f32_16x16x32_bf16 v[128:131], a[240:243], a[80:83], v[128:131]
ds_read_b128 a[248:251], v15 offset:36864
v_perm_b32 v63, v80, v19, s52
v_mfma_f32_16x16x32_bf16 v[132:135], a[240:243], a[84:87], v[132:135]
ds_read_b32 a96, v63
v_perm_b32 v62, v80, v19, s53
v_mfma_f32_16x16x32_bf16 v[136:139], a[240:243], a[88:91], v[136:139]
s_add_u32 m0, s33, 146816
ds_read_b32 a97, v62
v_perm_b32 v61, v84, v19, s52
v_mfma_f32_16x16x32_bf16 v[140:143], a[240:243], a[92:95], v[140:143]
s_waitcnt lgkmcnt(3)
ds_read_b32 a98, v61
v_mfma_f32_16x16x32_bf16 v[144:147], a[244:247], a[80:83], v[144:147]
ds_read_b128 a[252:255], v15 offset:38912
buffer_load_dwordx4 v8, s[20:23], 0 offen offset:640 lds
v_mfma_f32_16x16x32_bf16 v[148:151], a[244:247], a[84:87], v[148:151]
s_waitcnt vmcnt(9)
v_perm_b32 v60, v84, v19, s53
v_lshl_add_u64 v[104:105], v[108:109], 4, v[104:105]
v_mfma_f32_16x16x32_bf16 v[152:155], a[244:247], a[88:91], v[152:155]
ds_read_b32 a99, v60
v_perm_b32 v59, v80, v19, s54
v_mfma_f32_16x16x32_bf16 v[156:159], a[244:247], a[92:95], v[156:159]
s_waitcnt lgkmcnt(3)
ds_read_b32 a100, v59
v_perm_b32 v58, v80, v19, s55
v_mfma_f32_16x16x32_bf16 v[160:163], a[248:251], a[80:83], v[160:163]
s_barrier
ds_read_b128 a[240:243], v15 offset:40960
v_lshl_add_u64 v[106:107], v[110:111], 4, v[106:107]
v_mfma_f32_16x16x32_bf16 v[164:167], a[248:251], a[84:87], v[164:167]
ds_read_b32 a101, v58
v_perm_b32 v57, v84, v19, s54
v_mfma_f32_16x16x32_bf16 v[168:171], a[248:251], a[88:91], v[168:171]
ds_read_b32 a102, v57
v_perm_b32 v56, v84, v19, s55
v_mfma_f32_16x16x32_bf16 v[172:175], a[248:251], a[92:95], v[172:175]
s_waitcnt lgkmcnt(4)
ds_read_b32 a103, v56
v_lshl_add_u64 v[112:113], v[116:117], 4, v[112:113]
v_mfma_f32_16x16x32_bf16 v[176:179], a[252:255], a[80:83], v[176:179]
ds_read_b128 a[244:247], v15 offset:43008
v_perm_b32 v63, v81, v19, s52
v_mfma_f32_16x16x32_bf16 v[180:183], a[252:255], a[84:87], v[180:183]
ds_read_b32 a104, v63
buffer_load_dwordx4 v[40:43], v12, s[24:27], 0 offen offset:2048 sc1
v_mfma_f32_16x16x32_bf16 v[184:187], a[252:255], a[88:91], v[184:187]
v_perm_b32 v62, v81, v19, s53
v_lshl_add_u64 v[114:115], v[118:119], 4, v[114:115]
v_mfma_f32_16x16x32_bf16 v[188:191], a[252:255], a[92:95], v[188:191]
s_waitcnt lgkmcnt(3)
ds_read_b32 a105, v62
buffer_load_dwordx4 v[44:47], v12, s[24:27], 0 offen offset:3072 sc1
v_mfma_f32_16x16x32_bf16 v[192:195], a[240:243], a[80:83], v[192:195]
ds_read_b128 a[248:251], v15 offset:45056
v_add_u32 v12, 20480, v13
v_mfma_f32_16x16x32_bf16 v[196:199], a[240:243], a[84:87], v[196:199]
v_perm_b32 v61, v85, v19, s52
v_lshl_or_b32 v116, v112, 8, v104
v_mfma_f32_16x16x32_bf16 v[200:203], a[240:243], a[88:91], v[200:203]
s_add_u32 m0, s33, 150912
ds_read_b32 a106, v61
v_perm_b32 v60, v85, v19, s53
v_mfma_f32_16x16x32_bf16 v[204:207], a[240:243], a[92:95], v[204:207]
s_waitcnt lgkmcnt(3)
ds_read_b32 a107, v60
v_mfma_f32_16x16x32_bf16 v[208:211], a[244:247], a[80:83], v[208:211]
ds_read_b128 a[252:255], v15 offset:47104
buffer_load_dwordx4 v9, s[20:23], 0 offen offset:640 lds
v_mfma_f32_16x16x32_bf16 v[212:215], a[244:247], a[84:87], v[212:215]
v_perm_b32 v59, v81, v19, s54
v_lshl_or_b32 v117, v113, 8, v105
v_mfma_f32_16x16x32_bf16 v[216:219], a[244:247], a[88:91], v[216:219]
ds_read_b32 a108, v59
v_perm_b32 v58, v81, v19, s55
v_mfma_f32_16x16x32_bf16 v[220:223], a[244:247], a[92:95], v[220:223]
s_waitcnt lgkmcnt(3)
ds_read_b32 a109, v58
v_perm_b32 v57, v85, v19, s54
v_mfma_f32_16x16x32_bf16 v[224:227], a[248:251], a[80:83], v[224:227]
ds_read_b128 a[240:243], v14 offset:49152
v_lshl_or_b32 v118, v114, 8, v106
v_mfma_f32_16x16x32_bf16 v[228:231], a[248:251], a[84:87], v[228:231]
ds_read_b32 a110, v57
v_perm_b32 v56, v85, v19, s55
v_mfma_f32_16x16x32_bf16 v[232:235], a[248:251], a[88:91], v[232:235]
ds_read_b32 a111, v56
v_mfma_f32_16x16x32_bf16 v[236:239], a[248:251], a[92:95], v[236:239]
s_waitcnt lgkmcnt(4)
v_lshl_or_b32 v119, v115, 8, v107
v_mfma_f32_16x16x32_bf16 v[240:243], a[252:255], a[80:83], v[240:243]
ds_read_b128 a[244:247], v14 offset:51200
v_mfma_f32_16x16x32_bf16 v[244:247], a[252:255], a[84:87], v[244:247]
v_mfma_f32_16x16x32_bf16 v[248:251], a[252:255], a[88:91], v[248:251]
s_add_u32 m0, s33, 155008
v_lshl_or_b32 v108, v117, 16, v116
v_mfma_f32_16x16x32_bf16 v[252:255], a[252:255], a[92:95], v[252:255]
s_waitcnt vmcnt(9) lgkmcnt(1)
v_cmp_ne_u64 s[50:51], s[88:89], v[90:91]
v_cmp_ne_u64 s[44:45], s[88:89], v[94:95]
v_mfma_f32_16x16x32_bf16 v[128:131], a[240:243], a[96:99], v[128:131]
ds_read_b128 a[248:251], v14 offset:53248
buffer_load_dwordx4 v10, s[20:23], 0 offen offset:640 lds
v_mfma_f32_16x16x32_bf16 v[132:135], a[240:243], a[100:103], v[132:135]
s_or_b64 s[50:51], s[44:45], s[50:51]
v_lshl_or_b32 v109, v119, 16, v118
v_mfma_f32_16x16x32_bf16 v[136:139], a[240:243], a[104:107], v[136:139]
s_cbranch_scc1 L_SLOW7
L_BACK7:
v_mfma_f32_16x16x32_bf16 v[140:143], a[240:243], a[108:111], v[140:143]
s_waitcnt lgkmcnt(1)
v_perm_b32 v63, v88, v19, s52
v_mfma_f32_16x16x32_bf16 v[144:147], a[244:247], a[96:99], v[144:147]
ds_read_b128 a[252:255], v14 offset:55296
v_mov_b64 v[110:111], s[88:89]
v_mfma_f32_16x16x32_bf16 v[148:151], a[244:247], a[100:103], v[148:151]
ds_read_b32 a112, v63
v_perm_b32 v62, v88, v19, s53
v_mfma_f32_16x16x32_bf16 v[152:155], a[244:247], a[104:107], v[152:155]
ds_read_b32 a113, v62
v_perm_b32 v61, v92, v19, s52
v_mfma_f32_16x16x32_bf16 v[156:159], a[244:247], a[108:111], v[156:159]
s_waitcnt lgkmcnt(3)
ds_read_b32 a114, v61
v_mfma_f32_16x16x32_bf16 v[160:163], a[248:251], a[96:99], v[160:163]
ds_read_b128 a[240:243], v14 offset:57344
v_perm_b32 v60, v92, v19, s53
v_mfma_f32_16x16x32_bf16 v[164:167], a[248:251], a[100:103], v[164:167]
buffer_store_dwordx4 v[108:111], v13, s[76:79], 0 offen sc1
v_mfma_f32_16x16x32_bf16 v[168:171], a[248:251], a[104:107], v[168:171]
s_add_u32 m0, s33, 159104
ds_read_b32 a115, v60
v_perm_b32 v59, v88, v19, s54
v_mfma_f32_16x16x32_bf16 v[172:175], a[248:251], a[108:111], v[172:175]
s_waitcnt lgkmcnt(3)
ds_read_b32 a116, v59
v_perm_b32 v58, v88, v19, s55
v_mfma_f32_16x16x32_bf16 v[176:179], a[252:255], a[96:99], v[176:179]
ds_read_b128 a[244:247], v14 offset:59392
buffer_load_dwordx4 v11, s[20:23], 0 offen offset:640 lds
v_mfma_f32_16x16x32_bf16 v[180:183], a[252:255], a[100:103], v[180:183]
ds_read_b32 a117, v58
v_perm_b32 v57, v92, v19, s54
v_mfma_f32_16x16x32_bf16 v[184:187], a[252:255], a[104:107], v[184:187]
ds_read_b32 a118, v57
v_perm_b32 v56, v92, v19, s55
v_mfma_f32_16x16x32_bf16 v[188:191], a[252:255], a[108:111], v[188:191]
s_waitcnt lgkmcnt(4)
ds_read_b32 a119, v56
buffer_load_dwordx4 v[48:51], v12, s[24:27], 0 offen offset:0 sc1
v_mfma_f32_16x16x32_bf16 v[192:195], a[240:243], a[96:99], v[192:195]
ds_read_b128 a[248:251], v14 offset:61440
v_perm_b32 v63, v89, v19, s52
v_mfma_f32_16x16x32_bf16 v[196:199], a[240:243], a[100:103], v[196:199]
ds_read_b32 a120, v63
v_perm_b32 v62, v89, v19, s53
v_mfma_f32_16x16x32_bf16 v[200:203], a[240:243], a[104:107], v[200:203]
ds_read_b32 a121, v62
v_perm_b32 v61, v93, v19, s52
v_mfma_f32_16x16x32_bf16 v[204:207], a[240:243], a[108:111], v[204:207]
s_waitcnt lgkmcnt(4)
ds_read_b32 a122, v61
buffer_load_dwordx4 v[52:55], v12, s[24:27], 0 offen offset:1024 sc1
v_mfma_f32_16x16x32_bf16 v[208:211], a[244:247], a[96:99], v[208:211]
ds_read_b128 a[252:255], v14 offset:63488
v_perm_b32 v60, v93, v19, s53
v_mfma_f32_16x16x32_bf16 v[212:215], a[244:247], a[100:103], v[212:215]
ds_read_b32 a123, v60
v_perm_b32 v59, v89, v19, s54
v_mfma_f32_16x16x32_bf16 v[216:219], a[244:247], a[104:107], v[216:219]
ds_read_b32 a124, v59
v_perm_b32 v58, v89, v19, s55
v_mfma_f32_16x16x32_bf16 v[220:223], a[244:247], a[108:111], v[220:223]
s_waitcnt lgkmcnt(4)
ds_read_b32 a125, v58
v_mfma_f32_16x16x32_bf16 v[224:227], a[248:251], a[96:99], v[224:227]
ds_read_b128 a[240:243], v15 offset:49152
v_perm_b32 v57, v93, v19, s54
v_mfma_f32_16x16x32_bf16 v[228:231], a[248:251], a[100:103], v[228:231]
ds_read_b32 a126, v57
v_perm_b32 v56, v93, v19, s55
v_mfma_f32_16x16x32_bf16 v[232:235], a[248:251], a[104:107], v[232:235]
ds_read_b32 a127, v56
v_mfma_f32_16x16x32_bf16 v[236:239], a[248:251], a[108:111], v[236:239]
s_waitcnt lgkmcnt(4)
v_mfma_f32_16x16x32_bf16 v[240:243], a[252:255], a[96:99], v[240:243]
ds_read_b128 a[244:247], v15 offset:51200
v_mfma_f32_16x16x32_bf16 v[244:247], a[252:255], a[100:103], v[244:247]
v_mfma_f32_16x16x32_bf16 v[248:251], a[252:255], a[104:107], v[248:251]
s_waitcnt vmcnt(10)
v_cmp_ne_u64 s[50:51], s[88:89], v[34:35]
v_cmp_ne_u64 s[44:45], s[88:89], v[38:39]
v_mfma_f32_16x16x32_bf16 v[252:255], a[252:255], a[108:111], v[252:255]
s_waitcnt lgkmcnt(1)
v_mfma_f32_16x16x32_bf16 v[128:131], a[240:243], a[112:115], v[128:131]
s_or_b64 s[50:51], s[44:45], s[50:51]
ds_read_b128 a[248:251], v15 offset:53248
v_mfma_f32_16x16x32_bf16 v[132:135], a[240:243], a[116:119], v[132:135]
s_cbranch_scc1 L_SLOW8
L_BACK8:
v_mfma_f32_16x16x32_bf16 v[136:139], a[240:243], a[120:123], v[136:139]
s_add_u32 m0, s33, 64768
v_mfma_f32_16x16x32_bf16 v[140:143], a[240:243], a[124:127], v[140:143]
s_waitcnt lgkmcnt(1)
v_mfma_f32_16x16x32_bf16 v[144:147], a[244:247], a[112:115], v[144:147]
ds_read_b128 a[252:255], v15 offset:55296
buffer_load_dwordx4 v8, s[20:23], 0 offen offset:768 lds
v_mfma_f32_16x16x32_bf16 v[148:151], a[244:247], a[116:119], v[148:151]
v_perm_b32 v63, v32, v19, s52
v_mfma_f32_16x16x32_bf16 v[152:155], a[244:247], a[120:123], v[152:155]
ds_read_b32 a128, v63
v_perm_b32 v62, v32, v19, s53
v_mfma_f32_16x16x32_bf16 v[156:159], a[244:247], a[124:127], v[156:159]
s_waitcnt lgkmcnt(2)
ds_read_b32 a129, v62
v_mfma_f32_16x16x32_bf16 v[160:163], a[248:251], a[112:115], v[160:163]
s_waitcnt vmcnt(10)
s_barrier
ds_read_b128 a[240:243], v15 offset:57344
v_perm_b32 v61, v36, v19, s52
v_mfma_f32_16x16x32_bf16 v[164:167], a[248:251], a[116:119], v[164:167]
ds_read_b32 a130, v61
v_perm_b32 v60, v36, v19, s53
v_mfma_f32_16x16x32_bf16 v[168:171], a[248:251], a[120:123], v[168:171]
ds_read_b32 a131, v60
v_perm_b32 v59, v32, v19, s54
v_mfma_f32_16x16x32_bf16 v[172:175], a[248:251], a[124:127], v[172:175]
s_waitcnt lgkmcnt(4)
ds_read_b32 a132, v59
buffer_load_dwordx4 v[96:99], v12, s[24:27], 0 offen offset:2048 sc1
v_mfma_f32_16x16x32_bf16 v[176:179], a[252:255], a[112:115], v[176:179]
ds_read_b128 a[244:247], v15 offset:59392
v_perm_b32 v58, v32, v19, s55
v_mfma_f32_16x16x32_bf16 v[180:183], a[252:255], a[116:119], v[180:183]
ds_read_b32 a133, v58
v_perm_b32 v57, v36, v19, s54
v_mfma_f32_16x16x32_bf16 v[184:187], a[252:255], a[120:123], v[184:187]
ds_read_b32 a134, v57
v_perm_b32 v56, v36, v19, s55
v_mfma_f32_16x16x32_bf16 v[188:191], a[252:255], a[124:127], v[188:191]
s_waitcnt lgkmcnt(4)
ds_read_b32 a135, v56
buffer_load_dwordx4 v[100:103], v12, s[24:27], 0 offen offset:3072 sc1
v_mfma_f32_16x16x32_bf16 v[192:195], a[240:243], a[112:115], v[192:195]
ds_read_b128 a[248:251], v15 offset:61440
v_perm_b32 v63, v33, v19, s52
v_mfma_f32_16x16x32_bf16 v[196:199], a[240:243], a[116:119], v[196:199]
ds_read_b32 a136, v63
v_perm_b32 v62, v33, v19, s53
v_mfma_f32_16x16x32_bf16 v[200:203], a[240:243], a[120:123], v[200:203]
s_add_u32 m0, s33, 68864
ds_read_b32 a137, v62
v_perm_b32 v61, v37, v19, s52
v_mfma_f32_16x16x32_bf16 v[204:207], a[240:243], a[124:127], v[204:207]
s_waitcnt lgkmcnt(4)
ds_read_b32 a138, v61
v_perm_b32 v60, v37, v19, s53
v_mfma_f32_16x16x32_bf16 v[208:211], a[244:247], a[112:115], v[208:211]
ds_read_b128 a[252:255], v15 offset:63488
buffer_load_dwordx4 v9, s[20:23], 0 offen offset:768 lds
v_mfma_f32_16x16x32_bf16 v[212:215], a[244:247], a[116:119], v[212:215]
ds_read_b32 a139, v60
v_perm_b32 v59, v33, v19, s54
v_mfma_f32_16x16x32_bf16 v[216:219], a[244:247], a[120:123], v[216:219]
ds_read_b32 a140, v59
v_perm_b32 v58, v33, v19, s55
v_mfma_f32_16x16x32_bf16 v[220:223], a[244:247], a[124:127], v[220:223]
s_waitcnt lgkmcnt(4)
ds_read_b32 a141, v58
v_add_u32 v12, 24576, v13
v_mfma_f32_16x16x32_bf16 v[224:227], a[248:251], a[112:115], v[224:227]
ds_read_b128 a[240:243], v16 offset:0
v_perm_b32 v57, v37, v19, s54
v_mfma_f32_16x16x32_bf16 v[228:231], a[248:251], a[116:119], v[228:231]
ds_read_b32 a142, v57
v_perm_b32 v56, v37, v19, s55
v_mfma_f32_16x16x32_bf16 v[232:235], a[248:251], a[120:123], v[232:235]
ds_read_b32 a143, v56
v_mfma_f32_16x16x32_bf16 v[236:239], a[248:251], a[124:127], v[236:239]
s_waitcnt lgkmcnt(4)
v_mfma_f32_16x16x32_bf16 v[240:243], a[252:255], a[112:115], v[240:243]
ds_read_b128 a[244:247], v16 offset:2048
v_mfma_f32_16x16x32_bf16 v[244:247], a[252:255], a[116:119], v[244:247]
v_mfma_f32_16x16x32_bf16 v[248:251], a[252:255], a[120:123], v[248:251]
s_add_u32 m0, s33, 72960
v_mfma_f32_16x16x32_bf16 v[252:255], a[252:255], a[124:127], v[252:255]
s_waitcnt vmcnt(10) lgkmcnt(1)
v_cmp_ne_u64 s[50:51], s[88:89], v[42:43]
v_cmp_ne_u64 s[44:45], s[88:89], v[46:47]
v_mfma_f32_16x16x32_bf16 v[128:131], a[240:243], a[128:131], v[128:131]
ds_read_b128 a[248:251], v16 offset:4096
buffer_load_dwordx4 v10, s[20:23], 0 offen offset:768 lds
v_mfma_f32_16x16x32_bf16 v[132:135], a[240:243], a[132:135], v[132:135]
s_or_b64 s[50:51], s[44:45], s[50:51]
v_mfma_f32_16x16x32_bf16 v[136:139], a[240:243], a[136:139], v[136:139]
s_cbranch_scc1 L_SLOW9
L_BACK9:
v_mfma_f32_16x16x32_bf16 v[140:143], a[240:243], a[140:143], v[140:143]
s_waitcnt lgkmcnt(1)
v_mfma_f32_16x16x32_bf16 v[144:147], a[244:247], a[128:131], v[144:147]
ds_read_b128 a[252:255], v16 offset:6144
v_mfma_f32_16x16x32_bf16 v[148:151], a[244:247], a[132:135], v[148:151]
v_perm_b32 v63, v40, v19, s52
v_mfma_f32_16x16x32_bf16 v[152:155], a[244:247], a[136:139], v[152:155]
ds_read_b32 a144, v63
v_perm_b32 v62, v40, v19, s53
v_mfma_f32_16x16x32_bf16 v[156:159], a[244:247], a[140:143], v[156:159]
s_waitcnt lgkmcnt(2)
ds_read_b32 a145, v62
v_mfma_f32_16x16x32_bf16 v[160:163], a[248:251], a[128:131], v[160:163]
ds_read_b128 a[240:243], v16 offset:8192
v_perm_b32 v61, v44, v19, s52
v_mfma_f32_16x16x32_bf16 v[164:167], a[248:251], a[132:135], v[164:167]
ds_read_b32 a146, v61
v_perm_b32 v60, v44, v19, s53
v_mfma_f32_16x16x32_bf16 v[168:171], a[248:251], a[136:139], v[168:171]
s_add_u32 m0, s33, 77056
ds_read_b32 a147, v60
v_perm_b32 v59, v40, v19, s54
v_mfma_f32_16x16x32_bf16 v[172:175], a[248:251], a[140:143], v[172:175]
s_waitcnt lgkmcnt(4)
ds_read_b32 a148, v59
v_perm_b32 v58, v40, v19, s55
v_mfma_f32_16x16x32_bf16 v[176:179], a[252:255], a[128:131], v[176:179]
ds_read_b128 a[244:247], v16 offset:10240
buffer_load_dwordx4 v11, s[20:23], 0 offen offset:768 lds
v_mfma_f32_16x16x32_bf16 v[180:183], a[252:255], a[132:135], v[180:183]
ds_read_b32 a149, v58
v_perm_b32 v57, v44, v19, s54
v_mfma_f32_16x16x32_bf16 v[184:187], a[252:255], a[136:139], v[184:187]
ds_read_b32 a150, v57
v_perm_b32 v56, v44, v19, s55
v_mfma_f32_16x16x32_bf16 v[188:191], a[252:255], a[140:143], v[188:191]
s_waitcnt lgkmcnt(4)
ds_read_b32 a151, v56
buffer_load_dwordx4 v[80:83], v12, s[24:27], 0 offen offset:0 sc1
v_mfma_f32_16x16x32_bf16 v[192:195], a[240:243], a[128:131], v[192:195]
ds_read_b128 a[248:251], v16 offset:12288
v_perm_b32 v63, v41, v19, s52
v_mfma_f32_16x16x32_bf16 v[196:199], a[240:243], a[132:135], v[196:199]
ds_read_b32 a152, v63
v_perm_b32 v62, v41, v19, s53
v_mfma_f32_16x16x32_bf16 v[200:203], a[240:243], a[136:139], v[200:203]
ds_read_b32 a153, v62
v_perm_b32 v61, v45, v19, s52
v_mfma_f32_16x16x32_bf16 v[204:207], a[240:243], a[140:143], v[204:207]
s_waitcnt lgkmcnt(4)
ds_read_b32 a154, v61
buffer_load_dwordx4 v[84:87], v12, s[24:27], 0 offen offset:1024 sc1
v_mfma_f32_16x16x32_bf16 v[208:211], a[244:247], a[128:131], v[208:211]
ds_read_b128 a[252:255], v16 offset:14336
v_perm_b32 v60, v45, v19, s53
v_mfma_f32_16x16x32_bf16 v[212:215], a[244:247], a[132:135], v[212:215]
ds_read_b32 a155, v60
v_perm_b32 v59, v41, v19, s54
v_mfma_f32_16x16x32_bf16 v[216:219], a[244:247], a[136:139], v[216:219]
ds_read_b32 a156, v59
v_perm_b32 v58, v41, v19, s55
v_mfma_f32_16x16x32_bf16 v[220:223], a[244:247], a[140:143], v[220:223]
s_waitcnt lgkmcnt(4)
ds_read_b32 a157, v58
v_mfma_f32_16x16x32_bf16 v[224:227], a[248:251], a[128:131], v[224:227]
ds_read_b128 a[240:243], v17 offset:0
v_perm_b32 v57, v45, v19, s54
v_mfma_f32_16x16x32_bf16 v[228:231], a[248:251], a[132:135], v[228:231]
ds_read_b32 a158, v57
v_perm_b32 v56, v45, v19, s55
v_mfma_f32_16x16x32_bf16 v[232:235], a[248:251], a[136:139], v[232:235]
ds_read_b32 a159, v56
v_mfma_f32_16x16x32_bf16 v[236:239], a[248:251], a[140:143], v[236:239]
s_waitcnt lgkmcnt(4)
v_mfma_f32_16x16x32_bf16 v[240:243], a[252:255], a[128:131], v[240:243]
ds_read_b128 a[244:247], v17 offset:2048
v_mfma_f32_16x16x32_bf16 v[244:247], a[252:255], a[132:135], v[244:247]
v_mfma_f32_16x16x32_bf16 v[248:251], a[252:255], a[136:139], v[248:251]
s_waitcnt vmcnt(8)
v_cmp_ne_u64 s[50:51], s[88:89], v[50:51]
v_cmp_ne_u64 s[44:45], s[88:89], v[54:55]
v_mfma_f32_16x16x32_bf16 v[252:255], a[252:255], a[140:143], v[252:255]
s_waitcnt lgkmcnt(1)
v_mfma_f32_16x16x32_bf16 v[128:131], a[240:243], a[144:147], v[128:131]
s_or_b64 s[50:51], s[44:45], s[50:51]
ds_read_b128 a[248:251], v17 offset:4096
v_mfma_f32_16x16x32_bf16 v[132:135], a[240:243], a[148:151], v[132:135]
s_cbranch_scc1 L_SLOW10
L_BACK10:
v_mfma_f32_16x16x32_bf16 v[136:139], a[240:243], a[152:155], v[136:139]
s_add_u32 m0, s33, 81024
v_mfma_f32_16x16x32_bf16 v[140:143], a[240:243], a[156:159], v[140:143]
s_waitcnt lgkmcnt(1)
v_mfma_f32_16x16x32_bf16 v[144:147], a[244:247], a[144:147], v[144:147]
ds_read_b128 a[252:255], v17 offset:6144
buffer_load_dwordx4 v8, s[20:23], 0 offen offset:896 lds
v_mfma_f32_16x16x32_bf16 v[148:151], a[244:247], a[148:151], v[148:151]
v_perm_b32 v63, v48, v19, s52
v_mfma_f32_16x16x32_bf16 v[152:155], a[244:247], a[152:155], v[152:155]
ds_read_b32 a160, v63
v_perm_b32 v62, v48, v19, s53
v_mfma_f32_16x16x32_bf16 v[156:159], a[244:247], a[156:159], v[156:159]
s_waitcnt lgkmcnt(2)
ds_read_b32 a161, v62
v_mfma_f32_16x16x32_bf16 v[160:163], a[248:251], a[144:147], v[160:163]
s_barrier
ds_read_b128 a[240:243], v17 offset:8192
v_perm_b32 v61, v52, v19, s52
v_mfma_f32_16x16x32_bf16 v[164:167], a[248:251], a[148:151], v[164:167]
ds_read_b32 a162, v61
v_perm_b32 v60, v52, v19, s53
v_mfma_f32_16x16x32_bf16 v[168:171], a[248:251], a[152:155], v[168:171]
ds_read_b32 a163, v60
v_perm_b32 v59, v48, v19, s54
v_mfma_f32_16x16x32_bf16 v[172:175], a[248:251], a[156:159], v[172:175]
s_waitcnt lgkmcnt(4)
ds_read_b32 a164, v59
buffer_load_dwordx4 v[88:91], v12, s[24:27], 0 offen offset:2048 sc1
v_mfma_f32_16x16x32_bf16 v[176:179], a[252:255], a[144:147], v[176:179]
ds_read_b128 a[244:247], v17 offset:10240
v_perm_b32 v58, v48, v19, s55
v_mfma_f32_16x16x32_bf16 v[180:183], a[252:255], a[148:151], v[180:183]
ds_read_b32 a165, v58
v_perm_b32 v57, v52, v19, s54
v_mfma_f32_16x16x32_bf16 v[184:187], a[252:255], a[152:155], v[184:187]
ds_read_b32 a166, v57
v_perm_b32 v56, v52, v19, s55
v_mfma_f32_16x16x32_bf16 v[188:191], a[252:255], a[156:159], v[188:191]
s_waitcnt lgkmcnt(4)
ds_read_b32 a167, v56
buffer_load_dwordx4 v[92:95], v12, s[24:27], 0 offen offset:3072 sc1
v_mfma_f32_16x16x32_bf16 v[192:195], a[240:243], a[144:147], v[192:195]
ds_read_b128 a[248:251], v17 offset:12288
v_perm_b32 v63, v49, v19, s52
v_mfma_f32_16x16x32_bf16 v[196:199], a[240:243], a[148:151], v[196:199]
ds_read_b32 a168, v63
v_perm_b32 v62, v49, v19, s53
v_mfma_f32_16x16x32_bf16 v[200:203], a[240:243], a[152:155], v[200:203]
s_add_u32 m0, s33, 85120
ds_read_b32 a169, v62
v_perm_b32 v61, v53, v19, s52
v_mfma_f32_16x16x32_bf16 v[204:207], a[240:243], a[156:159], v[204:207]
s_waitcnt lgkmcnt(4)
ds_read_b32 a170, v61
v_perm_b32 v60, v53, v19, s53
v_mfma_f32_16x16x32_bf16 v[208:211], a[244:247], a[144:147], v[208:211]
ds_read_b128 a[252:255], v17 offset:14336
buffer_load_dwordx4 v9, s[20:23], 0 offen offset:896 lds
v_mfma_f32_16x16x32_bf16 v[212:215], a[244:247], a[148:151], v[212:215]
ds_read_b32 a171, v60
v_perm_b32 v59, v49, v19, s54
v_mfma_f32_16x16x32_bf16 v[216:219], a[244:247], a[152:155], v[216:219]
ds_read_b32 a172, v59
v_perm_b32 v58, v49, v19, s55
v_mfma_f32_16x16x32_bf16 v[220:223], a[244:247], a[156:159], v[220:223]
s_waitcnt lgkmcnt(4)
ds_read_b32 a173, v58
v_add_u32 v12, 28672, v13
v_mfma_f32_16x16x32_bf16 v[224:227], a[248:251], a[144:147], v[224:227]
ds_read_b128 a[240:243], v16 offset:16384
v_perm_b32 v57, v53, v19, s54
v_mfma_f32_16x16x32_bf16 v[228:231], a[248:251], a[148:151], v[228:231]
ds_read_b32 a174, v57
v_perm_b32 v56, v53, v19, s55
v_mfma_f32_16x16x32_bf16 v[232:235], a[248:251], a[152:155], v[232:235]
ds_read_b32 a175, v56
v_mfma_f32_16x16x32_bf16 v[236:239], a[248:251], a[156:159], v[236:239]
s_waitcnt lgkmcnt(4)
v_mfma_f32_16x16x32_bf16 v[240:243], a[252:255], a[144:147], v[240:243]
ds_read_b128 a[244:247], v16 offset:18432
v_mfma_f32_16x16x32_bf16 v[244:247], a[252:255], a[148:151], v[244:247]
v_mfma_f32_16x16x32_bf16 v[248:251], a[252:255], a[152:155], v[248:251]
s_add_u32 m0, s33, 89216
v_mfma_f32_16x16x32_bf16 v[252:255], a[252:255], a[156:159], v[252:255]
s_waitcnt vmcnt(9) lgkmcnt(1)
v_cmp_ne_u64 s[50:51], s[88:89], v[98:99]
v_cmp_ne_u64 s[44:45], s[88:89], v[102:103]
v_mfma_f32_16x16x32_bf16 v[128:131], a[240:243], a[160:163], v[128:131]
ds_read_b128 a[248:251], v16 offset:20480
buffer_load_dwordx4 v10, s[20:23], 0 offen offset:896 lds
v_mfma_f32_16x16x32_bf16 v[132:135], a[240:243], a[164:167], v[132:135]
s_or_b64 s[50:51], s[44:45], s[50:51]
v_mfma_f32_16x16x32_bf16 v[136:139], a[240:243], a[168:171], v[136:139]
s_cbranch_scc1 L_SLOW11
L_BACK11:
v_mfma_f32_16x16x32_bf16 v[140:143], a[240:243], a[172:175], v[140:143]
s_waitcnt lgkmcnt(1)
v_mfma_f32_16x16x32_bf16 v[144:147], a[244:247], a[160:163], v[144:147]
ds_read_b128 a[252:255], v16 offset:22528
v_mfma_f32_16x16x32_bf16 v[148:151], a[244:247], a[164:167], v[148:151]
v_perm_b32 v63, v96, v19, s52
v_mfma_f32_16x16x32_bf16 v[152:155], a[244:247], a[168:171], v[152:155]
ds_read_b32 a176, v63
v_perm_b32 v62, v96, v19, s53
v_mfma_f32_16x16x32_bf16 v[156:159], a[244:247], a[172:175], v[156:159]
s_waitcnt lgkmcnt(2)
ds_read_b32 a177, v62
buffer_load_dwordx4 v[32:35], v12, s[24:27], 0 offen offset:0 sc1
v_mfma_f32_16x16x32_bf16 v[160:163], a[248:251], a[160:163], v[160:163]
ds_read_b128 a[240:243], v16 offset:24576
v_perm_b32 v61, v100, v19, s52
v_mfma_f32_16x16x32_bf16 v[164:167], a[248:251], a[164:167], v[164:167]
ds_read_b32 a178, v61
v_perm_b32 v60, v100, v19, s53
v_mfma_f32_16x16x32_bf16 v[168:171], a[248:251], a[168:171], v[168:171]
s_add_u32 m0, s33, 93312
ds_read_b32 a179, v60
v_perm_b32 v59, v96, v19, s54
v_mfma_f32_16x16x32_bf16 v[172:175], a[248:251], a[172:175], v[172:175]
s_waitcnt lgkmcnt(4)
ds_read_b32 a180, v59
v_perm_b32 v58, v96, v19, s55
v_mfma_f32_16x16x32_bf16 v[176:179], a[252:255], a[160:163], v[176:179]
ds_read_b128 a[244:247], v16 offset:26624
buffer_load_dwordx4 v11, s[20:23], 0 offen offset:896 lds
v_mfma_f32_16x16x32_bf16 v[180:183], a[252:255], a[164:167], v[180:183]
ds_read_b32 a181, v58
v_perm_b32 v57, v100, v19, s54
v_mfma_f32_16x16x32_bf16 v[184:187], a[252:255], a[168:171], v[184:187]
ds_read_b32 a182, v57
v_perm_b32 v56, v100, v19, s55
v_mfma_f32_16x16x32_bf16 v[188:191], a[252:255], a[172:175], v[188:191]
s_waitcnt lgkmcnt(4)
ds_read_b32 a183, v56
buffer_load_dwordx4 v[36:39], v12, s[24:27], 0 offen offset:1024 sc1
v_mfma_f32_16x16x32_bf16 v[192:195], a[240:243], a[160:163], v[192:195]
ds_read_b128 a[248:251], v16 offset:28672
v_perm_b32 v63, v97, v19, s52
v_mfma_f32_16x16x32_bf16 v[196:199], a[240:243], a[164:167], v[196:199]
ds_read_b32 a184, v63
v_perm_b32 v62, v97, v19, s53
v_mfma_f32_16x16x32_bf16 v[200:203], a[240:243], a[168:171], v[200:203]
ds_read_b32 a185, v62
v_perm_b32 v61, v101, v19, s52
v_mfma_f32_16x16x32_bf16 v[204:207], a[240:243], a[172:175], v[204:207]
s_waitcnt lgkmcnt(4)
ds_read_b32 a186, v61
v_mfma_f32_16x16x32_bf16 v[208:211], a[244:247], a[160:163], v[208:211]
ds_read_b128 a[252:255], v16 offset:30720
v_perm_b32 v60, v101, v19, s53
v_mfma_f32_16x16x32_bf16 v[212:215], a[244:247], a[164:167], v[212:215]
ds_read_b32 a187, v60
v_perm_b32 v59, v97, v19, s54
v_mfma_f32_16x16x32_bf16 v[216:219], a[244:247], a[168:171], v[216:219]
L_PAD2:
s_cbranch_vccnz L_PAD3
ds_read_b32 a188, v59
v_perm_b32 v58, v97, v19, s55
v_mfma_f32_16x16x32_bf16 v[220:223], a[244:247], a[172:175], v[220:223]
s_waitcnt lgkmcnt(4)
ds_read_b32 a189, v58
v_mfma_f32_16x16x32_bf16 v[224:227], a[248:251], a[160:163], v[224:227]
ds_read_b128 a[240:243], v17 offset:16384
v_perm_b32 v57, v101, v19, s54
v_mfma_f32_16x16x32_bf16 v[228:231], a[248:251], a[164:167], v[228:231]
ds_read_b32 a190, v57
v_perm_b32 v56, v101, v19, s55
v_mfma_f32_16x16x32_bf16 v[232:235], a[248:251], a[168:171], v[232:235]
s_add_u32 m0, s33, 97280
ds_read_b32 a191, v56
v_mfma_f32_16x16x32_bf16 v[236:239], a[248:251], a[172:175], v[236:239]
s_waitcnt lgkmcnt(4)
v_mfma_f32_16x16x32_bf16 v[240:243], a[252:255], a[160:163], v[240:243]
ds_read_b128 a[244:247], v17 offset:18432
buffer_load_dwordx4 v8, s[20:23], 0 offen offset:1024 lds
v_mfma_f32_16x16x32_bf16 v[244:247], a[252:255], a[164:167], v[244:247]
v_mfma_f32_16x16x32_bf16 v[248:251], a[252:255], a[168:171], v[248:251]
s_waitcnt vmcnt(9)
v_cmp_ne_u64 s[50:51], s[88:89], v[82:83]
v_cmp_ne_u64 s[44:45], s[88:89], v[86:87]
v_mfma_f32_16x16x32_bf16 v[252:255], a[252:255], a[172:175], v[252:255]
s_waitcnt lgkmcnt(1)
v_mfma_f32_16x16x32_bf16 v[128:131], a[240:243], a[176:179], v[128:131]
s_or_b64 s[50:51], s[44:45], s[50:51]
ds_read_b128 a[248:251], v17 offset:20480
v_mfma_f32_16x16x32_bf16 v[132:135], a[240:243], a[180:183], v[132:135]
s_cbranch_scc1 L_SLOW12
L_BACK12:
v_mfma_f32_16x16x32_bf16 v[136:139], a[240:243], a[184:187], v[136:139]
s_add_u32 m0, s33, 101376
buffer_load_dwordx4 v[40:43], v12, s[24:27], 0 offen offset:2048 sc1
v_mfma_f32_16x16x32_bf16 v[140:143], a[240:243], a[188:191], v[140:143]
s_waitcnt lgkmcnt(1)
buffer_load_dwordx4 v[44:47], v12, s[24:27], 0 offen offset:3072 sc1
v_mfma_f32_16x16x32_bf16 v[144:147], a[244:247], a[176:179], v[144:147]
ds_read_b128 a[252:255], v17 offset:22528
buffer_load_dwordx4 v9, s[20:23], 0 offen offset:1024 lds
v_mfma_f32_16x16x32_bf16 v[148:151], a[244:247], a[180:183], v[148:151]
v_perm_b32 v63, v80, v19, s52
v_add_u32 v12, 32768, v13
v_mfma_f32_16x16x32_bf16 v[152:155], a[244:247], a[184:187], v[152:155]
ds_read_b32 a192, v63
v_perm_b32 v62, v80, v19, s53
v_mfma_f32_16x16x32_bf16 v[156:159], a[244:247], a[188:191], v[156:159]
s_waitcnt lgkmcnt(2)
ds_read_b32 a193, v62
v_mfma_f32_16x16x32_bf16 v[160:163], a[248:251], a[176:179], v[160:163]
s_barrier
ds_read_b128 a[240:243], v17 offset:24576
v_perm_b32 v61, v84, v19, s52
v_mfma_f32_16x16x32_bf16 v[164:167], a[248:251], a[180:183], v[164:167]
ds_read_b32 a194, v61
v_perm_b32 v60, v84, v19, s53
v_mfma_f32_16x16x32_bf16 v[168:171], a[248:251], a[184:187], v[168:171]
ds_read_b32 a195, v60
v_perm_b32 v59, v80, v19, s54
v_mfma_f32_16x16x32_bf16 v[172:175], a[248:251], a[188:191], v[172:175]
s_waitcnt lgkmcnt(4)
ds_read_b32 a196, v59
v_mfma_f32_16x16x32_bf16 v[176:179], a[252:255], a[176:179], v[176:179]
ds_read_b128 a[244:247], v17 offset:26624
v_perm_b32 v58, v80, v19, s55
v_mfma_f32_16x16x32_bf16 v[180:183], a[252:255], a[180:183], v[180:183]
ds_read_b32 a197, v58
v_perm_b32 v57, v84, v19, s54
v_mfma_f32_16x16x32_bf16 v[184:187], a[252:255], a[184:187], v[184:187]
ds_read_b32 a198, v57
v_perm_b32 v56, v84, v19, s55
v_mfma_f32_16x16x32_bf16 v[188:191], a[252:255], a[188:191], v[188:191]
s_waitcnt lgkmcnt(4)
ds_read_b32 a199, v56
v_mfma_f32_16x16x32_bf16 v[192:195], a[240:243], a[176:179], v[192:195]
ds_read_b128 a[248:251], v17 offset:28672
v_perm_b32 v63, v81, v19, s52
v_mfma_f32_16x16x32_bf16 v[196:199], a[240:243], a[180:183], v[196:199]
ds_read_b32 a200, v63
v_perm_b32 v62, v81, v19, s53
v_mfma_f32_16x16x32_bf16 v[200:203], a[240:243], a[184:187], v[200:203]
s_add_u32 m0, s33, 105472
ds_read_b32 a201, v62
v_perm_b32 v61, v85, v19, s52
v_mfma_f32_16x16x32_bf16 v[204:207], a[240:243], a[188:191], v[204:207]
s_waitcnt lgkmcnt(4)
ds_read_b32 a202, v61
v_perm_b32 v60, v85, v19, s53
v_mfma_f32_16x16x32_bf16 v[208:211], a[244:247], a[176:179], v[208:211]
ds_read_b128 a[252:255], v17 offset:30720
buffer_load_dwordx4 v10, s[20:23], 0 offen offset:1024 lds
v_mfma_f32_16x16x32_bf16 v[212:215], a[244:247], a[180:183], v[212:215]
ds_read_b32 a203, v60
v_perm_b32 v59, v81, v19, s54
v_mfma_f32_16x16x32_bf16 v[216:219], a[244:247], a[184:187], v[216:219]
ds_read_b32 a204, v59
v_perm_b32 v58, v81, v19, s55
v_mfma_f32_16x16x32_bf16 v[220:223], a[244:247], a[188:191], v[220:223]
s_waitcnt lgkmcnt(4)
ds_read_b32 a205, v58
v_mfma_f32_16x16x32_bf16 v[224:227], a[248:251], a[176:179], v[224:227]
ds_read_b128 a[240:243], v14 offset:0
v_perm_b32 v57, v85, v19, s54
v_mfma_f32_16x16x32_bf16 v[228:231], a[248:251], a[180:183], v[228:231]
ds_read_b32 a206, v57
v_perm_b32 v56, v85, v19, s55
v_mfma_f32_16x16x32_bf16 v[232:235], a[248:251], a[184:187], v[232:235]
ds_read_b32 a207, v56
v_mfma_f32_16x16x32_bf16 v[236:239], a[248:251], a[188:191], v[236:239]
s_waitcnt lgkmcnt(4)
buffer_load_dwordx4 v[48:51], v12, s[24:27], 0 offen offset:0 sc1
v_mfma_f32_16x16x32_bf16 v[240:243], a[252:255], a[176:179], v[240:243]
ds_read_b128 a[244:247], v14 offset:2048
buffer_load_dwordx4 v[52:55], v12, s[24:27], 0 offen offset:1024 sc1
v_mfma_f32_16x16x32_bf16 v[244:247], a[252:255], a[180:183], v[244:247]
v_mfma_f32_16x16x32_bf16 v[248:251], a[252:255], a[184:187], v[248:251]
s_add_u32 m0, s33, 109440
v_mfma_f32_16x16x32_bf16 v[252:255], a[252:255], a[188:191], v[252:255]
s_waitcnt vmcnt(12) lgkmcnt(1)
v_cmp_ne_u64 s[50:51], s[88:89], v[90:91]
v_cmp_ne_u64 s[44:45], s[88:89], v[94:95]
v_mfma_f32_16x16x32_bf16 v[128:131], a[240:243], a[192:195], v[128:131]
ds_read_b128 a[248:251], v14 offset:4096
buffer_load_dwordx4 v8, s[20:23], 0 offen offset:1152 lds
v_mfma_f32_16x16x32_bf16 v[132:135], a[240:243], a[196:199], v[132:135]
s_or_b64 s[50:51], s[44:45], s[50:51]
v_mfma_f32_16x16x32_bf16 v[136:139], a[240:243], a[200:203], v[136:139]
s_cbranch_scc1 L_SLOW13
L_BACK13:
v_mfma_f32_16x16x32_bf16 v[140:143], a[240:243], a[204:207], v[140:143]
s_waitcnt lgkmcnt(1)
v_mfma_f32_16x16x32_bf16 v[144:147], a[244:247], a[192:195], v[144:147]
ds_read_b128 a[252:255], v14 offset:6144
v_mfma_f32_16x16x32_bf16 v[148:151], a[244:247], a[196:199], v[148:151]
v_perm_b32 v63, v88, v19, s52
v_mfma_f32_16x16x32_bf16 v[152:155], a[244:247], a[200:203], v[152:155]
ds_read_b32 a208, v63
v_perm_b32 v62, v88, v19, s53
v_mfma_f32_16x16x32_bf16 v[156:159], a[244:247], a[204:207], v[156:159]
s_waitcnt lgkmcnt(2)
ds_read_b32 a209, v62
v_mfma_f32_16x16x32_bf16 v[160:163], a[248:251], a[192:195], v[160:163]
ds_read_b128 a[240:243], v14 offset:8192
v_perm_b32 v61, v92, v19, s52
v_mfma_f32_16x16x32_bf16 v[164:167], a[248:251], a[196:199], v[164:167]
ds_read_b32 a210, v61
v_perm_b32 v60, v92, v19, s53
v_mfma_f32_16x16x32_bf16 v[168:171], a[248:251], a[200:203], v[168:171]
s_add_u32 m0, s33, 113664
ds_read_b32 a211, v60
v_perm_b32 v59, v88, v19, s54
v_mfma_f32_16x16x32_bf16 v[172:175], a[248:251], a[204:207], v[172:175]
s_waitcnt lgkmcnt(4)
ds_read_b32 a212, v59
v_perm_b32 v58, v88, v19, s55
v_mfma_f32_16x16x32_bf16 v[176:179], a[252:255], a[192:195], v[176:179]
ds_read_b128 a[244:247], v14 offset:10240
buffer_load_dwordx4 v11, s[20:23], 0 offen offset:1024 lds
v_mfma_f32_16x16x32_bf16 v[180:183], a[252:255], a[196:199], v[180:183]
ds_read_b32 a213, v58
v_perm_b32 v57, v92, v19, s54
v_mfma_f32_16x16x32_bf16 v[184:187], a[252:255], a[200:203], v[184:187]
ds_read_b32 a214, v57
v_perm_b32 v56, v92, v19, s55
v_mfma_f32_16x16x32_bf16 v[188:191], a[252:255], a[204:207], v[188:191]
s_waitcnt lgkmcnt(4)
ds_read_b32 a215, v56
v_mfma_f32_16x16x32_bf16 v[192:195], a[240:243], a[192:195], v[192:195]
ds_read_b128 a[248:251], v14 offset:12288
v_perm_b32 v63, v89, v19, s52
v_mfma_f32_16x16x32_bf16 v[196:199], a[240:243], a[196:199], v[196:199]
ds_read_b32 a216, v63
v_perm_b32 v62, v89, v19, s53
v_mfma_f32_16x16x32_bf16 v[200:203], a[240:243], a[200:203], v[200:203]
ds_read_b32 a217, v62
v_perm_b32 v61, v93, v19, s52
v_mfma_f32_16x16x32_bf16 v[204:207], a[240:243], a[204:207], v[204:207]
s_waitcnt lgkmcnt(4)
ds_read_b32 a218, v61
v_mfma_f32_16x16x32_bf16 v[208:211], a[244:247], a[192:195], v[208:211]
ds_read_b128 a[252:255], v14 offset:14336
v_perm_b32 v60, v93, v19, s53
v_mfma_f32_16x16x32_bf16 v[212:215], a[244:247], a[196:199], v[212:215]
ds_read_b32 a219, v60
v_perm_b32 v59, v89, v19, s54
v_mfma_f32_16x16x32_bf16 v[216:219], a[244:247], a[200:203], v[216:219]
ds_read_b32 a220, v59
v_perm_b32 v58, v89, v19, s55
v_mfma_f32_16x16x32_bf16 v[220:223], a[244:247], a[204:207], v[220:223]
s_waitcnt lgkmcnt(4)
ds_read_b32 a221, v58
buffer_load_dwordx4 v[96:99], v12, s[24:27], 0 offen offset:2048 sc1
v_mfma_f32_16x16x32_bf16 v[224:227], a[248:251], a[192:195], v[224:227]
ds_read_b128 a[240:243], v15 offset:0
v_perm_b32 v57, v93, v19, s54
v_mfma_f32_16x16x32_bf16 v[228:231], a[248:251], a[196:199], v[228:231]
ds_read_b32 a222, v57
v_perm_b32 v56, v93, v19, s55
v_mfma_f32_16x16x32_bf16 v[232:235], a[248:251], a[200:203], v[232:235]
ds_read_b32 a223, v56
buffer_load_dwordx4 v[100:103], v12, s[24:27], 0 offen offset:3072 sc1
v_mfma_f32_16x16x32_bf16 v[236:239], a[248:251], a[204:207], v[236:239]
s_waitcnt vmcnt(11) lgkmcnt(4)
v_cmp_ne_u64 s[50:51], s[88:89], v[34:35]
v_cmp_ne_u64 s[44:45], s[88:89], v[38:39]
v_mfma_f32_16x16x32_bf16 v[240:243], a[252:255], a[192:195], v[240:243]
ds_read_b128 a[244:247], v15 offset:2048
v_add_u32 v12, 36864, v13
v_mfma_f32_16x16x32_bf16 v[244:247], a[252:255], a[196:199], v[244:247]
s_or_b64 s[50:51], s[44:45], s[50:51]
v_mfma_f32_16x16x32_bf16 v[248:251], a[252:255], a[200:203], v[248:251]
s_cbranch_scc1 L_SLOW14
L_BACK14:
v_mfma_f32_16x16x32_bf16 v[252:255], a[252:255], a[204:207], v[252:255]
s_waitcnt lgkmcnt(1)
v_mfma_f32_16x16x32_bf16 v[128:131], a[240:243], a[208:211], v[128:131]
ds_read_b128 a[248:251], v15 offset:4096
v_perm_b32 v63, v32, v19, s52
v_mfma_f32_16x16x32_bf16 v[132:135], a[240:243], a[212:215], v[132:135]
ds_read_b32 a224, v63
v_perm_b32 v62, v32, v19, s53
v_mfma_f32_16x16x32_bf16 v[136:139], a[240:243], a[216:219], v[136:139]
s_add_u32 m0, s33, 117632
ds_read_b32 a225, v62
v_perm_b32 v61, v36, v19, s52
v_mfma_f32_16x16x32_bf16 v[140:143], a[240:243], a[220:223], v[140:143]
s_waitcnt lgkmcnt(3)
ds_read_b32 a226, v61
v_perm_b32 v60, v36, v19, s53
v_mfma_f32_16x16x32_bf16 v[144:147], a[244:247], a[208:211], v[144:147]
ds_read_b128 a[252:255], v15 offset:6144
buffer_load_dwordx4 v9, s[20:23], 0 offen offset:1152 lds
v_mfma_f32_16x16x32_bf16 v[148:151], a[244:247], a[212:215], v[148:151]
ds_read_b32 a227, v60
v_perm_b32 v59, v32, v19, s54
v_mfma_f32_16x16x32_bf16 v[152:155], a[244:247], a[216:219], v[152:155]
ds_read_b32 a228, v59
v_perm_b32 v58, v32, v19, s55
v_mfma_f32_16x16x32_bf16 v[156:159], a[244:247], a[220:223], v[156:159]
s_waitcnt lgkmcnt(4)
ds_read_b32 a229, v58
v_mfma_f32_16x16x32_bf16 v[160:163], a[248:251], a[208:211], v[160:163]
s_barrier
ds_read_b128 a[240:243], v15 offset:8192
v_perm_b32 v57, v36, v19, s54
v_mfma_f32_16x16x32_bf16 v[164:167], a[248:251], a[212:215], v[164:167]
ds_read_b32 a230, v57
v_perm_b32 v56, v36, v19, s55
v_mfma_f32_16x16x32_bf16 v[168:171], a[248:251], a[216:219], v[168:171]
ds_read_b32 a231, v56
v_perm_b32 v63, v33, v19, s52
v_mfma_f32_16x16x32_bf16 v[172:175], a[248:251], a[220:223], v[172:175]
s_waitcnt lgkmcnt(4)
ds_read_b32 a232, v63
v_mfma_f32_16x16x32_bf16 v[176:179], a[252:255], a[208:211], v[176:179]
ds_read_b128 a[244:247], v15 offset:10240
v_perm_b32 v62, v33, v19, s53
v_mfma_f32_16x16x32_bf16 v[180:183], a[252:255], a[212:215], v[180:183]
ds_read_b32 a233, v62
v_perm_b32 v61, v37, v19, s52
v_mfma_f32_16x16x32_bf16 v[184:187], a[252:255], a[216:219], v[184:187]
ds_read_b32 a234, v61
v_perm_b32 v60, v37, v19, s53
v_mfma_f32_16x16x32_bf16 v[188:191], a[252:255], a[220:223], v[188:191]
s_waitcnt lgkmcnt(4)
ds_read_b32 a235, v60
buffer_load_dwordx4 v[80:83], v12, s[24:27], 0 offen offset:0 sc1
v_mfma_f32_16x16x32_bf16 v[192:195], a[240:243], a[208:211], v[192:195]
ds_read_b128 a[248:251], v15 offset:12288
v_perm_b32 v59, v33, v19, s54
v_mfma_f32_16x16x32_bf16 v[196:199], a[240:243], a[212:215], v[196:199]
ds_read_b32 a236, v59
v_perm_b32 v58, v33, v19, s55
v_mfma_f32_16x16x32_bf16 v[200:203], a[240:243], a[216:219], v[200:203]
s_add_u32 m0, s33, 121728
ds_read_b32 a237, v58
v_perm_b32 v57, v37, v19, s54
v_mfma_f32_16x16x32_bf16 v[204:207], a[240:243], a[220:223], v[204:207]
s_waitcnt lgkmcnt(4)
ds_read_b32 a238, v57
v_perm_b32 v56, v37, v19, s55
v_mfma_f32_16x16x32_bf16 v[208:211], a[244:247], a[208:211], v[208:211]
ds_read_b128 a[252:255], v14 offset:16384
buffer_load_dwordx4 v10, s[20:23], 0 offen offset:1152 lds
v_mfma_f32_16x16x32_bf16 v[212:215], a[244:247], a[212:215], v[212:215]
ds_read_b32 a239, v56
buffer_load_dwordx4 v[84:87], v12, s[24:27], 0 offen offset:1024 sc1
v_mfma_f32_16x16x32_bf16 v[216:219], a[244:247], a[216:219], v[216:219]
s_waitcnt vmcnt(12)
v_cmp_ne_u64 s[50:51], s[88:89], v[42:43]
v_cmp_ne_u64 s[44:45], s[88:89], v[46:47]
v_mfma_f32_16x16x32_bf16 v[220:223], a[244:247], a[220:223], v[220:223]
s_waitcnt lgkmcnt(3)
v_mfma_f32_16x16x32_bf16 v[224:227], a[248:251], a[208:211], v[224:227]
s_or_b64 s[50:51], s[44:45], s[50:51]
ds_read_b128 a[240:243], v14 offset:18432
v_mfma_f32_16x16x32_bf16 v[228:231], a[248:251], a[212:215], v[228:231]
s_cbranch_scc1 L_SLOW15
L_BACK15:
v_mfma_f32_16x16x32_bf16 v[232:235], a[248:251], a[216:219], v[232:235]
v_perm_b32 v63, v40, v19, s52
v_mfma_f32_16x16x32_bf16 v[236:239], a[248:251], a[220:223], v[236:239]
s_waitcnt lgkmcnt(1)
ds_read_b32 a0, v63
v_mfma_f32_16x16x32_bf16 v[128:131], a[252:255], a[224:227], v[128:131]
ds_read_b128 a[244:247], v14 offset:20480
v_perm_b32 v62, v40, v19, s53
v_mfma_f32_16x16x32_bf16 v[132:135], a[252:255], a[228:231], v[132:135]
ds_read_b32 a1, v62
v_perm_b32 v61, v44, v19, s52
v_mfma_f32_16x16x32_bf16 v[136:139], a[252:255], a[232:235], v[136:139]
s_add_u32 m0, s33, 125696
ds_read_b32 a2, v61
v_perm_b32 v60, v44, v19, s53
v_mfma_f32_16x16x32_bf16 v[140:143], a[252:255], a[236:239], v[140:143]
s_waitcnt lgkmcnt(4)
ds_read_b32 a3, v60
v_perm_b32 v59, v40, v19, s54
v_mfma_f32_16x16x32_bf16 v[144:147], a[240:243], a[224:227], v[144:147]
ds_read_b128 a[248:251], v14 offset:22528
buffer_load_dwordx4 v8, s[20:23], 0 offen offset:1280 lds
v_mfma_f32_16x16x32_bf16 v[148:151], a[240:243], a[228:231], v[148:151]
ds_read_b32 a4, v59
v_perm_b32 v58, v40, v19, s55
v_mfma_f32_16x16x32_bf16 v[152:155], a[240:243], a[232:235], v[152:155]
ds_read_b32 a5, v58
v_perm_b32 v57, v44, v19, s54
v_mfma_f32_16x16x32_bf16 v[156:159], a[240:243], a[236:239], v[156:159]
s_waitcnt lgkmcnt(4)
ds_read_b32 a6, v57
v_mfma_f32_16x16x32_bf16 v[160:163], a[244:247], a[224:227], v[160:163]
ds_read_b128 a[252:255], v14 offset:24576
v_perm_b32 v56, v44, v19, s55
v_mfma_f32_16x16x32_bf16 v[164:167], a[244:247], a[228:231], v[164:167]
ds_read_b32 a7, v56
v_perm_b32 v63, v41, v19, s52
v_mfma_f32_16x16x32_bf16 v[168:171], a[244:247], a[232:235], v[168:171]
ds_read_b32 a8, v63
v_perm_b32 v62, v41, v19, s53
v_mfma_f32_16x16x32_bf16 v[172:175], a[244:247], a[236:239], v[172:175]
s_waitcnt lgkmcnt(4)
ds_read_b32 a9, v62
v_mfma_f32_16x16x32_bf16 v[176:179], a[248:251], a[224:227], v[176:179]
ds_read_b128 a[240:243], v15 offset:14336
v_perm_b32 v61, v45, v19, s52
v_mfma_f32_16x16x32_bf16 v[180:183], a[248:251], a[228:231], v[180:183]
ds_read_b32 a10, v61
v_perm_b32 v60, v45, v19, s53
v_mfma_f32_16x16x32_bf16 v[184:187], a[248:251], a[232:235], v[184:187]
s_add_u32 m0, s33, 129792
ds_read_b32 a11, v60
v_perm_b32 v59, v41, v19, s54
v_mfma_f32_16x16x32_bf16 v[188:191], a[248:251], a[236:239], v[188:191]
s_waitcnt lgkmcnt(4)
ds_read_b32 a12, v59
v_perm_b32 v58, v41, v19, s55
v_mfma_f32_16x16x32_bf16 v[192:195], a[252:255], a[224:227], v[192:195]
ds_read_b128 a[244:247], v14 offset:26624
buffer_load_dwordx4 v9, s[20:23], 0 offen offset:1280 lds
v_mfma_f32_16x16x32_bf16 v[196:199], a[252:255], a[228:231], v[196:199]
ds_read_b32 a13, v58
v_perm_b32 v57, v45, v19, s54
v_mfma_f32_16x16x32_bf16 v[200:203], a[252:255], a[232:235], v[200:203]
ds_read_b32 a14, v57
buffer_load_dwordx4 v[88:91], v12, s[24:27], 0 offen offset:2048 sc1
v_mfma_f32_16x16x32_bf16 v[204:207], a[252:255], a[236:239], v[204:207]
s_waitcnt vmcnt(11) lgkmcnt(4)
v_cmp_ne_u64 s[50:51], s[88:89], v[50:51]
v_cmp_ne_u64 s[44:45], s[88:89], v[54:55]
v_mfma_f32_16x16x32_bf16 v[240:243], a[240:243], a[208:211], v[240:243]
ds_read_b128 a[248:251], v15 offset:16384
v_perm_b32 v56, v45, v19, s55
v_mfma_f32_16x16x32_bf16 v[244:247], a[240:243], a[212:215], v[244:247]
s_or_b64 s[50:51], s[44:45], s[50:51]
ds_read_b32 a15, v56
buffer_load_dwordx4 v[92:95], v12, s[24:27], 0 offen offset:3072 sc1
v_mfma_f32_16x16x32_bf16 v[248:251], a[240:243], a[216:219], v[248:251]
s_cbranch_scc1 L_SLOW16
L_BACK16:
v_mfma_f32_16x16x32_bf16 v[252:255], a[240:243], a[220:223], v[252:255]
s_waitcnt lgkmcnt(2)
v_add_u32 v12, 40960, v13
v_mfma_f32_16x16x32_bf16 v[208:211], a[244:247], a[224:227], v[208:211]
ds_read_b128 a[252:255], v14 offset:28672
v_perm_b32 v63, v48, v19, s52
v_mfma_f32_16x16x32_bf16 v[212:215], a[244:247], a[228:231], v[212:215]
ds_read_b32 a16, v63
v_perm_b32 v62, v48, v19, s53
v_mfma_f32_16x16x32_bf16 v[216:219], a[244:247], a[232:235], v[216:219]
ds_read_b32 a17, v62
v_perm_b32 v61, v52, v19, s52
v_mfma_f32_16x16x32_bf16 v[220:223], a[244:247], a[236:239], v[220:223]
s_waitcnt lgkmcnt(3)
ds_read_b32 a18, v61
v_mfma_f32_16x16x32_bf16 v[128:131], a[248:251], a[0:3], v[128:131]
ds_read_b128 a[240:243], v15 offset:18432
v_perm_b32 v60, v52, v19, s53
v_mfma_f32_16x16x32_bf16 v[132:135], a[248:251], a[4:7], v[132:135]
ds_read_b32 a19, v60
v_perm_b32 v59, v48, v19, s54
v_mfma_f32_16x16x32_bf16 v[136:139], a[248:251], a[8:11], v[136:139]
ds_read_b32 a20, v59
v_perm_b32 v58, v48, v19, s55
v_mfma_f32_16x16x32_bf16 v[140:143], a[248:251], a[12:15], v[140:143]
s_waitcnt lgkmcnt(4)
ds_read_b32 a21, v58
v_mfma_f32_16x16x32_bf16 v[224:227], a[252:255], a[224:227], v[224:227]
ds_read_b128 a[244:247], v15 offset:20480
v_perm_b32 v57, v52, v19, s54
v_mfma_f32_16x16x32_bf16 v[228:231], a[252:255], a[228:231], v[228:231]
ds_read_b32 a22, v57
v_perm_b32 v56, v52, v19, s55
v_mfma_f32_16x16x32_bf16 v[232:235], a[252:255], a[232:235], v[232:235]
ds_read_b32 a23, v56
v_perm_b32 v63, v49, v19, s52
v_mfma_f32_16x16x32_bf16 v[236:239], a[252:255], a[236:239], v[236:239]
s_waitcnt lgkmcnt(4)
ds_read_b32 a24, v63
v_mfma_f32_16x16x32_bf16 v[144:147], a[240:243], a[0:3], v[144:147]
ds_read_b128 a[248:251], v15 offset:22528
v_perm_b32 v62, v49, v19, s53
v_mfma_f32_16x16x32_bf16 v[148:151], a[240:243], a[4:7], v[148:151]
ds_read_b32 a25, v62
v_perm_b32 v61, v53, v19, s52
v_mfma_f32_16x16x32_bf16 v[152:155], a[240:243], a[8:11], v[152:155]
s_add_u32 m0, s33, 134016
ds_read_b32 a26, v61
v_perm_b32 v60, v53, v19, s53
v_mfma_f32_16x16x32_bf16 v[156:159], a[240:243], a[12:15], v[156:159]
s_waitcnt lgkmcnt(4)
ds_read_b32 a27, v60
v_perm_b32 v59, v49, v19, s54
v_mfma_f32_16x16x32_bf16 v[160:163], a[244:247], a[0:3], v[160:163]
ds_read_b128 a[252:255], v15 offset:24576
buffer_load_dwordx4 v11, s[20:23], 0 offen offset:1152 lds
v_mfma_f32_16x16x32_bf16 v[164:167], a[244:247], a[4:7], v[164:167]
ds_read_b32 a28, v59
v_perm_b32 v58, v49, v19, s55
v_mfma_f32_16x16x32_bf16 v[168:171], a[244:247], a[8:11], v[168:171]
ds_read_b32 a29, v58
v_perm_b32 v57, v53, v19, s54
v_mfma_f32_16x16x32_bf16 v[172:175], a[244:247], a[12:15], v[172:175]
s_waitcnt lgkmcnt(4)
ds_read_b32 a30, v57
buffer_load_dwordx4 v[32:35], v12, s[24:27], 0 offen offset:0 sc1
v_mfma_f32_16x16x32_bf16 v[176:179], a[248:251], a[0:3], v[176:179]
s_waitcnt vmcnt(12)
s_barrier
ds_read_b128 a[240:243], v14 offset:32768
v_perm_b32 v56, v53, v19, s55
v_mfma_f32_16x16x32_bf16 v[180:183], a[248:251], a[4:7], v[180:183]
ds_read_b32 a31, v56
buffer_load_dwordx4 v[36:39], v12, s[24:27], 0 offen offset:1024 sc1
v_mfma_f32_16x16x32_bf16 v[184:187], a[248:251], a[8:11], v[184:187]
s_waitcnt vmcnt(11)
v_cmp_ne_u64 s[50:51], s[88:89], v[98:99]
v_cmp_ne_u64 s[44:45], s[88:89], v[102:103]
v_mfma_f32_16x16x32_bf16 v[188:191], a[248:251], a[12:15], v[188:191]
s_waitcnt lgkmcnt(3)
v_mfma_f32_16x16x32_bf16 v[192:195], a[252:255], a[0:3], v[192:195]
s_or_b64 s[50:51], s[44:45], s[50:51]
ds_read_b128 a[244:247], v15 offset:26624
v_mfma_f32_16x16x32_bf16 v[196:199], a[252:255], a[4:7], v[196:199]
s_cbranch_scc1 L_SLOW17
L_BACK17:
v_mfma_f32_16x16x32_bf16 v[200:203], a[252:255], a[8:11], v[200:203]
v_perm_b32 v63, v96, v19, s52
v_mfma_f32_16x16x32_bf16 v[204:207], a[252:255], a[12:15], v[204:207]
s_waitcnt lgkmcnt(1)
ds_read_b32 a32, v63
v_mfma_f32_16x16x32_bf16 v[128:131], a[240:243], a[16:19], v[128:131]
ds_read_b128 a[248:251], v14 offset:34816
v_perm_b32 v62, v96, v19, s53
v_mfma_f32_16x16x32_bf16 v[132:135], a[240:243], a[20:23], v[132:135]
ds_read_b32 a33, v62
v_perm_b32 v61, v100, v19, s52
v_mfma_f32_16x16x32_bf16 v[136:139], a[240:243], a[24:27], v[136:139]
s_add_u32 m0, s33, 137984
ds_read_b32 a34, v61
v_perm_b32 v60, v100, v19, s53
v_mfma_f32_16x16x32_bf16 v[140:143], a[240:243], a[28:31], v[140:143]
s_waitcnt lgkmcnt(4)
ds_read_b32 a35, v60
v_perm_b32 v59, v96, v19, s54
v_mfma_f32_16x16x32_bf16 v[208:211], a[244:247], a[0:3], v[208:211]
ds_read_b128 a[252:255], v14 offset:36864
buffer_load_dwordx4 v10, s[20:23], 0 offen offset:1280 lds
v_mfma_f32_16x16x32_bf16 v[212:215], a[244:247], a[4:7], v[212:215]
ds_read_b32 a36, v59
v_perm_b32 v58, v96, v19, s55
v_mfma_f32_16x16x32_bf16 v[216:219], a[244:247], a[8:11], v[216:219]
ds_read_b32 a37, v58
v_perm_b32 v57, v100, v19, s54
v_mfma_f32_16x16x32_bf16 v[220:223], a[244:247], a[12:15], v[220:223]
s_waitcnt lgkmcnt(4)
ds_read_b32 a38, v57
v_mfma_f32_16x16x32_bf16 v[144:147], a[248:251], a[16:19], v[144:147]
ds_read_b128 a[240:243], v14 offset:38912
v_perm_b32 v56, v100, v19, s55
v_mfma_f32_16x16x32_bf16 v[148:151], a[248:251], a[20:23], v[148:151]
ds_read_b32 a39, v56
v_perm_b32 v63, v97, v19, s52
v_mfma_f32_16x16x32_bf16 v[152:155], a[248:251], a[24:27], v[152:155]
ds_read_b32 a40, v63
v_perm_b32 v62, v97, v19, s53
v_mfma_f32_16x16x32_bf16 v[156:159], a[248:251], a[28:31], v[156:159]
s_waitcnt lgkmcnt(4)
ds_read_b32 a41, v62
buffer_load_dwordx4 v[40:43], v12, s[24:27], 0 offen offset:2048 sc1
v_mfma_f32_16x16x32_bf16 v[160:163], a[252:255], a[16:19], v[160:163]
ds_read_b128 a[244:247], v15 offset:28672
v_perm_b32 v61, v101, v19, s52
v_mfma_f32_16x16x32_bf16 v[164:167], a[252:255], a[20:23], v[164:167]
ds_read_b32 a42, v61
v_perm_b32 v60, v101, v19, s53
v_mfma_f32_16x16x32_bf16 v[168:171], a[252:255], a[24:27], v[168:171]
s_add_u32 m0, s33, 141952
ds_read_b32 a43, v60
v_perm_b32 v59, v97, v19, s54
v_mfma_f32_16x16x32_bf16 v[172:175], a[252:255], a[28:31], v[172:175]
s_waitcnt lgkmcnt(4)
ds_read_b32 a44, v59
v_perm_b32 v58, v97, v19, s55
v_mfma_f32_16x16x32_bf16 v[176:179], a[240:243], a[16:19], v[176:179]
ds_read_b128 a[248:251], v14 offset:40960
buffer_load_dwordx4 v8, s[20:23], 0 offen offset:1408 lds
v_mfma_f32_16x16x32_bf16 v[180:183], a[240:243], a[20:23], v[180:183]
ds_read_b32 a45, v58
v_perm_b32 v57, v101, v19, s54
v_mfma_f32_16x16x32_bf16 v[184:187], a[240:243], a[24:27], v[184:187]
ds_read_b32 a46, v57
buffer_load_dwordx4 v[44:47], v12, s[24:27], 0 offen offset:3072 sc1
v_mfma_f32_16x16x32_bf16 v[188:191], a[240:243], a[28:31], v[188:191]
s_waitcnt vmcnt(11) lgkmcnt(4)
v_cmp_ne_u64 s[50:51], s[88:89], v[82:83]
v_cmp_ne_u64 s[44:45], s[88:89], v[86:87]
v_mfma_f32_16x16x32_bf16 v[224:227], a[244:247], a[0:3], v[224:227]
ds_read_b128 a[252:255], v15 offset:32768
v_perm_b32 v56, v101, v19, s55
v_mfma_f32_16x16x32_bf16 v[228:231], a[244:247], a[4:7], v[228:231]
s_or_b64 s[50:51], s[44:45], s[50:51]
ds_read_b32 a47, v56
v_add_u32 v12, 45056, v13
v_mfma_f32_16x16x32_bf16 v[232:235], a[244:247], a[8:11], v[232:235]
s_cbranch_scc1 L_SLOW18
L_BACK18:
v_mfma_f32_16x16x32_bf16 v[236:239], a[244:247], a[12:15], v[236:239]
s_waitcnt lgkmcnt(2)
v_mfma_f32_16x16x32_bf16 v[192:195], a[248:251], a[16:19], v[192:195]
ds_read_b128 a[240:243], v14 offset:30720
v_perm_b32 v63, v80, v19, s52
v_mfma_f32_16x16x32_bf16 v[196:199], a[248:251], a[20:23], v[196:199]
L_PAD3:
s_cbranch_vccnz L_PADRET
ds_read_b32 a48, v63
v_perm_b32 v62, v80, v19, s53
v_mfma_f32_16x16x32_bf16 v[200:203], a[248:251], a[24:27], v[200:203]
s_add_u32 m0, s33, 146048
ds_read_b32 a49, v62
v_perm_b32 v61, v84, v19, s52
v_mfma_f32_16x16x32_bf16 v[204:207], a[248:251], a[28:31], v[204:207]
s_waitcnt lgkmcnt(3)
ds_read_b32 a50, v61
v_perm_b32 v60, v84, v19, s53
v_mfma_f32_16x16x32_bf16 v[128:131], a[252:255], a[32:35], v[128:131]
ds_read_b128 a[244:247], v15 offset:34816
buffer_load_dwordx4 v9, s[20:23], 0 offen offset:1408 lds
v_mfma_f32_16x16x32_bf16 v[132:135], a[252:255], a[36:39], v[132:135]
ds_read_b32 a51, v60
v_perm_b32 v59, v80, v19, s54
v_mfma_f32_16x16x32_bf16 v[136:139], a[252:255], a[40:43], v[136:139]
ds_read_b32 a52, v59
v_perm_b32 v58, v80, v19, s55
v_mfma_f32_16x16x32_bf16 v[140:143], a[252:255], a[44:47], v[140:143]
s_waitcnt lgkmcnt(4)
ds_read_b32 a53, v58
v_mfma_f32_16x16x32_bf16 v[240:243], a[240:243], a[224:227], v[240:243]
ds_read_b128 a[248:251], v15 offset:36864
v_perm_b32 v57, v84, v19, s54
v_mfma_f32_16x16x32_bf16 v[244:247], a[240:243], a[228:231], v[244:247]
ds_read_b32 a54, v57
v_perm_b32 v56, v84, v19, s55
v_mfma_f32_16x16x32_bf16 v[248:251], a[240:243], a[232:235], v[248:251]
ds_read_b32 a55, v56
v_perm_b32 v63, v81, v19, s52
v_mfma_f32_16x16x32_bf16 v[252:255], a[240:243], a[236:239], v[252:255]
s_waitcnt lgkmcnt(4)
ds_read_b32 a56, v63
buffer_load_dwordx4 v[48:51], v12, s[24:27], 0 offen offset:0 sc1
v_mfma_f32_16x16x32_bf16 v[144:147], a[244:247], a[32:35], v[144:147]
ds_read_b128 a[252:255], v14 offset:43008
v_perm_b32 v62, v81, v19, s53
v_mfma_f32_16x16x32_bf16 v[148:151], a[244:247], a[36:39], v[148:151]
ds_read_b32 a57, v62
v_perm_b32 v61, v85, v19, s52
v_mfma_f32_16x16x32_bf16 v[152:155], a[244:247], a[40:43], v[152:155]
ds_read_b32 a58, v61
v_perm_b32 v60, v85, v19, s53
v_mfma_f32_16x16x32_bf16 v[156:159], a[244:247], a[44:47], v[156:159]
s_waitcnt lgkmcnt(4)
ds_read_b32 a59, v60
buffer_load_dwordx4 v[52:55], v12, s[24:27], 0 offen offset:1024 sc1
v_mfma_f32_16x16x32_bf16 v[160:163], a[248:251], a[32:35], v[160:163]
ds_read_b128 a[240:243], v15 offset:38912
v_perm_b32 v59, v81, v19, s54
v_mfma_f32_16x16x32_bf16 v[164:167], a[248:251], a[36:39], v[164:167]
ds_read_b32 a60, v59
v_perm_b32 v58, v81, v19, s55
v_mfma_f32_16x16x32_bf16 v[168:171], a[248:251], a[40:43], v[168:171]
ds_read_b32 a61, v58
v_perm_b32 v57, v85, v19, s54
v_mfma_f32_16x16x32_bf16 v[172:175], a[248:251], a[44:47], v[172:175]
s_waitcnt lgkmcnt(4)
ds_read_b32 a62, v57
v_mfma_f32_16x16x32_bf16 v[208:211], a[252:255], a[16:19], v[208:211]
ds_read_b128 a[244:247], v14 offset:45056
v_perm_b32 v56, v85, v19, s55
v_mfma_f32_16x16x32_bf16 v[212:215], a[252:255], a[20:23], v[212:215]
ds_read_b32 a63, v56
v_mfma_f32_16x16x32_bf16 v[216:219], a[252:255], a[24:27], v[216:219]
s_waitcnt vmcnt(10)
v_cmp_ne_u64 s[50:51], s[88:89], v[90:91]
v_cmp_ne_u64 s[44:45], s[88:89], v[94:95]
v_mfma_f32_16x16x32_bf16 v[220:223], a[252:255], a[28:31], v[220:223]
s_waitcnt lgkmcnt(3)
v_mfma_f32_16x16x32_bf16 v[176:179], a[240:243], a[32:35], v[176:179]
s_or_b64 s[50:51], s[44:45], s[50:51]
ds_read_b128 a[248:251], v15 offset:40960
v_mfma_f32_16x16x32_bf16 v[180:183], a[240:243], a[36:39], v[180:183]
s_cbranch_scc1 L_SLOW19
L_BACK19:
v_mfma_f32_16x16x32_bf16 v[184:187], a[240:243], a[40:43], v[184:187]
s_add_u32 m0, s33, 150016
v_perm_b32 v63, v88, v19, s52
v_mfma_f32_16x16x32_bf16 v[188:191], a[240:243], a[44:47], v[188:191]
s_waitcnt lgkmcnt(1)
ds_read_b32 a64, v63
v_perm_b32 v62, v88, v19, s53
v_mfma_f32_16x16x32_bf16 v[128:131], a[244:247], a[48:51], v[128:131]
ds_read_b128 a[252:255], v14 offset:49152
buffer_load_dwordx4 v8, s[20:23], 0 offen offset:1536 lds
v_mfma_f32_16x16x32_bf16 v[132:135], a[244:247], a[52:55], v[132:135]
ds_read_b32 a65, v62
v_perm_b32 v61, v92, v19, s52
v_mfma_f32_16x16x32_bf16 v[136:139], a[244:247], a[56:59], v[136:139]
ds_read_b32 a66, v61
v_perm_b32 v60, v92, v19, s53
v_mfma_f32_16x16x32_bf16 v[140:143], a[244:247], a[60:63], v[140:143]
s_waitcnt lgkmcnt(4)
ds_read_b32 a67, v60
v_mfma_f32_16x16x32_bf16 v[192:195], a[248:251], a[32:35], v[192:195]
s_barrier
ds_read_b128 a[240:243], v14 offset:47104
v_perm_b32 v59, v88, v19, s54
v_mfma_f32_16x16x32_bf16 v[196:199], a[248:251], a[36:39], v[196:199]
ds_read_b32 a68, v59
v_perm_b32 v58, v88, v19, s55
v_mfma_f32_16x16x32_bf16 v[200:203], a[248:251], a[40:43], v[200:203]
ds_read_b32 a69, v58
v_perm_b32 v57, v92, v19, s54
v_mfma_f32_16x16x32_bf16 v[204:207], a[248:251], a[44:47], v[204:207]
s_waitcnt lgkmcnt(4)
ds_read_b32 a70, v57
buffer_load_dwordx4 v[96:99], v12, s[24:27], 0 offen offset:2048 sc1
v_mfma_f32_16x16x32_bf16 v[224:227], a[252:255], a[16:19], v[224:227]
ds_read_b128 a[244:247], v14 offset:53248
v_perm_b32 v56, v92, v19, s55
v_mfma_f32_16x16x32_bf16 v[228:231], a[252:255], a[20:23], v[228:231]
ds_read_b32 a71, v56
v_perm_b32 v63, v89, v19, s52
v_mfma_f32_16x16x32_bf16 v[232:235], a[252:255], a[24:27], v[232:235]
ds_read_b32 a72, v63
v_perm_b32 v62, v89, v19, s53
v_mfma_f32_16x16x32_bf16 v[236:239], a[252:255], a[28:31], v[236:239]
s_waitcnt lgkmcnt(4)
ds_read_b32 a73, v62
buffer_load_dwordx4 v[100:103], v12, s[24:27], 0 offen offset:3072 sc1
v_mfma_f32_16x16x32_bf16 v[144:147], a[240:243], a[48:51], v[144:147]
ds_read_b128 a[248:251], v15 offset:43008
v_perm_b32 v61, v93, v19, s52
v_mfma_f32_16x16x32_bf16 v[148:151], a[240:243], a[52:55], v[148:151]
ds_read_b32 a74, v61
v_perm_b32 v60, v93, v19, s53
v_mfma_f32_16x16x32_bf16 v[152:155], a[240:243], a[56:59], v[152:155]
s_add_u32 m0, s33, 154240
ds_read_b32 a75, v60
v_perm_b32 v59, v89, v19, s54
v_mfma_f32_16x16x32_bf16 v[156:159], a[240:243], a[60:63], v[156:159]
s_waitcnt lgkmcnt(4)
ds_read_b32 a76, v59
v_perm_b32 v58, v89, v19, s55
v_mfma_f32_16x16x32_bf16 v[160:163], a[244:247], a[48:51], v[160:163]
ds_read_b128 a[252:255], v14 offset:55296
buffer_load_dwordx4 v10, s[20:23], 0 offen offset:1408 lds
v_mfma_f32_16x16x32_bf16 v[164:167], a[244:247], a[52:55], v[164:167]
ds_read_b32 a77, v58
v_perm_b32 v57, v93, v19, s54
v_mfma_f32_16x16x32_bf16 v[168:171], a[244:247], a[56:59], v[168:171]
s_waitcnt vmcnt(11)
v_cmp_ne_u64 s[50:51], s[88:89], v[34:35]
v_cmp_ne_u64 s[44:45], s[88:89], v[38:39]
v_mfma_f32_16x16x32_bf16 v[172:175], a[244:247], a[60:63], v[172:175]
s_waitcnt lgkmcnt(3)
ds_read_b32 a78, v57
v_add_u32 v12, 49152, v13
v_mfma_f32_16x16x32_bf16 v[208:211], a[248:251], a[32:35], v[208:211]
s_or_b64 s[50:51], s[44:45], s[50:51]
ds_read_b128 a[240:243], v15 offset:45056
v_perm_b32 v56, v93, v19, s55
v_mfma_f32_16x16x32_bf16 v[212:215], a[248:251], a[36:39], v[212:215]
s_cbranch_scc1 L_SLOW20
L_BACK20:
v_mfma_f32_16x16x32_bf16 v[216:219], a[248:251], a[40:43], v[216:219]
ds_read_b32 a79, v56
v_perm_b32 v63, v32, v19, s52
v_mfma_f32_16x16x32_bf16 v[220:223], a[248:251], a[44:47], v[220:223]
s_waitcnt lgkmcnt(3)
ds_read_b32 a80, v63
v_mfma_f32_16x16x32_bf16 v[176:179], a[252:255], a[48:51], v[176:179]
ds_read_b128 a[244:247], v15 offset:47104
v_perm_b32 v62, v32, v19, s53
v_mfma_f32_16x16x32_bf16 v[180:183], a[252:255], a[52:55], v[180:183]
ds_read_b32 a81, v62
v_perm_b32 v61, v36, v19, s52
v_mfma_f32_16x16x32_bf16 v[184:187], a[252:255], a[56:59], v[184:187]
s_add_u32 m0, s33, 158464
ds_read_b32 a82, v61
v_perm_b32 v60, v36, v19, s53
v_mfma_f32_16x16x32_bf16 v[188:191], a[252:255], a[60:63], v[188:191]
s_waitcnt lgkmcnt(4)
ds_read_b32 a83, v60
v_perm_b32 v59, v32, v19, s54
v_mfma_f32_16x16x32_bf16 v[128:131], a[240:243], a[64:67], v[128:131]
ds_read_b128 a[248:251], v14 offset:57344
buffer_load_dwordx4 v11, s[20:23], 0 offen offset:1280 lds
v_mfma_f32_16x16x32_bf16 v[132:135], a[240:243], a[68:71], v[132:135]
ds_read_b32 a84, v59
v_perm_b32 v58, v32, v19, s55
v_mfma_f32_16x16x32_bf16 v[136:139], a[240:243], a[72:75], v[136:139]
ds_read_b32 a85, v58
v_perm_b32 v57, v36, v19, s54
v_mfma_f32_16x16x32_bf16 v[140:143], a[240:243], a[76:79], v[140:143]
s_waitcnt lgkmcnt(4)
ds_read_b32 a86, v57
buffer_load_dwordx4 v[80:83], v12, s[24:27], 0 offen offset:0 sc1
v_mfma_f32_16x16x32_bf16 v[144:147], a[244:247], a[64:67], v[144:147]
ds_read_b128 a[252:255], v15 offset:53248
v_perm_b32 v56, v36, v19, s55
v_mfma_f32_16x16x32_bf16 v[148:151], a[244:247], a[68:71], v[148:151]
ds_read_b32 a87, v56
v_perm_b32 v63, v33, v19, s52
v_mfma_f32_16x16x32_bf16 v[152:155], a[244:247], a[72:75], v[152:155]
ds_read_b32 a88, v63
v_perm_b32 v62, v33, v19, s53
v_mfma_f32_16x16x32_bf16 v[156:159], a[244:247], a[76:79], v[156:159]
s_waitcnt lgkmcnt(4)
ds_read_b32 a89, v62
buffer_load_dwordx4 v[84:87], v12, s[24:27], 0 offen offset:1024 sc1
v_mfma_f32_16x16x32_bf16 v[192:195], a[248:251], a[48:51], v[192:195]
ds_read_b128 a[240:243], v15 offset:30720
v_perm_b32 v61, v37, v19, s52
v_mfma_f32_16x16x32_bf16 v[196:199], a[248:251], a[52:55], v[196:199]
ds_read_b32 a90, v61
v_perm_b32 v60, v37, v19, s53
v_mfma_f32_16x16x32_bf16 v[200:203], a[248:251], a[56:59], v[200:203]
s_add_u32 m0, s33, 64000
ds_read_b32 a91, v60
v_perm_b32 v59, v33, v19, s54
v_mfma_f32_16x16x32_bf16 v[204:207], a[248:251], a[60:63], v[204:207]
s_waitcnt lgkmcnt(4)
ds_read_b32 a92, v59
v_perm_b32 v58, v33, v19, s55
v_mfma_f32_16x16x32_bf16 v[160:163], a[252:255], a[64:67], v[160:163]
ds_read_b128 a[244:247], v15 offset:49152
buffer_load_dwordx4 v9, s[20:23], 0 offen offset:1536 lds
v_mfma_f32_16x16x32_bf16 v[164:167], a[252:255], a[68:71], v[164:167]
ds_read_b32 a93, v58
v_perm_b32 v57, v37, v19, s54
v_mfma_f32_16x16x32_bf16 v[168:171], a[252:255], a[72:75], v[168:171]
s_waitcnt vmcnt(11)
v_cmp_ne_u64 s[50:51], s[88:89], v[42:43]
v_cmp_ne_u64 s[44:45], s[88:89], v[46:47]
v_mfma_f32_16x16x32_bf16 v[172:175], a[252:255], a[76:79], v[172:175]
s_waitcnt lgkmcnt(3)
ds_read_b32 a94, v57
v_mfma_f32_16x16x32_bf16 v[240:243], a[240:243], a[0:3], v[240:243]
s_or_b64 s[50:51], s[44:45], s[50:51]
ds_read_b128 a[248:251], v14 offset:61440
v_perm_b32 v56, v37, v19, s55
v_mfma_f32_16x16x32_bf16 v[244:247], a[240:243], a[4:7], v[244:247]
s_cbranch_scc1 L_SLOW21
L_BACK21:
v_mfma_f32_16x16x32_bf16 v[248:251], a[240:243], a[8:11], v[248:251]
ds_read_b32 a95, v56
v_perm_b32 v63, v40, v19, s52
v_mfma_f32_16x16x32_bf16 v[252:255], a[240:243], a[12:15], v[252:255]
s_waitcnt lgkmcnt(3)
ds_read_b32 a96, v63
v_mfma_f32_16x16x32_bf16 v[224:227], a[244:247], a[32:35], v[224:227]
ds_read_b128 a[252:255], v15 offset:55296
v_perm_b32 v62, v40, v19, s53
v_mfma_f32_16x16x32_bf16 v[228:231], a[244:247], a[36:39], v[228:231]
ds_read_b32 a97, v62
v_perm_b32 v61, v44, v19, s52
v_mfma_f32_16x16x32_bf16 v[232:235], a[244:247], a[40:43], v[232:235]
ds_read_b32 a98, v61
v_perm_b32 v60, v44, v19, s53
v_mfma_f32_16x16x32_bf16 v[236:239], a[244:247], a[44:47], v[236:239]
s_waitcnt lgkmcnt(4)
ds_read_b32 a99, v60
v_mfma_f32_16x16x32_bf16 v[128:131], a[248:251], a[80:83], v[128:131]
ds_read_b128 a[240:243], v14 offset:59392
v_perm_b32 v59, v40, v19, s54
v_mfma_f32_16x16x32_bf16 v[132:135], a[248:251], a[84:87], v[132:135]
ds_read_b32 a100, v59
v_perm_b32 v58, v40, v19, s55
v_mfma_f32_16x16x32_bf16 v[136:139], a[248:251], a[88:91], v[136:139]
s_add_u32 m0, s33, 67968
ds_read_b32 a101, v58
v_perm_b32 v57, v44, v19, s54
v_mfma_f32_16x16x32_bf16 v[140:143], a[248:251], a[92:95], v[140:143]
s_waitcnt lgkmcnt(4)
ds_read_b32 a102, v57
v_perm_b32 v56, v44, v19, s55
v_mfma_f32_16x16x32_bf16 v[176:179], a[252:255], a[64:67], v[176:179]
ds_read_b128 a[244:247], v14 offset:63488
buffer_load_dwordx4 v8, s[20:23], 0 offen offset:1664 lds
v_mfma_f32_16x16x32_bf16 v[180:183], a[252:255], a[68:71], v[180:183]
ds_read_b32 a103, v56
v_perm_b32 v63, v41, v19, s52
v_mfma_f32_16x16x32_bf16 v[184:187], a[252:255], a[72:75], v[184:187]
ds_read_b32 a104, v63
v_perm_b32 v62, v41, v19, s53
v_mfma_f32_16x16x32_bf16 v[188:191], a[252:255], a[76:79], v[188:191]
s_waitcnt lgkmcnt(4)
ds_read_b32 a105, v62
buffer_load_dwordx4 v[88:91], v12, s[24:27], 0 offen offset:2048 sc1
v_mfma_f32_16x16x32_bf16 v[208:211], a[240:243], a[48:51], v[208:211]
ds_read_b128 a[248:251], v15 offset:57344
v_perm_b32 v61, v45, v19, s52
v_mfma_f32_16x16x32_bf16 v[212:215], a[240:243], a[52:55], v[212:215]
ds_read_b32 a106, v61
v_perm_b32 v60, v45, v19, s53
v_mfma_f32_16x16x32_bf16 v[216:219], a[240:243], a[56:59], v[216:219]
s_add_u32 m0, s33, 72192
ds_read_b32 a107, v60
v_perm_b32 v59, v41, v19, s54
v_mfma_f32_16x16x32_bf16 v[220:223], a[240:243], a[60:63], v[220:223]
s_waitcnt lgkmcnt(4)
ds_read_b32 a108, v59
v_perm_b32 v58, v41, v19, s55
v_mfma_f32_16x16x32_bf16 v[144:147], a[244:247], a[80:83], v[144:147]
ds_read_b128 a[252:255], v16 offset:0
buffer_load_dwordx4 v10, s[20:23], 0 offen offset:1536 lds
v_mfma_f32_16x16x32_bf16 v[148:151], a[244:247], a[84:87], v[148:151]
ds_read_b32 a109, v58
v_perm_b32 v57, v45, v19, s54
v_mfma_f32_16x16x32_bf16 v[152:155], a[244:247], a[88:91], v[152:155]
ds_read_b32 a110, v57
buffer_load_dwordx4 v[92:95], v12, s[24:27], 0 offen offset:3072 sc1
v_mfma_f32_16x16x32_bf16 v[156:159], a[244:247], a[92:95], v[156:159]
s_waitcnt vmcnt(12) lgkmcnt(4)
v_cmp_ne_u64 s[50:51], s[88:89], v[50:51]
v_cmp_ne_u64 s[44:45], s[88:89], v[54:55]
v_mfma_f32_16x16x32_bf16 v[192:195], a[248:251], a[64:67], v[192:195]
s_barrier
ds_read_b128 a[240:243], v15 offset:61440
v_perm_b32 v56, v45, v19, s55
v_mfma_f32_16x16x32_bf16 v[196:199], a[248:251], a[68:71], v[196:199]
s_or_b64 s[50:51], s[44:45], s[50:51]
ds_read_b32 a111, v56
v_add_u32 v12, 53248, v13
v_mfma_f32_16x16x32_bf16 v[200:203], a[248:251], a[72:75], v[200:203]
s_cbranch_scc1 L_SLOW22
L_BACK22:
v_mfma_f32_16x16x32_bf16 v[204:207], a[248:251], a[76:79], v[204:207]
s_waitcnt lgkmcnt(2)
v_mfma_f32_16x16x32_bf16 v[160:163], a[252:255], a[80:83], v[160:163]
ds_read_b128 a[244:247], v16 offset:2048
v_mfma_f32_16x16x32_bf16 v[164:167], a[252:255], a[84:87], v[164:167]
v_perm_b32 v63, v48, v19, s52
v_mfma_f32_16x16x32_bf16 v[168:171], a[252:255], a[88:91], v[168:171]
ds_read_b32 a112, v63
v_perm_b32 v62, v48, v19, s53
v_mfma_f32_16x16x32_bf16 v[172:175], a[252:255], a[92:95], v[172:175]
s_waitcnt lgkmcnt(2)
ds_read_b32 a113, v62
v_mfma_f32_16x16x32_bf16 v[128:131], a[240:243], a[96:99], v[128:131]
ds_read_b128 a[248:251], v16 offset:4096
v_perm_b32 v61, v52, v19, s52
v_mfma_f32_16x16x32_bf16 v[132:135], a[240:243], a[100:103], v[132:135]
ds_read_b32 a114, v61
v_perm_b32 v60, v52, v19, s53
v_mfma_f32_16x16x32_bf16 v[136:139], a[240:243], a[104:107], v[136:139]
s_add_u32 m0, s33, 76160
ds_read_b32 a115, v60
v_perm_b32 v59, v48, v19, s54
v_mfma_f32_16x16x32_bf16 v[140:143], a[240:243], a[108:111], v[140:143]
s_waitcnt lgkmcnt(4)
ds_read_b32 a116, v59
v_perm_b32 v58, v48, v19, s55
v_mfma_f32_16x16x32_bf16 v[176:179], a[244:247], a[80:83], v[176:179]
ds_read_b128 a[252:255], v15 offset:63488
buffer_load_dwordx4 v9, s[20:23], 0 offen offset:1664 lds
v_mfma_f32_16x16x32_bf16 v[180:183], a[244:247], a[84:87], v[180:183]
ds_read_b32 a117, v58
v_perm_b32 v57, v52, v19, s54
v_mfma_f32_16x16x32_bf16 v[184:187], a[244:247], a[88:91], v[184:187]
ds_read_b32 a118, v57
v_perm_b32 v56, v52, v19, s55
v_mfma_f32_16x16x32_bf16 v[188:191], a[244:247], a[92:95], v[188:191]
s_waitcnt lgkmcnt(4)
ds_read_b32 a119, v56
buffer_load_dwordx4 v[32:35], v12, s[24:27], 0 offen offset:0 sc1
v_mfma_f32_16x16x32_bf16 v[224:227], a[248:251], a[48:51], v[224:227]
ds_read_b128 a[240:243], v15 offset:59392
v_perm_b32 v63, v49, v19, s52
v_mfma_f32_16x16x32_bf16 v[228:231], a[248:251], a[52:55], v[228:231]
ds_read_b32 a120, v63
v_perm_b32 v62, v49, v19, s53
v_mfma_f32_16x16x32_bf16 v[232:235], a[248:251], a[56:59], v[232:235]
ds_read_b32 a121, v62
v_perm_b32 v61, v53, v19, s52
v_mfma_f32_16x16x32_bf16 v[236:239], a[248:251], a[60:63], v[236:239]
s_waitcnt lgkmcnt(4)
ds_read_b32 a122, v61
buffer_load_dwordx4 v[36:39], v12, s[24:27], 0 offen offset:1024 sc1
v_mfma_f32_16x16x32_bf16 v[144:147], a[252:255], a[96:99], v[144:147]
ds_read_b128 a[244:247], v17 offset:0
v_perm_b32 v60, v53, v19, s53
v_mfma_f32_16x16x32_bf16 v[148:151], a[252:255], a[100:103], v[148:151]
ds_read_b32 a123, v60
v_perm_b32 v59, v49, v19, s54
v_mfma_f32_16x16x32_bf16 v[152:155], a[252:255], a[104:107], v[152:155]
s_add_u32 m0, s33, 80512
ds_read_b32 a124, v59
v_perm_b32 v58, v49, v19, s55
v_mfma_f32_16x16x32_bf16 v[156:159], a[252:255], a[108:111], v[156:159]
s_waitcnt vmcnt(12) lgkmcnt(4)
v_cmp_ne_u64 s[50:51], s[88:89], v[98:99]
v_cmp_ne_u64 s[44:45], s[88:89], v[102:103]
v_mfma_f32_16x16x32_bf16 v[208:211], a[240:243], a[64:67], v[208:211]
ds_read_b128 a[248:251], v16 offset:8192
buffer_load_dwordx4 v11, s[20:23], 0 offen offset:1408 lds
v_mfma_f32_16x16x32_bf16 v[212:215], a[240:243], a[68:71], v[212:215]
s_or_b64 s[50:51], s[44:45], s[50:51]
ds_read_b32 a125, v58
v_perm_b32 v57, v53, v19, s54
v_mfma_f32_16x16x32_bf16 v[216:219], a[240:243], a[72:75], v[216:219]
s_cbranch_scc1 L_SLOW23
L_BACK23:
v_mfma_f32_16x16x32_bf16 v[220:223], a[240:243], a[76:79], v[220:223]
s_waitcnt lgkmcnt(2)
ds_read_b32 a126, v57
v_mfma_f32_16x16x32_bf16 v[160:163], a[244:247], a[96:99], v[160:163]
ds_read_b128 a[252:255], v16 offset:12288
v_perm_b32 v56, v53, v19, s55
v_mfma_f32_16x16x32_bf16 v[164:167], a[244:247], a[100:103], v[164:167]
ds_read_b32 a127, v56
v_perm_b32 v63, v96, v19, s52
v_mfma_f32_16x16x32_bf16 v[168:171], a[244:247], a[104:107], v[168:171]
ds_read_b32 a128, v63
v_perm_b32 v62, v96, v19, s53
v_mfma_f32_16x16x32_bf16 v[172:175], a[244:247], a[108:111], v[172:175]
s_waitcnt lgkmcnt(4)
ds_read_b32 a129, v62
v_mfma_f32_16x16x32_bf16 v[192:195], a[248:251], a[80:83], v[192:195]
ds_read_b128 a[240:243], v14 offset:51200
v_perm_b32 v61, v100, v19, s52
v_mfma_f32_16x16x32_bf16 v[196:199], a[248:251], a[84:87], v[196:199]
ds_read_b32 a130, v61
v_perm_b32 v60, v100, v19, s53
v_mfma_f32_16x16x32_bf16 v[200:203], a[248:251], a[88:91], v[200:203]
s_add_u32 m0, s33, 84224
ds_read_b32 a131, v60
v_perm_b32 v59, v96, v19, s54
v_mfma_f32_16x16x32_bf16 v[204:207], a[248:251], a[92:95], v[204:207]
s_waitcnt lgkmcnt(4)
ds_read_b32 a132, v59
v_perm_b32 v58, v96, v19, s55
v_mfma_f32_16x16x32_bf16 v[128:131], a[252:255], a[112:115], v[128:131]
ds_read_b128 a[244:247], v16 offset:14336
buffer_load_dwordx4 v8, s[20:23], 0 offen offset:1792 lds
v_mfma_f32_16x16x32_bf16 v[132:135], a[252:255], a[116:119], v[132:135]
ds_read_b32 a133, v58
v_perm_b32 v57, v100, v19, s54
v_mfma_f32_16x16x32_bf16 v[136:139], a[252:255], a[120:123], v[136:139]
ds_read_b32 a134, v57
v_perm_b32 v56, v100, v19, s55
v_mfma_f32_16x16x32_bf16 v[140:143], a[252:255], a[124:127], v[140:143]
s_waitcnt lgkmcnt(4)
ds_read_b32 a135, v56
buffer_load_dwordx4 v[40:43], v12, s[24:27], 0 offen offset:2048 sc1
v_mfma_f32_16x16x32_bf16 v[240:243], a[240:243], a[16:19], v[240:243]
ds_read_b128 a[248:251], v17 offset:2048
v_perm_b32 v63, v97, v19, s52
v_mfma_f32_16x16x32_bf16 v[244:247], a[240:243], a[20:23], v[244:247]
ds_read_b32 a136, v63
v_perm_b32 v62, v97, v19, s53
v_mfma_f32_16x16x32_bf16 v[248:251], a[240:243], a[24:27], v[248:251]
ds_read_b32 a137, v62
v_perm_b32 v61, v101, v19, s52
v_mfma_f32_16x16x32_bf16 v[252:255], a[240:243], a[28:31], v[252:255]
s_waitcnt lgkmcnt(4)
ds_read_b32 a138, v61
buffer_load_dwordx4 v[44:47], v12, s[24:27], 0 offen offset:3072 sc1
v_mfma_f32_16x16x32_bf16 v[144:147], a[244:247], a[112:115], v[144:147]
ds_read_b128 a[252:255], v17 offset:4096
v_perm_b32 v60, v101, v19, s53
v_mfma_f32_16x16x32_bf16 v[148:151], a[244:247], a[116:119], v[148:151]
ds_read_b32 a139, v60
v_perm_b32 v59, v97, v19, s54
v_mfma_f32_16x16x32_bf16 v[152:155], a[244:247], a[120:123], v[152:155]
s_waitcnt vmcnt(12)
v_cmp_ne_u64 s[50:51], s[88:89], v[82:83]
v_cmp_ne_u64 s[44:45], s[88:89], v[86:87]
v_mfma_f32_16x16x32_bf16 v[156:159], a[244:247], a[124:127], v[156:159]
s_waitcnt lgkmcnt(3)
ds_read_b32 a140, v59
v_add_u32 v12, 57344, v13
v_mfma_f32_16x16x32_bf16 v[176:179], a[248:251], a[96:99], v[176:179]
s_or_b64 s[50:51], s[44:45], s[50:51]
ds_read_b128 a[240:243], v16 offset:16384
v_perm_b32 v58, v97, v19, s55
v_mfma_f32_16x16x32_bf16 v[180:183], a[248:251], a[100:103], v[180:183]
s_cbranch_scc1 L_SLOW24
L_BACK24:
v_mfma_f32_16x16x32_bf16 v[184:187], a[248:251], a[104:107], v[184:187]
s_add_u32 m0, s33, 88448
ds_read_b32 a141, v58
v_perm_b32 v57, v101, v19, s54
v_mfma_f32_16x16x32_bf16 v[188:191], a[248:251], a[108:111], v[188:191]
s_waitcnt lgkmcnt(3)
ds_read_b32 a142, v57
v_perm_b32 v56, v101, v19, s55
v_mfma_f32_16x16x32_bf16 v[224:227], a[252:255], a[64:67], v[224:227]
ds_read_b128 a[244:247], v16 offset:10240
buffer_load_dwordx4 v10, s[20:23], 0 offen offset:1664 lds
v_mfma_f32_16x16x32_bf16 v[228:231], a[252:255], a[68:71], v[228:231]
ds_read_b32 a143, v56
v_perm_b32 v63, v80, v19, s52
v_mfma_f32_16x16x32_bf16 v[232:235], a[252:255], a[72:75], v[232:235]
ds_read_b32 a144, v63
v_perm_b32 v62, v80, v19, s53
v_mfma_f32_16x16x32_bf16 v[236:239], a[252:255], a[76:79], v[236:239]
s_waitcnt lgkmcnt(4)
ds_read_b32 a145, v62
v_mfma_f32_16x16x32_bf16 v[160:163], a[240:243], a[112:115], v[160:163]
ds_read_b128 a[248:251], v17 offset:12288
v_perm_b32 v61, v84, v19, s52
v_mfma_f32_16x16x32_bf16 v[164:167], a[240:243], a[116:119], v[164:167]
ds_read_b32 a146, v61
v_perm_b32 v60, v84, v19, s53
v_mfma_f32_16x16x32_bf16 v[168:171], a[240:243], a[120:123], v[168:171]
s_add_u32 m0, s33, 92416
ds_read_b32 a147, v60
v_perm_b32 v59, v80, v19, s54
v_mfma_f32_16x16x32_bf16 v[172:175], a[240:243], a[124:127], v[172:175]
s_waitcnt lgkmcnt(4)
ds_read_b32 a148, v59
v_perm_b32 v58, v80, v19, s55
v_mfma_f32_16x16x32_bf16 v[208:211], a[244:247], a[80:83], v[208:211]
ds_read_b128 a[252:255], v17 offset:8192
buffer_load_dwordx4 v9, s[20:23], 0 offen offset:1792 lds
v_mfma_f32_16x16x32_bf16 v[212:215], a[244:247], a[84:87], v[212:215]
ds_read_b32 a149, v58
v_perm_b32 v57, v84, v19, s54
v_mfma_f32_16x16x32_bf16 v[216:219], a[244:247], a[88:91], v[216:219]
ds_read_b32 a150, v57
v_perm_b32 v56, v84, v19, s55
v_mfma_f32_16x16x32_bf16 v[220:223], a[244:247], a[92:95], v[220:223]
s_waitcnt lgkmcnt(4)
ds_read_b32 a151, v56
v_mfma_f32_16x16x32_bf16 v[128:131], a[248:251], a[128:131], v[128:131]
s_waitcnt vmcnt(13)
s_barrier
ds_read_b128 a[240:243], v17 offset:14336
v_perm_b32 v63, v81, v19, s52
v_mfma_f32_16x16x32_bf16 v[132:135], a[248:251], a[132:135], v[132:135]
ds_read_b32 a152, v63
v_perm_b32 v62, v81, v19, s53
v_mfma_f32_16x16x32_bf16 v[136:139], a[248:251], a[136:139], v[136:139]
ds_read_b32 a153, v62
v_perm_b32 v61, v85, v19, s52
v_mfma_f32_16x16x32_bf16 v[140:143], a[248:251], a[140:143], v[140:143]
s_waitcnt lgkmcnt(4)
ds_read_b32 a154, v61
buffer_load_dwordx4 v[48:51], v12, s[24:27], 0 offen offset:0 sc1
v_mfma_f32_16x16x32_bf16 v[192:195], a[252:255], a[96:99], v[192:195]
ds_read_b128 a[244:247], v16 offset:18432
v_perm_b32 v60, v85, v19, s53
v_mfma_f32_16x16x32_bf16 v[196:199], a[252:255], a[100:103], v[196:199]
ds_read_b32 a155, v60
v_perm_b32 v59, v81, v19, s54
v_mfma_f32_16x16x32_bf16 v[200:203], a[252:255], a[104:107], v[200:203]
ds_read_b32 a156, v59
v_perm_b32 v58, v81, v19, s55
v_mfma_f32_16x16x32_bf16 v[204:207], a[252:255], a[108:111], v[204:207]
s_waitcnt lgkmcnt(4)
ds_read_b32 a157, v58
buffer_load_dwordx4 v[52:55], v12, s[24:27], 0 offen offset:1024 sc1
v_mfma_f32_16x16x32_bf16 v[144:147], a[240:243], a[128:131], v[144:147]
L_PAD4:
s_cbranch_vccnz L_PAD5
ds_read_b128 a[248:251], v16 offset:20480
v_perm_b32 v57, v85, v19, s54
v_mfma_f32_16x16x32_bf16 v[148:151], a[240:243], a[132:135], v[148:151]
ds_read_b32 a158, v57
v_perm_b32 v56, v85, v19, s55
v_mfma_f32_16x16x32_bf16 v[152:155], a[240:243], a[136:139], v[152:155]
s_add_u32 m0, s33, 96384
ds_read_b32 a159, v56
v_mfma_f32_16x16x32_bf16 v[156:159], a[240:243], a[140:143], v[156:159]
s_waitcnt vmcnt(11) lgkmcnt(4)
v_cmp_ne_u64 s[50:51], s[88:89], v[90:91]
v_cmp_ne_u64 s[44:45], s[88:89], v[94:95]
v_mfma_f32_16x16x32_bf16 v[176:179], a[244:247], a[112:115], v[176:179]
ds_read_b128 a[252:255], v17 offset:16384
buffer_load_dwordx4 v8, s[20:23], 0 offen offset:1920 lds
v_mfma_f32_16x16x32_bf16 v[180:183], a[244:247], a[116:119], v[180:183]
s_or_b64 s[50:51], s[44:45], s[50:51]
v_mfma_f32_16x16x32_bf16 v[184:187], a[244:247], a[120:123], v[184:187]
s_cbranch_scc1 L_SLOW25
L_BACK25:
v_mfma_f32_16x16x32_bf16 v[188:191], a[244:247], a[124:127], v[188:191]
s_waitcnt lgkmcnt(1)
v_mfma_f32_16x16x32_bf16 v[128:131], a[248:251], a[144:147], v[128:131]
ds_read_b128 a[240:243], v17 offset:10240
v_perm_b32 v63, v88, v19, s52
v_mfma_f32_16x16x32_bf16 v[132:135], a[248:251], a[148:151], v[132:135]
ds_read_b32 a160, v63
v_perm_b32 v62, v88, v19, s53
v_mfma_f32_16x16x32_bf16 v[136:139], a[248:251], a[152:155], v[136:139]
ds_read_b32 a161, v62
v_perm_b32 v61, v92, v19, s52
v_mfma_f32_16x16x32_bf16 v[140:143], a[248:251], a[156:159], v[140:143]
s_waitcnt lgkmcnt(3)
ds_read_b32 a162, v61
v_mfma_f32_16x16x32_bf16 v[160:163], a[252:255], a[128:131], v[160:163]
ds_read_b128 a[244:247], v16 offset:24576
v_perm_b32 v60, v92, v19, s53
v_mfma_f32_16x16x32_bf16 v[164:167], a[252:255], a[132:135], v[164:167]
ds_read_b32 a163, v60
v_perm_b32 v59, v88, v19, s54
v_mfma_f32_16x16x32_bf16 v[168:171], a[252:255], a[136:139], v[168:171]
s_add_u32 m0, s33, 100864
ds_read_b32 a164, v59
v_perm_b32 v58, v88, v19, s55
v_mfma_f32_16x16x32_bf16 v[172:175], a[252:255], a[140:143], v[172:175]
s_waitcnt lgkmcnt(4)
ds_read_b32 a165, v58
v_perm_b32 v57, v92, v19, s54
v_mfma_f32_16x16x32_bf16 v[208:211], a[240:243], a[96:99], v[208:211]
ds_read_b128 a[248:251], v16 offset:28672
buffer_load_dwordx4 v11, s[20:23], 0 offen offset:1536 lds
v_mfma_f32_16x16x32_bf16 v[212:215], a[240:243], a[100:103], v[212:215]
ds_read_b32 a166, v57
v_perm_b32 v56, v92, v19, s55
v_mfma_f32_16x16x32_bf16 v[216:219], a[240:243], a[104:107], v[216:219]
ds_read_b32 a167, v56
v_perm_b32 v63, v89, v19, s52
v_mfma_f32_16x16x32_bf16 v[220:223], a[240:243], a[108:111], v[220:223]
s_waitcnt lgkmcnt(4)
ds_read_b32 a168, v63
buffer_load_dwordx4 v[96:99], v12, s[24:27], 0 offen offset:2048 sc1
v_mfma_f32_16x16x32_bf16 v[192:195], a[244:247], a[112:115], v[192:195]
ds_read_b128 a[252:255], v16 offset:22528
v_perm_b32 v62, v89, v19, s53
v_mfma_f32_16x16x32_bf16 v[196:199], a[244:247], a[116:119], v[196:199]
ds_read_b32 a169, v62
v_perm_b32 v61, v93, v19, s52
v_mfma_f32_16x16x32_bf16 v[200:203], a[244:247], a[120:123], v[200:203]
ds_read_b32 a170, v61
v_perm_b32 v60, v93, v19, s53
v_mfma_f32_16x16x32_bf16 v[204:207], a[244:247], a[124:127], v[204:207]
s_waitcnt lgkmcnt(4)
ds_read_b32 a171, v60
buffer_load_dwordx4 v[100:103], v12, s[24:27], 0 offen offset:3072 sc1
v_mfma_f32_16x16x32_bf16 v[224:227], a[248:251], a[80:83], v[224:227]
ds_read_b128 a[240:243], v17 offset:18432
v_perm_b32 v59, v89, v19, s54
v_mfma_f32_16x16x32_bf16 v[228:231], a[248:251], a[84:87], v[228:231]
ds_read_b32 a172, v59
v_perm_b32 v58, v89, v19, s55
v_mfma_f32_16x16x32_bf16 v[232:235], a[248:251], a[88:91], v[232:235]
s_add_u32 m0, s33, 104576
ds_read_b32 a173, v58
v_perm_b32 v57, v93, v19, s54
v_mfma_f32_16x16x32_bf16 v[236:239], a[248:251], a[92:95], v[236:239]
s_waitcnt vmcnt(12) lgkmcnt(4)
v_cmp_ne_u64 s[50:51], s[88:89], v[34:35]
v_cmp_ne_u64 s[44:45], s[88:89], v[38:39]
v_mfma_f32_16x16x32_bf16 v[144:147], a[252:255], a[144:147], v[144:147]
ds_read_b128 a[244:247], v15 offset:51200
buffer_load_dwordx4 v9, s[20:23], 0 offen offset:1920 lds
v_mfma_f32_16x16x32_bf16 v[148:151], a[252:255], a[148:151], v[148:151]
s_or_b64 s[50:51], s[44:45], s[50:51]
ds_read_b32 a174, v57
v_perm_b32 v56, v93, v19, s55
v_mfma_f32_16x16x32_bf16 v[152:155], a[252:255], a[152:155], v[152:155]
s_cbranch_scc1 L_SLOW26
L_BACK26:
v_mfma_f32_16x16x32_bf16 v[156:159], a[252:255], a[156:159], v[156:159]
s_waitcnt lgkmcnt(2)
ds_read_b32 a175, v56
v_add_u32 v12, 61440, v13
v_mfma_f32_16x16x32_bf16 v[176:179], a[240:243], a[128:131], v[176:179]
ds_read_b128 a[248:251], v17 offset:20480
v_perm_b32 v63, v32, v19, s52
v_mfma_f32_16x16x32_bf16 v[180:183], a[240:243], a[132:135], v[180:183]
ds_read_b32 a176, v63
v_perm_b32 v62, v32, v19, s53
v_mfma_f32_16x16x32_bf16 v[184:187], a[240:243], a[136:139], v[184:187]
ds_read_b32 a177, v62
v_perm_b32 v61, v36, v19, s52
v_mfma_f32_16x16x32_bf16 v[188:191], a[240:243], a[140:143], v[188:191]
s_waitcnt lgkmcnt(4)
ds_read_b32 a178, v61
v_mfma_f32_16x16x32_bf16 v[240:243], a[244:247], a[32:35], v[240:243]
ds_read_b128 a[252:255], v14 offset:0
v_perm_b32 v60, v36, v19, s53
v_mfma_f32_16x16x32_bf16 v[244:247], a[244:247], a[36:39], v[244:247]
ds_read_b32 a179, v60
v_perm_b32 v59, v32, v19, s54
v_mfma_f32_16x16x32_bf16 v[248:251], a[244:247], a[40:43], v[248:251]
ds_read_b32 a180, v59
v_perm_b32 v58, v32, v19, s55
v_mfma_f32_16x16x32_bf16 v[252:255], a[244:247], a[44:47], v[252:255]
s_waitcnt lgkmcnt(4)
ds_read_b32 a181, v58
v_mfma_f32_16x16x32_bf16 v[128:131], a[248:251], a[160:163], v[128:131]
ds_read_b128 a[240:243], v17 offset:22528
v_perm_b32 v57, v36, v19, s54
v_mfma_f32_16x16x32_bf16 v[132:135], a[248:251], a[164:167], v[132:135]
ds_read_b32 a182, v57
v_perm_b32 v56, v36, v19, s55
v_mfma_f32_16x16x32_bf16 v[136:139], a[248:251], a[168:171], v[136:139]
ds_read_b32 a183, v56
v_perm_b32 v63, v33, v19, s52
v_mfma_f32_16x16x32_bf16 v[140:143], a[248:251], a[172:175], v[140:143]
s_waitcnt lgkmcnt(4)
ds_read_b32 a184, v63
v_mfma_f32_16x16x32_bf16 v[160:163], a[252:255], a[144:147], v[160:163]
ds_read_b128 a[244:247], v17 offset:24576
v_perm_b32 v62, v33, v19, s53
v_mfma_f32_16x16x32_bf16 v[164:167], a[252:255], a[148:151], v[164:167]
ds_read_b32 a185, v62
v_perm_b32 v61, v37, v19, s52
v_mfma_f32_16x16x32_bf16 v[168:171], a[252:255], a[152:155], v[168:171]
ds_read_b32 a186, v61
v_perm_b32 v60, v37, v19, s53
v_mfma_f32_16x16x32_bf16 v[172:175], a[252:255], a[156:159], v[172:175]
s_waitcnt lgkmcnt(4)
ds_read_b32 a187, v60
buffer_load_dwordx4 v[80:83], v12, s[24:27], 0 offen offset:0 sc1
v_mfma_f32_16x16x32_bf16 v[144:147], a[240:243], a[160:163], v[144:147]
ds_read_b128 a[248:251], v16 offset:26624
v_perm_b32 v59, v33, v19, s54
v_mfma_f32_16x16x32_bf16 v[148:151], a[240:243], a[164:167], v[148:151]
ds_read_b32 a188, v59
v_perm_b32 v58, v33, v19, s55
v_mfma_f32_16x16x32_bf16 v[152:155], a[240:243], a[168:171], v[152:155]
ds_read_b32 a189, v58
buffer_load_dwordx4 v[84:87], v12, s[24:27], 0 offen offset:1024 sc1
v_mfma_f32_16x16x32_bf16 v[156:159], a[240:243], a[172:175], v[156:159]
s_waitcnt vmcnt(11) lgkmcnt(4)
v_cmp_ne_u64 s[50:51], s[88:89], v[42:43]
v_cmp_ne_u64 s[44:45], s[88:89], v[46:47]
v_mfma_f32_16x16x32_bf16 v[192:195], a[244:247], a[128:131], v[192:195]
ds_read_b128 a[252:255], v14 offset:2048
v_perm_b32 v57, v37, v19, s54
v_mfma_f32_16x16x32_bf16 v[196:199], a[244:247], a[132:135], v[196:199]
s_or_b64 s[50:51], s[44:45], s[50:51]
ds_read_b32 a190, v57
v_perm_b32 v56, v37, v19, s55
v_mfma_f32_16x16x32_bf16 v[200:203], a[244:247], a[136:139], v[200:203]
s_cbranch_scc1 L_SLOW27
L_BACK27:
v_mfma_f32_16x16x32_bf16 v[204:207], a[244:247], a[140:143], v[204:207]
s_waitcnt lgkmcnt(2)
ds_read_b32 a191, v56
v_mfma_f32_16x16x32_bf16 v[208:211], a[248:251], a[112:115], v[208:211]
s_barrier
ds_read_b128 a[240:243], v17 offset:28672
v_perm_b32 v63, v40, v19, s52
v_mfma_f32_16x16x32_bf16 v[212:215], a[248:251], a[116:119], v[212:215]
ds_read_b32 a192, v63
v_perm_b32 v62, v40, v19, s53
v_mfma_f32_16x16x32_bf16 v[216:219], a[248:251], a[120:123], v[216:219]
s_add_u32 m0, s33, 108800
ds_read_b32 a193, v62
v_perm_b32 v61, v44, v19, s52
v_mfma_f32_16x16x32_bf16 v[220:223], a[248:251], a[124:127], v[220:223]
s_waitcnt lgkmcnt(4)
ds_read_b32 a194, v61
v_perm_b32 v60, v44, v19, s53
v_mfma_f32_16x16x32_bf16 v[176:179], a[252:255], a[144:147], v[176:179]
ds_read_b128 a[244:247], v14 offset:4096
buffer_load_dwordx4 v10, s[20:23], 0 offen offset:1792 lds
v_mfma_f32_16x16x32_bf16 v[180:183], a[252:255], a[148:151], v[180:183]
ds_read_b32 a195, v60
v_perm_b32 v59, v40, v19, s54
v_mfma_f32_16x16x32_bf16 v[184:187], a[252:255], a[152:155], v[184:187]
ds_read_b32 a196, v59
v_perm_b32 v58, v40, v19, s55
v_mfma_f32_16x16x32_bf16 v[188:191], a[252:255], a[156:159], v[188:191]
s_waitcnt lgkmcnt(4)
ds_read_b32 a197, v58
v_mfma_f32_16x16x32_bf16 v[224:227], a[240:243], a[96:99], v[224:227]
ds_read_b128 a[248:251], v15 offset:0
v_perm_b32 v57, v44, v19, s54
v_mfma_f32_16x16x32_bf16 v[228:231], a[240:243], a[100:103], v[228:231]
ds_read_b32 a198, v57
v_perm_b32 v56, v44, v19, s55
v_mfma_f32_16x16x32_bf16 v[232:235], a[240:243], a[104:107], v[232:235]
ds_read_b32 a199, v56
v_perm_b32 v63, v41, v19, s52
v_mfma_f32_16x16x32_bf16 v[236:239], a[240:243], a[108:111], v[236:239]
s_waitcnt lgkmcnt(4)
ds_read_b32 a200, v63
v_mfma_f32_16x16x32_bf16 v[128:131], a[244:247], a[176:179], v[128:131]
ds_read_b128 a[252:255], v14 offset:6144
v_perm_b32 v62, v41, v19, s53
v_mfma_f32_16x16x32_bf16 v[132:135], a[244:247], a[180:183], v[132:135]
ds_read_b32 a201, v62
v_perm_b32 v61, v45, v19, s52
v_mfma_f32_16x16x32_bf16 v[136:139], a[244:247], a[184:187], v[136:139]
s_add_u32 m0, s33, 113024
ds_read_b32 a202, v61
v_perm_b32 v60, v45, v19, s53
v_mfma_f32_16x16x32_bf16 v[140:143], a[244:247], a[188:191], v[140:143]
s_waitcnt lgkmcnt(4)
ds_read_b32 a203, v60
v_perm_b32 v59, v41, v19, s54
v_mfma_f32_16x16x32_bf16 v[160:163], a[248:251], a[160:163], v[160:163]
ds_read_b128 a[240:243], v14 offset:8192
buffer_load_dwordx4 v11, s[20:23], 0 offen offset:1664 lds
v_mfma_f32_16x16x32_bf16 v[164:167], a[248:251], a[164:167], v[164:167]
ds_read_b32 a204, v59
v_perm_b32 v58, v41, v19, s55
v_mfma_f32_16x16x32_bf16 v[168:171], a[248:251], a[168:171], v[168:171]
ds_read_b32 a205, v58
v_perm_b32 v57, v45, v19, s54
v_mfma_f32_16x16x32_bf16 v[172:175], a[248:251], a[172:175], v[172:175]
s_waitcnt lgkmcnt(4)
ds_read_b32 a206, v57
buffer_load_dwordx4 v[88:91], v12, s[24:27], 0 offen offset:2048 sc1
v_mfma_f32_16x16x32_bf16 v[144:147], a[252:255], a[176:179], v[144:147]
ds_read_b128 a[244:247], v15 offset:4096
v_perm_b32 v56, v45, v19, s55
v_mfma_f32_16x16x32_bf16 v[148:151], a[252:255], a[180:183], v[148:151]
ds_read_b32 a207, v56
buffer_load_dwordx4 v[92:95], v12, s[24:27], 0 offen offset:3072 sc1
v_mfma_f32_16x16x32_bf16 v[152:155], a[252:255], a[184:187], v[152:155]
s_waitcnt vmcnt(11)
v_cmp_ne_u64 s[50:51], s[88:89], v[50:51]
v_cmp_ne_u64 s[44:45], s[88:89], v[54:55]
v_mfma_f32_16x16x32_bf16 v[156:159], a[252:255], a[188:191], v[156:159]
s_waitcnt lgkmcnt(3)
v_mfma_f32_16x16x32_bf16 v[192:195], a[240:243], a[144:147], v[192:195]
s_or_b64 s[50:51], s[44:45], s[50:51]
ds_read_b128 a[248:251], v15 offset:2048
v_mfma_f32_16x16x32_bf16 v[196:199], a[240:243], a[148:151], v[196:199]
s_cbranch_scc1 L_SLOW28
L_BACK28:
v_mfma_f32_16x16x32_bf16 v[200:203], a[240:243], a[152:155], v[200:203]
s_add_u32 m0, s33, 116864
v_perm_b32 v63, v48, v19, s52
v_mfma_f32_16x16x32_bf16 v[204:207], a[240:243], a[156:159], v[204:207]
s_waitcnt lgkmcnt(1)
ds_read_b32 a208, v63
v_perm_b32 v62, v48, v19, s53
v_mfma_f32_16x16x32_bf16 v[128:131], a[244:247], a[192:195], v[128:131]
ds_read_b128 a[252:255], v17 offset:26624
buffer_load_dwordx4 v10, s[20:23], 0 offen offset:1920 lds
v_mfma_f32_16x16x32_bf16 v[132:135], a[244:247], a[196:199], v[132:135]
ds_read_b32 a209, v62
v_perm_b32 v61, v52, v19, s52
v_mfma_f32_16x16x32_bf16 v[136:139], a[244:247], a[200:203], v[136:139]
ds_read_b32 a210, v61
v_perm_b32 v60, v52, v19, s53
v_mfma_f32_16x16x32_bf16 v[140:143], a[244:247], a[204:207], v[140:143]
s_waitcnt lgkmcnt(4)
ds_read_b32 a211, v60
v_mfma_f32_16x16x32_bf16 v[176:179], a[248:251], a[160:163], v[176:179]
ds_read_b128 a[240:243], v14 offset:12288
v_perm_b32 v59, v48, v19, s54
v_mfma_f32_16x16x32_bf16 v[180:183], a[248:251], a[164:167], v[180:183]
ds_read_b32 a212, v59
v_perm_b32 v58, v48, v19, s55
v_mfma_f32_16x16x32_bf16 v[184:187], a[248:251], a[168:171], v[184:187]
ds_read_b32 a213, v58
v_perm_b32 v57, v52, v19, s54
v_mfma_f32_16x16x32_bf16 v[188:191], a[248:251], a[172:175], v[188:191]
s_waitcnt lgkmcnt(4)
ds_read_b32 a214, v57
v_mfma_f32_16x16x32_bf16 v[208:211], a[252:255], a[128:131], v[208:211]
ds_read_b128 a[244:247], v16 offset:6144
v_perm_b32 v56, v52, v19, s55
v_mfma_f32_16x16x32_bf16 v[212:215], a[252:255], a[132:135], v[212:215]
ds_read_b32 a215, v56
v_perm_b32 v63, v49, v19, s52
v_mfma_f32_16x16x32_bf16 v[216:219], a[252:255], a[136:139], v[216:219]
s_add_u32 m0, s33, 121088
ds_read_b32 a216, v63
v_perm_b32 v62, v49, v19, s53
v_mfma_f32_16x16x32_bf16 v[220:223], a[252:255], a[140:143], v[220:223]
s_waitcnt lgkmcnt(4)
ds_read_b32 a217, v62
v_perm_b32 v61, v53, v19, s52
v_mfma_f32_16x16x32_bf16 v[160:163], a[240:243], a[176:179], v[160:163]
ds_read_b128 a[248:251], v14 offset:16384
buffer_load_dwordx4 v11, s[20:23], 0 offen offset:1792 lds
v_mfma_f32_16x16x32_bf16 v[164:167], a[240:243], a[180:183], v[164:167]
ds_read_b32 a218, v61
v_perm_b32 v60, v53, v19, s53
v_mfma_f32_16x16x32_bf16 v[168:171], a[240:243], a[184:187], v[168:171]
ds_read_b32 a219, v60
v_perm_b32 v59, v49, v19, s54
v_mfma_f32_16x16x32_bf16 v[172:175], a[240:243], a[188:191], v[172:175]
s_waitcnt lgkmcnt(4)
ds_read_b32 a220, v59
v_mfma_f32_16x16x32_bf16 v[240:243], a[244:247], a[48:51], v[240:243]
ds_read_b128 a[252:255], v15 offset:6144
v_perm_b32 v58, v49, v19, s55
v_mfma_f32_16x16x32_bf16 v[244:247], a[244:247], a[52:55], v[244:247]
ds_read_b32 a221, v58
v_perm_b32 v57, v53, v19, s54
v_mfma_f32_16x16x32_bf16 v[248:251], a[244:247], a[56:59], v[248:251]
s_waitcnt vmcnt(9)
v_cmp_ne_u64 s[50:51], s[88:89], v[98:99]
v_cmp_ne_u64 s[44:45], s[88:89], v[102:103]
v_mfma_f32_16x16x32_bf16 v[252:255], a[244:247], a[60:63], v[252:255]
s_waitcnt lgkmcnt(3)
ds_read_b32 a222, v57
v_mfma_f32_16x16x32_bf16 v[224:227], a[248:251], a[112:115], v[224:227]
s_or_b64 s[50:51], s[44:45], s[50:51]
ds_read_b128 a[240:243], v14 offset:20480
v_perm_b32 v56, v53, v19, s55
v_mfma_f32_16x16x32_bf16 v[228:231], a[248:251], a[116:119], v[228:231]
s_cbranch_scc1 L_SLOW29
L_BACK29:
v_mfma_f32_16x16x32_bf16 v[232:235], a[248:251], a[120:123], v[232:235]
s_add_u32 m0, s33, 125056
ds_read_b32 a223, v56
v_mfma_f32_16x16x32_bf16 v[236:239], a[248:251], a[124:127], v[236:239]
s_waitcnt lgkmcnt(3)
v_mfma_f32_16x16x32_bf16 v[144:147], a[252:255], a[192:195], v[144:147]
ds_read_b128 a[244:247], v15 offset:8192
buffer_load_dwordx4 v11, s[20:23], 0 offen offset:1920 lds
v_mfma_f32_16x16x32_bf16 v[148:151], a[252:255], a[196:199], v[148:151]
v_perm_b32 v63, v96, v19, s52
v_mfma_f32_16x16x32_bf16 v[152:155], a[252:255], a[200:203], v[152:155]
ds_read_b32 a224, v63
v_perm_b32 v62, v96, v19, s53
v_mfma_f32_16x16x32_bf16 v[156:159], a[252:255], a[204:207], v[156:159]
s_waitcnt lgkmcnt(2)
ds_read_b32 a225, v62
v_mfma_f32_16x16x32_bf16 v[128:131], a[240:243], a[208:211], v[128:131]
ds_read_b128 a[248:251], v14 offset:14336
v_perm_b32 v61, v100, v19, s52
v_mfma_f32_16x16x32_bf16 v[132:135], a[240:243], a[212:215], v[132:135]
ds_read_b32 a226, v61
v_perm_b32 v60, v100, v19, s53
v_mfma_f32_16x16x32_bf16 v[136:139], a[240:243], a[216:219], v[136:139]
ds_read_b32 a227, v60
v_perm_b32 v59, v96, v19, s54
v_mfma_f32_16x16x32_bf16 v[140:143], a[240:243], a[220:223], v[140:143]
s_waitcnt lgkmcnt(4)
ds_read_b32 a228, v59
v_mfma_f32_16x16x32_bf16 v[192:195], a[244:247], a[160:163], v[192:195]
ds_read_b128 a[252:255], v15 offset:12288
v_perm_b32 v58, v96, v19, s55
v_mfma_f32_16x16x32_bf16 v[196:199], a[244:247], a[164:167], v[196:199]
ds_read_b32 a229, v58
v_perm_b32 v57, v100, v19, s54
v_mfma_f32_16x16x32_bf16 v[200:203], a[244:247], a[168:171], v[200:203]
ds_read_b32 a230, v57
v_perm_b32 v56, v100, v19, s55
v_mfma_f32_16x16x32_bf16 v[204:207], a[244:247], a[172:175], v[204:207]
s_waitcnt lgkmcnt(4)
ds_read_b32 a231, v56
v_mfma_f32_16x16x32_bf16 v[176:179], a[248:251], a[176:179], v[176:179]
s_waitcnt vmcnt(9)
s_barrier
ds_read_b128 a[240:243], v14 offset:10240
v_perm_b32 v63, v97, v19, s52
v_mfma_f32_16x16x32_bf16 v[180:183], a[248:251], a[180:183], v[180:183]
ds_read_b32 a232, v63
v_perm_b32 v62, v97, v19, s53
v_mfma_f32_16x16x32_bf16 v[184:187], a[248:251], a[184:187], v[184:187]
ds_read_b32 a233, v62
v_perm_b32 v61, v101, v19, s52
v_mfma_f32_16x16x32_bf16 v[188:191], a[248:251], a[188:191], v[188:191]
s_waitcnt lgkmcnt(4)
ds_read_b32 a234, v61
v_mfma_f32_16x16x32_bf16 v[160:163], a[252:255], a[192:195], v[160:163]
ds_read_b128 a[244:247], v14 offset:22528
v_perm_b32 v60, v101, v19, s53
v_mfma_f32_16x16x32_bf16 v[164:167], a[252:255], a[196:199], v[164:167]
ds_read_b32 a235, v60
v_perm_b32 v59, v97, v19, s54
v_mfma_f32_16x16x32_bf16 v[168:171], a[252:255], a[200:203], v[168:171]
ds_read_b32 a236, v59
v_perm_b32 v58, v97, v19, s55
v_mfma_f32_16x16x32_bf16 v[172:175], a[252:255], a[204:207], v[172:175]
s_waitcnt lgkmcnt(4)
ds_read_b32 a237, v58
v_mfma_f32_16x16x32_bf16 v[208:211], a[240:243], a[144:147], v[208:211]
ds_read_b128 a[248:251], v15 offset:20480
v_perm_b32 v57, v101, v19, s54
v_mfma_f32_16x16x32_bf16 v[212:215], a[240:243], a[148:151], v[212:215]
ds_read_b32 a238, v57
v_perm_b32 v56, v101, v19, s55
v_mfma_f32_16x16x32_bf16 v[216:219], a[240:243], a[152:155], v[216:219]
ds_read_b32 a239, v56
v_mfma_f32_16x16x32_bf16 v[220:223], a[240:243], a[156:159], v[220:223]
s_waitcnt vmcnt(7) lgkmcnt(4)
v_cmp_ne_u64 s[50:51], s[88:89], v[82:83]
v_cmp_ne_u64 s[44:45], s[88:89], v[86:87]
v_mfma_f32_16x16x32_bf16 v[144:147], a[244:247], a[208:211], v[144:147]
ds_read_b128 a[252:255], v15 offset:16384
v_mfma_f32_16x16x32_bf16 v[148:151], a[244:247], a[212:215], v[148:151]
s_or_b64 s[50:51], s[44:45], s[50:51]
v_mfma_f32_16x16x32_bf16 v[152:155], a[244:247], a[216:219], v[152:155]
s_cbranch_scc1 L_SLOW30
L_BACK30:
v_mfma_f32_16x16x32_bf16 v[156:159], a[244:247], a[220:223], v[156:159]
s_waitcnt lgkmcnt(1)
v_mfma_f32_16x16x32_bf16 v[128:131], a[248:251], a[224:227], v[128:131]
ds_read_b128 a[240:243], v15 offset:14336
v_mfma_f32_16x16x32_bf16 v[132:135], a[248:251], a[228:231], v[132:135]
v_perm_b32 v63, v80, v19, s52
v_mfma_f32_16x16x32_bf16 v[136:139], a[248:251], a[232:235], v[136:139]
ds_read_b32 a0, v63
v_perm_b32 v62, v80, v19, s53
v_mfma_f32_16x16x32_bf16 v[140:143], a[248:251], a[236:239], v[140:143]
s_waitcnt lgkmcnt(2)
ds_read_b32 a1, v62
v_mfma_f32_16x16x32_bf16 v[224:227], a[252:255], a[128:131], v[224:227]
ds_read_b128 a[244:247], v14 offset:24576
v_perm_b32 v61, v84, v19, s52
v_mfma_f32_16x16x32_bf16 v[228:231], a[252:255], a[132:135], v[228:231]
ds_read_b32 a2, v61
v_perm_b32 v60, v84, v19, s53
v_mfma_f32_16x16x32_bf16 v[232:235], a[252:255], a[136:139], v[232:235]
ds_read_b32 a3, v60
v_perm_b32 v59, v80, v19, s54
v_mfma_f32_16x16x32_bf16 v[236:239], a[252:255], a[140:143], v[236:239]
s_waitcnt lgkmcnt(4)
ds_read_b32 a4, v59
v_mfma_f32_16x16x32_bf16 v[176:179], a[240:243], a[192:195], v[176:179]
ds_read_b128 a[248:251], v14 offset:28672
v_perm_b32 v58, v80, v19, s55
v_mfma_f32_16x16x32_bf16 v[180:183], a[240:243], a[196:199], v[180:183]
ds_read_b32 a5, v58
v_perm_b32 v57, v84, v19, s54
v_mfma_f32_16x16x32_bf16 v[184:187], a[240:243], a[200:203], v[184:187]
ds_read_b32 a6, v57
v_perm_b32 v56, v84, v19, s55
v_mfma_f32_16x16x32_bf16 v[188:191], a[240:243], a[204:207], v[188:191]
s_waitcnt lgkmcnt(4)
ds_read_b32 a7, v56
v_mfma_f32_16x16x32_bf16 v[192:195], a[244:247], a[176:179], v[192:195]
ds_read_b128 a[252:255], v15 offset:22528
v_perm_b32 v63, v81, v19, s52
v_mfma_f32_16x16x32_bf16 v[196:199], a[244:247], a[180:183], v[196:199]
ds_read_b32 a8, v63
v_perm_b32 v62, v81, v19, s53
v_mfma_f32_16x16x32_bf16 v[200:203], a[244:247], a[184:187], v[200:203]
ds_read_b32 a9, v62
v_perm_b32 v61, v85, v19, s52
v_mfma_f32_16x16x32_bf16 v[204:207], a[244:247], a[188:191], v[204:207]
s_waitcnt lgkmcnt(4)
ds_read_b32 a10, v61
v_mfma_f32_16x16x32_bf16 v[160:163], a[248:251], a[208:211], v[160:163]
ds_read_b128 a[240:243], v15 offset:10240
v_perm_b32 v60, v85, v19, s53
v_mfma_f32_16x16x32_bf16 v[164:167], a[248:251], a[212:215], v[164:167]
ds_read_b32 a11, v60
v_perm_b32 v59, v81, v19, s54
v_mfma_f32_16x16x32_bf16 v[168:171], a[248:251], a[216:219], v[168:171]
ds_read_b32 a12, v59
v_perm_b32 v58, v81, v19, s55
v_mfma_f32_16x16x32_bf16 v[172:175], a[248:251], a[220:223], v[172:175]
s_waitcnt lgkmcnt(4)
ds_read_b32 a13, v58
v_mfma_f32_16x16x32_bf16 v[144:147], a[252:255], a[224:227], v[144:147]
ds_read_b128 a[244:247], v14 offset:32768
v_perm_b32 v57, v85, v19, s54
v_mfma_f32_16x16x32_bf16 v[148:151], a[252:255], a[228:231], v[148:151]
ds_read_b32 a14, v57
v_perm_b32 v56, v85, v19, s55
v_mfma_f32_16x16x32_bf16 v[152:155], a[252:255], a[232:235], v[152:155]
ds_read_b32 a15, v56
v_mfma_f32_16x16x32_bf16 v[156:159], a[252:255], a[236:239], v[156:159]
s_waitcnt vmcnt(3) lgkmcnt(4)
v_cmp_ne_u64 s[50:51], s[88:89], v[90:91]
v_cmp_ne_u64 s[44:45], s[88:89], v[94:95]
v_mfma_f32_16x16x32_bf16 v[208:211], a[240:243], a[160:163], v[208:211]
ds_read_b128 a[248:251], v17 offset:6144
v_mfma_f32_16x16x32_bf16 v[212:215], a[240:243], a[164:167], v[212:215]
s_or_b64 s[50:51], s[44:45], s[50:51]
v_mfma_f32_16x16x32_bf16 v[216:219], a[240:243], a[168:171], v[216:219]
s_cbranch_scc1 L_SLOW31
L_BACK31:
v_mfma_f32_16x16x32_bf16 v[220:223], a[240:243], a[172:175], v[220:223]
s_waitcnt lgkmcnt(1)
v_mfma_f32_16x16x32_bf16 v[128:131], a[244:247], a[0:3], v[128:131]
ds_read_b128 a[252:255], v14 offset:30720
v_mfma_f32_16x16x32_bf16 v[132:135], a[244:247], a[4:7], v[132:135]
v_perm_b32 v63, v88, v19, s52
v_mfma_f32_16x16x32_bf16 v[136:139], a[244:247], a[8:11], v[136:139]
ds_read_b32 a16, v63
v_perm_b32 v62, v88, v19, s53
v_mfma_f32_16x16x32_bf16 v[140:143], a[244:247], a[12:15], v[140:143]
s_waitcnt lgkmcnt(2)
ds_read_b32 a17, v62
v_mfma_f32_16x16x32_bf16 v[240:243], a[248:251], a[64:67], v[240:243]
ds_read_b128 a[240:243], v15 offset:28672
v_perm_b32 v61, v92, v19, s52
v_mfma_f32_16x16x32_bf16 v[244:247], a[248:251], a[68:71], v[244:247]
ds_read_b32 a18, v61
v_perm_b32 v60, v92, v19, s53
v_mfma_f32_16x16x32_bf16 v[248:251], a[248:251], a[72:75], v[248:251]
ds_read_b32 a19, v60
v_perm_b32 v59, v88, v19, s54
v_mfma_f32_16x16x32_bf16 v[252:255], a[248:251], a[76:79], v[252:255]
s_waitcnt lgkmcnt(4)
ds_read_b32 a20, v59
v_mfma_f32_16x16x32_bf16 v[176:179], a[252:255], a[208:211], v[176:179]
ds_read_b128 a[244:247], v15 offset:24576
v_perm_b32 v58, v88, v19, s55
v_mfma_f32_16x16x32_bf16 v[180:183], a[252:255], a[212:215], v[180:183]
ds_read_b32 a21, v58
v_perm_b32 v57, v92, v19, s54
v_mfma_f32_16x16x32_bf16 v[184:187], a[252:255], a[216:219], v[184:187]
ds_read_b32 a22, v57
v_perm_b32 v56, v92, v19, s55
v_mfma_f32_16x16x32_bf16 v[188:191], a[252:255], a[220:223], v[188:191]
s_waitcnt lgkmcnt(4)
ds_read_b32 a23, v56
v_mfma_f32_16x16x32_bf16 v[160:163], a[240:243], a[224:227], v[160:163]
ds_read_b128 a[248:251], v14 offset:36864
v_perm_b32 v63, v89, v19, s52
v_mfma_f32_16x16x32_bf16 v[164:167], a[240:243], a[228:231], v[164:167]
ds_read_b32 a24, v63
v_perm_b32 v62, v89, v19, s53
v_mfma_f32_16x16x32_bf16 v[168:171], a[240:243], a[232:235], v[168:171]
ds_read_b32 a25, v62
v_perm_b32 v61, v93, v19, s52
v_mfma_f32_16x16x32_bf16 v[172:175], a[240:243], a[236:239], v[172:175]
s_waitcnt lgkmcnt(4)
ds_read_b32 a26, v61
v_mfma_f32_16x16x32_bf16 v[192:195], a[244:247], a[192:195], v[192:195]
L_PAD5:
s_cbranch_vccnz L_PADRET
ds_read_b128 a[252:255], v14 offset:34816
v_perm_b32 v60, v93, v19, s53
v_mfma_f32_16x16x32_bf16 v[196:199], a[244:247], a[196:199], v[196:199]
ds_read_b32 a27, v60
v_perm_b32 v59, v89, v19, s54
v_mfma_f32_16x16x32_bf16 v[200:203], a[244:247], a[200:203], v[200:203]
ds_read_b32 a28, v59
v_perm_b32 v58, v89, v19, s55
v_mfma_f32_16x16x32_bf16 v[204:207], a[244:247], a[204:207], v[204:207]
s_waitcnt lgkmcnt(4)
ds_read_b32 a29, v58
v_mfma_f32_16x16x32_bf16 v[224:227], a[248:251], a[144:147], v[224:227]
ds_read_b128 a[240:243], v15 offset:32768
v_perm_b32 v57, v93, v19, s54
v_mfma_f32_16x16x32_bf16 v[228:231], a[248:251], a[148:151], v[228:231]
ds_read_b32 a30, v57
v_perm_b32 v56, v93, v19, s55
v_mfma_f32_16x16x32_bf16 v[232:235], a[248:251], a[152:155], v[232:235]
ds_read_b32 a31, v56
v_mfma_f32_16x16x32_bf16 v[236:239], a[248:251], a[156:159], v[236:239]
s_waitcnt lgkmcnt(4)
v_mfma_f32_16x16x32_bf16 v[144:147], a[252:255], a[0:3], v[144:147]
ds_read_b128 a[244:247], v14 offset:26624
v_mfma_f32_16x16x32_bf16 v[148:151], a[252:255], a[4:7], v[148:151]
v_mfma_f32_16x16x32_bf16 v[152:155], a[252:255], a[8:11], v[152:155]
v_mfma_f32_16x16x32_bf16 v[156:159], a[252:255], a[12:15], v[156:159]
s_waitcnt lgkmcnt(1)
v_mfma_f32_16x16x32_bf16 v[128:131], a[240:243], a[16:19], v[128:131]
ds_read_b128 a[248:251], v15 offset:30720
v_mfma_f32_16x16x32_bf16 v[132:135], a[240:243], a[20:23], v[132:135]
v_mfma_f32_16x16x32_bf16 v[136:139], a[240:243], a[24:27], v[136:139]
v_mfma_f32_16x16x32_bf16 v[140:143], a[240:243], a[28:31], v[140:143]
s_waitcnt lgkmcnt(1)
v_mfma_f32_16x16x32_bf16 v[208:211], a[244:247], a[176:179], v[208:211]
ds_read_b128 a[252:255], v14 offset:40960
v_mfma_f32_16x16x32_bf16 v[212:215], a[244:247], a[180:183], v[212:215]
v_mfma_f32_16x16x32_bf16 v[216:219], a[244:247], a[184:187], v[216:219]
v_mfma_f32_16x16x32_bf16 v[220:223], a[244:247], a[188:191], v[220:223]
s_waitcnt lgkmcnt(1)
v_mfma_f32_16x16x32_bf16 v[176:179], a[248:251], a[224:227], v[176:179]
s_waitcnt vmcnt(0)
s_barrier
ds_read_b128 a[240:243], v15 offset:34816
v_mfma_f32_16x16x32_bf16 v[180:183], a[248:251], a[228:231], v[180:183]
v_mfma_f32_16x16x32_bf16 v[184:187], a[248:251], a[232:235], v[184:187]
v_mfma_f32_16x16x32_bf16 v[188:191], a[248:251], a[236:239], v[188:191]
s_waitcnt lgkmcnt(1)
v_mul_f32 v128, v128, v24
v_mul_f32 v132, v132, v25
v_mfma_f32_16x16x32_bf16 v[160:163], a[252:255], a[0:3], v[160:163]
ds_read_b128 a[244:247], v14 offset:45056
v_mul_f32 v136, v136, v26
v_mfma_f32_16x16x32_bf16 v[164:167], a[252:255], a[4:7], v[164:167]
v_mul_f32 v140, v140, v27
v_cvt_pk_bf16_f32 v120, v128, v132
v_mfma_f32_16x16x32_bf16 v[168:171], a[252:255], a[8:11], v[168:171]
v_cvt_pk_bf16_f32 v121, v136, v140
v_mfma_f32_16x16x32_bf16 v[172:175], a[252:255], a[12:15], v[172:175]
s_waitcnt lgkmcnt(1)
v_mfma_f32_16x16x32_bf16 v[144:147], a[240:243], a[16:19], v[144:147]
ds_read_b128 a[248:251], v15 offset:36864
v_mfma_f32_16x16x32_bf16 v[148:151], a[240:243], a[20:23], v[148:151]
buffer_store_dwordx2 v[120:121], v18, s[28:31], 0 offen nt
v_mul_f32 v129, v129, v24
v_mfma_f32_16x16x32_bf16 v[152:155], a[240:243], a[24:27], v[152:155]
s_add_u32 s28, s28, 7168
v_mul_f32 v133, v133, v25
v_mul_f32 v137, v137, v26
v_mfma_f32_16x16x32_bf16 v[156:159], a[240:243], a[28:31], v[156:159]
s_waitcnt lgkmcnt(1)
v_mul_f32 v141, v141, v27
v_cvt_pk_bf16_f32 v122, v129, v133
v_mfma_f32_16x16x32_bf16 v[192:195], a[244:247], a[208:211], v[192:195]
s_addc_u32 s29, s29, 0
ds_read_b128 a[252:255], v15 offset:26624
v_cvt_pk_bf16_f32 v123, v137, v141
v_mfma_f32_16x16x32_bf16 v[196:199], a[244:247], a[212:215], v[196:199]
buffer_store_dwordx2 v[122:123], v18, s[28:31], 0 offen nt
v_mul_f32 v130, v130, v24
v_mfma_f32_16x16x32_bf16 v[200:203], a[244:247], a[216:219], v[200:203]
s_add_u32 s28, s28, 7168
v_mul_f32 v134, v134, v25
v_mul_f32 v138, v138, v26
v_mfma_f32_16x16x32_bf16 v[204:207], a[244:247], a[220:223], v[204:207]
s_waitcnt lgkmcnt(1)
v_mul_f32 v142, v142, v27
v_cvt_pk_bf16_f32 v124, v130, v134
v_mfma_f32_16x16x32_bf16 v[224:227], a[248:251], a[160:163], v[224:227]
s_addc_u32 s29, s29, 0
ds_read_b128 a[240:243], v16 offset:30720
v_cvt_pk_bf16_f32 v125, v138, v142
v_mfma_f32_16x16x32_bf16 v[228:231], a[248:251], a[164:167], v[228:231]
buffer_store_dwordx2 v[124:125], v18, s[28:31], 0 offen nt
v_mul_f32 v131, v131, v24
v_mfma_f32_16x16x32_bf16 v[232:235], a[248:251], a[168:171], v[232:235]
s_add_u32 s28, s28, 7168
v_mul_f32 v135, v135, v25
v_mul_f32 v139, v139, v26
v_mfma_f32_16x16x32_bf16 v[236:239], a[248:251], a[172:175], v[236:239]
s_waitcnt lgkmcnt(1)
v_mul_f32 v143, v143, v27
v_cvt_pk_bf16_f32 v126, v131, v135
v_mfma_f32_16x16x32_bf16 v[208:211], a[252:255], a[192:195], v[208:211]
s_addc_u32 s29, s29, 0
ds_read_b128 a[244:247], v15 offset:40960
v_cvt_pk_bf16_f32 v127, v139, v143
v_mfma_f32_16x16x32_bf16 v[212:215], a[252:255], a[196:199], v[212:215]
buffer_store_dwordx2 v[126:127], v18, s[28:31], 0 offen nt
v_mul_f32 v144, v144, v24
v_mfma_f32_16x16x32_bf16 v[216:219], a[252:255], a[200:203], v[216:219]
s_add_u32 s28, s28, 93184
v_mul_f32 v148, v148, v25
v_mul_f32 v152, v152, v26
v_mfma_f32_16x16x32_bf16 v[220:223], a[252:255], a[204:207], v[220:223]
s_waitcnt lgkmcnt(1)
v_mul_f32 v156, v156, v27
v_cvt_pk_bf16_f32 v120, v144, v148
v_mfma_f32_16x16x32_bf16 v[240:243], a[240:243], a[80:83], v[240:243]
s_addc_u32 s29, s29, 0
ds_read_b128 a[248:251], v14 offset:43008
v_cvt_pk_bf16_f32 v121, v152, v156
v_mfma_f32_16x16x32_bf16 v[244:247], a[240:243], a[84:87], v[244:247]
buffer_store_dwordx2 v[120:121], v18, s[28:31], 0 offen nt
v_mul_f32 v145, v145, v24
v_mfma_f32_16x16x32_bf16 v[248:251], a[240:243], a[88:91], v[248:251]
s_add_u32 s28, s28, 7168
v_mul_f32 v149, v149, v25
v_mul_f32 v153, v153, v26
v_mfma_f32_16x16x32_bf16 v[252:255], a[240:243], a[92:95], v[252:255]
s_waitcnt lgkmcnt(1)
v_mul_f32 v157, v157, v27
v_cvt_pk_bf16_f32 v122, v145, v149
v_mfma_f32_16x16x32_bf16 v[160:163], a[244:247], a[16:19], v[160:163]
s_addc_u32 s29, s29, 0
ds_read_b128 a[252:255], v15 offset:45056
v_cvt_pk_bf16_f32 v123, v153, v157
v_mfma_f32_16x16x32_bf16 v[164:167], a[244:247], a[20:23], v[164:167]
buffer_store_dwordx2 v[122:123], v18, s[28:31], 0 offen nt
v_mul_f32 v146, v146, v24
v_mfma_f32_16x16x32_bf16 v[168:171], a[244:247], a[24:27], v[168:171]
s_add_u32 s28, s28, 7168
v_mul_f32 v150, v150, v25
v_mul_f32 v154, v154, v26
v_mfma_f32_16x16x32_bf16 v[172:175], a[244:247], a[28:31], v[172:175]
s_waitcnt lgkmcnt(1)
v_mul_f32 v158, v158, v27
v_cvt_pk_bf16_f32 v124, v146, v150
v_mfma_f32_16x16x32_bf16 v[176:179], a[248:251], a[0:3], v[176:179]
s_addc_u32 s29, s29, 0
ds_read_b128 a[240:243], v14 offset:49152
v_cvt_pk_bf16_f32 v125, v154, v158
v_mfma_f32_16x16x32_bf16 v[180:183], a[248:251], a[4:7], v[180:183]
buffer_store_dwordx2 v[124:125], v18, s[28:31], 0 offen nt
v_mul_f32 v147, v147, v24
v_mfma_f32_16x16x32_bf16 v[184:187], a[248:251], a[8:11], v[184:187]
s_add_u32 s28, s28, 7168
v_mul_f32 v151, v151, v25
v_mul_f32 v155, v155, v26
v_mfma_f32_16x16x32_bf16 v[188:191], a[248:251], a[12:15], v[188:191]
s_waitcnt lgkmcnt(1)
v_mul_f32 v159, v159, v27
v_cvt_pk_bf16_f32 v126, v147, v151
v_mfma_f32_16x16x32_bf16 v[192:195], a[252:255], a[224:227], v[192:195]
s_addc_u32 s29, s29, 0
ds_read_b128 a[244:247], v14 offset:47104
v_cvt_pk_bf16_f32 v127, v155, v159
v_mfma_f32_16x16x32_bf16 v[196:199], a[252:255], a[228:231], v[196:199]
buffer_store_dwordx2 v[126:127], v18, s[28:31], 0 offen nt
v_mfma_f32_16x16x32_bf16 v[200:203], a[252:255], a[232:235], v[200:203]
v_mfma_f32_16x16x32_bf16 v[204:207], a[252:255], a[236:239], v[204:207]
s_waitcnt lgkmcnt(1)
v_mul_f32 v160, v160, v24
v_mul_f32 v164, v164, v25
v_mfma_f32_16x16x32_bf16 v[224:227], a[240:243], a[176:179], v[224:227]
s_add_u32 s28, s28, 93184
ds_read_b128 a[248:251], v15 offset:43008
v_mul_f32 v168, v168, v26
v_mfma_f32_16x16x32_bf16 v[228:231], a[240:243], a[180:183], v[228:231]
s_addc_u32 s29, s29, 0
v_mul_f32 v172, v172, v27
v_cvt_pk_bf16_f32 v120, v160, v164
v_mfma_f32_16x16x32_bf16 v[232:235], a[240:243], a[184:187], v[232:235]
v_cvt_pk_bf16_f32 v121, v168, v172
v_mfma_f32_16x16x32_bf16 v[236:239], a[240:243], a[188:191], v[236:239]
s_waitcnt lgkmcnt(1)
v_mfma_f32_16x16x32_bf16 v[208:211], a[244:247], a[208:211], v[208:211]
ds_read_b128 a[252:255], v14 offset:53248
v_mfma_f32_16x16x32_bf16 v[212:215], a[244:247], a[212:215], v[212:215]
buffer_store_dwordx2 v[120:121], v18, s[28:31], 0 offen nt
v_mul_f32 v161, v161, v24
v_mfma_f32_16x16x32_bf16 v[216:219], a[244:247], a[216:219], v[216:219]
s_add_u32 s28, s28, 7168
v_mul_f32 v165, v165, v25
v_mul_f32 v169, v169, v26
v_mfma_f32_16x16x32_bf16 v[220:223], a[244:247], a[220:223], v[220:223]
s_waitcnt lgkmcnt(1)
v_mul_f32 v173, v173, v27
v_cvt_pk_bf16_f32 v122, v161, v165
v_mfma_f32_16x16x32_bf16 v[176:179], a[248:251], a[16:19], v[176:179]
s_addc_u32 s29, s29, 0
ds_read_b128 a[240:243], v17 offset:30720
v_cvt_pk_bf16_f32 v123, v169, v173
v_mfma_f32_16x16x32_bf16 v[180:183], a[248:251], a[20:23], v[180:183]
buffer_store_dwordx2 v[122:123], v18, s[28:31], 0 offen nt
v_mul_f32 v162, v162, v24
v_mfma_f32_16x16x32_bf16 v[184:187], a[248:251], a[24:27], v[184:187]
s_add_u32 s28, s28, 7168
v_mul_f32 v166, v166, v25
v_mul_f32 v170, v170, v26
v_mfma_f32_16x16x32_bf16 v[188:191], a[248:251], a[28:31], v[188:191]
s_waitcnt lgkmcnt(1)
v_mul_f32 v174, v174, v27
v_cvt_pk_bf16_f32 v124, v162, v166
v_mfma_f32_16x16x32_bf16 v[192:195], a[252:255], a[0:3], v[192:195]
s_addc_u32 s29, s29, 0
ds_read_b128 a[244:247], v15 offset:47104
v_cvt_pk_bf16_f32 v125, v170, v174
v_mfma_f32_16x16x32_bf16 v[196:199], a[252:255], a[4:7], v[196:199]
buffer_store_dwordx2 v[124:125], v18, s[28:31], 0 offen nt
v_mul_f32 v163, v163, v24
v_mfma_f32_16x16x32_bf16 v[200:203], a[252:255], a[8:11], v[200:203]
s_add_u32 s28, s28, 7168
v_mul_f32 v167, v167, v25
v_mul_f32 v171, v171, v26
v_mfma_f32_16x16x32_bf16 v[204:207], a[252:255], a[12:15], v[204:207]
s_waitcnt lgkmcnt(1)
v_mul_f32 v175, v175, v27
v_cvt_pk_bf16_f32 v126, v163, v167
v_mfma_f32_16x16x32_bf16 v[240:243], a[240:243], a[96:99], v[240:243]
s_addc_u32 s29, s29, 0
ds_read_b128 a[248:251], v15 offset:49152
v_cvt_pk_bf16_f32 v127, v171, v175
v_mfma_f32_16x16x32_bf16 v[244:247], a[240:243], a[100:103], v[244:247]
buffer_store_dwordx2 v[126:127], v18, s[28:31], 0 offen nt
v_mfma_f32_16x16x32_bf16 v[248:251], a[240:243], a[104:107], v[248:251]
v_mfma_f32_16x16x32_bf16 v[252:255], a[240:243], a[108:111], v[252:255]
s_waitcnt lgkmcnt(1)
v_mul_f32 v176, v176, v24
v_mul_f32 v180, v180, v25
v_mfma_f32_16x16x32_bf16 v[208:211], a[244:247], a[224:227], v[208:211]
s_add_u32 s28, s28, 93184
ds_read_b128 a[252:255], v15 offset:53248
v_mul_f32 v184, v184, v26
v_mfma_f32_16x16x32_bf16 v[212:215], a[244:247], a[228:231], v[212:215]
s_addc_u32 s29, s29, 0
v_mul_f32 v188, v188, v27
v_cvt_pk_bf16_f32 v120, v176, v180
v_mfma_f32_16x16x32_bf16 v[216:219], a[244:247], a[232:235], v[216:219]
v_cvt_pk_bf16_f32 v121, v184, v188
v_mfma_f32_16x16x32_bf16 v[220:223], a[244:247], a[236:239], v[220:223]
s_waitcnt lgkmcnt(1)
v_mfma_f32_16x16x32_bf16 v[224:227], a[248:251], a[192:195], v[224:227]
ds_read_b128 a[240:243], v14 offset:55296
v_mfma_f32_16x16x32_bf16 v[228:231], a[248:251], a[196:199], v[228:231]
buffer_store_dwordx2 v[120:121], v18, s[28:31], 0 offen nt
v_mul_f32 v177, v177, v24
v_mfma_f32_16x16x32_bf16 v[232:235], a[248:251], a[200:203], v[232:235]
s_add_u32 s28, s28, 7168
v_mul_f32 v181, v181, v25
v_mul_f32 v185, v185, v26
v_mfma_f32_16x16x32_bf16 v[236:239], a[248:251], a[204:207], v[236:239]
s_waitcnt lgkmcnt(1)
v_mul_f32 v189, v189, v27
v_cvt_pk_bf16_f32 v122, v177, v181
v_mfma_f32_16x16x32_bf16 v[192:195], a[252:255], a[16:19], v[192:195]
s_addc_u32 s29, s29, 0
ds_read_b128 a[244:247], v14 offset:57344
v_cvt_pk_bf16_f32 v123, v185, v189
v_mfma_f32_16x16x32_bf16 v[196:199], a[252:255], a[20:23], v[196:199]
buffer_store_dwordx2 v[122:123], v18, s[28:31], 0 offen nt
v_mul_f32 v178, v178, v24
v_mfma_f32_16x16x32_bf16 v[200:203], a[252:255], a[24:27], v[200:203]
s_add_u32 s28, s28, 7168
v_mul_f32 v182, v182, v25
v_mul_f32 v186, v186, v26
v_mfma_f32_16x16x32_bf16 v[204:207], a[252:255], a[28:31], v[204:207]
s_waitcnt lgkmcnt(1)
v_mul_f32 v190, v190, v27
v_cvt_pk_bf16_f32 v124, v178, v182
v_mfma_f32_16x16x32_bf16 v[208:211], a[240:243], a[0:3], v[208:211]
s_addc_u32 s29, s29, 0
ds_read_b128 a[248:251], v14 offset:18432
v_cvt_pk_bf16_f32 v125, v186, v190
v_mfma_f32_16x16x32_bf16 v[212:215], a[240:243], a[4:7], v[212:215]
buffer_store_dwordx2 v[124:125], v18, s[28:31], 0 offen nt
v_mul_f32 v179, v179, v24
v_mfma_f32_16x16x32_bf16 v[216:219], a[240:243], a[8:11], v[216:219]
s_add_u32 s28, s28, 7168
v_mul_f32 v183, v183, v25
v_mul_f32 v187, v187, v26
v_mfma_f32_16x16x32_bf16 v[220:223], a[240:243], a[12:15], v[220:223]
s_waitcnt lgkmcnt(1)
v_mul_f32 v191, v191, v27
v_cvt_pk_bf16_f32 v126, v179, v183
v_mfma_f32_16x16x32_bf16 v[224:227], a[244:247], a[208:211], v[224:227]
s_addc_u32 s29, s29, 0
ds_read_b128 a[252:255], v15 offset:55296
v_cvt_pk_bf16_f32 v127, v187, v191
v_mfma_f32_16x16x32_bf16 v[228:231], a[244:247], a[212:215], v[228:231]
buffer_store_dwordx2 v[126:127], v18, s[28:31], 0 offen nt
v_mfma_f32_16x16x32_bf16 v[232:235], a[244:247], a[216:219], v[232:235]
v_mfma_f32_16x16x32_bf16 v[236:239], a[244:247], a[220:223], v[236:239]
s_waitcnt lgkmcnt(1)
v_mul_f32 v192, v192, v24
v_mul_f32 v196, v196, v25
v_mfma_f32_16x16x32_bf16 v[240:243], a[248:251], a[112:115], v[240:243]
s_add_u32 s28, s28, 93184
ds_read_b128 a[240:243], v15 offset:57344
v_mul_f32 v200, v200, v26
v_mfma_f32_16x16x32_bf16 v[244:247], a[248:251], a[116:119], v[244:247]
s_addc_u32 s29, s29, 0
v_mul_f32 v204, v204, v27
v_cvt_pk_bf16_f32 v120, v192, v196
v_mfma_f32_16x16x32_bf16 v[248:251], a[248:251], a[120:123], v[248:251]
v_cvt_pk_bf16_f32 v121, v200, v204
v_mfma_f32_16x16x32_bf16 v[252:255], a[248:251], a[124:127], v[252:255]
s_waitcnt lgkmcnt(1)
v_mfma_f32_16x16x32_bf16 v[208:211], a[252:255], a[16:19], v[208:211]
ds_read_b128 a[244:247], v14 offset:61440
v_mfma_f32_16x16x32_bf16 v[212:215], a[252:255], a[20:23], v[212:215]
buffer_store_dwordx2 v[120:121], v18, s[28:31], 0 offen nt
v_mul_f32 v193, v193, v24
v_mfma_f32_16x16x32_bf16 v[216:219], a[252:255], a[24:27], v[216:219]
s_add_u32 s28, s28, 7168
v_mul_f32 v197, v197, v25
v_mul_f32 v201, v201, v26
v_mfma_f32_16x16x32_bf16 v[220:223], a[252:255], a[28:31], v[220:223]
s_waitcnt lgkmcnt(1)
v_mul_f32 v205, v205, v27
v_cvt_pk_bf16_f32 v122, v193, v197
v_mfma_f32_16x16x32_bf16 v[224:227], a[240:243], a[224:227], v[224:227]
s_addc_u32 s29, s29, 0
ds_read_b128 a[248:251], v15 offset:18432
v_cvt_pk_bf16_f32 v123, v201, v205
v_mfma_f32_16x16x32_bf16 v[228:231], a[240:243], a[228:231], v[228:231]
buffer_store_dwordx2 v[122:123], v18, s[28:31], 0 offen nt
v_mul_f32 v194, v194, v24
v_mfma_f32_16x16x32_bf16 v[232:235], a[240:243], a[232:235], v[232:235]
s_add_u32 s28, s28, 7168
v_mul_f32 v198, v198, v25
v_mul_f32 v202, v202, v26
v_mfma_f32_16x16x32_bf16 v[236:239], a[240:243], a[236:239], v[236:239]
s_waitcnt lgkmcnt(1)
v_mul_f32 v206, v206, v27
v_cvt_pk_bf16_f32 v124, v194, v198
v_mfma_f32_16x16x32_bf16 v[224:227], a[244:247], a[0:3], v[224:227]
s_addc_u32 s29, s29, 0
ds_read_b128 a[252:255], v15 offset:61440
v_cvt_pk_bf16_f32 v125, v202, v206
v_mfma_f32_16x16x32_bf16 v[228:231], a[244:247], a[4:7], v[228:231]
buffer_store_dwordx2 v[124:125], v18, s[28:31], 0 offen nt
v_mul_f32 v195, v195, v24
v_mfma_f32_16x16x32_bf16 v[232:235], a[244:247], a[8:11], v[232:235]
s_add_u32 s28, s28, 7168
v_mul_f32 v199, v199, v25
v_mul_f32 v203, v203, v26
v_mfma_f32_16x16x32_bf16 v[236:239], a[244:247], a[12:15], v[236:239]
s_waitcnt lgkmcnt(1)
v_mul_f32 v207, v207, v27
v_cvt_pk_bf16_f32 v126, v195, v199
v_mfma_f32_16x16x32_bf16 v[240:243], a[248:251], a[128:131], v[240:243]
s_addc_u32 s29, s29, 0
ds_read_b128 a[240:243], v14 offset:38912
v_cvt_pk_bf16_f32 v127, v203, v207
v_mfma_f32_16x16x32_bf16 v[244:247], a[248:251], a[132:135], v[244:247]
buffer_store_dwordx2 v[126:127], v18, s[28:31], 0 offen nt
v_mul_f32 v208, v208, v24
v_mfma_f32_16x16x32_bf16 v[248:251], a[248:251], a[136:139], v[248:251]
s_add_u32 s28, s28, 93184
v_mul_f32 v212, v212, v25
v_mul_f32 v216, v216, v26
v_mfma_f32_16x16x32_bf16 v[252:255], a[248:251], a[140:143], v[252:255]
s_waitcnt lgkmcnt(1)
v_mul_f32 v220, v220, v27
v_cvt_pk_bf16_f32 v120, v208, v212
v_mfma_f32_16x16x32_bf16 v[224:227], a[252:255], a[16:19], v[224:227]
s_addc_u32 s29, s29, 0
ds_read_b128 a[244:247], v15 offset:38912
v_cvt_pk_bf16_f32 v121, v216, v220
v_mfma_f32_16x16x32_bf16 v[228:231], a[252:255], a[20:23], v[228:231]
buffer_store_dwordx2 v[120:121], v18, s[28:31], 0 offen nt
v_mul_f32 v209, v209, v24
v_mfma_f32_16x16x32_bf16 v[232:235], a[252:255], a[24:27], v[232:235]
s_add_u32 s28, s28, 7168
v_mul_f32 v213, v213, v25
v_mul_f32 v217, v217, v26
v_mfma_f32_16x16x32_bf16 v[236:239], a[252:255], a[28:31], v[236:239]
s_waitcnt lgkmcnt(1)
v_mul_f32 v221, v221, v27
v_cvt_pk_bf16_f32 v122, v209, v213
v_mfma_f32_16x16x32_bf16 v[240:243], a[240:243], a[144:147], v[240:243]
s_addc_u32 s29, s29, 0
ds_read_b128 a[248:251], v14 offset:51200
v_cvt_pk_bf16_f32 v123, v217, v221
v_mfma_f32_16x16x32_bf16 v[244:247], a[240:243], a[148:151], v[244:247]
buffer_store_dwordx2 v[122:123], v18, s[28:31], 0 offen nt
v_mul_f32 v210, v210, v24
v_mfma_f32_16x16x32_bf16 v[248:251], a[240:243], a[152:155], v[248:251]
s_add_u32 s28, s28, 7168
v_mul_f32 v214, v214, v25
v_mul_f32 v218, v218, v26
v_mfma_f32_16x16x32_bf16 v[252:255], a[240:243], a[156:159], v[252:255]
s_waitcnt lgkmcnt(1)
v_mul_f32 v222, v222, v27
v_cvt_pk_bf16_f32 v124, v210, v214
v_mfma_f32_16x16x32_bf16 v[240:243], a[244:247], a[160:163], v[240:243]
s_addc_u32 s29, s29, 0
ds_read_b128 a[252:255], v15 offset:51200
v_cvt_pk_bf16_f32 v125, v218, v222
v_mfma_f32_16x16x32_bf16 v[244:247], a[244:247], a[164:167], v[244:247]
buffer_store_dwordx2 v[124:125], v18, s[28:31], 0 offen nt
v_mul_f32 v211, v211, v24
v_mfma_f32_16x16x32_bf16 v[248:251], a[244:247], a[168:171], v[248:251]
s_add_u32 s28, s28, 7168
v_mul_f32 v215, v215, v25
v_mul_f32 v219, v219, v26
v_mfma_f32_16x16x32_bf16 v[252:255], a[244:247], a[172:175], v[252:255]
s_waitcnt lgkmcnt(1)
v_mul_f32 v223, v223, v27
v_cvt_pk_bf16_f32 v126, v211, v215
v_mfma_f32_16x16x32_bf16 v[240:243], a[248:251], a[176:179], v[240:243]
s_addc_u32 s29, s29, 0
ds_read_b128 a[240:243], v14 offset:59392
v_cvt_pk_bf16_f32 v127, v219, v223
v_mfma_f32_16x16x32_bf16 v[244:247], a[248:251], a[180:183], v[244:247]
buffer_store_dwordx2 v[126:127], v18, s[28:31], 0 offen nt
v_mul_f32 v224, v224, v24
v_mfma_f32_16x16x32_bf16 v[248:251], a[248:251], a[184:187], v[248:251]
s_add_u32 s28, s28, 93184
v_mul_f32 v228, v228, v25
v_mul_f32 v232, v232, v26
v_mfma_f32_16x16x32_bf16 v[252:255], a[248:251], a[188:191], v[252:255]
s_waitcnt lgkmcnt(1)
v_mul_f32 v236, v236, v27
v_cvt_pk_bf16_f32 v120, v224, v228
v_mfma_f32_16x16x32_bf16 v[240:243], a[252:255], a[192:195], v[240:243]
s_addc_u32 s29, s29, 0
ds_read_b128 a[244:247], v15 offset:59392
v_cvt_pk_bf16_f32 v121, v232, v236
v_mfma_f32_16x16x32_bf16 v[244:247], a[252:255], a[196:199], v[244:247]
buffer_store_dwordx2 v[120:121], v18, s[28:31], 0 offen nt
v_mul_f32 v225, v225, v24
v_mfma_f32_16x16x32_bf16 v[248:251], a[252:255], a[200:203], v[248:251]
s_add_u32 s28, s28, 7168
v_mul_f32 v229, v229, v25
v_mul_f32 v233, v233, v26
v_mfma_f32_16x16x32_bf16 v[252:255], a[252:255], a[204:207], v[252:255]
s_waitcnt lgkmcnt(1)
v_mul_f32 v237, v237, v27
v_cvt_pk_bf16_f32 v122, v225, v229
v_mfma_f32_16x16x32_bf16 v[240:243], a[240:243], a[208:211], v[240:243]
s_addc_u32 s29, s29, 0
ds_read_b128 a[248:251], v14 offset:63488
v_cvt_pk_bf16_f32 v123, v233, v237
v_mfma_f32_16x16x32_bf16 v[244:247], a[240:243], a[212:215], v[244:247]
buffer_store_dwordx2 v[122:123], v18, s[28:31], 0 offen nt
v_mul_f32 v226, v226, v24
v_mfma_f32_16x16x32_bf16 v[248:251], a[240:243], a[216:219], v[248:251]
s_add_u32 s28, s28, 7168
v_mul_f32 v230, v230, v25
v_mul_f32 v234, v234, v26
v_mfma_f32_16x16x32_bf16 v[252:255], a[240:243], a[220:223], v[252:255]
s_waitcnt lgkmcnt(1)
v_mul_f32 v238, v238, v27
v_cvt_pk_bf16_f32 v124, v226, v230
v_mfma_f32_16x16x32_bf16 v[240:243], a[244:247], a[224:227], v[240:243]
s_addc_u32 s29, s29, 0
ds_read_b128 a[252:255], v15 offset:63488
v_cvt_pk_bf16_f32 v125, v234, v238
v_mfma_f32_16x16x32_bf16 v[244:247], a[244:247], a[228:231], v[244:247]
buffer_store_dwordx2 v[124:125], v18, s[28:31], 0 offen nt
v_mul_f32 v227, v227, v24
v_mfma_f32_16x16x32_bf16 v[248:251], a[244:247], a[232:235], v[248:251]
s_add_u32 s28, s28, 7168
v_mul_f32 v231, v231, v25
v_mul_f32 v235, v235, v26
v_mfma_f32_16x16x32_bf16 v[252:255], a[244:247], a[236:239], v[252:255]
s_waitcnt lgkmcnt(1)
v_mul_f32 v239, v239, v27
v_cvt_pk_bf16_f32 v126, v227, v231
v_mfma_f32_16x16x32_bf16 v[240:243], a[248:251], a[0:3], v[240:243]
s_addc_u32 s29, s29, 0
v_cvt_pk_bf16_f32 v127, v235, v239
v_mfma_f32_16x16x32_bf16 v[244:247], a[248:251], a[4:7], v[244:247]
buffer_store_dwordx2 v[126:127], v18, s[28:31], 0 offen nt
v_mfma_f32_16x16x32_bf16 v[248:251], a[248:251], a[8:11], v[248:251]
v_mfma_f32_16x16x32_bf16 v[252:255], a[248:251], a[12:15], v[252:255]
s_waitcnt lgkmcnt(0)
v_mfma_f32_16x16x32_bf16 v[240:243], a[252:255], a[16:19], v[240:243]
v_mfma_f32_16x16x32_bf16 v[244:247], a[252:255], a[20:23], v[244:247]
v_mfma_f32_16x16x32_bf16 v[248:251], a[252:255], a[24:27], v[248:251]
v_mfma_f32_16x16x32_bf16 v[252:255], a[252:255], a[28:31], v[252:255]
s_nop 7
v_pk_mul_f32 v[240:241], v[240:241], v[24:25] op_sel:[0,0] op_sel_hi:[1,0]
v_pk_mul_f32 v[244:245], v[244:245], v[24:25] op_sel:[0,1] op_sel_hi:[1,1]
v_pk_mul_f32 v[248:249], v[248:249], v[26:27] op_sel:[0,0] op_sel_hi:[1,0]
v_pk_mul_f32 v[252:253], v[252:253], v[26:27] op_sel:[0,1] op_sel_hi:[1,1]
v_cvt_pk_bf16_f32 v120, v240, v244
v_cvt_pk_bf16_f32 v121, v248, v252
s_add_u32 s28, s28, 93184
s_addc_u32 s29, s29, 0
buffer_store_dwordx2 v[120:121], v18, s[28:31], 0 offen nt
v_cvt_pk_bf16_f32 v122, v241, v245
v_cvt_pk_bf16_f32 v123, v249, v253
s_add_u32 s28, s28, 7168
s_addc_u32 s29, s29, 0
buffer_store_dwordx2 v[122:123], v18, s[28:31], 0 offen nt
v_pk_mul_f32 v[242:243], v[242:243], v[24:25] op_sel:[0,0] op_sel_hi:[1,0]
v_pk_mul_f32 v[246:247], v[246:247], v[24:25] op_sel:[0,1] op_sel_hi:[1,1]
v_pk_mul_f32 v[250:251], v[250:251], v[26:27] op_sel:[0,0] op_sel_hi:[1,0]
v_pk_mul_f32 v[254:255], v[254:255], v[26:27] op_sel:[0,1] op_sel_hi:[1,1]
v_cvt_pk_bf16_f32 v124, v242, v246
v_cvt_pk_bf16_f32 v125, v250, v254
s_add_u32 s28, s28, 7168
s_addc_u32 s29, s29, 0
buffer_store_dwordx2 v[124:125], v18, s[28:31], 0 offen nt
v_cvt_pk_bf16_f32 v126, v243, v247
v_cvt_pk_bf16_f32 v127, v251, v255
s_add_u32 s28, s28, 7168
s_addc_u32 s29, s29, 0
buffer_store_dwordx2 v[126:127], v18, s[28:31], 0 offen nt
s_endpgm
L_NOTAG:
buffer_load_dwordx2 v[22:23], off, s[80:83], 0 sc1
s_waitcnt vmcnt(0)
v_readfirstlane_b32 s88, v22
v_readfirstlane_b32 s89, v23
s_sub_u32 s90, s90, 1
s_nop 0
s_cmp_eq_u64 s[88:89], 0
s_cbranch_scc0 L_TAGOK
s_cmp_gt_i32 s90, 0
s_cbranch_scc1 L_NOTAG
s_mov_b32 s26, 0
s_mov_b32 s78, 0
s_mov_b64 s[88:89], 1
s_branch L_TAGOK
.p2align 6
L_PADS:
s_cbranch_vccnz L_PADRET
L_TRY:
s_waitcnt vmcnt(0)
v_cmp_ne_u64 s[50:51], s[88:89], v[122:123]
v_cmp_ne_u64 s[44:45], s[88:89], v[126:127]
s_sub_u32 s90, s90, 1
s_nop 0
s_or_b64 s[50:51], s[44:45], s[50:51]
s_cbranch_scc0 L_WRET
s_cmp_gt_i32 s90, 0
s_cbranch_scc0 L_SELF
L_WRET:
s_setpc_b64 s[100:101]
L_SLOW2:
s_lshr_b32 s91, s41, 6
s_add_u32 s91, s91, 0
s_lshl_b32 s47, s91, 11
buffer_load_dwordx4 v[120:123], v13, s[24:27], s47 offen offset:0 sc1
buffer_load_dwordx4 v[124:127], v13, s[24:27], s47 offen offset:1024 sc1
s_lshr_b32 s47, s41, 6
s_add_u32 s47, s47, 1
s_lshl_b32 s47, s47, 11
buffer_load_dwordx4 v[40:43], v13, s[24:27], s47 offen offset:0 sc1
buffer_load_dwordx4 v[44:47], v13, s[24:27], s47 offen offset:1024 sc1
s_lshr_b32 s47, s42, 6
s_add_u32 s47, s47, 0
s_lshl_b32 s47, s47, 11
buffer_load_dwordx4 v[48:51], v13, s[24:27], s47 offen offset:0 sc1
buffer_load_dwordx4 v[52:55], v13, s[24:27], s47 offen offset:1024 sc1
s_call_b64 s[100:101], L_TRY
s_cbranch_scc1 L_SLOW2
v_mov_b64 v[32:33], v[120:121]
v_mov_b64 v[36:37], v[124:125]
s_branch L_BACK2
L_SLOW3:
s_lshr_b32 s91, s41, 6
s_add_u32 s91, s91, 1
s_lshl_b32 s47, s91, 11
buffer_load_dwordx4 v[120:123], v13, s[24:27], s47 offen offset:0 sc1
buffer_load_dwordx4 v[124:127], v13, s[24:27], s47 offen offset:1024 sc1
s_lshr_b32 s47, s42, 6
s_add_u32 s47, s47, 0
s_lshl_b32 s47, s47, 11
buffer_load_dwordx4 v[48:51], v13, s[24:27], s47 offen offset:0 sc1
buffer_load_dwordx4 v[52:55], v13, s[24:27], s47 offen offset:1024 sc1
s_lshr_b32 s47, s42, 6
s_add_u32 s47, s47, 1
s_lshl_b32 s47, s47, 11
buffer_load_dwordx4 v[96:99], v13, s[24:27], s47 offen offset:0 sc1
buffer_load_dwordx4 v[100:103], v13, s[24:27], s47 offen offset:1024 sc1
s_call_b64 s[100:101], L_TRY
s_cbranch_scc1 L_SLOW3
v_mov_b64 v[40:41], v[120:121]
v_mov_b64 v[44:45], v[124:125]
s_branch L_BACK3
L_SLOW4:
s_lshr_b32 s91, s42, 6
s_add_u32 s91, s91, 0
s_lshl_b32 s47, s91, 11
buffer_load_dwordx4 v[120:123], v13, s[24:27], s47 offen offset:0 sc1
buffer_load_dwordx4 v[124:127], v13, s[24:27], s47 offen offset:1024 sc1
s_lshr_b32 s47, s42, 6
s_add_u32 s47, s47, 1
s_lshl_b32 s47, s47, 11
buffer_load_dwordx4 v[96:99], v13, s[24:27], s47 offen offset:0 sc1
buffer_load_dwordx4 v[100:103], v13, s[24:27], s47 offen offset:1024 sc1
s_lshr_b32 s47, s43, 6
s_add_u32 s47, s47, 0
s_lshl_b32 s47, s47, 11
buffer_load_dwordx4 v[80:83], v13, s[24:27], s47 offen offset:0 sc1
buffer_load_dwordx4 v[84:87], v13, s[24:27], s47 offen offset:1024 sc1
s_call_b64 s[100:101], L_TRY
s_cbranch_scc1 L_SLOW4
v_mov_b64 v[48:49], v[120:121]
v_mov_b64 v[52:53], v[124:125]
s_branch L_BACK4
L_SLOW5:
s_lshr_b32 s91, s42, 6
s_add_u32 s91, s91, 1
s_lshl_b32 s47, s91, 11
buffer_load_dwordx4 v[120:123], v13, s[24:27], s47 offen offset:0 sc1
buffer_load_dwordx4 v[124:127], v13, s[24:27], s47 offen offset:1024 sc1
s_lshr_b32 s47, s43, 6
s_add_u32 s47, s47, 0
s_lshl_b32 s47, s47, 11
buffer_load_dwordx4 v[80:83], v13, s[24:27], s47 offen offset:0 sc1
buffer_load_dwordx4 v[84:87], v13, s[24:27], s47 offen offset:1024 sc1
s_lshr_b32 s47, s43, 6
s_add_u32 s47, s47, 1
s_lshl_b32 s47, s47, 11
buffer_load_dwordx4 v[88:91], v13, s[24:27], s47 offen offset:0 sc1
buffer_load_dwordx4 v[92:95], v13, s[24:27], s47 offen offset:1024 sc1
s_call_b64 s[100:101], L_TRY
s_cbranch_scc1 L_SLOW5
v_mov_b64 v[96:97], v[120:121]
v_mov_b64 v[100:101], v[124:125]
s_branch L_BACK5
L_SLOW6:
s_lshr_b32 s91, s43, 6
s_add_u32 s91, s91, 0
s_lshl_b32 s47, s91, 11
buffer_load_dwordx4 v[120:123], v13, s[24:27], s47 offen offset:0 sc1
buffer_load_dwordx4 v[124:127], v13, s[24:27], s47 offen offset:1024 sc1
s_lshr_b32 s47, s43, 6
s_add_u32 s47, s47, 1
s_lshl_b32 s47, s47, 11
buffer_load_dwordx4 v[88:91], v13, s[24:27], s47 offen offset:0 sc1
buffer_load_dwordx4 v[92:95], v13, s[24:27], s47 offen offset:1024 sc1
s_movk_i32 s47, 8
s_lshl_b32 s47, s47, 11
buffer_load_dwordx4 v[32:35], v13, s[24:27], s47 offen offset:0 sc1
buffer_load_dwordx4 v[36:39], v13, s[24:27], s47 offen offset:1024 sc1
s_call_b64 s[100:101], L_TRY
s_cbranch_scc1 L_SLOW6
v_mov_b64 v[80:81], v[120:121]
v_mov_b64 v[84:85], v[124:125]
s_branch L_BACK6
L_SLOW7:
s_lshr_b32 s91, s43, 6
s_add_u32 s91, s91, 1
s_lshl_b32 s47, s91, 11
buffer_load_dwordx4 v[120:123], v13, s[24:27], s47 offen offset:0 sc1
buffer_load_dwordx4 v[124:127], v13, s[24:27], s47 offen offset:1024 sc1
s_movk_i32 s47, 8
s_lshl_b32 s47, s47, 11
buffer_load_dwordx4 v[32:35], v13, s[24:27], s47 offen offset:0 sc1
buffer_load_dwordx4 v[36:39], v13, s[24:27], s47 offen offset:1024 sc1
s_movk_i32 s47, 9
s_lshl_b32 s47, s47, 11
buffer_load_dwordx4 v[40:43], v13, s[24:27], s47 offen offset:0 sc1
buffer_load_dwordx4 v[44:47], v13, s[24:27], s47 offen offset:1024 sc1
s_call_b64 s[100:101], L_TRY
s_cbranch_scc1 L_SLOW7
v_mov_b64 v[88:89], v[120:121]
v_mov_b64 v[92:93], v[124:125]
s_branch L_BACK7
L_SLOW8:
s_movk_i32 s91, 8
s_lshl_b32 s47, s91, 11
buffer_load_dwordx4 v[120:123], v13, s[24:27], s47 offen offset:0 sc1
buffer_load_dwordx4 v[124:127], v13, s[24:27], s47 offen offset:1024 sc1
s_movk_i32 s47, 9
s_lshl_b32 s47, s47, 11
buffer_load_dwordx4 v[40:43], v13, s[24:27], s47 offen offset:0 sc1
buffer_load_dwordx4 v[44:47], v13, s[24:27], s47 offen offset:1024 sc1
s_movk_i32 s47, 10
s_lshl_b32 s47, s47, 11
buffer_load_dwordx4 v[48:51], v13, s[24:27], s47 offen offset:0 sc1
buffer_load_dwordx4 v[52:55], v13, s[24:27], s47 offen offset:1024 sc1
s_call_b64 s[100:101], L_TRY
s_cbranch_scc1 L_SLOW8
v_mov_b64 v[32:33], v[120:121]
v_mov_b64 v[36:37], v[124:125]
s_branch L_BACK8
L_SLOW9:
s_movk_i32 s91, 9
s_lshl_b32 s47, s91, 11
buffer_load_dwordx4 v[120:123], v13, s[24:27], s47 offen offset:0 sc1
buffer_load_dwordx4 v[124:127], v13, s[24:27], s47 offen offset:1024 sc1
s_movk_i32 s47, 10
s_lshl_b32 s47, s47, 11
buffer_load_dwordx4 v[48:51], v13, s[24:27], s47 offen offset:0 sc1
buffer_load_dwordx4 v[52:55], v13, s[24:27], s47 offen offset:1024 sc1
s_movk_i32 s47, 11
s_lshl_b32 s47, s47, 11
buffer_load_dwordx4 v[96:99], v13, s[24:27], s47 offen offset:0 sc1
buffer_load_dwordx4 v[100:103], v13, s[24:27], s47 offen offset:1024 sc1
s_call_b64 s[100:101], L_TRY
s_cbranch_scc1 L_SLOW9
v_mov_b64 v[40:41], v[120:121]
v_mov_b64 v[44:45], v[124:125]
s_branch L_BACK9
L_SLOW10:
s_movk_i32 s91, 10
s_lshl_b32 s47, s91, 11
buffer_load_dwordx4 v[120:123], v13, s[24:27], s47 offen offset:0 sc1
buffer_load_dwordx4 v[124:127], v13, s[24:27], s47 offen offset:1024 sc1
s_movk_i32 s47, 11
s_lshl_b32 s47, s47, 11
buffer_load_dwordx4 v[96:99], v13, s[24:27], s47 offen offset:0 sc1
buffer_load_dwordx4 v[100:103], v13, s[24:27], s47 offen offset:1024 sc1
s_movk_i32 s47, 12
s_lshl_b32 s47, s47, 11
buffer_load_dwordx4 v[80:83], v13, s[24:27], s47 offen offset:0 sc1
buffer_load_dwordx4 v[84:87], v13, s[24:27], s47 offen offset:1024 sc1
s_call_b64 s[100:101], L_TRY
s_cbranch_scc1 L_SLOW10
v_mov_b64 v[48:49], v[120:121]
v_mov_b64 v[52:53], v[124:125]
s_branch L_BACK10
L_SLOW11:
s_movk_i32 s91, 11
s_lshl_b32 s47, s91, 11
buffer_load_dwordx4 v[120:123], v13, s[24:27], s47 offen offset:0 sc1
buffer_load_dwordx4 v[124:127], v13, s[24:27], s47 offen offset:1024 sc1
s_movk_i32 s47, 12
s_lshl_b32 s47, s47, 11
buffer_load_dwordx4 v[80:83], v13, s[24:27], s47 offen offset:0 sc1
buffer_load_dwordx4 v[84:87], v13, s[24:27], s47 offen offset:1024 sc1
s_movk_i32 s47, 13
s_lshl_b32 s47, s47, 11
buffer_load_dwordx4 v[88:91], v13, s[24:27], s47 offen offset:0 sc1
buffer_load_dwordx4 v[92:95], v13, s[24:27], s47 offen offset:1024 sc1
s_call_b64 s[100:101], L_TRY
s_cbranch_scc1 L_SLOW11
v_mov_b64 v[96:97], v[120:121]
v_mov_b64 v[100:101], v[124:125]
s_branch L_BACK11
L_SLOW12:
s_movk_i32 s91, 12
s_lshl_b32 s47, s91, 11
buffer_load_dwordx4 v[120:123], v13, s[24:27], s47 offen offset:0 sc1
buffer_load_dwordx4 v[124:127], v13, s[24:27], s47 offen offset:1024 sc1
s_movk_i32 s47, 13
s_lshl_b32 s47, s47, 11
buffer_load_dwordx4 v[88:91], v13, s[24:27], s47 offen offset:0 sc1
buffer_load_dwordx4 v[92:95], v13, s[24:27], s47 offen offset:1024 sc1
s_movk_i32 s47, 14
s_lshl_b32 s47, s47, 11
buffer_load_dwordx4 v[32:35], v13, s[24:27], s47 offen offset:0 sc1
buffer_load_dwordx4 v[36:39], v13, s[24:27], s47 offen offset:1024 sc1
s_call_b64 s[100:101], L_TRY
s_cbranch_scc1 L_SLOW12
v_mov_b64 v[80:81], v[120:121]
v_mov_b64 v[84:85], v[124:125]
s_branch L_BACK12
L_SLOW13:
s_movk_i32 s91, 13
s_lshl_b32 s47, s91, 11
buffer_load_dwordx4 v[120:123], v13, s[24:27], s47 offen offset:0 sc1
buffer_load_dwordx4 v[124:127], v13, s[24:27], s47 offen offset:1024 sc1
s_movk_i32 s47, 14
s_lshl_b32 s47, s47, 11
buffer_load_dwordx4 v[32:35], v13, s[24:27], s47 offen offset:0 sc1
buffer_load_dwordx4 v[36:39], v13, s[24:27], s47 offen offset:1024 sc1
s_movk_i32 s47, 15
s_lshl_b32 s47, s47, 11
buffer_load_dwordx4 v[40:43], v13, s[24:27], s47 offen offset:0 sc1
buffer_load_dwordx4 v[44:47], v13, s[24:27], s47 offen offset:1024 sc1
s_call_b64 s[100:101], L_TRY
s_cbranch_scc1 L_SLOW13
v_mov_b64 v[88:89], v[120:121]
v_mov_b64 v[92:93], v[124:125]
s_branch L_BACK13
L_SLOW14:
s_movk_i32 s91, 14
s_lshl_b32 s47, s91, 11
buffer_load_dwordx4 v[120:123], v13, s[24:27], s47 offen offset:0 sc1
buffer_load_dwordx4 v[124:127], v13, s[24:27], s47 offen offset:1024 sc1
s_movk_i32 s47, 15
s_lshl_b32 s47, s47, 11
buffer_load_dwordx4 v[40:43], v13, s[24:27], s47 offen offset:0 sc1
buffer_load_dwordx4 v[44:47], v13, s[24:27], s47 offen offset:1024 sc1
s_movk_i32 s47, 16
s_lshl_b32 s47, s47, 11
buffer_load_dwordx4 v[48:51], v13, s[24:27], s47 offen offset:0 sc1
buffer_load_dwordx4 v[52:55], v13, s[24:27], s47 offen offset:1024 sc1
s_call_b64 s[100:101], L_TRY
s_cbranch_scc1 L_SLOW14
v_mov_b64 v[32:33], v[120:121]
v_mov_b64 v[36:37], v[124:125]
s_branch L_BACK14
L_SLOW15:
s_movk_i32 s91, 15
s_lshl_b32 s47, s91, 11
buffer_load_dwordx4 v[120:123], v13, s[24:27], s47 offen offset:0 sc1
buffer_load_dwordx4 v[124:127], v13, s[24:27], s47 offen offset:1024 sc1
s_movk_i32 s47, 16
s_lshl_b32 s47, s47, 11
buffer_load_dwordx4 v[48:51], v13, s[24:27], s47 offen offset:0 sc1
buffer_load_dwordx4 v[52:55], v13, s[24:27], s47 offen offset:1024 sc1
s_movk_i32 s47, 17
s_lshl_b32 s47, s47, 11
buffer_load_dwordx4 v[96:99], v13, s[24:27], s47 offen offset:0 sc1
buffer_load_dwordx4 v[100:103], v13, s[24:27], s47 offen offset:1024 sc1
s_call_b64 s[100:101], L_TRY
s_cbranch_scc1 L_SLOW15
v_mov_b64 v[40:41], v[120:121]
v_mov_b64 v[44:45], v[124:125]
s_branch L_BACK15
L_SLOW16:
s_movk_i32 s91, 16
s_lshl_b32 s47, s91, 11
buffer_load_dwordx4 v[120:123], v13, s[24:27], s47 offen offset:0 sc1
buffer_load_dwordx4 v[124:127], v13, s[24:27], s47 offen offset:1024 sc1
s_movk_i32 s47, 17
s_lshl_b32 s47, s47, 11
buffer_load_dwordx4 v[96:99], v13, s[24:27], s47 offen offset:0 sc1
buffer_load_dwordx4 v[100:103], v13, s[24:27], s47 offen offset:1024 sc1
s_movk_i32 s47, 18
s_lshl_b32 s47, s47, 11
buffer_load_dwordx4 v[80:83], v13, s[24:27], s47 offen offset:0 sc1
buffer_load_dwordx4 v[84:87], v13, s[24:27], s47 offen offset:1024 sc1
s_call_b64 s[100:101], L_TRY
s_cbranch_scc1 L_SLOW16
v_mov_b64 v[48:49], v[120:121]
v_mov_b64 v[52:53], v[124:125]
s_branch L_BACK16
L_SLOW17:
s_movk_i32 s91, 17
s_lshl_b32 s47, s91, 11
buffer_load_dwordx4 v[120:123], v13, s[24:27], s47 offen offset:0 sc1
buffer_load_dwordx4 v[124:127], v13, s[24:27], s47 offen offset:1024 sc1
s_movk_i32 s47, 18
s_lshl_b32 s47, s47, 11
buffer_load_dwordx4 v[80:83], v13, s[24:27], s47 offen offset:0 sc1
buffer_load_dwordx4 v[84:87], v13, s[24:27], s47 offen offset:1024 sc1
s_movk_i32 s47, 19
s_lshl_b32 s47, s47, 11
buffer_load_dwordx4 v[88:91], v13, s[24:27], s47 offen offset:0 sc1
buffer_load_dwordx4 v[92:95], v13, s[24:27], s47 offen offset:1024 sc1
s_call_b64 s[100:101], L_TRY
s_cbranch_scc1 L_SLOW17
v_mov_b64 v[96:97], v[120:121]
v_mov_b64 v[100:101], v[124:125]
s_branch L_BACK17
L_SLOW18:
s_movk_i32 s91, 18
s_lshl_b32 s47, s91, 11
buffer_load_dwordx4 v[120:123], v13, s[24:27], s47 offen offset:0 sc1
buffer_load_dwordx4 v[124:127], v13, s[24:27], s47 offen offset:1024 sc1
s_movk_i32 s47, 19
s_lshl_b32 s47, s47, 11
buffer_load_dwordx4 v[88:91], v13, s[24:27], s47 offen offset:0 sc1
buffer_load_dwordx4 v[92:95], v13, s[24:27], s47 offen offset:1024 sc1
s_movk_i32 s47, 20
s_lshl_b32 s47, s47, 11
buffer_load_dwordx4 v[32:35], v13, s[24:27], s47 offen offset:0 sc1
buffer_load_dwordx4 v[36:39], v13, s[24:27], s47 offen offset:1024 sc1
s_call_b64 s[100:101], L_TRY
s_cbranch_scc1 L_SLOW18
v_mov_b64 v[80:81], v[120:121]
v_mov_b64 v[84:85], v[124:125]
s_branch L_BACK18
L_SLOW19:
s_movk_i32 s91, 19
s_lshl_b32 s47, s91, 11
buffer_load_dwordx4 v[120:123], v13, s[24:27], s47 offen offset:0 sc1
buffer_load_dwordx4 v[124:127], v13, s[24:27], s47 offen offset:1024 sc1
s_movk_i32 s47, 20
s_lshl_b32 s47, s47, 11
buffer_load_dwordx4 v[32:35], v13, s[24:27], s47 offen offset:0 sc1
buffer_load_dwordx4 v[36:39], v13, s[24:27], s47 offen offset:1024 sc1
s_movk_i32 s47, 21
s_lshl_b32 s47, s47, 11
buffer_load_dwordx4 v[40:43], v13, s[24:27], s47 offen offset:0 sc1
buffer_load_dwordx4 v[44:47], v13, s[24:27], s47 offen offset:1024 sc1
s_call_b64 s[100:101], L_TRY
s_cbranch_scc1 L_SLOW19
v_mov_b64 v[88:89], v[120:121]
v_mov_b64 v[92:93], v[124:125]
s_branch L_BACK19
L_SLOW20:
s_movk_i32 s91, 20
s_lshl_b32 s47, s91, 11
buffer_load_dwordx4 v[120:123], v13, s[24:27], s47 offen offset:0 sc1
buffer_load_dwordx4 v[124:127], v13, s[24:27], s47 offen offset:1024 sc1
s_movk_i32 s47, 21
s_lshl_b32 s47, s47, 11
buffer_load_dwordx4 v[40:43], v13, s[24:27], s47 offen offset:0 sc1
buffer_load_dwordx4 v[44:47], v13, s[24:27], s47 offen offset:1024 sc1
s_movk_i32 s47, 22
s_lshl_b32 s47, s47, 11
buffer_load_dwordx4 v[48:51], v13, s[24:27], s47 offen offset:0 sc1
buffer_load_dwordx4 v[52:55], v13, s[24:27], s47 offen offset:1024 sc1
s_call_b64 s[100:101], L_TRY
s_cbranch_scc1 L_SLOW20
v_mov_b64 v[32:33], v[120:121]
v_mov_b64 v[36:37], v[124:125]
s_branch L_BACK20
L_SLOW21:
s_movk_i32 s91, 21
s_lshl_b32 s47, s91, 11
buffer_load_dwordx4 v[120:123], v13, s[24:27], s47 offen offset:0 sc1
buffer_load_dwordx4 v[124:127], v13, s[24:27], s47 offen offset:1024 sc1
s_movk_i32 s47, 22
s_lshl_b32 s47, s47, 11
buffer_load_dwordx4 v[48:51], v13, s[24:27], s47 offen offset:0 sc1
buffer_load_dwordx4 v[52:55], v13, s[24:27], s47 offen offset:1024 sc1
s_movk_i32 s47, 23
s_lshl_b32 s47, s47, 11
buffer_load_dwordx4 v[96:99], v13, s[24:27], s47 offen offset:0 sc1
buffer_load_dwordx4 v[100:103], v13, s[24:27], s47 offen offset:1024 sc1
s_call_b64 s[100:101], L_TRY
s_cbranch_scc1 L_SLOW21
v_mov_b64 v[40:41], v[120:121]
v_mov_b64 v[44:45], v[124:125]
s_branch L_BACK21
L_SLOW22:
s_movk_i32 s91, 22
s_lshl_b32 s47, s91, 11
buffer_load_dwordx4 v[120:123], v13, s[24:27], s47 offen offset:0 sc1
buffer_load_dwordx4 v[124:127], v13, s[24:27], s47 offen offset:1024 sc1
s_movk_i32 s47, 23
s_lshl_b32 s47, s47, 11
buffer_load_dwordx4 v[96:99], v13, s[24:27], s47 offen offset:0 sc1
buffer_load_dwordx4 v[100:103], v13, s[24:27], s47 offen offset:1024 sc1
s_movk_i32 s47, 24
s_lshl_b32 s47, s47, 11
buffer_load_dwordx4 v[80:83], v13, s[24:27], s47 offen offset:0 sc1
buffer_load_dwordx4 v[84:87], v13, s[24:27], s47 offen offset:1024 sc1
s_call_b64 s[100:101], L_TRY
s_cbranch_scc1 L_SLOW22
v_mov_b64 v[48:49], v[120:121]
v_mov_b64 v[52:53], v[124:125]
s_branch L_BACK22
L_SLOW23:
s_movk_i32 s91, 23
s_lshl_b32 s47, s91, 11
buffer_load_dwordx4 v[120:123], v13, s[24:27], s47 offen offset:0 sc1
buffer_load_dwordx4 v[124:127], v13, s[24:27], s47 offen offset:1024 sc1
s_movk_i32 s47, 24
s_lshl_b32 s47, s47, 11
buffer_load_dwordx4 v[80:83], v13, s[24:27], s47 offen offset:0 sc1
buffer_load_dwordx4 v[84:87], v13, s[24:27], s47 offen offset:1024 sc1
s_movk_i32 s47, 25
s_lshl_b32 s47, s47, 11
buffer_load_dwordx4 v[88:91], v13, s[24:27], s47 offen offset:0 sc1
buffer_load_dwordx4 v[92:95], v13, s[24:27], s47 offen offset:1024 sc1
s_call_b64 s[100:101], L_TRY
s_cbranch_scc1 L_SLOW23
v_mov_b64 v[96:97], v[120:121]
v_mov_b64 v[100:101], v[124:125]
s_branch L_BACK23
L_SLOW24:
s_movk_i32 s91, 24
s_lshl_b32 s47, s91, 11
buffer_load_dwordx4 v[120:123], v13, s[24:27], s47 offen offset:0 sc1
buffer_load_dwordx4 v[124:127], v13, s[24:27], s47 offen offset:1024 sc1
s_movk_i32 s47, 25
s_lshl_b32 s47, s47, 11
buffer_load_dwordx4 v[88:91], v13, s[24:27], s47 offen offset:0 sc1
buffer_load_dwordx4 v[92:95], v13, s[24:27], s47 offen offset:1024 sc1
s_movk_i32 s47, 26
s_lshl_b32 s47, s47, 11
buffer_load_dwordx4 v[32:35], v13, s[24:27], s47 offen offset:0 sc1
buffer_load_dwordx4 v[36:39], v13, s[24:27], s47 offen offset:1024 sc1
s_call_b64 s[100:101], L_TRY
s_cbranch_scc1 L_SLOW24
v_mov_b64 v[80:81], v[120:121]
v_mov_b64 v[84:85], v[124:125]
s_branch L_BACK24
L_SLOW25:
s_movk_i32 s91, 25
s_lshl_b32 s47, s91, 11
buffer_load_dwordx4 v[120:123], v13, s[24:27], s47 offen offset:0 sc1
buffer_load_dwordx4 v[124:127], v13, s[24:27], s47 offen offset:1024 sc1
s_movk_i32 s47, 26
s_lshl_b32 s47, s47, 11
buffer_load_dwordx4 v[32:35], v13, s[24:27], s47 offen offset:0 sc1
buffer_load_dwordx4 v[36:39], v13, s[24:27], s47 offen offset:1024 sc1
s_movk_i32 s47, 27
s_lshl_b32 s47, s47, 11
buffer_load_dwordx4 v[40:43], v13, s[24:27], s47 offen offset:0 sc1
buffer_load_dwordx4 v[44:47], v13, s[24:27], s47 offen offset:1024 sc1
s_call_b64 s[100:101], L_TRY
s_cbranch_scc1 L_SLOW25
v_mov_b64 v[88:89], v[120:121]
v_mov_b64 v[92:93], v[124:125]
s_branch L_BACK25
L_SLOW26:
s_movk_i32 s91, 26
s_lshl_b32 s47, s91, 11
buffer_load_dwordx4 v[120:123], v13, s[24:27], s47 offen offset:0 sc1
buffer_load_dwordx4 v[124:127], v13, s[24:27], s47 offen offset:1024 sc1
s_movk_i32 s47, 27
s_lshl_b32 s47, s47, 11
buffer_load_dwordx4 v[40:43], v13, s[24:27], s47 offen offset:0 sc1
buffer_load_dwordx4 v[44:47], v13, s[24:27], s47 offen offset:1024 sc1
s_movk_i32 s47, 28
s_lshl_b32 s47, s47, 11
buffer_load_dwordx4 v[48:51], v13, s[24:27], s47 offen offset:0 sc1
buffer_load_dwordx4 v[52:55], v13, s[24:27], s47 offen offset:1024 sc1
s_call_b64 s[100:101], L_TRY
s_cbranch_scc1 L_SLOW26
v_mov_b64 v[32:33], v[120:121]
v_mov_b64 v[36:37], v[124:125]
s_branch L_BACK26
L_SLOW27:
s_movk_i32 s91, 27
s_lshl_b32 s47, s91, 11
buffer_load_dwordx4 v[120:123], v13, s[24:27], s47 offen offset:0 sc1
buffer_load_dwordx4 v[124:127], v13, s[24:27], s47 offen offset:1024 sc1
s_movk_i32 s47, 28
s_lshl_b32 s47, s47, 11
buffer_load_dwordx4 v[48:51], v13, s[24:27], s47 offen offset:0 sc1
buffer_load_dwordx4 v[52:55], v13, s[24:27], s47 offen offset:1024 sc1
s_movk_i32 s47, 29
s_lshl_b32 s47, s47, 11
buffer_load_dwordx4 v[96:99], v13, s[24:27], s47 offen offset:0 sc1
buffer_load_dwordx4 v[100:103], v13, s[24:27], s47 offen offset:1024 sc1
s_call_b64 s[100:101], L_TRY
s_cbranch_scc1 L_SLOW27
v_mov_b64 v[40:41], v[120:121]
v_mov_b64 v[44:45], v[124:125]
s_branch L_BACK27
L_SLOW28:
s_movk_i32 s91, 28
s_lshl_b32 s47, s91, 11
buffer_load_dwordx4 v[120:123], v13, s[24:27], s47 offen offset:0 sc1
buffer_load_dwordx4 v[124:127], v13, s[24:27], s47 offen offset:1024 sc1
s_movk_i32 s47, 29
s_lshl_b32 s47, s47, 11
buffer_load_dwordx4 v[96:99], v13, s[24:27], s47 offen offset:0 sc1
buffer_load_dwordx4 v[100:103], v13, s[24:27], s47 offen offset:1024 sc1
s_movk_i32 s47, 30
s_lshl_b32 s47, s47, 11
buffer_load_dwordx4 v[80:83], v13, s[24:27], s47 offen offset:0 sc1
buffer_load_dwordx4 v[84:87], v13, s[24:27], s47 offen offset:1024 sc1
s_call_b64 s[100:101], L_TRY
s_cbranch_scc1 L_SLOW28
v_mov_b64 v[48:49], v[120:121]
v_mov_b64 v[52:53], v[124:125]
s_branch L_BACK28
L_SLOW29:
s_movk_i32 s91, 29
s_lshl_b32 s47, s91, 11
buffer_load_dwordx4 v[120:123], v13, s[24:27], s47 offen offset:0 sc1
buffer_load_dwordx4 v[124:127], v13, s[24:27], s47 offen offset:1024 sc1
s_movk_i32 s47, 30
s_lshl_b32 s47, s47, 11
buffer_load_dwordx4 v[80:83], v13, s[24:27], s47 offen offset:0 sc1
buffer_load_dwordx4 v[84:87], v13, s[24:27], s47 offen offset:1024 sc1
s_movk_i32 s47, 31
s_lshl_b32 s47, s47, 11
buffer_load_dwordx4 v[88:91], v13, s[24:27], s47 offen offset:0 sc1
buffer_load_dwordx4 v[92:95], v13, s[24:27], s47 offen offset:1024 sc1
s_call_b64 s[100:101], L_TRY
s_cbranch_scc1 L_SLOW29
v_mov_b64 v[96:97], v[120:121]
v_mov_b64 v[100:101], v[124:125]
s_branch L_BACK29
L_SLOW30:
s_movk_i32 s91, 30
s_lshl_b32 s47, s91, 11
buffer_load_dwordx4 v[120:123], v13, s[24:27], s47 offen offset:0 sc1
buffer_load_dwordx4 v[124:127], v13, s[24:27], s47 offen offset:1024 sc1
s_movk_i32 s47, 31
s_lshl_b32 s47, s47, 11
buffer_load_dwordx4 v[88:91], v13, s[24:27], s47 offen offset:0 sc1
buffer_load_dwordx4 v[92:95], v13, s[24:27], s47 offen offset:1024 sc1
s_call_b64 s[100:101], L_TRY
s_cbranch_scc1 L_SLOW30
v_mov_b64 v[80:81], v[120:121]
v_mov_b64 v[84:85], v[124:125]
s_branch L_BACK30
L_SLOW31:
s_movk_i32 s91, 31
s_lshl_b32 s47, s91, 11
buffer_load_dwordx4 v[120:123], v13, s[24:27], s47 offen offset:0 sc1
buffer_load_dwordx4 v[124:127], v13, s[24:27], s47 offen offset:1024 sc1
s_call_b64 s[100:101], L_TRY
s_cbranch_scc1 L_SLOW31
v_mov_b64 v[88:89], v[120:121]
v_mov_b64 v[92:93], v[124:125]
s_branch L_BACK31
L_SELF:
s_mul_i32 s47, s91, 458752
s_lshl_b32 s46, s39, 8
s_add_u32 s47, s47, s46
s_add_u32 s84, s6, s47
s_addc_u32 s85, s7, 0
s_mov_b32 s86, 387328
s_mov_b32 s87, 0x20000
buffer_load_dwordx4 v[64:67], v30, s[84:87], 0 offen
buffer_load_dwordx4 v[68:71], v30, s[84:87], s92 offen
buffer_load_dwordx4 v[72:75], v30, s[84:87], s93 offen
buffer_load_dwordx4 v[76:79], v30, s[84:87], s94 offen
s_waitcnt vmcnt(0)
v_lshl_add_u64 v[64:65], v[68:69], 4, v[64:65]
v_lshl_add_u64 v[66:67], v[70:71], 4, v[66:67]
v_lshl_add_u64 v[72:73], v[76:77], 4, v[72:73]
v_lshl_add_u64 v[74:75], v[78:79], 4, v[74:75]
v_lshl_or_b32 v76, v72, 8, v64
v_lshl_or_b32 v77, v73, 8, v65
v_lshl_or_b32 v78, v74, 8, v66
v_lshl_or_b32 v79, v75, 8, v67
v_lshl_or_b32 v120, v77, 16, v76
v_lshl_or_b32 v121, v79, 16, v78
s_add_u32 s84, s84, 57344
s_addc_u32 s85, s85, 0
buffer_load_dwordx4 v[64:67], v30, s[84:87], 0 offen
buffer_load_dwordx4 v[68:71], v30, s[84:87], s92 offen
buffer_load_dwordx4 v[72:75], v30, s[84:87], s93 offen
buffer_load_dwordx4 v[76:79], v30, s[84:87], s94 offen
s_waitcnt vmcnt(0)
v_lshl_add_u64 v[64:65], v[68:69], 4, v[64:65]
v_lshl_add_u64 v[66:67], v[70:71], 4, v[66:67]
v_lshl_add_u64 v[72:73], v[76:77], 4, v[72:73]
v_lshl_add_u64 v[74:75], v[78:79], 4, v[74:75]
v_lshl_or_b32 v76, v72, 8, v64
v_lshl_or_b32 v77, v73, 8, v65
v_lshl_or_b32 v78, v74, 8, v66
v_lshl_or_b32 v79, v75, 8, v67
v_lshl_or_b32 v124, v77, 16, v76
v_lshl_or_b32 v125, v79, 16, v78
s_cmp_eq_u32 s39, -1
s_setpc_b64 s[100:101]
L_END:
s_endpgm
.section .rodata,"a"
.p2align 6
.amdhsa_kernel standalone__normalfloat_lut_af4__prompt_kernel
  .amdhsa_next_free_vgpr 512
  .amdhsa_next_free_sgpr 102
  .amdhsa_accum_offset 256
  .amdhsa_group_segment_fixed_size 0
  .amdhsa_kernarg_size 56
  .amdhsa_user_sgpr_count 2
  .amdhsa_user_sgpr_kernarg_segment_ptr 1
  .amdhsa_system_sgpr_workgroup_id_x 1
.end_amdhsa_kernel
```

```asm
; @launch grid=(256,1,1) block=(256,1,1) lds=163840
.amdgcn_target "amdgcn-amd-amdhsa--gfx950"
.text
.globl standalone__normalfloat_lut_af4__prompt_kernel
.p2align 12
.p2align 8
.type standalone__normalfloat_lut_af4__prompt_kernel,@function
standalone__normalfloat_lut_af4__prompt_kernel:
s_load_dwordx4 s[4:7], s[0:1], 0
s_load_dwordx4 s[12:15], s[0:1], 40
s_load_dwordx4 s[8:11], s[0:1], 24
s_memrealtime s[56:57]
s_cmp_ge_u32 s2, 256
s_cbranch_scc1 L_END
s_getpc_b64 s[48:49]
L_PC0:
v_bfi_b32 v2, 7, v0, s2
v_lshlrev_b32 v2, 7, v2
v_min_u32 v2, L_END-L_PC0, v2
global_load_dword v7, v2, s[48:49]
v_lshrrev_b32 v1, 6, v0
s_cmp_lt_u32 s2, 32
v_readfirstlane_b32 s36, v1
s_cbranch_scc1 L_PACK
s_bfe_u32 s34, s2, 0x20001
s_bfe_u32 s37, s2, 0x20003
s_lshl2_add_u32 s37, s34, s37
s_and_b32 s43, s2, 1
s_mul_i32 s43, s43, 7
s_lshr_b32 s38, s2, 5
s_add_u32 s38, s38, s43
s_lshl2_add_u32 s39, s38, s36
s_sub_u32 s39, s39, 4
v_bfe_u32 v6, v0, 4, 2
v_and_b32 v3, 15, v0
v_mul_u32_u24 v2, 114688, v6
v_lshl_add_u32 v30, v3, 4, v2
s_lshr_b32 s46, s37, 1
s_and_b32 s45, s37, 1
s_lshl3_add_u32 s46, s46, s45
s_mul_i32 s46, s46, 57344
s_lshl_b32 s47, s39, 8
s_add_u32 s44, s46, s47
s_mov_b32 s18, 387328
s_mov_b32 s19, 0x20000
s_mov_b32 s92, 14336
s_mov_b32 s93, 28672
s_mov_b32 s94, 43008
s_waitcnt lgkmcnt(0)
s_add_u32 s16, s6, s44
s_addc_u32 s17, s7, 0
buffer_load_dwordx4 v[104:107], v30, s[16:19], 0 offen
buffer_load_dwordx4 v[108:111], v30, s[16:19], s92 offen
buffer_load_dwordx4 v[112:115], v30, s[16:19], s93 offen
buffer_load_dwordx4 v[116:119], v30, s[16:19], s94 offen
s_branch L_MAIN
L_PACK:
v_lshrrev_b32 v2, 2, v0
v_and_b32 v3, 3, v0
s_lshl_b32 s45, s2, 17
v_lshl_add_u32 v2, v2, 11, s45
v_lshl_add_u32 v17, v3, 7, v2
s_mov_b32 s30, 4194304
s_mov_b32 s31, 0x20000
v_lshlrev_b32 v16, 3, v0
s_cmp_lt_u32 s2, 2
s_cselect_b32 s34, 8, 0
s_mov_b32 s35, 0x20000
v_mov_b64 v[22:23], 0
s_waitcnt lgkmcnt(0)
s_mov_b64 s[32:33], s[12:13]
v_mov_b64 v[20:21], s[56:57]
buffer_atomic_cmpswap_x2 v[20:23], v16, s[32:35], 0 offen sc1
s_mov_b64 s[28:29], s[4:5]
buffer_load_dword v19, v17, s[28:31], 0 offen offset:0
s_branch L_PACK1
L_MAIN:
s_mov_b64 s[20:21], s[4:5]
s_mov_b32 s22, 4194304
s_mov_b32 s23, 0x20000
s_lshl_b32 s46, s37, 18
v_lshrrev_b32 v5, 3, v0
v_lshl_add_u32 v2, v5, 11, s46
v_lshrrev_b32 v4, 4, v0
v_xor_b32 v4, v4, v0
v_and_b32 v4, 7, v4
v_lshl_add_u32 v8, v4, 4, v2
v_add_u32 v9, 65536, v8
v_add_u32 v10, 131072, v8
v_add_u32 v11, 196608, v8
s_lshl_b32 s33, s36, 10
s_mul_i32 s47, s45, 114688
s_sub_u32 s47, s44, s47
s_add_u32 s47, s47, 57344
s_add_u32 s84, s6, s47
s_addc_u32 s85, s7, 0
s_mov_b32 s86, 387328
s_mov_b32 s87, 0x20000
s_lshl_b32 s40, s34, 7
s_add_u32 m0, s33, 65536
s_nop 0
buffer_load_dwordx4 v8, s[20:23], s40 offen lds
s_add_u32 m0, s33, 69632
s_nop 0
buffer_load_dwordx4 v9, s[20:23], s40 offen lds
s_add_u32 m0, s33, 73728
s_nop 0
buffer_load_dwordx4 v10, s[20:23], s40 offen lds
s_add_u32 m0, s33, 77824
s_nop 0
buffer_load_dwordx4 v11, s[20:23], s40 offen lds
v_mov_b32 v2, 0x3da3bf80
s_lshl_b64 exec, exec, 8
v_mov_b32 v2, 0x3e25bf32
s_lshl_b64 exec, exec, 8
v_mov_b32 v2, 0x3e7cbf06
s_lshl_b64 exec, exec, 8
v_mov_b32 v2, 0x3eadbeca
s_lshl_b64 exec, exec, 8
v_mov_b32 v2, 0x3ee2be92
s_lshl_b64 exec, exec, 8
v_mov_b32 v2, 0x3f10be3d
s_lshl_b64 exec, exec, 8
v_mov_b32 v2, 0x3f39bdba
s_lshl_b64 exec, exec, 8
v_mov_b32 v2, 0x3f800000
s_mov_b64 exec, -1
s_and_b32 s45, s36, 1
s_mul_i32 s45, s45, 0x0202
s_lshr_b32 s46, s36, 1
s_mul_i32 s46, s46, 0x02020000
s_add_u32 s45, s45, s46
s_add_u32 s45, s45, 0x05040100
v_mov_b32 v4, s45
v_lshlrev_b32 v5, 8, v5
v_and_b32 v31, 7, v0
v_lshl_add_u32 v31, v31, 4, v5
s_mov_b32 s45, 0xbf32bf80
v_perm_b32 v128, s45, v2, v4
v_mov_b32 v129, v128
v_mov_b64 v[130:131], v[128:129]
ds_write_b128 v31, v[128:131] offset:0
s_mov_b32 s45, 0xbecabf06
v_perm_b32 v132, s45, v2, v4
v_mov_b32 v133, v132
v_mov_b64 v[134:135], v[132:133]
v_and_b32 v5, 31, v0
v_lshlrev_b32 v19, 2, v5
v_and_b32 v0, 63, v0
s_lshl_b32 s46, s39, 7
ds_write_b128 v31, v[132:135] offset:8192
s_mov_b32 s45, 0xbe3dbe92
v_perm_b32 v136, s45, v2, v4
v_mov_b32 v137, v136
v_mov_b64 v[138:139], v[136:137]
v_lshl_add_u32 v28, v3, 3, s46
s_mul_i32 s47, s37, 917504
s_add_u32 s47, s47, s46
s_add_u32 s28, s10, s47
s_addc_u32 s29, s11, 0
ds_write_b128 v31, v[136:139] offset:16384
s_mov_b32 s45, 0xbdba
v_perm_b32 v140, s45, v2, v4
v_mov_b32 v141, v140
v_mov_b64 v[142:143], v[140:141]
s_mov_b32 s30, 86144
s_mov_b32 s31, 0x20000
v_mul_u32_u24 v29, 28672, v6
v_lshl_add_u32 v18, v3, 3, v29
ds_write_b128 v31, v[140:143] offset:24576
s_mov_b32 s45, 0x3e253da3
v_perm_b32 v144, s45, v2, v4
v_mov_b32 v145, v144
v_mov_b64 v[146:147], v[144:145]
v_lshlrev_b32 v29, 7, v3
v_bfe_u32 v5, v0, 1, 3
v_xor_b32 v5, v5, v6
v_lshl_add_u32 v29, v5, 4, v29
s_load_dwordx2 s[88:89], s[12:13], 0
ds_write_b128 v31, v[144:147] offset:32768
s_mov_b32 s45, 0x3ead3e7c
v_perm_b32 v148, s45, v2, v4
v_mov_b32 v149, v148
v_mov_b64 v[150:151], v[148:149]
v_add_u32 v14, 65536, v29
v_xor_b32 v15, 64, v14
v_add_u32 v16, 0x10000, v14
v_add_u32 v17, 0x10000, v15
ds_write_b128 v31, v[148:151] offset:40960
s_mov_b32 s45, 0x3f103ee2
v_perm_b32 v152, s45, v2, v4
v_mov_b32 v153, v152
v_mov_b64 v[154:155], v[152:153]
s_mov_b32 s52, 0x0c0c0400
s_mov_b32 s53, 0x0c0c0500
s_mov_b32 s54, 0x0c0c0600
s_mov_b32 s55, 0x0c0c0700
ds_write_b128 v31, v[152:155] offset:49152
s_mov_b32 s45, 0x3f803f39
v_perm_b32 v156, s45, v2, v4
v_mov_b32 v157, v156
v_mov_b64 v[158:159], v[156:157]
v_lshlrev_b32 v13, 4, v0
s_lshl_b32 s47, s39, 16
s_add_u32 s24, s14, s47
s_addc_u32 s25, s15, 0
s_lshl_b32 s47, s37, 10
ds_write_b128 v31, v[156:159] offset:57344
s_add_u32 s76, s24, s47
s_addc_u32 s77, s25, 0
s_movk_i32 s78, 1024
s_mov_b32 s79, 0x20000
s_lshl_b32 s47, s34, 3
s_lshr_b32 s47, 0x90d0b2d, s47
s_bfe_u32 s41, s47, 0x20000
s_lshl_b32 s41, s41, 7
s_bfe_u32 s42, s47, 0x20002
s_lshl_b32 s42, s42, 7
s_bfe_u32 s43, s47, 0x20004
s_lshl_b32 s43, s43, 7
s_lshl_b32 s47, s34, 1
s_lshr_b32 s47, 0x63, s47
s_and_b32 s47, s47, 3
s_sub_u32 s47, s47, s34
s_lshl1_add_u32 s3, s47, 14
s_mul_i32 s47, s3, 458752
s_add_u32 s16, s16, s47
s_addc_u32 s17, s17, 0
s_lshl_b32 s3, s3, 11
s_lshr_b32 s35, s37, 1
s_xor_b32 s35, s35, 1
v_lshl_add_u32 v12, s41, 5, v13
s_mul_i32 s47, s35, 458752
s_lshl_b32 s46, s39, 8
s_add_u32 s47, s47, s46
s_add_u32 s72, s6, s47
s_addc_u32 s73, s7, 0
s_mov_b32 s74, 444672
s_mov_b32 s75, 0x20000
v_add_u32 v31, 57344, v30
s_and_b32 s47, s37, 2
s_lshl_b32 s47, s47, 5
v_xor_b32 v2, s47, v14
v_xor_b32 v4, 64, v2
s_mov_b32 s26, 65536
s_mov_b32 s27, 0x20000
s_mov_b64 s[80:81], s[12:13]
s_movk_i32 s82, 128
s_mov_b32 s83, 0x20000
s_movk_i32 s90, 4096
buffer_load_dwordx4 v[64:67], v30, s[84:87], 0 offen
buffer_load_dwordx4 v[68:71], v30, s[84:87], s92 offen
buffer_load_dwordx4 v[72:75], v30, s[84:87], s93 offen
buffer_load_dwordx4 v[76:79], v30, s[84:87], s94 offen
s_mov_b64 vcc, -1
s_branch L_PAD0
L_PADRET0:
s_mov_b64 vcc, 0
s_waitcnt vmcnt(8)
v_lshl_add_u64 v[104:105], v[108:109], 4, v[104:105]
v_lshl_add_u64 v[106:107], v[110:111], 4, v[106:107]
v_lshl_add_u64 v[112:113], v[116:117], 4, v[112:113]
v_lshl_add_u64 v[114:115], v[118:119], 4, v[114:115]
v_lshl_or_b32 v116, v112, 8, v104
v_lshl_or_b32 v117, v113, 8, v105
v_lshl_or_b32 v118, v114, 8, v106
v_lshl_or_b32 v119, v115, 8, v107
v_lshl_or_b32 v108, v117, 16, v116
v_lshl_or_b32 v109, v119, 16, v118
s_waitcnt lgkmcnt(0)
s_cmp_eq_u64 s[88:89], 0
s_cbranch_scc1 L_NOTAG
L_TAGOK:
v_mov_b64 v[110:111], s[88:89]
buffer_store_dwordx4 v[108:111], v13, s[76:79], 0 offen sc1
s_add_u32 s76, s76, s3
s_addc_u32 s77, s77, 0
s_waitcnt lgkmcnt(0)
s_nop 0
s_branch L_STREAM
L_PACK1:
v_and_b32 v0, 63, v0
v_lshrrev_b32 v2, 4, v0
v_and_b32 v3, 15, v0
v_mul_u32_u24 v2, 114688, v2
v_lshl_add_u32 v8, v3, 4, v2
s_movk_i32 s47, 0x3800
v_add_u32 v9, s47, v8
v_add_u32 v10, s47, v9
v_add_u32 v11, s47, v10
v_add_u32 v12, s47, v11
v_add_u32 v13, s47, v12
v_add_u32 v14, s47, v13
v_add_u32 v15, s47, v14
s_sub_u32 s3, s2, 1
s_and_b32 s3, s3, 7
s_lshr_b32 s45, s2, 3
s_lshl2_add_u32 s3, s3, s45
s_mul_i32 s40, s3, 4682
s_lshr_b32 s40, s40, 16
s_mul_i32 s41, s40, 14
s_sub_u32 s41, s3, s41
s_add_u32 s40, s40, 8
s_mov_b32 s22, 14680064
s_mov_b32 s23, 0x20000
s_mov_b64 s[20:21], s[6:7]
s_cmp_ge_u32 s40, 14
s_cselect_b32 s45, 8, 0
s_add_u32 s45, s45, s40
s_lshl2_add_u32 s42, s41, s36
s_mul_i32 s43, s45, 458752
s_lshl_b32 s44, s42, 8
s_add_u32 s43, s43, s44
s_lshl_b32 s44, s42, 5
s_add_u32 s44, s44, s45
s_lshl_b32 s52, s44, 11
s_cmp_lt_u32 s45, 32
s_cselect_b32 s52, s52, 0x1000000
s_cselect_b32 s22, 14680064, 0
s_add_u32 s41, s41, 4
s_add_u32 s40, s40, 2
s_cmp_ge_u32 s41, 14
s_cselect_b32 s48, 14, 0
s_addc_u32 s40, s40, 0
s_sub_u32 s41, s41, s48
s_load_dwordx2 s[50:51], s[12:13], 0
buffer_load_dwordx4 v[32:35], v8, s[20:23], s43 offen
buffer_load_dwordx4 v[36:39], v9, s[20:23], s43 offen
buffer_load_dwordx4 v[40:43], v10, s[20:23], s43 offen
buffer_load_dwordx4 v[44:47], v11, s[20:23], s43 offen
buffer_load_dwordx4 v[48:51], v12, s[20:23], s43 offen
buffer_load_dwordx4 v[52:55], v13, s[20:23], s43 offen
buffer_load_dwordx4 v[56:59], v14, s[20:23], s43 offen
buffer_load_dwordx4 v[60:63], v15, s[20:23], s43 offen
s_mov_b64 s[24:25], s[14:15]
s_mov_b32 s26, 3670016
s_mov_b32 s27, 0x20000
s_movk_i32 s34, 128
v_mov_b32 v16, 0
v_lshlrev_b32 v18, 4, v0
s_movk_i32 s46, 4096
s_waitcnt vmcnt(4) lgkmcnt(0)
v_mov_b64 v[22:23], s[50:51]
s_nop 0
L_PKN:
v_cmp_ne_u64 vcc, 0, v[22:23]
s_sub_u32 s46, s46, 1
s_cmp_gt_i32 s46, 0
s_cbranch_vccnz L_PKGO
s_cbranch_scc0 L_END
buffer_load_dwordx2 v[22:23], v16, s[32:35], 0 offen sc1
s_waitcnt vmcnt(0)
s_branch L_PKN
L_PKGO:
s_call_b64 s[100:101], L_PK0
buffer_store_dwordx4 v[20:23], v18, s[24:27], s52 offen offset:0 sc1
s_waitcnt lgkmcnt(0)
s_call_b64 s[100:101], L_UNIT
s_mov_b32 s53, s49
buffer_load_dwordx4 v[64:67], v8, s[20:23], s43 offen
buffer_load_dwordx4 v[68:71], v9, s[20:23], s43 offen
buffer_load_dwordx4 v[72:75], v10, s[20:23], s43 offen
buffer_load_dwordx4 v[76:79], v11, s[20:23], s43 offen
s_waitcnt vmcnt(5)
s_call_b64 s[100:101], L_PK1
buffer_store_dwordx4 v[20:23], v18, s[24:27], s52 offen offset:1024 sc1
buffer_load_dwordx4 v[80:83], v12, s[20:23], s43 offen
buffer_load_dwordx4 v[84:87], v13, s[20:23], s43 offen
buffer_load_dwordx4 v[88:91], v14, s[20:23], s43 offen
buffer_load_dwordx4 v[92:95], v15, s[20:23], s43 offen
s_waitcnt vmcnt(5)
s_call_b64 s[100:101], L_PK2
buffer_store_dwordx4 v[20:23], v18, s[24:27], s53 offen offset:0 sc1
s_call_b64 s[100:101], L_UNIT
s_mov_b32 s54, s49
buffer_load_dwordx4 v[32:35], v8, s[20:23], s43 offen
buffer_load_dwordx4 v[36:39], v9, s[20:23], s43 offen
buffer_load_dwordx4 v[40:43], v10, s[20:23], s43 offen
buffer_load_dwordx4 v[44:47], v11, s[20:23], s43 offen
s_waitcnt vmcnt(5)
s_call_b64 s[100:101], L_PK3
buffer_store_dwordx4 v[20:23], v18, s[24:27], s53 offen offset:1024 sc1
buffer_load_dwordx4 v[48:51], v12, s[20:23], s43 offen
buffer_load_dwordx4 v[52:55], v13, s[20:23], s43 offen
buffer_load_dwordx4 v[56:59], v14, s[20:23], s43 offen
buffer_load_dwordx4 v[60:63], v15, s[20:23], s43 offen
s_waitcnt vmcnt(5)
s_call_b64 s[100:101], L_PK0
buffer_store_dwordx4 v[20:23], v18, s[24:27], s54 offen offset:0 sc1
s_call_b64 s[100:101], L_UNIT
s_mov_b32 s55, s49
buffer_load_dwordx4 v[64:67], v8, s[20:23], s43 offen
buffer_load_dwordx4 v[68:71], v9, s[20:23], s43 offen
buffer_load_dwordx4 v[72:75], v10, s[20:23], s43 offen
buffer_load_dwordx4 v[76:79], v11, s[20:23], s43 offen
s_waitcnt vmcnt(5)
s_call_b64 s[100:101], L_PK1
buffer_store_dwordx4 v[20:23], v18, s[24:27], s54 offen offset:1024 sc1
buffer_load_dwordx4 v[80:83], v12, s[20:23], s43 offen
buffer_load_dwordx4 v[84:87], v13, s[20:23], s43 offen
buffer_load_dwordx4 v[88:91], v14, s[20:23], s43 offen
buffer_load_dwordx4 v[92:95], v15, s[20:23], s43 offen
s_waitcnt vmcnt(5)
s_call_b64 s[100:101], L_PK2
buffer_store_dwordx4 v[20:23], v18, s[24:27], s55 offen offset:0 sc1
s_call_b64 s[100:101], L_UNIT
s_mov_b32 s52, s49
buffer_load_dwordx4 v[32:35], v8, s[20:23], s43 offen
buffer_load_dwordx4 v[36:39], v9, s[20:23], s43 offen
buffer_load_dwordx4 v[40:43], v10, s[20:23], s43 offen
buffer_load_dwordx4 v[44:47], v11, s[20:23], s43 offen
s_waitcnt vmcnt(5)
s_call_b64 s[100:101], L_PK3
buffer_store_dwordx4 v[20:23], v18, s[24:27], s55 offen offset:1024 sc1
buffer_load_dwordx4 v[48:51], v12, s[20:23], s43 offen
buffer_load_dwordx4 v[52:55], v13, s[20:23], s43 offen
buffer_load_dwordx4 v[56:59], v14, s[20:23], s43 offen
buffer_load_dwordx4 v[60:63], v15, s[20:23], s43 offen
s_waitcnt vmcnt(5)
s_call_b64 s[100:101], L_PK0
buffer_store_dwordx4 v[20:23], v18, s[24:27], s52 offen offset:0 sc1
buffer_load_dword v19, v17, s[28:31], 0 offen offset:1536
s_waitcnt vmcnt(2)
s_call_b64 s[100:101], L_PK1
buffer_store_dwordx4 v[20:23], v18, s[24:27], s52 offen offset:1024 sc1
s_call_b64 s[100:101], L_UNIT
s_mov_b32 s53, s49
buffer_load_dwordx4 v[64:67], v8, s[20:23], s43 offen
buffer_load_dwordx4 v[68:71], v9, s[20:23], s43 offen
buffer_load_dwordx4 v[72:75], v10, s[20:23], s43 offen
buffer_load_dwordx4 v[76:79], v11, s[20:23], s43 offen
buffer_load_dwordx4 v[80:83], v12, s[20:23], s43 offen
buffer_load_dwordx4 v[84:87], v13, s[20:23], s43 offen
buffer_load_dwordx4 v[88:91], v14, s[20:23], s43 offen
buffer_load_dwordx4 v[92:95], v15, s[20:23], s43 offen
s_waitcnt vmcnt(4)
s_call_b64 s[100:101], L_PK2
buffer_store_dwordx4 v[20:23], v18, s[24:27], s53 offen offset:0 sc1
s_call_b64 s[100:101], L_UNIT
s_mov_b32 s54, s49
buffer_load_dwordx4 v[32:35], v8, s[20:23], s43 offen
buffer_load_dwordx4 v[36:39], v9, s[20:23], s43 offen
buffer_load_dwordx4 v[40:43], v10, s[20:23], s43 offen
buffer_load_dwordx4 v[44:47], v11, s[20:23], s43 offen
s_waitcnt vmcnt(5)
s_call_b64 s[100:101], L_PK3
buffer_store_dwordx4 v[20:23], v18, s[24:27], s53 offen offset:1024 sc1
buffer_load_dwordx4 v[48:51], v12, s[20:23], s43 offen
buffer_load_dwordx4 v[52:55], v13, s[20:23], s43 offen
buffer_load_dwordx4 v[56:59], v14, s[20:23], s43 offen
buffer_load_dwordx4 v[60:63], v15, s[20:23], s43 offen
s_waitcnt vmcnt(5)
s_call_b64 s[100:101], L_PK0
buffer_store_dwordx4 v[20:23], v18, s[24:27], s54 offen offset:0 sc1
s_waitcnt vmcnt(1)
s_call_b64 s[100:101], L_PK1
buffer_store_dwordx4 v[20:23], v18, s[24:27], s54 offen offset:1024 sc1
s_endpgm
L_UNIT:
s_cmp_ge_u32 s40, 14
s_cselect_b32 s45, 8, 0
s_add_u32 s45, s45, s40
s_lshl2_add_u32 s42, s41, s36
s_mul_i32 s43, s45, 458752
s_lshl_b32 s44, s42, 8
s_add_u32 s43, s43, s44
s_lshl_b32 s44, s42, 5
s_add_u32 s44, s44, s45
s_lshl_b32 s49, s44, 11
s_cmp_lt_u32 s45, 32
s_cselect_b32 s49, s49, 0x1000000
s_cselect_b32 s22, 14680064, 0
s_add_u32 s41, s41, 4
s_add_u32 s40, s40, 2
s_cmp_ge_u32 s41, 14
s_cselect_b32 s48, 14, 0
s_addc_u32 s40, s40, 0
s_sub_u32 s41, s41, s48
s_setpc_b64 s[100:101]
L_PK0:
v_lshl_add_u64 v[32:33], v[36:37], 4, v[32:33]
v_lshl_add_u64 v[34:35], v[38:39], 4, v[34:35]
v_lshl_add_u64 v[40:41], v[44:45], 4, v[40:41]
v_lshl_add_u64 v[42:43], v[46:47], 4, v[42:43]
v_lshl_or_b32 v44, v40, 8, v32
v_lshl_or_b32 v45, v41, 8, v33
v_lshl_or_b32 v46, v42, 8, v34
v_lshl_or_b32 v47, v43, 8, v35
v_lshl_or_b32 v20, v45, 16, v44
v_lshl_or_b32 v21, v47, 16, v46
s_setpc_b64 s[100:101]
L_PK1:
v_lshl_add_u64 v[48:49], v[52:53], 4, v[48:49]
v_lshl_add_u64 v[50:51], v[54:55], 4, v[50:51]
v_lshl_add_u64 v[56:57], v[60:61], 4, v[56:57]
v_lshl_add_u64 v[58:59], v[62:63], 4, v[58:59]
v_lshl_or_b32 v60, v56, 8, v48
v_lshl_or_b32 v61, v57, 8, v49
v_lshl_or_b32 v62, v58, 8, v50
v_lshl_or_b32 v63, v59, 8, v51
v_lshl_or_b32 v20, v61, 16, v60
v_lshl_or_b32 v21, v63, 16, v62
s_setpc_b64 s[100:101]
L_PK2:
v_lshl_add_u64 v[64:65], v[68:69], 4, v[64:65]
v_lshl_add_u64 v[66:67], v[70:71], 4, v[66:67]
v_lshl_add_u64 v[72:73], v[76:77], 4, v[72:73]
v_lshl_add_u64 v[74:75], v[78:79], 4, v[74:75]
v_lshl_or_b32 v76, v72, 8, v64
v_lshl_or_b32 v77, v73, 8, v65
v_lshl_or_b32 v78, v74, 8, v66
v_lshl_or_b32 v79, v75, 8, v67
v_lshl_or_b32 v20, v77, 16, v76
v_lshl_or_b32 v21, v79, 16, v78
s_setpc_b64 s[100:101]
L_PK3:
v_lshl_add_u64 v[80:81], v[84:85], 4, v[80:81]
v_lshl_add_u64 v[82:83], v[86:87], 4, v[82:83]
v_lshl_add_u64 v[88:89], v[92:93], 4, v[88:89]
v_lshl_add_u64 v[90:91], v[94:95], 4, v[90:91]
v_lshl_or_b32 v92, v88, 8, v80
v_lshl_or_b32 v93, v89, 8, v81
v_lshl_or_b32 v94, v90, 8, v82
v_lshl_or_b32 v95, v91, 8, v83
v_lshl_or_b32 v20, v93, 16, v92
v_lshl_or_b32 v21, v95, 16, v94
s_setpc_b64 s[100:101]
.p2align 12
L_STREAM:
L_PAD0:
s_cbranch_vccnz L_PADRET0
buffer_load_dwordx4 v[80:83], v30, s[72:75], 0 offen
buffer_load_dwordx4 v[84:87], v30, s[72:75], s92 offen
buffer_load_dwordx4 v[88:91], v30, s[72:75], s93 offen
buffer_load_dwordx4 v[92:95], v30, s[72:75], s94 offen
s_waitcnt vmcnt(9)
s_barrier
ds_read_b128 a[240:243], v2 offset:0
ds_read_b128 a[244:247], v2 offset:2048
v_lshl_add_u32 v104, v104, 8, v19
v_lshl_add_u32 v105, v105, 8, v19
v_lshl_add_u32 v106, v106, 8, v19
v_lshl_add_u32 v107, v107, 8, v19
v_lshl_add_u32 v112, v112, 8, v19
v_lshl_add_u32 v113, v113, 8, v19
v_lshl_add_u32 v114, v114, 8, v19
v_lshl_add_u32 v115, v115, 8, v19
s_waitcnt vmcnt(5)
v_lshl_add_u64 v[64:65], v[68:69], 4, v[64:65]
v_lshl_add_u64 v[66:67], v[70:71], 4, v[66:67]
v_lshl_add_u64 v[72:73], v[76:77], 4, v[72:73]
v_lshl_add_u64 v[74:75], v[78:79], 4, v[74:75]
v_lshl_add_u32 v64, v64, 8, v19
v_lshl_add_u32 v65, v65, 8, v19
v_lshl_add_u32 v66, v66, 8, v19
v_lshl_add_u32 v67, v67, 8, v19
v_lshl_add_u32 v72, v72, 8, v19
v_lshl_add_u32 v73, v73, 8, v19
v_lshl_add_u32 v74, v74, 8, v19
v_lshl_add_u32 v75, v75, 8, v19
s_bitcmp1_b32 s37, 0
s_cbranch_scc0 L_NOSWAP
v_swap_b32 v104, v64
v_swap_b32 v105, v65
v_swap_b32 v106, v66
v_swap_b32 v107, v67
v_swap_b32 v112, v72
v_swap_b32 v113, v73
v_swap_b32 v114, v74
v_swap_b32 v115, v75
L_NOSWAP:
ds_read_b32 a0, v104
ds_read_b32 a1, v112
ds_read_b32 a2, v64
ds_read_b32 a3, v72
ds_read_b32 a4, v105
ds_read_b32 a5, v113
ds_read_b32 a6, v65
ds_read_b32 a7, v73
ds_read_b32 a8, v106
ds_read_b32 a9, v114
ds_read_b32 a10, v66
ds_read_b32 a11, v74
ds_read_b32 a12, v107
ds_read_b32 a13, v115
ds_read_b32 a14, v67
ds_read_b32 a15, v75
s_waitcnt lgkmcnt(12)
v_mfma_f32_16x16x32_bf16 v[128:131], a[240:243], a[0:3], 0
s_waitcnt lgkmcnt(8)
ds_read_b128 a[248:251], v2 offset:4096
buffer_load_dwordx4 v[40:43], v31, s[72:75], 0 offen
v_mfma_f32_16x16x32_bf16 v[132:135], a[240:243], a[4:7], 0
s_waitcnt lgkmcnt(5)
buffer_load_dwordx4 v[44:47], v31, s[72:75], s92 offen
v_mfma_f32_16x16x32_bf16 v[136:139], a[240:243], a[8:11], 0
s_waitcnt lgkmcnt(1)
buffer_load_dwordx4 v[48:51], v31, s[72:75], s93 offen
v_mfma_f32_16x16x32_bf16 v[140:143], a[240:243], a[12:15], 0
buffer_load_dwordx4 v[52:55], v31, s[72:75], s94 offen
v_mfma_f32_16x16x32_bf16 v[144:147], a[244:247], a[0:3], 0
ds_read_b128 a[252:255], v2 offset:6144
v_mfma_f32_16x16x32_bf16 v[148:151], a[244:247], a[4:7], 0
v_mfma_f32_16x16x32_bf16 v[152:155], a[244:247], a[8:11], 0
s_add_u32 m0, s33, 81920
v_mfma_f32_16x16x32_bf16 v[156:159], a[244:247], a[12:15], 0
s_waitcnt lgkmcnt(1)
v_mfma_f32_16x16x32_bf16 v[160:163], a[248:251], a[0:3], 0
ds_read_b128 a[240:243], v2 offset:8192
buffer_load_dwordx4 v8, s[20:23], s41 offen lds
v_mfma_f32_16x16x32_bf16 v[164:167], a[248:251], a[4:7], 0
v_mfma_f32_16x16x32_bf16 v[168:171], a[248:251], a[8:11], 0
s_add_u32 m0, s33, 86016
v_mfma_f32_16x16x32_bf16 v[172:175], a[248:251], a[12:15], 0
s_waitcnt lgkmcnt(1)
v_mfma_f32_16x16x32_bf16 v[176:179], a[252:255], a[0:3], 0
ds_read_b128 a[244:247], v2 offset:10240
buffer_load_dwordx4 v9, s[20:23], s41 offen lds
v_mfma_f32_16x16x32_bf16 v[180:183], a[252:255], a[4:7], 0
v_mfma_f32_16x16x32_bf16 v[184:187], a[252:255], a[8:11], 0
s_add_u32 m0, s33, 90112
v_mfma_f32_16x16x32_bf16 v[188:191], a[252:255], a[12:15], 0
s_waitcnt lgkmcnt(1)
v_mfma_f32_16x16x32_bf16 v[192:195], a[240:243], a[0:3], 0
buffer_load_dwordx4 v10, s[20:23], s41 offen lds
v_mfma_f32_16x16x32_bf16 v[196:199], a[240:243], a[4:7], 0
v_mfma_f32_16x16x32_bf16 v[200:203], a[240:243], a[8:11], 0
s_add_u32 m0, s33, 94208
v_mfma_f32_16x16x32_bf16 v[204:207], a[240:243], a[12:15], 0
s_waitcnt lgkmcnt(0)
v_mfma_f32_16x16x32_bf16 v[208:211], a[244:247], a[0:3], 0
ds_read_b128 a[248:251], v2 offset:12288
buffer_load_dwordx4 v11, s[20:23], s41 offen lds
v_mfma_f32_16x16x32_bf16 v[212:215], a[244:247], a[4:7], 0
v_mfma_f32_16x16x32_bf16 v[216:219], a[244:247], a[8:11], 0
v_mfma_f32_16x16x32_bf16 v[220:223], a[244:247], a[12:15], 0
s_waitcnt vmcnt(10)
ds_read_b128 a[252:255], v2 offset:14336
v_lshl_add_u64 v[80:81], v[84:85], 4, v[80:81]
v_lshl_add_u64 v[82:83], v[86:87], 4, v[82:83]
v_lshl_add_u32 v80, v80, 8, v19
v_lshl_add_u32 v81, v81, 8, v19
v_lshl_add_u32 v82, v82, 8, v19
v_lshl_add_u32 v83, v83, 8, v19
ds_read_b32 a16, v80
ds_read_b32 a20, v81
ds_read_b32 a24, v82
ds_read_b32 a28, v83
s_waitcnt vmcnt(8)
v_lshl_add_u64 v[88:89], v[92:93], 4, v[88:89]
v_lshl_add_u64 v[90:91], v[94:95], 4, v[90:91]
v_lshl_add_u32 v88, v88, 8, v19
v_lshl_add_u32 v89, v89, 8, v19
v_lshl_add_u32 v90, v90, 8, v19
v_lshl_add_u32 v91, v91, 8, v19
ds_read_b32 a17, v88
ds_read_b32 a21, v89
ds_read_b32 a25, v90
ds_read_b32 a29, v91
s_waitcnt vmcnt(6)
buffer_load_dwordx4 v[32:35], v12, s[24:27], 0 offen offset:0 sc1
v_lshl_add_u64 v[40:41], v[44:45], 4, v[40:41]
v_lshl_add_u64 v[42:43], v[46:47], 4, v[42:43]
v_lshl_add_u32 v40, v40, 8, v19
v_lshl_add_u32 v41, v41, 8, v19
v_lshl_add_u32 v42, v42, 8, v19
v_lshl_add_u32 v43, v43, 8, v19
ds_read_b32 a18, v40
ds_read_b32 a22, v41
ds_read_b32 a26, v42
ds_read_b32 a30, v43
s_waitcnt vmcnt(5) lgkmcnt(13)
buffer_load_dwordx4 v[36:39], v12, s[24:27], 0 offen offset:1024 sc1
v_lshl_add_u64 v[48:49], v[52:53], 4, v[48:49]
v_lshl_add_u64 v[50:51], v[54:55], 4, v[50:51]
v_lshl_add_u32 v48, v48, 8, v19
v_lshl_add_u32 v49, v49, 8, v19
v_lshl_add_u32 v50, v50, 8, v19
v_lshl_add_u32 v51, v51, 8, v19
ds_read_b32 a19, v48
ds_read_b32 a23, v49
ds_read_b32 a27, v50
ds_read_b32 a31, v51
v_mfma_f32_16x16x32_bf16 v[224:227], a[248:251], a[0:3], 0
ds_read_b128 a[240:243], v4 offset:0
v_mfma_f32_16x16x32_bf16 v[228:231], a[248:251], a[4:7], 0
v_mfma_f32_16x16x32_bf16 v[232:235], a[248:251], a[8:11], 0
global_load_dwordx2 v[20:21], v28, s[8:9]
v_mfma_f32_16x16x32_bf16 v[236:239], a[248:251], a[12:15], 0
s_waitcnt lgkmcnt(5)
v_mfma_f32_16x16x32_bf16 v[240:243], a[252:255], a[0:3], 0
ds_read_b128 a[244:247], v4 offset:2048
v_mfma_f32_16x16x32_bf16 v[244:247], a[252:255], a[4:7], 0
v_mfma_f32_16x16x32_bf16 v[248:251], a[252:255], a[8:11], 0
v_mfma_f32_16x16x32_bf16 v[252:255], a[252:255], a[12:15], 0
s_waitcnt lgkmcnt(1)
v_mfma_f32_16x16x32_bf16 v[128:131], a[240:243], a[16:19], v[128:131]
ds_read_b128 a[248:251], v4 offset:4096
v_mfma_f32_16x16x32_bf16 v[132:135], a[240:243], a[20:23], v[132:135]
v_mfma_f32_16x16x32_bf16 v[136:139], a[240:243], a[24:27], v[136:139]
buffer_load_dwordx4 v[40:43], v12, s[24:27], 0 offen offset:2048 sc1
v_mfma_f32_16x16x32_bf16 v[140:143], a[240:243], a[28:31], v[140:143]
s_waitcnt lgkmcnt(1)
buffer_load_dwordx4 v[44:47], v12, s[24:27], 0 offen offset:3072 sc1
v_mfma_f32_16x16x32_bf16 v[144:147], a[244:247], a[16:19], v[144:147]
ds_read_b128 a[252:255], v4 offset:6144
v_lshl_add_u32 v12, s42, 5, v13
v_mfma_f32_16x16x32_bf16 v[148:151], a[244:247], a[20:23], v[148:151]
v_mfma_f32_16x16x32_bf16 v[152:155], a[244:247], a[24:27], v[152:155]
v_mfma_f32_16x16x32_bf16 v[156:159], a[244:247], a[28:31], v[156:159]
s_waitcnt lgkmcnt(1)
v_mfma_f32_16x16x32_bf16 v[160:163], a[248:251], a[16:19], v[160:163]
ds_read_b128 a[240:243], v4 offset:8192
v_mfma_f32_16x16x32_bf16 v[164:167], a[248:251], a[20:23], v[164:167]
v_mfma_f32_16x16x32_bf16 v[168:171], a[248:251], a[24:27], v[168:171]
v_mfma_f32_16x16x32_bf16 v[172:175], a[248:251], a[28:31], v[172:175]
s_waitcnt lgkmcnt(1)
v_mfma_f32_16x16x32_bf16 v[176:179], a[252:255], a[16:19], v[176:179]
ds_read_b128 a[244:247], v4 offset:10240
buffer_load_dwordx4 v[48:51], v12, s[24:27], 0 offen offset:0 sc1
v_mfma_f32_16x16x32_bf16 v[180:183], a[252:255], a[20:23], v[180:183]
buffer_load_dwordx4 v[52:55], v12, s[24:27], 0 offen offset:1024 sc1
v_mfma_f32_16x16x32_bf16 v[184:187], a[252:255], a[24:27], v[184:187]
s_add_u32 m0, s33, 98304
v_mfma_f32_16x16x32_bf16 v[188:191], a[252:255], a[28:31], v[188:191]
s_waitcnt lgkmcnt(1)
v_mfma_f32_16x16x32_bf16 v[192:195], a[240:243], a[16:19], v[192:195]
buffer_load_dwordx4 v8, s[20:23], s42 offen lds
v_mfma_f32_16x16x32_bf16 v[196:199], a[240:243], a[20:23], v[196:199]
v_mfma_f32_16x16x32_bf16 v[200:203], a[240:243], a[24:27], v[200:203]
s_add_u32 m0, s33, 102400
v_mfma_f32_16x16x32_bf16 v[204:207], a[240:243], a[28:31], v[204:207]
s_waitcnt lgkmcnt(0)
v_mfma_f32_16x16x32_bf16 v[208:211], a[244:247], a[16:19], v[208:211]
s_waitcnt vmcnt(8)
s_barrier
ds_read_b128 a[248:251], v4 offset:12288
buffer_load_dwordx4 v9, s[20:23], s42 offen lds
v_mfma_f32_16x16x32_bf16 v[212:215], a[244:247], a[20:23], v[212:215]
v_mfma_f32_16x16x32_bf16 v[216:219], a[244:247], a[24:27], v[216:219]
s_add_u32 m0, s33, 106496
v_mfma_f32_16x16x32_bf16 v[220:223], a[244:247], a[28:31], v[220:223]
ds_read_b128 a[252:255], v4 offset:14336
buffer_load_dwordx4 v10, s[20:23], s42 offen lds
s_waitcnt vmcnt(8)
v_cmp_ne_u64 s[50:51], s[88:89], v[34:35]
v_cmp_ne_u64 s[44:45], s[88:89], v[38:39]
s_or_b64 s[50:51], s[44:45], s[50:51]
s_cbranch_scc1 L_SLOW2
L_BACK2:
v_perm_b32 v64, v32, v19, s52
v_perm_b32 v65, v32, v19, s53
v_perm_b32 v66, v36, v19, s52
v_perm_b32 v67, v36, v19, s53
v_perm_b32 v68, v32, v19, s54
v_perm_b32 v69, v32, v19, s55
v_perm_b32 v70, v36, v19, s54
v_perm_b32 v71, v36, v19, s55
ds_read_b32 a32, v64
ds_read_b32 a33, v65
ds_read_b32 a34, v66
ds_read_b32 a35, v67
ds_read_b32 a36, v68
ds_read_b32 a37, v69
ds_read_b32 a38, v70
ds_read_b32 a39, v71
v_perm_b32 v72, v33, v19, s52
v_perm_b32 v73, v33, v19, s53
v_perm_b32 v74, v37, v19, s52
v_perm_b32 v75, v37, v19, s53
v_perm_b32 v76, v33, v19, s54
v_perm_b32 v77, v33, v19, s55
v_perm_b32 v78, v37, v19, s54
v_perm_b32 v79, v37, v19, s55
ds_read_b32 a40, v72
ds_read_b32 a41, v73
ds_read_b32 a42, v74
ds_read_b32 a43, v75
ds_read_b32 a44, v76
ds_read_b32 a45, v77
ds_read_b32 a46, v78
ds_read_b32 a47, v79
s_add_u32 m0, s33, 110592
s_waitcnt lgkmcnt(15)
v_mfma_f32_16x16x32_bf16 v[224:227], a[248:251], a[16:19], v[224:227]
ds_read_b128 a[240:243], v14 offset:16384
buffer_load_dwordx4 v11, s[20:23], s42 offen lds
v_mfma_f32_16x16x32_bf16 v[228:231], a[248:251], a[20:23], v[228:231]
v_mfma_f32_16x16x32_bf16 v[232:235], a[248:251], a[24:27], v[232:235]
s_waitcnt vmcnt(6)
s_add_u32 m0, s33, 114688
v_cmp_ne_u64 s[50:51], s[88:89], v[42:43]
v_cmp_ne_u64 s[44:45], s[88:89], v[46:47]
v_mfma_f32_16x16x32_bf16 v[236:239], a[248:251], a[28:31], v[236:239]
v_mfma_f32_16x16x32_bf16 v[240:243], a[252:255], a[16:19], v[240:243]
s_or_b64 s[50:51], s[44:45], s[50:51]
ds_read_b128 a[244:247], v14 offset:18432
buffer_load_dwordx4 v8, s[20:23], s43 offen lds
v_mfma_f32_16x16x32_bf16 v[244:247], a[252:255], a[20:23], v[244:247]
s_cbranch_scc1 L_SLOW3
L_BACK3:
v_mfma_f32_16x16x32_bf16 v[248:251], a[252:255], a[24:27], v[248:251]
s_add_u32 m0, s33, 118784
v_mfma_f32_16x16x32_bf16 v[252:255], a[252:255], a[28:31], v[252:255]
s_waitcnt lgkmcnt(1)
v_mfma_f32_16x16x32_bf16 v[128:131], a[240:243], a[32:35], v[128:131]
ds_read_b128 a[248:251], v14 offset:20480
buffer_load_dwordx4 v9, s[20:23], s43 offen lds
v_mfma_f32_16x16x32_bf16 v[132:135], a[240:243], a[36:39], v[132:135]
v_perm_b32 v63, v40, v19, s52
v_mfma_f32_16x16x32_bf16 v[136:139], a[240:243], a[40:43], v[136:139]
ds_read_b32 a48, v63
v_perm_b32 v62, v40, v19, s53
v_mfma_f32_16x16x32_bf16 v[140:143], a[240:243], a[44:47], v[140:143]
s_waitcnt lgkmcnt(2)
ds_read_b32 a49, v62
v_mfma_f32_16x16x32_bf16 v[144:147], a[244:247], a[32:35], v[144:147]
ds_read_b128 a[252:255], v14 offset:22528
v_perm_b32 v61, v44, v19, s52
v_mfma_f32_16x16x32_bf16 v[148:151], a[244:247], a[36:39], v[148:151]
ds_read_b32 a50, v61
v_perm_b32 v60, v44, v19, s53
v_mfma_f32_16x16x32_bf16 v[152:155], a[244:247], a[40:43], v[152:155]
s_add_u32 m0, s33, 122880
ds_read_b32 a51, v60
v_perm_b32 v59, v40, v19, s54
v_mfma_f32_16x16x32_bf16 v[156:159], a[244:247], a[44:47], v[156:159]
s_waitcnt lgkmcnt(4)
ds_read_b32 a52, v59
v_perm_b32 v58, v40, v19, s55
v_mfma_f32_16x16x32_bf16 v[160:163], a[248:251], a[32:35], v[160:163]
ds_read_b128 a[240:243], v14 offset:24576
buffer_load_dwordx4 v10, s[20:23], s43 offen lds
v_mfma_f32_16x16x32_bf16 v[164:167], a[248:251], a[36:39], v[164:167]
buffer_load_dwordx4 v[104:107], v30, s[16:19], 0 offen
v_mfma_f32_16x16x32_bf16 v[168:171], a[248:251], a[40:43], v[168:171]
ds_read_b32 a53, v58
v_perm_b32 v57, v44, v19, s54
v_mfma_f32_16x16x32_bf16 v[172:175], a[248:251], a[44:47], v[172:175]
s_waitcnt lgkmcnt(3)
ds_read_b32 a54, v57
v_mfma_f32_16x16x32_bf16 v[176:179], a[252:255], a[32:35], v[176:179]
ds_read_b128 a[244:247], v14 offset:26624
v_perm_b32 v56, v44, v19, s55
v_mfma_f32_16x16x32_bf16 v[180:183], a[252:255], a[36:39], v[180:183]
ds_read_b32 a55, v56
v_perm_b32 v63, v41, v19, s52
v_mfma_f32_16x16x32_bf16 v[184:187], a[252:255], a[40:43], v[184:187]
ds_read_b32 a56, v63
v_perm_b32 v62, v41, v19, s53
v_mfma_f32_16x16x32_bf16 v[188:191], a[252:255], a[44:47], v[188:191]
s_waitcnt lgkmcnt(4)
ds_read_b32 a57, v62
v_mfma_f32_16x16x32_bf16 v[192:195], a[240:243], a[32:35], v[192:195]
ds_read_b128 a[248:251], v14 offset:28672
v_perm_b32 v61, v45, v19, s52
v_mfma_f32_16x16x32_bf16 v[196:199], a[240:243], a[36:39], v[196:199]
buffer_load_dwordx4 v[108:111], v30, s[16:19], s92 offen
v_mfma_f32_16x16x32_bf16 v[200:203], a[240:243], a[40:43], v[200:203]
s_add_u32 m0, s33, 126976
ds_read_b32 a58, v61
v_perm_b32 v60, v45, v19, s53
v_mfma_f32_16x16x32_bf16 v[204:207], a[240:243], a[44:47], v[204:207]
s_waitcnt lgkmcnt(3)
ds_read_b32 a59, v60
v_perm_b32 v59, v41, v19, s54
v_mfma_f32_16x16x32_bf16 v[208:211], a[244:247], a[32:35], v[208:211]
ds_read_b128 a[252:255], v14 offset:30720
buffer_load_dwordx4 v11, s[20:23], s43 offen lds
v_mfma_f32_16x16x32_bf16 v[212:215], a[244:247], a[36:39], v[212:215]
ds_read_b32 a60, v59
v_perm_b32 v58, v41, v19, s55
v_mfma_f32_16x16x32_bf16 v[216:219], a[244:247], a[40:43], v[216:219]
ds_read_b32 a61, v58
v_perm_b32 v57, v45, v19, s54
v_mfma_f32_16x16x32_bf16 v[220:223], a[244:247], a[44:47], v[220:223]
s_waitcnt lgkmcnt(4)
ds_read_b32 a62, v57
buffer_load_dwordx4 v[96:99], v12, s[24:27], 0 offen offset:2048 sc1
v_mfma_f32_16x16x32_bf16 v[224:227], a[248:251], a[32:35], v[224:227]
ds_read_b128 a[240:243], v15 offset:16384
v_perm_b32 v56, v45, v19, s55
v_mfma_f32_16x16x32_bf16 v[228:231], a[248:251], a[36:39], v[228:231]
buffer_load_dwordx4 v[112:115], v30, s[16:19], s93 offen
v_mfma_f32_16x16x32_bf16 v[232:235], a[248:251], a[40:43], v[232:235]
ds_read_b32 a63, v56
buffer_load_dwordx4 v[100:103], v12, s[24:27], 0 offen offset:3072 sc1
v_mfma_f32_16x16x32_bf16 v[236:239], a[248:251], a[44:47], v[236:239]
s_waitcnt lgkmcnt(3)
v_lshl_add_u32 v12, s43, 5, v13
v_mfma_f32_16x16x32_bf16 v[240:243], a[252:255], a[32:35], v[240:243]
ds_read_b128 a[244:247], v15 offset:18432
buffer_load_dwordx4 v[80:83], v12, s[24:27], 0 offen offset:0 sc1
s_mov_b64 vcc, -1
s_cmp_eq_u32 s36, 0
s_cbranch_scc1 L_PAD1
s_cmp_eq_u32 s36, 1
s_cbranch_scc1 L_PAD3
s_cmp_eq_u32 s36, 2
s_cbranch_scc1 L_PAD5
s_cmp_eq_u32 s36, 3
s_cbranch_scc1 L_PADS
L_PADRET:
s_mov_b64 vcc, 0
v_mfma_f32_16x16x32_bf16 v[244:247], a[252:255], a[36:39], v[244:247]
buffer_load_dwordx4 v[84:87], v12, s[24:27], 0 offen offset:1024 sc1
v_lshlrev_b32 v24, 16, v20
v_mfma_f32_16x16x32_bf16 v[248:251], a[252:255], a[40:43], v[248:251]
s_waitcnt vmcnt(15)
v_cmp_ne_u64 s[50:51], s[88:89], v[50:51]
v_cmp_ne_u64 s[44:45], s[88:89], v[54:55]
v_mfma_f32_16x16x32_bf16 v[252:255], a[252:255], a[44:47], v[252:255]
s_waitcnt lgkmcnt(1)
v_and_b32 v25, 0xffff0000, v20
v_lshlrev_b32 v26, 16, v21
v_mfma_f32_16x16x32_bf16 v[128:131], a[240:243], a[48:51], v[128:131]
s_or_b64 s[50:51], s[44:45], s[50:51]
ds_read_b128 a[248:251], v15 offset:20480
v_and_b32 v27, 0xffff0000, v21
v_mfma_f32_16x16x32_bf16 v[132:135], a[240:243], a[52:55], v[132:135]
buffer_load_dwordx4 v[116:119], v30, s[16:19], s94 offen
v_mfma_f32_16x16x32_bf16 v[136:139], a[240:243], a[56:59], v[136:139]
s_cbranch_scc1 L_SLOW4
L_BACK4:
v_mfma_f32_16x16x32_bf16 v[140:143], a[240:243], a[60:63], v[140:143]
s_waitcnt lgkmcnt(1)
v_mfma_f32_16x16x32_bf16 v[144:147], a[244:247], a[48:51], v[144:147]
ds_read_b128 a[252:255], v15 offset:22528
v_mfma_f32_16x16x32_bf16 v[148:151], a[244:247], a[52:55], v[148:151]
v_perm_b32 v63, v48, v19, s52
v_mfma_f32_16x16x32_bf16 v[152:155], a[244:247], a[56:59], v[152:155]
ds_read_b32 a64, v63
v_perm_b32 v62, v48, v19, s53
v_mfma_f32_16x16x32_bf16 v[156:159], a[244:247], a[60:63], v[156:159]
s_waitcnt lgkmcnt(2)
ds_read_b32 a65, v62
v_mfma_f32_16x16x32_bf16 v[160:163], a[248:251], a[48:51], v[160:163]
ds_read_b128 a[240:243], v15 offset:24576
v_perm_b32 v61, v52, v19, s52
v_mfma_f32_16x16x32_bf16 v[164:167], a[248:251], a[52:55], v[164:167]
ds_read_b32 a66, v61
v_perm_b32 v60, v52, v19, s53
v_mfma_f32_16x16x32_bf16 v[168:171], a[248:251], a[56:59], v[168:171]
s_add_u32 m0, s33, 130560
ds_read_b32 a67, v60
v_perm_b32 v59, v48, v19, s54
v_mfma_f32_16x16x32_bf16 v[172:175], a[248:251], a[60:63], v[172:175]
s_waitcnt lgkmcnt(4)
ds_read_b32 a68, v59
v_perm_b32 v58, v48, v19, s55
v_mfma_f32_16x16x32_bf16 v[176:179], a[252:255], a[48:51], v[176:179]
ds_read_b128 a[244:247], v15 offset:26624
buffer_load_dwordx4 v8, s[20:23], 0 offen offset:512 lds
v_mfma_f32_16x16x32_bf16 v[180:183], a[252:255], a[52:55], v[180:183]
ds_read_b32 a69, v58
v_perm_b32 v57, v52, v19, s54
v_mfma_f32_16x16x32_bf16 v[184:187], a[252:255], a[56:59], v[184:187]
ds_read_b32 a70, v57
v_perm_b32 v56, v52, v19, s55
v_mfma_f32_16x16x32_bf16 v[188:191], a[252:255], a[60:63], v[188:191]
s_waitcnt lgkmcnt(4)
ds_read_b32 a71, v56
buffer_load_dwordx4 v[88:91], v12, s[24:27], 0 offen offset:2048 sc1
v_mfma_f32_16x16x32_bf16 v[192:195], a[240:243], a[48:51], v[192:195]
s_waitcnt vmcnt(14)
s_barrier
ds_read_b128 a[248:251], v15 offset:28672
v_perm_b32 v63, v49, v19, s52
v_mfma_f32_16x16x32_bf16 v[196:199], a[240:243], a[52:55], v[196:199]
ds_read_b32 a72, v63
v_perm_b32 v62, v49, v19, s53
v_mfma_f32_16x16x32_bf16 v[200:203], a[240:243], a[56:59], v[200:203]
ds_read_b32 a73, v62
v_perm_b32 v61, v53, v19, s52
v_mfma_f32_16x16x32_bf16 v[204:207], a[240:243], a[60:63], v[204:207]
s_waitcnt lgkmcnt(4)
ds_read_b32 a74, v61
buffer_load_dwordx4 v[92:95], v12, s[24:27], 0 offen offset:3072 sc1
v_mfma_f32_16x16x32_bf16 v[208:211], a[244:247], a[48:51], v[208:211]
ds_read_b128 a[252:255], v15 offset:30720
v_perm_b32 v60, v53, v19, s53
v_mfma_f32_16x16x32_bf16 v[212:215], a[244:247], a[52:55], v[212:215]
ds_read_b32 a75, v60
v_perm_b32 v59, v49, v19, s54
v_mfma_f32_16x16x32_bf16 v[216:219], a[244:247], a[56:59], v[216:219]
ds_read_b32 a76, v59
v_perm_b32 v58, v49, v19, s55
v_mfma_f32_16x16x32_bf16 v[220:223], a[244:247], a[60:63], v[220:223]
s_waitcnt lgkmcnt(4)
ds_read_b32 a77, v58
v_add_u32 v12, 16384, v13
v_mfma_f32_16x16x32_bf16 v[224:227], a[248:251], a[48:51], v[224:227]
ds_read_b128 a[240:243], v14 offset:32768
v_perm_b32 v57, v53, v19, s54
v_mfma_f32_16x16x32_bf16 v[228:231], a[248:251], a[52:55], v[228:231]
ds_read_b32 a78, v57
v_perm_b32 v56, v53, v19, s55
v_mfma_f32_16x16x32_bf16 v[232:235], a[248:251], a[56:59], v[232:235]
s_add_u32 m0, s33, 134656
ds_read_b32 a79, v56
v_mfma_f32_16x16x32_bf16 v[236:239], a[248:251], a[60:63], v[236:239]
s_waitcnt lgkmcnt(4)
v_mfma_f32_16x16x32_bf16 v[240:243], a[252:255], a[48:51], v[240:243]
ds_read_b128 a[244:247], v14 offset:34816
buffer_load_dwordx4 v9, s[20:23], 0 offen offset:512 lds
v_mfma_f32_16x16x32_bf16 v[244:247], a[252:255], a[52:55], v[244:247]
v_mfma_f32_16x16x32_bf16 v[248:251], a[252:255], a[56:59], v[248:251]
v_mfma_f32_16x16x32_bf16 v[252:255], a[252:255], a[60:63], v[252:255]
s_waitcnt lgkmcnt(1)
v_mfma_f32_16x16x32_bf16 v[128:131], a[240:243], a[64:67], v[128:131]
ds_read_b128 a[248:251], v14 offset:36864
v_mfma_f32_16x16x32_bf16 v[132:135], a[240:243], a[68:71], v[132:135]
v_mfma_f32_16x16x32_bf16 v[136:139], a[240:243], a[72:75], v[136:139]
v_mfma_f32_16x16x32_bf16 v[140:143], a[240:243], a[76:79], v[140:143]
s_waitcnt lgkmcnt(1)
v_mfma_f32_16x16x32_bf16 v[144:147], a[244:247], a[64:67], v[144:147]
ds_read_b128 a[252:255], v14 offset:38912
v_mfma_f32_16x16x32_bf16 v[148:151], a[244:247], a[68:71], v[148:151]
v_mfma_f32_16x16x32_bf16 v[152:155], a[244:247], a[72:75], v[152:155]
s_add_u32 m0, s33, 138752
v_mfma_f32_16x16x32_bf16 v[156:159], a[244:247], a[76:79], v[156:159]
s_waitcnt lgkmcnt(1)
v_mfma_f32_16x16x32_bf16 v[160:163], a[248:251], a[64:67], v[160:163]
ds_read_b128 a[240:243], v14 offset:40960
buffer_load_dwordx4 v10, s[20:23], 0 offen offset:512 lds
v_mfma_f32_16x16x32_bf16 v[164:167], a[248:251], a[68:71], v[164:167]
v_mfma_f32_16x16x32_bf16 v[168:171], a[248:251], a[72:75], v[168:171]
v_mfma_f32_16x16x32_bf16 v[172:175], a[248:251], a[76:79], v[172:175]
s_waitcnt lgkmcnt(1)
v_mfma_f32_16x16x32_bf16 v[176:179], a[252:255], a[64:67], v[176:179]
ds_read_b128 a[244:247], v14 offset:43008
v_mfma_f32_16x16x32_bf16 v[180:183], a[252:255], a[68:71], v[180:183]
v_mfma_f32_16x16x32_bf16 v[184:187], a[252:255], a[72:75], v[184:187]
v_mfma_f32_16x16x32_bf16 v[188:191], a[252:255], a[76:79], v[188:191]
s_waitcnt lgkmcnt(1)
buffer_load_dwordx4 v[32:35], v12, s[24:27], 0 offen offset:0 sc1
v_mfma_f32_16x16x32_bf16 v[192:195], a[240:243], a[64:67], v[192:195]
buffer_load_dwordx4 v[36:39], v12, s[24:27], 0 offen offset:1024 sc1
v_mfma_f32_16x16x32_bf16 v[196:199], a[240:243], a[68:71], v[196:199]
v_mfma_f32_16x16x32_bf16 v[200:203], a[240:243], a[72:75], v[200:203]
s_add_u32 m0, s33, 142848
v_mfma_f32_16x16x32_bf16 v[204:207], a[240:243], a[76:79], v[204:207]
s_waitcnt lgkmcnt(0)
v_mfma_f32_16x16x32_bf16 v[208:211], a[244:247], a[64:67], v[208:211]
ds_read_b128 a[248:251], v14 offset:45056
buffer_load_dwordx4 v11, s[20:23], 0 offen offset:512 lds
v_mfma_f32_16x16x32_bf16 v[212:215], a[244:247], a[68:71], v[212:215]
v_mfma_f32_16x16x32_bf16 v[216:219], a[244:247], a[72:75], v[216:219]
v_mfma_f32_16x16x32_bf16 v[220:223], a[244:247], a[76:79], v[220:223]
ds_read_b128 a[252:255], v14 offset:47104
s_waitcnt vmcnt(11)
v_cmp_ne_u64 s[50:51], s[88:89], v[98:99]
v_cmp_ne_u64 s[44:45], s[88:89], v[102:103]
s_or_b64 s[50:51], s[44:45], s[50:51]
s_cbranch_scc1 L_SLOW5
L_BACK5:
v_perm_b32 v64, v96, v19, s52
v_perm_b32 v65, v96, v19, s53
v_perm_b32 v66, v100, v19, s52
v_perm_b32 v67, v100, v19, s53
v_perm_b32 v68, v96, v19, s54
v_perm_b32 v69, v96, v19, s55
v_perm_b32 v70, v100, v19, s54
v_perm_b32 v71, v100, v19, s55
ds_read_b32 a80, v64
ds_read_b32 a81, v65
ds_read_b32 a82, v66
ds_read_b32 a83, v67
ds_read_b32 a84, v68
ds_read_b32 a85, v69
ds_read_b32 a86, v70
ds_read_b32 a87, v71
v_perm_b32 v72, v97, v19, s52
v_perm_b32 v73, v97, v19, s53
v_perm_b32 v74, v101, v19, s52
v_perm_b32 v75, v101, v19, s53
v_perm_b32 v76, v97, v19, s54
v_perm_b32 v77, v97, v19, s55
v_perm_b32 v78, v101, v19, s54
v_perm_b32 v79, v101, v19, s55
ds_read_b32 a88, v72
ds_read_b32 a89, v73
ds_read_b32 a90, v74
ds_read_b32 a91, v75
ds_read_b32 a92, v76
ds_read_b32 a93, v77
ds_read_b32 a94, v78
ds_read_b32 a95, v79
s_waitcnt lgkmcnt(15)
v_mfma_f32_16x16x32_bf16 v[224:227], a[248:251], a[64:67], v[224:227]
ds_read_b128 a[240:243], v15 offset:32768
v_mfma_f32_16x16x32_bf16 v[228:231], a[248:251], a[68:71], v[228:231]
L_PAD1:
s_cbranch_vccnz L_PAD2
v_mfma_f32_16x16x32_bf16 v[232:235], a[248:251], a[72:75], v[232:235]
v_mfma_f32_16x16x32_bf16 v[236:239], a[248:251], a[76:79], v[236:239]
s_waitcnt vmcnt(9)
v_cmp_ne_u64 s[50:51], s[88:89], v[82:83]
v_cmp_ne_u64 s[44:45], s[88:89], v[86:87]
v_mfma_f32_16x16x32_bf16 v[240:243], a[252:255], a[64:67], v[240:243]
ds_read_b128 a[244:247], v15 offset:34816
v_mfma_f32_16x16x32_bf16 v[244:247], a[252:255], a[68:71], v[244:247]
s_or_b64 s[50:51], s[44:45], s[50:51]
v_mfma_f32_16x16x32_bf16 v[248:251], a[252:255], a[72:75], v[248:251]
s_cbranch_scc1 L_SLOW6
L_BACK6:
v_mfma_f32_16x16x32_bf16 v[252:255], a[252:255], a[76:79], v[252:255]
s_waitcnt lgkmcnt(1)
v_mfma_f32_16x16x32_bf16 v[128:131], a[240:243], a[80:83], v[128:131]
ds_read_b128 a[248:251], v15 offset:36864
v_mfma_f32_16x16x32_bf16 v[132:135], a[240:243], a[84:87], v[132:135]
v_perm_b32 v63, v80, v19, s52
v_mfma_f32_16x16x32_bf16 v[136:139], a[240:243], a[88:91], v[136:139]
ds_read_b32 a96, v63
v_perm_b32 v62, v80, v19, s53
v_mfma_f32_16x16x32_bf16 v[140:143], a[240:243], a[92:95], v[140:143]
s_waitcnt lgkmcnt(2)
ds_read_b32 a97, v62
v_mfma_f32_16x16x32_bf16 v[144:147], a[244:247], a[80:83], v[144:147]
ds_read_b128 a[252:255], v15 offset:38912
v_perm_b32 v61, v84, v19, s52
v_mfma_f32_16x16x32_bf16 v[148:151], a[244:247], a[84:87], v[148:151]
ds_read_b32 a98, v61
v_perm_b32 v60, v84, v19, s53
v_mfma_f32_16x16x32_bf16 v[152:155], a[244:247], a[88:91], v[152:155]
s_add_u32 m0, s33, 146816
ds_read_b32 a99, v60
v_perm_b32 v59, v80, v19, s54
v_mfma_f32_16x16x32_bf16 v[156:159], a[244:247], a[92:95], v[156:159]
s_waitcnt lgkmcnt(4)
ds_read_b32 a100, v59
v_perm_b32 v58, v80, v19, s55
v_mfma_f32_16x16x32_bf16 v[160:163], a[248:251], a[80:83], v[160:163]
ds_read_b128 a[240:243], v15 offset:40960
buffer_load_dwordx4 v8, s[20:23], 0 offen offset:640 lds
v_mfma_f32_16x16x32_bf16 v[164:167], a[248:251], a[84:87], v[164:167]
ds_read_b32 a101, v58
v_perm_b32 v57, v84, v19, s54
v_mfma_f32_16x16x32_bf16 v[168:171], a[248:251], a[88:91], v[168:171]
ds_read_b32 a102, v57
v_perm_b32 v56, v84, v19, s55
v_mfma_f32_16x16x32_bf16 v[172:175], a[248:251], a[92:95], v[172:175]
s_waitcnt lgkmcnt(4)
ds_read_b32 a103, v56
buffer_load_dwordx4 v[40:43], v12, s[24:27], 0 offen offset:2048 sc1
v_mfma_f32_16x16x32_bf16 v[176:179], a[252:255], a[80:83], v[176:179]
s_barrier
ds_read_b128 a[244:247], v15 offset:43008
buffer_load_dwordx4 v[44:47], v12, s[24:27], 0 offen offset:3072 sc1
v_mfma_f32_16x16x32_bf16 v[180:183], a[252:255], a[84:87], v[180:183]
s_waitcnt vmcnt(11)
v_perm_b32 v63, v81, v19, s52
v_lshl_add_u64 v[104:105], v[108:109], 4, v[104:105]
v_mfma_f32_16x16x32_bf16 v[184:187], a[252:255], a[88:91], v[184:187]
ds_read_b32 a104, v63
v_perm_b32 v62, v81, v19, s53
v_mfma_f32_16x16x32_bf16 v[188:191], a[252:255], a[92:95], v[188:191]
s_waitcnt lgkmcnt(3)
ds_read_b32 a105, v62
v_perm_b32 v61, v85, v19, s52
v_mfma_f32_16x16x32_bf16 v[192:195], a[240:243], a[80:83], v[192:195]
ds_read_b128 a[248:251], v15 offset:45056
v_lshl_add_u64 v[106:107], v[110:111], 4, v[106:107]
v_mfma_f32_16x16x32_bf16 v[196:199], a[240:243], a[84:87], v[196:199]
ds_read_b32 a106, v61
v_perm_b32 v60, v85, v19, s53
v_mfma_f32_16x16x32_bf16 v[200:203], a[240:243], a[88:91], v[200:203]
ds_read_b32 a107, v60
v_perm_b32 v59, v81, v19, s54
v_mfma_f32_16x16x32_bf16 v[204:207], a[240:243], a[92:95], v[204:207]
s_waitcnt lgkmcnt(4)
ds_read_b32 a108, v59
v_lshl_add_u64 v[112:113], v[116:117], 4, v[112:113]
v_mfma_f32_16x16x32_bf16 v[208:211], a[244:247], a[80:83], v[208:211]
ds_read_b128 a[252:255], v15 offset:47104
v_perm_b32 v58, v81, v19, s55
v_mfma_f32_16x16x32_bf16 v[212:215], a[244:247], a[84:87], v[212:215]
ds_read_b32 a109, v58
v_add_u32 v12, 20480, v13
v_mfma_f32_16x16x32_bf16 v[216:219], a[244:247], a[88:91], v[216:219]
s_add_u32 m0, s33, 150912
v_perm_b32 v57, v85, v19, s54
v_lshl_add_u64 v[114:115], v[118:119], 4, v[114:115]
v_mfma_f32_16x16x32_bf16 v[220:223], a[244:247], a[92:95], v[220:223]
s_waitcnt lgkmcnt(3)
ds_read_b32 a110, v57
v_mfma_f32_16x16x32_bf16 v[224:227], a[248:251], a[80:83], v[224:227]
ds_read_b128 a[240:243], v14 offset:49152
buffer_load_dwordx4 v9, s[20:23], 0 offen offset:640 lds
v_mfma_f32_16x16x32_bf16 v[228:231], a[248:251], a[84:87], v[228:231]
v_perm_b32 v56, v85, v19, s55
v_lshl_or_b32 v116, v112, 8, v104
v_mfma_f32_16x16x32_bf16 v[232:235], a[248:251], a[88:91], v[232:235]
ds_read_b32 a111, v56
v_mfma_f32_16x16x32_bf16 v[236:239], a[248:251], a[92:95], v[236:239]
s_waitcnt lgkmcnt(3)
v_mfma_f32_16x16x32_bf16 v[240:243], a[252:255], a[80:83], v[240:243]
ds_read_b128 a[244:247], v14 offset:51200
v_lshl_or_b32 v117, v113, 8, v105
v_mfma_f32_16x16x32_bf16 v[244:247], a[252:255], a[84:87], v[244:247]
v_mfma_f32_16x16x32_bf16 v[248:251], a[252:255], a[88:91], v[248:251]
s_waitcnt vmcnt(9)
v_cmp_ne_u64 s[50:51], s[88:89], v[90:91]
v_cmp_ne_u64 s[44:45], s[88:89], v[94:95]
v_mfma_f32_16x16x32_bf16 v[252:255], a[252:255], a[92:95], v[252:255]
s_waitcnt lgkmcnt(1)
v_lshl_or_b32 v118, v114, 8, v106
v_mfma_f32_16x16x32_bf16 v[128:131], a[240:243], a[96:99], v[128:131]
s_or_b64 s[50:51], s[44:45], s[50:51]
ds_read_b128 a[248:251], v14 offset:53248
v_mfma_f32_16x16x32_bf16 v[132:135], a[240:243], a[100:103], v[132:135]
s_cbranch_scc1 L_SLOW7
L_BACK7:
v_mfma_f32_16x16x32_bf16 v[136:139], a[240:243], a[104:107], v[136:139]
s_add_u32 m0, s33, 155008
v_perm_b32 v63, v88, v19, s52
v_lshl_or_b32 v119, v115, 8, v107
v_mfma_f32_16x16x32_bf16 v[140:143], a[240:243], a[108:111], v[140:143]
s_waitcnt lgkmcnt(1)
ds_read_b32 a112, v63
v_mfma_f32_16x16x32_bf16 v[144:147], a[244:247], a[96:99], v[144:147]
ds_read_b128 a[252:255], v14 offset:55296
buffer_load_dwordx4 v10, s[20:23], 0 offen offset:640 lds
v_mfma_f32_16x16x32_bf16 v[148:151], a[244:247], a[100:103], v[148:151]
v_perm_b32 v62, v88, v19, s53
v_lshl_or_b32 v108, v117, 16, v116
v_mfma_f32_16x16x32_bf16 v[152:155], a[244:247], a[104:107], v[152:155]
ds_read_b32 a113, v62
v_perm_b32 v61, v92, v19, s52
v_mfma_f32_16x16x32_bf16 v[156:159], a[244:247], a[108:111], v[156:159]
s_waitcnt lgkmcnt(3)
ds_read_b32 a114, v61
v_perm_b32 v60, v92, v19, s53
v_mfma_f32_16x16x32_bf16 v[160:163], a[248:251], a[96:99], v[160:163]
ds_read_b128 a[240:243], v14 offset:57344
v_lshl_or_b32 v109, v119, 16, v118
v_mfma_f32_16x16x32_bf16 v[164:167], a[248:251], a[100:103], v[164:167]
ds_read_b32 a115, v60
v_perm_b32 v59, v88, v19, s54
v_mfma_f32_16x16x32_bf16 v[168:171], a[248:251], a[104:107], v[168:171]
ds_read_b32 a116, v59
v_perm_b32 v58, v88, v19, s55
v_mfma_f32_16x16x32_bf16 v[172:175], a[248:251], a[108:111], v[172:175]
s_waitcnt lgkmcnt(4)
ds_read_b32 a117, v58
v_mov_b64 v[110:111], s[88:89]
v_mfma_f32_16x16x32_bf16 v[176:179], a[252:255], a[96:99], v[176:179]
ds_read_b128 a[244:247], v14 offset:59392
v_perm_b32 v57, v92, v19, s54
v_mfma_f32_16x16x32_bf16 v[180:183], a[252:255], a[100:103], v[180:183]
ds_read_b32 a118, v57
v_perm_b32 v56, v92, v19, s55
v_mfma_f32_16x16x32_bf16 v[184:187], a[252:255], a[104:107], v[184:187]
s_add_u32 m0, s33, 159104
ds_read_b32 a119, v56
v_perm_b32 v63, v89, v19, s52
v_mfma_f32_16x16x32_bf16 v[188:191], a[252:255], a[108:111], v[188:191]
s_waitcnt lgkmcnt(4)
ds_read_b32 a120, v63
v_perm_b32 v62, v89, v19, s53
v_mfma_f32_16x16x32_bf16 v[192:195], a[240:243], a[96:99], v[192:195]
ds_read_b128 a[248:251], v14 offset:61440
buffer_load_dwordx4 v11, s[20:23], 0 offen offset:640 lds
v_mfma_f32_16x16x32_bf16 v[196:199], a[240:243], a[100:103], v[196:199]
buffer_store_dwordx4 v[108:111], v13, s[76:79], 0 offen sc1
v_mfma_f32_16x16x32_bf16 v[200:203], a[240:243], a[104:107], v[200:203]
ds_read_b32 a121, v62
v_perm_b32 v61, v93, v19, s52
v_mfma_f32_16x16x32_bf16 v[204:207], a[240:243], a[108:111], v[204:207]
s_waitcnt lgkmcnt(3)
ds_read_b32 a122, v61
buffer_load_dwordx4 v[48:51], v12, s[24:27], 0 offen offset:0 sc1
v_mfma_f32_16x16x32_bf16 v[208:211], a[244:247], a[96:99], v[208:211]
ds_read_b128 a[252:255], v14 offset:63488
v_perm_b32 v60, v93, v19, s53
v_mfma_f32_16x16x32_bf16 v[212:215], a[244:247], a[100:103], v[212:215]
ds_read_b32 a123, v60
v_perm_b32 v59, v89, v19, s54
v_mfma_f32_16x16x32_bf16 v[216:219], a[244:247], a[104:107], v[216:219]
ds_read_b32 a124, v59
v_perm_b32 v58, v89, v19, s55
v_mfma_f32_16x16x32_bf16 v[220:223], a[244:247], a[108:111], v[220:223]
s_waitcnt lgkmcnt(4)
ds_read_b32 a125, v58
buffer_load_dwordx4 v[52:55], v12, s[24:27], 0 offen offset:1024 sc1
v_mfma_f32_16x16x32_bf16 v[224:227], a[248:251], a[96:99], v[224:227]
ds_read_b128 a[240:243], v15 offset:49152
v_perm_b32 v57, v93, v19, s54
v_mfma_f32_16x16x32_bf16 v[228:231], a[248:251], a[100:103], v[228:231]
ds_read_b32 a126, v57
v_perm_b32 v56, v93, v19, s55
v_mfma_f32_16x16x32_bf16 v[232:235], a[248:251], a[104:107], v[232:235]
ds_read_b32 a127, v56
v_mfma_f32_16x16x32_bf16 v[236:239], a[248:251], a[108:111], v[236:239]
s_waitcnt lgkmcnt(4)
v_mfma_f32_16x16x32_bf16 v[240:243], a[252:255], a[96:99], v[240:243]
ds_read_b128 a[244:247], v15 offset:51200
v_mfma_f32_16x16x32_bf16 v[244:247], a[252:255], a[100:103], v[244:247]
v_mfma_f32_16x16x32_bf16 v[248:251], a[252:255], a[104:107], v[248:251]
v_mfma_f32_16x16x32_bf16 v[252:255], a[252:255], a[108:111], v[252:255]
s_waitcnt vmcnt(10) lgkmcnt(1)
v_cmp_ne_u64 s[50:51], s[88:89], v[34:35]
v_cmp_ne_u64 s[44:45], s[88:89], v[38:39]
v_mfma_f32_16x16x32_bf16 v[128:131], a[240:243], a[112:115], v[128:131]
ds_read_b128 a[248:251], v15 offset:53248
v_mfma_f32_16x16x32_bf16 v[132:135], a[240:243], a[116:119], v[132:135]
s_or_b64 s[50:51], s[44:45], s[50:51]
v_mfma_f32_16x16x32_bf16 v[136:139], a[240:243], a[120:123], v[136:139]
s_cbranch_scc1 L_SLOW8
L_BACK8:
v_mfma_f32_16x16x32_bf16 v[140:143], a[240:243], a[124:127], v[140:143]
s_waitcnt lgkmcnt(1)
v_mfma_f32_16x16x32_bf16 v[144:147], a[244:247], a[112:115], v[144:147]
ds_read_b128 a[252:255], v15 offset:55296
v_mfma_f32_16x16x32_bf16 v[148:151], a[244:247], a[116:119], v[148:151]
v_perm_b32 v63, v32, v19, s52
v_mfma_f32_16x16x32_bf16 v[152:155], a[244:247], a[120:123], v[152:155]
s_add_u32 m0, s33, 64768
ds_read_b32 a128, v63
v_perm_b32 v62, v32, v19, s53
v_mfma_f32_16x16x32_bf16 v[156:159], a[244:247], a[124:127], v[156:159]
s_waitcnt lgkmcnt(2)
ds_read_b32 a129, v62
v_perm_b32 v61, v36, v19, s52
v_mfma_f32_16x16x32_bf16 v[160:163], a[248:251], a[112:115], v[160:163]
ds_read_b128 a[240:243], v15 offset:57344
buffer_load_dwordx4 v8, s[20:23], 0 offen offset:768 lds
v_mfma_f32_16x16x32_bf16 v[164:167], a[248:251], a[116:119], v[164:167]
ds_read_b32 a130, v61
v_perm_b32 v60, v36, v19, s53
v_mfma_f32_16x16x32_bf16 v[168:171], a[248:251], a[120:123], v[168:171]
ds_read_b32 a131, v60
v_perm_b32 v59, v32, v19, s54
v_mfma_f32_16x16x32_bf16 v[172:175], a[248:251], a[124:127], v[172:175]
s_waitcnt lgkmcnt(4)
ds_read_b32 a132, v59
buffer_load_dwordx4 v[96:99], v12, s[24:27], 0 offen offset:2048 sc1
v_mfma_f32_16x16x32_bf16 v[176:179], a[252:255], a[112:115], v[176:179]
s_waitcnt vmcnt(11)
s_barrier
ds_read_b128 a[244:247], v15 offset:59392
v_perm_b32 v58, v32, v19, s55
v_mfma_f32_16x16x32_bf16 v[180:183], a[252:255], a[116:119], v[180:183]
ds_read_b32 a133, v58
v_perm_b32 v57, v36, v19, s54
v_mfma_f32_16x16x32_bf16 v[184:187], a[252:255], a[120:123], v[184:187]
ds_read_b32 a134, v57
v_perm_b32 v56, v36, v19, s55
v_mfma_f32_16x16x32_bf16 v[188:191], a[252:255], a[124:127], v[188:191]
s_waitcnt lgkmcnt(4)
ds_read_b32 a135, v56
buffer_load_dwordx4 v[100:103], v12, s[24:27], 0 offen offset:3072 sc1
v_mfma_f32_16x16x32_bf16 v[192:195], a[240:243], a[112:115], v[192:195]
ds_read_b128 a[248:251], v15 offset:61440
v_perm_b32 v63, v33, v19, s52
v_mfma_f32_16x16x32_bf16 v[196:199], a[240:243], a[116:119], v[196:199]
ds_read_b32 a136, v63
v_perm_b32 v62, v33, v19, s53
v_mfma_f32_16x16x32_bf16 v[200:203], a[240:243], a[120:123], v[200:203]
ds_read_b32 a137, v62
v_perm_b32 v61, v37, v19, s52
v_mfma_f32_16x16x32_bf16 v[204:207], a[240:243], a[124:127], v[204:207]
s_waitcnt lgkmcnt(4)
ds_read_b32 a138, v61
v_add_u32 v12, 24576, v13
v_mfma_f32_16x16x32_bf16 v[208:211], a[244:247], a[112:115], v[208:211]
ds_read_b128 a[252:255], v15 offset:63488
v_perm_b32 v60, v37, v19, s53
v_mfma_f32_16x16x32_bf16 v[212:215], a[244:247], a[116:119], v[212:215]
ds_read_b32 a139, v60
v_perm_b32 v59, v33, v19, s54
v_mfma_f32_16x16x32_bf16 v[216:219], a[244:247], a[120:123], v[216:219]
s_add_u32 m0, s33, 68864
ds_read_b32 a140, v59
v_perm_b32 v58, v33, v19, s55
v_mfma_f32_16x16x32_bf16 v[220:223], a[244:247], a[124:127], v[220:223]
s_waitcnt lgkmcnt(4)
ds_read_b32 a141, v58
v_perm_b32 v57, v37, v19, s54
v_mfma_f32_16x16x32_bf16 v[224:227], a[248:251], a[112:115], v[224:227]
ds_read_b128 a[240:243], v16 offset:0
buffer_load_dwordx4 v9, s[20:23], 0 offen offset:768 lds
v_mfma_f32_16x16x32_bf16 v[228:231], a[248:251], a[116:119], v[228:231]
ds_read_b32 a142, v57
v_perm_b32 v56, v37, v19, s55
v_mfma_f32_16x16x32_bf16 v[232:235], a[248:251], a[120:123], v[232:235]
ds_read_b32 a143, v56
v_mfma_f32_16x16x32_bf16 v[236:239], a[248:251], a[124:127], v[236:239]
s_waitcnt lgkmcnt(4)
v_mfma_f32_16x16x32_bf16 v[240:243], a[252:255], a[112:115], v[240:243]
ds_read_b128 a[244:247], v16 offset:2048
v_mfma_f32_16x16x32_bf16 v[244:247], a[252:255], a[116:119], v[244:247]
v_mfma_f32_16x16x32_bf16 v[248:251], a[252:255], a[120:123], v[248:251]
s_waitcnt vmcnt(10)
v_cmp_ne_u64 s[50:51], s[88:89], v[42:43]
v_cmp_ne_u64 s[44:45], s[88:89], v[46:47]
v_mfma_f32_16x16x32_bf16 v[252:255], a[252:255], a[124:127], v[252:255]
s_waitcnt lgkmcnt(1)
v_mfma_f32_16x16x32_bf16 v[128:131], a[240:243], a[128:131], v[128:131]
s_or_b64 s[50:51], s[44:45], s[50:51]
ds_read_b128 a[248:251], v16 offset:4096
v_mfma_f32_16x16x32_bf16 v[132:135], a[240:243], a[132:135], v[132:135]
s_cbranch_scc1 L_SLOW9
L_BACK9:
v_mfma_f32_16x16x32_bf16 v[136:139], a[240:243], a[136:139], v[136:139]
s_add_u32 m0, s33, 72960
v_mfma_f32_16x16x32_bf16 v[140:143], a[240:243], a[140:143], v[140:143]
s_waitcnt lgkmcnt(1)
v_mfma_f32_16x16x32_bf16 v[144:147], a[244:247], a[128:131], v[144:147]
ds_read_b128 a[252:255], v16 offset:6144
buffer_load_dwordx4 v10, s[20:23], 0 offen offset:768 lds
v_mfma_f32_16x16x32_bf16 v[148:151], a[244:247], a[132:135], v[148:151]
v_perm_b32 v63, v40, v19, s52
v_mfma_f32_16x16x32_bf16 v[152:155], a[244:247], a[136:139], v[152:155]
ds_read_b32 a144, v63
v_perm_b32 v62, v40, v19, s53
v_mfma_f32_16x16x32_bf16 v[156:159], a[244:247], a[140:143], v[156:159]
s_waitcnt lgkmcnt(2)
ds_read_b32 a145, v62
v_mfma_f32_16x16x32_bf16 v[160:163], a[248:251], a[128:131], v[160:163]
ds_read_b128 a[240:243], v16 offset:8192
v_perm_b32 v61, v44, v19, s52
v_mfma_f32_16x16x32_bf16 v[164:167], a[248:251], a[132:135], v[164:167]
ds_read_b32 a146, v61
v_perm_b32 v60, v44, v19, s53
v_mfma_f32_16x16x32_bf16 v[168:171], a[248:251], a[136:139], v[168:171]
ds_read_b32 a147, v60
v_perm_b32 v59, v40, v19, s54
v_mfma_f32_16x16x32_bf16 v[172:175], a[248:251], a[140:143], v[172:175]
s_waitcnt lgkmcnt(4)
ds_read_b32 a148, v59
buffer_load_dwordx4 v[80:83], v12, s[24:27], 0 offen offset:0 sc1
v_mfma_f32_16x16x32_bf16 v[176:179], a[252:255], a[128:131], v[176:179]
ds_read_b128 a[244:247], v16 offset:10240
v_perm_b32 v58, v40, v19, s55
v_mfma_f32_16x16x32_bf16 v[180:183], a[252:255], a[132:135], v[180:183]
ds_read_b32 a149, v58
v_perm_b32 v57, v44, v19, s54
v_mfma_f32_16x16x32_bf16 v[184:187], a[252:255], a[136:139], v[184:187]
s_add_u32 m0, s33, 77056
ds_read_b32 a150, v57
v_perm_b32 v56, v44, v19, s55
v_mfma_f32_16x16x32_bf16 v[188:191], a[252:255], a[140:143], v[188:191]
s_waitcnt lgkmcnt(4)
ds_read_b32 a151, v56
v_perm_b32 v63, v41, v19, s52
v_mfma_f32_16x16x32_bf16 v[192:195], a[240:243], a[128:131], v[192:195]
ds_read_b128 a[248:251], v16 offset:12288
buffer_load_dwordx4 v11, s[20:23], 0 offen offset:768 lds
v_mfma_f32_16x16x32_bf16 v[196:199], a[240:243], a[132:135], v[196:199]
ds_read_b32 a152, v63
v_perm_b32 v62, v41, v19, s53
v_mfma_f32_16x16x32_bf16 v[200:203], a[240:243], a[136:139], v[200:203]
ds_read_b32 a153, v62
v_perm_b32 v61, v45, v19, s52
v_mfma_f32_16x16x32_bf16 v[204:207], a[240:243], a[140:143], v[204:207]
s_waitcnt lgkmcnt(4)
ds_read_b32 a154, v61
buffer_load_dwordx4 v[84:87], v12, s[24:27], 0 offen offset:1024 sc1
v_mfma_f32_16x16x32_bf16 v[208:211], a[244:247], a[128:131], v[208:211]
ds_read_b128 a[252:255], v16 offset:14336
v_perm_b32 v60, v45, v19, s53
v_mfma_f32_16x16x32_bf16 v[212:215], a[244:247], a[132:135], v[212:215]
ds_read_b32 a155, v60
v_perm_b32 v59, v41, v19, s54
v_mfma_f32_16x16x32_bf16 v[216:219], a[244:247], a[136:139], v[216:219]
ds_read_b32 a156, v59
v_perm_b32 v58, v41, v19, s55
v_mfma_f32_16x16x32_bf16 v[220:223], a[244:247], a[140:143], v[220:223]
s_waitcnt lgkmcnt(4)
ds_read_b32 a157, v58
v_mfma_f32_16x16x32_bf16 v[224:227], a[248:251], a[128:131], v[224:227]
ds_read_b128 a[240:243], v17 offset:0
v_perm_b32 v57, v45, v19, s54
v_mfma_f32_16x16x32_bf16 v[228:231], a[248:251], a[132:135], v[228:231]
ds_read_b32 a158, v57
v_perm_b32 v56, v45, v19, s55
v_mfma_f32_16x16x32_bf16 v[232:235], a[248:251], a[136:139], v[232:235]
ds_read_b32 a159, v56
v_mfma_f32_16x16x32_bf16 v[236:239], a[248:251], a[140:143], v[236:239]
s_waitcnt lgkmcnt(4)
v_mfma_f32_16x16x32_bf16 v[240:243], a[252:255], a[128:131], v[240:243]
ds_read_b128 a[244:247], v17 offset:2048
v_mfma_f32_16x16x32_bf16 v[244:247], a[252:255], a[132:135], v[244:247]
v_mfma_f32_16x16x32_bf16 v[248:251], a[252:255], a[136:139], v[248:251]
s_add_u32 m0, s33, 81024
v_mfma_f32_16x16x32_bf16 v[252:255], a[252:255], a[140:143], v[252:255]
s_waitcnt vmcnt(8) lgkmcnt(1)
v_cmp_ne_u64 s[50:51], s[88:89], v[50:51]
v_cmp_ne_u64 s[44:45], s[88:89], v[54:55]
v_mfma_f32_16x16x32_bf16 v[128:131], a[240:243], a[144:147], v[128:131]
ds_read_b128 a[248:251], v17 offset:4096
buffer_load_dwordx4 v8, s[20:23], 0 offen offset:896 lds
v_mfma_f32_16x16x32_bf16 v[132:135], a[240:243], a[148:151], v[132:135]
s_or_b64 s[50:51], s[44:45], s[50:51]
v_mfma_f32_16x16x32_bf16 v[136:139], a[240:243], a[152:155], v[136:139]
s_cbranch_scc1 L_SLOW10
L_BACK10:
v_mfma_f32_16x16x32_bf16 v[140:143], a[240:243], a[156:159], v[140:143]
s_waitcnt lgkmcnt(1)
v_mfma_f32_16x16x32_bf16 v[144:147], a[244:247], a[144:147], v[144:147]
ds_read_b128 a[252:255], v17 offset:6144
v_mfma_f32_16x16x32_bf16 v[148:151], a[244:247], a[148:151], v[148:151]
v_perm_b32 v63, v48, v19, s52
v_mfma_f32_16x16x32_bf16 v[152:155], a[244:247], a[152:155], v[152:155]
s_add_u32 m0, s33, 85120
ds_read_b32 a160, v63
v_perm_b32 v62, v48, v19, s53
v_mfma_f32_16x16x32_bf16 v[156:159], a[244:247], a[156:159], v[156:159]
s_waitcnt lgkmcnt(2)
ds_read_b32 a161, v62
v_perm_b32 v61, v52, v19, s52
v_mfma_f32_16x16x32_bf16 v[160:163], a[248:251], a[144:147], v[160:163]
ds_read_b128 a[240:243], v17 offset:8192
buffer_load_dwordx4 v9, s[20:23], 0 offen offset:896 lds
v_mfma_f32_16x16x32_bf16 v[164:167], a[248:251], a[148:151], v[164:167]
ds_read_b32 a162, v61
v_perm_b32 v60, v52, v19, s53
v_mfma_f32_16x16x32_bf16 v[168:171], a[248:251], a[152:155], v[168:171]
ds_read_b32 a163, v60
v_perm_b32 v59, v48, v19, s54
v_mfma_f32_16x16x32_bf16 v[172:175], a[248:251], a[156:159], v[172:175]
s_waitcnt lgkmcnt(4)
ds_read_b32 a164, v59
buffer_load_dwordx4 v[88:91], v12, s[24:27], 0 offen offset:2048 sc1
v_mfma_f32_16x16x32_bf16 v[176:179], a[252:255], a[144:147], v[176:179]
s_barrier
ds_read_b128 a[244:247], v17 offset:10240
v_perm_b32 v58, v48, v19, s55
v_mfma_f32_16x16x32_bf16 v[180:183], a[252:255], a[148:151], v[180:183]
ds_read_b32 a165, v58
v_perm_b32 v57, v52, v19, s54
v_mfma_f32_16x16x32_bf16 v[184:187], a[252:255], a[152:155], v[184:187]
ds_read_b32 a166, v57
v_perm_b32 v56, v52, v19, s55
v_mfma_f32_16x16x32_bf16 v[188:191], a[252:255], a[156:159], v[188:191]
s_waitcnt lgkmcnt(4)
ds_read_b32 a167, v56
buffer_load_dwordx4 v[92:95], v12, s[24:27], 0 offen offset:3072 sc1
v_mfma_f32_16x16x32_bf16 v[192:195], a[240:243], a[144:147], v[192:195]
ds_read_b128 a[248:251], v17 offset:12288
v_perm_b32 v63, v49, v19, s52
v_mfma_f32_16x16x32_bf16 v[196:199], a[240:243], a[148:151], v[196:199]
ds_read_b32 a168, v63
v_perm_b32 v62, v49, v19, s53
v_mfma_f32_16x16x32_bf16 v[200:203], a[240:243], a[152:155], v[200:203]
ds_read_b32 a169, v62
v_perm_b32 v61, v53, v19, s52
v_mfma_f32_16x16x32_bf16 v[204:207], a[240:243], a[156:159], v[204:207]
s_waitcnt lgkmcnt(4)
ds_read_b32 a170, v61
v_add_u32 v12, 28672, v13
v_mfma_f32_16x16x32_bf16 v[208:211], a[244:247], a[144:147], v[208:211]
ds_read_b128 a[252:255], v17 offset:14336
v_perm_b32 v60, v53, v19, s53
v_mfma_f32_16x16x32_bf16 v[212:215], a[244:247], a[148:151], v[212:215]
ds_read_b32 a171, v60
v_perm_b32 v59, v49, v19, s54
v_mfma_f32_16x16x32_bf16 v[216:219], a[244:247], a[152:155], v[216:219]
s_add_u32 m0, s33, 89216
ds_read_b32 a172, v59
v_perm_b32 v58, v49, v19, s55
v_mfma_f32_16x16x32_bf16 v[220:223], a[244:247], a[156:159], v[220:223]
s_waitcnt lgkmcnt(4)
ds_read_b32 a173, v58
v_perm_b32 v57, v53, v19, s54
v_mfma_f32_16x16x32_bf16 v[224:227], a[248:251], a[144:147], v[224:227]
ds_read_b128 a[240:243], v16 offset:16384
buffer_load_dwordx4 v10, s[20:23], 0 offen offset:896 lds
v_mfma_f32_16x16x32_bf16 v[228:231], a[248:251], a[148:151], v[228:231]
ds_read_b32 a174, v57
v_perm_b32 v56, v53, v19, s55
v_mfma_f32_16x16x32_bf16 v[232:235], a[248:251], a[152:155], v[232:235]
ds_read_b32 a175, v56
v_mfma_f32_16x16x32_bf16 v[236:239], a[248:251], a[156:159], v[236:239]
s_waitcnt lgkmcnt(4)
v_mfma_f32_16x16x32_bf16 v[240:243], a[252:255], a[144:147], v[240:243]
ds_read_b128 a[244:247], v16 offset:18432
v_mfma_f32_16x16x32_bf16 v[244:247], a[252:255], a[148:151], v[244:247]
v_mfma_f32_16x16x32_bf16 v[248:251], a[252:255], a[152:155], v[248:251]
s_waitcnt vmcnt(10)
v_cmp_ne_u64 s[50:51], s[88:89], v[98:99]
v_cmp_ne_u64 s[44:45], s[88:89], v[102:103]
v_mfma_f32_16x16x32_bf16 v[252:255], a[252:255], a[156:159], v[252:255]
s_waitcnt lgkmcnt(1)
v_mfma_f32_16x16x32_bf16 v[128:131], a[240:243], a[160:163], v[128:131]
s_or_b64 s[50:51], s[44:45], s[50:51]
ds_read_b128 a[248:251], v16 offset:20480
v_mfma_f32_16x16x32_bf16 v[132:135], a[240:243], a[164:167], v[132:135]
s_cbranch_scc1 L_SLOW11
L_BACK11:
v_mfma_f32_16x16x32_bf16 v[136:139], a[240:243], a[168:171], v[136:139]
s_add_u32 m0, s33, 93312
v_mfma_f32_16x16x32_bf16 v[140:143], a[240:243], a[172:175], v[140:143]
s_waitcnt lgkmcnt(1)
v_mfma_f32_16x16x32_bf16 v[144:147], a[244:247], a[160:163], v[144:147]
ds_read_b128 a[252:255], v16 offset:22528
buffer_load_dwordx4 v11, s[20:23], 0 offen offset:896 lds
v_mfma_f32_16x16x32_bf16 v[148:151], a[244:247], a[164:167], v[148:151]
v_perm_b32 v63, v96, v19, s52
v_mfma_f32_16x16x32_bf16 v[152:155], a[244:247], a[168:171], v[152:155]
ds_read_b32 a176, v63
v_perm_b32 v62, v96, v19, s53
v_mfma_f32_16x16x32_bf16 v[156:159], a[244:247], a[172:175], v[156:159]
s_waitcnt lgkmcnt(2)
ds_read_b32 a177, v62
buffer_load_dwordx4 v[32:35], v12, s[24:27], 0 offen offset:0 sc1
v_mfma_f32_16x16x32_bf16 v[160:163], a[248:251], a[160:163], v[160:163]
ds_read_b128 a[240:243], v16 offset:24576
v_perm_b32 v61, v100, v19, s52
v_mfma_f32_16x16x32_bf16 v[164:167], a[248:251], a[164:167], v[164:167]
ds_read_b32 a178, v61
v_perm_b32 v60, v100, v19, s53
v_mfma_f32_16x16x32_bf16 v[168:171], a[248:251], a[168:171], v[168:171]
ds_read_b32 a179, v60
v_perm_b32 v59, v96, v19, s54
v_mfma_f32_16x16x32_bf16 v[172:175], a[248:251], a[172:175], v[172:175]
s_waitcnt lgkmcnt(4)
ds_read_b32 a180, v59
buffer_load_dwordx4 v[36:39], v12, s[24:27], 0 offen offset:1024 sc1
v_mfma_f32_16x16x32_bf16 v[176:179], a[252:255], a[160:163], v[176:179]
ds_read_b128 a[244:247], v16 offset:26624
v_perm_b32 v58, v96, v19, s55
v_mfma_f32_16x16x32_bf16 v[180:183], a[252:255], a[164:167], v[180:183]
ds_read_b32 a181, v58
v_perm_b32 v57, v100, v19, s54
v_mfma_f32_16x16x32_bf16 v[184:187], a[252:255], a[168:171], v[184:187]
s_add_u32 m0, s33, 97280
ds_read_b32 a182, v57
v_perm_b32 v56, v100, v19, s55
v_mfma_f32_16x16x32_bf16 v[188:191], a[252:255], a[172:175], v[188:191]
s_waitcnt lgkmcnt(4)
ds_read_b32 a183, v56
v_perm_b32 v63, v97, v19, s52
v_mfma_f32_16x16x32_bf16 v[192:195], a[240:243], a[160:163], v[192:195]
ds_read_b128 a[248:251], v16 offset:28672
buffer_load_dwordx4 v8, s[20:23], 0 offen offset:1024 lds
v_mfma_f32_16x16x32_bf16 v[196:199], a[240:243], a[164:167], v[196:199]
ds_read_b32 a184, v63
v_perm_b32 v62, v97, v19, s53
v_mfma_f32_16x16x32_bf16 v[200:203], a[240:243], a[168:171], v[200:203]
ds_read_b32 a185, v62
v_perm_b32 v61, v101, v19, s52
v_mfma_f32_16x16x32_bf16 v[204:207], a[240:243], a[172:175], v[204:207]
L_PAD2:
s_cbranch_vccnz L_PADRET
s_waitcnt lgkmcnt(4)
ds_read_b32 a186, v61
v_mfma_f32_16x16x32_bf16 v[208:211], a[244:247], a[160:163], v[208:211]
ds_read_b128 a[252:255], v16 offset:30720
v_perm_b32 v60, v101, v19, s53
v_mfma_f32_16x16x32_bf16 v[212:215], a[244:247], a[164:167], v[212:215]
ds_read_b32 a187, v60
v_perm_b32 v59, v97, v19, s54
v_mfma_f32_16x16x32_bf16 v[216:219], a[244:247], a[168:171], v[216:219]
ds_read_b32 a188, v59
v_perm_b32 v58, v97, v19, s55
v_mfma_f32_16x16x32_bf16 v[220:223], a[244:247], a[172:175], v[220:223]
s_waitcnt lgkmcnt(4)
ds_read_b32 a189, v58
v_mfma_f32_16x16x32_bf16 v[224:227], a[248:251], a[160:163], v[224:227]
ds_read_b128 a[240:243], v17 offset:16384
v_perm_b32 v57, v101, v19, s54
v_mfma_f32_16x16x32_bf16 v[228:231], a[248:251], a[164:167], v[228:231]
ds_read_b32 a190, v57
v_perm_b32 v56, v101, v19, s55
v_mfma_f32_16x16x32_bf16 v[232:235], a[248:251], a[168:171], v[232:235]
ds_read_b32 a191, v56
v_mfma_f32_16x16x32_bf16 v[236:239], a[248:251], a[172:175], v[236:239]
s_waitcnt lgkmcnt(4)
v_mfma_f32_16x16x32_bf16 v[240:243], a[252:255], a[160:163], v[240:243]
ds_read_b128 a[244:247], v17 offset:18432
v_mfma_f32_16x16x32_bf16 v[244:247], a[252:255], a[164:167], v[244:247]
v_mfma_f32_16x16x32_bf16 v[248:251], a[252:255], a[168:171], v[248:251]
v_mfma_f32_16x16x32_bf16 v[252:255], a[252:255], a[172:175], v[252:255]
s_waitcnt vmcnt(9) lgkmcnt(1)
v_cmp_ne_u64 s[50:51], s[88:89], v[82:83]
v_cmp_ne_u64 s[44:45], s[88:89], v[86:87]
v_mfma_f32_16x16x32_bf16 v[128:131], a[240:243], a[176:179], v[128:131]
ds_read_b128 a[248:251], v17 offset:20480
v_mfma_f32_16x16x32_bf16 v[132:135], a[240:243], a[180:183], v[132:135]
s_or_b64 s[50:51], s[44:45], s[50:51]
v_mfma_f32_16x16x32_bf16 v[136:139], a[240:243], a[184:187], v[136:139]
s_cbranch_scc1 L_SLOW12
L_BACK12:
v_mfma_f32_16x16x32_bf16 v[140:143], a[240:243], a[188:191], v[140:143]
s_waitcnt lgkmcnt(1)
buffer_load_dwordx4 v[40:43], v12, s[24:27], 0 offen offset:2048 sc1
v_mfma_f32_16x16x32_bf16 v[144:147], a[244:247], a[176:179], v[144:147]
ds_read_b128 a[252:255], v17 offset:22528
buffer_load_dwordx4 v[44:47], v12, s[24:27], 0 offen offset:3072 sc1
v_mfma_f32_16x16x32_bf16 v[148:151], a[244:247], a[180:183], v[148:151]
v_perm_b32 v63, v80, v19, s52
v_add_u32 v12, 32768, v13
v_mfma_f32_16x16x32_bf16 v[152:155], a[244:247], a[184:187], v[152:155]
s_add_u32 m0, s33, 101376
ds_read_b32 a192, v63
v_perm_b32 v62, v80, v19, s53
v_mfma_f32_16x16x32_bf16 v[156:159], a[244:247], a[188:191], v[156:159]
s_waitcnt lgkmcnt(2)
ds_read_b32 a193, v62
v_perm_b32 v61, v84, v19, s52
v_mfma_f32_16x16x32_bf16 v[160:163], a[248:251], a[176:179], v[160:163]
ds_read_b128 a[240:243], v17 offset:24576
buffer_load_dwordx4 v9, s[20:23], 0 offen offset:1024 lds
v_mfma_f32_16x16x32_bf16 v[164:167], a[248:251], a[180:183], v[164:167]
ds_read_b32 a194, v61
v_perm_b32 v60, v84, v19, s53
v_mfma_f32_16x16x32_bf16 v[168:171], a[248:251], a[184:187], v[168:171]
ds_read_b32 a195, v60
v_perm_b32 v59, v80, v19, s54
v_mfma_f32_16x16x32_bf16 v[172:175], a[248:251], a[188:191], v[172:175]
s_waitcnt lgkmcnt(4)
ds_read_b32 a196, v59
v_mfma_f32_16x16x32_bf16 v[176:179], a[252:255], a[176:179], v[176:179]
s_barrier
ds_read_b128 a[244:247], v17 offset:26624
v_perm_b32 v58, v80, v19, s55
v_mfma_f32_16x16x32_bf16 v[180:183], a[252:255], a[180:183], v[180:183]
ds_read_b32 a197, v58
v_perm_b32 v57, v84, v19, s54
v_mfma_f32_16x16x32_bf16 v[184:187], a[252:255], a[184:187], v[184:187]
ds_read_b32 a198, v57
v_perm_b32 v56, v84, v19, s55
v_mfma_f32_16x16x32_bf16 v[188:191], a[252:255], a[188:191], v[188:191]
s_waitcnt lgkmcnt(4)
ds_read_b32 a199, v56
v_mfma_f32_16x16x32_bf16 v[192:195], a[240:243], a[176:179], v[192:195]
ds_read_b128 a[248:251], v17 offset:28672
v_perm_b32 v63, v81, v19, s52
v_mfma_f32_16x16x32_bf16 v[196:199], a[240:243], a[180:183], v[196:199]
ds_read_b32 a200, v63
v_perm_b32 v62, v81, v19, s53
v_mfma_f32_16x16x32_bf16 v[200:203], a[240:243], a[184:187], v[200:203]
ds_read_b32 a201, v62
v_perm_b32 v61, v85, v19, s52
v_mfma_f32_16x16x32_bf16 v[204:207], a[240:243], a[188:191], v[204:207]
s_waitcnt lgkmcnt(4)
ds_read_b32 a202, v61
v_mfma_f32_16x16x32_bf16 v[208:211], a[244:247], a[176:179], v[208:211]
ds_read_b128 a[252:255], v17 offset:30720
v_perm_b32 v60, v85, v19, s53
v_mfma_f32_16x16x32_bf16 v[212:215], a[244:247], a[180:183], v[212:215]
ds_read_b32 a203, v60
v_perm_b32 v59, v81, v19, s54
v_mfma_f32_16x16x32_bf16 v[216:219], a[244:247], a[184:187], v[216:219]
s_add_u32 m0, s33, 105472
ds_read_b32 a204, v59
v_perm_b32 v58, v81, v19, s55
v_mfma_f32_16x16x32_bf16 v[220:223], a[244:247], a[188:191], v[220:223]
s_waitcnt lgkmcnt(4)
ds_read_b32 a205, v58
v_perm_b32 v57, v85, v19, s54
v_mfma_f32_16x16x32_bf16 v[224:227], a[248:251], a[176:179], v[224:227]
ds_read_b128 a[240:243], v14 offset:0
buffer_load_dwordx4 v10, s[20:23], 0 offen offset:1024 lds
v_mfma_f32_16x16x32_bf16 v[228:231], a[248:251], a[180:183], v[228:231]
ds_read_b32 a206, v57
v_perm_b32 v56, v85, v19, s55
v_mfma_f32_16x16x32_bf16 v[232:235], a[248:251], a[184:187], v[232:235]
ds_read_b32 a207, v56
v_mfma_f32_16x16x32_bf16 v[236:239], a[248:251], a[188:191], v[236:239]
s_waitcnt lgkmcnt(4)
buffer_load_dwordx4 v[48:51], v12, s[24:27], 0 offen offset:0 sc1
v_mfma_f32_16x16x32_bf16 v[240:243], a[252:255], a[176:179], v[240:243]
ds_read_b128 a[244:247], v14 offset:2048
buffer_load_dwordx4 v[52:55], v12, s[24:27], 0 offen offset:1024 sc1
v_mfma_f32_16x16x32_bf16 v[244:247], a[252:255], a[180:183], v[244:247]
v_mfma_f32_16x16x32_bf16 v[248:251], a[252:255], a[184:187], v[248:251]
s_waitcnt vmcnt(11)
v_cmp_ne_u64 s[50:51], s[88:89], v[90:91]
v_cmp_ne_u64 s[44:45], s[88:89], v[94:95]
v_mfma_f32_16x16x32_bf16 v[252:255], a[252:255], a[188:191], v[252:255]
s_waitcnt lgkmcnt(1)
v_mfma_f32_16x16x32_bf16 v[128:131], a[240:243], a[192:195], v[128:131]
s_or_b64 s[50:51], s[44:45], s[50:51]
ds_read_b128 a[248:251], v14 offset:4096
v_mfma_f32_16x16x32_bf16 v[132:135], a[240:243], a[196:199], v[132:135]
s_cbranch_scc1 L_SLOW13
L_BACK13:
v_mfma_f32_16x16x32_bf16 v[136:139], a[240:243], a[200:203], v[136:139]
s_add_u32 m0, s33, 109440
v_mfma_f32_16x16x32_bf16 v[140:143], a[240:243], a[204:207], v[140:143]
s_waitcnt lgkmcnt(1)
v_mfma_f32_16x16x32_bf16 v[144:147], a[244:247], a[192:195], v[144:147]
ds_read_b128 a[252:255], v14 offset:6144
buffer_load_dwordx4 v8, s[20:23], 0 offen offset:1152 lds
v_mfma_f32_16x16x32_bf16 v[148:151], a[244:247], a[196:199], v[148:151]
v_perm_b32 v63, v88, v19, s52
v_mfma_f32_16x16x32_bf16 v[152:155], a[244:247], a[200:203], v[152:155]
ds_read_b32 a208, v63
v_perm_b32 v62, v88, v19, s53
v_mfma_f32_16x16x32_bf16 v[156:159], a[244:247], a[204:207], v[156:159]
s_waitcnt lgkmcnt(2)
ds_read_b32 a209, v62
v_mfma_f32_16x16x32_bf16 v[160:163], a[248:251], a[192:195], v[160:163]
ds_read_b128 a[240:243], v14 offset:8192
v_perm_b32 v61, v92, v19, s52
v_mfma_f32_16x16x32_bf16 v[164:167], a[248:251], a[196:199], v[164:167]
ds_read_b32 a210, v61
v_perm_b32 v60, v92, v19, s53
v_mfma_f32_16x16x32_bf16 v[168:171], a[248:251], a[200:203], v[168:171]
ds_read_b32 a211, v60
v_perm_b32 v59, v88, v19, s54
v_mfma_f32_16x16x32_bf16 v[172:175], a[248:251], a[204:207], v[172:175]
s_waitcnt lgkmcnt(4)
ds_read_b32 a212, v59
v_mfma_f32_16x16x32_bf16 v[176:179], a[252:255], a[192:195], v[176:179]
ds_read_b128 a[244:247], v14 offset:10240
v_perm_b32 v58, v88, v19, s55
v_mfma_f32_16x16x32_bf16 v[180:183], a[252:255], a[196:199], v[180:183]
ds_read_b32 a213, v58
v_perm_b32 v57, v92, v19, s54
v_mfma_f32_16x16x32_bf16 v[184:187], a[252:255], a[200:203], v[184:187]
s_add_u32 m0, s33, 113664
ds_read_b32 a214, v57
v_perm_b32 v56, v92, v19, s55
v_mfma_f32_16x16x32_bf16 v[188:191], a[252:255], a[204:207], v[188:191]
s_waitcnt lgkmcnt(4)
ds_read_b32 a215, v56
v_perm_b32 v63, v89, v19, s52
v_mfma_f32_16x16x32_bf16 v[192:195], a[240:243], a[192:195], v[192:195]
ds_read_b128 a[248:251], v14 offset:12288
buffer_load_dwordx4 v11, s[20:23], 0 offen offset:1024 lds
v_mfma_f32_16x16x32_bf16 v[196:199], a[240:243], a[196:199], v[196:199]
ds_read_b32 a216, v63
v_perm_b32 v62, v89, v19, s53
v_mfma_f32_16x16x32_bf16 v[200:203], a[240:243], a[200:203], v[200:203]
ds_read_b32 a217, v62
v_perm_b32 v61, v93, v19, s52
v_mfma_f32_16x16x32_bf16 v[204:207], a[240:243], a[204:207], v[204:207]
s_waitcnt lgkmcnt(4)
ds_read_b32 a218, v61
buffer_load_dwordx4 v[96:99], v12, s[24:27], 0 offen offset:2048 sc1
v_mfma_f32_16x16x32_bf16 v[208:211], a[244:247], a[192:195], v[208:211]
ds_read_b128 a[252:255], v14 offset:14336
v_perm_b32 v60, v93, v19, s53
v_mfma_f32_16x16x32_bf16 v[212:215], a[244:247], a[196:199], v[212:215]
ds_read_b32 a219, v60
v_perm_b32 v59, v89, v19, s54
v_mfma_f32_16x16x32_bf16 v[216:219], a[244:247], a[200:203], v[216:219]
ds_read_b32 a220, v59
v_perm_b32 v58, v89, v19, s55
v_mfma_f32_16x16x32_bf16 v[220:223], a[244:247], a[204:207], v[220:223]
s_waitcnt lgkmcnt(4)
ds_read_b32 a221, v58
buffer_load_dwordx4 v[100:103], v12, s[24:27], 0 offen offset:3072 sc1
v_mfma_f32_16x16x32_bf16 v[224:227], a[248:251], a[192:195], v[224:227]
ds_read_b128 a[240:243], v15 offset:0
v_perm_b32 v57, v93, v19, s54
v_mfma_f32_16x16x32_bf16 v[228:231], a[248:251], a[196:199], v[228:231]
ds_read_b32 a222, v57
v_perm_b32 v56, v93, v19, s55
v_mfma_f32_16x16x32_bf16 v[232:235], a[248:251], a[200:203], v[232:235]
ds_read_b32 a223, v56
v_add_u32 v12, 36864, v13
v_mfma_f32_16x16x32_bf16 v[236:239], a[248:251], a[204:207], v[236:239]
s_waitcnt vmcnt(11) lgkmcnt(4)
v_cmp_ne_u64 s[50:51], s[88:89], v[34:35]
v_cmp_ne_u64 s[44:45], s[88:89], v[38:39]
v_mfma_f32_16x16x32_bf16 v[240:243], a[252:255], a[192:195], v[240:243]
ds_read_b128 a[244:247], v15 offset:2048
v_mfma_f32_16x16x32_bf16 v[244:247], a[252:255], a[196:199], v[244:247]
s_or_b64 s[50:51], s[44:45], s[50:51]
v_mfma_f32_16x16x32_bf16 v[248:251], a[252:255], a[200:203], v[248:251]
s_cbranch_scc1 L_SLOW14
L_BACK14:
v_mfma_f32_16x16x32_bf16 v[252:255], a[252:255], a[204:207], v[252:255]
s_waitcnt lgkmcnt(1)
v_mfma_f32_16x16x32_bf16 v[128:131], a[240:243], a[208:211], v[128:131]
ds_read_b128 a[248:251], v15 offset:4096
v_perm_b32 v63, v32, v19, s52
v_mfma_f32_16x16x32_bf16 v[132:135], a[240:243], a[212:215], v[132:135]
ds_read_b32 a224, v63
v_perm_b32 v62, v32, v19, s53
v_mfma_f32_16x16x32_bf16 v[136:139], a[240:243], a[216:219], v[136:139]
ds_read_b32 a225, v62
v_perm_b32 v61, v36, v19, s52
v_mfma_f32_16x16x32_bf16 v[140:143], a[240:243], a[220:223], v[140:143]
s_waitcnt lgkmcnt(3)
ds_read_b32 a226, v61
v_mfma_f32_16x16x32_bf16 v[144:147], a[244:247], a[208:211], v[144:147]
ds_read_b128 a[252:255], v15 offset:6144
v_perm_b32 v60, v36, v19, s53
v_mfma_f32_16x16x32_bf16 v[148:151], a[244:247], a[212:215], v[148:151]
ds_read_b32 a227, v60
v_perm_b32 v59, v32, v19, s54
v_mfma_f32_16x16x32_bf16 v[152:155], a[244:247], a[216:219], v[152:155]
s_add_u32 m0, s33, 117632
ds_read_b32 a228, v59
v_perm_b32 v58, v32, v19, s55
v_mfma_f32_16x16x32_bf16 v[156:159], a[244:247], a[220:223], v[156:159]
s_waitcnt lgkmcnt(4)
ds_read_b32 a229, v58
v_perm_b32 v57, v36, v19, s54
v_mfma_f32_16x16x32_bf16 v[160:163], a[248:251], a[208:211], v[160:163]
ds_read_b128 a[240:243], v15 offset:8192
buffer_load_dwordx4 v9, s[20:23], 0 offen offset:1152 lds
v_mfma_f32_16x16x32_bf16 v[164:167], a[248:251], a[212:215], v[164:167]
ds_read_b32 a230, v57
v_perm_b32 v56, v36, v19, s55
v_mfma_f32_16x16x32_bf16 v[168:171], a[248:251], a[216:219], v[168:171]
ds_read_b32 a231, v56
v_perm_b32 v63, v33, v19, s52
v_mfma_f32_16x16x32_bf16 v[172:175], a[248:251], a[220:223], v[172:175]
s_waitcnt lgkmcnt(4)
ds_read_b32 a232, v63
v_mfma_f32_16x16x32_bf16 v[176:179], a[252:255], a[208:211], v[176:179]
s_waitcnt vmcnt(11)
s_barrier
ds_read_b128 a[244:247], v15 offset:10240
v_perm_b32 v62, v33, v19, s53
v_mfma_f32_16x16x32_bf16 v[180:183], a[252:255], a[212:215], v[180:183]
ds_read_b32 a233, v62
v_perm_b32 v61, v37, v19, s52
v_mfma_f32_16x16x32_bf16 v[184:187], a[252:255], a[216:219], v[184:187]
ds_read_b32 a234, v61
v_perm_b32 v60, v37, v19, s53
v_mfma_f32_16x16x32_bf16 v[188:191], a[252:255], a[220:223], v[188:191]
s_waitcnt lgkmcnt(4)
ds_read_b32 a235, v60
buffer_load_dwordx4 v[80:83], v12, s[24:27], 0 offen offset:0 sc1
v_mfma_f32_16x16x32_bf16 v[192:195], a[240:243], a[208:211], v[192:195]
ds_read_b128 a[248:251], v15 offset:12288
v_perm_b32 v59, v33, v19, s54
v_mfma_f32_16x16x32_bf16 v[196:199], a[240:243], a[212:215], v[196:199]
ds_read_b32 a236, v59
v_perm_b32 v58, v33, v19, s55
v_mfma_f32_16x16x32_bf16 v[200:203], a[240:243], a[216:219], v[200:203]
ds_read_b32 a237, v58
v_perm_b32 v57, v37, v19, s54
v_mfma_f32_16x16x32_bf16 v[204:207], a[240:243], a[220:223], v[204:207]
s_waitcnt lgkmcnt(4)
ds_read_b32 a238, v57
buffer_load_dwordx4 v[84:87], v12, s[24:27], 0 offen offset:1024 sc1
v_mfma_f32_16x16x32_bf16 v[208:211], a[244:247], a[208:211], v[208:211]
ds_read_b128 a[252:255], v14 offset:16384
v_perm_b32 v56, v37, v19, s55
v_mfma_f32_16x16x32_bf16 v[212:215], a[244:247], a[212:215], v[212:215]
ds_read_b32 a239, v56
v_mfma_f32_16x16x32_bf16 v[216:219], a[244:247], a[216:219], v[216:219]
s_waitcnt vmcnt(11)
s_add_u32 m0, s33, 121728
v_cmp_ne_u64 s[50:51], s[88:89], v[42:43]
v_cmp_ne_u64 s[44:45], s[88:89], v[46:47]
v_mfma_f32_16x16x32_bf16 v[220:223], a[244:247], a[220:223], v[220:223]
s_waitcnt lgkmcnt(3)
v_mfma_f32_16x16x32_bf16 v[224:227], a[248:251], a[208:211], v[224:227]
s_or_b64 s[50:51], s[44:45], s[50:51]
ds_read_b128 a[240:243], v14 offset:18432
buffer_load_dwordx4 v10, s[20:23], 0 offen offset:1152 lds
v_mfma_f32_16x16x32_bf16 v[228:231], a[248:251], a[212:215], v[228:231]
s_cbranch_scc1 L_SLOW15
L_BACK15:
v_mfma_f32_16x16x32_bf16 v[232:235], a[248:251], a[216:219], v[232:235]
v_perm_b32 v63, v40, v19, s52
v_mfma_f32_16x16x32_bf16 v[236:239], a[248:251], a[220:223], v[236:239]
s_waitcnt lgkmcnt(1)
ds_read_b32 a0, v63
v_mfma_f32_16x16x32_bf16 v[128:131], a[252:255], a[224:227], v[128:131]
ds_read_b128 a[244:247], v14 offset:20480
v_perm_b32 v62, v40, v19, s53
v_mfma_f32_16x16x32_bf16 v[132:135], a[252:255], a[228:231], v[132:135]
ds_read_b32 a1, v62
v_perm_b32 v61, v44, v19, s52
v_mfma_f32_16x16x32_bf16 v[136:139], a[252:255], a[232:235], v[136:139]
ds_read_b32 a2, v61
v_perm_b32 v60, v44, v19, s53
v_mfma_f32_16x16x32_bf16 v[140:143], a[252:255], a[236:239], v[140:143]
s_waitcnt lgkmcnt(4)
ds_read_b32 a3, v60
v_mfma_f32_16x16x32_bf16 v[144:147], a[240:243], a[224:227], v[144:147]
ds_read_b128 a[248:251], v14 offset:22528
v_perm_b32 v59, v40, v19, s54
v_mfma_f32_16x16x32_bf16 v[148:151], a[240:243], a[228:231], v[148:151]
ds_read_b32 a4, v59
v_perm_b32 v58, v40, v19, s55
v_mfma_f32_16x16x32_bf16 v[152:155], a[240:243], a[232:235], v[152:155]
s_add_u32 m0, s33, 125696
ds_read_b32 a5, v58
v_perm_b32 v57, v44, v19, s54
v_mfma_f32_16x16x32_bf16 v[156:159], a[240:243], a[236:239], v[156:159]
s_waitcnt lgkmcnt(4)
ds_read_b32 a6, v57
v_perm_b32 v56, v44, v19, s55
v_mfma_f32_16x16x32_bf16 v[160:163], a[244:247], a[224:227], v[160:163]
ds_read_b128 a[252:255], v14 offset:24576
buffer_load_dwordx4 v8, s[20:23], 0 offen offset:1280 lds
v_mfma_f32_16x16x32_bf16 v[164:167], a[244:247], a[228:231], v[164:167]
ds_read_b32 a7, v56
v_perm_b32 v63, v41, v19, s52
v_mfma_f32_16x16x32_bf16 v[168:171], a[244:247], a[232:235], v[168:171]
ds_read_b32 a8, v63
v_perm_b32 v62, v41, v19, s53
v_mfma_f32_16x16x32_bf16 v[172:175], a[244:247], a[236:239], v[172:175]
s_waitcnt lgkmcnt(4)
ds_read_b32 a9, v62
v_mfma_f32_16x16x32_bf16 v[176:179], a[248:251], a[224:227], v[176:179]
ds_read_b128 a[240:243], v15 offset:14336
v_perm_b32 v61, v45, v19, s52
v_mfma_f32_16x16x32_bf16 v[180:183], a[248:251], a[228:231], v[180:183]
ds_read_b32 a10, v61
v_perm_b32 v60, v45, v19, s53
v_mfma_f32_16x16x32_bf16 v[184:187], a[248:251], a[232:235], v[184:187]
ds_read_b32 a11, v60
v_perm_b32 v59, v41, v19, s54
v_mfma_f32_16x16x32_bf16 v[188:191], a[248:251], a[236:239], v[188:191]
s_waitcnt lgkmcnt(4)
ds_read_b32 a12, v59
buffer_load_dwordx4 v[88:91], v12, s[24:27], 0 offen offset:2048 sc1
v_mfma_f32_16x16x32_bf16 v[192:195], a[252:255], a[224:227], v[192:195]
ds_read_b128 a[244:247], v14 offset:26624
v_perm_b32 v58, v41, v19, s55
v_mfma_f32_16x16x32_bf16 v[196:199], a[252:255], a[228:231], v[196:199]
ds_read_b32 a13, v58
v_perm_b32 v57, v45, v19, s54
v_mfma_f32_16x16x32_bf16 v[200:203], a[252:255], a[232:235], v[200:203]
s_add_u32 m0, s33, 129792
ds_read_b32 a14, v57
v_perm_b32 v56, v45, v19, s55
v_mfma_f32_16x16x32_bf16 v[204:207], a[252:255], a[236:239], v[204:207]
s_waitcnt vmcnt(10) lgkmcnt(4)
v_cmp_ne_u64 s[50:51], s[88:89], v[50:51]
v_cmp_ne_u64 s[44:45], s[88:89], v[54:55]
v_mfma_f32_16x16x32_bf16 v[240:243], a[240:243], a[208:211], v[240:243]
ds_read_b128 a[248:251], v15 offset:16384
buffer_load_dwordx4 v9, s[20:23], 0 offen offset:1280 lds
v_mfma_f32_16x16x32_bf16 v[244:247], a[240:243], a[212:215], v[244:247]
s_or_b64 s[50:51], s[44:45], s[50:51]
ds_read_b32 a15, v56
buffer_load_dwordx4 v[92:95], v12, s[24:27], 0 offen offset:3072 sc1
v_mfma_f32_16x16x32_bf16 v[248:251], a[240:243], a[216:219], v[248:251]
s_cbranch_scc1 L_SLOW16
L_BACK16:
v_mfma_f32_16x16x32_bf16 v[252:255], a[240:243], a[220:223], v[252:255]
s_waitcnt lgkmcnt(2)
v_add_u32 v12, 40960, v13
v_mfma_f32_16x16x32_bf16 v[208:211], a[244:247], a[224:227], v[208:211]
ds_read_b128 a[252:255], v14 offset:28672
v_perm_b32 v63, v48, v19, s52
v_mfma_f32_16x16x32_bf16 v[212:215], a[244:247], a[228:231], v[212:215]
ds_read_b32 a16, v63
v_perm_b32 v62, v48, v19, s53
v_mfma_f32_16x16x32_bf16 v[216:219], a[244:247], a[232:235], v[216:219]
ds_read_b32 a17, v62
v_perm_b32 v61, v52, v19, s52
v_mfma_f32_16x16x32_bf16 v[220:223], a[244:247], a[236:239], v[220:223]
s_waitcnt lgkmcnt(3)
ds_read_b32 a18, v61
v_mfma_f32_16x16x32_bf16 v[128:131], a[248:251], a[0:3], v[128:131]
ds_read_b128 a[240:243], v15 offset:18432
v_perm_b32 v60, v52, v19, s53
v_mfma_f32_16x16x32_bf16 v[132:135], a[248:251], a[4:7], v[132:135]
ds_read_b32 a19, v60
v_perm_b32 v59, v48, v19, s54
v_mfma_f32_16x16x32_bf16 v[136:139], a[248:251], a[8:11], v[136:139]
ds_read_b32 a20, v59
v_perm_b32 v58, v48, v19, s55
v_mfma_f32_16x16x32_bf16 v[140:143], a[248:251], a[12:15], v[140:143]
s_waitcnt lgkmcnt(4)
ds_read_b32 a21, v58
v_mfma_f32_16x16x32_bf16 v[224:227], a[252:255], a[224:227], v[224:227]
ds_read_b128 a[244:247], v15 offset:20480
v_perm_b32 v57, v52, v19, s54
v_mfma_f32_16x16x32_bf16 v[228:231], a[252:255], a[228:231], v[228:231]
ds_read_b32 a22, v57
v_perm_b32 v56, v52, v19, s55
v_mfma_f32_16x16x32_bf16 v[232:235], a[252:255], a[232:235], v[232:235]
ds_read_b32 a23, v56
v_perm_b32 v63, v49, v19, s52
v_mfma_f32_16x16x32_bf16 v[236:239], a[252:255], a[236:239], v[236:239]
s_waitcnt lgkmcnt(4)
ds_read_b32 a24, v63
v_mfma_f32_16x16x32_bf16 v[144:147], a[240:243], a[0:3], v[144:147]
ds_read_b128 a[248:251], v15 offset:22528
v_perm_b32 v62, v49, v19, s53
v_mfma_f32_16x16x32_bf16 v[148:151], a[240:243], a[4:7], v[148:151]
ds_read_b32 a25, v62
v_perm_b32 v61, v53, v19, s52
v_mfma_f32_16x16x32_bf16 v[152:155], a[240:243], a[8:11], v[152:155]
ds_read_b32 a26, v61
v_perm_b32 v60, v53, v19, s53
v_mfma_f32_16x16x32_bf16 v[156:159], a[240:243], a[12:15], v[156:159]
s_waitcnt lgkmcnt(4)
ds_read_b32 a27, v60
buffer_load_dwordx4 v[32:35], v12, s[24:27], 0 offen offset:0 sc1
v_mfma_f32_16x16x32_bf16 v[160:163], a[244:247], a[0:3], v[160:163]
ds_read_b128 a[252:255], v15 offset:24576
v_perm_b32 v59, v49, v19, s54
v_mfma_f32_16x16x32_bf16 v[164:167], a[244:247], a[4:7], v[164:167]
ds_read_b32 a28, v59
v_perm_b32 v58, v49, v19, s55
v_mfma_f32_16x16x32_bf16 v[168:171], a[244:247], a[8:11], v[168:171]
s_add_u32 m0, s33, 134016
ds_read_b32 a29, v58
v_perm_b32 v57, v53, v19, s54
v_mfma_f32_16x16x32_bf16 v[172:175], a[244:247], a[12:15], v[172:175]
s_waitcnt vmcnt(9) lgkmcnt(4)
v_cmp_ne_u64 s[50:51], s[88:89], v[98:99]
v_cmp_ne_u64 s[44:45], s[88:89], v[102:103]
v_mfma_f32_16x16x32_bf16 v[176:179], a[248:251], a[0:3], v[176:179]
ds_read_b128 a[240:243], v14 offset:32768
buffer_load_dwordx4 v11, s[20:23], 0 offen offset:1152 lds
v_mfma_f32_16x16x32_bf16 v[180:183], a[248:251], a[4:7], v[180:183]
ds_read_b32 a30, v57
v_perm_b32 v56, v53, v19, s55
v_mfma_f32_16x16x32_bf16 v[184:187], a[248:251], a[8:11], v[184:187]
s_or_b64 s[50:51], s[44:45], s[50:51]
ds_read_b32 a31, v56
buffer_load_dwordx4 v[36:39], v12, s[24:27], 0 offen offset:1024 sc1
v_mfma_f32_16x16x32_bf16 v[188:191], a[248:251], a[12:15], v[188:191]
s_waitcnt lgkmcnt(3)
v_mfma_f32_16x16x32_bf16 v[192:195], a[252:255], a[0:3], v[192:195]
s_barrier
ds_read_b128 a[244:247], v15 offset:26624
v_mfma_f32_16x16x32_bf16 v[196:199], a[252:255], a[4:7], v[196:199]
s_cbranch_scc1 L_SLOW17
L_BACK17:
v_mfma_f32_16x16x32_bf16 v[200:203], a[252:255], a[8:11], v[200:203]
v_perm_b32 v63, v96, v19, s52
v_mfma_f32_16x16x32_bf16 v[204:207], a[252:255], a[12:15], v[204:207]
s_waitcnt lgkmcnt(1)
ds_read_b32 a32, v63
v_mfma_f32_16x16x32_bf16 v[128:131], a[240:243], a[16:19], v[128:131]
ds_read_b128 a[248:251], v14 offset:34816
v_perm_b32 v62, v96, v19, s53
v_mfma_f32_16x16x32_bf16 v[132:135], a[240:243], a[20:23], v[132:135]
ds_read_b32 a33, v62
v_perm_b32 v61, v100, v19, s52
v_mfma_f32_16x16x32_bf16 v[136:139], a[240:243], a[24:27], v[136:139]
ds_read_b32 a34, v61
v_perm_b32 v60, v100, v19, s53
v_mfma_f32_16x16x32_bf16 v[140:143], a[240:243], a[28:31], v[140:143]
s_waitcnt lgkmcnt(4)
ds_read_b32 a35, v60
v_mfma_f32_16x16x32_bf16 v[208:211], a[244:247], a[0:3], v[208:211]
ds_read_b128 a[252:255], v14 offset:36864
v_perm_b32 v59, v96, v19, s54
v_mfma_f32_16x16x32_bf16 v[212:215], a[244:247], a[4:7], v[212:215]
ds_read_b32 a36, v59
v_perm_b32 v58, v96, v19, s55
v_mfma_f32_16x16x32_bf16 v[216:219], a[244:247], a[8:11], v[216:219]
s_add_u32 m0, s33, 137984
ds_read_b32 a37, v58
v_perm_b32 v57, v100, v19, s54
v_mfma_f32_16x16x32_bf16 v[220:223], a[244:247], a[12:15], v[220:223]
s_waitcnt lgkmcnt(4)
ds_read_b32 a38, v57
v_perm_b32 v56, v100, v19, s55
v_mfma_f32_16x16x32_bf16 v[144:147], a[248:251], a[16:19], v[144:147]
ds_read_b128 a[240:243], v14 offset:38912
buffer_load_dwordx4 v10, s[20:23], 0 offen offset:1280 lds
v_mfma_f32_16x16x32_bf16 v[148:151], a[248:251], a[20:23], v[148:151]
ds_read_b32 a39, v56
v_perm_b32 v63, v97, v19, s52
v_mfma_f32_16x16x32_bf16 v[152:155], a[248:251], a[24:27], v[152:155]
ds_read_b32 a40, v63
v_perm_b32 v62, v97, v19, s53
v_mfma_f32_16x16x32_bf16 v[156:159], a[248:251], a[28:31], v[156:159]
s_waitcnt lgkmcnt(4)
ds_read_b32 a41, v62
buffer_load_dwordx4 v[40:43], v12, s[24:27], 0 offen offset:2048 sc1
v_mfma_f32_16x16x32_bf16 v[160:163], a[252:255], a[16:19], v[160:163]
ds_read_b128 a[244:247], v15 offset:28672
v_perm_b32 v61, v101, v19, s52
v_mfma_f32_16x16x32_bf16 v[164:167], a[252:255], a[20:23], v[164:167]
ds_read_b32 a42, v61
v_perm_b32 v60, v101, v19, s53
v_mfma_f32_16x16x32_bf16 v[168:171], a[252:255], a[24:27], v[168:171]
ds_read_b32 a43, v60
v_perm_b32 v59, v97, v19, s54
v_mfma_f32_16x16x32_bf16 v[172:175], a[252:255], a[28:31], v[172:175]
s_waitcnt lgkmcnt(4)
ds_read_b32 a44, v59
buffer_load_dwordx4 v[44:47], v12, s[24:27], 0 offen offset:3072 sc1
v_mfma_f32_16x16x32_bf16 v[176:179], a[240:243], a[16:19], v[176:179]
ds_read_b128 a[248:251], v14 offset:40960
v_perm_b32 v58, v97, v19, s55
v_mfma_f32_16x16x32_bf16 v[180:183], a[240:243], a[20:23], v[180:183]
ds_read_b32 a45, v58
v_perm_b32 v57, v101, v19, s54
v_mfma_f32_16x16x32_bf16 v[184:187], a[240:243], a[24:27], v[184:187]
s_add_u32 m0, s33, 141952
ds_read_b32 a46, v57
v_perm_b32 v56, v101, v19, s55
v_mfma_f32_16x16x32_bf16 v[188:191], a[240:243], a[28:31], v[188:191]
s_waitcnt vmcnt(11) lgkmcnt(4)
v_cmp_ne_u64 s[50:51], s[88:89], v[82:83]
v_cmp_ne_u64 s[44:45], s[88:89], v[86:87]
v_mfma_f32_16x16x32_bf16 v[224:227], a[244:247], a[0:3], v[224:227]
ds_read_b128 a[252:255], v15 offset:32768
buffer_load_dwordx4 v8, s[20:23], 0 offen offset:1408 lds
v_mfma_f32_16x16x32_bf16 v[228:231], a[244:247], a[4:7], v[228:231]
s_or_b64 s[50:51], s[44:45], s[50:51]
ds_read_b32 a47, v56
v_add_u32 v12, 45056, v13
v_mfma_f32_16x16x32_bf16 v[232:235], a[244:247], a[8:11], v[232:235]
L_PAD3:
s_cbranch_vccnz L_PAD4
s_cbranch_scc1 L_SLOW18
L_BACK18:
v_mfma_f32_16x16x32_bf16 v[236:239], a[244:247], a[12:15], v[236:239]
s_waitcnt lgkmcnt(2)
v_mfma_f32_16x16x32_bf16 v[192:195], a[248:251], a[16:19], v[192:195]
ds_read_b128 a[240:243], v14 offset:30720
v_perm_b32 v63, v80, v19, s52
v_mfma_f32_16x16x32_bf16 v[196:199], a[248:251], a[20:23], v[196:199]
ds_read_b32 a48, v63
v_perm_b32 v62, v80, v19, s53
v_mfma_f32_16x16x32_bf16 v[200:203], a[248:251], a[24:27], v[200:203]
ds_read_b32 a49, v62
v_perm_b32 v61, v84, v19, s52
v_mfma_f32_16x16x32_bf16 v[204:207], a[248:251], a[28:31], v[204:207]
s_waitcnt lgkmcnt(3)
ds_read_b32 a50, v61
v_mfma_f32_16x16x32_bf16 v[128:131], a[252:255], a[32:35], v[128:131]
ds_read_b128 a[244:247], v15 offset:34816
v_perm_b32 v60, v84, v19, s53
v_mfma_f32_16x16x32_bf16 v[132:135], a[252:255], a[36:39], v[132:135]
ds_read_b32 a51, v60
v_perm_b32 v59, v80, v19, s54
v_mfma_f32_16x16x32_bf16 v[136:139], a[252:255], a[40:43], v[136:139]
s_add_u32 m0, s33, 146048
ds_read_b32 a52, v59
v_perm_b32 v58, v80, v19, s55
v_mfma_f32_16x16x32_bf16 v[140:143], a[252:255], a[44:47], v[140:143]
s_waitcnt lgkmcnt(4)
ds_read_b32 a53, v58
v_perm_b32 v57, v84, v19, s54
v_mfma_f32_16x16x32_bf16 v[240:243], a[240:243], a[224:227], v[240:243]
ds_read_b128 a[248:251], v15 offset:36864
buffer_load_dwordx4 v9, s[20:23], 0 offen offset:1408 lds
v_mfma_f32_16x16x32_bf16 v[244:247], a[240:243], a[228:231], v[244:247]
ds_read_b32 a54, v57
v_perm_b32 v56, v84, v19, s55
v_mfma_f32_16x16x32_bf16 v[248:251], a[240:243], a[232:235], v[248:251]
ds_read_b32 a55, v56
v_perm_b32 v63, v81, v19, s52
v_mfma_f32_16x16x32_bf16 v[252:255], a[240:243], a[236:239], v[252:255]
s_waitcnt lgkmcnt(4)
ds_read_b32 a56, v63
buffer_load_dwordx4 v[48:51], v12, s[24:27], 0 offen offset:0 sc1
v_mfma_f32_16x16x32_bf16 v[144:147], a[244:247], a[32:35], v[144:147]
ds_read_b128 a[252:255], v14 offset:43008
v_perm_b32 v62, v81, v19, s53
v_mfma_f32_16x16x32_bf16 v[148:151], a[244:247], a[36:39], v[148:151]
ds_read_b32 a57, v62
v_perm_b32 v61, v85, v19, s52
v_mfma_f32_16x16x32_bf16 v[152:155], a[244:247], a[40:43], v[152:155]
ds_read_b32 a58, v61
v_perm_b32 v60, v85, v19, s53
v_mfma_f32_16x16x32_bf16 v[156:159], a[244:247], a[44:47], v[156:159]
s_waitcnt lgkmcnt(4)
ds_read_b32 a59, v60
buffer_load_dwordx4 v[52:55], v12, s[24:27], 0 offen offset:1024 sc1
v_mfma_f32_16x16x32_bf16 v[160:163], a[248:251], a[32:35], v[160:163]
ds_read_b128 a[240:243], v15 offset:38912
v_perm_b32 v59, v81, v19, s54
v_mfma_f32_16x16x32_bf16 v[164:167], a[248:251], a[36:39], v[164:167]
ds_read_b32 a60, v59
v_perm_b32 v58, v81, v19, s55
v_mfma_f32_16x16x32_bf16 v[168:171], a[248:251], a[40:43], v[168:171]
ds_read_b32 a61, v58
v_perm_b32 v57, v85, v19, s54
v_mfma_f32_16x16x32_bf16 v[172:175], a[248:251], a[44:47], v[172:175]
s_waitcnt lgkmcnt(4)
ds_read_b32 a62, v57
v_mfma_f32_16x16x32_bf16 v[208:211], a[252:255], a[16:19], v[208:211]
ds_read_b128 a[244:247], v14 offset:45056
v_perm_b32 v56, v85, v19, s55
v_mfma_f32_16x16x32_bf16 v[212:215], a[252:255], a[20:23], v[212:215]
ds_read_b32 a63, v56
v_mfma_f32_16x16x32_bf16 v[216:219], a[252:255], a[24:27], v[216:219]
s_waitcnt vmcnt(10)
v_cmp_ne_u64 s[50:51], s[88:89], v[90:91]
v_cmp_ne_u64 s[44:45], s[88:89], v[94:95]
v_mfma_f32_16x16x32_bf16 v[220:223], a[252:255], a[28:31], v[220:223]
s_waitcnt lgkmcnt(3)
v_mfma_f32_16x16x32_bf16 v[176:179], a[240:243], a[32:35], v[176:179]
s_or_b64 s[50:51], s[44:45], s[50:51]
ds_read_b128 a[248:251], v15 offset:40960
v_mfma_f32_16x16x32_bf16 v[180:183], a[240:243], a[36:39], v[180:183]
s_cbranch_scc1 L_SLOW19
L_BACK19:
v_mfma_f32_16x16x32_bf16 v[184:187], a[240:243], a[40:43], v[184:187]
v_perm_b32 v63, v88, v19, s52
v_mfma_f32_16x16x32_bf16 v[188:191], a[240:243], a[44:47], v[188:191]
s_waitcnt lgkmcnt(1)
ds_read_b32 a64, v63
v_mfma_f32_16x16x32_bf16 v[128:131], a[244:247], a[48:51], v[128:131]
ds_read_b128 a[252:255], v14 offset:49152
v_perm_b32 v62, v88, v19, s53
v_mfma_f32_16x16x32_bf16 v[132:135], a[244:247], a[52:55], v[132:135]
ds_read_b32 a65, v62
v_perm_b32 v61, v92, v19, s52
v_mfma_f32_16x16x32_bf16 v[136:139], a[244:247], a[56:59], v[136:139]
s_add_u32 m0, s33, 150016
ds_read_b32 a66, v61
v_perm_b32 v60, v92, v19, s53
v_mfma_f32_16x16x32_bf16 v[140:143], a[244:247], a[60:63], v[140:143]
s_waitcnt lgkmcnt(4)
ds_read_b32 a67, v60
v_perm_b32 v59, v88, v19, s54
v_mfma_f32_16x16x32_bf16 v[192:195], a[248:251], a[32:35], v[192:195]
ds_read_b128 a[240:243], v14 offset:47104
buffer_load_dwordx4 v8, s[20:23], 0 offen offset:1536 lds
v_mfma_f32_16x16x32_bf16 v[196:199], a[248:251], a[36:39], v[196:199]
ds_read_b32 a68, v59
v_perm_b32 v58, v88, v19, s55
v_mfma_f32_16x16x32_bf16 v[200:203], a[248:251], a[40:43], v[200:203]
ds_read_b32 a69, v58
v_perm_b32 v57, v92, v19, s54
v_mfma_f32_16x16x32_bf16 v[204:207], a[248:251], a[44:47], v[204:207]
s_waitcnt lgkmcnt(4)
ds_read_b32 a70, v57
buffer_load_dwordx4 v[96:99], v12, s[24:27], 0 offen offset:2048 sc1
v_mfma_f32_16x16x32_bf16 v[224:227], a[252:255], a[16:19], v[224:227]
s_barrier
ds_read_b128 a[244:247], v14 offset:53248
v_perm_b32 v56, v92, v19, s55
v_mfma_f32_16x16x32_bf16 v[228:231], a[252:255], a[20:23], v[228:231]
ds_read_b32 a71, v56
v_perm_b32 v63, v89, v19, s52
v_mfma_f32_16x16x32_bf16 v[232:235], a[252:255], a[24:27], v[232:235]
ds_read_b32 a72, v63
v_perm_b32 v62, v89, v19, s53
v_mfma_f32_16x16x32_bf16 v[236:239], a[252:255], a[28:31], v[236:239]
s_waitcnt lgkmcnt(4)
ds_read_b32 a73, v62
buffer_load_dwordx4 v[100:103], v12, s[24:27], 0 offen offset:3072 sc1
v_mfma_f32_16x16x32_bf16 v[144:147], a[240:243], a[48:51], v[144:147]
ds_read_b128 a[248:251], v15 offset:43008
v_perm_b32 v61, v93, v19, s52
v_mfma_f32_16x16x32_bf16 v[148:151], a[240:243], a[52:55], v[148:151]
ds_read_b32 a74, v61
v_perm_b32 v60, v93, v19, s53
v_mfma_f32_16x16x32_bf16 v[152:155], a[240:243], a[56:59], v[152:155]
ds_read_b32 a75, v60
v_perm_b32 v59, v89, v19, s54
v_mfma_f32_16x16x32_bf16 v[156:159], a[240:243], a[60:63], v[156:159]
s_waitcnt lgkmcnt(4)
ds_read_b32 a76, v59
v_add_u32 v12, 49152, v13
v_mfma_f32_16x16x32_bf16 v[160:163], a[244:247], a[48:51], v[160:163]
ds_read_b128 a[252:255], v14 offset:55296
v_perm_b32 v58, v89, v19, s55
v_mfma_f32_16x16x32_bf16 v[164:167], a[244:247], a[52:55], v[164:167]
ds_read_b32 a77, v58
v_perm_b32 v57, v93, v19, s54
v_mfma_f32_16x16x32_bf16 v[168:171], a[244:247], a[56:59], v[168:171]
s_waitcnt vmcnt(10)
s_add_u32 m0, s33, 154240
v_cmp_ne_u64 s[50:51], s[88:89], v[34:35]
v_cmp_ne_u64 s[44:45], s[88:89], v[38:39]
v_mfma_f32_16x16x32_bf16 v[172:175], a[244:247], a[60:63], v[172:175]
s_waitcnt lgkmcnt(3)
ds_read_b32 a78, v57
v_perm_b32 v56, v93, v19, s55
v_mfma_f32_16x16x32_bf16 v[208:211], a[248:251], a[32:35], v[208:211]
s_or_b64 s[50:51], s[44:45], s[50:51]
ds_read_b128 a[240:243], v15 offset:45056
buffer_load_dwordx4 v10, s[20:23], 0 offen offset:1408 lds
v_mfma_f32_16x16x32_bf16 v[212:215], a[248:251], a[36:39], v[212:215]
s_cbranch_scc1 L_SLOW20
L_BACK20:
v_mfma_f32_16x16x32_bf16 v[216:219], a[248:251], a[40:43], v[216:219]
ds_read_b32 a79, v56
v_perm_b32 v63, v32, v19, s52
v_mfma_f32_16x16x32_bf16 v[220:223], a[248:251], a[44:47], v[220:223]
s_waitcnt lgkmcnt(3)
ds_read_b32 a80, v63
v_mfma_f32_16x16x32_bf16 v[176:179], a[252:255], a[48:51], v[176:179]
ds_read_b128 a[244:247], v15 offset:47104
v_perm_b32 v62, v32, v19, s53
v_mfma_f32_16x16x32_bf16 v[180:183], a[252:255], a[52:55], v[180:183]
ds_read_b32 a81, v62
v_perm_b32 v61, v36, v19, s52
v_mfma_f32_16x16x32_bf16 v[184:187], a[252:255], a[56:59], v[184:187]
ds_read_b32 a82, v61
v_perm_b32 v60, v36, v19, s53
v_mfma_f32_16x16x32_bf16 v[188:191], a[252:255], a[60:63], v[188:191]
s_waitcnt lgkmcnt(4)
ds_read_b32 a83, v60
v_mfma_f32_16x16x32_bf16 v[128:131], a[240:243], a[64:67], v[128:131]
ds_read_b128 a[248:251], v14 offset:57344
v_perm_b32 v59, v32, v19, s54
v_mfma_f32_16x16x32_bf16 v[132:135], a[240:243], a[68:71], v[132:135]
ds_read_b32 a84, v59
v_perm_b32 v58, v32, v19, s55
v_mfma_f32_16x16x32_bf16 v[136:139], a[240:243], a[72:75], v[136:139]
s_add_u32 m0, s33, 158464
ds_read_b32 a85, v58
v_perm_b32 v57, v36, v19, s54
v_mfma_f32_16x16x32_bf16 v[140:143], a[240:243], a[76:79], v[140:143]
s_waitcnt lgkmcnt(4)
ds_read_b32 a86, v57
v_perm_b32 v56, v36, v19, s55
v_mfma_f32_16x16x32_bf16 v[144:147], a[244:247], a[64:67], v[144:147]
ds_read_b128 a[252:255], v15 offset:53248
buffer_load_dwordx4 v11, s[20:23], 0 offen offset:1280 lds
v_mfma_f32_16x16x32_bf16 v[148:151], a[244:247], a[68:71], v[148:151]
ds_read_b32 a87, v56
v_perm_b32 v63, v33, v19, s52
v_mfma_f32_16x16x32_bf16 v[152:155], a[244:247], a[72:75], v[152:155]
ds_read_b32 a88, v63
v_perm_b32 v62, v33, v19, s53
v_mfma_f32_16x16x32_bf16 v[156:159], a[244:247], a[76:79], v[156:159]
s_waitcnt lgkmcnt(4)
ds_read_b32 a89, v62
buffer_load_dwordx4 v[80:83], v12, s[24:27], 0 offen offset:0 sc1
v_mfma_f32_16x16x32_bf16 v[192:195], a[248:251], a[48:51], v[192:195]
ds_read_b128 a[240:243], v15 offset:30720
v_perm_b32 v61, v37, v19, s52
v_mfma_f32_16x16x32_bf16 v[196:199], a[248:251], a[52:55], v[196:199]
ds_read_b32 a90, v61
v_perm_b32 v60, v37, v19, s53
v_mfma_f32_16x16x32_bf16 v[200:203], a[248:251], a[56:59], v[200:203]
ds_read_b32 a91, v60
v_perm_b32 v59, v33, v19, s54
v_mfma_f32_16x16x32_bf16 v[204:207], a[248:251], a[60:63], v[204:207]
s_waitcnt lgkmcnt(4)
ds_read_b32 a92, v59
buffer_load_dwordx4 v[84:87], v12, s[24:27], 0 offen offset:1024 sc1
v_mfma_f32_16x16x32_bf16 v[160:163], a[252:255], a[64:67], v[160:163]
ds_read_b128 a[244:247], v15 offset:49152
v_perm_b32 v58, v33, v19, s55
v_mfma_f32_16x16x32_bf16 v[164:167], a[252:255], a[68:71], v[164:167]
ds_read_b32 a93, v58
v_perm_b32 v57, v37, v19, s54
v_mfma_f32_16x16x32_bf16 v[168:171], a[252:255], a[72:75], v[168:171]
s_waitcnt vmcnt(11)
s_add_u32 m0, s33, 64000
v_cmp_ne_u64 s[50:51], s[88:89], v[42:43]
v_cmp_ne_u64 s[44:45], s[88:89], v[46:47]
v_mfma_f32_16x16x32_bf16 v[172:175], a[252:255], a[76:79], v[172:175]
s_waitcnt lgkmcnt(3)
ds_read_b32 a94, v57
v_perm_b32 v56, v37, v19, s55
v_mfma_f32_16x16x32_bf16 v[240:243], a[240:243], a[0:3], v[240:243]
s_or_b64 s[50:51], s[44:45], s[50:51]
ds_read_b128 a[248:251], v14 offset:61440
buffer_load_dwordx4 v9, s[20:23], 0 offen offset:1536 lds
v_mfma_f32_16x16x32_bf16 v[244:247], a[240:243], a[4:7], v[244:247]
s_cbranch_scc1 L_SLOW21
L_BACK21:
v_mfma_f32_16x16x32_bf16 v[248:251], a[240:243], a[8:11], v[248:251]
ds_read_b32 a95, v56
v_perm_b32 v63, v40, v19, s52
v_mfma_f32_16x16x32_bf16 v[252:255], a[240:243], a[12:15], v[252:255]
s_waitcnt lgkmcnt(3)
ds_read_b32 a96, v63
v_mfma_f32_16x16x32_bf16 v[224:227], a[244:247], a[32:35], v[224:227]
ds_read_b128 a[252:255], v15 offset:55296
v_perm_b32 v62, v40, v19, s53
v_mfma_f32_16x16x32_bf16 v[228:231], a[244:247], a[36:39], v[228:231]
ds_read_b32 a97, v62
v_perm_b32 v61, v44, v19, s52
v_mfma_f32_16x16x32_bf16 v[232:235], a[244:247], a[40:43], v[232:235]
ds_read_b32 a98, v61
v_perm_b32 v60, v44, v19, s53
v_mfma_f32_16x16x32_bf16 v[236:239], a[244:247], a[44:47], v[236:239]
s_waitcnt lgkmcnt(4)
ds_read_b32 a99, v60
v_mfma_f32_16x16x32_bf16 v[128:131], a[248:251], a[80:83], v[128:131]
ds_read_b128 a[240:243], v14 offset:59392
v_perm_b32 v59, v40, v19, s54
v_mfma_f32_16x16x32_bf16 v[132:135], a[248:251], a[84:87], v[132:135]
ds_read_b32 a100, v59
v_perm_b32 v58, v40, v19, s55
v_mfma_f32_16x16x32_bf16 v[136:139], a[248:251], a[88:91], v[136:139]
ds_read_b32 a101, v58
v_perm_b32 v57, v44, v19, s54
v_mfma_f32_16x16x32_bf16 v[140:143], a[248:251], a[92:95], v[140:143]
s_waitcnt lgkmcnt(4)
ds_read_b32 a102, v57
v_mfma_f32_16x16x32_bf16 v[176:179], a[252:255], a[64:67], v[176:179]
ds_read_b128 a[244:247], v14 offset:63488
v_perm_b32 v56, v44, v19, s55
v_mfma_f32_16x16x32_bf16 v[180:183], a[252:255], a[68:71], v[180:183]
ds_read_b32 a103, v56
v_perm_b32 v63, v41, v19, s52
v_mfma_f32_16x16x32_bf16 v[184:187], a[252:255], a[72:75], v[184:187]
s_add_u32 m0, s33, 67968
ds_read_b32 a104, v63
v_perm_b32 v62, v41, v19, s53
v_mfma_f32_16x16x32_bf16 v[188:191], a[252:255], a[76:79], v[188:191]
s_waitcnt lgkmcnt(4)
ds_read_b32 a105, v62
v_perm_b32 v61, v45, v19, s52
v_mfma_f32_16x16x32_bf16 v[208:211], a[240:243], a[48:51], v[208:211]
ds_read_b128 a[248:251], v15 offset:57344
buffer_load_dwordx4 v8, s[20:23], 0 offen offset:1664 lds
v_mfma_f32_16x16x32_bf16 v[212:215], a[240:243], a[52:55], v[212:215]
ds_read_b32 a106, v61
v_perm_b32 v60, v45, v19, s53
v_mfma_f32_16x16x32_bf16 v[216:219], a[240:243], a[56:59], v[216:219]
ds_read_b32 a107, v60
v_perm_b32 v59, v41, v19, s54
v_mfma_f32_16x16x32_bf16 v[220:223], a[240:243], a[60:63], v[220:223]
s_waitcnt lgkmcnt(4)
ds_read_b32 a108, v59
buffer_load_dwordx4 v[88:91], v12, s[24:27], 0 offen offset:2048 sc1
v_mfma_f32_16x16x32_bf16 v[144:147], a[244:247], a[80:83], v[144:147]
ds_read_b128 a[252:255], v16 offset:0
v_perm_b32 v58, v41, v19, s55
v_mfma_f32_16x16x32_bf16 v[148:151], a[244:247], a[84:87], v[148:151]
ds_read_b32 a109, v58
v_perm_b32 v57, v45, v19, s54
v_mfma_f32_16x16x32_bf16 v[152:155], a[244:247], a[88:91], v[152:155]
s_add_u32 m0, s33, 72192
ds_read_b32 a110, v57
v_perm_b32 v56, v45, v19, s55
v_mfma_f32_16x16x32_bf16 v[156:159], a[244:247], a[92:95], v[156:159]
s_waitcnt vmcnt(10) lgkmcnt(4)
v_cmp_ne_u64 s[50:51], s[88:89], v[50:51]
v_cmp_ne_u64 s[44:45], s[88:89], v[54:55]
v_mfma_f32_16x16x32_bf16 v[192:195], a[248:251], a[64:67], v[192:195]
ds_read_b128 a[240:243], v15 offset:61440
buffer_load_dwordx4 v10, s[20:23], 0 offen offset:1536 lds
v_mfma_f32_16x16x32_bf16 v[196:199], a[248:251], a[68:71], v[196:199]
s_or_b64 s[50:51], s[44:45], s[50:51]
ds_read_b32 a111, v56
buffer_load_dwordx4 v[92:95], v12, s[24:27], 0 offen offset:3072 sc1
v_mfma_f32_16x16x32_bf16 v[200:203], a[248:251], a[72:75], v[200:203]
s_cbranch_scc1 L_SLOW22
L_BACK22:
v_mfma_f32_16x16x32_bf16 v[204:207], a[248:251], a[76:79], v[204:207]
s_waitcnt lgkmcnt(2)
v_add_u32 v12, 53248, v13
v_mfma_f32_16x16x32_bf16 v[160:163], a[252:255], a[80:83], v[160:163]
s_barrier
ds_read_b128 a[244:247], v16 offset:2048
v_perm_b32 v63, v48, v19, s52
v_mfma_f32_16x16x32_bf16 v[164:167], a[252:255], a[84:87], v[164:167]
ds_read_b32 a112, v63
v_perm_b32 v62, v48, v19, s53
v_mfma_f32_16x16x32_bf16 v[168:171], a[252:255], a[88:91], v[168:171]
ds_read_b32 a113, v62
v_perm_b32 v61, v52, v19, s52
v_mfma_f32_16x16x32_bf16 v[172:175], a[252:255], a[92:95], v[172:175]
s_waitcnt lgkmcnt(3)
ds_read_b32 a114, v61
v_mfma_f32_16x16x32_bf16 v[128:131], a[240:243], a[96:99], v[128:131]
ds_read_b128 a[248:251], v16 offset:4096
v_perm_b32 v60, v52, v19, s53
v_mfma_f32_16x16x32_bf16 v[132:135], a[240:243], a[100:103], v[132:135]
ds_read_b32 a115, v60
v_perm_b32 v59, v48, v19, s54
v_mfma_f32_16x16x32_bf16 v[136:139], a[240:243], a[104:107], v[136:139]
ds_read_b32 a116, v59
v_perm_b32 v58, v48, v19, s55
v_mfma_f32_16x16x32_bf16 v[140:143], a[240:243], a[108:111], v[140:143]
s_waitcnt lgkmcnt(4)
ds_read_b32 a117, v58
v_mfma_f32_16x16x32_bf16 v[176:179], a[244:247], a[80:83], v[176:179]
ds_read_b128 a[252:255], v15 offset:63488
v_perm_b32 v57, v52, v19, s54
v_mfma_f32_16x16x32_bf16 v[180:183], a[244:247], a[84:87], v[180:183]
ds_read_b32 a118, v57
v_perm_b32 v56, v52, v19, s55
v_mfma_f32_16x16x32_bf16 v[184:187], a[244:247], a[88:91], v[184:187]
s_add_u32 m0, s33, 76160
ds_read_b32 a119, v56
v_perm_b32 v63, v49, v19, s52
v_mfma_f32_16x16x32_bf16 v[188:191], a[244:247], a[92:95], v[188:191]
s_waitcnt lgkmcnt(4)
ds_read_b32 a120, v63
v_perm_b32 v62, v49, v19, s53
v_mfma_f32_16x16x32_bf16 v[224:227], a[248:251], a[48:51], v[224:227]
ds_read_b128 a[240:243], v15 offset:59392
buffer_load_dwordx4 v9, s[20:23], 0 offen offset:1664 lds
v_mfma_f32_16x16x32_bf16 v[228:231], a[248:251], a[52:55], v[228:231]
ds_read_b32 a121, v62
v_perm_b32 v61, v53, v19, s52
v_mfma_f32_16x16x32_bf16 v[232:235], a[248:251], a[56:59], v[232:235]
ds_read_b32 a122, v61
v_perm_b32 v60, v53, v19, s53
v_mfma_f32_16x16x32_bf16 v[236:239], a[248:251], a[60:63], v[236:239]
s_waitcnt lgkmcnt(4)
ds_read_b32 a123, v60
buffer_load_dwordx4 v[32:35], v12, s[24:27], 0 offen offset:0 sc1
v_mfma_f32_16x16x32_bf16 v[144:147], a[252:255], a[96:99], v[144:147]
ds_read_b128 a[244:247], v17 offset:0
v_perm_b32 v59, v49, v19, s54
v_mfma_f32_16x16x32_bf16 v[148:151], a[252:255], a[100:103], v[148:151]
ds_read_b32 a124, v59
v_perm_b32 v58, v49, v19, s55
v_mfma_f32_16x16x32_bf16 v[152:155], a[252:255], a[104:107], v[152:155]
s_waitcnt vmcnt(11)
v_cmp_ne_u64 s[50:51], s[88:89], v[98:99]
v_cmp_ne_u64 s[44:45], s[88:89], v[102:103]
v_mfma_f32_16x16x32_bf16 v[156:159], a[252:255], a[108:111], v[156:159]
s_waitcnt lgkmcnt(3)
ds_read_b32 a125, v58
buffer_load_dwordx4 v[36:39], v12, s[24:27], 0 offen offset:1024 sc1
v_mfma_f32_16x16x32_bf16 v[208:211], a[240:243], a[64:67], v[208:211]
s_or_b64 s[50:51], s[44:45], s[50:51]
ds_read_b128 a[248:251], v16 offset:8192
v_perm_b32 v57, v53, v19, s54
v_mfma_f32_16x16x32_bf16 v[212:215], a[240:243], a[68:71], v[212:215]
s_cbranch_scc1 L_SLOW23
L_BACK23:
v_mfma_f32_16x16x32_bf16 v[216:219], a[240:243], a[72:75], v[216:219]
s_add_u32 m0, s33, 80512
ds_read_b32 a126, v57
v_perm_b32 v56, v53, v19, s55
v_mfma_f32_16x16x32_bf16 v[220:223], a[240:243], a[76:79], v[220:223]
s_waitcnt lgkmcnt(3)
ds_read_b32 a127, v56
v_perm_b32 v63, v96, v19, s52
v_mfma_f32_16x16x32_bf16 v[160:163], a[244:247], a[96:99], v[160:163]
ds_read_b128 a[252:255], v16 offset:12288
buffer_load_dwordx4 v11, s[20:23], 0 offen offset:1408 lds
v_mfma_f32_16x16x32_bf16 v[164:167], a[244:247], a[100:103], v[164:167]
ds_read_b32 a128, v63
v_perm_b32 v62, v96, v19, s53
v_mfma_f32_16x16x32_bf16 v[168:171], a[244:247], a[104:107], v[168:171]
ds_read_b32 a129, v62
v_perm_b32 v61, v100, v19, s52
v_mfma_f32_16x16x32_bf16 v[172:175], a[244:247], a[108:111], v[172:175]
s_waitcnt lgkmcnt(4)
ds_read_b32 a130, v61
v_mfma_f32_16x16x32_bf16 v[192:195], a[248:251], a[80:83], v[192:195]
ds_read_b128 a[240:243], v14 offset:51200
v_perm_b32 v60, v100, v19, s53
v_mfma_f32_16x16x32_bf16 v[196:199], a[248:251], a[84:87], v[196:199]
ds_read_b32 a131, v60
v_perm_b32 v59, v96, v19, s54
v_mfma_f32_16x16x32_bf16 v[200:203], a[248:251], a[88:91], v[200:203]
ds_read_b32 a132, v59
v_perm_b32 v58, v96, v19, s55
v_mfma_f32_16x16x32_bf16 v[204:207], a[248:251], a[92:95], v[204:207]
s_waitcnt lgkmcnt(4)
ds_read_b32 a133, v58
v_mfma_f32_16x16x32_bf16 v[128:131], a[252:255], a[112:115], v[128:131]
ds_read_b128 a[244:247], v16 offset:14336
v_perm_b32 v57, v100, v19, s54
v_mfma_f32_16x16x32_bf16 v[132:135], a[252:255], a[116:119], v[132:135]
ds_read_b32 a134, v57
v_perm_b32 v56, v100, v19, s55
v_mfma_f32_16x16x32_bf16 v[136:139], a[252:255], a[120:123], v[136:139]
s_add_u32 m0, s33, 84224
ds_read_b32 a135, v56
v_perm_b32 v63, v97, v19, s52
v_mfma_f32_16x16x32_bf16 v[140:143], a[252:255], a[124:127], v[140:143]
s_waitcnt lgkmcnt(4)
ds_read_b32 a136, v63
v_perm_b32 v62, v97, v19, s53
v_mfma_f32_16x16x32_bf16 v[240:243], a[240:243], a[16:19], v[240:243]
ds_read_b128 a[248:251], v17 offset:2048
buffer_load_dwordx4 v8, s[20:23], 0 offen offset:1792 lds
v_mfma_f32_16x16x32_bf16 v[244:247], a[240:243], a[20:23], v[244:247]
ds_read_b32 a137, v62
v_perm_b32 v61, v101, v19, s52
v_mfma_f32_16x16x32_bf16 v[248:251], a[240:243], a[24:27], v[248:251]
ds_read_b32 a138, v61
v_perm_b32 v60, v101, v19, s53
v_mfma_f32_16x16x32_bf16 v[252:255], a[240:243], a[28:31], v[252:255]
s_waitcnt lgkmcnt(4)
ds_read_b32 a139, v60
buffer_load_dwordx4 v[40:43], v12, s[24:27], 0 offen offset:2048 sc1
v_mfma_f32_16x16x32_bf16 v[144:147], a[244:247], a[112:115], v[144:147]
ds_read_b128 a[252:255], v17 offset:4096
v_perm_b32 v59, v97, v19, s54
v_mfma_f32_16x16x32_bf16 v[148:151], a[244:247], a[116:119], v[148:151]
ds_read_b32 a140, v59
v_perm_b32 v58, v97, v19, s55
v_mfma_f32_16x16x32_bf16 v[152:155], a[244:247], a[120:123], v[152:155]
ds_read_b32 a141, v58
buffer_load_dwordx4 v[44:47], v12, s[24:27], 0 offen offset:3072 sc1
v_mfma_f32_16x16x32_bf16 v[156:159], a[244:247], a[124:127], v[156:159]
s_waitcnt vmcnt(12) lgkmcnt(4)
v_cmp_ne_u64 s[50:51], s[88:89], v[82:83]
v_cmp_ne_u64 s[44:45], s[88:89], v[86:87]
v_mfma_f32_16x16x32_bf16 v[176:179], a[248:251], a[96:99], v[176:179]
ds_read_b128 a[240:243], v16 offset:16384
v_perm_b32 v57, v101, v19, s54
v_mfma_f32_16x16x32_bf16 v[180:183], a[248:251], a[100:103], v[180:183]
s_or_b64 s[50:51], s[44:45], s[50:51]
ds_read_b32 a142, v57
v_perm_b32 v56, v101, v19, s55
v_mfma_f32_16x16x32_bf16 v[184:187], a[248:251], a[104:107], v[184:187]
s_cbranch_scc1 L_SLOW24
L_BACK24:
v_mfma_f32_16x16x32_bf16 v[188:191], a[248:251], a[108:111], v[188:191]
s_waitcnt lgkmcnt(2)
ds_read_b32 a143, v56
v_add_u32 v12, 57344, v13
v_mfma_f32_16x16x32_bf16 v[224:227], a[252:255], a[64:67], v[224:227]
ds_read_b128 a[244:247], v16 offset:10240
v_perm_b32 v63, v80, v19, s52
v_mfma_f32_16x16x32_bf16 v[228:231], a[252:255], a[68:71], v[228:231]
ds_read_b32 a144, v63
v_perm_b32 v62, v80, v19, s53
v_mfma_f32_16x16x32_bf16 v[232:235], a[252:255], a[72:75], v[232:235]
s_add_u32 m0, s33, 88448
ds_read_b32 a145, v62
v_perm_b32 v61, v84, v19, s52
v_mfma_f32_16x16x32_bf16 v[236:239], a[252:255], a[76:79], v[236:239]
s_waitcnt lgkmcnt(4)
ds_read_b32 a146, v61
v_perm_b32 v60, v84, v19, s53
v_mfma_f32_16x16x32_bf16 v[160:163], a[240:243], a[112:115], v[160:163]
ds_read_b128 a[248:251], v17 offset:12288
buffer_load_dwordx4 v10, s[20:23], 0 offen offset:1664 lds
v_mfma_f32_16x16x32_bf16 v[164:167], a[240:243], a[116:119], v[164:167]
ds_read_b32 a147, v60
v_perm_b32 v59, v80, v19, s54
v_mfma_f32_16x16x32_bf16 v[168:171], a[240:243], a[120:123], v[168:171]
ds_read_b32 a148, v59
v_perm_b32 v58, v80, v19, s55
v_mfma_f32_16x16x32_bf16 v[172:175], a[240:243], a[124:127], v[172:175]
s_waitcnt lgkmcnt(4)
ds_read_b32 a149, v58
v_mfma_f32_16x16x32_bf16 v[208:211], a[244:247], a[80:83], v[208:211]
ds_read_b128 a[252:255], v17 offset:8192
v_perm_b32 v57, v84, v19, s54
v_mfma_f32_16x16x32_bf16 v[212:215], a[244:247], a[84:87], v[212:215]
ds_read_b32 a150, v57
v_perm_b32 v56, v84, v19, s55
v_mfma_f32_16x16x32_bf16 v[216:219], a[244:247], a[88:91], v[216:219]
s_add_u32 m0, s33, 92416
ds_read_b32 a151, v56
v_perm_b32 v63, v81, v19, s52
v_mfma_f32_16x16x32_bf16 v[220:223], a[244:247], a[92:95], v[220:223]
s_waitcnt lgkmcnt(4)
ds_read_b32 a152, v63
v_perm_b32 v62, v81, v19, s53
v_mfma_f32_16x16x32_bf16 v[128:131], a[248:251], a[128:131], v[128:131]
ds_read_b128 a[240:243], v17 offset:14336
buffer_load_dwordx4 v9, s[20:23], 0 offen offset:1792 lds
v_mfma_f32_16x16x32_bf16 v[132:135], a[248:251], a[132:135], v[132:135]
ds_read_b32 a153, v62
v_perm_b32 v61, v85, v19, s52
v_mfma_f32_16x16x32_bf16 v[136:139], a[248:251], a[136:139], v[136:139]
ds_read_b32 a154, v61
v_perm_b32 v60, v85, v19, s53
v_mfma_f32_16x16x32_bf16 v[140:143], a[248:251], a[140:143], v[140:143]
s_waitcnt lgkmcnt(4)
ds_read_b32 a155, v60
buffer_load_dwordx4 v[48:51], v12, s[24:27], 0 offen offset:0 sc1
v_mfma_f32_16x16x32_bf16 v[192:195], a[252:255], a[96:99], v[192:195]
s_waitcnt vmcnt(14)
s_barrier
ds_read_b128 a[244:247], v16 offset:18432
v_perm_b32 v59, v81, v19, s54
v_mfma_f32_16x16x32_bf16 v[196:199], a[252:255], a[100:103], v[196:199]
L_PAD4:
s_cbranch_vccnz L_PADRET
ds_read_b32 a156, v59
v_perm_b32 v58, v81, v19, s55
v_mfma_f32_16x16x32_bf16 v[200:203], a[252:255], a[104:107], v[200:203]
ds_read_b32 a157, v58
v_perm_b32 v57, v85, v19, s54
v_mfma_f32_16x16x32_bf16 v[204:207], a[252:255], a[108:111], v[204:207]
s_waitcnt lgkmcnt(4)
ds_read_b32 a158, v57
buffer_load_dwordx4 v[52:55], v12, s[24:27], 0 offen offset:1024 sc1
v_mfma_f32_16x16x32_bf16 v[144:147], a[240:243], a[128:131], v[144:147]
ds_read_b128 a[248:251], v16 offset:20480
v_perm_b32 v56, v85, v19, s55
v_mfma_f32_16x16x32_bf16 v[148:151], a[240:243], a[132:135], v[148:151]
ds_read_b32 a159, v56
v_mfma_f32_16x16x32_bf16 v[152:155], a[240:243], a[136:139], v[152:155]
s_waitcnt vmcnt(11)
v_cmp_ne_u64 s[50:51], s[88:89], v[90:91]
v_cmp_ne_u64 s[44:45], s[88:89], v[94:95]
v_mfma_f32_16x16x32_bf16 v[156:159], a[240:243], a[140:143], v[156:159]
s_waitcnt lgkmcnt(3)
v_mfma_f32_16x16x32_bf16 v[176:179], a[244:247], a[112:115], v[176:179]
s_or_b64 s[50:51], s[44:45], s[50:51]
ds_read_b128 a[252:255], v17 offset:16384
v_mfma_f32_16x16x32_bf16 v[180:183], a[244:247], a[116:119], v[180:183]
s_cbranch_scc1 L_SLOW25
L_BACK25:
v_mfma_f32_16x16x32_bf16 v[184:187], a[244:247], a[120:123], v[184:187]
s_add_u32 m0, s33, 96384
v_mfma_f32_16x16x32_bf16 v[188:191], a[244:247], a[124:127], v[188:191]
s_waitcnt lgkmcnt(1)
v_perm_b32 v63, v88, v19, s52
v_mfma_f32_16x16x32_bf16 v[128:131], a[248:251], a[144:147], v[128:131]
ds_read_b128 a[240:243], v17 offset:10240
buffer_load_dwordx4 v8, s[20:23], 0 offen offset:1920 lds
v_mfma_f32_16x16x32_bf16 v[132:135], a[248:251], a[148:151], v[132:135]
ds_read_b32 a160, v63
v_perm_b32 v62, v88, v19, s53
v_mfma_f32_16x16x32_bf16 v[136:139], a[248:251], a[152:155], v[136:139]
ds_read_b32 a161, v62
v_perm_b32 v61, v92, v19, s52
v_mfma_f32_16x16x32_bf16 v[140:143], a[248:251], a[156:159], v[140:143]
s_waitcnt lgkmcnt(3)
ds_read_b32 a162, v61
v_mfma_f32_16x16x32_bf16 v[160:163], a[252:255], a[128:131], v[160:163]
ds_read_b128 a[244:247], v16 offset:24576
v_perm_b32 v60, v92, v19, s53
v_mfma_f32_16x16x32_bf16 v[164:167], a[252:255], a[132:135], v[164:167]
ds_read_b32 a163, v60
v_perm_b32 v59, v88, v19, s54
v_mfma_f32_16x16x32_bf16 v[168:171], a[252:255], a[136:139], v[168:171]
ds_read_b32 a164, v59
v_perm_b32 v58, v88, v19, s55
v_mfma_f32_16x16x32_bf16 v[172:175], a[252:255], a[140:143], v[172:175]
s_waitcnt lgkmcnt(4)
ds_read_b32 a165, v58
v_mfma_f32_16x16x32_bf16 v[208:211], a[240:243], a[96:99], v[208:211]
ds_read_b128 a[248:251], v16 offset:28672
v_perm_b32 v57, v92, v19, s54
v_mfma_f32_16x16x32_bf16 v[212:215], a[240:243], a[100:103], v[212:215]
ds_read_b32 a166, v57
v_perm_b32 v56, v92, v19, s55
v_mfma_f32_16x16x32_bf16 v[216:219], a[240:243], a[104:107], v[216:219]
s_add_u32 m0, s33, 100864
ds_read_b32 a167, v56
v_perm_b32 v63, v89, v19, s52
v_mfma_f32_16x16x32_bf16 v[220:223], a[240:243], a[108:111], v[220:223]
s_waitcnt lgkmcnt(4)
ds_read_b32 a168, v63
v_perm_b32 v62, v89, v19, s53
v_mfma_f32_16x16x32_bf16 v[192:195], a[244:247], a[112:115], v[192:195]
ds_read_b128 a[252:255], v16 offset:22528
buffer_load_dwordx4 v11, s[20:23], 0 offen offset:1536 lds
v_mfma_f32_16x16x32_bf16 v[196:199], a[244:247], a[116:119], v[196:199]
ds_read_b32 a169, v62
v_perm_b32 v61, v93, v19, s52
v_mfma_f32_16x16x32_bf16 v[200:203], a[244:247], a[120:123], v[200:203]
ds_read_b32 a170, v61
v_perm_b32 v60, v93, v19, s53
v_mfma_f32_16x16x32_bf16 v[204:207], a[244:247], a[124:127], v[204:207]
s_waitcnt lgkmcnt(4)
ds_read_b32 a171, v60
buffer_load_dwordx4 v[96:99], v12, s[24:27], 0 offen offset:2048 sc1
v_mfma_f32_16x16x32_bf16 v[224:227], a[248:251], a[80:83], v[224:227]
ds_read_b128 a[240:243], v17 offset:18432
v_perm_b32 v59, v89, v19, s54
v_mfma_f32_16x16x32_bf16 v[228:231], a[248:251], a[84:87], v[228:231]
ds_read_b32 a172, v59
v_perm_b32 v58, v89, v19, s55
v_mfma_f32_16x16x32_bf16 v[232:235], a[248:251], a[88:91], v[232:235]
s_waitcnt vmcnt(11)
v_cmp_ne_u64 s[50:51], s[88:89], v[34:35]
v_cmp_ne_u64 s[44:45], s[88:89], v[38:39]
v_mfma_f32_16x16x32_bf16 v[236:239], a[248:251], a[92:95], v[236:239]
s_waitcnt lgkmcnt(3)
ds_read_b32 a173, v58
buffer_load_dwordx4 v[100:103], v12, s[24:27], 0 offen offset:3072 sc1
v_mfma_f32_16x16x32_bf16 v[144:147], a[252:255], a[144:147], v[144:147]
s_or_b64 s[50:51], s[44:45], s[50:51]
ds_read_b128 a[244:247], v15 offset:51200
v_perm_b32 v57, v93, v19, s54
v_mfma_f32_16x16x32_bf16 v[148:151], a[252:255], a[148:151], v[148:151]
s_cbranch_scc1 L_SLOW26
L_BACK26:
v_mfma_f32_16x16x32_bf16 v[152:155], a[252:255], a[152:155], v[152:155]
s_add_u32 m0, s33, 104576
ds_read_b32 a174, v57
v_perm_b32 v56, v93, v19, s55
v_mfma_f32_16x16x32_bf16 v[156:159], a[252:255], a[156:159], v[156:159]
s_waitcnt lgkmcnt(3)
ds_read_b32 a175, v56
v_perm_b32 v63, v32, v19, s52
v_mfma_f32_16x16x32_bf16 v[176:179], a[240:243], a[128:131], v[176:179]
ds_read_b128 a[248:251], v17 offset:20480
buffer_load_dwordx4 v9, s[20:23], 0 offen offset:1920 lds
v_mfma_f32_16x16x32_bf16 v[180:183], a[240:243], a[132:135], v[180:183]
ds_read_b32 a176, v63
v_perm_b32 v62, v32, v19, s53
v_mfma_f32_16x16x32_bf16 v[184:187], a[240:243], a[136:139], v[184:187]
ds_read_b32 a177, v62
v_perm_b32 v61, v36, v19, s52
v_mfma_f32_16x16x32_bf16 v[188:191], a[240:243], a[140:143], v[188:191]
s_waitcnt lgkmcnt(4)
ds_read_b32 a178, v61
v_add_u32 v12, 61440, v13
v_mfma_f32_16x16x32_bf16 v[240:243], a[244:247], a[32:35], v[240:243]
ds_read_b128 a[252:255], v14 offset:0
v_perm_b32 v60, v36, v19, s53
v_mfma_f32_16x16x32_bf16 v[244:247], a[244:247], a[36:39], v[244:247]
ds_read_b32 a179, v60
v_perm_b32 v59, v32, v19, s54
v_mfma_f32_16x16x32_bf16 v[248:251], a[244:247], a[40:43], v[248:251]
ds_read_b32 a180, v59
v_perm_b32 v58, v32, v19, s55
v_mfma_f32_16x16x32_bf16 v[252:255], a[244:247], a[44:47], v[252:255]
s_waitcnt lgkmcnt(4)
ds_read_b32 a181, v58
v_mfma_f32_16x16x32_bf16 v[128:131], a[248:251], a[160:163], v[128:131]
ds_read_b128 a[240:243], v17 offset:22528
v_perm_b32 v57, v36, v19, s54
v_mfma_f32_16x16x32_bf16 v[132:135], a[248:251], a[164:167], v[132:135]
ds_read_b32 a182, v57
v_perm_b32 v56, v36, v19, s55
v_mfma_f32_16x16x32_bf16 v[136:139], a[248:251], a[168:171], v[136:139]
ds_read_b32 a183, v56
v_perm_b32 v63, v33, v19, s52
v_mfma_f32_16x16x32_bf16 v[140:143], a[248:251], a[172:175], v[140:143]
s_waitcnt lgkmcnt(4)
ds_read_b32 a184, v63
v_mfma_f32_16x16x32_bf16 v[160:163], a[252:255], a[144:147], v[160:163]
ds_read_b128 a[244:247], v17 offset:24576
v_perm_b32 v62, v33, v19, s53
v_mfma_f32_16x16x32_bf16 v[164:167], a[252:255], a[148:151], v[164:167]
ds_read_b32 a185, v62
v_perm_b32 v61, v37, v19, s52
v_mfma_f32_16x16x32_bf16 v[168:171], a[252:255], a[152:155], v[168:171]
ds_read_b32 a186, v61
v_perm_b32 v60, v37, v19, s53
v_mfma_f32_16x16x32_bf16 v[172:175], a[252:255], a[156:159], v[172:175]
s_waitcnt lgkmcnt(4)
ds_read_b32 a187, v60
buffer_load_dwordx4 v[80:83], v12, s[24:27], 0 offen offset:0 sc1
v_mfma_f32_16x16x32_bf16 v[144:147], a[240:243], a[160:163], v[144:147]
ds_read_b128 a[248:251], v16 offset:26624
v_perm_b32 v59, v33, v19, s54
v_mfma_f32_16x16x32_bf16 v[148:151], a[240:243], a[164:167], v[148:151]
ds_read_b32 a188, v59
v_perm_b32 v58, v33, v19, s55
v_mfma_f32_16x16x32_bf16 v[152:155], a[240:243], a[168:171], v[152:155]
s_waitcnt vmcnt(10)
v_cmp_ne_u64 s[50:51], s[88:89], v[42:43]
v_cmp_ne_u64 s[44:45], s[88:89], v[46:47]
v_mfma_f32_16x16x32_bf16 v[156:159], a[240:243], a[172:175], v[156:159]
s_waitcnt lgkmcnt(3)
ds_read_b32 a189, v58
buffer_load_dwordx4 v[84:87], v12, s[24:27], 0 offen offset:1024 sc1
v_mfma_f32_16x16x32_bf16 v[192:195], a[244:247], a[128:131], v[192:195]
s_or_b64 s[50:51], s[44:45], s[50:51]
ds_read_b128 a[252:255], v14 offset:2048
v_perm_b32 v57, v37, v19, s54
v_mfma_f32_16x16x32_bf16 v[196:199], a[244:247], a[132:135], v[196:199]
s_cbranch_scc1 L_SLOW27
L_BACK27:
v_mfma_f32_16x16x32_bf16 v[200:203], a[244:247], a[136:139], v[200:203]
s_add_u32 m0, s33, 108800
ds_read_b32 a190, v57
v_perm_b32 v56, v37, v19, s55
v_mfma_f32_16x16x32_bf16 v[204:207], a[244:247], a[140:143], v[204:207]
s_waitcnt lgkmcnt(3)
ds_read_b32 a191, v56
v_perm_b32 v63, v40, v19, s52
v_mfma_f32_16x16x32_bf16 v[208:211], a[248:251], a[112:115], v[208:211]
ds_read_b128 a[240:243], v17 offset:28672
buffer_load_dwordx4 v10, s[20:23], 0 offen offset:1792 lds
v_mfma_f32_16x16x32_bf16 v[212:215], a[248:251], a[116:119], v[212:215]
ds_read_b32 a192, v63
v_perm_b32 v62, v40, v19, s53
v_mfma_f32_16x16x32_bf16 v[216:219], a[248:251], a[120:123], v[216:219]
ds_read_b32 a193, v62
v_perm_b32 v61, v44, v19, s52
v_mfma_f32_16x16x32_bf16 v[220:223], a[248:251], a[124:127], v[220:223]
s_waitcnt lgkmcnt(4)
ds_read_b32 a194, v61
v_mfma_f32_16x16x32_bf16 v[176:179], a[252:255], a[144:147], v[176:179]
s_barrier
ds_read_b128 a[244:247], v14 offset:4096
v_perm_b32 v60, v44, v19, s53
v_mfma_f32_16x16x32_bf16 v[180:183], a[252:255], a[148:151], v[180:183]
ds_read_b32 a195, v60
v_perm_b32 v59, v40, v19, s54
v_mfma_f32_16x16x32_bf16 v[184:187], a[252:255], a[152:155], v[184:187]
ds_read_b32 a196, v59
v_perm_b32 v58, v40, v19, s55
v_mfma_f32_16x16x32_bf16 v[188:191], a[252:255], a[156:159], v[188:191]
s_waitcnt lgkmcnt(4)
ds_read_b32 a197, v58
v_mfma_f32_16x16x32_bf16 v[224:227], a[240:243], a[96:99], v[224:227]
ds_read_b128 a[248:251], v15 offset:0
v_perm_b32 v57, v44, v19, s54
v_mfma_f32_16x16x32_bf16 v[228:231], a[240:243], a[100:103], v[228:231]
ds_read_b32 a198, v57
v_perm_b32 v56, v44, v19, s55
v_mfma_f32_16x16x32_bf16 v[232:235], a[240:243], a[104:107], v[232:235]
ds_read_b32 a199, v56
v_perm_b32 v63, v41, v19, s52
v_mfma_f32_16x16x32_bf16 v[236:239], a[240:243], a[108:111], v[236:239]
s_waitcnt lgkmcnt(4)
ds_read_b32 a200, v63
v_mfma_f32_16x16x32_bf16 v[128:131], a[244:247], a[176:179], v[128:131]
ds_read_b128 a[252:255], v14 offset:6144
v_perm_b32 v62, v41, v19, s53
v_mfma_f32_16x16x32_bf16 v[132:135], a[244:247], a[180:183], v[132:135]
ds_read_b32 a201, v62
v_perm_b32 v61, v45, v19, s52
v_mfma_f32_16x16x32_bf16 v[136:139], a[244:247], a[184:187], v[136:139]
s_add_u32 m0, s33, 113024
ds_read_b32 a202, v61
v_perm_b32 v60, v45, v19, s53
v_mfma_f32_16x16x32_bf16 v[140:143], a[244:247], a[188:191], v[140:143]
s_waitcnt lgkmcnt(4)
ds_read_b32 a203, v60
v_perm_b32 v59, v41, v19, s54
v_mfma_f32_16x16x32_bf16 v[160:163], a[248:251], a[160:163], v[160:163]
ds_read_b128 a[240:243], v14 offset:8192
buffer_load_dwordx4 v11, s[20:23], 0 offen offset:1664 lds
v_mfma_f32_16x16x32_bf16 v[164:167], a[248:251], a[164:167], v[164:167]
ds_read_b32 a204, v59
v_perm_b32 v58, v41, v19, s55
v_mfma_f32_16x16x32_bf16 v[168:171], a[248:251], a[168:171], v[168:171]
ds_read_b32 a205, v58
v_perm_b32 v57, v45, v19, s54
v_mfma_f32_16x16x32_bf16 v[172:175], a[248:251], a[172:175], v[172:175]
s_waitcnt lgkmcnt(4)
ds_read_b32 a206, v57
buffer_load_dwordx4 v[88:91], v12, s[24:27], 0 offen offset:2048 sc1
v_mfma_f32_16x16x32_bf16 v[144:147], a[252:255], a[176:179], v[144:147]
ds_read_b128 a[244:247], v15 offset:4096
v_perm_b32 v56, v45, v19, s55
v_mfma_f32_16x16x32_bf16 v[148:151], a[252:255], a[180:183], v[148:151]
ds_read_b32 a207, v56
buffer_load_dwordx4 v[92:95], v12, s[24:27], 0 offen offset:3072 sc1
v_mfma_f32_16x16x32_bf16 v[152:155], a[252:255], a[184:187], v[152:155]
s_waitcnt vmcnt(11)
v_cmp_ne_u64 s[50:51], s[88:89], v[50:51]
v_cmp_ne_u64 s[44:45], s[88:89], v[54:55]
v_mfma_f32_16x16x32_bf16 v[156:159], a[252:255], a[188:191], v[156:159]
s_waitcnt lgkmcnt(3)
v_mfma_f32_16x16x32_bf16 v[192:195], a[240:243], a[144:147], v[192:195]
s_or_b64 s[50:51], s[44:45], s[50:51]
ds_read_b128 a[248:251], v15 offset:2048
v_mfma_f32_16x16x32_bf16 v[196:199], a[240:243], a[148:151], v[196:199]
s_cbranch_scc1 L_SLOW28
L_BACK28:
v_mfma_f32_16x16x32_bf16 v[200:203], a[240:243], a[152:155], v[200:203]
s_add_u32 m0, s33, 116864
v_perm_b32 v63, v48, v19, s52
v_mfma_f32_16x16x32_bf16 v[204:207], a[240:243], a[156:159], v[204:207]
s_waitcnt lgkmcnt(1)
ds_read_b32 a208, v63
v_perm_b32 v62, v48, v19, s53
v_mfma_f32_16x16x32_bf16 v[128:131], a[244:247], a[192:195], v[128:131]
ds_read_b128 a[252:255], v17 offset:26624
buffer_load_dwordx4 v10, s[20:23], 0 offen offset:1920 lds
v_mfma_f32_16x16x32_bf16 v[132:135], a[244:247], a[196:199], v[132:135]
ds_read_b32 a209, v62
v_perm_b32 v61, v52, v19, s52
v_mfma_f32_16x16x32_bf16 v[136:139], a[244:247], a[200:203], v[136:139]
ds_read_b32 a210, v61
v_perm_b32 v60, v52, v19, s53
v_mfma_f32_16x16x32_bf16 v[140:143], a[244:247], a[204:207], v[140:143]
s_waitcnt lgkmcnt(4)
ds_read_b32 a211, v60
v_mfma_f32_16x16x32_bf16 v[176:179], a[248:251], a[160:163], v[176:179]
ds_read_b128 a[240:243], v14 offset:12288
v_perm_b32 v59, v48, v19, s54
v_mfma_f32_16x16x32_bf16 v[180:183], a[248:251], a[164:167], v[180:183]
ds_read_b32 a212, v59
v_perm_b32 v58, v48, v19, s55
v_mfma_f32_16x16x32_bf16 v[184:187], a[248:251], a[168:171], v[184:187]
ds_read_b32 a213, v58
v_perm_b32 v57, v52, v19, s54
v_mfma_f32_16x16x32_bf16 v[188:191], a[248:251], a[172:175], v[188:191]
s_waitcnt lgkmcnt(4)
ds_read_b32 a214, v57
v_mfma_f32_16x16x32_bf16 v[208:211], a[252:255], a[128:131], v[208:211]
ds_read_b128 a[244:247], v16 offset:6144
v_perm_b32 v56, v52, v19, s55
v_mfma_f32_16x16x32_bf16 v[212:215], a[252:255], a[132:135], v[212:215]
ds_read_b32 a215, v56
v_perm_b32 v63, v49, v19, s52
v_mfma_f32_16x16x32_bf16 v[216:219], a[252:255], a[136:139], v[216:219]
s_add_u32 m0, s33, 121088
ds_read_b32 a216, v63
v_perm_b32 v62, v49, v19, s53
v_mfma_f32_16x16x32_bf16 v[220:223], a[252:255], a[140:143], v[220:223]
s_waitcnt lgkmcnt(4)
ds_read_b32 a217, v62
v_perm_b32 v61, v53, v19, s52
v_mfma_f32_16x16x32_bf16 v[160:163], a[240:243], a[176:179], v[160:163]
ds_read_b128 a[248:251], v14 offset:16384
buffer_load_dwordx4 v11, s[20:23], 0 offen offset:1792 lds
v_mfma_f32_16x16x32_bf16 v[164:167], a[240:243], a[180:183], v[164:167]
ds_read_b32 a218, v61
v_perm_b32 v60, v53, v19, s53
v_mfma_f32_16x16x32_bf16 v[168:171], a[240:243], a[184:187], v[168:171]
ds_read_b32 a219, v60
v_perm_b32 v59, v49, v19, s54
v_mfma_f32_16x16x32_bf16 v[172:175], a[240:243], a[188:191], v[172:175]
s_waitcnt lgkmcnt(4)
ds_read_b32 a220, v59
v_mfma_f32_16x16x32_bf16 v[240:243], a[244:247], a[48:51], v[240:243]
ds_read_b128 a[252:255], v15 offset:6144
v_perm_b32 v58, v49, v19, s55
v_mfma_f32_16x16x32_bf16 v[244:247], a[244:247], a[52:55], v[244:247]
ds_read_b32 a221, v58
v_perm_b32 v57, v53, v19, s54
v_mfma_f32_16x16x32_bf16 v[248:251], a[244:247], a[56:59], v[248:251]
s_waitcnt vmcnt(9)
v_cmp_ne_u64 s[50:51], s[88:89], v[98:99]
v_cmp_ne_u64 s[44:45], s[88:89], v[102:103]
v_mfma_f32_16x16x32_bf16 v[252:255], a[244:247], a[60:63], v[252:255]
s_waitcnt lgkmcnt(3)
ds_read_b32 a222, v57
v_mfma_f32_16x16x32_bf16 v[224:227], a[248:251], a[112:115], v[224:227]
s_or_b64 s[50:51], s[44:45], s[50:51]
ds_read_b128 a[240:243], v14 offset:20480
v_perm_b32 v56, v53, v19, s55
v_mfma_f32_16x16x32_bf16 v[228:231], a[248:251], a[116:119], v[228:231]
s_cbranch_scc1 L_SLOW29
L_BACK29:
v_mfma_f32_16x16x32_bf16 v[232:235], a[248:251], a[120:123], v[232:235]
s_add_u32 m0, s33, 125056
ds_read_b32 a223, v56
v_mfma_f32_16x16x32_bf16 v[236:239], a[248:251], a[124:127], v[236:239]
s_waitcnt lgkmcnt(3)
v_mfma_f32_16x16x32_bf16 v[144:147], a[252:255], a[192:195], v[144:147]
ds_read_b128 a[244:247], v15 offset:8192
buffer_load_dwordx4 v11, s[20:23], 0 offen offset:1920 lds
v_mfma_f32_16x16x32_bf16 v[148:151], a[252:255], a[196:199], v[148:151]
v_perm_b32 v63, v96, v19, s52
v_mfma_f32_16x16x32_bf16 v[152:155], a[252:255], a[200:203], v[152:155]
ds_read_b32 a224, v63
v_perm_b32 v62, v96, v19, s53
v_mfma_f32_16x16x32_bf16 v[156:159], a[252:255], a[204:207], v[156:159]
s_waitcnt lgkmcnt(2)
ds_read_b32 a225, v62
v_mfma_f32_16x16x32_bf16 v[128:131], a[240:243], a[208:211], v[128:131]
ds_read_b128 a[248:251], v14 offset:14336
v_perm_b32 v61, v100, v19, s52
v_mfma_f32_16x16x32_bf16 v[132:135], a[240:243], a[212:215], v[132:135]
ds_read_b32 a226, v61
v_perm_b32 v60, v100, v19, s53
v_mfma_f32_16x16x32_bf16 v[136:139], a[240:243], a[216:219], v[136:139]
ds_read_b32 a227, v60
v_perm_b32 v59, v96, v19, s54
v_mfma_f32_16x16x32_bf16 v[140:143], a[240:243], a[220:223], v[140:143]
s_waitcnt lgkmcnt(4)
ds_read_b32 a228, v59
v_mfma_f32_16x16x32_bf16 v[192:195], a[244:247], a[160:163], v[192:195]
ds_read_b128 a[252:255], v15 offset:12288
v_perm_b32 v58, v96, v19, s55
v_mfma_f32_16x16x32_bf16 v[196:199], a[244:247], a[164:167], v[196:199]
ds_read_b32 a229, v58
v_perm_b32 v57, v100, v19, s54
v_mfma_f32_16x16x32_bf16 v[200:203], a[244:247], a[168:171], v[200:203]
ds_read_b32 a230, v57
v_perm_b32 v56, v100, v19, s55
v_mfma_f32_16x16x32_bf16 v[204:207], a[244:247], a[172:175], v[204:207]
s_waitcnt lgkmcnt(4)
ds_read_b32 a231, v56
v_mfma_f32_16x16x32_bf16 v[176:179], a[248:251], a[176:179], v[176:179]
ds_read_b128 a[240:243], v14 offset:10240
v_perm_b32 v63, v97, v19, s52
v_mfma_f32_16x16x32_bf16 v[180:183], a[248:251], a[180:183], v[180:183]
ds_read_b32 a232, v63
v_perm_b32 v62, v97, v19, s53
v_mfma_f32_16x16x32_bf16 v[184:187], a[248:251], a[184:187], v[184:187]
ds_read_b32 a233, v62
v_perm_b32 v61, v101, v19, s52
v_mfma_f32_16x16x32_bf16 v[188:191], a[248:251], a[188:191], v[188:191]
s_waitcnt lgkmcnt(4)
ds_read_b32 a234, v61
v_mfma_f32_16x16x32_bf16 v[160:163], a[252:255], a[192:195], v[160:163]
s_waitcnt vmcnt(9)
s_barrier
ds_read_b128 a[244:247], v14 offset:22528
v_perm_b32 v60, v101, v19, s53
v_mfma_f32_16x16x32_bf16 v[164:167], a[252:255], a[196:199], v[164:167]
ds_read_b32 a235, v60
v_perm_b32 v59, v97, v19, s54
v_mfma_f32_16x16x32_bf16 v[168:171], a[252:255], a[200:203], v[168:171]
ds_read_b32 a236, v59
v_perm_b32 v58, v97, v19, s55
v_mfma_f32_16x16x32_bf16 v[172:175], a[252:255], a[204:207], v[172:175]
s_waitcnt lgkmcnt(4)
ds_read_b32 a237, v58
v_mfma_f32_16x16x32_bf16 v[208:211], a[240:243], a[144:147], v[208:211]
ds_read_b128 a[248:251], v15 offset:20480
v_perm_b32 v57, v101, v19, s54
v_mfma_f32_16x16x32_bf16 v[212:215], a[240:243], a[148:151], v[212:215]
ds_read_b32 a238, v57
v_perm_b32 v56, v101, v19, s55
v_mfma_f32_16x16x32_bf16 v[216:219], a[240:243], a[152:155], v[216:219]
ds_read_b32 a239, v56
v_mfma_f32_16x16x32_bf16 v[220:223], a[240:243], a[156:159], v[220:223]
s_waitcnt vmcnt(7) lgkmcnt(4)
v_cmp_ne_u64 s[50:51], s[88:89], v[82:83]
v_cmp_ne_u64 s[44:45], s[88:89], v[86:87]
v_mfma_f32_16x16x32_bf16 v[144:147], a[244:247], a[208:211], v[144:147]
ds_read_b128 a[252:255], v15 offset:16384
v_mfma_f32_16x16x32_bf16 v[148:151], a[244:247], a[212:215], v[148:151]
s_or_b64 s[50:51], s[44:45], s[50:51]
v_mfma_f32_16x16x32_bf16 v[152:155], a[244:247], a[216:219], v[152:155]
s_cbranch_scc1 L_SLOW30
L_BACK30:
v_mfma_f32_16x16x32_bf16 v[156:159], a[244:247], a[220:223], v[156:159]
s_waitcnt lgkmcnt(1)
v_mfma_f32_16x16x32_bf16 v[128:131], a[248:251], a[224:227], v[128:131]
ds_read_b128 a[240:243], v15 offset:14336
v_mfma_f32_16x16x32_bf16 v[132:135], a[248:251], a[228:231], v[132:135]
v_perm_b32 v63, v80, v19, s52
v_mfma_f32_16x16x32_bf16 v[136:139], a[248:251], a[232:235], v[136:139]
ds_read_b32 a0, v63
v_perm_b32 v62, v80, v19, s53
v_mfma_f32_16x16x32_bf16 v[140:143], a[248:251], a[236:239], v[140:143]
s_waitcnt lgkmcnt(2)
ds_read_b32 a1, v62
v_mfma_f32_16x16x32_bf16 v[224:227], a[252:255], a[128:131], v[224:227]
ds_read_b128 a[244:247], v14 offset:24576
v_perm_b32 v61, v84, v19, s52
v_mfma_f32_16x16x32_bf16 v[228:231], a[252:255], a[132:135], v[228:231]
ds_read_b32 a2, v61
v_perm_b32 v60, v84, v19, s53
v_mfma_f32_16x16x32_bf16 v[232:235], a[252:255], a[136:139], v[232:235]
ds_read_b32 a3, v60
v_perm_b32 v59, v80, v19, s54
v_mfma_f32_16x16x32_bf16 v[236:239], a[252:255], a[140:143], v[236:239]
s_waitcnt lgkmcnt(4)
ds_read_b32 a4, v59
v_mfma_f32_16x16x32_bf16 v[176:179], a[240:243], a[192:195], v[176:179]
ds_read_b128 a[248:251], v14 offset:28672
v_perm_b32 v58, v80, v19, s55
v_mfma_f32_16x16x32_bf16 v[180:183], a[240:243], a[196:199], v[180:183]
ds_read_b32 a5, v58
v_perm_b32 v57, v84, v19, s54
v_mfma_f32_16x16x32_bf16 v[184:187], a[240:243], a[200:203], v[184:187]
ds_read_b32 a6, v57
v_perm_b32 v56, v84, v19, s55
v_mfma_f32_16x16x32_bf16 v[188:191], a[240:243], a[204:207], v[188:191]
s_waitcnt lgkmcnt(4)
ds_read_b32 a7, v56
v_mfma_f32_16x16x32_bf16 v[192:195], a[244:247], a[176:179], v[192:195]
ds_read_b128 a[252:255], v15 offset:22528
v_perm_b32 v63, v81, v19, s52
v_mfma_f32_16x16x32_bf16 v[196:199], a[244:247], a[180:183], v[196:199]
ds_read_b32 a8, v63
v_perm_b32 v62, v81, v19, s53
v_mfma_f32_16x16x32_bf16 v[200:203], a[244:247], a[184:187], v[200:203]
ds_read_b32 a9, v62
v_perm_b32 v61, v85, v19, s52
v_mfma_f32_16x16x32_bf16 v[204:207], a[244:247], a[188:191], v[204:207]
s_waitcnt lgkmcnt(4)
ds_read_b32 a10, v61
v_mfma_f32_16x16x32_bf16 v[160:163], a[248:251], a[208:211], v[160:163]
ds_read_b128 a[240:243], v15 offset:10240
v_perm_b32 v60, v85, v19, s53
v_mfma_f32_16x16x32_bf16 v[164:167], a[248:251], a[212:215], v[164:167]
ds_read_b32 a11, v60
v_perm_b32 v59, v81, v19, s54
v_mfma_f32_16x16x32_bf16 v[168:171], a[248:251], a[216:219], v[168:171]
ds_read_b32 a12, v59
v_perm_b32 v58, v81, v19, s55
v_mfma_f32_16x16x32_bf16 v[172:175], a[248:251], a[220:223], v[172:175]
s_waitcnt lgkmcnt(4)
ds_read_b32 a13, v58
v_mfma_f32_16x16x32_bf16 v[144:147], a[252:255], a[224:227], v[144:147]
ds_read_b128 a[244:247], v14 offset:32768
v_perm_b32 v57, v85, v19, s54
v_mfma_f32_16x16x32_bf16 v[148:151], a[252:255], a[228:231], v[148:151]
ds_read_b32 a14, v57
v_perm_b32 v56, v85, v19, s55
v_mfma_f32_16x16x32_bf16 v[152:155], a[252:255], a[232:235], v[152:155]
ds_read_b32 a15, v56
v_mfma_f32_16x16x32_bf16 v[156:159], a[252:255], a[236:239], v[156:159]
s_waitcnt vmcnt(3) lgkmcnt(4)
v_cmp_ne_u64 s[50:51], s[88:89], v[90:91]
v_cmp_ne_u64 s[44:45], s[88:89], v[94:95]
v_mfma_f32_16x16x32_bf16 v[208:211], a[240:243], a[160:163], v[208:211]
ds_read_b128 a[248:251], v17 offset:6144
v_mfma_f32_16x16x32_bf16 v[212:215], a[240:243], a[164:167], v[212:215]
s_or_b64 s[50:51], s[44:45], s[50:51]
v_mfma_f32_16x16x32_bf16 v[216:219], a[240:243], a[168:171], v[216:219]
s_cbranch_scc1 L_SLOW31
L_BACK31:
v_mfma_f32_16x16x32_bf16 v[220:223], a[240:243], a[172:175], v[220:223]
s_waitcnt lgkmcnt(1)
v_mfma_f32_16x16x32_bf16 v[128:131], a[244:247], a[0:3], v[128:131]
ds_read_b128 a[252:255], v14 offset:30720
v_mfma_f32_16x16x32_bf16 v[132:135], a[244:247], a[4:7], v[132:135]
v_perm_b32 v63, v88, v19, s52
v_mfma_f32_16x16x32_bf16 v[136:139], a[244:247], a[8:11], v[136:139]
ds_read_b32 a16, v63
v_perm_b32 v62, v88, v19, s53
v_mfma_f32_16x16x32_bf16 v[140:143], a[244:247], a[12:15], v[140:143]
s_waitcnt lgkmcnt(2)
ds_read_b32 a17, v62
v_mfma_f32_16x16x32_bf16 v[240:243], a[248:251], a[64:67], v[240:243]
ds_read_b128 a[240:243], v15 offset:28672
v_perm_b32 v61, v92, v19, s52
v_mfma_f32_16x16x32_bf16 v[244:247], a[248:251], a[68:71], v[244:247]
ds_read_b32 a18, v61
v_perm_b32 v60, v92, v19, s53
v_mfma_f32_16x16x32_bf16 v[248:251], a[248:251], a[72:75], v[248:251]
ds_read_b32 a19, v60
v_perm_b32 v59, v88, v19, s54
v_mfma_f32_16x16x32_bf16 v[252:255], a[248:251], a[76:79], v[252:255]
s_waitcnt lgkmcnt(4)
ds_read_b32 a20, v59
v_mfma_f32_16x16x32_bf16 v[176:179], a[252:255], a[208:211], v[176:179]
ds_read_b128 a[244:247], v15 offset:24576
v_perm_b32 v58, v88, v19, s55
v_mfma_f32_16x16x32_bf16 v[180:183], a[252:255], a[212:215], v[180:183]
ds_read_b32 a21, v58
v_perm_b32 v57, v92, v19, s54
v_mfma_f32_16x16x32_bf16 v[184:187], a[252:255], a[216:219], v[184:187]
ds_read_b32 a22, v57
v_perm_b32 v56, v92, v19, s55
v_mfma_f32_16x16x32_bf16 v[188:191], a[252:255], a[220:223], v[188:191]
s_waitcnt lgkmcnt(4)
ds_read_b32 a23, v56
v_mfma_f32_16x16x32_bf16 v[160:163], a[240:243], a[224:227], v[160:163]
ds_read_b128 a[248:251], v14 offset:36864
v_perm_b32 v63, v89, v19, s52
v_mfma_f32_16x16x32_bf16 v[164:167], a[240:243], a[228:231], v[164:167]
L_PAD5:
s_cbranch_vccnz L_PADRET
ds_read_b32 a24, v63
v_perm_b32 v62, v89, v19, s53
v_mfma_f32_16x16x32_bf16 v[168:171], a[240:243], a[232:235], v[168:171]
ds_read_b32 a25, v62
v_perm_b32 v61, v93, v19, s52
v_mfma_f32_16x16x32_bf16 v[172:175], a[240:243], a[236:239], v[172:175]
s_waitcnt lgkmcnt(4)
ds_read_b32 a26, v61
v_mfma_f32_16x16x32_bf16 v[192:195], a[244:247], a[192:195], v[192:195]
ds_read_b128 a[252:255], v14 offset:34816
v_perm_b32 v60, v93, v19, s53
v_mfma_f32_16x16x32_bf16 v[196:199], a[244:247], a[196:199], v[196:199]
ds_read_b32 a27, v60
v_perm_b32 v59, v89, v19, s54
v_mfma_f32_16x16x32_bf16 v[200:203], a[244:247], a[200:203], v[200:203]
ds_read_b32 a28, v59
v_perm_b32 v58, v89, v19, s55
v_mfma_f32_16x16x32_bf16 v[204:207], a[244:247], a[204:207], v[204:207]
s_waitcnt lgkmcnt(4)
ds_read_b32 a29, v58
v_mfma_f32_16x16x32_bf16 v[224:227], a[248:251], a[144:147], v[224:227]
ds_read_b128 a[240:243], v15 offset:32768
v_perm_b32 v57, v93, v19, s54
v_mfma_f32_16x16x32_bf16 v[228:231], a[248:251], a[148:151], v[228:231]
ds_read_b32 a30, v57
v_perm_b32 v56, v93, v19, s55
v_mfma_f32_16x16x32_bf16 v[232:235], a[248:251], a[152:155], v[232:235]
ds_read_b32 a31, v56
v_mfma_f32_16x16x32_bf16 v[236:239], a[248:251], a[156:159], v[236:239]
s_waitcnt lgkmcnt(4)
v_mfma_f32_16x16x32_bf16 v[144:147], a[252:255], a[0:3], v[144:147]
ds_read_b128 a[244:247], v14 offset:26624
v_mfma_f32_16x16x32_bf16 v[148:151], a[252:255], a[4:7], v[148:151]
v_mfma_f32_16x16x32_bf16 v[152:155], a[252:255], a[8:11], v[152:155]
v_mfma_f32_16x16x32_bf16 v[156:159], a[252:255], a[12:15], v[156:159]
s_waitcnt lgkmcnt(1)
v_mfma_f32_16x16x32_bf16 v[128:131], a[240:243], a[16:19], v[128:131]
ds_read_b128 a[248:251], v15 offset:30720
v_mfma_f32_16x16x32_bf16 v[132:135], a[240:243], a[20:23], v[132:135]
v_mfma_f32_16x16x32_bf16 v[136:139], a[240:243], a[24:27], v[136:139]
v_mfma_f32_16x16x32_bf16 v[140:143], a[240:243], a[28:31], v[140:143]
s_waitcnt lgkmcnt(1)
v_mfma_f32_16x16x32_bf16 v[208:211], a[244:247], a[176:179], v[208:211]
ds_read_b128 a[252:255], v14 offset:40960
v_mfma_f32_16x16x32_bf16 v[212:215], a[244:247], a[180:183], v[212:215]
v_mfma_f32_16x16x32_bf16 v[216:219], a[244:247], a[184:187], v[216:219]
v_mfma_f32_16x16x32_bf16 v[220:223], a[244:247], a[188:191], v[220:223]
s_waitcnt lgkmcnt(1)
v_mfma_f32_16x16x32_bf16 v[176:179], a[248:251], a[224:227], v[176:179]
s_waitcnt vmcnt(0)
s_barrier
ds_read_b128 a[240:243], v15 offset:34816
v_mfma_f32_16x16x32_bf16 v[180:183], a[248:251], a[228:231], v[180:183]
v_mfma_f32_16x16x32_bf16 v[184:187], a[248:251], a[232:235], v[184:187]
v_mfma_f32_16x16x32_bf16 v[188:191], a[248:251], a[236:239], v[188:191]
s_waitcnt lgkmcnt(1)
v_mul_f32 v128, v128, v24
v_mul_f32 v132, v132, v25
v_mfma_f32_16x16x32_bf16 v[160:163], a[252:255], a[0:3], v[160:163]
ds_read_b128 a[244:247], v14 offset:45056
v_mul_f32 v136, v136, v26
v_mfma_f32_16x16x32_bf16 v[164:167], a[252:255], a[4:7], v[164:167]
v_mul_f32 v140, v140, v27
v_cvt_pk_bf16_f32 v120, v128, v132
v_mfma_f32_16x16x32_bf16 v[168:171], a[252:255], a[8:11], v[168:171]
v_cvt_pk_bf16_f32 v121, v136, v140
v_mfma_f32_16x16x32_bf16 v[172:175], a[252:255], a[12:15], v[172:175]
s_waitcnt lgkmcnt(1)
v_mfma_f32_16x16x32_bf16 v[144:147], a[240:243], a[16:19], v[144:147]
ds_read_b128 a[248:251], v15 offset:36864
v_mfma_f32_16x16x32_bf16 v[148:151], a[240:243], a[20:23], v[148:151]
buffer_store_dwordx2 v[120:121], v18, s[28:31], 0 offen nt
v_mul_f32 v129, v129, v24
v_mfma_f32_16x16x32_bf16 v[152:155], a[240:243], a[24:27], v[152:155]
s_add_u32 s28, s28, 7168
v_mul_f32 v133, v133, v25
v_mul_f32 v137, v137, v26
v_mfma_f32_16x16x32_bf16 v[156:159], a[240:243], a[28:31], v[156:159]
s_waitcnt lgkmcnt(1)
v_mul_f32 v141, v141, v27
v_cvt_pk_bf16_f32 v122, v129, v133
v_mfma_f32_16x16x32_bf16 v[192:195], a[244:247], a[208:211], v[192:195]
s_addc_u32 s29, s29, 0
ds_read_b128 a[252:255], v15 offset:26624
v_cvt_pk_bf16_f32 v123, v137, v141
v_mfma_f32_16x16x32_bf16 v[196:199], a[244:247], a[212:215], v[196:199]
buffer_store_dwordx2 v[122:123], v18, s[28:31], 0 offen nt
v_mul_f32 v130, v130, v24
v_mfma_f32_16x16x32_bf16 v[200:203], a[244:247], a[216:219], v[200:203]
s_add_u32 s28, s28, 7168
v_mul_f32 v134, v134, v25
v_mul_f32 v138, v138, v26
v_mfma_f32_16x16x32_bf16 v[204:207], a[244:247], a[220:223], v[204:207]
s_waitcnt lgkmcnt(1)
v_mul_f32 v142, v142, v27
v_cvt_pk_bf16_f32 v124, v130, v134
v_mfma_f32_16x16x32_bf16 v[224:227], a[248:251], a[160:163], v[224:227]
s_addc_u32 s29, s29, 0
ds_read_b128 a[240:243], v16 offset:30720
v_cvt_pk_bf16_f32 v125, v138, v142
v_mfma_f32_16x16x32_bf16 v[228:231], a[248:251], a[164:167], v[228:231]
buffer_store_dwordx2 v[124:125], v18, s[28:31], 0 offen nt
v_mul_f32 v131, v131, v24
v_mfma_f32_16x16x32_bf16 v[232:235], a[248:251], a[168:171], v[232:235]
s_add_u32 s28, s28, 7168
v_mul_f32 v135, v135, v25
v_mul_f32 v139, v139, v26
v_mfma_f32_16x16x32_bf16 v[236:239], a[248:251], a[172:175], v[236:239]
s_waitcnt lgkmcnt(1)
v_mul_f32 v143, v143, v27
v_cvt_pk_bf16_f32 v126, v131, v135
v_mfma_f32_16x16x32_bf16 v[208:211], a[252:255], a[192:195], v[208:211]
s_addc_u32 s29, s29, 0
ds_read_b128 a[244:247], v15 offset:40960
v_cvt_pk_bf16_f32 v127, v139, v143
v_mfma_f32_16x16x32_bf16 v[212:215], a[252:255], a[196:199], v[212:215]
buffer_store_dwordx2 v[126:127], v18, s[28:31], 0 offen nt
v_mul_f32 v144, v144, v24
v_mfma_f32_16x16x32_bf16 v[216:219], a[252:255], a[200:203], v[216:219]
s_add_u32 s28, s28, 93184
v_mul_f32 v148, v148, v25
v_mul_f32 v152, v152, v26
v_mfma_f32_16x16x32_bf16 v[220:223], a[252:255], a[204:207], v[220:223]
s_waitcnt lgkmcnt(1)
v_mul_f32 v156, v156, v27
v_cvt_pk_bf16_f32 v120, v144, v148
v_mfma_f32_16x16x32_bf16 v[240:243], a[240:243], a[80:83], v[240:243]
s_addc_u32 s29, s29, 0
ds_read_b128 a[248:251], v14 offset:43008
v_cvt_pk_bf16_f32 v121, v152, v156
v_mfma_f32_16x16x32_bf16 v[244:247], a[240:243], a[84:87], v[244:247]
buffer_store_dwordx2 v[120:121], v18, s[28:31], 0 offen nt
v_mul_f32 v145, v145, v24
v_mfma_f32_16x16x32_bf16 v[248:251], a[240:243], a[88:91], v[248:251]
s_add_u32 s28, s28, 7168
v_mul_f32 v149, v149, v25
v_mul_f32 v153, v153, v26
v_mfma_f32_16x16x32_bf16 v[252:255], a[240:243], a[92:95], v[252:255]
s_waitcnt lgkmcnt(1)
v_mul_f32 v157, v157, v27
v_cvt_pk_bf16_f32 v122, v145, v149
v_mfma_f32_16x16x32_bf16 v[160:163], a[244:247], a[16:19], v[160:163]
s_addc_u32 s29, s29, 0
ds_read_b128 a[252:255], v15 offset:45056
v_cvt_pk_bf16_f32 v123, v153, v157
v_mfma_f32_16x16x32_bf16 v[164:167], a[244:247], a[20:23], v[164:167]
buffer_store_dwordx2 v[122:123], v18, s[28:31], 0 offen nt
v_mul_f32 v146, v146, v24
v_mfma_f32_16x16x32_bf16 v[168:171], a[244:247], a[24:27], v[168:171]
s_add_u32 s28, s28, 7168
v_mul_f32 v150, v150, v25
v_mul_f32 v154, v154, v26
v_mfma_f32_16x16x32_bf16 v[172:175], a[244:247], a[28:31], v[172:175]
s_waitcnt lgkmcnt(1)
v_mul_f32 v158, v158, v27
v_cvt_pk_bf16_f32 v124, v146, v150
v_mfma_f32_16x16x32_bf16 v[176:179], a[248:251], a[0:3], v[176:179]
s_addc_u32 s29, s29, 0
ds_read_b128 a[240:243], v14 offset:49152
v_cvt_pk_bf16_f32 v125, v154, v158
v_mfma_f32_16x16x32_bf16 v[180:183], a[248:251], a[4:7], v[180:183]
buffer_store_dwordx2 v[124:125], v18, s[28:31], 0 offen nt
v_mul_f32 v147, v147, v24
v_mfma_f32_16x16x32_bf16 v[184:187], a[248:251], a[8:11], v[184:187]
s_add_u32 s28, s28, 7168
v_mul_f32 v151, v151, v25
v_mul_f32 v155, v155, v26
v_mfma_f32_16x16x32_bf16 v[188:191], a[248:251], a[12:15], v[188:191]
s_waitcnt lgkmcnt(1)
v_mul_f32 v159, v159, v27
v_cvt_pk_bf16_f32 v126, v147, v151
v_mfma_f32_16x16x32_bf16 v[192:195], a[252:255], a[224:227], v[192:195]
s_addc_u32 s29, s29, 0
ds_read_b128 a[244:247], v14 offset:47104
v_cvt_pk_bf16_f32 v127, v155, v159
v_mfma_f32_16x16x32_bf16 v[196:199], a[252:255], a[228:231], v[196:199]
buffer_store_dwordx2 v[126:127], v18, s[28:31], 0 offen nt
v_mfma_f32_16x16x32_bf16 v[200:203], a[252:255], a[232:235], v[200:203]
v_mfma_f32_16x16x32_bf16 v[204:207], a[252:255], a[236:239], v[204:207]
s_waitcnt lgkmcnt(1)
v_mul_f32 v160, v160, v24
v_mul_f32 v164, v164, v25
v_mfma_f32_16x16x32_bf16 v[224:227], a[240:243], a[176:179], v[224:227]
s_add_u32 s28, s28, 93184
ds_read_b128 a[248:251], v15 offset:43008
v_mul_f32 v168, v168, v26
v_mfma_f32_16x16x32_bf16 v[228:231], a[240:243], a[180:183], v[228:231]
s_addc_u32 s29, s29, 0
v_mul_f32 v172, v172, v27
v_cvt_pk_bf16_f32 v120, v160, v164
v_mfma_f32_16x16x32_bf16 v[232:235], a[240:243], a[184:187], v[232:235]
v_cvt_pk_bf16_f32 v121, v168, v172
v_mfma_f32_16x16x32_bf16 v[236:239], a[240:243], a[188:191], v[236:239]
s_waitcnt lgkmcnt(1)
v_mfma_f32_16x16x32_bf16 v[208:211], a[244:247], a[208:211], v[208:211]
ds_read_b128 a[252:255], v14 offset:53248
v_mfma_f32_16x16x32_bf16 v[212:215], a[244:247], a[212:215], v[212:215]
buffer_store_dwordx2 v[120:121], v18, s[28:31], 0 offen nt
v_mul_f32 v161, v161, v24
v_mfma_f32_16x16x32_bf16 v[216:219], a[244:247], a[216:219], v[216:219]
s_add_u32 s28, s28, 7168
v_mul_f32 v165, v165, v25
v_mul_f32 v169, v169, v26
v_mfma_f32_16x16x32_bf16 v[220:223], a[244:247], a[220:223], v[220:223]
s_waitcnt lgkmcnt(1)
v_mul_f32 v173, v173, v27
v_cvt_pk_bf16_f32 v122, v161, v165
v_mfma_f32_16x16x32_bf16 v[176:179], a[248:251], a[16:19], v[176:179]
s_addc_u32 s29, s29, 0
ds_read_b128 a[240:243], v17 offset:30720
v_cvt_pk_bf16_f32 v123, v169, v173
v_mfma_f32_16x16x32_bf16 v[180:183], a[248:251], a[20:23], v[180:183]
buffer_store_dwordx2 v[122:123], v18, s[28:31], 0 offen nt
v_mul_f32 v162, v162, v24
v_mfma_f32_16x16x32_bf16 v[184:187], a[248:251], a[24:27], v[184:187]
s_add_u32 s28, s28, 7168
v_mul_f32 v166, v166, v25
v_mul_f32 v170, v170, v26
v_mfma_f32_16x16x32_bf16 v[188:191], a[248:251], a[28:31], v[188:191]
s_waitcnt lgkmcnt(1)
v_mul_f32 v174, v174, v27
v_cvt_pk_bf16_f32 v124, v162, v166
v_mfma_f32_16x16x32_bf16 v[192:195], a[252:255], a[0:3], v[192:195]
s_addc_u32 s29, s29, 0
ds_read_b128 a[244:247], v15 offset:47104
v_cvt_pk_bf16_f32 v125, v170, v174
v_mfma_f32_16x16x32_bf16 v[196:199], a[252:255], a[4:7], v[196:199]
buffer_store_dwordx2 v[124:125], v18, s[28:31], 0 offen nt
v_mul_f32 v163, v163, v24
v_mfma_f32_16x16x32_bf16 v[200:203], a[252:255], a[8:11], v[200:203]
s_add_u32 s28, s28, 7168
v_mul_f32 v167, v167, v25
v_mul_f32 v171, v171, v26
v_mfma_f32_16x16x32_bf16 v[204:207], a[252:255], a[12:15], v[204:207]
s_waitcnt lgkmcnt(1)
v_mul_f32 v175, v175, v27
v_cvt_pk_bf16_f32 v126, v163, v167
v_mfma_f32_16x16x32_bf16 v[240:243], a[240:243], a[96:99], v[240:243]
s_addc_u32 s29, s29, 0
ds_read_b128 a[248:251], v15 offset:49152
v_cvt_pk_bf16_f32 v127, v171, v175
v_mfma_f32_16x16x32_bf16 v[244:247], a[240:243], a[100:103], v[244:247]
buffer_store_dwordx2 v[126:127], v18, s[28:31], 0 offen nt
v_mfma_f32_16x16x32_bf16 v[248:251], a[240:243], a[104:107], v[248:251]
v_mfma_f32_16x16x32_bf16 v[252:255], a[240:243], a[108:111], v[252:255]
s_waitcnt lgkmcnt(1)
v_mul_f32 v176, v176, v24
v_mul_f32 v180, v180, v25
v_mfma_f32_16x16x32_bf16 v[208:211], a[244:247], a[224:227], v[208:211]
s_add_u32 s28, s28, 93184
ds_read_b128 a[252:255], v15 offset:53248
v_mul_f32 v184, v184, v26
v_mfma_f32_16x16x32_bf16 v[212:215], a[244:247], a[228:231], v[212:215]
s_addc_u32 s29, s29, 0
v_mul_f32 v188, v188, v27
v_cvt_pk_bf16_f32 v120, v176, v180
v_mfma_f32_16x16x32_bf16 v[216:219], a[244:247], a[232:235], v[216:219]
v_cvt_pk_bf16_f32 v121, v184, v188
v_mfma_f32_16x16x32_bf16 v[220:223], a[244:247], a[236:239], v[220:223]
s_waitcnt lgkmcnt(1)
v_mfma_f32_16x16x32_bf16 v[224:227], a[248:251], a[192:195], v[224:227]
ds_read_b128 a[240:243], v14 offset:55296
v_mfma_f32_16x16x32_bf16 v[228:231], a[248:251], a[196:199], v[228:231]
buffer_store_dwordx2 v[120:121], v18, s[28:31], 0 offen nt
v_mul_f32 v177, v177, v24
v_mfma_f32_16x16x32_bf16 v[232:235], a[248:251], a[200:203], v[232:235]
s_add_u32 s28, s28, 7168
v_mul_f32 v181, v181, v25
v_mul_f32 v185, v185, v26
v_mfma_f32_16x16x32_bf16 v[236:239], a[248:251], a[204:207], v[236:239]
s_waitcnt lgkmcnt(1)
v_mul_f32 v189, v189, v27
v_cvt_pk_bf16_f32 v122, v177, v181
v_mfma_f32_16x16x32_bf16 v[192:195], a[252:255], a[16:19], v[192:195]
s_addc_u32 s29, s29, 0
ds_read_b128 a[244:247], v14 offset:57344
v_cvt_pk_bf16_f32 v123, v185, v189
v_mfma_f32_16x16x32_bf16 v[196:199], a[252:255], a[20:23], v[196:199]
buffer_store_dwordx2 v[122:123], v18, s[28:31], 0 offen nt
v_mul_f32 v178, v178, v24
v_mfma_f32_16x16x32_bf16 v[200:203], a[252:255], a[24:27], v[200:203]
s_add_u32 s28, s28, 7168
v_mul_f32 v182, v182, v25
v_mul_f32 v186, v186, v26
v_mfma_f32_16x16x32_bf16 v[204:207], a[252:255], a[28:31], v[204:207]
s_waitcnt lgkmcnt(1)
v_mul_f32 v190, v190, v27
v_cvt_pk_bf16_f32 v124, v178, v182
v_mfma_f32_16x16x32_bf16 v[208:211], a[240:243], a[0:3], v[208:211]
s_addc_u32 s29, s29, 0
ds_read_b128 a[248:251], v14 offset:18432
v_cvt_pk_bf16_f32 v125, v186, v190
v_mfma_f32_16x16x32_bf16 v[212:215], a[240:243], a[4:7], v[212:215]
buffer_store_dwordx2 v[124:125], v18, s[28:31], 0 offen nt
v_mul_f32 v179, v179, v24
v_mfma_f32_16x16x32_bf16 v[216:219], a[240:243], a[8:11], v[216:219]
s_add_u32 s28, s28, 7168
v_mul_f32 v183, v183, v25
v_mul_f32 v187, v187, v26
v_mfma_f32_16x16x32_bf16 v[220:223], a[240:243], a[12:15], v[220:223]
s_waitcnt lgkmcnt(1)
v_mul_f32 v191, v191, v27
v_cvt_pk_bf16_f32 v126, v179, v183
v_mfma_f32_16x16x32_bf16 v[224:227], a[244:247], a[208:211], v[224:227]
s_addc_u32 s29, s29, 0
ds_read_b128 a[252:255], v15 offset:55296
v_cvt_pk_bf16_f32 v127, v187, v191
v_mfma_f32_16x16x32_bf16 v[228:231], a[244:247], a[212:215], v[228:231]
buffer_store_dwordx2 v[126:127], v18, s[28:31], 0 offen nt
v_mfma_f32_16x16x32_bf16 v[232:235], a[244:247], a[216:219], v[232:235]
v_mfma_f32_16x16x32_bf16 v[236:239], a[244:247], a[220:223], v[236:239]
s_waitcnt lgkmcnt(1)
v_mul_f32 v192, v192, v24
v_mul_f32 v196, v196, v25
v_mfma_f32_16x16x32_bf16 v[240:243], a[248:251], a[112:115], v[240:243]
s_add_u32 s28, s28, 93184
ds_read_b128 a[240:243], v15 offset:57344
v_mul_f32 v200, v200, v26
v_mfma_f32_16x16x32_bf16 v[244:247], a[248:251], a[116:119], v[244:247]
s_addc_u32 s29, s29, 0
v_mul_f32 v204, v204, v27
v_cvt_pk_bf16_f32 v120, v192, v196
v_mfma_f32_16x16x32_bf16 v[248:251], a[248:251], a[120:123], v[248:251]
v_cvt_pk_bf16_f32 v121, v200, v204
v_mfma_f32_16x16x32_bf16 v[252:255], a[248:251], a[124:127], v[252:255]
s_waitcnt lgkmcnt(1)
v_mfma_f32_16x16x32_bf16 v[208:211], a[252:255], a[16:19], v[208:211]
ds_read_b128 a[244:247], v14 offset:61440
v_mfma_f32_16x16x32_bf16 v[212:215], a[252:255], a[20:23], v[212:215]
buffer_store_dwordx2 v[120:121], v18, s[28:31], 0 offen nt
v_mul_f32 v193, v193, v24
v_mfma_f32_16x16x32_bf16 v[216:219], a[252:255], a[24:27], v[216:219]
s_add_u32 s28, s28, 7168
v_mul_f32 v197, v197, v25
v_mul_f32 v201, v201, v26
v_mfma_f32_16x16x32_bf16 v[220:223], a[252:255], a[28:31], v[220:223]
s_waitcnt lgkmcnt(1)
v_mul_f32 v205, v205, v27
v_cvt_pk_bf16_f32 v122, v193, v197
v_mfma_f32_16x16x32_bf16 v[224:227], a[240:243], a[224:227], v[224:227]
s_addc_u32 s29, s29, 0
ds_read_b128 a[248:251], v15 offset:18432
v_cvt_pk_bf16_f32 v123, v201, v205
v_mfma_f32_16x16x32_bf16 v[228:231], a[240:243], a[228:231], v[228:231]
buffer_store_dwordx2 v[122:123], v18, s[28:31], 0 offen nt
v_mul_f32 v194, v194, v24
v_mfma_f32_16x16x32_bf16 v[232:235], a[240:243], a[232:235], v[232:235]
s_add_u32 s28, s28, 7168
v_mul_f32 v198, v198, v25
v_mul_f32 v202, v202, v26
v_mfma_f32_16x16x32_bf16 v[236:239], a[240:243], a[236:239], v[236:239]
s_waitcnt lgkmcnt(1)
v_mul_f32 v206, v206, v27
v_cvt_pk_bf16_f32 v124, v194, v198
v_mfma_f32_16x16x32_bf16 v[224:227], a[244:247], a[0:3], v[224:227]
s_addc_u32 s29, s29, 0
ds_read_b128 a[252:255], v15 offset:61440
v_cvt_pk_bf16_f32 v125, v202, v206
v_mfma_f32_16x16x32_bf16 v[228:231], a[244:247], a[4:7], v[228:231]
buffer_store_dwordx2 v[124:125], v18, s[28:31], 0 offen nt
v_mul_f32 v195, v195, v24
v_mfma_f32_16x16x32_bf16 v[232:235], a[244:247], a[8:11], v[232:235]
s_add_u32 s28, s28, 7168
v_mul_f32 v199, v199, v25
v_mul_f32 v203, v203, v26
v_mfma_f32_16x16x32_bf16 v[236:239], a[244:247], a[12:15], v[236:239]
s_waitcnt lgkmcnt(1)
v_mul_f32 v207, v207, v27
v_cvt_pk_bf16_f32 v126, v195, v199
v_mfma_f32_16x16x32_bf16 v[240:243], a[248:251], a[128:131], v[240:243]
s_addc_u32 s29, s29, 0
ds_read_b128 a[240:243], v14 offset:38912
v_cvt_pk_bf16_f32 v127, v203, v207
v_mfma_f32_16x16x32_bf16 v[244:247], a[248:251], a[132:135], v[244:247]
buffer_store_dwordx2 v[126:127], v18, s[28:31], 0 offen nt
v_mul_f32 v208, v208, v24
v_mfma_f32_16x16x32_bf16 v[248:251], a[248:251], a[136:139], v[248:251]
s_add_u32 s28, s28, 93184
v_mul_f32 v212, v212, v25
v_mul_f32 v216, v216, v26
v_mfma_f32_16x16x32_bf16 v[252:255], a[248:251], a[140:143], v[252:255]
s_waitcnt lgkmcnt(1)
v_mul_f32 v220, v220, v27
v_cvt_pk_bf16_f32 v120, v208, v212
v_mfma_f32_16x16x32_bf16 v[224:227], a[252:255], a[16:19], v[224:227]
s_addc_u32 s29, s29, 0
ds_read_b128 a[244:247], v15 offset:38912
v_cvt_pk_bf16_f32 v121, v216, v220
v_mfma_f32_16x16x32_bf16 v[228:231], a[252:255], a[20:23], v[228:231]
buffer_store_dwordx2 v[120:121], v18, s[28:31], 0 offen nt
v_mul_f32 v209, v209, v24
v_mfma_f32_16x16x32_bf16 v[232:235], a[252:255], a[24:27], v[232:235]
s_add_u32 s28, s28, 7168
v_mul_f32 v213, v213, v25
v_mul_f32 v217, v217, v26
v_mfma_f32_16x16x32_bf16 v[236:239], a[252:255], a[28:31], v[236:239]
s_waitcnt lgkmcnt(1)
v_mul_f32 v221, v221, v27
v_cvt_pk_bf16_f32 v122, v209, v213
v_mfma_f32_16x16x32_bf16 v[240:243], a[240:243], a[144:147], v[240:243]
s_addc_u32 s29, s29, 0
ds_read_b128 a[248:251], v14 offset:51200
v_cvt_pk_bf16_f32 v123, v217, v221
v_mfma_f32_16x16x32_bf16 v[244:247], a[240:243], a[148:151], v[244:247]
buffer_store_dwordx2 v[122:123], v18, s[28:31], 0 offen nt
v_mul_f32 v210, v210, v24
v_mfma_f32_16x16x32_bf16 v[248:251], a[240:243], a[152:155], v[248:251]
s_add_u32 s28, s28, 7168
v_mul_f32 v214, v214, v25
v_mul_f32 v218, v218, v26
v_mfma_f32_16x16x32_bf16 v[252:255], a[240:243], a[156:159], v[252:255]
s_waitcnt lgkmcnt(1)
v_mul_f32 v222, v222, v27
v_cvt_pk_bf16_f32 v124, v210, v214
v_mfma_f32_16x16x32_bf16 v[240:243], a[244:247], a[160:163], v[240:243]
s_addc_u32 s29, s29, 0
ds_read_b128 a[252:255], v15 offset:51200
v_cvt_pk_bf16_f32 v125, v218, v222
v_mfma_f32_16x16x32_bf16 v[244:247], a[244:247], a[164:167], v[244:247]
buffer_store_dwordx2 v[124:125], v18, s[28:31], 0 offen nt
v_mul_f32 v211, v211, v24
v_mfma_f32_16x16x32_bf16 v[248:251], a[244:247], a[168:171], v[248:251]
s_add_u32 s28, s28, 7168
v_mul_f32 v215, v215, v25
v_mul_f32 v219, v219, v26
v_mfma_f32_16x16x32_bf16 v[252:255], a[244:247], a[172:175], v[252:255]
s_waitcnt lgkmcnt(1)
v_mul_f32 v223, v223, v27
v_cvt_pk_bf16_f32 v126, v211, v215
v_mfma_f32_16x16x32_bf16 v[240:243], a[248:251], a[176:179], v[240:243]
s_addc_u32 s29, s29, 0
ds_read_b128 a[240:243], v14 offset:59392
v_cvt_pk_bf16_f32 v127, v219, v223
v_mfma_f32_16x16x32_bf16 v[244:247], a[248:251], a[180:183], v[244:247]
buffer_store_dwordx2 v[126:127], v18, s[28:31], 0 offen nt
v_mul_f32 v224, v224, v24
v_mfma_f32_16x16x32_bf16 v[248:251], a[248:251], a[184:187], v[248:251]
s_add_u32 s28, s28, 93184
v_mul_f32 v228, v228, v25
v_mul_f32 v232, v232, v26
v_mfma_f32_16x16x32_bf16 v[252:255], a[248:251], a[188:191], v[252:255]
s_waitcnt lgkmcnt(1)
v_mul_f32 v236, v236, v27
v_cvt_pk_bf16_f32 v120, v224, v228
v_mfma_f32_16x16x32_bf16 v[240:243], a[252:255], a[192:195], v[240:243]
s_addc_u32 s29, s29, 0
ds_read_b128 a[244:247], v15 offset:59392
v_cvt_pk_bf16_f32 v121, v232, v236
v_mfma_f32_16x16x32_bf16 v[244:247], a[252:255], a[196:199], v[244:247]
buffer_store_dwordx2 v[120:121], v18, s[28:31], 0 offen nt
v_mul_f32 v225, v225, v24
v_mfma_f32_16x16x32_bf16 v[248:251], a[252:255], a[200:203], v[248:251]
s_add_u32 s28, s28, 7168
v_mul_f32 v229, v229, v25
v_mul_f32 v233, v233, v26
v_mfma_f32_16x16x32_bf16 v[252:255], a[252:255], a[204:207], v[252:255]
s_waitcnt lgkmcnt(1)
v_mul_f32 v237, v237, v27
v_cvt_pk_bf16_f32 v122, v225, v229
v_mfma_f32_16x16x32_bf16 v[240:243], a[240:243], a[208:211], v[240:243]
s_addc_u32 s29, s29, 0
ds_read_b128 a[248:251], v14 offset:63488
v_cvt_pk_bf16_f32 v123, v233, v237
v_mfma_f32_16x16x32_bf16 v[244:247], a[240:243], a[212:215], v[244:247]
buffer_store_dwordx2 v[122:123], v18, s[28:31], 0 offen nt
v_mul_f32 v226, v226, v24
v_mfma_f32_16x16x32_bf16 v[248:251], a[240:243], a[216:219], v[248:251]
s_add_u32 s28, s28, 7168
v_mul_f32 v230, v230, v25
v_mul_f32 v234, v234, v26
v_mfma_f32_16x16x32_bf16 v[252:255], a[240:243], a[220:223], v[252:255]
s_waitcnt lgkmcnt(1)
v_mul_f32 v238, v238, v27
v_cvt_pk_bf16_f32 v124, v226, v230
v_mfma_f32_16x16x32_bf16 v[240:243], a[244:247], a[224:227], v[240:243]
s_addc_u32 s29, s29, 0
ds_read_b128 a[252:255], v15 offset:63488
v_cvt_pk_bf16_f32 v125, v234, v238
v_mfma_f32_16x16x32_bf16 v[244:247], a[244:247], a[228:231], v[244:247]
buffer_store_dwordx2 v[124:125], v18, s[28:31], 0 offen nt
v_mul_f32 v227, v227, v24
v_mfma_f32_16x16x32_bf16 v[248:251], a[244:247], a[232:235], v[248:251]
s_add_u32 s28, s28, 7168
v_mul_f32 v231, v231, v25
v_mul_f32 v235, v235, v26
v_mfma_f32_16x16x32_bf16 v[252:255], a[244:247], a[236:239], v[252:255]
s_waitcnt lgkmcnt(1)
v_mul_f32 v239, v239, v27
v_cvt_pk_bf16_f32 v126, v227, v231
v_mfma_f32_16x16x32_bf16 v[240:243], a[248:251], a[0:3], v[240:243]
s_addc_u32 s29, s29, 0
v_cvt_pk_bf16_f32 v127, v235, v239
v_mfma_f32_16x16x32_bf16 v[244:247], a[248:251], a[4:7], v[244:247]
buffer_store_dwordx2 v[126:127], v18, s[28:31], 0 offen nt
v_mfma_f32_16x16x32_bf16 v[248:251], a[248:251], a[8:11], v[248:251]
v_mfma_f32_16x16x32_bf16 v[252:255], a[248:251], a[12:15], v[252:255]
s_waitcnt lgkmcnt(0)
v_mfma_f32_16x16x32_bf16 v[240:243], a[252:255], a[16:19], v[240:243]
v_mfma_f32_16x16x32_bf16 v[244:247], a[252:255], a[20:23], v[244:247]
v_mfma_f32_16x16x32_bf16 v[248:251], a[252:255], a[24:27], v[248:251]
v_mfma_f32_16x16x32_bf16 v[252:255], a[252:255], a[28:31], v[252:255]
s_nop 7
v_pk_mul_f32 v[240:241], v[240:241], v[24:25] op_sel:[0,0] op_sel_hi:[1,0]
v_pk_mul_f32 v[244:245], v[244:245], v[24:25] op_sel:[0,1] op_sel_hi:[1,1]
v_pk_mul_f32 v[248:249], v[248:249], v[26:27] op_sel:[0,0] op_sel_hi:[1,0]
v_pk_mul_f32 v[252:253], v[252:253], v[26:27] op_sel:[0,1] op_sel_hi:[1,1]
v_cvt_pk_bf16_f32 v120, v240, v244
v_cvt_pk_bf16_f32 v121, v248, v252
s_add_u32 s28, s28, 93184
s_addc_u32 s29, s29, 0
buffer_store_dwordx2 v[120:121], v18, s[28:31], 0 offen nt
v_cvt_pk_bf16_f32 v122, v241, v245
v_cvt_pk_bf16_f32 v123, v249, v253
s_add_u32 s28, s28, 7168
s_addc_u32 s29, s29, 0
buffer_store_dwordx2 v[122:123], v18, s[28:31], 0 offen nt
v_pk_mul_f32 v[242:243], v[242:243], v[24:25] op_sel:[0,0] op_sel_hi:[1,0]
v_pk_mul_f32 v[246:247], v[246:247], v[24:25] op_sel:[0,1] op_sel_hi:[1,1]
v_pk_mul_f32 v[250:251], v[250:251], v[26:27] op_sel:[0,0] op_sel_hi:[1,0]
v_pk_mul_f32 v[254:255], v[254:255], v[26:27] op_sel:[0,1] op_sel_hi:[1,1]
v_cvt_pk_bf16_f32 v124, v242, v246
v_cvt_pk_bf16_f32 v125, v250, v254
s_add_u32 s28, s28, 7168
s_addc_u32 s29, s29, 0
buffer_store_dwordx2 v[124:125], v18, s[28:31], 0 offen nt
v_cvt_pk_bf16_f32 v126, v243, v247
v_cvt_pk_bf16_f32 v127, v251, v255
s_add_u32 s28, s28, 7168
s_addc_u32 s29, s29, 0
buffer_store_dwordx2 v[126:127], v18, s[28:31], 0 offen nt
s_endpgm
L_NOTAG:
buffer_load_dwordx2 v[22:23], off, s[80:83], 0 sc1
s_waitcnt vmcnt(0)
v_readfirstlane_b32 s88, v22
v_readfirstlane_b32 s89, v23
s_sub_u32 s90, s90, 1
s_nop 0
s_cmp_eq_u64 s[88:89], 0
s_cbranch_scc0 L_TAGOK
s_cmp_gt_i32 s90, 0
s_cbranch_scc1 L_NOTAG
s_mov_b32 s26, 0
s_mov_b32 s78, 0
s_mov_b64 s[88:89], 1
s_branch L_TAGOK
.p2align 6
L_PADS:
s_cbranch_vccnz L_PADRET
L_TRY:
s_waitcnt vmcnt(0)
v_cmp_ne_u64 s[50:51], s[88:89], v[122:123]
v_cmp_ne_u64 s[44:45], s[88:89], v[126:127]
s_sub_u32 s90, s90, 1
s_nop 0
s_or_b64 s[50:51], s[44:45], s[50:51]
s_cbranch_scc0 L_WRET
s_cmp_gt_i32 s90, 0
s_cbranch_scc0 L_SELF
L_WRET:
s_setpc_b64 s[100:101]
L_SLOW2:
s_lshr_b32 s91, s41, 6
s_add_u32 s91, s91, 0
s_lshl_b32 s47, s91, 11
buffer_load_dwordx4 v[120:123], v13, s[24:27], s47 offen offset:0 sc1
buffer_load_dwordx4 v[124:127], v13, s[24:27], s47 offen offset:1024 sc1
s_lshr_b32 s47, s41, 6
s_add_u32 s47, s47, 1
s_lshl_b32 s47, s47, 11
buffer_load_dwordx4 v[40:43], v13, s[24:27], s47 offen offset:0 sc1
buffer_load_dwordx4 v[44:47], v13, s[24:27], s47 offen offset:1024 sc1
s_lshr_b32 s47, s42, 6
s_add_u32 s47, s47, 0
s_lshl_b32 s47, s47, 11
buffer_load_dwordx4 v[48:51], v13, s[24:27], s47 offen offset:0 sc1
buffer_load_dwordx4 v[52:55], v13, s[24:27], s47 offen offset:1024 sc1
s_call_b64 s[100:101], L_TRY
s_cbranch_scc1 L_SLOW2
v_mov_b64 v[32:33], v[120:121]
v_mov_b64 v[36:37], v[124:125]
s_branch L_BACK2
L_SLOW3:
s_lshr_b32 s91, s41, 6
s_add_u32 s91, s91, 1
s_lshl_b32 s47, s91, 11
buffer_load_dwordx4 v[120:123], v13, s[24:27], s47 offen offset:0 sc1
buffer_load_dwordx4 v[124:127], v13, s[24:27], s47 offen offset:1024 sc1
s_lshr_b32 s47, s42, 6
s_add_u32 s47, s47, 0
s_lshl_b32 s47, s47, 11
buffer_load_dwordx4 v[48:51], v13, s[24:27], s47 offen offset:0 sc1
buffer_load_dwordx4 v[52:55], v13, s[24:27], s47 offen offset:1024 sc1
s_call_b64 s[100:101], L_TRY
s_cbranch_scc1 L_SLOW3
v_mov_b64 v[40:41], v[120:121]
v_mov_b64 v[44:45], v[124:125]
s_branch L_BACK3
L_SLOW4:
s_lshr_b32 s91, s42, 6
s_add_u32 s91, s91, 0
s_lshl_b32 s47, s91, 11
buffer_load_dwordx4 v[120:123], v13, s[24:27], s47 offen offset:0 sc1
buffer_load_dwordx4 v[124:127], v13, s[24:27], s47 offen offset:1024 sc1
s_lshr_b32 s47, s42, 6
s_add_u32 s47, s47, 1
s_lshl_b32 s47, s47, 11
buffer_load_dwordx4 v[96:99], v13, s[24:27], s47 offen offset:0 sc1
buffer_load_dwordx4 v[100:103], v13, s[24:27], s47 offen offset:1024 sc1
s_lshr_b32 s47, s43, 6
s_add_u32 s47, s47, 0
s_lshl_b32 s47, s47, 11
buffer_load_dwordx4 v[80:83], v13, s[24:27], s47 offen offset:0 sc1
buffer_load_dwordx4 v[84:87], v13, s[24:27], s47 offen offset:1024 sc1
s_call_b64 s[100:101], L_TRY
s_cbranch_scc1 L_SLOW4
v_mov_b64 v[48:49], v[120:121]
v_mov_b64 v[52:53], v[124:125]
s_branch L_BACK4
L_SLOW5:
s_lshr_b32 s91, s42, 6
s_add_u32 s91, s91, 1
s_lshl_b32 s47, s91, 11
buffer_load_dwordx4 v[120:123], v13, s[24:27], s47 offen offset:0 sc1
buffer_load_dwordx4 v[124:127], v13, s[24:27], s47 offen offset:1024 sc1
s_lshr_b32 s47, s43, 6
s_add_u32 s47, s47, 0
s_lshl_b32 s47, s47, 11
buffer_load_dwordx4 v[80:83], v13, s[24:27], s47 offen offset:0 sc1
buffer_load_dwordx4 v[84:87], v13, s[24:27], s47 offen offset:1024 sc1
s_lshr_b32 s47, s43, 6
s_add_u32 s47, s47, 1
s_lshl_b32 s47, s47, 11
buffer_load_dwordx4 v[88:91], v13, s[24:27], s47 offen offset:0 sc1
buffer_load_dwordx4 v[92:95], v13, s[24:27], s47 offen offset:1024 sc1
s_call_b64 s[100:101], L_TRY
s_cbranch_scc1 L_SLOW5
v_mov_b64 v[96:97], v[120:121]
v_mov_b64 v[100:101], v[124:125]
s_branch L_BACK5
L_SLOW6:
s_lshr_b32 s91, s43, 6
s_add_u32 s91, s91, 0
s_lshl_b32 s47, s91, 11
buffer_load_dwordx4 v[120:123], v13, s[24:27], s47 offen offset:0 sc1
buffer_load_dwordx4 v[124:127], v13, s[24:27], s47 offen offset:1024 sc1
s_lshr_b32 s47, s43, 6
s_add_u32 s47, s47, 1
s_lshl_b32 s47, s47, 11
buffer_load_dwordx4 v[88:91], v13, s[24:27], s47 offen offset:0 sc1
buffer_load_dwordx4 v[92:95], v13, s[24:27], s47 offen offset:1024 sc1
s_movk_i32 s47, 8
s_lshl_b32 s47, s47, 11
buffer_load_dwordx4 v[32:35], v13, s[24:27], s47 offen offset:0 sc1
buffer_load_dwordx4 v[36:39], v13, s[24:27], s47 offen offset:1024 sc1
s_call_b64 s[100:101], L_TRY
s_cbranch_scc1 L_SLOW6
v_mov_b64 v[80:81], v[120:121]
v_mov_b64 v[84:85], v[124:125]
s_branch L_BACK6
L_SLOW7:
s_lshr_b32 s91, s43, 6
s_add_u32 s91, s91, 1
s_lshl_b32 s47, s91, 11
buffer_load_dwordx4 v[120:123], v13, s[24:27], s47 offen offset:0 sc1
buffer_load_dwordx4 v[124:127], v13, s[24:27], s47 offen offset:1024 sc1
s_movk_i32 s47, 8
s_lshl_b32 s47, s47, 11
buffer_load_dwordx4 v[32:35], v13, s[24:27], s47 offen offset:0 sc1
buffer_load_dwordx4 v[36:39], v13, s[24:27], s47 offen offset:1024 sc1
s_movk_i32 s47, 9
s_lshl_b32 s47, s47, 11
buffer_load_dwordx4 v[40:43], v13, s[24:27], s47 offen offset:0 sc1
buffer_load_dwordx4 v[44:47], v13, s[24:27], s47 offen offset:1024 sc1
s_call_b64 s[100:101], L_TRY
s_cbranch_scc1 L_SLOW7
v_mov_b64 v[88:89], v[120:121]
v_mov_b64 v[92:93], v[124:125]
s_branch L_BACK7
L_SLOW8:
s_movk_i32 s91, 8
s_lshl_b32 s47, s91, 11
buffer_load_dwordx4 v[120:123], v13, s[24:27], s47 offen offset:0 sc1
buffer_load_dwordx4 v[124:127], v13, s[24:27], s47 offen offset:1024 sc1
s_movk_i32 s47, 9
s_lshl_b32 s47, s47, 11
buffer_load_dwordx4 v[40:43], v13, s[24:27], s47 offen offset:0 sc1
buffer_load_dwordx4 v[44:47], v13, s[24:27], s47 offen offset:1024 sc1
s_movk_i32 s47, 10
s_lshl_b32 s47, s47, 11
buffer_load_dwordx4 v[48:51], v13, s[24:27], s47 offen offset:0 sc1
buffer_load_dwordx4 v[52:55], v13, s[24:27], s47 offen offset:1024 sc1
s_call_b64 s[100:101], L_TRY
s_cbranch_scc1 L_SLOW8
v_mov_b64 v[32:33], v[120:121]
v_mov_b64 v[36:37], v[124:125]
s_branch L_BACK8
L_SLOW9:
s_movk_i32 s91, 9
s_lshl_b32 s47, s91, 11
buffer_load_dwordx4 v[120:123], v13, s[24:27], s47 offen offset:0 sc1
buffer_load_dwordx4 v[124:127], v13, s[24:27], s47 offen offset:1024 sc1
s_movk_i32 s47, 10
s_lshl_b32 s47, s47, 11
buffer_load_dwordx4 v[48:51], v13, s[24:27], s47 offen offset:0 sc1
buffer_load_dwordx4 v[52:55], v13, s[24:27], s47 offen offset:1024 sc1
s_movk_i32 s47, 11
s_lshl_b32 s47, s47, 11
buffer_load_dwordx4 v[96:99], v13, s[24:27], s47 offen offset:0 sc1
buffer_load_dwordx4 v[100:103], v13, s[24:27], s47 offen offset:1024 sc1
s_call_b64 s[100:101], L_TRY
s_cbranch_scc1 L_SLOW9
v_mov_b64 v[40:41], v[120:121]
v_mov_b64 v[44:45], v[124:125]
s_branch L_BACK9
L_SLOW10:
s_movk_i32 s91, 10
s_lshl_b32 s47, s91, 11
buffer_load_dwordx4 v[120:123], v13, s[24:27], s47 offen offset:0 sc1
buffer_load_dwordx4 v[124:127], v13, s[24:27], s47 offen offset:1024 sc1
s_movk_i32 s47, 11
s_lshl_b32 s47, s47, 11
buffer_load_dwordx4 v[96:99], v13, s[24:27], s47 offen offset:0 sc1
buffer_load_dwordx4 v[100:103], v13, s[24:27], s47 offen offset:1024 sc1
s_movk_i32 s47, 12
s_lshl_b32 s47, s47, 11
buffer_load_dwordx4 v[80:83], v13, s[24:27], s47 offen offset:0 sc1
buffer_load_dwordx4 v[84:87], v13, s[24:27], s47 offen offset:1024 sc1
s_call_b64 s[100:101], L_TRY
s_cbranch_scc1 L_SLOW10
v_mov_b64 v[48:49], v[120:121]
v_mov_b64 v[52:53], v[124:125]
s_branch L_BACK10
L_SLOW11:
s_movk_i32 s91, 11
s_lshl_b32 s47, s91, 11
buffer_load_dwordx4 v[120:123], v13, s[24:27], s47 offen offset:0 sc1
buffer_load_dwordx4 v[124:127], v13, s[24:27], s47 offen offset:1024 sc1
s_movk_i32 s47, 12
s_lshl_b32 s47, s47, 11
buffer_load_dwordx4 v[80:83], v13, s[24:27], s47 offen offset:0 sc1
buffer_load_dwordx4 v[84:87], v13, s[24:27], s47 offen offset:1024 sc1
s_movk_i32 s47, 13
s_lshl_b32 s47, s47, 11
buffer_load_dwordx4 v[88:91], v13, s[24:27], s47 offen offset:0 sc1
buffer_load_dwordx4 v[92:95], v13, s[24:27], s47 offen offset:1024 sc1
s_call_b64 s[100:101], L_TRY
s_cbranch_scc1 L_SLOW11
v_mov_b64 v[96:97], v[120:121]
v_mov_b64 v[100:101], v[124:125]
s_branch L_BACK11
L_SLOW12:
s_movk_i32 s91, 12
s_lshl_b32 s47, s91, 11
buffer_load_dwordx4 v[120:123], v13, s[24:27], s47 offen offset:0 sc1
buffer_load_dwordx4 v[124:127], v13, s[24:27], s47 offen offset:1024 sc1
s_movk_i32 s47, 13
s_lshl_b32 s47, s47, 11
buffer_load_dwordx4 v[88:91], v13, s[24:27], s47 offen offset:0 sc1
buffer_load_dwordx4 v[92:95], v13, s[24:27], s47 offen offset:1024 sc1
s_movk_i32 s47, 14
s_lshl_b32 s47, s47, 11
buffer_load_dwordx4 v[32:35], v13, s[24:27], s47 offen offset:0 sc1
buffer_load_dwordx4 v[36:39], v13, s[24:27], s47 offen offset:1024 sc1
s_call_b64 s[100:101], L_TRY
s_cbranch_scc1 L_SLOW12
v_mov_b64 v[80:81], v[120:121]
v_mov_b64 v[84:85], v[124:125]
s_branch L_BACK12
L_SLOW13:
s_movk_i32 s91, 13
s_lshl_b32 s47, s91, 11
buffer_load_dwordx4 v[120:123], v13, s[24:27], s47 offen offset:0 sc1
buffer_load_dwordx4 v[124:127], v13, s[24:27], s47 offen offset:1024 sc1
s_movk_i32 s47, 14
s_lshl_b32 s47, s47, 11
buffer_load_dwordx4 v[32:35], v13, s[24:27], s47 offen offset:0 sc1
buffer_load_dwordx4 v[36:39], v13, s[24:27], s47 offen offset:1024 sc1
s_movk_i32 s47, 15
s_lshl_b32 s47, s47, 11
buffer_load_dwordx4 v[40:43], v13, s[24:27], s47 offen offset:0 sc1
buffer_load_dwordx4 v[44:47], v13, s[24:27], s47 offen offset:1024 sc1
s_call_b64 s[100:101], L_TRY
s_cbranch_scc1 L_SLOW13
v_mov_b64 v[88:89], v[120:121]
v_mov_b64 v[92:93], v[124:125]
s_branch L_BACK13
L_SLOW14:
s_movk_i32 s91, 14
s_lshl_b32 s47, s91, 11
buffer_load_dwordx4 v[120:123], v13, s[24:27], s47 offen offset:0 sc1
buffer_load_dwordx4 v[124:127], v13, s[24:27], s47 offen offset:1024 sc1
s_movk_i32 s47, 15
s_lshl_b32 s47, s47, 11
buffer_load_dwordx4 v[40:43], v13, s[24:27], s47 offen offset:0 sc1
buffer_load_dwordx4 v[44:47], v13, s[24:27], s47 offen offset:1024 sc1
s_movk_i32 s47, 16
s_lshl_b32 s47, s47, 11
buffer_load_dwordx4 v[48:51], v13, s[24:27], s47 offen offset:0 sc1
buffer_load_dwordx4 v[52:55], v13, s[24:27], s47 offen offset:1024 sc1
s_call_b64 s[100:101], L_TRY
s_cbranch_scc1 L_SLOW14
v_mov_b64 v[32:33], v[120:121]
v_mov_b64 v[36:37], v[124:125]
s_branch L_BACK14
L_SLOW15:
s_movk_i32 s91, 15
s_lshl_b32 s47, s91, 11
buffer_load_dwordx4 v[120:123], v13, s[24:27], s47 offen offset:0 sc1
buffer_load_dwordx4 v[124:127], v13, s[24:27], s47 offen offset:1024 sc1
s_movk_i32 s47, 16
s_lshl_b32 s47, s47, 11
buffer_load_dwordx4 v[48:51], v13, s[24:27], s47 offen offset:0 sc1
buffer_load_dwordx4 v[52:55], v13, s[24:27], s47 offen offset:1024 sc1
s_movk_i32 s47, 17
s_lshl_b32 s47, s47, 11
buffer_load_dwordx4 v[96:99], v13, s[24:27], s47 offen offset:0 sc1
buffer_load_dwordx4 v[100:103], v13, s[24:27], s47 offen offset:1024 sc1
s_call_b64 s[100:101], L_TRY
s_cbranch_scc1 L_SLOW15
v_mov_b64 v[40:41], v[120:121]
v_mov_b64 v[44:45], v[124:125]
s_branch L_BACK15
L_SLOW16:
s_movk_i32 s91, 16
s_lshl_b32 s47, s91, 11
buffer_load_dwordx4 v[120:123], v13, s[24:27], s47 offen offset:0 sc1
buffer_load_dwordx4 v[124:127], v13, s[24:27], s47 offen offset:1024 sc1
s_movk_i32 s47, 17
s_lshl_b32 s47, s47, 11
buffer_load_dwordx4 v[96:99], v13, s[24:27], s47 offen offset:0 sc1
buffer_load_dwordx4 v[100:103], v13, s[24:27], s47 offen offset:1024 sc1
s_movk_i32 s47, 18
s_lshl_b32 s47, s47, 11
buffer_load_dwordx4 v[80:83], v13, s[24:27], s47 offen offset:0 sc1
buffer_load_dwordx4 v[84:87], v13, s[24:27], s47 offen offset:1024 sc1
s_call_b64 s[100:101], L_TRY
s_cbranch_scc1 L_SLOW16
v_mov_b64 v[48:49], v[120:121]
v_mov_b64 v[52:53], v[124:125]
s_branch L_BACK16
L_SLOW17:
s_movk_i32 s91, 17
s_lshl_b32 s47, s91, 11
buffer_load_dwordx4 v[120:123], v13, s[24:27], s47 offen offset:0 sc1
buffer_load_dwordx4 v[124:127], v13, s[24:27], s47 offen offset:1024 sc1
s_movk_i32 s47, 18
s_lshl_b32 s47, s47, 11
buffer_load_dwordx4 v[80:83], v13, s[24:27], s47 offen offset:0 sc1
buffer_load_dwordx4 v[84:87], v13, s[24:27], s47 offen offset:1024 sc1
s_movk_i32 s47, 19
s_lshl_b32 s47, s47, 11
buffer_load_dwordx4 v[88:91], v13, s[24:27], s47 offen offset:0 sc1
buffer_load_dwordx4 v[92:95], v13, s[24:27], s47 offen offset:1024 sc1
s_call_b64 s[100:101], L_TRY
s_cbranch_scc1 L_SLOW17
v_mov_b64 v[96:97], v[120:121]
v_mov_b64 v[100:101], v[124:125]
s_branch L_BACK17
L_SLOW18:
s_movk_i32 s91, 18
s_lshl_b32 s47, s91, 11
buffer_load_dwordx4 v[120:123], v13, s[24:27], s47 offen offset:0 sc1
buffer_load_dwordx4 v[124:127], v13, s[24:27], s47 offen offset:1024 sc1
s_movk_i32 s47, 19
s_lshl_b32 s47, s47, 11
buffer_load_dwordx4 v[88:91], v13, s[24:27], s47 offen offset:0 sc1
buffer_load_dwordx4 v[92:95], v13, s[24:27], s47 offen offset:1024 sc1
s_movk_i32 s47, 20
s_lshl_b32 s47, s47, 11
buffer_load_dwordx4 v[32:35], v13, s[24:27], s47 offen offset:0 sc1
buffer_load_dwordx4 v[36:39], v13, s[24:27], s47 offen offset:1024 sc1
s_call_b64 s[100:101], L_TRY
s_cbranch_scc1 L_SLOW18
v_mov_b64 v[80:81], v[120:121]
v_mov_b64 v[84:85], v[124:125]
s_branch L_BACK18
L_SLOW19:
s_movk_i32 s91, 19
s_lshl_b32 s47, s91, 11
buffer_load_dwordx4 v[120:123], v13, s[24:27], s47 offen offset:0 sc1
buffer_load_dwordx4 v[124:127], v13, s[24:27], s47 offen offset:1024 sc1
s_movk_i32 s47, 20
s_lshl_b32 s47, s47, 11
buffer_load_dwordx4 v[32:35], v13, s[24:27], s47 offen offset:0 sc1
buffer_load_dwordx4 v[36:39], v13, s[24:27], s47 offen offset:1024 sc1
s_movk_i32 s47, 21
s_lshl_b32 s47, s47, 11
buffer_load_dwordx4 v[40:43], v13, s[24:27], s47 offen offset:0 sc1
buffer_load_dwordx4 v[44:47], v13, s[24:27], s47 offen offset:1024 sc1
s_call_b64 s[100:101], L_TRY
s_cbranch_scc1 L_SLOW19
v_mov_b64 v[88:89], v[120:121]
v_mov_b64 v[92:93], v[124:125]
s_branch L_BACK19
L_SLOW20:
s_movk_i32 s91, 20
s_lshl_b32 s47, s91, 11
buffer_load_dwordx4 v[120:123], v13, s[24:27], s47 offen offset:0 sc1
buffer_load_dwordx4 v[124:127], v13, s[24:27], s47 offen offset:1024 sc1
s_movk_i32 s47, 21
s_lshl_b32 s47, s47, 11
buffer_load_dwordx4 v[40:43], v13, s[24:27], s47 offen offset:0 sc1
buffer_load_dwordx4 v[44:47], v13, s[24:27], s47 offen offset:1024 sc1
s_movk_i32 s47, 22
s_lshl_b32 s47, s47, 11
buffer_load_dwordx4 v[48:51], v13, s[24:27], s47 offen offset:0 sc1
buffer_load_dwordx4 v[52:55], v13, s[24:27], s47 offen offset:1024 sc1
s_call_b64 s[100:101], L_TRY
s_cbranch_scc1 L_SLOW20
v_mov_b64 v[32:33], v[120:121]
v_mov_b64 v[36:37], v[124:125]
s_branch L_BACK20
L_SLOW21:
s_movk_i32 s91, 21
s_lshl_b32 s47, s91, 11
buffer_load_dwordx4 v[120:123], v13, s[24:27], s47 offen offset:0 sc1
buffer_load_dwordx4 v[124:127], v13, s[24:27], s47 offen offset:1024 sc1
s_movk_i32 s47, 22
s_lshl_b32 s47, s47, 11
buffer_load_dwordx4 v[48:51], v13, s[24:27], s47 offen offset:0 sc1
buffer_load_dwordx4 v[52:55], v13, s[24:27], s47 offen offset:1024 sc1
s_movk_i32 s47, 23
s_lshl_b32 s47, s47, 11
buffer_load_dwordx4 v[96:99], v13, s[24:27], s47 offen offset:0 sc1
buffer_load_dwordx4 v[100:103], v13, s[24:27], s47 offen offset:1024 sc1
s_call_b64 s[100:101], L_TRY
s_cbranch_scc1 L_SLOW21
v_mov_b64 v[40:41], v[120:121]
v_mov_b64 v[44:45], v[124:125]
s_branch L_BACK21
L_SLOW22:
s_movk_i32 s91, 22
s_lshl_b32 s47, s91, 11
buffer_load_dwordx4 v[120:123], v13, s[24:27], s47 offen offset:0 sc1
buffer_load_dwordx4 v[124:127], v13, s[24:27], s47 offen offset:1024 sc1
s_movk_i32 s47, 23
s_lshl_b32 s47, s47, 11
buffer_load_dwordx4 v[96:99], v13, s[24:27], s47 offen offset:0 sc1
buffer_load_dwordx4 v[100:103], v13, s[24:27], s47 offen offset:1024 sc1
s_movk_i32 s47, 24
s_lshl_b32 s47, s47, 11
buffer_load_dwordx4 v[80:83], v13, s[24:27], s47 offen offset:0 sc1
buffer_load_dwordx4 v[84:87], v13, s[24:27], s47 offen offset:1024 sc1
s_call_b64 s[100:101], L_TRY
s_cbranch_scc1 L_SLOW22
v_mov_b64 v[48:49], v[120:121]
v_mov_b64 v[52:53], v[124:125]
s_branch L_BACK22
L_SLOW23:
s_movk_i32 s91, 23
s_lshl_b32 s47, s91, 11
buffer_load_dwordx4 v[120:123], v13, s[24:27], s47 offen offset:0 sc1
buffer_load_dwordx4 v[124:127], v13, s[24:27], s47 offen offset:1024 sc1
s_movk_i32 s47, 24
s_lshl_b32 s47, s47, 11
buffer_load_dwordx4 v[80:83], v13, s[24:27], s47 offen offset:0 sc1
buffer_load_dwordx4 v[84:87], v13, s[24:27], s47 offen offset:1024 sc1
s_movk_i32 s47, 25
s_lshl_b32 s47, s47, 11
buffer_load_dwordx4 v[88:91], v13, s[24:27], s47 offen offset:0 sc1
buffer_load_dwordx4 v[92:95], v13, s[24:27], s47 offen offset:1024 sc1
s_call_b64 s[100:101], L_TRY
s_cbranch_scc1 L_SLOW23
v_mov_b64 v[96:97], v[120:121]
v_mov_b64 v[100:101], v[124:125]
s_branch L_BACK23
L_SLOW24:
s_movk_i32 s91, 24
s_lshl_b32 s47, s91, 11
buffer_load_dwordx4 v[120:123], v13, s[24:27], s47 offen offset:0 sc1
buffer_load_dwordx4 v[124:127], v13, s[24:27], s47 offen offset:1024 sc1
s_movk_i32 s47, 25
s_lshl_b32 s47, s47, 11
buffer_load_dwordx4 v[88:91], v13, s[24:27], s47 offen offset:0 sc1
buffer_load_dwordx4 v[92:95], v13, s[24:27], s47 offen offset:1024 sc1
s_movk_i32 s47, 26
s_lshl_b32 s47, s47, 11
buffer_load_dwordx4 v[32:35], v13, s[24:27], s47 offen offset:0 sc1
buffer_load_dwordx4 v[36:39], v13, s[24:27], s47 offen offset:1024 sc1
s_call_b64 s[100:101], L_TRY
s_cbranch_scc1 L_SLOW24
v_mov_b64 v[80:81], v[120:121]
v_mov_b64 v[84:85], v[124:125]
s_branch L_BACK24
L_SLOW25:
s_movk_i32 s91, 25
s_lshl_b32 s47, s91, 11
buffer_load_dwordx4 v[120:123], v13, s[24:27], s47 offen offset:0 sc1
buffer_load_dwordx4 v[124:127], v13, s[24:27], s47 offen offset:1024 sc1
s_movk_i32 s47, 26
s_lshl_b32 s47, s47, 11
buffer_load_dwordx4 v[32:35], v13, s[24:27], s47 offen offset:0 sc1
buffer_load_dwordx4 v[36:39], v13, s[24:27], s47 offen offset:1024 sc1
s_movk_i32 s47, 27
s_lshl_b32 s47, s47, 11
buffer_load_dwordx4 v[40:43], v13, s[24:27], s47 offen offset:0 sc1
buffer_load_dwordx4 v[44:47], v13, s[24:27], s47 offen offset:1024 sc1
s_call_b64 s[100:101], L_TRY
s_cbranch_scc1 L_SLOW25
v_mov_b64 v[88:89], v[120:121]
v_mov_b64 v[92:93], v[124:125]
s_branch L_BACK25
L_SLOW26:
s_movk_i32 s91, 26
s_lshl_b32 s47, s91, 11
buffer_load_dwordx4 v[120:123], v13, s[24:27], s47 offen offset:0 sc1
buffer_load_dwordx4 v[124:127], v13, s[24:27], s47 offen offset:1024 sc1
s_movk_i32 s47, 27
s_lshl_b32 s47, s47, 11
buffer_load_dwordx4 v[40:43], v13, s[24:27], s47 offen offset:0 sc1
buffer_load_dwordx4 v[44:47], v13, s[24:27], s47 offen offset:1024 sc1
s_movk_i32 s47, 28
s_lshl_b32 s47, s47, 11
buffer_load_dwordx4 v[48:51], v13, s[24:27], s47 offen offset:0 sc1
buffer_load_dwordx4 v[52:55], v13, s[24:27], s47 offen offset:1024 sc1
s_call_b64 s[100:101], L_TRY
s_cbranch_scc1 L_SLOW26
v_mov_b64 v[32:33], v[120:121]
v_mov_b64 v[36:37], v[124:125]
s_branch L_BACK26
L_SLOW27:
s_movk_i32 s91, 27
s_lshl_b32 s47, s91, 11
buffer_load_dwordx4 v[120:123], v13, s[24:27], s47 offen offset:0 sc1
buffer_load_dwordx4 v[124:127], v13, s[24:27], s47 offen offset:1024 sc1
s_movk_i32 s47, 28
s_lshl_b32 s47, s47, 11
buffer_load_dwordx4 v[48:51], v13, s[24:27], s47 offen offset:0 sc1
buffer_load_dwordx4 v[52:55], v13, s[24:27], s47 offen offset:1024 sc1
s_movk_i32 s47, 29
s_lshl_b32 s47, s47, 11
buffer_load_dwordx4 v[96:99], v13, s[24:27], s47 offen offset:0 sc1
buffer_load_dwordx4 v[100:103], v13, s[24:27], s47 offen offset:1024 sc1
s_call_b64 s[100:101], L_TRY
s_cbranch_scc1 L_SLOW27
v_mov_b64 v[40:41], v[120:121]
v_mov_b64 v[44:45], v[124:125]
s_branch L_BACK27
L_SLOW28:
s_movk_i32 s91, 28
s_lshl_b32 s47, s91, 11
buffer_load_dwordx4 v[120:123], v13, s[24:27], s47 offen offset:0 sc1
buffer_load_dwordx4 v[124:127], v13, s[24:27], s47 offen offset:1024 sc1
s_movk_i32 s47, 29
s_lshl_b32 s47, s47, 11
buffer_load_dwordx4 v[96:99], v13, s[24:27], s47 offen offset:0 sc1
buffer_load_dwordx4 v[100:103], v13, s[24:27], s47 offen offset:1024 sc1
s_movk_i32 s47, 30
s_lshl_b32 s47, s47, 11
buffer_load_dwordx4 v[80:83], v13, s[24:27], s47 offen offset:0 sc1
buffer_load_dwordx4 v[84:87], v13, s[24:27], s47 offen offset:1024 sc1
s_call_b64 s[100:101], L_TRY
s_cbranch_scc1 L_SLOW28
v_mov_b64 v[48:49], v[120:121]
v_mov_b64 v[52:53], v[124:125]
s_branch L_BACK28
L_SLOW29:
s_movk_i32 s91, 29
s_lshl_b32 s47, s91, 11
buffer_load_dwordx4 v[120:123], v13, s[24:27], s47 offen offset:0 sc1
buffer_load_dwordx4 v[124:127], v13, s[24:27], s47 offen offset:1024 sc1
s_movk_i32 s47, 30
s_lshl_b32 s47, s47, 11
buffer_load_dwordx4 v[80:83], v13, s[24:27], s47 offen offset:0 sc1
buffer_load_dwordx4 v[84:87], v13, s[24:27], s47 offen offset:1024 sc1
s_movk_i32 s47, 31
s_lshl_b32 s47, s47, 11
buffer_load_dwordx4 v[88:91], v13, s[24:27], s47 offen offset:0 sc1
buffer_load_dwordx4 v[92:95], v13, s[24:27], s47 offen offset:1024 sc1
s_call_b64 s[100:101], L_TRY
s_cbranch_scc1 L_SLOW29
v_mov_b64 v[96:97], v[120:121]
v_mov_b64 v[100:101], v[124:125]
s_branch L_BACK29
L_SLOW30:
s_movk_i32 s91, 30
s_lshl_b32 s47, s91, 11
buffer_load_dwordx4 v[120:123], v13, s[24:27], s47 offen offset:0 sc1
buffer_load_dwordx4 v[124:127], v13, s[24:27], s47 offen offset:1024 sc1
s_movk_i32 s47, 31
s_lshl_b32 s47, s47, 11
buffer_load_dwordx4 v[88:91], v13, s[24:27], s47 offen offset:0 sc1
buffer_load_dwordx4 v[92:95], v13, s[24:27], s47 offen offset:1024 sc1
s_call_b64 s[100:101], L_TRY
s_cbranch_scc1 L_SLOW30
v_mov_b64 v[80:81], v[120:121]
v_mov_b64 v[84:85], v[124:125]
s_branch L_BACK30
L_SLOW31:
s_movk_i32 s91, 31
s_lshl_b32 s47, s91, 11
buffer_load_dwordx4 v[120:123], v13, s[24:27], s47 offen offset:0 sc1
buffer_load_dwordx4 v[124:127], v13, s[24:27], s47 offen offset:1024 sc1
s_call_b64 s[100:101], L_TRY
s_cbranch_scc1 L_SLOW31
v_mov_b64 v[88:89], v[120:121]
v_mov_b64 v[92:93], v[124:125]
s_branch L_BACK31
L_SELF:
s_mul_i32 s47, s91, 458752
s_lshl_b32 s46, s39, 8
s_add_u32 s47, s47, s46
s_add_u32 s84, s6, s47
s_addc_u32 s85, s7, 0
s_mov_b32 s86, 387328
s_mov_b32 s87, 0x20000
buffer_load_dwordx4 v[64:67], v30, s[84:87], 0 offen
buffer_load_dwordx4 v[68:71], v30, s[84:87], s92 offen
buffer_load_dwordx4 v[72:75], v30, s[84:87], s93 offen
buffer_load_dwordx4 v[76:79], v30, s[84:87], s94 offen
s_waitcnt vmcnt(0)
v_lshl_add_u64 v[64:65], v[68:69], 4, v[64:65]
v_lshl_add_u64 v[66:67], v[70:71], 4, v[66:67]
v_lshl_add_u64 v[72:73], v[76:77], 4, v[72:73]
v_lshl_add_u64 v[74:75], v[78:79], 4, v[74:75]
v_lshl_or_b32 v76, v72, 8, v64
v_lshl_or_b32 v77, v73, 8, v65
v_lshl_or_b32 v78, v74, 8, v66
v_lshl_or_b32 v79, v75, 8, v67
v_lshl_or_b32 v120, v77, 16, v76
v_lshl_or_b32 v121, v79, 16, v78
s_add_u32 s84, s84, 57344
s_addc_u32 s85, s85, 0
buffer_load_dwordx4 v[64:67], v30, s[84:87], 0 offen
buffer_load_dwordx4 v[68:71], v30, s[84:87], s92 offen
buffer_load_dwordx4 v[72:75], v30, s[84:87], s93 offen
buffer_load_dwordx4 v[76:79], v30, s[84:87], s94 offen
s_waitcnt vmcnt(0)
v_lshl_add_u64 v[64:65], v[68:69], 4, v[64:65]
v_lshl_add_u64 v[66:67], v[70:71], 4, v[66:67]
v_lshl_add_u64 v[72:73], v[76:77], 4, v[72:73]
v_lshl_add_u64 v[74:75], v[78:79], 4, v[74:75]
v_lshl_or_b32 v76, v72, 8, v64
v_lshl_or_b32 v77, v73, 8, v65
v_lshl_or_b32 v78, v74, 8, v66
v_lshl_or_b32 v79, v75, 8, v67
v_lshl_or_b32 v124, v77, 16, v76
v_lshl_or_b32 v125, v79, 16, v78
s_cmp_eq_u32 s39, -1
s_setpc_b64 s[100:101]
L_END:
s_endpgm
.section .rodata,"a"
.p2align 6
.amdhsa_kernel standalone__normalfloat_lut_af4__prompt_kernel
  .amdhsa_next_free_vgpr 512
  .amdhsa_next_free_sgpr 102
  .amdhsa_accum_offset 256
  .amdhsa_group_segment_fixed_size 0
  .amdhsa_kernarg_size 56
  .amdhsa_user_sgpr_count 2
  .amdhsa_user_sgpr_kernarg_segment_ptr 1
  .amdhsa_system_sgpr_workgroup_id_x 1
.end_amdhsa_kernel
```

```asm
; @launch grid=(256,1,1) block=(256,1,1) lds=163840
.amdgcn_target "amdgcn-amd-amdhsa--gfx950"
.text
.globl standalone__normalfloat_lut_af4__prompt_kernel
.p2align 12
.p2align 8
.type standalone__normalfloat_lut_af4__prompt_kernel,@function
standalone__normalfloat_lut_af4__prompt_kernel:
s_load_dwordx4 s[4:7], s[0:1], 0
s_load_dwordx4 s[12:15], s[0:1], 40
s_load_dwordx4 s[8:11], s[0:1], 24
s_load_dwordx2 s[50:51], s[0:1], 16
s_memrealtime s[56:57]
s_cmp_ge_u32 s2, 256
s_cbranch_scc1 L_END
s_getpc_b64 s[48:49]
L_PC0:
v_bfi_b32 v2, 7, v0, s2
v_lshlrev_b32 v2, 7, v2
v_min_u32 v2, L_END-L_PC0, v2
global_load_dword v7, v2, s[48:49]
v_lshrrev_b32 v1, 6, v0
s_cmp_lt_u32 s2, 32
v_readfirstlane_b32 s36, v1
s_cbranch_scc1 L_PACK
s_bfe_u32 s34, s2, 0x20001
s_bfe_u32 s37, s2, 0x20003
s_lshl2_add_u32 s37, s34, s37
s_and_b32 s43, s2, 1
s_mul_i32 s43, s43, 7
s_lshr_b32 s38, s2, 5
s_add_u32 s38, s38, s43
s_lshl2_add_u32 s39, s38, s36
s_sub_u32 s39, s39, 4
v_bfe_u32 v6, v0, 4, 2
v_and_b32 v3, 15, v0
v_mul_u32_u24 v2, 114688, v6
v_lshl_add_u32 v30, v3, 4, v2
s_lshr_b32 s46, s37, 1
s_and_b32 s45, s37, 1
s_lshl3_add_u32 s46, s46, s45
s_mul_i32 s46, s46, 57344
s_lshl_b32 s47, s39, 8
s_add_u32 s44, s46, s47
s_mov_b32 s18, 387328
s_mov_b32 s19, 0x20000
s_mov_b32 s92, 14336
s_mov_b32 s93, 28672
s_mov_b32 s94, 43008
s_waitcnt lgkmcnt(0)
s_load_dwordx8 s[64:71], s[50:51], 0
s_add_u32 s16, s6, s44
s_addc_u32 s17, s7, 0
buffer_load_dwordx4 v[104:107], v30, s[16:19], 0 offen
buffer_load_dwordx4 v[108:111], v30, s[16:19], s92 offen
buffer_load_dwordx4 v[112:115], v30, s[16:19], s93 offen
buffer_load_dwordx4 v[116:119], v30, s[16:19], s94 offen
s_branch L_MAIN
L_PACK:
v_lshrrev_b32 v2, 2, v0
v_and_b32 v3, 3, v0
s_lshl_b32 s45, s2, 17
v_lshl_add_u32 v2, v2, 11, s45
v_lshl_add_u32 v17, v3, 7, v2
s_mov_b32 s30, 4194304
s_mov_b32 s31, 0x20000
v_lshlrev_b32 v16, 3, v0
s_cmp_lt_u32 s2, 2
s_cselect_b32 s34, 8, 0
s_mov_b32 s35, 0x20000
v_mov_b64 v[22:23], 0
s_waitcnt lgkmcnt(0)
s_mov_b64 s[32:33], s[12:13]
v_mov_b64 v[20:21], s[56:57]
buffer_atomic_cmpswap_x2 v[20:23], v16, s[32:35], 0 offen sc1
s_mov_b64 s[28:29], s[4:5]
buffer_load_dword v19, v17, s[28:31], 0 offen offset:0
s_branch L_PACK1
L_MAIN:
s_mov_b64 s[20:21], s[4:5]
s_mov_b32 s22, 4194304
s_mov_b32 s23, 0x20000
s_lshl_b32 s46, s37, 18
v_lshrrev_b32 v5, 3, v0
v_lshl_add_u32 v2, v5, 11, s46
v_lshrrev_b32 v4, 4, v0
v_xor_b32 v4, v4, v0
v_and_b32 v4, 7, v4
v_lshl_add_u32 v8, v4, 4, v2
v_add_u32 v9, 65536, v8
v_add_u32 v10, 131072, v8
v_add_u32 v11, 196608, v8
s_lshl_b32 s33, s36, 10
s_mul_i32 s47, s45, 114688
s_sub_u32 s47, s44, s47
s_add_u32 s47, s47, 57344
s_add_u32 s84, s6, s47
s_addc_u32 s85, s7, 0
s_mov_b32 s86, 387328
s_mov_b32 s87, 0x20000
s_lshl_b32 s40, s34, 7
s_add_u32 m0, s33, 65536
s_nop 0
buffer_load_dwordx4 v8, s[20:23], s40 offen lds
s_add_u32 m0, s33, 69632
s_nop 0
buffer_load_dwordx4 v9, s[20:23], s40 offen lds
s_add_u32 m0, s33, 73728
s_nop 0
buffer_load_dwordx4 v10, s[20:23], s40 offen lds
s_add_u32 m0, s33, 77824
s_nop 0
buffer_load_dwordx4 v11, s[20:23], s40 offen lds
s_and_b32 s45, s36, 1
s_mul_i32 s45, s45, 0x0202
s_lshr_b32 s46, s36, 1
s_mul_i32 s46, s46, 0x02020000
s_add_u32 s45, s45, s46
s_add_u32 s45, s45, 0x05040100
v_mov_b32 v57, s45
v_lshlrev_b32 v5, 8, v5
v_and_b32 v58, 7, v0
v_lshl_add_u32 v58, v58, 4, v5
v_and_b32 v5, 31, v0
v_lshlrev_b32 v19, 2, v5
v_and_b32 v0, 63, v0
s_lshl_b32 s46, s39, 7
v_lshl_add_u32 v28, v3, 3, s46
s_mul_i32 s47, s37, 917504
s_add_u32 s47, s47, s46
s_add_u32 s28, s10, s47
s_addc_u32 s29, s11, 0
s_mov_b32 s30, 86144
s_mov_b32 s31, 0x20000
v_mul_u32_u24 v29, 28672, v6
v_lshl_add_u32 v18, v3, 3, v29
v_lshlrev_b32 v29, 7, v3
v_bfe_u32 v5, v0, 1, 3
v_xor_b32 v5, v5, v6
v_lshl_add_u32 v29, v5, 4, v29
v_add_u32 v14, 65536, v29
v_xor_b32 v15, 64, v14
v_add_u32 v16, 0x10000, v14
v_add_u32 v17, 0x10000, v15
s_mov_b32 s52, 0x0c0c0400
s_mov_b32 s53, 0x0c0c0500
s_mov_b32 s54, 0x0c0c0600
s_mov_b32 s55, 0x0c0c0700
v_lshlrev_b32 v13, 4, v0
s_lshl_b32 s47, s39, 16
s_add_u32 s24, s14, s47
s_addc_u32 s25, s15, 0
s_lshl_b32 s47, s37, 10
s_add_u32 s76, s24, s47
s_addc_u32 s77, s25, 0
s_movk_i32 s78, 1024
s_mov_b32 s79, 0x20000
s_lshl_b32 s47, s34, 3
s_lshr_b32 s47, 0x90d0b2d, s47
s_bfe_u32 s41, s47, 0x20000
s_lshl_b32 s41, s41, 7
s_bfe_u32 s42, s47, 0x20002
s_lshl_b32 s42, s42, 7
s_bfe_u32 s43, s47, 0x20004
s_lshl_b32 s43, s43, 7
s_lshl_b32 s47, s34, 1
s_lshr_b32 s47, 0x63, s47
s_and_b32 s47, s47, 3
s_sub_u32 s47, s47, s34
s_lshl1_add_u32 s3, s47, 14
s_mul_i32 s47, s3, 458752
s_add_u32 s16, s16, s47
s_addc_u32 s17, s17, 0
s_lshl_b32 s3, s3, 11
s_lshr_b32 s35, s37, 1
s_xor_b32 s35, s35, 1
v_lshl_add_u32 v12, s41, 5, v13
s_mul_i32 s47, s35, 458752
s_lshl_b32 s46, s39, 8
s_add_u32 s47, s47, s46
s_add_u32 s72, s6, s47
s_addc_u32 s73, s7, 0
s_mov_b32 s74, 444672
s_mov_b32 s75, 0x20000
v_add_u32 v31, 57344, v30
s_and_b32 s47, s37, 2
s_lshl_b32 s47, s47, 5
v_xor_b32 v2, s47, v14
v_xor_b32 v4, 64, v2
s_mov_b32 s26, 65536
s_mov_b32 s27, 0x20000
s_mov_b64 s[80:81], s[12:13]
s_movk_i32 s82, 128
s_mov_b32 s83, 0x20000
s_movk_i32 s90, 4096
s_waitcnt lgkmcnt(0)
s_pack_ll_b32_b16 s45, s64, s68
v_mov_b32 v56, s45
s_lshl_b64 exec, exec, 8
s_pack_hh_b32_b16 s45, s64, s68
v_mov_b32 v56, s45
s_lshl_b64 exec, exec, 8
s_pack_ll_b32_b16 s45, s65, s69
v_mov_b32 v56, s45
s_lshl_b64 exec, exec, 8
s_pack_hh_b32_b16 s45, s65, s69
v_mov_b32 v56, s45
s_lshl_b64 exec, exec, 8
s_pack_ll_b32_b16 s45, s66, s70
v_mov_b32 v56, s45
s_lshl_b64 exec, exec, 8
s_pack_hh_b32_b16 s45, s66, s70
v_mov_b32 v56, s45
s_lshl_b64 exec, exec, 8
s_pack_ll_b32_b16 s45, s67, s71
v_mov_b32 v56, s45
s_lshl_b64 exec, exec, 8
s_pack_hh_b32_b16 s45, s67, s71
v_mov_b32 v56, s45
s_mov_b64 exec, -1
v_perm_b32 v128, s64, v56, v57
v_mov_b32 v129, v128
v_mov_b64 v[130:131], v[128:129]
s_load_dwordx2 s[88:89], s[12:13], 0
ds_write_b128 v58, v[128:131] offset:0
v_perm_b32 v132, s65, v56, v57
v_mov_b32 v133, v132
v_mov_b64 v[134:135], v[132:133]
ds_write_b128 v58, v[132:135] offset:8192
v_perm_b32 v136, s66, v56, v57
v_mov_b32 v137, v136
v_mov_b64 v[138:139], v[136:137]
ds_write_b128 v58, v[136:139] offset:16384
v_perm_b32 v140, s67, v56, v57
v_mov_b32 v141, v140
v_mov_b64 v[142:143], v[140:141]
ds_write_b128 v58, v[140:143] offset:24576
v_perm_b32 v144, s68, v56, v57
v_mov_b32 v145, v144
v_mov_b64 v[146:147], v[144:145]
ds_write_b128 v58, v[144:147] offset:32768
v_perm_b32 v148, s69, v56, v57
v_mov_b32 v149, v148
v_mov_b64 v[150:151], v[148:149]
ds_write_b128 v58, v[148:151] offset:40960
v_perm_b32 v152, s70, v56, v57
v_mov_b32 v153, v152
v_mov_b64 v[154:155], v[152:153]
ds_write_b128 v58, v[152:155] offset:49152
v_perm_b32 v156, s71, v56, v57
v_mov_b32 v157, v156
v_mov_b64 v[158:159], v[156:157]
ds_write_b128 v58, v[156:159] offset:57344
buffer_load_dwordx4 v[64:67], v30, s[84:87], 0 offen
buffer_load_dwordx4 v[68:71], v30, s[84:87], s92 offen
buffer_load_dwordx4 v[72:75], v30, s[84:87], s93 offen
buffer_load_dwordx4 v[76:79], v30, s[84:87], s94 offen
s_mov_b64 vcc, -1
s_branch L_PAD0
L_PADRET0:
s_mov_b64 vcc, 0
s_waitcnt vmcnt(8)
v_lshl_add_u64 v[104:105], v[108:109], 4, v[104:105]
v_lshl_add_u64 v[106:107], v[110:111], 4, v[106:107]
v_lshl_add_u64 v[112:113], v[116:117], 4, v[112:113]
v_lshl_add_u64 v[114:115], v[118:119], 4, v[114:115]
v_lshl_or_b32 v116, v112, 8, v104
v_lshl_or_b32 v117, v113, 8, v105
v_lshl_or_b32 v118, v114, 8, v106
v_lshl_or_b32 v119, v115, 8, v107
v_lshl_or_b32 v108, v117, 16, v116
v_lshl_or_b32 v109, v119, 16, v118
s_waitcnt lgkmcnt(0)
s_cmp_eq_u64 s[88:89], 0
s_cbranch_scc1 L_NOTAG
L_TAGOK:
v_mov_b64 v[110:111], s[88:89]
buffer_store_dwordx4 v[108:111], v13, s[76:79], 0 offen sc1
s_add_u32 s76, s76, s3
s_addc_u32 s77, s77, 0
s_waitcnt lgkmcnt(0)
s_nop 0
s_branch L_STREAM
L_PACK1:
v_and_b32 v0, 63, v0
v_lshrrev_b32 v2, 4, v0
v_and_b32 v3, 15, v0
v_mul_u32_u24 v2, 114688, v2
v_lshl_add_u32 v8, v3, 4, v2
s_movk_i32 s47, 0x3800
v_add_u32 v9, s47, v8
v_add_u32 v10, s47, v9
v_add_u32 v11, s47, v10
v_add_u32 v12, s47, v11
v_add_u32 v13, s47, v12
v_add_u32 v14, s47, v13
v_add_u32 v15, s47, v14
s_sub_u32 s3, s2, 1
s_and_b32 s3, s3, 7
s_lshr_b32 s45, s2, 3
s_lshl2_add_u32 s3, s3, s45
s_mul_i32 s40, s3, 4682
s_lshr_b32 s40, s40, 16
s_mul_i32 s41, s40, 14
s_sub_u32 s41, s3, s41
s_add_u32 s40, s40, 8
s_mov_b32 s22, 14680064
s_mov_b32 s23, 0x20000
s_mov_b64 s[20:21], s[6:7]
s_cmp_ge_u32 s40, 14
s_cselect_b32 s45, 8, 0
s_add_u32 s45, s45, s40
s_lshl2_add_u32 s42, s41, s36
s_mul_i32 s43, s45, 458752
s_lshl_b32 s44, s42, 8
s_add_u32 s43, s43, s44
s_lshl_b32 s44, s42, 5
s_add_u32 s44, s44, s45
s_lshl_b32 s52, s44, 11
s_cmp_lt_u32 s45, 32
s_cselect_b32 s52, s52, 0x1000000
s_cselect_b32 s22, 14680064, 0
s_add_u32 s41, s41, 4
s_add_u32 s40, s40, 2
s_cmp_ge_u32 s41, 14
s_cselect_b32 s48, 14, 0
s_addc_u32 s40, s40, 0
s_sub_u32 s41, s41, s48
s_load_dwordx2 s[50:51], s[12:13], 0
buffer_load_dwordx4 v[32:35], v8, s[20:23], s43 offen
buffer_load_dwordx4 v[36:39], v9, s[20:23], s43 offen
buffer_load_dwordx4 v[40:43], v10, s[20:23], s43 offen
buffer_load_dwordx4 v[44:47], v11, s[20:23], s43 offen
buffer_load_dwordx4 v[48:51], v12, s[20:23], s43 offen
buffer_load_dwordx4 v[52:55], v13, s[20:23], s43 offen
buffer_load_dwordx4 v[56:59], v14, s[20:23], s43 offen
buffer_load_dwordx4 v[60:63], v15, s[20:23], s43 offen
s_mov_b64 s[24:25], s[14:15]
s_mov_b32 s26, 3670016
s_mov_b32 s27, 0x20000
s_movk_i32 s34, 128
v_mov_b32 v16, 0
v_lshlrev_b32 v18, 4, v0
s_movk_i32 s46, 4096
s_waitcnt vmcnt(4) lgkmcnt(0)
v_mov_b64 v[22:23], s[50:51]
s_nop 0
L_PKN:
v_cmp_ne_u64 vcc, 0, v[22:23]
s_sub_u32 s46, s46, 1
s_cmp_gt_i32 s46, 0
s_cbranch_vccnz L_PKGO
s_cbranch_scc0 L_END
buffer_load_dwordx2 v[22:23], v16, s[32:35], 0 offen sc1
s_waitcnt vmcnt(0)
s_branch L_PKN
L_PKGO:
s_call_b64 s[100:101], L_PK0
buffer_store_dwordx4 v[20:23], v18, s[24:27], s52 offen offset:0 sc1
s_waitcnt lgkmcnt(0)
s_call_b64 s[100:101], L_UNIT
s_mov_b32 s53, s49
buffer_load_dwordx4 v[64:67], v8, s[20:23], s43 offen
buffer_load_dwordx4 v[68:71], v9, s[20:23], s43 offen
buffer_load_dwordx4 v[72:75], v10, s[20:23], s43 offen
buffer_load_dwordx4 v[76:79], v11, s[20:23], s43 offen
s_waitcnt vmcnt(5)
s_call_b64 s[100:101], L_PK1
buffer_store_dwordx4 v[20:23], v18, s[24:27], s52 offen offset:1024 sc1
buffer_load_dwordx4 v[80:83], v12, s[20:23], s43 offen
buffer_load_dwordx4 v[84:87], v13, s[20:23], s43 offen
buffer_load_dwordx4 v[88:91], v14, s[20:23], s43 offen
buffer_load_dwordx4 v[92:95], v15, s[20:23], s43 offen
s_waitcnt vmcnt(5)
s_call_b64 s[100:101], L_PK2
buffer_store_dwordx4 v[20:23], v18, s[24:27], s53 offen offset:0 sc1
s_call_b64 s[100:101], L_UNIT
s_mov_b32 s54, s49
buffer_load_dwordx4 v[32:35], v8, s[20:23], s43 offen
buffer_load_dwordx4 v[36:39], v9, s[20:23], s43 offen
buffer_load_dwordx4 v[40:43], v10, s[20:23], s43 offen
buffer_load_dwordx4 v[44:47], v11, s[20:23], s43 offen
s_waitcnt vmcnt(5)
s_call_b64 s[100:101], L_PK3
buffer_store_dwordx4 v[20:23], v18, s[24:27], s53 offen offset:1024 sc1
buffer_load_dwordx4 v[48:51], v12, s[20:23], s43 offen
buffer_load_dwordx4 v[52:55], v13, s[20:23], s43 offen
buffer_load_dwordx4 v[56:59], v14, s[20:23], s43 offen
buffer_load_dwordx4 v[60:63], v15, s[20:23], s43 offen
s_waitcnt vmcnt(5)
s_call_b64 s[100:101], L_PK0
buffer_store_dwordx4 v[20:23], v18, s[24:27], s54 offen offset:0 sc1
s_call_b64 s[100:101], L_UNIT
s_mov_b32 s55, s49
buffer_load_dwordx4 v[64:67], v8, s[20:23], s43 offen
buffer_load_dwordx4 v[68:71], v9, s[20:23], s43 offen
buffer_load_dwordx4 v[72:75], v10, s[20:23], s43 offen
buffer_load_dwordx4 v[76:79], v11, s[20:23], s43 offen
s_waitcnt vmcnt(5)
s_call_b64 s[100:101], L_PK1
buffer_store_dwordx4 v[20:23], v18, s[24:27], s54 offen offset:1024 sc1
buffer_load_dwordx4 v[80:83], v12, s[20:23], s43 offen
buffer_load_dwordx4 v[84:87], v13, s[20:23], s43 offen
buffer_load_dwordx4 v[88:91], v14, s[20:23], s43 offen
buffer_load_dwordx4 v[92:95], v15, s[20:23], s43 offen
s_waitcnt vmcnt(5)
s_call_b64 s[100:101], L_PK2
buffer_store_dwordx4 v[20:23], v18, s[24:27], s55 offen offset:0 sc1
s_call_b64 s[100:101], L_UNIT
s_mov_b32 s52, s49
buffer_load_dwordx4 v[32:35], v8, s[20:23], s43 offen
buffer_load_dwordx4 v[36:39], v9, s[20:23], s43 offen
buffer_load_dwordx4 v[40:43], v10, s[20:23], s43 offen
buffer_load_dwordx4 v[44:47], v11, s[20:23], s43 offen
s_waitcnt vmcnt(5)
s_call_b64 s[100:101], L_PK3
buffer_store_dwordx4 v[20:23], v18, s[24:27], s55 offen offset:1024 sc1
buffer_load_dwordx4 v[48:51], v12, s[20:23], s43 offen
buffer_load_dwordx4 v[52:55], v13, s[20:23], s43 offen
buffer_load_dwordx4 v[56:59], v14, s[20:23], s43 offen
buffer_load_dwordx4 v[60:63], v15, s[20:23], s43 offen
s_waitcnt vmcnt(5)
s_call_b64 s[100:101], L_PK0
buffer_store_dwordx4 v[20:23], v18, s[24:27], s52 offen offset:0 sc1
buffer_load_dword v19, v17, s[28:31], 0 offen offset:1536
s_waitcnt vmcnt(2)
s_call_b64 s[100:101], L_PK1
buffer_store_dwordx4 v[20:23], v18, s[24:27], s52 offen offset:1024 sc1
s_call_b64 s[100:101], L_UNIT
s_mov_b32 s53, s49
buffer_load_dwordx4 v[64:67], v8, s[20:23], s43 offen
buffer_load_dwordx4 v[68:71], v9, s[20:23], s43 offen
buffer_load_dwordx4 v[72:75], v10, s[20:23], s43 offen
buffer_load_dwordx4 v[76:79], v11, s[20:23], s43 offen
buffer_load_dwordx4 v[80:83], v12, s[20:23], s43 offen
buffer_load_dwordx4 v[84:87], v13, s[20:23], s43 offen
buffer_load_dwordx4 v[88:91], v14, s[20:23], s43 offen
buffer_load_dwordx4 v[92:95], v15, s[20:23], s43 offen
s_waitcnt vmcnt(4)
s_call_b64 s[100:101], L_PK2
buffer_store_dwordx4 v[20:23], v18, s[24:27], s53 offen offset:0 sc1
s_call_b64 s[100:101], L_UNIT
s_mov_b32 s54, s49
buffer_load_dwordx4 v[32:35], v8, s[20:23], s43 offen
buffer_load_dwordx4 v[36:39], v9, s[20:23], s43 offen
buffer_load_dwordx4 v[40:43], v10, s[20:23], s43 offen
buffer_load_dwordx4 v[44:47], v11, s[20:23], s43 offen
s_waitcnt vmcnt(5)
s_call_b64 s[100:101], L_PK3
buffer_store_dwordx4 v[20:23], v18, s[24:27], s53 offen offset:1024 sc1
buffer_load_dwordx4 v[48:51], v12, s[20:23], s43 offen
buffer_load_dwordx4 v[52:55], v13, s[20:23], s43 offen
buffer_load_dwordx4 v[56:59], v14, s[20:23], s43 offen
buffer_load_dwordx4 v[60:63], v15, s[20:23], s43 offen
s_waitcnt vmcnt(5)
s_call_b64 s[100:101], L_PK0
buffer_store_dwordx4 v[20:23], v18, s[24:27], s54 offen offset:0 sc1
s_waitcnt vmcnt(1)
s_call_b64 s[100:101], L_PK1
buffer_store_dwordx4 v[20:23], v18, s[24:27], s54 offen offset:1024 sc1
s_endpgm
L_UNIT:
s_cmp_ge_u32 s40, 14
s_cselect_b32 s45, 8, 0
s_add_u32 s45, s45, s40
s_lshl2_add_u32 s42, s41, s36
s_mul_i32 s43, s45, 458752
s_lshl_b32 s44, s42, 8
s_add_u32 s43, s43, s44
s_lshl_b32 s44, s42, 5
s_add_u32 s44, s44, s45
s_lshl_b32 s49, s44, 11
s_cmp_lt_u32 s45, 32
s_cselect_b32 s49, s49, 0x1000000
s_cselect_b32 s22, 14680064, 0
s_add_u32 s41, s41, 4
s_add_u32 s40, s40, 2
s_cmp_ge_u32 s41, 14
s_cselect_b32 s48, 14, 0
s_addc_u32 s40, s40, 0
s_sub_u32 s41, s41, s48
s_setpc_b64 s[100:101]
L_PK0:
v_lshl_add_u64 v[32:33], v[36:37], 4, v[32:33]
v_lshl_add_u64 v[34:35], v[38:39], 4, v[34:35]
v_lshl_add_u64 v[40:41], v[44:45], 4, v[40:41]
v_lshl_add_u64 v[42:43], v[46:47], 4, v[42:43]
v_lshl_or_b32 v44, v40, 8, v32
v_lshl_or_b32 v45, v41, 8, v33
v_lshl_or_b32 v46, v42, 8, v34
v_lshl_or_b32 v47, v43, 8, v35
v_lshl_or_b32 v20, v45, 16, v44
v_lshl_or_b32 v21, v47, 16, v46
s_setpc_b64 s[100:101]
L_PK1:
v_lshl_add_u64 v[48:49], v[52:53], 4, v[48:49]
v_lshl_add_u64 v[50:51], v[54:55], 4, v[50:51]
v_lshl_add_u64 v[56:57], v[60:61], 4, v[56:57]
v_lshl_add_u64 v[58:59], v[62:63], 4, v[58:59]
v_lshl_or_b32 v60, v56, 8, v48
v_lshl_or_b32 v61, v57, 8, v49
v_lshl_or_b32 v62, v58, 8, v50
v_lshl_or_b32 v63, v59, 8, v51
v_lshl_or_b32 v20, v61, 16, v60
v_lshl_or_b32 v21, v63, 16, v62
s_setpc_b64 s[100:101]
L_PK2:
v_lshl_add_u64 v[64:65], v[68:69], 4, v[64:65]
v_lshl_add_u64 v[66:67], v[70:71], 4, v[66:67]
v_lshl_add_u64 v[72:73], v[76:77], 4, v[72:73]
v_lshl_add_u64 v[74:75], v[78:79], 4, v[74:75]
v_lshl_or_b32 v76, v72, 8, v64
v_lshl_or_b32 v77, v73, 8, v65
v_lshl_or_b32 v78, v74, 8, v66
v_lshl_or_b32 v79, v75, 8, v67
v_lshl_or_b32 v20, v77, 16, v76
v_lshl_or_b32 v21, v79, 16, v78
s_setpc_b64 s[100:101]
L_PK3:
v_lshl_add_u64 v[80:81], v[84:85], 4, v[80:81]
v_lshl_add_u64 v[82:83], v[86:87], 4, v[82:83]
v_lshl_add_u64 v[88:89], v[92:93], 4, v[88:89]
v_lshl_add_u64 v[90:91], v[94:95], 4, v[90:91]
v_lshl_or_b32 v92, v88, 8, v80
v_lshl_or_b32 v93, v89, 8, v81
v_lshl_or_b32 v94, v90, 8, v82
v_lshl_or_b32 v95, v91, 8, v83
v_lshl_or_b32 v20, v93, 16, v92
v_lshl_or_b32 v21, v95, 16, v94
s_setpc_b64 s[100:101]
.p2align 12
L_STREAM:
L_PAD0:
s_cbranch_vccnz L_PADRET0
buffer_load_dwordx4 v[80:83], v30, s[72:75], 0 offen
buffer_load_dwordx4 v[84:87], v30, s[72:75], s92 offen
buffer_load_dwordx4 v[88:91], v30, s[72:75], s93 offen
buffer_load_dwordx4 v[92:95], v30, s[72:75], s94 offen
s_waitcnt vmcnt(9)
s_barrier
ds_read_b128 a[240:243], v2 offset:0
ds_read_b128 a[244:247], v2 offset:2048
v_lshl_add_u32 v104, v104, 8, v19
v_lshl_add_u32 v105, v105, 8, v19
v_lshl_add_u32 v106, v106, 8, v19
v_lshl_add_u32 v107, v107, 8, v19
v_lshl_add_u32 v112, v112, 8, v19
v_lshl_add_u32 v113, v113, 8, v19
v_lshl_add_u32 v114, v114, 8, v19
v_lshl_add_u32 v115, v115, 8, v19
s_waitcnt vmcnt(5)
v_lshl_add_u64 v[64:65], v[68:69], 4, v[64:65]
v_lshl_add_u64 v[66:67], v[70:71], 4, v[66:67]
v_lshl_add_u64 v[72:73], v[76:77], 4, v[72:73]
v_lshl_add_u64 v[74:75], v[78:79], 4, v[74:75]
v_lshl_add_u32 v64, v64, 8, v19
v_lshl_add_u32 v65, v65, 8, v19
v_lshl_add_u32 v66, v66, 8, v19
v_lshl_add_u32 v67, v67, 8, v19
v_lshl_add_u32 v72, v72, 8, v19
v_lshl_add_u32 v73, v73, 8, v19
v_lshl_add_u32 v74, v74, 8, v19
v_lshl_add_u32 v75, v75, 8, v19
s_bitcmp1_b32 s37, 0
s_cbranch_scc0 L_NOSWAP
v_swap_b32 v104, v64
v_swap_b32 v105, v65
v_swap_b32 v106, v66
v_swap_b32 v107, v67
v_swap_b32 v112, v72
v_swap_b32 v113, v73
v_swap_b32 v114, v74
v_swap_b32 v115, v75
L_NOSWAP:
ds_read_b32 a0, v104
ds_read_b32 a1, v112
ds_read_b32 a2, v64
ds_read_b32 a3, v72
ds_read_b32 a4, v105
ds_read_b32 a5, v113
ds_read_b32 a6, v65
ds_read_b32 a7, v73
ds_read_b32 a8, v106
ds_read_b32 a9, v114
ds_read_b32 a10, v66
ds_read_b32 a11, v74
ds_read_b32 a12, v107
ds_read_b32 a13, v115
ds_read_b32 a14, v67
ds_read_b32 a15, v75
s_waitcnt lgkmcnt(12)
v_mfma_f32_16x16x32_bf16 v[128:131], a[240:243], a[0:3], 0
s_waitcnt lgkmcnt(8)
ds_read_b128 a[248:251], v2 offset:4096
buffer_load_dwordx4 v[40:43], v31, s[72:75], 0 offen
v_mfma_f32_16x16x32_bf16 v[132:135], a[240:243], a[4:7], 0
s_waitcnt lgkmcnt(5)
buffer_load_dwordx4 v[44:47], v31, s[72:75], s92 offen
v_mfma_f32_16x16x32_bf16 v[136:139], a[240:243], a[8:11], 0
s_waitcnt lgkmcnt(1)
buffer_load_dwordx4 v[48:51], v31, s[72:75], s93 offen
v_mfma_f32_16x16x32_bf16 v[140:143], a[240:243], a[12:15], 0
buffer_load_dwordx4 v[52:55], v31, s[72:75], s94 offen
v_mfma_f32_16x16x32_bf16 v[144:147], a[244:247], a[0:3], 0
ds_read_b128 a[252:255], v2 offset:6144
v_mfma_f32_16x16x32_bf16 v[148:151], a[244:247], a[4:7], 0
v_mfma_f32_16x16x32_bf16 v[152:155], a[244:247], a[8:11], 0
s_add_u32 m0, s33, 81920
v_mfma_f32_16x16x32_bf16 v[156:159], a[244:247], a[12:15], 0
s_waitcnt lgkmcnt(1)
v_mfma_f32_16x16x32_bf16 v[160:163], a[248:251], a[0:3], 0
ds_read_b128 a[240:243], v2 offset:8192
buffer_load_dwordx4 v8, s[20:23], s41 offen lds
v_mfma_f32_16x16x32_bf16 v[164:167], a[248:251], a[4:7], 0
v_mfma_f32_16x16x32_bf16 v[168:171], a[248:251], a[8:11], 0
s_add_u32 m0, s33, 86016
v_mfma_f32_16x16x32_bf16 v[172:175], a[248:251], a[12:15], 0
s_waitcnt lgkmcnt(1)
v_mfma_f32_16x16x32_bf16 v[176:179], a[252:255], a[0:3], 0
ds_read_b128 a[244:247], v2 offset:10240
buffer_load_dwordx4 v9, s[20:23], s41 offen lds
v_mfma_f32_16x16x32_bf16 v[180:183], a[252:255], a[4:7], 0
v_mfma_f32_16x16x32_bf16 v[184:187], a[252:255], a[8:11], 0
s_add_u32 m0, s33, 90112
v_mfma_f32_16x16x32_bf16 v[188:191], a[252:255], a[12:15], 0
s_waitcnt lgkmcnt(1)
v_mfma_f32_16x16x32_bf16 v[192:195], a[240:243], a[0:3], 0
buffer_load_dwordx4 v10, s[20:23], s41 offen lds
v_mfma_f32_16x16x32_bf16 v[196:199], a[240:243], a[4:7], 0
v_mfma_f32_16x16x32_bf16 v[200:203], a[240:243], a[8:11], 0
s_add_u32 m0, s33, 94208
v_mfma_f32_16x16x32_bf16 v[204:207], a[240:243], a[12:15], 0
s_waitcnt lgkmcnt(0)
v_mfma_f32_16x16x32_bf16 v[208:211], a[244:247], a[0:3], 0
ds_read_b128 a[248:251], v2 offset:12288
buffer_load_dwordx4 v11, s[20:23], s41 offen lds
v_mfma_f32_16x16x32_bf16 v[212:215], a[244:247], a[4:7], 0
v_mfma_f32_16x16x32_bf16 v[216:219], a[244:247], a[8:11], 0
v_mfma_f32_16x16x32_bf16 v[220:223], a[244:247], a[12:15], 0
s_waitcnt vmcnt(10)
ds_read_b128 a[252:255], v2 offset:14336
v_lshl_add_u64 v[80:81], v[84:85], 4, v[80:81]
v_lshl_add_u64 v[82:83], v[86:87], 4, v[82:83]
v_lshl_add_u32 v80, v80, 8, v19
v_lshl_add_u32 v81, v81, 8, v19
v_lshl_add_u32 v82, v82, 8, v19
v_lshl_add_u32 v83, v83, 8, v19
ds_read_b32 a16, v80
ds_read_b32 a20, v81
ds_read_b32 a24, v82
ds_read_b32 a28, v83
s_waitcnt vmcnt(8)
v_lshl_add_u64 v[88:89], v[92:93], 4, v[88:89]
v_lshl_add_u64 v[90:91], v[94:95], 4, v[90:91]
v_lshl_add_u32 v88, v88, 8, v19
v_lshl_add_u32 v89, v89, 8, v19
v_lshl_add_u32 v90, v90, 8, v19
v_lshl_add_u32 v91, v91, 8, v19
ds_read_b32 a17, v88
ds_read_b32 a21, v89
ds_read_b32 a25, v90
ds_read_b32 a29, v91
s_waitcnt vmcnt(6)
buffer_load_dwordx4 v[32:35], v12, s[24:27], 0 offen offset:0 sc1
v_lshl_add_u64 v[40:41], v[44:45], 4, v[40:41]
v_lshl_add_u64 v[42:43], v[46:47], 4, v[42:43]
v_lshl_add_u32 v40, v40, 8, v19
v_lshl_add_u32 v41, v41, 8, v19
v_lshl_add_u32 v42, v42, 8, v19
v_lshl_add_u32 v43, v43, 8, v19
ds_read_b32 a18, v40
ds_read_b32 a22, v41
ds_read_b32 a26, v42
ds_read_b32 a30, v43
s_waitcnt vmcnt(5) lgkmcnt(13)
buffer_load_dwordx4 v[36:39], v12, s[24:27], 0 offen offset:1024 sc1
v_lshl_add_u64 v[48:49], v[52:53], 4, v[48:49]
v_lshl_add_u64 v[50:51], v[54:55], 4, v[50:51]
v_lshl_add_u32 v48, v48, 8, v19
v_lshl_add_u32 v49, v49, 8, v19
v_lshl_add_u32 v50, v50, 8, v19
v_lshl_add_u32 v51, v51, 8, v19
ds_read_b32 a19, v48
ds_read_b32 a23, v49
ds_read_b32 a27, v50
ds_read_b32 a31, v51
v_mfma_f32_16x16x32_bf16 v[224:227], a[248:251], a[0:3], 0
ds_read_b128 a[240:243], v4 offset:0
v_mfma_f32_16x16x32_bf16 v[228:231], a[248:251], a[4:7], 0
v_mfma_f32_16x16x32_bf16 v[232:235], a[248:251], a[8:11], 0
global_load_dwordx2 v[20:21], v28, s[8:9]
v_mfma_f32_16x16x32_bf16 v[236:239], a[248:251], a[12:15], 0
s_waitcnt lgkmcnt(5)
v_mfma_f32_16x16x32_bf16 v[240:243], a[252:255], a[0:3], 0
ds_read_b128 a[244:247], v4 offset:2048
v_mfma_f32_16x16x32_bf16 v[244:247], a[252:255], a[4:7], 0
v_mfma_f32_16x16x32_bf16 v[248:251], a[252:255], a[8:11], 0
v_mfma_f32_16x16x32_bf16 v[252:255], a[252:255], a[12:15], 0
s_waitcnt lgkmcnt(1)
v_mfma_f32_16x16x32_bf16 v[128:131], a[240:243], a[16:19], v[128:131]
ds_read_b128 a[248:251], v4 offset:4096
v_mfma_f32_16x16x32_bf16 v[132:135], a[240:243], a[20:23], v[132:135]
v_mfma_f32_16x16x32_bf16 v[136:139], a[240:243], a[24:27], v[136:139]
buffer_load_dwordx4 v[40:43], v12, s[24:27], 0 offen offset:2048 sc1
v_mfma_f32_16x16x32_bf16 v[140:143], a[240:243], a[28:31], v[140:143]
s_waitcnt lgkmcnt(1)
buffer_load_dwordx4 v[44:47], v12, s[24:27], 0 offen offset:3072 sc1
v_mfma_f32_16x16x32_bf16 v[144:147], a[244:247], a[16:19], v[144:147]
ds_read_b128 a[252:255], v4 offset:6144
v_lshl_add_u32 v12, s42, 5, v13
v_mfma_f32_16x16x32_bf16 v[148:151], a[244:247], a[20:23], v[148:151]
v_mfma_f32_16x16x32_bf16 v[152:155], a[244:247], a[24:27], v[152:155]
v_mfma_f32_16x16x32_bf16 v[156:159], a[244:247], a[28:31], v[156:159]
s_waitcnt lgkmcnt(1)
v_mfma_f32_16x16x32_bf16 v[160:163], a[248:251], a[16:19], v[160:163]
ds_read_b128 a[240:243], v4 offset:8192
v_mfma_f32_16x16x32_bf16 v[164:167], a[248:251], a[20:23], v[164:167]
v_mfma_f32_16x16x32_bf16 v[168:171], a[248:251], a[24:27], v[168:171]
v_mfma_f32_16x16x32_bf16 v[172:175], a[248:251], a[28:31], v[172:175]
s_waitcnt lgkmcnt(1)
v_mfma_f32_16x16x32_bf16 v[176:179], a[252:255], a[16:19], v[176:179]
ds_read_b128 a[244:247], v4 offset:10240
buffer_load_dwordx4 v[48:51], v12, s[24:27], 0 offen offset:0 sc1
v_mfma_f32_16x16x32_bf16 v[180:183], a[252:255], a[20:23], v[180:183]
buffer_load_dwordx4 v[52:55], v12, s[24:27], 0 offen offset:1024 sc1
v_mfma_f32_16x16x32_bf16 v[184:187], a[252:255], a[24:27], v[184:187]
s_add_u32 m0, s33, 98304
v_mfma_f32_16x16x32_bf16 v[188:191], a[252:255], a[28:31], v[188:191]
s_waitcnt lgkmcnt(1)
v_mfma_f32_16x16x32_bf16 v[192:195], a[240:243], a[16:19], v[192:195]
buffer_load_dwordx4 v8, s[20:23], s42 offen lds
v_mfma_f32_16x16x32_bf16 v[196:199], a[240:243], a[20:23], v[196:199]
v_mfma_f32_16x16x32_bf16 v[200:203], a[240:243], a[24:27], v[200:203]
s_add_u32 m0, s33, 102400
v_mfma_f32_16x16x32_bf16 v[204:207], a[240:243], a[28:31], v[204:207]
s_waitcnt lgkmcnt(0)
v_mfma_f32_16x16x32_bf16 v[208:211], a[244:247], a[16:19], v[208:211]
s_waitcnt vmcnt(8)
s_barrier
ds_read_b128 a[248:251], v4 offset:12288
buffer_load_dwordx4 v9, s[20:23], s42 offen lds
v_mfma_f32_16x16x32_bf16 v[212:215], a[244:247], a[20:23], v[212:215]
v_mfma_f32_16x16x32_bf16 v[216:219], a[244:247], a[24:27], v[216:219]
s_add_u32 m0, s33, 106496
v_mfma_f32_16x16x32_bf16 v[220:223], a[244:247], a[28:31], v[220:223]
ds_read_b128 a[252:255], v4 offset:14336
buffer_load_dwordx4 v10, s[20:23], s42 offen lds
s_waitcnt vmcnt(8)
v_cmp_ne_u64 s[50:51], s[88:89], v[34:35]
v_cmp_ne_u64 s[44:45], s[88:89], v[38:39]
s_or_b64 s[50:51], s[44:45], s[50:51]
s_cbranch_scc1 L_SLOW2
L_BACK2:
v_perm_b32 v64, v32, v19, s52
v_perm_b32 v65, v32, v19, s53
v_perm_b32 v66, v36, v19, s52
v_perm_b32 v67, v36, v19, s53
v_perm_b32 v68, v32, v19, s54
v_perm_b32 v69, v32, v19, s55
v_perm_b32 v70, v36, v19, s54
v_perm_b32 v71, v36, v19, s55
ds_read_b32 a32, v64
ds_read_b32 a33, v65
ds_read_b32 a34, v66
ds_read_b32 a35, v67
ds_read_b32 a36, v68
ds_read_b32 a37, v69
ds_read_b32 a38, v70
ds_read_b32 a39, v71
v_perm_b32 v72, v33, v19, s52
v_perm_b32 v73, v33, v19, s53
v_perm_b32 v74, v37, v19, s52
v_perm_b32 v75, v37, v19, s53
v_perm_b32 v76, v33, v19, s54
v_perm_b32 v77, v33, v19, s55
v_perm_b32 v78, v37, v19, s54
v_perm_b32 v79, v37, v19, s55
ds_read_b32 a40, v72
ds_read_b32 a41, v73
ds_read_b32 a42, v74
ds_read_b32 a43, v75
ds_read_b32 a44, v76
ds_read_b32 a45, v77
ds_read_b32 a46, v78
ds_read_b32 a47, v79
s_add_u32 m0, s33, 110592
s_waitcnt lgkmcnt(15)
v_mfma_f32_16x16x32_bf16 v[224:227], a[248:251], a[16:19], v[224:227]
ds_read_b128 a[240:243], v14 offset:16384
buffer_load_dwordx4 v11, s[20:23], s42 offen lds
v_mfma_f32_16x16x32_bf16 v[228:231], a[248:251], a[20:23], v[228:231]
v_mfma_f32_16x16x32_bf16 v[232:235], a[248:251], a[24:27], v[232:235]
s_waitcnt vmcnt(6)
s_add_u32 m0, s33, 114688
v_cmp_ne_u64 s[50:51], s[88:89], v[42:43]
v_cmp_ne_u64 s[44:45], s[88:89], v[46:47]
v_mfma_f32_16x16x32_bf16 v[236:239], a[248:251], a[28:31], v[236:239]
v_mfma_f32_16x16x32_bf16 v[240:243], a[252:255], a[16:19], v[240:243]
s_or_b64 s[50:51], s[44:45], s[50:51]
ds_read_b128 a[244:247], v14 offset:18432
buffer_load_dwordx4 v8, s[20:23], s43 offen lds
v_mfma_f32_16x16x32_bf16 v[244:247], a[252:255], a[20:23], v[244:247]
s_cbranch_scc1 L_SLOW3
L_BACK3:
v_mfma_f32_16x16x32_bf16 v[248:251], a[252:255], a[24:27], v[248:251]
s_add_u32 m0, s33, 118784
v_mfma_f32_16x16x32_bf16 v[252:255], a[252:255], a[28:31], v[252:255]
s_waitcnt lgkmcnt(1)
v_mfma_f32_16x16x32_bf16 v[128:131], a[240:243], a[32:35], v[128:131]
ds_read_b128 a[248:251], v14 offset:20480
buffer_load_dwordx4 v9, s[20:23], s43 offen lds
v_mfma_f32_16x16x32_bf16 v[132:135], a[240:243], a[36:39], v[132:135]
v_perm_b32 v63, v40, v19, s52
v_mfma_f32_16x16x32_bf16 v[136:139], a[240:243], a[40:43], v[136:139]
ds_read_b32 a48, v63
v_perm_b32 v62, v40, v19, s53
v_mfma_f32_16x16x32_bf16 v[140:143], a[240:243], a[44:47], v[140:143]
s_waitcnt lgkmcnt(2)
ds_read_b32 a49, v62
v_mfma_f32_16x16x32_bf16 v[144:147], a[244:247], a[32:35], v[144:147]
ds_read_b128 a[252:255], v14 offset:22528
v_perm_b32 v61, v44, v19, s52
v_mfma_f32_16x16x32_bf16 v[148:151], a[244:247], a[36:39], v[148:151]
ds_read_b32 a50, v61
v_perm_b32 v60, v44, v19, s53
v_mfma_f32_16x16x32_bf16 v[152:155], a[244:247], a[40:43], v[152:155]
s_add_u32 m0, s33, 122880
ds_read_b32 a51, v60
v_perm_b32 v59, v40, v19, s54
v_mfma_f32_16x16x32_bf16 v[156:159], a[244:247], a[44:47], v[156:159]
s_waitcnt lgkmcnt(4)
ds_read_b32 a52, v59
v_perm_b32 v58, v40, v19, s55
v_mfma_f32_16x16x32_bf16 v[160:163], a[248:251], a[32:35], v[160:163]
ds_read_b128 a[240:243], v14 offset:24576
buffer_load_dwordx4 v10, s[20:23], s43 offen lds
v_mfma_f32_16x16x32_bf16 v[164:167], a[248:251], a[36:39], v[164:167]
buffer_load_dwordx4 v[104:107], v30, s[16:19], 0 offen
v_mfma_f32_16x16x32_bf16 v[168:171], a[248:251], a[40:43], v[168:171]
ds_read_b32 a53, v58
v_perm_b32 v57, v44, v19, s54
v_mfma_f32_16x16x32_bf16 v[172:175], a[248:251], a[44:47], v[172:175]
s_waitcnt lgkmcnt(3)
ds_read_b32 a54, v57
v_mfma_f32_16x16x32_bf16 v[176:179], a[252:255], a[32:35], v[176:179]
ds_read_b128 a[244:247], v14 offset:26624
v_perm_b32 v56, v44, v19, s55
v_mfma_f32_16x16x32_bf16 v[180:183], a[252:255], a[36:39], v[180:183]
ds_read_b32 a55, v56
v_perm_b32 v63, v41, v19, s52
v_mfma_f32_16x16x32_bf16 v[184:187], a[252:255], a[40:43], v[184:187]
ds_read_b32 a56, v63
v_perm_b32 v62, v41, v19, s53
v_mfma_f32_16x16x32_bf16 v[188:191], a[252:255], a[44:47], v[188:191]
s_waitcnt lgkmcnt(4)
ds_read_b32 a57, v62
v_mfma_f32_16x16x32_bf16 v[192:195], a[240:243], a[32:35], v[192:195]
ds_read_b128 a[248:251], v14 offset:28672
v_perm_b32 v61, v45, v19, s52
v_mfma_f32_16x16x32_bf16 v[196:199], a[240:243], a[36:39], v[196:199]
buffer_load_dwordx4 v[108:111], v30, s[16:19], s92 offen
v_mfma_f32_16x16x32_bf16 v[200:203], a[240:243], a[40:43], v[200:203]
s_add_u32 m0, s33, 126976
ds_read_b32 a58, v61
v_perm_b32 v60, v45, v19, s53
v_mfma_f32_16x16x32_bf16 v[204:207], a[240:243], a[44:47], v[204:207]
s_waitcnt lgkmcnt(3)
ds_read_b32 a59, v60
v_perm_b32 v59, v41, v19, s54
v_mfma_f32_16x16x32_bf16 v[208:211], a[244:247], a[32:35], v[208:211]
ds_read_b128 a[252:255], v14 offset:30720
buffer_load_dwordx4 v11, s[20:23], s43 offen lds
v_mfma_f32_16x16x32_bf16 v[212:215], a[244:247], a[36:39], v[212:215]
ds_read_b32 a60, v59
v_perm_b32 v58, v41, v19, s55
v_mfma_f32_16x16x32_bf16 v[216:219], a[244:247], a[40:43], v[216:219]
ds_read_b32 a61, v58
v_perm_b32 v57, v45, v19, s54
v_mfma_f32_16x16x32_bf16 v[220:223], a[244:247], a[44:47], v[220:223]
s_waitcnt lgkmcnt(4)
ds_read_b32 a62, v57
buffer_load_dwordx4 v[96:99], v12, s[24:27], 0 offen offset:2048 sc1
v_mfma_f32_16x16x32_bf16 v[224:227], a[248:251], a[32:35], v[224:227]
ds_read_b128 a[240:243], v15 offset:16384
v_perm_b32 v56, v45, v19, s55
v_mfma_f32_16x16x32_bf16 v[228:231], a[248:251], a[36:39], v[228:231]
buffer_load_dwordx4 v[112:115], v30, s[16:19], s93 offen
v_mfma_f32_16x16x32_bf16 v[232:235], a[248:251], a[40:43], v[232:235]
ds_read_b32 a63, v56
buffer_load_dwordx4 v[100:103], v12, s[24:27], 0 offen offset:3072 sc1
v_mfma_f32_16x16x32_bf16 v[236:239], a[248:251], a[44:47], v[236:239]
s_waitcnt lgkmcnt(3)
v_lshl_add_u32 v12, s43, 5, v13
v_mfma_f32_16x16x32_bf16 v[240:243], a[252:255], a[32:35], v[240:243]
ds_read_b128 a[244:247], v15 offset:18432
buffer_load_dwordx4 v[80:83], v12, s[24:27], 0 offen offset:0 sc1
s_mov_b64 vcc, -1
s_cmp_eq_u32 s36, 0
s_cbranch_scc1 L_PAD1
s_cmp_eq_u32 s36, 1
s_cbranch_scc1 L_PAD3
s_cmp_eq_u32 s36, 2
s_cbranch_scc1 L_PAD5
s_cmp_eq_u32 s36, 3
s_cbranch_scc1 L_PADS
L_PADRET:
s_mov_b64 vcc, 0
v_mfma_f32_16x16x32_bf16 v[244:247], a[252:255], a[36:39], v[244:247]
buffer_load_dwordx4 v[84:87], v12, s[24:27], 0 offen offset:1024 sc1
v_lshlrev_b32 v24, 16, v20
v_mfma_f32_16x16x32_bf16 v[248:251], a[252:255], a[40:43], v[248:251]
s_waitcnt vmcnt(15)
v_cmp_ne_u64 s[50:51], s[88:89], v[50:51]
v_cmp_ne_u64 s[44:45], s[88:89], v[54:55]
v_mfma_f32_16x16x32_bf16 v[252:255], a[252:255], a[44:47], v[252:255]
s_waitcnt lgkmcnt(1)
v_and_b32 v25, 0xffff0000, v20
v_lshlrev_b32 v26, 16, v21
v_mfma_f32_16x16x32_bf16 v[128:131], a[240:243], a[48:51], v[128:131]
s_or_b64 s[50:51], s[44:45], s[50:51]
ds_read_b128 a[248:251], v15 offset:20480
v_and_b32 v27, 0xffff0000, v21
v_mfma_f32_16x16x32_bf16 v[132:135], a[240:243], a[52:55], v[132:135]
buffer_load_dwordx4 v[116:119], v30, s[16:19], s94 offen
v_mfma_f32_16x16x32_bf16 v[136:139], a[240:243], a[56:59], v[136:139]
s_cbranch_scc1 L_SLOW4
L_BACK4:
v_mfma_f32_16x16x32_bf16 v[140:143], a[240:243], a[60:63], v[140:143]
s_waitcnt lgkmcnt(1)
v_mfma_f32_16x16x32_bf16 v[144:147], a[244:247], a[48:51], v[144:147]
ds_read_b128 a[252:255], v15 offset:22528
v_mfma_f32_16x16x32_bf16 v[148:151], a[244:247], a[52:55], v[148:151]
v_perm_b32 v63, v48, v19, s52
v_mfma_f32_16x16x32_bf16 v[152:155], a[244:247], a[56:59], v[152:155]
ds_read_b32 a64, v63
v_perm_b32 v62, v48, v19, s53
v_mfma_f32_16x16x32_bf16 v[156:159], a[244:247], a[60:63], v[156:159]
s_waitcnt lgkmcnt(2)
ds_read_b32 a65, v62
v_mfma_f32_16x16x32_bf16 v[160:163], a[248:251], a[48:51], v[160:163]
ds_read_b128 a[240:243], v15 offset:24576
v_perm_b32 v61, v52, v19, s52
v_mfma_f32_16x16x32_bf16 v[164:167], a[248:251], a[52:55], v[164:167]
ds_read_b32 a66, v61
v_perm_b32 v60, v52, v19, s53
v_mfma_f32_16x16x32_bf16 v[168:171], a[248:251], a[56:59], v[168:171]
s_add_u32 m0, s33, 130560
ds_read_b32 a67, v60
v_perm_b32 v59, v48, v19, s54
v_mfma_f32_16x16x32_bf16 v[172:175], a[248:251], a[60:63], v[172:175]
s_waitcnt lgkmcnt(4)
ds_read_b32 a68, v59
v_perm_b32 v58, v48, v19, s55
v_mfma_f32_16x16x32_bf16 v[176:179], a[252:255], a[48:51], v[176:179]
ds_read_b128 a[244:247], v15 offset:26624
buffer_load_dwordx4 v8, s[20:23], 0 offen offset:512 lds
v_mfma_f32_16x16x32_bf16 v[180:183], a[252:255], a[52:55], v[180:183]
ds_read_b32 a69, v58
v_perm_b32 v57, v52, v19, s54
v_mfma_f32_16x16x32_bf16 v[184:187], a[252:255], a[56:59], v[184:187]
ds_read_b32 a70, v57
v_perm_b32 v56, v52, v19, s55
v_mfma_f32_16x16x32_bf16 v[188:191], a[252:255], a[60:63], v[188:191]
s_waitcnt lgkmcnt(4)
ds_read_b32 a71, v56
buffer_load_dwordx4 v[88:91], v12, s[24:27], 0 offen offset:2048 sc1
v_mfma_f32_16x16x32_bf16 v[192:195], a[240:243], a[48:51], v[192:195]
s_waitcnt vmcnt(14)
s_barrier
ds_read_b128 a[248:251], v15 offset:28672
v_perm_b32 v63, v49, v19, s52
v_mfma_f32_16x16x32_bf16 v[196:199], a[240:243], a[52:55], v[196:199]
ds_read_b32 a72, v63
v_perm_b32 v62, v49, v19, s53
v_mfma_f32_16x16x32_bf16 v[200:203], a[240:243], a[56:59], v[200:203]
ds_read_b32 a73, v62
v_perm_b32 v61, v53, v19, s52
v_mfma_f32_16x16x32_bf16 v[204:207], a[240:243], a[60:63], v[204:207]
s_waitcnt lgkmcnt(4)
ds_read_b32 a74, v61
buffer_load_dwordx4 v[92:95], v12, s[24:27], 0 offen offset:3072 sc1
v_mfma_f32_16x16x32_bf16 v[208:211], a[244:247], a[48:51], v[208:211]
ds_read_b128 a[252:255], v15 offset:30720
v_perm_b32 v60, v53, v19, s53
v_mfma_f32_16x16x32_bf16 v[212:215], a[244:247], a[52:55], v[212:215]
ds_read_b32 a75, v60
v_perm_b32 v59, v49, v19, s54
v_mfma_f32_16x16x32_bf16 v[216:219], a[244:247], a[56:59], v[216:219]
ds_read_b32 a76, v59
v_perm_b32 v58, v49, v19, s55
v_mfma_f32_16x16x32_bf16 v[220:223], a[244:247], a[60:63], v[220:223]
s_waitcnt lgkmcnt(4)
ds_read_b32 a77, v58
v_add_u32 v12, 16384, v13
v_mfma_f32_16x16x32_bf16 v[224:227], a[248:251], a[48:51], v[224:227]
ds_read_b128 a[240:243], v14 offset:32768
v_perm_b32 v57, v53, v19, s54
v_mfma_f32_16x16x32_bf16 v[228:231], a[248:251], a[52:55], v[228:231]
ds_read_b32 a78, v57
v_perm_b32 v56, v53, v19, s55
v_mfma_f32_16x16x32_bf16 v[232:235], a[248:251], a[56:59], v[232:235]
s_add_u32 m0, s33, 134656
ds_read_b32 a79, v56
v_mfma_f32_16x16x32_bf16 v[236:239], a[248:251], a[60:63], v[236:239]
s_waitcnt lgkmcnt(4)
v_mfma_f32_16x16x32_bf16 v[240:243], a[252:255], a[48:51], v[240:243]
ds_read_b128 a[244:247], v14 offset:34816
buffer_load_dwordx4 v9, s[20:23], 0 offen offset:512 lds
v_mfma_f32_16x16x32_bf16 v[244:247], a[252:255], a[52:55], v[244:247]
v_mfma_f32_16x16x32_bf16 v[248:251], a[252:255], a[56:59], v[248:251]
v_mfma_f32_16x16x32_bf16 v[252:255], a[252:255], a[60:63], v[252:255]
s_waitcnt lgkmcnt(1)
v_mfma_f32_16x16x32_bf16 v[128:131], a[240:243], a[64:67], v[128:131]
ds_read_b128 a[248:251], v14 offset:36864
v_mfma_f32_16x16x32_bf16 v[132:135], a[240:243], a[68:71], v[132:135]
v_mfma_f32_16x16x32_bf16 v[136:139], a[240:243], a[72:75], v[136:139]
v_mfma_f32_16x16x32_bf16 v[140:143], a[240:243], a[76:79], v[140:143]
s_waitcnt lgkmcnt(1)
v_mfma_f32_16x16x32_bf16 v[144:147], a[244:247], a[64:67], v[144:147]
ds_read_b128 a[252:255], v14 offset:38912
v_mfma_f32_16x16x32_bf16 v[148:151], a[244:247], a[68:71], v[148:151]
v_mfma_f32_16x16x32_bf16 v[152:155], a[244:247], a[72:75], v[152:155]
s_add_u32 m0, s33, 138752
v_mfma_f32_16x16x32_bf16 v[156:159], a[244:247], a[76:79], v[156:159]
s_waitcnt lgkmcnt(1)
v_mfma_f32_16x16x32_bf16 v[160:163], a[248:251], a[64:67], v[160:163]
ds_read_b128 a[240:243], v14 offset:40960
buffer_load_dwordx4 v10, s[20:23], 0 offen offset:512 lds
v_mfma_f32_16x16x32_bf16 v[164:167], a[248:251], a[68:71], v[164:167]
v_mfma_f32_16x16x32_bf16 v[168:171], a[248:251], a[72:75], v[168:171]
v_mfma_f32_16x16x32_bf16 v[172:175], a[248:251], a[76:79], v[172:175]
s_waitcnt lgkmcnt(1)
v_mfma_f32_16x16x32_bf16 v[176:179], a[252:255], a[64:67], v[176:179]
ds_read_b128 a[244:247], v14 offset:43008
v_mfma_f32_16x16x32_bf16 v[180:183], a[252:255], a[68:71], v[180:183]
v_mfma_f32_16x16x32_bf16 v[184:187], a[252:255], a[72:75], v[184:187]
v_mfma_f32_16x16x32_bf16 v[188:191], a[252:255], a[76:79], v[188:191]
s_waitcnt lgkmcnt(1)
buffer_load_dwordx4 v[32:35], v12, s[24:27], 0 offen offset:0 sc1
v_mfma_f32_16x16x32_bf16 v[192:195], a[240:243], a[64:67], v[192:195]
buffer_load_dwordx4 v[36:39], v12, s[24:27], 0 offen offset:1024 sc1
v_mfma_f32_16x16x32_bf16 v[196:199], a[240:243], a[68:71], v[196:199]
v_mfma_f32_16x16x32_bf16 v[200:203], a[240:243], a[72:75], v[200:203]
s_add_u32 m0, s33, 142848
v_mfma_f32_16x16x32_bf16 v[204:207], a[240:243], a[76:79], v[204:207]
s_waitcnt lgkmcnt(0)
v_mfma_f32_16x16x32_bf16 v[208:211], a[244:247], a[64:67], v[208:211]
ds_read_b128 a[248:251], v14 offset:45056
buffer_load_dwordx4 v11, s[20:23], 0 offen offset:512 lds
v_mfma_f32_16x16x32_bf16 v[212:215], a[244:247], a[68:71], v[212:215]
v_mfma_f32_16x16x32_bf16 v[216:219], a[244:247], a[72:75], v[216:219]
v_mfma_f32_16x16x32_bf16 v[220:223], a[244:247], a[76:79], v[220:223]
ds_read_b128 a[252:255], v14 offset:47104
s_waitcnt vmcnt(11)
v_cmp_ne_u64 s[50:51], s[88:89], v[98:99]
v_cmp_ne_u64 s[44:45], s[88:89], v[102:103]
s_or_b64 s[50:51], s[44:45], s[50:51]
s_cbranch_scc1 L_SLOW5
L_BACK5:
v_perm_b32 v64, v96, v19, s52
v_perm_b32 v65, v96, v19, s53
v_perm_b32 v66, v100, v19, s52
v_perm_b32 v67, v100, v19, s53
v_perm_b32 v68, v96, v19, s54
v_perm_b32 v69, v96, v19, s55
v_perm_b32 v70, v100, v19, s54
v_perm_b32 v71, v100, v19, s55
ds_read_b32 a80, v64
ds_read_b32 a81, v65
ds_read_b32 a82, v66
ds_read_b32 a83, v67
ds_read_b32 a84, v68
ds_read_b32 a85, v69
ds_read_b32 a86, v70
ds_read_b32 a87, v71
v_perm_b32 v72, v97, v19, s52
v_perm_b32 v73, v97, v19, s53
v_perm_b32 v74, v101, v19, s52
v_perm_b32 v75, v101, v19, s53
v_perm_b32 v76, v97, v19, s54
v_perm_b32 v77, v97, v19, s55
v_perm_b32 v78, v101, v19, s54
v_perm_b32 v79, v101, v19, s55
ds_read_b32 a88, v72
ds_read_b32 a89, v73
ds_read_b32 a90, v74
ds_read_b32 a91, v75
ds_read_b32 a92, v76
ds_read_b32 a93, v77
ds_read_b32 a94, v78
ds_read_b32 a95, v79
s_waitcnt lgkmcnt(15)
v_mfma_f32_16x16x32_bf16 v[224:227], a[248:251], a[64:67], v[224:227]
ds_read_b128 a[240:243], v15 offset:32768
v_mfma_f32_16x16x32_bf16 v[228:231], a[248:251], a[68:71], v[228:231]
L_PAD1:
s_cbranch_vccnz L_PAD2
v_mfma_f32_16x16x32_bf16 v[232:235], a[248:251], a[72:75], v[232:235]
v_mfma_f32_16x16x32_bf16 v[236:239], a[248:251], a[76:79], v[236:239]
s_waitcnt vmcnt(9)
v_cmp_ne_u64 s[50:51], s[88:89], v[82:83]
v_cmp_ne_u64 s[44:45], s[88:89], v[86:87]
v_mfma_f32_16x16x32_bf16 v[240:243], a[252:255], a[64:67], v[240:243]
ds_read_b128 a[244:247], v15 offset:34816
v_mfma_f32_16x16x32_bf16 v[244:247], a[252:255], a[68:71], v[244:247]
s_or_b64 s[50:51], s[44:45], s[50:51]
v_mfma_f32_16x16x32_bf16 v[248:251], a[252:255], a[72:75], v[248:251]
s_cbranch_scc1 L_SLOW6
L_BACK6:
v_mfma_f32_16x16x32_bf16 v[252:255], a[252:255], a[76:79], v[252:255]
s_waitcnt lgkmcnt(1)
v_mfma_f32_16x16x32_bf16 v[128:131], a[240:243], a[80:83], v[128:131]
ds_read_b128 a[248:251], v15 offset:36864
v_mfma_f32_16x16x32_bf16 v[132:135], a[240:243], a[84:87], v[132:135]
v_perm_b32 v63, v80, v19, s52
v_mfma_f32_16x16x32_bf16 v[136:139], a[240:243], a[88:91], v[136:139]
ds_read_b32 a96, v63
v_perm_b32 v62, v80, v19, s53
v_mfma_f32_16x16x32_bf16 v[140:143], a[240:243], a[92:95], v[140:143]
s_waitcnt lgkmcnt(2)
ds_read_b32 a97, v62
v_mfma_f32_16x16x32_bf16 v[144:147], a[244:247], a[80:83], v[144:147]
ds_read_b128 a[252:255], v15 offset:38912
v_perm_b32 v61, v84, v19, s52
v_mfma_f32_16x16x32_bf16 v[148:151], a[244:247], a[84:87], v[148:151]
ds_read_b32 a98, v61
v_perm_b32 v60, v84, v19, s53
v_mfma_f32_16x16x32_bf16 v[152:155], a[244:247], a[88:91], v[152:155]
s_add_u32 m0, s33, 146816
ds_read_b32 a99, v60
v_perm_b32 v59, v80, v19, s54
v_mfma_f32_16x16x32_bf16 v[156:159], a[244:247], a[92:95], v[156:159]
s_waitcnt lgkmcnt(4)
ds_read_b32 a100, v59
v_perm_b32 v58, v80, v19, s55
v_mfma_f32_16x16x32_bf16 v[160:163], a[248:251], a[80:83], v[160:163]
ds_read_b128 a[240:243], v15 offset:40960
buffer_load_dwordx4 v8, s[20:23], 0 offen offset:640 lds
v_mfma_f32_16x16x32_bf16 v[164:167], a[248:251], a[84:87], v[164:167]
ds_read_b32 a101, v58
v_perm_b32 v57, v84, v19, s54
v_mfma_f32_16x16x32_bf16 v[168:171], a[248:251], a[88:91], v[168:171]
ds_read_b32 a102, v57
v_perm_b32 v56, v84, v19, s55
v_mfma_f32_16x16x32_bf16 v[172:175], a[248:251], a[92:95], v[172:175]
s_waitcnt lgkmcnt(4)
ds_read_b32 a103, v56
buffer_load_dwordx4 v[40:43], v12, s[24:27], 0 offen offset:2048 sc1
v_mfma_f32_16x16x32_bf16 v[176:179], a[252:255], a[80:83], v[176:179]
s_barrier
ds_read_b128 a[244:247], v15 offset:43008
buffer_load_dwordx4 v[44:47], v12, s[24:27], 0 offen offset:3072 sc1
v_mfma_f32_16x16x32_bf16 v[180:183], a[252:255], a[84:87], v[180:183]
s_waitcnt vmcnt(11)
v_perm_b32 v63, v81, v19, s52
v_lshl_add_u64 v[104:105], v[108:109], 4, v[104:105]
v_mfma_f32_16x16x32_bf16 v[184:187], a[252:255], a[88:91], v[184:187]
ds_read_b32 a104, v63
v_perm_b32 v62, v81, v19, s53
v_mfma_f32_16x16x32_bf16 v[188:191], a[252:255], a[92:95], v[188:191]
s_waitcnt lgkmcnt(3)
ds_read_b32 a105, v62
v_perm_b32 v61, v85, v19, s52
v_mfma_f32_16x16x32_bf16 v[192:195], a[240:243], a[80:83], v[192:195]
ds_read_b128 a[248:251], v15 offset:45056
v_lshl_add_u64 v[106:107], v[110:111], 4, v[106:107]
v_mfma_f32_16x16x32_bf16 v[196:199], a[240:243], a[84:87], v[196:199]
ds_read_b32 a106, v61
v_perm_b32 v60, v85, v19, s53
v_mfma_f32_16x16x32_bf16 v[200:203], a[240:243], a[88:91], v[200:203]
ds_read_b32 a107, v60
v_perm_b32 v59, v81, v19, s54
v_mfma_f32_16x16x32_bf16 v[204:207], a[240:243], a[92:95], v[204:207]
s_waitcnt lgkmcnt(4)
ds_read_b32 a108, v59
v_lshl_add_u64 v[112:113], v[116:117], 4, v[112:113]
v_mfma_f32_16x16x32_bf16 v[208:211], a[244:247], a[80:83], v[208:211]
ds_read_b128 a[252:255], v15 offset:47104
v_perm_b32 v58, v81, v19, s55
v_mfma_f32_16x16x32_bf16 v[212:215], a[244:247], a[84:87], v[212:215]
ds_read_b32 a109, v58
v_add_u32 v12, 20480, v13
v_mfma_f32_16x16x32_bf16 v[216:219], a[244:247], a[88:91], v[216:219]
s_add_u32 m0, s33, 150912
v_perm_b32 v57, v85, v19, s54
v_lshl_add_u64 v[114:115], v[118:119], 4, v[114:115]
v_mfma_f32_16x16x32_bf16 v[220:223], a[244:247], a[92:95], v[220:223]
s_waitcnt lgkmcnt(3)
ds_read_b32 a110, v57
v_mfma_f32_16x16x32_bf16 v[224:227], a[248:251], a[80:83], v[224:227]
ds_read_b128 a[240:243], v14 offset:49152
buffer_load_dwordx4 v9, s[20:23], 0 offen offset:640 lds
v_mfma_f32_16x16x32_bf16 v[228:231], a[248:251], a[84:87], v[228:231]
v_perm_b32 v56, v85, v19, s55
v_lshl_or_b32 v116, v112, 8, v104
v_mfma_f32_16x16x32_bf16 v[232:235], a[248:251], a[88:91], v[232:235]
ds_read_b32 a111, v56
v_mfma_f32_16x16x32_bf16 v[236:239], a[248:251], a[92:95], v[236:239]
s_waitcnt lgkmcnt(3)
v_mfma_f32_16x16x32_bf16 v[240:243], a[252:255], a[80:83], v[240:243]
ds_read_b128 a[244:247], v14 offset:51200
v_lshl_or_b32 v117, v113, 8, v105
v_mfma_f32_16x16x32_bf16 v[244:247], a[252:255], a[84:87], v[244:247]
v_mfma_f32_16x16x32_bf16 v[248:251], a[252:255], a[88:91], v[248:251]
s_waitcnt vmcnt(9)
v_cmp_ne_u64 s[50:51], s[88:89], v[90:91]
v_cmp_ne_u64 s[44:45], s[88:89], v[94:95]
v_mfma_f32_16x16x32_bf16 v[252:255], a[252:255], a[92:95], v[252:255]
s_waitcnt lgkmcnt(1)
v_lshl_or_b32 v118, v114, 8, v106
v_mfma_f32_16x16x32_bf16 v[128:131], a[240:243], a[96:99], v[128:131]
s_or_b64 s[50:51], s[44:45], s[50:51]
ds_read_b128 a[248:251], v14 offset:53248
v_mfma_f32_16x16x32_bf16 v[132:135], a[240:243], a[100:103], v[132:135]
s_cbranch_scc1 L_SLOW7
L_BACK7:
v_mfma_f32_16x16x32_bf16 v[136:139], a[240:243], a[104:107], v[136:139]
s_add_u32 m0, s33, 155008
v_perm_b32 v63, v88, v19, s52
v_lshl_or_b32 v119, v115, 8, v107
v_mfma_f32_16x16x32_bf16 v[140:143], a[240:243], a[108:111], v[140:143]
s_waitcnt lgkmcnt(1)
ds_read_b32 a112, v63
v_mfma_f32_16x16x32_bf16 v[144:147], a[244:247], a[96:99], v[144:147]
ds_read_b128 a[252:255], v14 offset:55296
buffer_load_dwordx4 v10, s[20:23], 0 offen offset:640 lds
v_mfma_f32_16x16x32_bf16 v[148:151], a[244:247], a[100:103], v[148:151]
v_perm_b32 v62, v88, v19, s53
v_lshl_or_b32 v108, v117, 16, v116
v_mfma_f32_16x16x32_bf16 v[152:155], a[244:247], a[104:107], v[152:155]
ds_read_b32 a113, v62
v_perm_b32 v61, v92, v19, s52
v_mfma_f32_16x16x32_bf16 v[156:159], a[244:247], a[108:111], v[156:159]
s_waitcnt lgkmcnt(3)
ds_read_b32 a114, v61
v_perm_b32 v60, v92, v19, s53
v_mfma_f32_16x16x32_bf16 v[160:163], a[248:251], a[96:99], v[160:163]
ds_read_b128 a[240:243], v14 offset:57344
v_lshl_or_b32 v109, v119, 16, v118
v_mfma_f32_16x16x32_bf16 v[164:167], a[248:251], a[100:103], v[164:167]
ds_read_b32 a115, v60
v_perm_b32 v59, v88, v19, s54
v_mfma_f32_16x16x32_bf16 v[168:171], a[248:251], a[104:107], v[168:171]
ds_read_b32 a116, v59
v_perm_b32 v58, v88, v19, s55
v_mfma_f32_16x16x32_bf16 v[172:175], a[248:251], a[108:111], v[172:175]
s_waitcnt lgkmcnt(4)
ds_read_b32 a117, v58
v_mov_b64 v[110:111], s[88:89]
v_mfma_f32_16x16x32_bf16 v[176:179], a[252:255], a[96:99], v[176:179]
ds_read_b128 a[244:247], v14 offset:59392
v_perm_b32 v57, v92, v19, s54
v_mfma_f32_16x16x32_bf16 v[180:183], a[252:255], a[100:103], v[180:183]
ds_read_b32 a118, v57
v_perm_b32 v56, v92, v19, s55
v_mfma_f32_16x16x32_bf16 v[184:187], a[252:255], a[104:107], v[184:187]
s_add_u32 m0, s33, 159104
ds_read_b32 a119, v56
v_perm_b32 v63, v89, v19, s52
v_mfma_f32_16x16x32_bf16 v[188:191], a[252:255], a[108:111], v[188:191]
s_waitcnt lgkmcnt(4)
ds_read_b32 a120, v63
v_perm_b32 v62, v89, v19, s53
v_mfma_f32_16x16x32_bf16 v[192:195], a[240:243], a[96:99], v[192:195]
ds_read_b128 a[248:251], v14 offset:61440
buffer_load_dwordx4 v11, s[20:23], 0 offen offset:640 lds
v_mfma_f32_16x16x32_bf16 v[196:199], a[240:243], a[100:103], v[196:199]
buffer_store_dwordx4 v[108:111], v13, s[76:79], 0 offen sc1
v_mfma_f32_16x16x32_bf16 v[200:203], a[240:243], a[104:107], v[200:203]
ds_read_b32 a121, v62
v_perm_b32 v61, v93, v19, s52
v_mfma_f32_16x16x32_bf16 v[204:207], a[240:243], a[108:111], v[204:207]
s_waitcnt lgkmcnt(3)
ds_read_b32 a122, v61
buffer_load_dwordx4 v[48:51], v12, s[24:27], 0 offen offset:0 sc1
v_mfma_f32_16x16x32_bf16 v[208:211], a[244:247], a[96:99], v[208:211]
ds_read_b128 a[252:255], v14 offset:63488
v_perm_b32 v60, v93, v19, s53
v_mfma_f32_16x16x32_bf16 v[212:215], a[244:247], a[100:103], v[212:215]
ds_read_b32 a123, v60
v_perm_b32 v59, v89, v19, s54
v_mfma_f32_16x16x32_bf16 v[216:219], a[244:247], a[104:107], v[216:219]
ds_read_b32 a124, v59
v_perm_b32 v58, v89, v19, s55
v_mfma_f32_16x16x32_bf16 v[220:223], a[244:247], a[108:111], v[220:223]
s_waitcnt lgkmcnt(4)
ds_read_b32 a125, v58
buffer_load_dwordx4 v[52:55], v12, s[24:27], 0 offen offset:1024 sc1
v_mfma_f32_16x16x32_bf16 v[224:227], a[248:251], a[96:99], v[224:227]
ds_read_b128 a[240:243], v15 offset:49152
v_perm_b32 v57, v93, v19, s54
v_mfma_f32_16x16x32_bf16 v[228:231], a[248:251], a[100:103], v[228:231]
ds_read_b32 a126, v57
v_perm_b32 v56, v93, v19, s55
v_mfma_f32_16x16x32_bf16 v[232:235], a[248:251], a[104:107], v[232:235]
ds_read_b32 a127, v56
v_mfma_f32_16x16x32_bf16 v[236:239], a[248:251], a[108:111], v[236:239]
s_waitcnt lgkmcnt(4)
v_mfma_f32_16x16x32_bf16 v[240:243], a[252:255], a[96:99], v[240:243]
ds_read_b128 a[244:247], v15 offset:51200
v_mfma_f32_16x16x32_bf16 v[244:247], a[252:255], a[100:103], v[244:247]
v_mfma_f32_16x16x32_bf16 v[248:251], a[252:255], a[104:107], v[248:251]
v_mfma_f32_16x16x32_bf16 v[252:255], a[252:255], a[108:111], v[252:255]
s_waitcnt vmcnt(10) lgkmcnt(1)
v_cmp_ne_u64 s[50:51], s[88:89], v[34:35]
v_cmp_ne_u64 s[44:45], s[88:89], v[38:39]
v_mfma_f32_16x16x32_bf16 v[128:131], a[240:243], a[112:115], v[128:131]
ds_read_b128 a[248:251], v15 offset:53248
v_mfma_f32_16x16x32_bf16 v[132:135], a[240:243], a[116:119], v[132:135]
s_or_b64 s[50:51], s[44:45], s[50:51]
v_mfma_f32_16x16x32_bf16 v[136:139], a[240:243], a[120:123], v[136:139]
s_cbranch_scc1 L_SLOW8
L_BACK8:
v_mfma_f32_16x16x32_bf16 v[140:143], a[240:243], a[124:127], v[140:143]
s_waitcnt lgkmcnt(1)
v_mfma_f32_16x16x32_bf16 v[144:147], a[244:247], a[112:115], v[144:147]
ds_read_b128 a[252:255], v15 offset:55296
v_mfma_f32_16x16x32_bf16 v[148:151], a[244:247], a[116:119], v[148:151]
v_perm_b32 v63, v32, v19, s52
v_mfma_f32_16x16x32_bf16 v[152:155], a[244:247], a[120:123], v[152:155]
s_add_u32 m0, s33, 64768
ds_read_b32 a128, v63
v_perm_b32 v62, v32, v19, s53
v_mfma_f32_16x16x32_bf16 v[156:159], a[244:247], a[124:127], v[156:159]
s_waitcnt lgkmcnt(2)
ds_read_b32 a129, v62
v_perm_b32 v61, v36, v19, s52
v_mfma_f32_16x16x32_bf16 v[160:163], a[248:251], a[112:115], v[160:163]
ds_read_b128 a[240:243], v15 offset:57344
buffer_load_dwordx4 v8, s[20:23], 0 offen offset:768 lds
v_mfma_f32_16x16x32_bf16 v[164:167], a[248:251], a[116:119], v[164:167]
ds_read_b32 a130, v61
v_perm_b32 v60, v36, v19, s53
v_mfma_f32_16x16x32_bf16 v[168:171], a[248:251], a[120:123], v[168:171]
ds_read_b32 a131, v60
v_perm_b32 v59, v32, v19, s54
v_mfma_f32_16x16x32_bf16 v[172:175], a[248:251], a[124:127], v[172:175]
s_waitcnt lgkmcnt(4)
ds_read_b32 a132, v59
buffer_load_dwordx4 v[96:99], v12, s[24:27], 0 offen offset:2048 sc1
v_mfma_f32_16x16x32_bf16 v[176:179], a[252:255], a[112:115], v[176:179]
s_waitcnt vmcnt(11)
s_barrier
ds_read_b128 a[244:247], v15 offset:59392
v_perm_b32 v58, v32, v19, s55
v_mfma_f32_16x16x32_bf16 v[180:183], a[252:255], a[116:119], v[180:183]
ds_read_b32 a133, v58
v_perm_b32 v57, v36, v19, s54
v_mfma_f32_16x16x32_bf16 v[184:187], a[252:255], a[120:123], v[184:187]
ds_read_b32 a134, v57
v_perm_b32 v56, v36, v19, s55
v_mfma_f32_16x16x32_bf16 v[188:191], a[252:255], a[124:127], v[188:191]
s_waitcnt lgkmcnt(4)
ds_read_b32 a135, v56
buffer_load_dwordx4 v[100:103], v12, s[24:27], 0 offen offset:3072 sc1
v_mfma_f32_16x16x32_bf16 v[192:195], a[240:243], a[112:115], v[192:195]
ds_read_b128 a[248:251], v15 offset:61440
v_perm_b32 v63, v33, v19, s52
v_mfma_f32_16x16x32_bf16 v[196:199], a[240:243], a[116:119], v[196:199]
ds_read_b32 a136, v63
v_perm_b32 v62, v33, v19, s53
v_mfma_f32_16x16x32_bf16 v[200:203], a[240:243], a[120:123], v[200:203]
ds_read_b32 a137, v62
v_perm_b32 v61, v37, v19, s52
v_mfma_f32_16x16x32_bf16 v[204:207], a[240:243], a[124:127], v[204:207]
s_waitcnt lgkmcnt(4)
ds_read_b32 a138, v61
v_add_u32 v12, 24576, v13
v_mfma_f32_16x16x32_bf16 v[208:211], a[244:247], a[112:115], v[208:211]
ds_read_b128 a[252:255], v15 offset:63488
v_perm_b32 v60, v37, v19, s53
v_mfma_f32_16x16x32_bf16 v[212:215], a[244:247], a[116:119], v[212:215]
ds_read_b32 a139, v60
v_perm_b32 v59, v33, v19, s54
v_mfma_f32_16x16x32_bf16 v[216:219], a[244:247], a[120:123], v[216:219]
s_add_u32 m0, s33, 68864
ds_read_b32 a140, v59
v_perm_b32 v58, v33, v19, s55
v_mfma_f32_16x16x32_bf16 v[220:223], a[244:247], a[124:127], v[220:223]
s_waitcnt lgkmcnt(4)
ds_read_b32 a141, v58
v_perm_b32 v57, v37, v19, s54
v_mfma_f32_16x16x32_bf16 v[224:227], a[248:251], a[112:115], v[224:227]
ds_read_b128 a[240:243], v16 offset:0
buffer_load_dwordx4 v9, s[20:23], 0 offen offset:768 lds
v_mfma_f32_16x16x32_bf16 v[228:231], a[248:251], a[116:119], v[228:231]
ds_read_b32 a142, v57
v_perm_b32 v56, v37, v19, s55
v_mfma_f32_16x16x32_bf16 v[232:235], a[248:251], a[120:123], v[232:235]
ds_read_b32 a143, v56
v_mfma_f32_16x16x32_bf16 v[236:239], a[248:251], a[124:127], v[236:239]
s_waitcnt lgkmcnt(4)
v_mfma_f32_16x16x32_bf16 v[240:243], a[252:255], a[112:115], v[240:243]
ds_read_b128 a[244:247], v16 offset:2048
v_mfma_f32_16x16x32_bf16 v[244:247], a[252:255], a[116:119], v[244:247]
v_mfma_f32_16x16x32_bf16 v[248:251], a[252:255], a[120:123], v[248:251]
s_waitcnt vmcnt(10)
v_cmp_ne_u64 s[50:51], s[88:89], v[42:43]
v_cmp_ne_u64 s[44:45], s[88:89], v[46:47]
v_mfma_f32_16x16x32_bf16 v[252:255], a[252:255], a[124:127], v[252:255]
s_waitcnt lgkmcnt(1)
v_mfma_f32_16x16x32_bf16 v[128:131], a[240:243], a[128:131], v[128:131]
s_or_b64 s[50:51], s[44:45], s[50:51]
ds_read_b128 a[248:251], v16 offset:4096
v_mfma_f32_16x16x32_bf16 v[132:135], a[240:243], a[132:135], v[132:135]
s_cbranch_scc1 L_SLOW9
L_BACK9:
v_mfma_f32_16x16x32_bf16 v[136:139], a[240:243], a[136:139], v[136:139]
s_add_u32 m0, s33, 72960
v_mfma_f32_16x16x32_bf16 v[140:143], a[240:243], a[140:143], v[140:143]
s_waitcnt lgkmcnt(1)
v_mfma_f32_16x16x32_bf16 v[144:147], a[244:247], a[128:131], v[144:147]
ds_read_b128 a[252:255], v16 offset:6144
buffer_load_dwordx4 v10, s[20:23], 0 offen offset:768 lds
v_mfma_f32_16x16x32_bf16 v[148:151], a[244:247], a[132:135], v[148:151]
v_perm_b32 v63, v40, v19, s52
v_mfma_f32_16x16x32_bf16 v[152:155], a[244:247], a[136:139], v[152:155]
ds_read_b32 a144, v63
v_perm_b32 v62, v40, v19, s53
v_mfma_f32_16x16x32_bf16 v[156:159], a[244:247], a[140:143], v[156:159]
s_waitcnt lgkmcnt(2)
ds_read_b32 a145, v62
v_mfma_f32_16x16x32_bf16 v[160:163], a[248:251], a[128:131], v[160:163]
ds_read_b128 a[240:243], v16 offset:8192
v_perm_b32 v61, v44, v19, s52
v_mfma_f32_16x16x32_bf16 v[164:167], a[248:251], a[132:135], v[164:167]
ds_read_b32 a146, v61
v_perm_b32 v60, v44, v19, s53
v_mfma_f32_16x16x32_bf16 v[168:171], a[248:251], a[136:139], v[168:171]
ds_read_b32 a147, v60
v_perm_b32 v59, v40, v19, s54
v_mfma_f32_16x16x32_bf16 v[172:175], a[248:251], a[140:143], v[172:175]
s_waitcnt lgkmcnt(4)
ds_read_b32 a148, v59
buffer_load_dwordx4 v[80:83], v12, s[24:27], 0 offen offset:0 sc1
v_mfma_f32_16x16x32_bf16 v[176:179], a[252:255], a[128:131], v[176:179]
ds_read_b128 a[244:247], v16 offset:10240
v_perm_b32 v58, v40, v19, s55
v_mfma_f32_16x16x32_bf16 v[180:183], a[252:255], a[132:135], v[180:183]
ds_read_b32 a149, v58
v_perm_b32 v57, v44, v19, s54
v_mfma_f32_16x16x32_bf16 v[184:187], a[252:255], a[136:139], v[184:187]
s_add_u32 m0, s33, 77056
ds_read_b32 a150, v57
v_perm_b32 v56, v44, v19, s55
v_mfma_f32_16x16x32_bf16 v[188:191], a[252:255], a[140:143], v[188:191]
s_waitcnt lgkmcnt(4)
ds_read_b32 a151, v56
v_perm_b32 v63, v41, v19, s52
v_mfma_f32_16x16x32_bf16 v[192:195], a[240:243], a[128:131], v[192:195]
ds_read_b128 a[248:251], v16 offset:12288
buffer_load_dwordx4 v11, s[20:23], 0 offen offset:768 lds
v_mfma_f32_16x16x32_bf16 v[196:199], a[240:243], a[132:135], v[196:199]
ds_read_b32 a152, v63
v_perm_b32 v62, v41, v19, s53
v_mfma_f32_16x16x32_bf16 v[200:203], a[240:243], a[136:139], v[200:203]
ds_read_b32 a153, v62
v_perm_b32 v61, v45, v19, s52
v_mfma_f32_16x16x32_bf16 v[204:207], a[240:243], a[140:143], v[204:207]
s_waitcnt lgkmcnt(4)
ds_read_b32 a154, v61
buffer_load_dwordx4 v[84:87], v12, s[24:27], 0 offen offset:1024 sc1
v_mfma_f32_16x16x32_bf16 v[208:211], a[244:247], a[128:131], v[208:211]
ds_read_b128 a[252:255], v16 offset:14336
v_perm_b32 v60, v45, v19, s53
v_mfma_f32_16x16x32_bf16 v[212:215], a[244:247], a[132:135], v[212:215]
ds_read_b32 a155, v60
v_perm_b32 v59, v41, v19, s54
v_mfma_f32_16x16x32_bf16 v[216:219], a[244:247], a[136:139], v[216:219]
ds_read_b32 a156, v59
v_perm_b32 v58, v41, v19, s55
v_mfma_f32_16x16x32_bf16 v[220:223], a[244:247], a[140:143], v[220:223]
s_waitcnt lgkmcnt(4)
ds_read_b32 a157, v58
v_mfma_f32_16x16x32_bf16 v[224:227], a[248:251], a[128:131], v[224:227]
ds_read_b128 a[240:243], v17 offset:0
v_perm_b32 v57, v45, v19, s54
v_mfma_f32_16x16x32_bf16 v[228:231], a[248:251], a[132:135], v[228:231]
ds_read_b32 a158, v57
v_perm_b32 v56, v45, v19, s55
v_mfma_f32_16x16x32_bf16 v[232:235], a[248:251], a[136:139], v[232:235]
ds_read_b32 a159, v56
v_mfma_f32_16x16x32_bf16 v[236:239], a[248:251], a[140:143], v[236:239]
s_waitcnt lgkmcnt(4)
v_mfma_f32_16x16x32_bf16 v[240:243], a[252:255], a[128:131], v[240:243]
ds_read_b128 a[244:247], v17 offset:2048
v_mfma_f32_16x16x32_bf16 v[244:247], a[252:255], a[132:135], v[244:247]
v_mfma_f32_16x16x32_bf16 v[248:251], a[252:255], a[136:139], v[248:251]
s_add_u32 m0, s33, 81024
v_mfma_f32_16x16x32_bf16 v[252:255], a[252:255], a[140:143], v[252:255]
s_waitcnt vmcnt(8) lgkmcnt(1)
v_cmp_ne_u64 s[50:51], s[88:89], v[50:51]
v_cmp_ne_u64 s[44:45], s[88:89], v[54:55]
v_mfma_f32_16x16x32_bf16 v[128:131], a[240:243], a[144:147], v[128:131]
ds_read_b128 a[248:251], v17 offset:4096
buffer_load_dwordx4 v8, s[20:23], 0 offen offset:896 lds
v_mfma_f32_16x16x32_bf16 v[132:135], a[240:243], a[148:151], v[132:135]
s_or_b64 s[50:51], s[44:45], s[50:51]
v_mfma_f32_16x16x32_bf16 v[136:139], a[240:243], a[152:155], v[136:139]
s_cbranch_scc1 L_SLOW10
L_BACK10:
v_mfma_f32_16x16x32_bf16 v[140:143], a[240:243], a[156:159], v[140:143]
s_waitcnt lgkmcnt(1)
v_mfma_f32_16x16x32_bf16 v[144:147], a[244:247], a[144:147], v[144:147]
ds_read_b128 a[252:255], v17 offset:6144
v_mfma_f32_16x16x32_bf16 v[148:151], a[244:247], a[148:151], v[148:151]
v_perm_b32 v63, v48, v19, s52
v_mfma_f32_16x16x32_bf16 v[152:155], a[244:247], a[152:155], v[152:155]
s_add_u32 m0, s33, 85120
ds_read_b32 a160, v63
v_perm_b32 v62, v48, v19, s53
v_mfma_f32_16x16x32_bf16 v[156:159], a[244:247], a[156:159], v[156:159]
s_waitcnt lgkmcnt(2)
ds_read_b32 a161, v62
v_perm_b32 v61, v52, v19, s52
v_mfma_f32_16x16x32_bf16 v[160:163], a[248:251], a[144:147], v[160:163]
ds_read_b128 a[240:243], v17 offset:8192
buffer_load_dwordx4 v9, s[20:23], 0 offen offset:896 lds
v_mfma_f32_16x16x32_bf16 v[164:167], a[248:251], a[148:151], v[164:167]
ds_read_b32 a162, v61
v_perm_b32 v60, v52, v19, s53
v_mfma_f32_16x16x32_bf16 v[168:171], a[248:251], a[152:155], v[168:171]
ds_read_b32 a163, v60
v_perm_b32 v59, v48, v19, s54
v_mfma_f32_16x16x32_bf16 v[172:175], a[248:251], a[156:159], v[172:175]
s_waitcnt lgkmcnt(4)
ds_read_b32 a164, v59
buffer_load_dwordx4 v[88:91], v12, s[24:27], 0 offen offset:2048 sc1
v_mfma_f32_16x16x32_bf16 v[176:179], a[252:255], a[144:147], v[176:179]
s_barrier
ds_read_b128 a[244:247], v17 offset:10240
v_perm_b32 v58, v48, v19, s55
v_mfma_f32_16x16x32_bf16 v[180:183], a[252:255], a[148:151], v[180:183]
ds_read_b32 a165, v58
v_perm_b32 v57, v52, v19, s54
v_mfma_f32_16x16x32_bf16 v[184:187], a[252:255], a[152:155], v[184:187]
ds_read_b32 a166, v57
v_perm_b32 v56, v52, v19, s55
v_mfma_f32_16x16x32_bf16 v[188:191], a[252:255], a[156:159], v[188:191]
s_waitcnt lgkmcnt(4)
ds_read_b32 a167, v56
buffer_load_dwordx4 v[92:95], v12, s[24:27], 0 offen offset:3072 sc1
v_mfma_f32_16x16x32_bf16 v[192:195], a[240:243], a[144:147], v[192:195]
ds_read_b128 a[248:251], v17 offset:12288
v_perm_b32 v63, v49, v19, s52
v_mfma_f32_16x16x32_bf16 v[196:199], a[240:243], a[148:151], v[196:199]
ds_read_b32 a168, v63
v_perm_b32 v62, v49, v19, s53
v_mfma_f32_16x16x32_bf16 v[200:203], a[240:243], a[152:155], v[200:203]
ds_read_b32 a169, v62
v_perm_b32 v61, v53, v19, s52
v_mfma_f32_16x16x32_bf16 v[204:207], a[240:243], a[156:159], v[204:207]
s_waitcnt lgkmcnt(4)
ds_read_b32 a170, v61
v_add_u32 v12, 28672, v13
v_mfma_f32_16x16x32_bf16 v[208:211], a[244:247], a[144:147], v[208:211]
ds_read_b128 a[252:255], v17 offset:14336
v_perm_b32 v60, v53, v19, s53
v_mfma_f32_16x16x32_bf16 v[212:215], a[244:247], a[148:151], v[212:215]
ds_read_b32 a171, v60
v_perm_b32 v59, v49, v19, s54
v_mfma_f32_16x16x32_bf16 v[216:219], a[244:247], a[152:155], v[216:219]
s_add_u32 m0, s33, 89216
ds_read_b32 a172, v59
v_perm_b32 v58, v49, v19, s55
v_mfma_f32_16x16x32_bf16 v[220:223], a[244:247], a[156:159], v[220:223]
s_waitcnt lgkmcnt(4)
ds_read_b32 a173, v58
v_perm_b32 v57, v53, v19, s54
v_mfma_f32_16x16x32_bf16 v[224:227], a[248:251], a[144:147], v[224:227]
ds_read_b128 a[240:243], v16 offset:16384
buffer_load_dwordx4 v10, s[20:23], 0 offen offset:896 lds
v_mfma_f32_16x16x32_bf16 v[228:231], a[248:251], a[148:151], v[228:231]
ds_read_b32 a174, v57
v_perm_b32 v56, v53, v19, s55
v_mfma_f32_16x16x32_bf16 v[232:235], a[248:251], a[152:155], v[232:235]
ds_read_b32 a175, v56
v_mfma_f32_16x16x32_bf16 v[236:239], a[248:251], a[156:159], v[236:239]
s_waitcnt lgkmcnt(4)
v_mfma_f32_16x16x32_bf16 v[240:243], a[252:255], a[144:147], v[240:243]
ds_read_b128 a[244:247], v16 offset:18432
v_mfma_f32_16x16x32_bf16 v[244:247], a[252:255], a[148:151], v[244:247]
v_mfma_f32_16x16x32_bf16 v[248:251], a[252:255], a[152:155], v[248:251]
s_waitcnt vmcnt(10)
v_cmp_ne_u64 s[50:51], s[88:89], v[98:99]
v_cmp_ne_u64 s[44:45], s[88:89], v[102:103]
v_mfma_f32_16x16x32_bf16 v[252:255], a[252:255], a[156:159], v[252:255]
s_waitcnt lgkmcnt(1)
v_mfma_f32_16x16x32_bf16 v[128:131], a[240:243], a[160:163], v[128:131]
s_or_b64 s[50:51], s[44:45], s[50:51]
ds_read_b128 a[248:251], v16 offset:20480
v_mfma_f32_16x16x32_bf16 v[132:135], a[240:243], a[164:167], v[132:135]
s_cbranch_scc1 L_SLOW11
L_BACK11:
v_mfma_f32_16x16x32_bf16 v[136:139], a[240:243], a[168:171], v[136:139]
s_add_u32 m0, s33, 93312
v_mfma_f32_16x16x32_bf16 v[140:143], a[240:243], a[172:175], v[140:143]
s_waitcnt lgkmcnt(1)
v_mfma_f32_16x16x32_bf16 v[144:147], a[244:247], a[160:163], v[144:147]
ds_read_b128 a[252:255], v16 offset:22528
buffer_load_dwordx4 v11, s[20:23], 0 offen offset:896 lds
v_mfma_f32_16x16x32_bf16 v[148:151], a[244:247], a[164:167], v[148:151]
v_perm_b32 v63, v96, v19, s52
v_mfma_f32_16x16x32_bf16 v[152:155], a[244:247], a[168:171], v[152:155]
ds_read_b32 a176, v63
v_perm_b32 v62, v96, v19, s53
v_mfma_f32_16x16x32_bf16 v[156:159], a[244:247], a[172:175], v[156:159]
s_waitcnt lgkmcnt(2)
ds_read_b32 a177, v62
buffer_load_dwordx4 v[32:35], v12, s[24:27], 0 offen offset:0 sc1
v_mfma_f32_16x16x32_bf16 v[160:163], a[248:251], a[160:163], v[160:163]
ds_read_b128 a[240:243], v16 offset:24576
v_perm_b32 v61, v100, v19, s52
v_mfma_f32_16x16x32_bf16 v[164:167], a[248:251], a[164:167], v[164:167]
ds_read_b32 a178, v61
v_perm_b32 v60, v100, v19, s53
v_mfma_f32_16x16x32_bf16 v[168:171], a[248:251], a[168:171], v[168:171]
ds_read_b32 a179, v60
v_perm_b32 v59, v96, v19, s54
v_mfma_f32_16x16x32_bf16 v[172:175], a[248:251], a[172:175], v[172:175]
s_waitcnt lgkmcnt(4)
ds_read_b32 a180, v59
buffer_load_dwordx4 v[36:39], v12, s[24:27], 0 offen offset:1024 sc1
v_mfma_f32_16x16x32_bf16 v[176:179], a[252:255], a[160:163], v[176:179]
ds_read_b128 a[244:247], v16 offset:26624
v_perm_b32 v58, v96, v19, s55
v_mfma_f32_16x16x32_bf16 v[180:183], a[252:255], a[164:167], v[180:183]
ds_read_b32 a181, v58
v_perm_b32 v57, v100, v19, s54
v_mfma_f32_16x16x32_bf16 v[184:187], a[252:255], a[168:171], v[184:187]
s_add_u32 m0, s33, 97280
ds_read_b32 a182, v57
v_perm_b32 v56, v100, v19, s55
v_mfma_f32_16x16x32_bf16 v[188:191], a[252:255], a[172:175], v[188:191]
s_waitcnt lgkmcnt(4)
ds_read_b32 a183, v56
v_perm_b32 v63, v97, v19, s52
v_mfma_f32_16x16x32_bf16 v[192:195], a[240:243], a[160:163], v[192:195]
ds_read_b128 a[248:251], v16 offset:28672
buffer_load_dwordx4 v8, s[20:23], 0 offen offset:1024 lds
v_mfma_f32_16x16x32_bf16 v[196:199], a[240:243], a[164:167], v[196:199]
ds_read_b32 a184, v63
v_perm_b32 v62, v97, v19, s53
v_mfma_f32_16x16x32_bf16 v[200:203], a[240:243], a[168:171], v[200:203]
ds_read_b32 a185, v62
v_perm_b32 v61, v101, v19, s52
v_mfma_f32_16x16x32_bf16 v[204:207], a[240:243], a[172:175], v[204:207]
L_PAD2:
s_cbranch_vccnz L_PADRET
s_waitcnt lgkmcnt(4)
ds_read_b32 a186, v61
v_mfma_f32_16x16x32_bf16 v[208:211], a[244:247], a[160:163], v[208:211]
ds_read_b128 a[252:255], v16 offset:30720
v_perm_b32 v60, v101, v19, s53
v_mfma_f32_16x16x32_bf16 v[212:215], a[244:247], a[164:167], v[212:215]
ds_read_b32 a187, v60
v_perm_b32 v59, v97, v19, s54
v_mfma_f32_16x16x32_bf16 v[216:219], a[244:247], a[168:171], v[216:219]
ds_read_b32 a188, v59
v_perm_b32 v58, v97, v19, s55
v_mfma_f32_16x16x32_bf16 v[220:223], a[244:247], a[172:175], v[220:223]
s_waitcnt lgkmcnt(4)
ds_read_b32 a189, v58
v_mfma_f32_16x16x32_bf16 v[224:227], a[248:251], a[160:163], v[224:227]
ds_read_b128 a[240:243], v17 offset:16384
v_perm_b32 v57, v101, v19, s54
v_mfma_f32_16x16x32_bf16 v[228:231], a[248:251], a[164:167], v[228:231]
ds_read_b32 a190, v57
v_perm_b32 v56, v101, v19, s55
v_mfma_f32_16x16x32_bf16 v[232:235], a[248:251], a[168:171], v[232:235]
ds_read_b32 a191, v56
v_mfma_f32_16x16x32_bf16 v[236:239], a[248:251], a[172:175], v[236:239]
s_waitcnt lgkmcnt(4)
v_mfma_f32_16x16x32_bf16 v[240:243], a[252:255], a[160:163], v[240:243]
ds_read_b128 a[244:247], v17 offset:18432
v_mfma_f32_16x16x32_bf16 v[244:247], a[252:255], a[164:167], v[244:247]
v_mfma_f32_16x16x32_bf16 v[248:251], a[252:255], a[168:171], v[248:251]
v_mfma_f32_16x16x32_bf16 v[252:255], a[252:255], a[172:175], v[252:255]
s_waitcnt vmcnt(9) lgkmcnt(1)
v_cmp_ne_u64 s[50:51], s[88:89], v[82:83]
v_cmp_ne_u64 s[44:45], s[88:89], v[86:87]
v_mfma_f32_16x16x32_bf16 v[128:131], a[240:243], a[176:179], v[128:131]
ds_read_b128 a[248:251], v17 offset:20480
v_mfma_f32_16x16x32_bf16 v[132:135], a[240:243], a[180:183], v[132:135]
s_or_b64 s[50:51], s[44:45], s[50:51]
v_mfma_f32_16x16x32_bf16 v[136:139], a[240:243], a[184:187], v[136:139]
s_cbranch_scc1 L_SLOW12
L_BACK12:
v_mfma_f32_16x16x32_bf16 v[140:143], a[240:243], a[188:191], v[140:143]
s_waitcnt lgkmcnt(1)
buffer_load_dwordx4 v[40:43], v12, s[24:27], 0 offen offset:2048 sc1
v_mfma_f32_16x16x32_bf16 v[144:147], a[244:247], a[176:179], v[144:147]
ds_read_b128 a[252:255], v17 offset:22528
buffer_load_dwordx4 v[44:47], v12, s[24:27], 0 offen offset:3072 sc1
v_mfma_f32_16x16x32_bf16 v[148:151], a[244:247], a[180:183], v[148:151]
v_perm_b32 v63, v80, v19, s52
v_add_u32 v12, 32768, v13
v_mfma_f32_16x16x32_bf16 v[152:155], a[244:247], a[184:187], v[152:155]
s_add_u32 m0, s33, 101376
ds_read_b32 a192, v63
v_perm_b32 v62, v80, v19, s53
v_mfma_f32_16x16x32_bf16 v[156:159], a[244:247], a[188:191], v[156:159]
s_waitcnt lgkmcnt(2)
ds_read_b32 a193, v62
v_perm_b32 v61, v84, v19, s52
v_mfma_f32_16x16x32_bf16 v[160:163], a[248:251], a[176:179], v[160:163]
ds_read_b128 a[240:243], v17 offset:24576
buffer_load_dwordx4 v9, s[20:23], 0 offen offset:1024 lds
v_mfma_f32_16x16x32_bf16 v[164:167], a[248:251], a[180:183], v[164:167]
ds_read_b32 a194, v61
v_perm_b32 v60, v84, v19, s53
v_mfma_f32_16x16x32_bf16 v[168:171], a[248:251], a[184:187], v[168:171]
ds_read_b32 a195, v60
v_perm_b32 v59, v80, v19, s54
v_mfma_f32_16x16x32_bf16 v[172:175], a[248:251], a[188:191], v[172:175]
s_waitcnt lgkmcnt(4)
ds_read_b32 a196, v59
v_mfma_f32_16x16x32_bf16 v[176:179], a[252:255], a[176:179], v[176:179]
s_barrier
ds_read_b128 a[244:247], v17 offset:26624
v_perm_b32 v58, v80, v19, s55
v_mfma_f32_16x16x32_bf16 v[180:183], a[252:255], a[180:183], v[180:183]
ds_read_b32 a197, v58
v_perm_b32 v57, v84, v19, s54
v_mfma_f32_16x16x32_bf16 v[184:187], a[252:255], a[184:187], v[184:187]
ds_read_b32 a198, v57
v_perm_b32 v56, v84, v19, s55
v_mfma_f32_16x16x32_bf16 v[188:191], a[252:255], a[188:191], v[188:191]
s_waitcnt lgkmcnt(4)
ds_read_b32 a199, v56
v_mfma_f32_16x16x32_bf16 v[192:195], a[240:243], a[176:179], v[192:195]
ds_read_b128 a[248:251], v17 offset:28672
v_perm_b32 v63, v81, v19, s52
v_mfma_f32_16x16x32_bf16 v[196:199], a[240:243], a[180:183], v[196:199]
ds_read_b32 a200, v63
v_perm_b32 v62, v81, v19, s53
v_mfma_f32_16x16x32_bf16 v[200:203], a[240:243], a[184:187], v[200:203]
ds_read_b32 a201, v62
v_perm_b32 v61, v85, v19, s52
v_mfma_f32_16x16x32_bf16 v[204:207], a[240:243], a[188:191], v[204:207]
s_waitcnt lgkmcnt(4)
ds_read_b32 a202, v61
v_mfma_f32_16x16x32_bf16 v[208:211], a[244:247], a[176:179], v[208:211]
ds_read_b128 a[252:255], v17 offset:30720
v_perm_b32 v60, v85, v19, s53
v_mfma_f32_16x16x32_bf16 v[212:215], a[244:247], a[180:183], v[212:215]
ds_read_b32 a203, v60
v_perm_b32 v59, v81, v19, s54
v_mfma_f32_16x16x32_bf16 v[216:219], a[244:247], a[184:187], v[216:219]
s_add_u32 m0, s33, 105472
ds_read_b32 a204, v59
v_perm_b32 v58, v81, v19, s55
v_mfma_f32_16x16x32_bf16 v[220:223], a[244:247], a[188:191], v[220:223]
s_waitcnt lgkmcnt(4)
ds_read_b32 a205, v58
v_perm_b32 v57, v85, v19, s54
v_mfma_f32_16x16x32_bf16 v[224:227], a[248:251], a[176:179], v[224:227]
ds_read_b128 a[240:243], v14 offset:0
buffer_load_dwordx4 v10, s[20:23], 0 offen offset:1024 lds
v_mfma_f32_16x16x32_bf16 v[228:231], a[248:251], a[180:183], v[228:231]
ds_read_b32 a206, v57
v_perm_b32 v56, v85, v19, s55
v_mfma_f32_16x16x32_bf16 v[232:235], a[248:251], a[184:187], v[232:235]
ds_read_b32 a207, v56
v_mfma_f32_16x16x32_bf16 v[236:239], a[248:251], a[188:191], v[236:239]
s_waitcnt lgkmcnt(4)
buffer_load_dwordx4 v[48:51], v12, s[24:27], 0 offen offset:0 sc1
v_mfma_f32_16x16x32_bf16 v[240:243], a[252:255], a[176:179], v[240:243]
ds_read_b128 a[244:247], v14 offset:2048
buffer_load_dwordx4 v[52:55], v12, s[24:27], 0 offen offset:1024 sc1
v_mfma_f32_16x16x32_bf16 v[244:247], a[252:255], a[180:183], v[244:247]
v_mfma_f32_16x16x32_bf16 v[248:251], a[252:255], a[184:187], v[248:251]
s_waitcnt vmcnt(11)
v_cmp_ne_u64 s[50:51], s[88:89], v[90:91]
v_cmp_ne_u64 s[44:45], s[88:89], v[94:95]
v_mfma_f32_16x16x32_bf16 v[252:255], a[252:255], a[188:191], v[252:255]
s_waitcnt lgkmcnt(1)
v_mfma_f32_16x16x32_bf16 v[128:131], a[240:243], a[192:195], v[128:131]
s_or_b64 s[50:51], s[44:45], s[50:51]
ds_read_b128 a[248:251], v14 offset:4096
v_mfma_f32_16x16x32_bf16 v[132:135], a[240:243], a[196:199], v[132:135]
s_cbranch_scc1 L_SLOW13
L_BACK13:
v_mfma_f32_16x16x32_bf16 v[136:139], a[240:243], a[200:203], v[136:139]
s_add_u32 m0, s33, 109440
v_mfma_f32_16x16x32_bf16 v[140:143], a[240:243], a[204:207], v[140:143]
s_waitcnt lgkmcnt(1)
v_mfma_f32_16x16x32_bf16 v[144:147], a[244:247], a[192:195], v[144:147]
ds_read_b128 a[252:255], v14 offset:6144
buffer_load_dwordx4 v8, s[20:23], 0 offen offset:1152 lds
v_mfma_f32_16x16x32_bf16 v[148:151], a[244:247], a[196:199], v[148:151]
v_perm_b32 v63, v88, v19, s52
v_mfma_f32_16x16x32_bf16 v[152:155], a[244:247], a[200:203], v[152:155]
ds_read_b32 a208, v63
v_perm_b32 v62, v88, v19, s53
v_mfma_f32_16x16x32_bf16 v[156:159], a[244:247], a[204:207], v[156:159]
s_waitcnt lgkmcnt(2)
ds_read_b32 a209, v62
v_mfma_f32_16x16x32_bf16 v[160:163], a[248:251], a[192:195], v[160:163]
ds_read_b128 a[240:243], v14 offset:8192
v_perm_b32 v61, v92, v19, s52
v_mfma_f32_16x16x32_bf16 v[164:167], a[248:251], a[196:199], v[164:167]
ds_read_b32 a210, v61
v_perm_b32 v60, v92, v19, s53
v_mfma_f32_16x16x32_bf16 v[168:171], a[248:251], a[200:203], v[168:171]
ds_read_b32 a211, v60
v_perm_b32 v59, v88, v19, s54
v_mfma_f32_16x16x32_bf16 v[172:175], a[248:251], a[204:207], v[172:175]
s_waitcnt lgkmcnt(4)
ds_read_b32 a212, v59
v_mfma_f32_16x16x32_bf16 v[176:179], a[252:255], a[192:195], v[176:179]
ds_read_b128 a[244:247], v14 offset:10240
v_perm_b32 v58, v88, v19, s55
v_mfma_f32_16x16x32_bf16 v[180:183], a[252:255], a[196:199], v[180:183]
ds_read_b32 a213, v58
v_perm_b32 v57, v92, v19, s54
v_mfma_f32_16x16x32_bf16 v[184:187], a[252:255], a[200:203], v[184:187]
s_add_u32 m0, s33, 113664
ds_read_b32 a214, v57
v_perm_b32 v56, v92, v19, s55
v_mfma_f32_16x16x32_bf16 v[188:191], a[252:255], a[204:207], v[188:191]
s_waitcnt lgkmcnt(4)
ds_read_b32 a215, v56
v_perm_b32 v63, v89, v19, s52
v_mfma_f32_16x16x32_bf16 v[192:195], a[240:243], a[192:195], v[192:195]
ds_read_b128 a[248:251], v14 offset:12288
buffer_load_dwordx4 v11, s[20:23], 0 offen offset:1024 lds
v_mfma_f32_16x16x32_bf16 v[196:199], a[240:243], a[196:199], v[196:199]
ds_read_b32 a216, v63
v_perm_b32 v62, v89, v19, s53
v_mfma_f32_16x16x32_bf16 v[200:203], a[240:243], a[200:203], v[200:203]
ds_read_b32 a217, v62
v_perm_b32 v61, v93, v19, s52
v_mfma_f32_16x16x32_bf16 v[204:207], a[240:243], a[204:207], v[204:207]
s_waitcnt lgkmcnt(4)
ds_read_b32 a218, v61
buffer_load_dwordx4 v[96:99], v12, s[24:27], 0 offen offset:2048 sc1
v_mfma_f32_16x16x32_bf16 v[208:211], a[244:247], a[192:195], v[208:211]
ds_read_b128 a[252:255], v14 offset:14336
v_perm_b32 v60, v93, v19, s53
v_mfma_f32_16x16x32_bf16 v[212:215], a[244:247], a[196:199], v[212:215]
ds_read_b32 a219, v60
v_perm_b32 v59, v89, v19, s54
v_mfma_f32_16x16x32_bf16 v[216:219], a[244:247], a[200:203], v[216:219]
ds_read_b32 a220, v59
v_perm_b32 v58, v89, v19, s55
v_mfma_f32_16x16x32_bf16 v[220:223], a[244:247], a[204:207], v[220:223]
s_waitcnt lgkmcnt(4)
ds_read_b32 a221, v58
buffer_load_dwordx4 v[100:103], v12, s[24:27], 0 offen offset:3072 sc1
v_mfma_f32_16x16x32_bf16 v[224:227], a[248:251], a[192:195], v[224:227]
ds_read_b128 a[240:243], v15 offset:0
v_perm_b32 v57, v93, v19, s54
v_mfma_f32_16x16x32_bf16 v[228:231], a[248:251], a[196:199], v[228:231]
ds_read_b32 a222, v57
v_perm_b32 v56, v93, v19, s55
v_mfma_f32_16x16x32_bf16 v[232:235], a[248:251], a[200:203], v[232:235]
ds_read_b32 a223, v56
v_add_u32 v12, 36864, v13
v_mfma_f32_16x16x32_bf16 v[236:239], a[248:251], a[204:207], v[236:239]
s_waitcnt vmcnt(11) lgkmcnt(4)
v_cmp_ne_u64 s[50:51], s[88:89], v[34:35]
v_cmp_ne_u64 s[44:45], s[88:89], v[38:39]
v_mfma_f32_16x16x32_bf16 v[240:243], a[252:255], a[192:195], v[240:243]
ds_read_b128 a[244:247], v15 offset:2048
v_mfma_f32_16x16x32_bf16 v[244:247], a[252:255], a[196:199], v[244:247]
s_or_b64 s[50:51], s[44:45], s[50:51]
v_mfma_f32_16x16x32_bf16 v[248:251], a[252:255], a[200:203], v[248:251]
s_cbranch_scc1 L_SLOW14
L_BACK14:
v_mfma_f32_16x16x32_bf16 v[252:255], a[252:255], a[204:207], v[252:255]
s_waitcnt lgkmcnt(1)
v_mfma_f32_16x16x32_bf16 v[128:131], a[240:243], a[208:211], v[128:131]
ds_read_b128 a[248:251], v15 offset:4096
v_perm_b32 v63, v32, v19, s52
v_mfma_f32_16x16x32_bf16 v[132:135], a[240:243], a[212:215], v[132:135]
ds_read_b32 a224, v63
v_perm_b32 v62, v32, v19, s53
v_mfma_f32_16x16x32_bf16 v[136:139], a[240:243], a[216:219], v[136:139]
ds_read_b32 a225, v62
v_perm_b32 v61, v36, v19, s52
v_mfma_f32_16x16x32_bf16 v[140:143], a[240:243], a[220:223], v[140:143]
s_waitcnt lgkmcnt(3)
ds_read_b32 a226, v61
v_mfma_f32_16x16x32_bf16 v[144:147], a[244:247], a[208:211], v[144:147]
ds_read_b128 a[252:255], v15 offset:6144
v_perm_b32 v60, v36, v19, s53
v_mfma_f32_16x16x32_bf16 v[148:151], a[244:247], a[212:215], v[148:151]
ds_read_b32 a227, v60
v_perm_b32 v59, v32, v19, s54
v_mfma_f32_16x16x32_bf16 v[152:155], a[244:247], a[216:219], v[152:155]
s_add_u32 m0, s33, 117632
ds_read_b32 a228, v59
v_perm_b32 v58, v32, v19, s55
v_mfma_f32_16x16x32_bf16 v[156:159], a[244:247], a[220:223], v[156:159]
s_waitcnt lgkmcnt(4)
ds_read_b32 a229, v58
v_perm_b32 v57, v36, v19, s54
v_mfma_f32_16x16x32_bf16 v[160:163], a[248:251], a[208:211], v[160:163]
ds_read_b128 a[240:243], v15 offset:8192
buffer_load_dwordx4 v9, s[20:23], 0 offen offset:1152 lds
v_mfma_f32_16x16x32_bf16 v[164:167], a[248:251], a[212:215], v[164:167]
ds_read_b32 a230, v57
v_perm_b32 v56, v36, v19, s55
v_mfma_f32_16x16x32_bf16 v[168:171], a[248:251], a[216:219], v[168:171]
ds_read_b32 a231, v56
v_perm_b32 v63, v33, v19, s52
v_mfma_f32_16x16x32_bf16 v[172:175], a[248:251], a[220:223], v[172:175]
s_waitcnt lgkmcnt(4)
ds_read_b32 a232, v63
v_mfma_f32_16x16x32_bf16 v[176:179], a[252:255], a[208:211], v[176:179]
s_waitcnt vmcnt(11)
s_barrier
ds_read_b128 a[244:247], v15 offset:10240
v_perm_b32 v62, v33, v19, s53
v_mfma_f32_16x16x32_bf16 v[180:183], a[252:255], a[212:215], v[180:183]
ds_read_b32 a233, v62
v_perm_b32 v61, v37, v19, s52
v_mfma_f32_16x16x32_bf16 v[184:187], a[252:255], a[216:219], v[184:187]
ds_read_b32 a234, v61
v_perm_b32 v60, v37, v19, s53
v_mfma_f32_16x16x32_bf16 v[188:191], a[252:255], a[220:223], v[188:191]
s_waitcnt lgkmcnt(4)
ds_read_b32 a235, v60
buffer_load_dwordx4 v[80:83], v12, s[24:27], 0 offen offset:0 sc1
v_mfma_f32_16x16x32_bf16 v[192:195], a[240:243], a[208:211], v[192:195]
ds_read_b128 a[248:251], v15 offset:12288
v_perm_b32 v59, v33, v19, s54
v_mfma_f32_16x16x32_bf16 v[196:199], a[240:243], a[212:215], v[196:199]
ds_read_b32 a236, v59
v_perm_b32 v58, v33, v19, s55
v_mfma_f32_16x16x32_bf16 v[200:203], a[240:243], a[216:219], v[200:203]
ds_read_b32 a237, v58
v_perm_b32 v57, v37, v19, s54
v_mfma_f32_16x16x32_bf16 v[204:207], a[240:243], a[220:223], v[204:207]
s_waitcnt lgkmcnt(4)
ds_read_b32 a238, v57
buffer_load_dwordx4 v[84:87], v12, s[24:27], 0 offen offset:1024 sc1
v_mfma_f32_16x16x32_bf16 v[208:211], a[244:247], a[208:211], v[208:211]
ds_read_b128 a[252:255], v14 offset:16384
v_perm_b32 v56, v37, v19, s55
v_mfma_f32_16x16x32_bf16 v[212:215], a[244:247], a[212:215], v[212:215]
ds_read_b32 a239, v56
v_mfma_f32_16x16x32_bf16 v[216:219], a[244:247], a[216:219], v[216:219]
s_waitcnt vmcnt(11)
s_add_u32 m0, s33, 121728
v_cmp_ne_u64 s[50:51], s[88:89], v[42:43]
v_cmp_ne_u64 s[44:45], s[88:89], v[46:47]
v_mfma_f32_16x16x32_bf16 v[220:223], a[244:247], a[220:223], v[220:223]
s_waitcnt lgkmcnt(3)
v_mfma_f32_16x16x32_bf16 v[224:227], a[248:251], a[208:211], v[224:227]
s_or_b64 s[50:51], s[44:45], s[50:51]
ds_read_b128 a[240:243], v14 offset:18432
buffer_load_dwordx4 v10, s[20:23], 0 offen offset:1152 lds
v_mfma_f32_16x16x32_bf16 v[228:231], a[248:251], a[212:215], v[228:231]
s_cbranch_scc1 L_SLOW15
L_BACK15:
v_mfma_f32_16x16x32_bf16 v[232:235], a[248:251], a[216:219], v[232:235]
v_perm_b32 v63, v40, v19, s52
v_mfma_f32_16x16x32_bf16 v[236:239], a[248:251], a[220:223], v[236:239]
s_waitcnt lgkmcnt(1)
ds_read_b32 a0, v63
v_mfma_f32_16x16x32_bf16 v[128:131], a[252:255], a[224:227], v[128:131]
ds_read_b128 a[244:247], v14 offset:20480
v_perm_b32 v62, v40, v19, s53
v_mfma_f32_16x16x32_bf16 v[132:135], a[252:255], a[228:231], v[132:135]
ds_read_b32 a1, v62
v_perm_b32 v61, v44, v19, s52
v_mfma_f32_16x16x32_bf16 v[136:139], a[252:255], a[232:235], v[136:139]
ds_read_b32 a2, v61
v_perm_b32 v60, v44, v19, s53
v_mfma_f32_16x16x32_bf16 v[140:143], a[252:255], a[236:239], v[140:143]
s_waitcnt lgkmcnt(4)
ds_read_b32 a3, v60
v_mfma_f32_16x16x32_bf16 v[144:147], a[240:243], a[224:227], v[144:147]
ds_read_b128 a[248:251], v14 offset:22528
v_perm_b32 v59, v40, v19, s54
v_mfma_f32_16x16x32_bf16 v[148:151], a[240:243], a[228:231], v[148:151]
ds_read_b32 a4, v59
v_perm_b32 v58, v40, v19, s55
v_mfma_f32_16x16x32_bf16 v[152:155], a[240:243], a[232:235], v[152:155]
s_add_u32 m0, s33, 125696
ds_read_b32 a5, v58
v_perm_b32 v57, v44, v19, s54
v_mfma_f32_16x16x32_bf16 v[156:159], a[240:243], a[236:239], v[156:159]
s_waitcnt lgkmcnt(4)
ds_read_b32 a6, v57
v_perm_b32 v56, v44, v19, s55
v_mfma_f32_16x16x32_bf16 v[160:163], a[244:247], a[224:227], v[160:163]
ds_read_b128 a[252:255], v14 offset:24576
buffer_load_dwordx4 v8, s[20:23], 0 offen offset:1280 lds
v_mfma_f32_16x16x32_bf16 v[164:167], a[244:247], a[228:231], v[164:167]
ds_read_b32 a7, v56
v_perm_b32 v63, v41, v19, s52
v_mfma_f32_16x16x32_bf16 v[168:171], a[244:247], a[232:235], v[168:171]
ds_read_b32 a8, v63
v_perm_b32 v62, v41, v19, s53
v_mfma_f32_16x16x32_bf16 v[172:175], a[244:247], a[236:239], v[172:175]
s_waitcnt lgkmcnt(4)
ds_read_b32 a9, v62
v_mfma_f32_16x16x32_bf16 v[176:179], a[248:251], a[224:227], v[176:179]
ds_read_b128 a[240:243], v15 offset:14336
v_perm_b32 v61, v45, v19, s52
v_mfma_f32_16x16x32_bf16 v[180:183], a[248:251], a[228:231], v[180:183]
ds_read_b32 a10, v61
v_perm_b32 v60, v45, v19, s53
v_mfma_f32_16x16x32_bf16 v[184:187], a[248:251], a[232:235], v[184:187]
ds_read_b32 a11, v60
v_perm_b32 v59, v41, v19, s54
v_mfma_f32_16x16x32_bf16 v[188:191], a[248:251], a[236:239], v[188:191]
s_waitcnt lgkmcnt(4)
ds_read_b32 a12, v59
buffer_load_dwordx4 v[88:91], v12, s[24:27], 0 offen offset:2048 sc1
v_mfma_f32_16x16x32_bf16 v[192:195], a[252:255], a[224:227], v[192:195]
ds_read_b128 a[244:247], v14 offset:26624
v_perm_b32 v58, v41, v19, s55
v_mfma_f32_16x16x32_bf16 v[196:199], a[252:255], a[228:231], v[196:199]
ds_read_b32 a13, v58
v_perm_b32 v57, v45, v19, s54
v_mfma_f32_16x16x32_bf16 v[200:203], a[252:255], a[232:235], v[200:203]
s_add_u32 m0, s33, 129792
ds_read_b32 a14, v57
v_perm_b32 v56, v45, v19, s55
v_mfma_f32_16x16x32_bf16 v[204:207], a[252:255], a[236:239], v[204:207]
s_waitcnt vmcnt(10) lgkmcnt(4)
v_cmp_ne_u64 s[50:51], s[88:89], v[50:51]
v_cmp_ne_u64 s[44:45], s[88:89], v[54:55]
v_mfma_f32_16x16x32_bf16 v[240:243], a[240:243], a[208:211], v[240:243]
ds_read_b128 a[248:251], v15 offset:16384
buffer_load_dwordx4 v9, s[20:23], 0 offen offset:1280 lds
v_mfma_f32_16x16x32_bf16 v[244:247], a[240:243], a[212:215], v[244:247]
s_or_b64 s[50:51], s[44:45], s[50:51]
ds_read_b32 a15, v56
buffer_load_dwordx4 v[92:95], v12, s[24:27], 0 offen offset:3072 sc1
v_mfma_f32_16x16x32_bf16 v[248:251], a[240:243], a[216:219], v[248:251]
s_cbranch_scc1 L_SLOW16
L_BACK16:
v_mfma_f32_16x16x32_bf16 v[252:255], a[240:243], a[220:223], v[252:255]
s_waitcnt lgkmcnt(2)
v_add_u32 v12, 40960, v13
v_mfma_f32_16x16x32_bf16 v[208:211], a[244:247], a[224:227], v[208:211]
ds_read_b128 a[252:255], v14 offset:28672
v_perm_b32 v63, v48, v19, s52
v_mfma_f32_16x16x32_bf16 v[212:215], a[244:247], a[228:231], v[212:215]
ds_read_b32 a16, v63
v_perm_b32 v62, v48, v19, s53
v_mfma_f32_16x16x32_bf16 v[216:219], a[244:247], a[232:235], v[216:219]
ds_read_b32 a17, v62
v_perm_b32 v61, v52, v19, s52
v_mfma_f32_16x16x32_bf16 v[220:223], a[244:247], a[236:239], v[220:223]
s_waitcnt lgkmcnt(3)
ds_read_b32 a18, v61
v_mfma_f32_16x16x32_bf16 v[128:131], a[248:251], a[0:3], v[128:131]
ds_read_b128 a[240:243], v15 offset:18432
v_perm_b32 v60, v52, v19, s53
v_mfma_f32_16x16x32_bf16 v[132:135], a[248:251], a[4:7], v[132:135]
ds_read_b32 a19, v60
v_perm_b32 v59, v48, v19, s54
v_mfma_f32_16x16x32_bf16 v[136:139], a[248:251], a[8:11], v[136:139]
ds_read_b32 a20, v59
v_perm_b32 v58, v48, v19, s55
v_mfma_f32_16x16x32_bf16 v[140:143], a[248:251], a[12:15], v[140:143]
s_waitcnt lgkmcnt(4)
ds_read_b32 a21, v58
v_mfma_f32_16x16x32_bf16 v[224:227], a[252:255], a[224:227], v[224:227]
ds_read_b128 a[244:247], v15 offset:20480
v_perm_b32 v57, v52, v19, s54
v_mfma_f32_16x16x32_bf16 v[228:231], a[252:255], a[228:231], v[228:231]
ds_read_b32 a22, v57
v_perm_b32 v56, v52, v19, s55
v_mfma_f32_16x16x32_bf16 v[232:235], a[252:255], a[232:235], v[232:235]
ds_read_b32 a23, v56
v_perm_b32 v63, v49, v19, s52
v_mfma_f32_16x16x32_bf16 v[236:239], a[252:255], a[236:239], v[236:239]
s_waitcnt lgkmcnt(4)
ds_read_b32 a24, v63
v_mfma_f32_16x16x32_bf16 v[144:147], a[240:243], a[0:3], v[144:147]
ds_read_b128 a[248:251], v15 offset:22528
v_perm_b32 v62, v49, v19, s53
v_mfma_f32_16x16x32_bf16 v[148:151], a[240:243], a[4:7], v[148:151]
ds_read_b32 a25, v62
v_perm_b32 v61, v53, v19, s52
v_mfma_f32_16x16x32_bf16 v[152:155], a[240:243], a[8:11], v[152:155]
ds_read_b32 a26, v61
v_perm_b32 v60, v53, v19, s53
v_mfma_f32_16x16x32_bf16 v[156:159], a[240:243], a[12:15], v[156:159]
s_waitcnt lgkmcnt(4)
ds_read_b32 a27, v60
buffer_load_dwordx4 v[32:35], v12, s[24:27], 0 offen offset:0 sc1
v_mfma_f32_16x16x32_bf16 v[160:163], a[244:247], a[0:3], v[160:163]
ds_read_b128 a[252:255], v15 offset:24576
v_perm_b32 v59, v49, v19, s54
v_mfma_f32_16x16x32_bf16 v[164:167], a[244:247], a[4:7], v[164:167]
ds_read_b32 a28, v59
v_perm_b32 v58, v49, v19, s55
v_mfma_f32_16x16x32_bf16 v[168:171], a[244:247], a[8:11], v[168:171]
s_add_u32 m0, s33, 134016
ds_read_b32 a29, v58
v_perm_b32 v57, v53, v19, s54
v_mfma_f32_16x16x32_bf16 v[172:175], a[244:247], a[12:15], v[172:175]
s_waitcnt vmcnt(9) lgkmcnt(4)
v_cmp_ne_u64 s[50:51], s[88:89], v[98:99]
v_cmp_ne_u64 s[44:45], s[88:89], v[102:103]
v_mfma_f32_16x16x32_bf16 v[176:179], a[248:251], a[0:3], v[176:179]
ds_read_b128 a[240:243], v14 offset:32768
buffer_load_dwordx4 v11, s[20:23], 0 offen offset:1152 lds
v_mfma_f32_16x16x32_bf16 v[180:183], a[248:251], a[4:7], v[180:183]
ds_read_b32 a30, v57
v_perm_b32 v56, v53, v19, s55
v_mfma_f32_16x16x32_bf16 v[184:187], a[248:251], a[8:11], v[184:187]
s_or_b64 s[50:51], s[44:45], s[50:51]
ds_read_b32 a31, v56
buffer_load_dwordx4 v[36:39], v12, s[24:27], 0 offen offset:1024 sc1
v_mfma_f32_16x16x32_bf16 v[188:191], a[248:251], a[12:15], v[188:191]
s_waitcnt lgkmcnt(3)
v_mfma_f32_16x16x32_bf16 v[192:195], a[252:255], a[0:3], v[192:195]
s_barrier
ds_read_b128 a[244:247], v15 offset:26624
v_mfma_f32_16x16x32_bf16 v[196:199], a[252:255], a[4:7], v[196:199]
s_cbranch_scc1 L_SLOW17
L_BACK17:
v_mfma_f32_16x16x32_bf16 v[200:203], a[252:255], a[8:11], v[200:203]
v_perm_b32 v63, v96, v19, s52
v_mfma_f32_16x16x32_bf16 v[204:207], a[252:255], a[12:15], v[204:207]
s_waitcnt lgkmcnt(1)
ds_read_b32 a32, v63
v_mfma_f32_16x16x32_bf16 v[128:131], a[240:243], a[16:19], v[128:131]
ds_read_b128 a[248:251], v14 offset:34816
v_perm_b32 v62, v96, v19, s53
v_mfma_f32_16x16x32_bf16 v[132:135], a[240:243], a[20:23], v[132:135]
ds_read_b32 a33, v62
v_perm_b32 v61, v100, v19, s52
v_mfma_f32_16x16x32_bf16 v[136:139], a[240:243], a[24:27], v[136:139]
ds_read_b32 a34, v61
v_perm_b32 v60, v100, v19, s53
v_mfma_f32_16x16x32_bf16 v[140:143], a[240:243], a[28:31], v[140:143]
s_waitcnt lgkmcnt(4)
ds_read_b32 a35, v60
v_mfma_f32_16x16x32_bf16 v[208:211], a[244:247], a[0:3], v[208:211]
ds_read_b128 a[252:255], v14 offset:36864
v_perm_b32 v59, v96, v19, s54
v_mfma_f32_16x16x32_bf16 v[212:215], a[244:247], a[4:7], v[212:215]
ds_read_b32 a36, v59
v_perm_b32 v58, v96, v19, s55
v_mfma_f32_16x16x32_bf16 v[216:219], a[244:247], a[8:11], v[216:219]
s_add_u32 m0, s33, 137984
ds_read_b32 a37, v58
v_perm_b32 v57, v100, v19, s54
v_mfma_f32_16x16x32_bf16 v[220:223], a[244:247], a[12:15], v[220:223]
s_waitcnt lgkmcnt(4)
ds_read_b32 a38, v57
v_perm_b32 v56, v100, v19, s55
v_mfma_f32_16x16x32_bf16 v[144:147], a[248:251], a[16:19], v[144:147]
ds_read_b128 a[240:243], v14 offset:38912
buffer_load_dwordx4 v10, s[20:23], 0 offen offset:1280 lds
v_mfma_f32_16x16x32_bf16 v[148:151], a[248:251], a[20:23], v[148:151]
ds_read_b32 a39, v56
v_perm_b32 v63, v97, v19, s52
v_mfma_f32_16x16x32_bf16 v[152:155], a[248:251], a[24:27], v[152:155]
ds_read_b32 a40, v63
v_perm_b32 v62, v97, v19, s53
v_mfma_f32_16x16x32_bf16 v[156:159], a[248:251], a[28:31], v[156:159]
s_waitcnt lgkmcnt(4)
ds_read_b32 a41, v62
buffer_load_dwordx4 v[40:43], v12, s[24:27], 0 offen offset:2048 sc1
v_mfma_f32_16x16x32_bf16 v[160:163], a[252:255], a[16:19], v[160:163]
ds_read_b128 a[244:247], v15 offset:28672
v_perm_b32 v61, v101, v19, s52
v_mfma_f32_16x16x32_bf16 v[164:167], a[252:255], a[20:23], v[164:167]
ds_read_b32 a42, v61
v_perm_b32 v60, v101, v19, s53
v_mfma_f32_16x16x32_bf16 v[168:171], a[252:255], a[24:27], v[168:171]
ds_read_b32 a43, v60
v_perm_b32 v59, v97, v19, s54
v_mfma_f32_16x16x32_bf16 v[172:175], a[252:255], a[28:31], v[172:175]
s_waitcnt lgkmcnt(4)
ds_read_b32 a44, v59
buffer_load_dwordx4 v[44:47], v12, s[24:27], 0 offen offset:3072 sc1
v_mfma_f32_16x16x32_bf16 v[176:179], a[240:243], a[16:19], v[176:179]
ds_read_b128 a[248:251], v14 offset:40960
v_perm_b32 v58, v97, v19, s55
v_mfma_f32_16x16x32_bf16 v[180:183], a[240:243], a[20:23], v[180:183]
ds_read_b32 a45, v58
v_perm_b32 v57, v101, v19, s54
v_mfma_f32_16x16x32_bf16 v[184:187], a[240:243], a[24:27], v[184:187]
s_add_u32 m0, s33, 141952
ds_read_b32 a46, v57
v_perm_b32 v56, v101, v19, s55
v_mfma_f32_16x16x32_bf16 v[188:191], a[240:243], a[28:31], v[188:191]
s_waitcnt vmcnt(11) lgkmcnt(4)
v_cmp_ne_u64 s[50:51], s[88:89], v[82:83]
v_cmp_ne_u64 s[44:45], s[88:89], v[86:87]
v_mfma_f32_16x16x32_bf16 v[224:227], a[244:247], a[0:3], v[224:227]
ds_read_b128 a[252:255], v15 offset:32768
buffer_load_dwordx4 v8, s[20:23], 0 offen offset:1408 lds
v_mfma_f32_16x16x32_bf16 v[228:231], a[244:247], a[4:7], v[228:231]
s_or_b64 s[50:51], s[44:45], s[50:51]
ds_read_b32 a47, v56
v_add_u32 v12, 45056, v13
v_mfma_f32_16x16x32_bf16 v[232:235], a[244:247], a[8:11], v[232:235]
L_PAD3:
s_cbranch_vccnz L_PAD4
s_cbranch_scc1 L_SLOW18
L_BACK18:
v_mfma_f32_16x16x32_bf16 v[236:239], a[244:247], a[12:15], v[236:239]
s_waitcnt lgkmcnt(2)
v_mfma_f32_16x16x32_bf16 v[192:195], a[248:251], a[16:19], v[192:195]
ds_read_b128 a[240:243], v14 offset:30720
v_perm_b32 v63, v80, v19, s52
v_mfma_f32_16x16x32_bf16 v[196:199], a[248:251], a[20:23], v[196:199]
ds_read_b32 a48, v63
v_perm_b32 v62, v80, v19, s53
v_mfma_f32_16x16x32_bf16 v[200:203], a[248:251], a[24:27], v[200:203]
ds_read_b32 a49, v62
v_perm_b32 v61, v84, v19, s52
v_mfma_f32_16x16x32_bf16 v[204:207], a[248:251], a[28:31], v[204:207]
s_waitcnt lgkmcnt(3)
ds_read_b32 a50, v61
v_mfma_f32_16x16x32_bf16 v[128:131], a[252:255], a[32:35], v[128:131]
ds_read_b128 a[244:247], v15 offset:34816
v_perm_b32 v60, v84, v19, s53
v_mfma_f32_16x16x32_bf16 v[132:135], a[252:255], a[36:39], v[132:135]
ds_read_b32 a51, v60
v_perm_b32 v59, v80, v19, s54
v_mfma_f32_16x16x32_bf16 v[136:139], a[252:255], a[40:43], v[136:139]
s_add_u32 m0, s33, 146048
ds_read_b32 a52, v59
v_perm_b32 v58, v80, v19, s55
v_mfma_f32_16x16x32_bf16 v[140:143], a[252:255], a[44:47], v[140:143]
s_waitcnt lgkmcnt(4)
ds_read_b32 a53, v58
v_perm_b32 v57, v84, v19, s54
v_mfma_f32_16x16x32_bf16 v[240:243], a[240:243], a[224:227], v[240:243]
ds_read_b128 a[248:251], v15 offset:36864
buffer_load_dwordx4 v9, s[20:23], 0 offen offset:1408 lds
v_mfma_f32_16x16x32_bf16 v[244:247], a[240:243], a[228:231], v[244:247]
ds_read_b32 a54, v57
v_perm_b32 v56, v84, v19, s55
v_mfma_f32_16x16x32_bf16 v[248:251], a[240:243], a[232:235], v[248:251]
ds_read_b32 a55, v56
v_perm_b32 v63, v81, v19, s52
v_mfma_f32_16x16x32_bf16 v[252:255], a[240:243], a[236:239], v[252:255]
s_waitcnt lgkmcnt(4)
ds_read_b32 a56, v63
buffer_load_dwordx4 v[48:51], v12, s[24:27], 0 offen offset:0 sc1
v_mfma_f32_16x16x32_bf16 v[144:147], a[244:247], a[32:35], v[144:147]
ds_read_b128 a[252:255], v14 offset:43008
v_perm_b32 v62, v81, v19, s53
v_mfma_f32_16x16x32_bf16 v[148:151], a[244:247], a[36:39], v[148:151]
ds_read_b32 a57, v62
v_perm_b32 v61, v85, v19, s52
v_mfma_f32_16x16x32_bf16 v[152:155], a[244:247], a[40:43], v[152:155]
ds_read_b32 a58, v61
v_perm_b32 v60, v85, v19, s53
v_mfma_f32_16x16x32_bf16 v[156:159], a[244:247], a[44:47], v[156:159]
s_waitcnt lgkmcnt(4)
ds_read_b32 a59, v60
buffer_load_dwordx4 v[52:55], v12, s[24:27], 0 offen offset:1024 sc1
v_mfma_f32_16x16x32_bf16 v[160:163], a[248:251], a[32:35], v[160:163]
ds_read_b128 a[240:243], v15 offset:38912
v_perm_b32 v59, v81, v19, s54
v_mfma_f32_16x16x32_bf16 v[164:167], a[248:251], a[36:39], v[164:167]
ds_read_b32 a60, v59
v_perm_b32 v58, v81, v19, s55
v_mfma_f32_16x16x32_bf16 v[168:171], a[248:251], a[40:43], v[168:171]
ds_read_b32 a61, v58
v_perm_b32 v57, v85, v19, s54
v_mfma_f32_16x16x32_bf16 v[172:175], a[248:251], a[44:47], v[172:175]
s_waitcnt lgkmcnt(4)
ds_read_b32 a62, v57
v_mfma_f32_16x16x32_bf16 v[208:211], a[252:255], a[16:19], v[208:211]
ds_read_b128 a[244:247], v14 offset:45056
v_perm_b32 v56, v85, v19, s55
v_mfma_f32_16x16x32_bf16 v[212:215], a[252:255], a[20:23], v[212:215]
ds_read_b32 a63, v56
v_mfma_f32_16x16x32_bf16 v[216:219], a[252:255], a[24:27], v[216:219]
s_waitcnt vmcnt(10)
v_cmp_ne_u64 s[50:51], s[88:89], v[90:91]
v_cmp_ne_u64 s[44:45], s[88:89], v[94:95]
v_mfma_f32_16x16x32_bf16 v[220:223], a[252:255], a[28:31], v[220:223]
s_waitcnt lgkmcnt(3)
v_mfma_f32_16x16x32_bf16 v[176:179], a[240:243], a[32:35], v[176:179]
s_or_b64 s[50:51], s[44:45], s[50:51]
ds_read_b128 a[248:251], v15 offset:40960
v_mfma_f32_16x16x32_bf16 v[180:183], a[240:243], a[36:39], v[180:183]
s_cbranch_scc1 L_SLOW19
L_BACK19:
v_mfma_f32_16x16x32_bf16 v[184:187], a[240:243], a[40:43], v[184:187]
v_perm_b32 v63, v88, v19, s52
v_mfma_f32_16x16x32_bf16 v[188:191], a[240:243], a[44:47], v[188:191]
s_waitcnt lgkmcnt(1)
ds_read_b32 a64, v63
v_mfma_f32_16x16x32_bf16 v[128:131], a[244:247], a[48:51], v[128:131]
ds_read_b128 a[252:255], v14 offset:49152
v_perm_b32 v62, v88, v19, s53
v_mfma_f32_16x16x32_bf16 v[132:135], a[244:247], a[52:55], v[132:135]
ds_read_b32 a65, v62
v_perm_b32 v61, v92, v19, s52
v_mfma_f32_16x16x32_bf16 v[136:139], a[244:247], a[56:59], v[136:139]
s_add_u32 m0, s33, 150016
ds_read_b32 a66, v61
v_perm_b32 v60, v92, v19, s53
v_mfma_f32_16x16x32_bf16 v[140:143], a[244:247], a[60:63], v[140:143]
s_waitcnt lgkmcnt(4)
ds_read_b32 a67, v60
v_perm_b32 v59, v88, v19, s54
v_mfma_f32_16x16x32_bf16 v[192:195], a[248:251], a[32:35], v[192:195]
ds_read_b128 a[240:243], v14 offset:47104
buffer_load_dwordx4 v8, s[20:23], 0 offen offset:1536 lds
v_mfma_f32_16x16x32_bf16 v[196:199], a[248:251], a[36:39], v[196:199]
ds_read_b32 a68, v59
v_perm_b32 v58, v88, v19, s55
v_mfma_f32_16x16x32_bf16 v[200:203], a[248:251], a[40:43], v[200:203]
ds_read_b32 a69, v58
v_perm_b32 v57, v92, v19, s54
v_mfma_f32_16x16x32_bf16 v[204:207], a[248:251], a[44:47], v[204:207]
s_waitcnt lgkmcnt(4)
ds_read_b32 a70, v57
buffer_load_dwordx4 v[96:99], v12, s[24:27], 0 offen offset:2048 sc1
v_mfma_f32_16x16x32_bf16 v[224:227], a[252:255], a[16:19], v[224:227]
s_barrier
ds_read_b128 a[244:247], v14 offset:53248
v_perm_b32 v56, v92, v19, s55
v_mfma_f32_16x16x32_bf16 v[228:231], a[252:255], a[20:23], v[228:231]
ds_read_b32 a71, v56
v_perm_b32 v63, v89, v19, s52
v_mfma_f32_16x16x32_bf16 v[232:235], a[252:255], a[24:27], v[232:235]
ds_read_b32 a72, v63
v_perm_b32 v62, v89, v19, s53
v_mfma_f32_16x16x32_bf16 v[236:239], a[252:255], a[28:31], v[236:239]
s_waitcnt lgkmcnt(4)
ds_read_b32 a73, v62
buffer_load_dwordx4 v[100:103], v12, s[24:27], 0 offen offset:3072 sc1
v_mfma_f32_16x16x32_bf16 v[144:147], a[240:243], a[48:51], v[144:147]
ds_read_b128 a[248:251], v15 offset:43008
v_perm_b32 v61, v93, v19, s52
v_mfma_f32_16x16x32_bf16 v[148:151], a[240:243], a[52:55], v[148:151]
ds_read_b32 a74, v61
v_perm_b32 v60, v93, v19, s53
v_mfma_f32_16x16x32_bf16 v[152:155], a[240:243], a[56:59], v[152:155]
ds_read_b32 a75, v60
v_perm_b32 v59, v89, v19, s54
v_mfma_f32_16x16x32_bf16 v[156:159], a[240:243], a[60:63], v[156:159]
s_waitcnt lgkmcnt(4)
ds_read_b32 a76, v59
v_add_u32 v12, 49152, v13
v_mfma_f32_16x16x32_bf16 v[160:163], a[244:247], a[48:51], v[160:163]
ds_read_b128 a[252:255], v14 offset:55296
v_perm_b32 v58, v89, v19, s55
v_mfma_f32_16x16x32_bf16 v[164:167], a[244:247], a[52:55], v[164:167]
ds_read_b32 a77, v58
v_perm_b32 v57, v93, v19, s54
v_mfma_f32_16x16x32_bf16 v[168:171], a[244:247], a[56:59], v[168:171]
s_waitcnt vmcnt(10)
s_add_u32 m0, s33, 154240
v_cmp_ne_u64 s[50:51], s[88:89], v[34:35]
v_cmp_ne_u64 s[44:45], s[88:89], v[38:39]
v_mfma_f32_16x16x32_bf16 v[172:175], a[244:247], a[60:63], v[172:175]
s_waitcnt lgkmcnt(3)
ds_read_b32 a78, v57
v_perm_b32 v56, v93, v19, s55
v_mfma_f32_16x16x32_bf16 v[208:211], a[248:251], a[32:35], v[208:211]
s_or_b64 s[50:51], s[44:45], s[50:51]
ds_read_b128 a[240:243], v15 offset:45056
buffer_load_dwordx4 v10, s[20:23], 0 offen offset:1408 lds
v_mfma_f32_16x16x32_bf16 v[212:215], a[248:251], a[36:39], v[212:215]
s_cbranch_scc1 L_SLOW20
L_BACK20:
v_mfma_f32_16x16x32_bf16 v[216:219], a[248:251], a[40:43], v[216:219]
ds_read_b32 a79, v56
v_perm_b32 v63, v32, v19, s52
v_mfma_f32_16x16x32_bf16 v[220:223], a[248:251], a[44:47], v[220:223]
s_waitcnt lgkmcnt(3)
ds_read_b32 a80, v63
v_mfma_f32_16x16x32_bf16 v[176:179], a[252:255], a[48:51], v[176:179]
ds_read_b128 a[244:247], v15 offset:47104
v_perm_b32 v62, v32, v19, s53
v_mfma_f32_16x16x32_bf16 v[180:183], a[252:255], a[52:55], v[180:183]
ds_read_b32 a81, v62
v_perm_b32 v61, v36, v19, s52
v_mfma_f32_16x16x32_bf16 v[184:187], a[252:255], a[56:59], v[184:187]
ds_read_b32 a82, v61
v_perm_b32 v60, v36, v19, s53
v_mfma_f32_16x16x32_bf16 v[188:191], a[252:255], a[60:63], v[188:191]
s_waitcnt lgkmcnt(4)
ds_read_b32 a83, v60
v_mfma_f32_16x16x32_bf16 v[128:131], a[240:243], a[64:67], v[128:131]
ds_read_b128 a[248:251], v14 offset:57344
v_perm_b32 v59, v32, v19, s54
v_mfma_f32_16x16x32_bf16 v[132:135], a[240:243], a[68:71], v[132:135]
ds_read_b32 a84, v59
v_perm_b32 v58, v32, v19, s55
v_mfma_f32_16x16x32_bf16 v[136:139], a[240:243], a[72:75], v[136:139]
s_add_u32 m0, s33, 158464
ds_read_b32 a85, v58
v_perm_b32 v57, v36, v19, s54
v_mfma_f32_16x16x32_bf16 v[140:143], a[240:243], a[76:79], v[140:143]
s_waitcnt lgkmcnt(4)
ds_read_b32 a86, v57
v_perm_b32 v56, v36, v19, s55
v_mfma_f32_16x16x32_bf16 v[144:147], a[244:247], a[64:67], v[144:147]
ds_read_b128 a[252:255], v15 offset:53248
buffer_load_dwordx4 v11, s[20:23], 0 offen offset:1280 lds
v_mfma_f32_16x16x32_bf16 v[148:151], a[244:247], a[68:71], v[148:151]
ds_read_b32 a87, v56
v_perm_b32 v63, v33, v19, s52
v_mfma_f32_16x16x32_bf16 v[152:155], a[244:247], a[72:75], v[152:155]
ds_read_b32 a88, v63
v_perm_b32 v62, v33, v19, s53
v_mfma_f32_16x16x32_bf16 v[156:159], a[244:247], a[76:79], v[156:159]
s_waitcnt lgkmcnt(4)
ds_read_b32 a89, v62
buffer_load_dwordx4 v[80:83], v12, s[24:27], 0 offen offset:0 sc1
v_mfma_f32_16x16x32_bf16 v[192:195], a[248:251], a[48:51], v[192:195]
ds_read_b128 a[240:243], v15 offset:30720
v_perm_b32 v61, v37, v19, s52
v_mfma_f32_16x16x32_bf16 v[196:199], a[248:251], a[52:55], v[196:199]
ds_read_b32 a90, v61
v_perm_b32 v60, v37, v19, s53
v_mfma_f32_16x16x32_bf16 v[200:203], a[248:251], a[56:59], v[200:203]
ds_read_b32 a91, v60
v_perm_b32 v59, v33, v19, s54
v_mfma_f32_16x16x32_bf16 v[204:207], a[248:251], a[60:63], v[204:207]
s_waitcnt lgkmcnt(4)
ds_read_b32 a92, v59
buffer_load_dwordx4 v[84:87], v12, s[24:27], 0 offen offset:1024 sc1
v_mfma_f32_16x16x32_bf16 v[160:163], a[252:255], a[64:67], v[160:163]
ds_read_b128 a[244:247], v15 offset:49152
v_perm_b32 v58, v33, v19, s55
v_mfma_f32_16x16x32_bf16 v[164:167], a[252:255], a[68:71], v[164:167]
ds_read_b32 a93, v58
v_perm_b32 v57, v37, v19, s54
v_mfma_f32_16x16x32_bf16 v[168:171], a[252:255], a[72:75], v[168:171]
s_waitcnt vmcnt(11)
s_add_u32 m0, s33, 64000
v_cmp_ne_u64 s[50:51], s[88:89], v[42:43]
v_cmp_ne_u64 s[44:45], s[88:89], v[46:47]
v_mfma_f32_16x16x32_bf16 v[172:175], a[252:255], a[76:79], v[172:175]
s_waitcnt lgkmcnt(3)
ds_read_b32 a94, v57
v_perm_b32 v56, v37, v19, s55
v_mfma_f32_16x16x32_bf16 v[240:243], a[240:243], a[0:3], v[240:243]
s_or_b64 s[50:51], s[44:45], s[50:51]
ds_read_b128 a[248:251], v14 offset:61440
buffer_load_dwordx4 v9, s[20:23], 0 offen offset:1536 lds
v_mfma_f32_16x16x32_bf16 v[244:247], a[240:243], a[4:7], v[244:247]
s_cbranch_scc1 L_SLOW21
L_BACK21:
v_mfma_f32_16x16x32_bf16 v[248:251], a[240:243], a[8:11], v[248:251]
ds_read_b32 a95, v56
v_perm_b32 v63, v40, v19, s52
v_mfma_f32_16x16x32_bf16 v[252:255], a[240:243], a[12:15], v[252:255]
s_waitcnt lgkmcnt(3)
ds_read_b32 a96, v63
v_mfma_f32_16x16x32_bf16 v[224:227], a[244:247], a[32:35], v[224:227]
ds_read_b128 a[252:255], v15 offset:55296
v_perm_b32 v62, v40, v19, s53
v_mfma_f32_16x16x32_bf16 v[228:231], a[244:247], a[36:39], v[228:231]
ds_read_b32 a97, v62
v_perm_b32 v61, v44, v19, s52
v_mfma_f32_16x16x32_bf16 v[232:235], a[244:247], a[40:43], v[232:235]
ds_read_b32 a98, v61
v_perm_b32 v60, v44, v19, s53
v_mfma_f32_16x16x32_bf16 v[236:239], a[244:247], a[44:47], v[236:239]
s_waitcnt lgkmcnt(4)
ds_read_b32 a99, v60
v_mfma_f32_16x16x32_bf16 v[128:131], a[248:251], a[80:83], v[128:131]
ds_read_b128 a[240:243], v14 offset:59392
v_perm_b32 v59, v40, v19, s54
v_mfma_f32_16x16x32_bf16 v[132:135], a[248:251], a[84:87], v[132:135]
ds_read_b32 a100, v59
v_perm_b32 v58, v40, v19, s55
v_mfma_f32_16x16x32_bf16 v[136:139], a[248:251], a[88:91], v[136:139]
ds_read_b32 a101, v58
v_perm_b32 v57, v44, v19, s54
v_mfma_f32_16x16x32_bf16 v[140:143], a[248:251], a[92:95], v[140:143]
s_waitcnt lgkmcnt(4)
ds_read_b32 a102, v57
v_mfma_f32_16x16x32_bf16 v[176:179], a[252:255], a[64:67], v[176:179]
ds_read_b128 a[244:247], v14 offset:63488
v_perm_b32 v56, v44, v19, s55
v_mfma_f32_16x16x32_bf16 v[180:183], a[252:255], a[68:71], v[180:183]
ds_read_b32 a103, v56
v_perm_b32 v63, v41, v19, s52
v_mfma_f32_16x16x32_bf16 v[184:187], a[252:255], a[72:75], v[184:187]
s_add_u32 m0, s33, 67968
ds_read_b32 a104, v63
v_perm_b32 v62, v41, v19, s53
v_mfma_f32_16x16x32_bf16 v[188:191], a[252:255], a[76:79], v[188:191]
s_waitcnt lgkmcnt(4)
ds_read_b32 a105, v62
v_perm_b32 v61, v45, v19, s52
v_mfma_f32_16x16x32_bf16 v[208:211], a[240:243], a[48:51], v[208:211]
ds_read_b128 a[248:251], v15 offset:57344
buffer_load_dwordx4 v8, s[20:23], 0 offen offset:1664 lds
v_mfma_f32_16x16x32_bf16 v[212:215], a[240:243], a[52:55], v[212:215]
ds_read_b32 a106, v61
v_perm_b32 v60, v45, v19, s53
v_mfma_f32_16x16x32_bf16 v[216:219], a[240:243], a[56:59], v[216:219]
ds_read_b32 a107, v60
v_perm_b32 v59, v41, v19, s54
v_mfma_f32_16x16x32_bf16 v[220:223], a[240:243], a[60:63], v[220:223]
s_waitcnt lgkmcnt(4)
ds_read_b32 a108, v59
buffer_load_dwordx4 v[88:91], v12, s[24:27], 0 offen offset:2048 sc1
v_mfma_f32_16x16x32_bf16 v[144:147], a[244:247], a[80:83], v[144:147]
ds_read_b128 a[252:255], v16 offset:0
v_perm_b32 v58, v41, v19, s55
v_mfma_f32_16x16x32_bf16 v[148:151], a[244:247], a[84:87], v[148:151]
ds_read_b32 a109, v58
v_perm_b32 v57, v45, v19, s54
v_mfma_f32_16x16x32_bf16 v[152:155], a[244:247], a[88:91], v[152:155]
s_add_u32 m0, s33, 72192
ds_read_b32 a110, v57
v_perm_b32 v56, v45, v19, s55
v_mfma_f32_16x16x32_bf16 v[156:159], a[244:247], a[92:95], v[156:159]
s_waitcnt vmcnt(10) lgkmcnt(4)
v_cmp_ne_u64 s[50:51], s[88:89], v[50:51]
v_cmp_ne_u64 s[44:45], s[88:89], v[54:55]
v_mfma_f32_16x16x32_bf16 v[192:195], a[248:251], a[64:67], v[192:195]
ds_read_b128 a[240:243], v15 offset:61440
buffer_load_dwordx4 v10, s[20:23], 0 offen offset:1536 lds
v_mfma_f32_16x16x32_bf16 v[196:199], a[248:251], a[68:71], v[196:199]
s_or_b64 s[50:51], s[44:45], s[50:51]
ds_read_b32 a111, v56
buffer_load_dwordx4 v[92:95], v12, s[24:27], 0 offen offset:3072 sc1
v_mfma_f32_16x16x32_bf16 v[200:203], a[248:251], a[72:75], v[200:203]
s_cbranch_scc1 L_SLOW22
L_BACK22:
v_mfma_f32_16x16x32_bf16 v[204:207], a[248:251], a[76:79], v[204:207]
s_waitcnt lgkmcnt(2)
v_add_u32 v12, 53248, v13
v_mfma_f32_16x16x32_bf16 v[160:163], a[252:255], a[80:83], v[160:163]
s_barrier
ds_read_b128 a[244:247], v16 offset:2048
v_perm_b32 v63, v48, v19, s52
v_mfma_f32_16x16x32_bf16 v[164:167], a[252:255], a[84:87], v[164:167]
ds_read_b32 a112, v63
v_perm_b32 v62, v48, v19, s53
v_mfma_f32_16x16x32_bf16 v[168:171], a[252:255], a[88:91], v[168:171]
ds_read_b32 a113, v62
v_perm_b32 v61, v52, v19, s52
v_mfma_f32_16x16x32_bf16 v[172:175], a[252:255], a[92:95], v[172:175]
s_waitcnt lgkmcnt(3)
ds_read_b32 a114, v61
v_mfma_f32_16x16x32_bf16 v[128:131], a[240:243], a[96:99], v[128:131]
ds_read_b128 a[248:251], v16 offset:4096
v_perm_b32 v60, v52, v19, s53
v_mfma_f32_16x16x32_bf16 v[132:135], a[240:243], a[100:103], v[132:135]
ds_read_b32 a115, v60
v_perm_b32 v59, v48, v19, s54
v_mfma_f32_16x16x32_bf16 v[136:139], a[240:243], a[104:107], v[136:139]
ds_read_b32 a116, v59
v_perm_b32 v58, v48, v19, s55
v_mfma_f32_16x16x32_bf16 v[140:143], a[240:243], a[108:111], v[140:143]
s_waitcnt lgkmcnt(4)
ds_read_b32 a117, v58
v_mfma_f32_16x16x32_bf16 v[176:179], a[244:247], a[80:83], v[176:179]
ds_read_b128 a[252:255], v15 offset:63488
v_perm_b32 v57, v52, v19, s54
v_mfma_f32_16x16x32_bf16 v[180:183], a[244:247], a[84:87], v[180:183]
ds_read_b32 a118, v57
v_perm_b32 v56, v52, v19, s55
v_mfma_f32_16x16x32_bf16 v[184:187], a[244:247], a[88:91], v[184:187]
s_add_u32 m0, s33, 76160
ds_read_b32 a119, v56
v_perm_b32 v63, v49, v19, s52
v_mfma_f32_16x16x32_bf16 v[188:191], a[244:247], a[92:95], v[188:191]
s_waitcnt lgkmcnt(4)
ds_read_b32 a120, v63
v_perm_b32 v62, v49, v19, s53
v_mfma_f32_16x16x32_bf16 v[224:227], a[248:251], a[48:51], v[224:227]
ds_read_b128 a[240:243], v15 offset:59392
buffer_load_dwordx4 v9, s[20:23], 0 offen offset:1664 lds
v_mfma_f32_16x16x32_bf16 v[228:231], a[248:251], a[52:55], v[228:231]
ds_read_b32 a121, v62
v_perm_b32 v61, v53, v19, s52
v_mfma_f32_16x16x32_bf16 v[232:235], a[248:251], a[56:59], v[232:235]
ds_read_b32 a122, v61
v_perm_b32 v60, v53, v19, s53
v_mfma_f32_16x16x32_bf16 v[236:239], a[248:251], a[60:63], v[236:239]
s_waitcnt lgkmcnt(4)
ds_read_b32 a123, v60
buffer_load_dwordx4 v[32:35], v12, s[24:27], 0 offen offset:0 sc1
v_mfma_f32_16x16x32_bf16 v[144:147], a[252:255], a[96:99], v[144:147]
ds_read_b128 a[244:247], v17 offset:0
v_perm_b32 v59, v49, v19, s54
v_mfma_f32_16x16x32_bf16 v[148:151], a[252:255], a[100:103], v[148:151]
ds_read_b32 a124, v59
v_perm_b32 v58, v49, v19, s55
v_mfma_f32_16x16x32_bf16 v[152:155], a[252:255], a[104:107], v[152:155]
s_waitcnt vmcnt(11)
v_cmp_ne_u64 s[50:51], s[88:89], v[98:99]
v_cmp_ne_u64 s[44:45], s[88:89], v[102:103]
v_mfma_f32_16x16x32_bf16 v[156:159], a[252:255], a[108:111], v[156:159]
s_waitcnt lgkmcnt(3)
ds_read_b32 a125, v58
buffer_load_dwordx4 v[36:39], v12, s[24:27], 0 offen offset:1024 sc1
v_mfma_f32_16x16x32_bf16 v[208:211], a[240:243], a[64:67], v[208:211]
s_or_b64 s[50:51], s[44:45], s[50:51]
ds_read_b128 a[248:251], v16 offset:8192
v_perm_b32 v57, v53, v19, s54
v_mfma_f32_16x16x32_bf16 v[212:215], a[240:243], a[68:71], v[212:215]
s_cbranch_scc1 L_SLOW23
L_BACK23:
v_mfma_f32_16x16x32_bf16 v[216:219], a[240:243], a[72:75], v[216:219]
s_add_u32 m0, s33, 80512
ds_read_b32 a126, v57
v_perm_b32 v56, v53, v19, s55
v_mfma_f32_16x16x32_bf16 v[220:223], a[240:243], a[76:79], v[220:223]
s_waitcnt lgkmcnt(3)
ds_read_b32 a127, v56
v_perm_b32 v63, v96, v19, s52
v_mfma_f32_16x16x32_bf16 v[160:163], a[244:247], a[96:99], v[160:163]
ds_read_b128 a[252:255], v16 offset:12288
buffer_load_dwordx4 v11, s[20:23], 0 offen offset:1408 lds
v_mfma_f32_16x16x32_bf16 v[164:167], a[244:247], a[100:103], v[164:167]
ds_read_b32 a128, v63
v_perm_b32 v62, v96, v19, s53
v_mfma_f32_16x16x32_bf16 v[168:171], a[244:247], a[104:107], v[168:171]
ds_read_b32 a129, v62
v_perm_b32 v61, v100, v19, s52
v_mfma_f32_16x16x32_bf16 v[172:175], a[244:247], a[108:111], v[172:175]
s_waitcnt lgkmcnt(4)
ds_read_b32 a130, v61
v_mfma_f32_16x16x32_bf16 v[192:195], a[248:251], a[80:83], v[192:195]
ds_read_b128 a[240:243], v14 offset:51200
v_perm_b32 v60, v100, v19, s53
v_mfma_f32_16x16x32_bf16 v[196:199], a[248:251], a[84:87], v[196:199]
ds_read_b32 a131, v60
v_perm_b32 v59, v96, v19, s54
v_mfma_f32_16x16x32_bf16 v[200:203], a[248:251], a[88:91], v[200:203]
ds_read_b32 a132, v59
v_perm_b32 v58, v96, v19, s55
v_mfma_f32_16x16x32_bf16 v[204:207], a[248:251], a[92:95], v[204:207]
s_waitcnt lgkmcnt(4)
ds_read_b32 a133, v58
v_mfma_f32_16x16x32_bf16 v[128:131], a[252:255], a[112:115], v[128:131]
ds_read_b128 a[244:247], v16 offset:14336
v_perm_b32 v57, v100, v19, s54
v_mfma_f32_16x16x32_bf16 v[132:135], a[252:255], a[116:119], v[132:135]
ds_read_b32 a134, v57
v_perm_b32 v56, v100, v19, s55
v_mfma_f32_16x16x32_bf16 v[136:139], a[252:255], a[120:123], v[136:139]
s_add_u32 m0, s33, 84224
ds_read_b32 a135, v56
v_perm_b32 v63, v97, v19, s52
v_mfma_f32_16x16x32_bf16 v[140:143], a[252:255], a[124:127], v[140:143]
s_waitcnt lgkmcnt(4)
ds_read_b32 a136, v63
v_perm_b32 v62, v97, v19, s53
v_mfma_f32_16x16x32_bf16 v[240:243], a[240:243], a[16:19], v[240:243]
ds_read_b128 a[248:251], v17 offset:2048
buffer_load_dwordx4 v8, s[20:23], 0 offen offset:1792 lds
v_mfma_f32_16x16x32_bf16 v[244:247], a[240:243], a[20:23], v[244:247]
ds_read_b32 a137, v62
v_perm_b32 v61, v101, v19, s52
v_mfma_f32_16x16x32_bf16 v[248:251], a[240:243], a[24:27], v[248:251]
ds_read_b32 a138, v61
v_perm_b32 v60, v101, v19, s53
v_mfma_f32_16x16x32_bf16 v[252:255], a[240:243], a[28:31], v[252:255]
s_waitcnt lgkmcnt(4)
ds_read_b32 a139, v60
buffer_load_dwordx4 v[40:43], v12, s[24:27], 0 offen offset:2048 sc1
v_mfma_f32_16x16x32_bf16 v[144:147], a[244:247], a[112:115], v[144:147]
ds_read_b128 a[252:255], v17 offset:4096
v_perm_b32 v59, v97, v19, s54
v_mfma_f32_16x16x32_bf16 v[148:151], a[244:247], a[116:119], v[148:151]
ds_read_b32 a140, v59
v_perm_b32 v58, v97, v19, s55
v_mfma_f32_16x16x32_bf16 v[152:155], a[244:247], a[120:123], v[152:155]
ds_read_b32 a141, v58
buffer_load_dwordx4 v[44:47], v12, s[24:27], 0 offen offset:3072 sc1
v_mfma_f32_16x16x32_bf16 v[156:159], a[244:247], a[124:127], v[156:159]
s_waitcnt vmcnt(12) lgkmcnt(4)
v_cmp_ne_u64 s[50:51], s[88:89], v[82:83]
v_cmp_ne_u64 s[44:45], s[88:89], v[86:87]
v_mfma_f32_16x16x32_bf16 v[176:179], a[248:251], a[96:99], v[176:179]
ds_read_b128 a[240:243], v16 offset:16384
v_perm_b32 v57, v101, v19, s54
v_mfma_f32_16x16x32_bf16 v[180:183], a[248:251], a[100:103], v[180:183]
s_or_b64 s[50:51], s[44:45], s[50:51]
ds_read_b32 a142, v57
v_perm_b32 v56, v101, v19, s55
v_mfma_f32_16x16x32_bf16 v[184:187], a[248:251], a[104:107], v[184:187]
s_cbranch_scc1 L_SLOW24
L_BACK24:
v_mfma_f32_16x16x32_bf16 v[188:191], a[248:251], a[108:111], v[188:191]
s_waitcnt lgkmcnt(2)
ds_read_b32 a143, v56
v_add_u32 v12, 57344, v13
v_mfma_f32_16x16x32_bf16 v[224:227], a[252:255], a[64:67], v[224:227]
ds_read_b128 a[244:247], v16 offset:10240
v_perm_b32 v63, v80, v19, s52
v_mfma_f32_16x16x32_bf16 v[228:231], a[252:255], a[68:71], v[228:231]
ds_read_b32 a144, v63
v_perm_b32 v62, v80, v19, s53
v_mfma_f32_16x16x32_bf16 v[232:235], a[252:255], a[72:75], v[232:235]
s_add_u32 m0, s33, 88448
ds_read_b32 a145, v62
v_perm_b32 v61, v84, v19, s52
v_mfma_f32_16x16x32_bf16 v[236:239], a[252:255], a[76:79], v[236:239]
s_waitcnt lgkmcnt(4)
ds_read_b32 a146, v61
v_perm_b32 v60, v84, v19, s53
v_mfma_f32_16x16x32_bf16 v[160:163], a[240:243], a[112:115], v[160:163]
ds_read_b128 a[248:251], v17 offset:12288
buffer_load_dwordx4 v10, s[20:23], 0 offen offset:1664 lds
v_mfma_f32_16x16x32_bf16 v[164:167], a[240:243], a[116:119], v[164:167]
ds_read_b32 a147, v60
v_perm_b32 v59, v80, v19, s54
v_mfma_f32_16x16x32_bf16 v[168:171], a[240:243], a[120:123], v[168:171]
ds_read_b32 a148, v59
v_perm_b32 v58, v80, v19, s55
v_mfma_f32_16x16x32_bf16 v[172:175], a[240:243], a[124:127], v[172:175]
s_waitcnt lgkmcnt(4)
ds_read_b32 a149, v58
v_mfma_f32_16x16x32_bf16 v[208:211], a[244:247], a[80:83], v[208:211]
ds_read_b128 a[252:255], v17 offset:8192
v_perm_b32 v57, v84, v19, s54
v_mfma_f32_16x16x32_bf16 v[212:215], a[244:247], a[84:87], v[212:215]
ds_read_b32 a150, v57
v_perm_b32 v56, v84, v19, s55
v_mfma_f32_16x16x32_bf16 v[216:219], a[244:247], a[88:91], v[216:219]
s_add_u32 m0, s33, 92416
ds_read_b32 a151, v56
v_perm_b32 v63, v81, v19, s52
v_mfma_f32_16x16x32_bf16 v[220:223], a[244:247], a[92:95], v[220:223]
s_waitcnt lgkmcnt(4)
ds_read_b32 a152, v63
v_perm_b32 v62, v81, v19, s53
v_mfma_f32_16x16x32_bf16 v[128:131], a[248:251], a[128:131], v[128:131]
ds_read_b128 a[240:243], v17 offset:14336
buffer_load_dwordx4 v9, s[20:23], 0 offen offset:1792 lds
v_mfma_f32_16x16x32_bf16 v[132:135], a[248:251], a[132:135], v[132:135]
ds_read_b32 a153, v62
v_perm_b32 v61, v85, v19, s52
v_mfma_f32_16x16x32_bf16 v[136:139], a[248:251], a[136:139], v[136:139]
ds_read_b32 a154, v61
v_perm_b32 v60, v85, v19, s53
v_mfma_f32_16x16x32_bf16 v[140:143], a[248:251], a[140:143], v[140:143]
s_waitcnt lgkmcnt(4)
ds_read_b32 a155, v60
buffer_load_dwordx4 v[48:51], v12, s[24:27], 0 offen offset:0 sc1
v_mfma_f32_16x16x32_bf16 v[192:195], a[252:255], a[96:99], v[192:195]
s_waitcnt vmcnt(14)
s_barrier
ds_read_b128 a[244:247], v16 offset:18432
v_perm_b32 v59, v81, v19, s54
v_mfma_f32_16x16x32_bf16 v[196:199], a[252:255], a[100:103], v[196:199]
L_PAD4:
s_cbranch_vccnz L_PADRET
ds_read_b32 a156, v59
v_perm_b32 v58, v81, v19, s55
v_mfma_f32_16x16x32_bf16 v[200:203], a[252:255], a[104:107], v[200:203]
ds_read_b32 a157, v58
v_perm_b32 v57, v85, v19, s54
v_mfma_f32_16x16x32_bf16 v[204:207], a[252:255], a[108:111], v[204:207]
s_waitcnt lgkmcnt(4)
ds_read_b32 a158, v57
buffer_load_dwordx4 v[52:55], v12, s[24:27], 0 offen offset:1024 sc1
v_mfma_f32_16x16x32_bf16 v[144:147], a[240:243], a[128:131], v[144:147]
ds_read_b128 a[248:251], v16 offset:20480
v_perm_b32 v56, v85, v19, s55
v_mfma_f32_16x16x32_bf16 v[148:151], a[240:243], a[132:135], v[148:151]
ds_read_b32 a159, v56
v_mfma_f32_16x16x32_bf16 v[152:155], a[240:243], a[136:139], v[152:155]
s_waitcnt vmcnt(11)
v_cmp_ne_u64 s[50:51], s[88:89], v[90:91]
v_cmp_ne_u64 s[44:45], s[88:89], v[94:95]
v_mfma_f32_16x16x32_bf16 v[156:159], a[240:243], a[140:143], v[156:159]
s_waitcnt lgkmcnt(3)
v_mfma_f32_16x16x32_bf16 v[176:179], a[244:247], a[112:115], v[176:179]
s_or_b64 s[50:51], s[44:45], s[50:51]
ds_read_b128 a[252:255], v17 offset:16384
v_mfma_f32_16x16x32_bf16 v[180:183], a[244:247], a[116:119], v[180:183]
s_cbranch_scc1 L_SLOW25
L_BACK25:
v_mfma_f32_16x16x32_bf16 v[184:187], a[244:247], a[120:123], v[184:187]
s_add_u32 m0, s33, 96384
v_mfma_f32_16x16x32_bf16 v[188:191], a[244:247], a[124:127], v[188:191]
s_waitcnt lgkmcnt(1)
v_perm_b32 v63, v88, v19, s52
v_mfma_f32_16x16x32_bf16 v[128:131], a[248:251], a[144:147], v[128:131]
ds_read_b128 a[240:243], v17 offset:10240
buffer_load_dwordx4 v8, s[20:23], 0 offen offset:1920 lds
v_mfma_f32_16x16x32_bf16 v[132:135], a[248:251], a[148:151], v[132:135]
ds_read_b32 a160, v63
v_perm_b32 v62, v88, v19, s53
v_mfma_f32_16x16x32_bf16 v[136:139], a[248:251], a[152:155], v[136:139]
ds_read_b32 a161, v62
v_perm_b32 v61, v92, v19, s52
v_mfma_f32_16x16x32_bf16 v[140:143], a[248:251], a[156:159], v[140:143]
s_waitcnt lgkmcnt(3)
ds_read_b32 a162, v61
v_mfma_f32_16x16x32_bf16 v[160:163], a[252:255], a[128:131], v[160:163]
ds_read_b128 a[244:247], v16 offset:24576
v_perm_b32 v60, v92, v19, s53
v_mfma_f32_16x16x32_bf16 v[164:167], a[252:255], a[132:135], v[164:167]
ds_read_b32 a163, v60
v_perm_b32 v59, v88, v19, s54
v_mfma_f32_16x16x32_bf16 v[168:171], a[252:255], a[136:139], v[168:171]
ds_read_b32 a164, v59
v_perm_b32 v58, v88, v19, s55
v_mfma_f32_16x16x32_bf16 v[172:175], a[252:255], a[140:143], v[172:175]
s_waitcnt lgkmcnt(4)
ds_read_b32 a165, v58
v_mfma_f32_16x16x32_bf16 v[208:211], a[240:243], a[96:99], v[208:211]
ds_read_b128 a[248:251], v16 offset:28672
v_perm_b32 v57, v92, v19, s54
v_mfma_f32_16x16x32_bf16 v[212:215], a[240:243], a[100:103], v[212:215]
ds_read_b32 a166, v57
v_perm_b32 v56, v92, v19, s55
v_mfma_f32_16x16x32_bf16 v[216:219], a[240:243], a[104:107], v[216:219]
s_add_u32 m0, s33, 100864
ds_read_b32 a167, v56
v_perm_b32 v63, v89, v19, s52
v_mfma_f32_16x16x32_bf16 v[220:223], a[240:243], a[108:111], v[220:223]
s_waitcnt lgkmcnt(4)
ds_read_b32 a168, v63
v_perm_b32 v62, v89, v19, s53
v_mfma_f32_16x16x32_bf16 v[192:195], a[244:247], a[112:115], v[192:195]
ds_read_b128 a[252:255], v16 offset:22528
buffer_load_dwordx4 v11, s[20:23], 0 offen offset:1536 lds
v_mfma_f32_16x16x32_bf16 v[196:199], a[244:247], a[116:119], v[196:199]
ds_read_b32 a169, v62
v_perm_b32 v61, v93, v19, s52
v_mfma_f32_16x16x32_bf16 v[200:203], a[244:247], a[120:123], v[200:203]
ds_read_b32 a170, v61
v_perm_b32 v60, v93, v19, s53
v_mfma_f32_16x16x32_bf16 v[204:207], a[244:247], a[124:127], v[204:207]
s_waitcnt lgkmcnt(4)
ds_read_b32 a171, v60
buffer_load_dwordx4 v[96:99], v12, s[24:27], 0 offen offset:2048 sc1
v_mfma_f32_16x16x32_bf16 v[224:227], a[248:251], a[80:83], v[224:227]
ds_read_b128 a[240:243], v17 offset:18432
v_perm_b32 v59, v89, v19, s54
v_mfma_f32_16x16x32_bf16 v[228:231], a[248:251], a[84:87], v[228:231]
ds_read_b32 a172, v59
v_perm_b32 v58, v89, v19, s55
v_mfma_f32_16x16x32_bf16 v[232:235], a[248:251], a[88:91], v[232:235]
s_waitcnt vmcnt(11)
v_cmp_ne_u64 s[50:51], s[88:89], v[34:35]
v_cmp_ne_u64 s[44:45], s[88:89], v[38:39]
v_mfma_f32_16x16x32_bf16 v[236:239], a[248:251], a[92:95], v[236:239]
s_waitcnt lgkmcnt(3)
ds_read_b32 a173, v58
buffer_load_dwordx4 v[100:103], v12, s[24:27], 0 offen offset:3072 sc1
v_mfma_f32_16x16x32_bf16 v[144:147], a[252:255], a[144:147], v[144:147]
s_or_b64 s[50:51], s[44:45], s[50:51]
ds_read_b128 a[244:247], v15 offset:51200
v_perm_b32 v57, v93, v19, s54
v_mfma_f32_16x16x32_bf16 v[148:151], a[252:255], a[148:151], v[148:151]
s_cbranch_scc1 L_SLOW26
L_BACK26:
v_mfma_f32_16x16x32_bf16 v[152:155], a[252:255], a[152:155], v[152:155]
s_add_u32 m0, s33, 104576
ds_read_b32 a174, v57
v_perm_b32 v56, v93, v19, s55
v_mfma_f32_16x16x32_bf16 v[156:159], a[252:255], a[156:159], v[156:159]
s_waitcnt lgkmcnt(3)
ds_read_b32 a175, v56
v_perm_b32 v63, v32, v19, s52
v_mfma_f32_16x16x32_bf16 v[176:179], a[240:243], a[128:131], v[176:179]
ds_read_b128 a[248:251], v17 offset:20480
buffer_load_dwordx4 v9, s[20:23], 0 offen offset:1920 lds
v_mfma_f32_16x16x32_bf16 v[180:183], a[240:243], a[132:135], v[180:183]
ds_read_b32 a176, v63
v_perm_b32 v62, v32, v19, s53
v_mfma_f32_16x16x32_bf16 v[184:187], a[240:243], a[136:139], v[184:187]
ds_read_b32 a177, v62
v_perm_b32 v61, v36, v19, s52
v_mfma_f32_16x16x32_bf16 v[188:191], a[240:243], a[140:143], v[188:191]
s_waitcnt lgkmcnt(4)
ds_read_b32 a178, v61
v_add_u32 v12, 61440, v13
v_mfma_f32_16x16x32_bf16 v[240:243], a[244:247], a[32:35], v[240:243]
ds_read_b128 a[252:255], v14 offset:0
v_perm_b32 v60, v36, v19, s53
v_mfma_f32_16x16x32_bf16 v[244:247], a[244:247], a[36:39], v[244:247]
ds_read_b32 a179, v60
v_perm_b32 v59, v32, v19, s54
v_mfma_f32_16x16x32_bf16 v[248:251], a[244:247], a[40:43], v[248:251]
ds_read_b32 a180, v59
v_perm_b32 v58, v32, v19, s55
v_mfma_f32_16x16x32_bf16 v[252:255], a[244:247], a[44:47], v[252:255]
s_waitcnt lgkmcnt(4)
ds_read_b32 a181, v58
v_mfma_f32_16x16x32_bf16 v[128:131], a[248:251], a[160:163], v[128:131]
ds_read_b128 a[240:243], v17 offset:22528
v_perm_b32 v57, v36, v19, s54
v_mfma_f32_16x16x32_bf16 v[132:135], a[248:251], a[164:167], v[132:135]
ds_read_b32 a182, v57
v_perm_b32 v56, v36, v19, s55
v_mfma_f32_16x16x32_bf16 v[136:139], a[248:251], a[168:171], v[136:139]
ds_read_b32 a183, v56
v_perm_b32 v63, v33, v19, s52
v_mfma_f32_16x16x32_bf16 v[140:143], a[248:251], a[172:175], v[140:143]
s_waitcnt lgkmcnt(4)
ds_read_b32 a184, v63
v_mfma_f32_16x16x32_bf16 v[160:163], a[252:255], a[144:147], v[160:163]
ds_read_b128 a[244:247], v17 offset:24576
v_perm_b32 v62, v33, v19, s53
v_mfma_f32_16x16x32_bf16 v[164:167], a[252:255], a[148:151], v[164:167]
ds_read_b32 a185, v62
v_perm_b32 v61, v37, v19, s52
v_mfma_f32_16x16x32_bf16 v[168:171], a[252:255], a[152:155], v[168:171]
ds_read_b32 a186, v61
v_perm_b32 v60, v37, v19, s53
v_mfma_f32_16x16x32_bf16 v[172:175], a[252:255], a[156:159], v[172:175]
s_waitcnt lgkmcnt(4)
ds_read_b32 a187, v60
buffer_load_dwordx4 v[80:83], v12, s[24:27], 0 offen offset:0 sc1
v_mfma_f32_16x16x32_bf16 v[144:147], a[240:243], a[160:163], v[144:147]
ds_read_b128 a[248:251], v16 offset:26624
v_perm_b32 v59, v33, v19, s54
v_mfma_f32_16x16x32_bf16 v[148:151], a[240:243], a[164:167], v[148:151]
ds_read_b32 a188, v59
v_perm_b32 v58, v33, v19, s55
v_mfma_f32_16x16x32_bf16 v[152:155], a[240:243], a[168:171], v[152:155]
s_waitcnt vmcnt(10)
v_cmp_ne_u64 s[50:51], s[88:89], v[42:43]
v_cmp_ne_u64 s[44:45], s[88:89], v[46:47]
v_mfma_f32_16x16x32_bf16 v[156:159], a[240:243], a[172:175], v[156:159]
s_waitcnt lgkmcnt(3)
ds_read_b32 a189, v58
buffer_load_dwordx4 v[84:87], v12, s[24:27], 0 offen offset:1024 sc1
v_mfma_f32_16x16x32_bf16 v[192:195], a[244:247], a[128:131], v[192:195]
s_or_b64 s[50:51], s[44:45], s[50:51]
ds_read_b128 a[252:255], v14 offset:2048
v_perm_b32 v57, v37, v19, s54
v_mfma_f32_16x16x32_bf16 v[196:199], a[244:247], a[132:135], v[196:199]
s_cbranch_scc1 L_SLOW27
L_BACK27:
v_mfma_f32_16x16x32_bf16 v[200:203], a[244:247], a[136:139], v[200:203]
s_add_u32 m0, s33, 108800
ds_read_b32 a190, v57
v_perm_b32 v56, v37, v19, s55
v_mfma_f32_16x16x32_bf16 v[204:207], a[244:247], a[140:143], v[204:207]
s_waitcnt lgkmcnt(3)
ds_read_b32 a191, v56
v_perm_b32 v63, v40, v19, s52
v_mfma_f32_16x16x32_bf16 v[208:211], a[248:251], a[112:115], v[208:211]
ds_read_b128 a[240:243], v17 offset:28672
buffer_load_dwordx4 v10, s[20:23], 0 offen offset:1792 lds
v_mfma_f32_16x16x32_bf16 v[212:215], a[248:251], a[116:119], v[212:215]
ds_read_b32 a192, v63
v_perm_b32 v62, v40, v19, s53
v_mfma_f32_16x16x32_bf16 v[216:219], a[248:251], a[120:123], v[216:219]
ds_read_b32 a193, v62
v_perm_b32 v61, v44, v19, s52
v_mfma_f32_16x16x32_bf16 v[220:223], a[248:251], a[124:127], v[220:223]
s_waitcnt lgkmcnt(4)
ds_read_b32 a194, v61
v_mfma_f32_16x16x32_bf16 v[176:179], a[252:255], a[144:147], v[176:179]
s_barrier
ds_read_b128 a[244:247], v14 offset:4096
v_perm_b32 v60, v44, v19, s53
v_mfma_f32_16x16x32_bf16 v[180:183], a[252:255], a[148:151], v[180:183]
ds_read_b32 a195, v60
v_perm_b32 v59, v40, v19, s54
v_mfma_f32_16x16x32_bf16 v[184:187], a[252:255], a[152:155], v[184:187]
ds_read_b32 a196, v59
v_perm_b32 v58, v40, v19, s55
v_mfma_f32_16x16x32_bf16 v[188:191], a[252:255], a[156:159], v[188:191]
s_waitcnt lgkmcnt(4)
ds_read_b32 a197, v58
v_mfma_f32_16x16x32_bf16 v[224:227], a[240:243], a[96:99], v[224:227]
ds_read_b128 a[248:251], v15 offset:0
v_perm_b32 v57, v44, v19, s54
v_mfma_f32_16x16x32_bf16 v[228:231], a[240:243], a[100:103], v[228:231]
ds_read_b32 a198, v57
v_perm_b32 v56, v44, v19, s55
v_mfma_f32_16x16x32_bf16 v[232:235], a[240:243], a[104:107], v[232:235]
ds_read_b32 a199, v56
v_perm_b32 v63, v41, v19, s52
v_mfma_f32_16x16x32_bf16 v[236:239], a[240:243], a[108:111], v[236:239]
s_waitcnt lgkmcnt(4)
ds_read_b32 a200, v63
v_mfma_f32_16x16x32_bf16 v[128:131], a[244:247], a[176:179], v[128:131]
ds_read_b128 a[252:255], v14 offset:6144
v_perm_b32 v62, v41, v19, s53
v_mfma_f32_16x16x32_bf16 v[132:135], a[244:247], a[180:183], v[132:135]
ds_read_b32 a201, v62
v_perm_b32 v61, v45, v19, s52
v_mfma_f32_16x16x32_bf16 v[136:139], a[244:247], a[184:187], v[136:139]
s_add_u32 m0, s33, 113024
ds_read_b32 a202, v61
v_perm_b32 v60, v45, v19, s53
v_mfma_f32_16x16x32_bf16 v[140:143], a[244:247], a[188:191], v[140:143]
s_waitcnt lgkmcnt(4)
ds_read_b32 a203, v60
v_perm_b32 v59, v41, v19, s54
v_mfma_f32_16x16x32_bf16 v[160:163], a[248:251], a[160:163], v[160:163]
ds_read_b128 a[240:243], v14 offset:8192
buffer_load_dwordx4 v11, s[20:23], 0 offen offset:1664 lds
v_mfma_f32_16x16x32_bf16 v[164:167], a[248:251], a[164:167], v[164:167]
ds_read_b32 a204, v59
v_perm_b32 v58, v41, v19, s55
v_mfma_f32_16x16x32_bf16 v[168:171], a[248:251], a[168:171], v[168:171]
ds_read_b32 a205, v58
v_perm_b32 v57, v45, v19, s54
v_mfma_f32_16x16x32_bf16 v[172:175], a[248:251], a[172:175], v[172:175]
s_waitcnt lgkmcnt(4)
ds_read_b32 a206, v57
buffer_load_dwordx4 v[88:91], v12, s[24:27], 0 offen offset:2048 sc1
v_mfma_f32_16x16x32_bf16 v[144:147], a[252:255], a[176:179], v[144:147]
ds_read_b128 a[244:247], v15 offset:4096
v_perm_b32 v56, v45, v19, s55
v_mfma_f32_16x16x32_bf16 v[148:151], a[252:255], a[180:183], v[148:151]
ds_read_b32 a207, v56
buffer_load_dwordx4 v[92:95], v12, s[24:27], 0 offen offset:3072 sc1
v_mfma_f32_16x16x32_bf16 v[152:155], a[252:255], a[184:187], v[152:155]
s_waitcnt vmcnt(11)
v_cmp_ne_u64 s[50:51], s[88:89], v[50:51]
v_cmp_ne_u64 s[44:45], s[88:89], v[54:55]
v_mfma_f32_16x16x32_bf16 v[156:159], a[252:255], a[188:191], v[156:159]
s_waitcnt lgkmcnt(3)
v_mfma_f32_16x16x32_bf16 v[192:195], a[240:243], a[144:147], v[192:195]
s_or_b64 s[50:51], s[44:45], s[50:51]
ds_read_b128 a[248:251], v15 offset:2048
v_mfma_f32_16x16x32_bf16 v[196:199], a[240:243], a[148:151], v[196:199]
s_cbranch_scc1 L_SLOW28
L_BACK28:
v_mfma_f32_16x16x32_bf16 v[200:203], a[240:243], a[152:155], v[200:203]
s_add_u32 m0, s33, 116864
v_perm_b32 v63, v48, v19, s52
v_mfma_f32_16x16x32_bf16 v[204:207], a[240:243], a[156:159], v[204:207]
s_waitcnt lgkmcnt(1)
ds_read_b32 a208, v63
v_perm_b32 v62, v48, v19, s53
v_mfma_f32_16x16x32_bf16 v[128:131], a[244:247], a[192:195], v[128:131]
ds_read_b128 a[252:255], v17 offset:26624
buffer_load_dwordx4 v10, s[20:23], 0 offen offset:1920 lds
v_mfma_f32_16x16x32_bf16 v[132:135], a[244:247], a[196:199], v[132:135]
ds_read_b32 a209, v62
v_perm_b32 v61, v52, v19, s52
v_mfma_f32_16x16x32_bf16 v[136:139], a[244:247], a[200:203], v[136:139]
ds_read_b32 a210, v61
v_perm_b32 v60, v52, v19, s53
v_mfma_f32_16x16x32_bf16 v[140:143], a[244:247], a[204:207], v[140:143]
s_waitcnt lgkmcnt(4)
ds_read_b32 a211, v60
v_mfma_f32_16x16x32_bf16 v[176:179], a[248:251], a[160:163], v[176:179]
ds_read_b128 a[240:243], v14 offset:12288
v_perm_b32 v59, v48, v19, s54
v_mfma_f32_16x16x32_bf16 v[180:183], a[248:251], a[164:167], v[180:183]
ds_read_b32 a212, v59
v_perm_b32 v58, v48, v19, s55
v_mfma_f32_16x16x32_bf16 v[184:187], a[248:251], a[168:171], v[184:187]
ds_read_b32 a213, v58
v_perm_b32 v57, v52, v19, s54
v_mfma_f32_16x16x32_bf16 v[188:191], a[248:251], a[172:175], v[188:191]
s_waitcnt lgkmcnt(4)
ds_read_b32 a214, v57
v_mfma_f32_16x16x32_bf16 v[208:211], a[252:255], a[128:131], v[208:211]
ds_read_b128 a[244:247], v16 offset:6144
v_perm_b32 v56, v52, v19, s55
v_mfma_f32_16x16x32_bf16 v[212:215], a[252:255], a[132:135], v[212:215]
ds_read_b32 a215, v56
v_perm_b32 v63, v49, v19, s52
v_mfma_f32_16x16x32_bf16 v[216:219], a[252:255], a[136:139], v[216:219]
s_add_u32 m0, s33, 121088
ds_read_b32 a216, v63
v_perm_b32 v62, v49, v19, s53
v_mfma_f32_16x16x32_bf16 v[220:223], a[252:255], a[140:143], v[220:223]
s_waitcnt lgkmcnt(4)
ds_read_b32 a217, v62
v_perm_b32 v61, v53, v19, s52
v_mfma_f32_16x16x32_bf16 v[160:163], a[240:243], a[176:179], v[160:163]
ds_read_b128 a[248:251], v14 offset:16384
buffer_load_dwordx4 v11, s[20:23], 0 offen offset:1792 lds
v_mfma_f32_16x16x32_bf16 v[164:167], a[240:243], a[180:183], v[164:167]
ds_read_b32 a218, v61
v_perm_b32 v60, v53, v19, s53
v_mfma_f32_16x16x32_bf16 v[168:171], a[240:243], a[184:187], v[168:171]
ds_read_b32 a219, v60
v_perm_b32 v59, v49, v19, s54
v_mfma_f32_16x16x32_bf16 v[172:175], a[240:243], a[188:191], v[172:175]
s_waitcnt lgkmcnt(4)
ds_read_b32 a220, v59
v_mfma_f32_16x16x32_bf16 v[240:243], a[244:247], a[48:51], v[240:243]
ds_read_b128 a[252:255], v15 offset:6144
v_perm_b32 v58, v49, v19, s55
v_mfma_f32_16x16x32_bf16 v[244:247], a[244:247], a[52:55], v[244:247]
ds_read_b32 a221, v58
v_perm_b32 v57, v53, v19, s54
v_mfma_f32_16x16x32_bf16 v[248:251], a[244:247], a[56:59], v[248:251]
s_waitcnt vmcnt(9)
v_cmp_ne_u64 s[50:51], s[88:89], v[98:99]
v_cmp_ne_u64 s[44:45], s[88:89], v[102:103]
v_mfma_f32_16x16x32_bf16 v[252:255], a[244:247], a[60:63], v[252:255]
s_waitcnt lgkmcnt(3)
ds_read_b32 a222, v57
v_mfma_f32_16x16x32_bf16 v[224:227], a[248:251], a[112:115], v[224:227]
s_or_b64 s[50:51], s[44:45], s[50:51]
ds_read_b128 a[240:243], v14 offset:20480
v_perm_b32 v56, v53, v19, s55
v_mfma_f32_16x16x32_bf16 v[228:231], a[248:251], a[116:119], v[228:231]
s_cbranch_scc1 L_SLOW29
L_BACK29:
v_mfma_f32_16x16x32_bf16 v[232:235], a[248:251], a[120:123], v[232:235]
s_add_u32 m0, s33, 125056
ds_read_b32 a223, v56
v_mfma_f32_16x16x32_bf16 v[236:239], a[248:251], a[124:127], v[236:239]
s_waitcnt lgkmcnt(3)
v_mfma_f32_16x16x32_bf16 v[144:147], a[252:255], a[192:195], v[144:147]
ds_read_b128 a[244:247], v15 offset:8192
buffer_load_dwordx4 v11, s[20:23], 0 offen offset:1920 lds
v_mfma_f32_16x16x32_bf16 v[148:151], a[252:255], a[196:199], v[148:151]
v_perm_b32 v63, v96, v19, s52
v_mfma_f32_16x16x32_bf16 v[152:155], a[252:255], a[200:203], v[152:155]
ds_read_b32 a224, v63
v_perm_b32 v62, v96, v19, s53
v_mfma_f32_16x16x32_bf16 v[156:159], a[252:255], a[204:207], v[156:159]
s_waitcnt lgkmcnt(2)
ds_read_b32 a225, v62
v_mfma_f32_16x16x32_bf16 v[128:131], a[240:243], a[208:211], v[128:131]
ds_read_b128 a[248:251], v14 offset:14336
v_perm_b32 v61, v100, v19, s52
v_mfma_f32_16x16x32_bf16 v[132:135], a[240:243], a[212:215], v[132:135]
ds_read_b32 a226, v61
v_perm_b32 v60, v100, v19, s53
v_mfma_f32_16x16x32_bf16 v[136:139], a[240:243], a[216:219], v[136:139]
ds_read_b32 a227, v60
v_perm_b32 v59, v96, v19, s54
v_mfma_f32_16x16x32_bf16 v[140:143], a[240:243], a[220:223], v[140:143]
s_waitcnt lgkmcnt(4)
ds_read_b32 a228, v59
v_mfma_f32_16x16x32_bf16 v[192:195], a[244:247], a[160:163], v[192:195]
ds_read_b128 a[252:255], v15 offset:12288
v_perm_b32 v58, v96, v19, s55
v_mfma_f32_16x16x32_bf16 v[196:199], a[244:247], a[164:167], v[196:199]
ds_read_b32 a229, v58
v_perm_b32 v57, v100, v19, s54
v_mfma_f32_16x16x32_bf16 v[200:203], a[244:247], a[168:171], v[200:203]
ds_read_b32 a230, v57
v_perm_b32 v56, v100, v19, s55
v_mfma_f32_16x16x32_bf16 v[204:207], a[244:247], a[172:175], v[204:207]
s_waitcnt lgkmcnt(4)
ds_read_b32 a231, v56
v_mfma_f32_16x16x32_bf16 v[176:179], a[248:251], a[176:179], v[176:179]
ds_read_b128 a[240:243], v14 offset:10240
v_perm_b32 v63, v97, v19, s52
v_mfma_f32_16x16x32_bf16 v[180:183], a[248:251], a[180:183], v[180:183]
ds_read_b32 a232, v63
v_perm_b32 v62, v97, v19, s53
v_mfma_f32_16x16x32_bf16 v[184:187], a[248:251], a[184:187], v[184:187]
ds_read_b32 a233, v62
v_perm_b32 v61, v101, v19, s52
v_mfma_f32_16x16x32_bf16 v[188:191], a[248:251], a[188:191], v[188:191]
s_waitcnt lgkmcnt(4)
ds_read_b32 a234, v61
v_mfma_f32_16x16x32_bf16 v[160:163], a[252:255], a[192:195], v[160:163]
s_waitcnt vmcnt(9)
s_barrier
ds_read_b128 a[244:247], v14 offset:22528
v_perm_b32 v60, v101, v19, s53
v_mfma_f32_16x16x32_bf16 v[164:167], a[252:255], a[196:199], v[164:167]
ds_read_b32 a235, v60
v_perm_b32 v59, v97, v19, s54
v_mfma_f32_16x16x32_bf16 v[168:171], a[252:255], a[200:203], v[168:171]
ds_read_b32 a236, v59
v_perm_b32 v58, v97, v19, s55
v_mfma_f32_16x16x32_bf16 v[172:175], a[252:255], a[204:207], v[172:175]
s_waitcnt lgkmcnt(4)
ds_read_b32 a237, v58
v_mfma_f32_16x16x32_bf16 v[208:211], a[240:243], a[144:147], v[208:211]
ds_read_b128 a[248:251], v15 offset:20480
v_perm_b32 v57, v101, v19, s54
v_mfma_f32_16x16x32_bf16 v[212:215], a[240:243], a[148:151], v[212:215]
ds_read_b32 a238, v57
v_perm_b32 v56, v101, v19, s55
v_mfma_f32_16x16x32_bf16 v[216:219], a[240:243], a[152:155], v[216:219]
ds_read_b32 a239, v56
v_mfma_f32_16x16x32_bf16 v[220:223], a[240:243], a[156:159], v[220:223]
s_waitcnt vmcnt(7) lgkmcnt(4)
v_cmp_ne_u64 s[50:51], s[88:89], v[82:83]
v_cmp_ne_u64 s[44:45], s[88:89], v[86:87]
v_mfma_f32_16x16x32_bf16 v[144:147], a[244:247], a[208:211], v[144:147]
ds_read_b128 a[252:255], v15 offset:16384
v_mfma_f32_16x16x32_bf16 v[148:151], a[244:247], a[212:215], v[148:151]
s_or_b64 s[50:51], s[44:45], s[50:51]
v_mfma_f32_16x16x32_bf16 v[152:155], a[244:247], a[216:219], v[152:155]
s_cbranch_scc1 L_SLOW30
L_BACK30:
v_mfma_f32_16x16x32_bf16 v[156:159], a[244:247], a[220:223], v[156:159]
s_waitcnt lgkmcnt(1)
v_mfma_f32_16x16x32_bf16 v[128:131], a[248:251], a[224:227], v[128:131]
ds_read_b128 a[240:243], v15 offset:14336
v_mfma_f32_16x16x32_bf16 v[132:135], a[248:251], a[228:231], v[132:135]
v_perm_b32 v63, v80, v19, s52
v_mfma_f32_16x16x32_bf16 v[136:139], a[248:251], a[232:235], v[136:139]
ds_read_b32 a0, v63
v_perm_b32 v62, v80, v19, s53
v_mfma_f32_16x16x32_bf16 v[140:143], a[248:251], a[236:239], v[140:143]
s_waitcnt lgkmcnt(2)
ds_read_b32 a1, v62
v_mfma_f32_16x16x32_bf16 v[224:227], a[252:255], a[128:131], v[224:227]
ds_read_b128 a[244:247], v14 offset:24576
v_perm_b32 v61, v84, v19, s52
v_mfma_f32_16x16x32_bf16 v[228:231], a[252:255], a[132:135], v[228:231]
ds_read_b32 a2, v61
v_perm_b32 v60, v84, v19, s53
v_mfma_f32_16x16x32_bf16 v[232:235], a[252:255], a[136:139], v[232:235]
ds_read_b32 a3, v60
v_perm_b32 v59, v80, v19, s54
v_mfma_f32_16x16x32_bf16 v[236:239], a[252:255], a[140:143], v[236:239]
s_waitcnt lgkmcnt(4)
ds_read_b32 a4, v59
v_mfma_f32_16x16x32_bf16 v[176:179], a[240:243], a[192:195], v[176:179]
ds_read_b128 a[248:251], v14 offset:28672
v_perm_b32 v58, v80, v19, s55
v_mfma_f32_16x16x32_bf16 v[180:183], a[240:243], a[196:199], v[180:183]
ds_read_b32 a5, v58
v_perm_b32 v57, v84, v19, s54
v_mfma_f32_16x16x32_bf16 v[184:187], a[240:243], a[200:203], v[184:187]
ds_read_b32 a6, v57
v_perm_b32 v56, v84, v19, s55
v_mfma_f32_16x16x32_bf16 v[188:191], a[240:243], a[204:207], v[188:191]
s_waitcnt lgkmcnt(4)
ds_read_b32 a7, v56
v_mfma_f32_16x16x32_bf16 v[192:195], a[244:247], a[176:179], v[192:195]
ds_read_b128 a[252:255], v15 offset:22528
v_perm_b32 v63, v81, v19, s52
v_mfma_f32_16x16x32_bf16 v[196:199], a[244:247], a[180:183], v[196:199]
ds_read_b32 a8, v63
v_perm_b32 v62, v81, v19, s53
v_mfma_f32_16x16x32_bf16 v[200:203], a[244:247], a[184:187], v[200:203]
ds_read_b32 a9, v62
v_perm_b32 v61, v85, v19, s52
v_mfma_f32_16x16x32_bf16 v[204:207], a[244:247], a[188:191], v[204:207]
s_waitcnt lgkmcnt(4)
ds_read_b32 a10, v61
v_mfma_f32_16x16x32_bf16 v[160:163], a[248:251], a[208:211], v[160:163]
ds_read_b128 a[240:243], v15 offset:10240
v_perm_b32 v60, v85, v19, s53
v_mfma_f32_16x16x32_bf16 v[164:167], a[248:251], a[212:215], v[164:167]
ds_read_b32 a11, v60
v_perm_b32 v59, v81, v19, s54
v_mfma_f32_16x16x32_bf16 v[168:171], a[248:251], a[216:219], v[168:171]
ds_read_b32 a12, v59
v_perm_b32 v58, v81, v19, s55
v_mfma_f32_16x16x32_bf16 v[172:175], a[248:251], a[220:223], v[172:175]
s_waitcnt lgkmcnt(4)
ds_read_b32 a13, v58
v_mfma_f32_16x16x32_bf16 v[144:147], a[252:255], a[224:227], v[144:147]
ds_read_b128 a[244:247], v14 offset:32768
v_perm_b32 v57, v85, v19, s54
v_mfma_f32_16x16x32_bf16 v[148:151], a[252:255], a[228:231], v[148:151]
ds_read_b32 a14, v57
v_perm_b32 v56, v85, v19, s55
v_mfma_f32_16x16x32_bf16 v[152:155], a[252:255], a[232:235], v[152:155]
ds_read_b32 a15, v56
v_mfma_f32_16x16x32_bf16 v[156:159], a[252:255], a[236:239], v[156:159]
s_waitcnt vmcnt(3) lgkmcnt(4)
v_cmp_ne_u64 s[50:51], s[88:89], v[90:91]
v_cmp_ne_u64 s[44:45], s[88:89], v[94:95]
v_mfma_f32_16x16x32_bf16 v[208:211], a[240:243], a[160:163], v[208:211]
ds_read_b128 a[248:251], v17 offset:6144
v_mfma_f32_16x16x32_bf16 v[212:215], a[240:243], a[164:167], v[212:215]
s_or_b64 s[50:51], s[44:45], s[50:51]
v_mfma_f32_16x16x32_bf16 v[216:219], a[240:243], a[168:171], v[216:219]
s_cbranch_scc1 L_SLOW31
L_BACK31:
v_mfma_f32_16x16x32_bf16 v[220:223], a[240:243], a[172:175], v[220:223]
s_waitcnt lgkmcnt(1)
v_mfma_f32_16x16x32_bf16 v[128:131], a[244:247], a[0:3], v[128:131]
ds_read_b128 a[252:255], v14 offset:30720
v_mfma_f32_16x16x32_bf16 v[132:135], a[244:247], a[4:7], v[132:135]
v_perm_b32 v63, v88, v19, s52
v_mfma_f32_16x16x32_bf16 v[136:139], a[244:247], a[8:11], v[136:139]
ds_read_b32 a16, v63
v_perm_b32 v62, v88, v19, s53
v_mfma_f32_16x16x32_bf16 v[140:143], a[244:247], a[12:15], v[140:143]
s_waitcnt lgkmcnt(2)
ds_read_b32 a17, v62
v_mfma_f32_16x16x32_bf16 v[240:243], a[248:251], a[64:67], v[240:243]
ds_read_b128 a[240:243], v15 offset:28672
v_perm_b32 v61, v92, v19, s52
v_mfma_f32_16x16x32_bf16 v[244:247], a[248:251], a[68:71], v[244:247]
ds_read_b32 a18, v61
v_perm_b32 v60, v92, v19, s53
v_mfma_f32_16x16x32_bf16 v[248:251], a[248:251], a[72:75], v[248:251]
ds_read_b32 a19, v60
v_perm_b32 v59, v88, v19, s54
v_mfma_f32_16x16x32_bf16 v[252:255], a[248:251], a[76:79], v[252:255]
s_waitcnt lgkmcnt(4)
ds_read_b32 a20, v59
v_mfma_f32_16x16x32_bf16 v[176:179], a[252:255], a[208:211], v[176:179]
ds_read_b128 a[244:247], v15 offset:24576
v_perm_b32 v58, v88, v19, s55
v_mfma_f32_16x16x32_bf16 v[180:183], a[252:255], a[212:215], v[180:183]
ds_read_b32 a21, v58
v_perm_b32 v57, v92, v19, s54
v_mfma_f32_16x16x32_bf16 v[184:187], a[252:255], a[216:219], v[184:187]
ds_read_b32 a22, v57
v_perm_b32 v56, v92, v19, s55
v_mfma_f32_16x16x32_bf16 v[188:191], a[252:255], a[220:223], v[188:191]
s_waitcnt lgkmcnt(4)
ds_read_b32 a23, v56
v_mfma_f32_16x16x32_bf16 v[160:163], a[240:243], a[224:227], v[160:163]
ds_read_b128 a[248:251], v14 offset:36864
v_perm_b32 v63, v89, v19, s52
v_mfma_f32_16x16x32_bf16 v[164:167], a[240:243], a[228:231], v[164:167]
L_PAD5:
s_cbranch_vccnz L_PADRET
ds_read_b32 a24, v63
v_perm_b32 v62, v89, v19, s53
v_mfma_f32_16x16x32_bf16 v[168:171], a[240:243], a[232:235], v[168:171]
ds_read_b32 a25, v62
v_perm_b32 v61, v93, v19, s52
v_mfma_f32_16x16x32_bf16 v[172:175], a[240:243], a[236:239], v[172:175]
s_waitcnt lgkmcnt(4)
ds_read_b32 a26, v61
v_mfma_f32_16x16x32_bf16 v[192:195], a[244:247], a[192:195], v[192:195]
ds_read_b128 a[252:255], v14 offset:34816
v_perm_b32 v60, v93, v19, s53
v_mfma_f32_16x16x32_bf16 v[196:199], a[244:247], a[196:199], v[196:199]
ds_read_b32 a27, v60
v_perm_b32 v59, v89, v19, s54
v_mfma_f32_16x16x32_bf16 v[200:203], a[244:247], a[200:203], v[200:203]
ds_read_b32 a28, v59
v_perm_b32 v58, v89, v19, s55
v_mfma_f32_16x16x32_bf16 v[204:207], a[244:247], a[204:207], v[204:207]
s_waitcnt lgkmcnt(4)
ds_read_b32 a29, v58
v_mfma_f32_16x16x32_bf16 v[224:227], a[248:251], a[144:147], v[224:227]
ds_read_b128 a[240:243], v15 offset:32768
v_perm_b32 v57, v93, v19, s54
v_mfma_f32_16x16x32_bf16 v[228:231], a[248:251], a[148:151], v[228:231]
ds_read_b32 a30, v57
v_perm_b32 v56, v93, v19, s55
v_mfma_f32_16x16x32_bf16 v[232:235], a[248:251], a[152:155], v[232:235]
ds_read_b32 a31, v56
v_mfma_f32_16x16x32_bf16 v[236:239], a[248:251], a[156:159], v[236:239]
s_waitcnt lgkmcnt(4)
v_mfma_f32_16x16x32_bf16 v[144:147], a[252:255], a[0:3], v[144:147]
ds_read_b128 a[244:247], v14 offset:26624
v_mfma_f32_16x16x32_bf16 v[148:151], a[252:255], a[4:7], v[148:151]
v_mfma_f32_16x16x32_bf16 v[152:155], a[252:255], a[8:11], v[152:155]
v_mfma_f32_16x16x32_bf16 v[156:159], a[252:255], a[12:15], v[156:159]
s_waitcnt lgkmcnt(1)
v_mfma_f32_16x16x32_bf16 v[128:131], a[240:243], a[16:19], v[128:131]
ds_read_b128 a[248:251], v15 offset:30720
v_mfma_f32_16x16x32_bf16 v[132:135], a[240:243], a[20:23], v[132:135]
v_mfma_f32_16x16x32_bf16 v[136:139], a[240:243], a[24:27], v[136:139]
v_mfma_f32_16x16x32_bf16 v[140:143], a[240:243], a[28:31], v[140:143]
s_waitcnt lgkmcnt(1)
v_mfma_f32_16x16x32_bf16 v[208:211], a[244:247], a[176:179], v[208:211]
ds_read_b128 a[252:255], v14 offset:40960
v_mfma_f32_16x16x32_bf16 v[212:215], a[244:247], a[180:183], v[212:215]
v_mfma_f32_16x16x32_bf16 v[216:219], a[244:247], a[184:187], v[216:219]
v_mfma_f32_16x16x32_bf16 v[220:223], a[244:247], a[188:191], v[220:223]
s_waitcnt lgkmcnt(1)
v_mfma_f32_16x16x32_bf16 v[176:179], a[248:251], a[224:227], v[176:179]
s_waitcnt vmcnt(0)
s_barrier
ds_read_b128 a[240:243], v15 offset:34816
v_mfma_f32_16x16x32_bf16 v[180:183], a[248:251], a[228:231], v[180:183]
v_mfma_f32_16x16x32_bf16 v[184:187], a[248:251], a[232:235], v[184:187]
v_mfma_f32_16x16x32_bf16 v[188:191], a[248:251], a[236:239], v[188:191]
s_waitcnt lgkmcnt(1)
v_mul_f32 v128, v128, v24
v_mul_f32 v132, v132, v25
v_mfma_f32_16x16x32_bf16 v[160:163], a[252:255], a[0:3], v[160:163]
ds_read_b128 a[244:247], v14 offset:45056
v_mul_f32 v136, v136, v26
v_mfma_f32_16x16x32_bf16 v[164:167], a[252:255], a[4:7], v[164:167]
v_mul_f32 v140, v140, v27
v_cvt_pk_bf16_f32 v120, v128, v132
v_mfma_f32_16x16x32_bf16 v[168:171], a[252:255], a[8:11], v[168:171]
v_cvt_pk_bf16_f32 v121, v136, v140
v_mfma_f32_16x16x32_bf16 v[172:175], a[252:255], a[12:15], v[172:175]
s_waitcnt lgkmcnt(1)
v_mfma_f32_16x16x32_bf16 v[144:147], a[240:243], a[16:19], v[144:147]
ds_read_b128 a[248:251], v15 offset:36864
v_mfma_f32_16x16x32_bf16 v[148:151], a[240:243], a[20:23], v[148:151]
buffer_store_dwordx2 v[120:121], v18, s[28:31], 0 offen nt
v_mul_f32 v129, v129, v24
v_mfma_f32_16x16x32_bf16 v[152:155], a[240:243], a[24:27], v[152:155]
s_add_u32 s28, s28, 7168
v_mul_f32 v133, v133, v25
v_mul_f32 v137, v137, v26
v_mfma_f32_16x16x32_bf16 v[156:159], a[240:243], a[28:31], v[156:159]
s_waitcnt lgkmcnt(1)
v_mul_f32 v141, v141, v27
v_cvt_pk_bf16_f32 v122, v129, v133
v_mfma_f32_16x16x32_bf16 v[192:195], a[244:247], a[208:211], v[192:195]
s_addc_u32 s29, s29, 0
ds_read_b128 a[252:255], v15 offset:26624
v_cvt_pk_bf16_f32 v123, v137, v141
v_mfma_f32_16x16x32_bf16 v[196:199], a[244:247], a[212:215], v[196:199]
buffer_store_dwordx2 v[122:123], v18, s[28:31], 0 offen nt
v_mul_f32 v130, v130, v24
v_mfma_f32_16x16x32_bf16 v[200:203], a[244:247], a[216:219], v[200:203]
s_add_u32 s28, s28, 7168
v_mul_f32 v134, v134, v25
v_mul_f32 v138, v138, v26
v_mfma_f32_16x16x32_bf16 v[204:207], a[244:247], a[220:223], v[204:207]
s_waitcnt lgkmcnt(1)
v_mul_f32 v142, v142, v27
v_cvt_pk_bf16_f32 v124, v130, v134
v_mfma_f32_16x16x32_bf16 v[224:227], a[248:251], a[160:163], v[224:227]
s_addc_u32 s29, s29, 0
ds_read_b128 a[240:243], v16 offset:30720
v_cvt_pk_bf16_f32 v125, v138, v142
v_mfma_f32_16x16x32_bf16 v[228:231], a[248:251], a[164:167], v[228:231]
buffer_store_dwordx2 v[124:125], v18, s[28:31], 0 offen nt
v_mul_f32 v131, v131, v24
v_mfma_f32_16x16x32_bf16 v[232:235], a[248:251], a[168:171], v[232:235]
s_add_u32 s28, s28, 7168
v_mul_f32 v135, v135, v25
v_mul_f32 v139, v139, v26
v_mfma_f32_16x16x32_bf16 v[236:239], a[248:251], a[172:175], v[236:239]
s_waitcnt lgkmcnt(1)
v_mul_f32 v143, v143, v27
v_cvt_pk_bf16_f32 v126, v131, v135
v_mfma_f32_16x16x32_bf16 v[208:211], a[252:255], a[192:195], v[208:211]
s_addc_u32 s29, s29, 0
ds_read_b128 a[244:247], v15 offset:40960
v_cvt_pk_bf16_f32 v127, v139, v143
v_mfma_f32_16x16x32_bf16 v[212:215], a[252:255], a[196:199], v[212:215]
buffer_store_dwordx2 v[126:127], v18, s[28:31], 0 offen nt
v_mul_f32 v144, v144, v24
v_mfma_f32_16x16x32_bf16 v[216:219], a[252:255], a[200:203], v[216:219]
s_add_u32 s28, s28, 93184
v_mul_f32 v148, v148, v25
v_mul_f32 v152, v152, v26
v_mfma_f32_16x16x32_bf16 v[220:223], a[252:255], a[204:207], v[220:223]
s_waitcnt lgkmcnt(1)
v_mul_f32 v156, v156, v27
v_cvt_pk_bf16_f32 v120, v144, v148
v_mfma_f32_16x16x32_bf16 v[240:243], a[240:243], a[80:83], v[240:243]
s_addc_u32 s29, s29, 0
ds_read_b128 a[248:251], v14 offset:43008
v_cvt_pk_bf16_f32 v121, v152, v156
v_mfma_f32_16x16x32_bf16 v[244:247], a[240:243], a[84:87], v[244:247]
buffer_store_dwordx2 v[120:121], v18, s[28:31], 0 offen nt
v_mul_f32 v145, v145, v24
v_mfma_f32_16x16x32_bf16 v[248:251], a[240:243], a[88:91], v[248:251]
s_add_u32 s28, s28, 7168
v_mul_f32 v149, v149, v25
v_mul_f32 v153, v153, v26
v_mfma_f32_16x16x32_bf16 v[252:255], a[240:243], a[92:95], v[252:255]
s_waitcnt lgkmcnt(1)
v_mul_f32 v157, v157, v27
v_cvt_pk_bf16_f32 v122, v145, v149
v_mfma_f32_16x16x32_bf16 v[160:163], a[244:247], a[16:19], v[160:163]
s_addc_u32 s29, s29, 0
ds_read_b128 a[252:255], v15 offset:45056
v_cvt_pk_bf16_f32 v123, v153, v157
v_mfma_f32_16x16x32_bf16 v[164:167], a[244:247], a[20:23], v[164:167]
buffer_store_dwordx2 v[122:123], v18, s[28:31], 0 offen nt
v_mul_f32 v146, v146, v24
v_mfma_f32_16x16x32_bf16 v[168:171], a[244:247], a[24:27], v[168:171]
s_add_u32 s28, s28, 7168
v_mul_f32 v150, v150, v25
v_mul_f32 v154, v154, v26
v_mfma_f32_16x16x32_bf16 v[172:175], a[244:247], a[28:31], v[172:175]
s_waitcnt lgkmcnt(1)
v_mul_f32 v158, v158, v27
v_cvt_pk_bf16_f32 v124, v146, v150
v_mfma_f32_16x16x32_bf16 v[176:179], a[248:251], a[0:3], v[176:179]
s_addc_u32 s29, s29, 0
ds_read_b128 a[240:243], v14 offset:49152
v_cvt_pk_bf16_f32 v125, v154, v158
v_mfma_f32_16x16x32_bf16 v[180:183], a[248:251], a[4:7], v[180:183]
buffer_store_dwordx2 v[124:125], v18, s[28:31], 0 offen nt
v_mul_f32 v147, v147, v24
v_mfma_f32_16x16x32_bf16 v[184:187], a[248:251], a[8:11], v[184:187]
s_add_u32 s28, s28, 7168
v_mul_f32 v151, v151, v25
v_mul_f32 v155, v155, v26
v_mfma_f32_16x16x32_bf16 v[188:191], a[248:251], a[12:15], v[188:191]
s_waitcnt lgkmcnt(1)
v_mul_f32 v159, v159, v27
v_cvt_pk_bf16_f32 v126, v147, v151
v_mfma_f32_16x16x32_bf16 v[192:195], a[252:255], a[224:227], v[192:195]
s_addc_u32 s29, s29, 0
ds_read_b128 a[244:247], v14 offset:47104
v_cvt_pk_bf16_f32 v127, v155, v159
v_mfma_f32_16x16x32_bf16 v[196:199], a[252:255], a[228:231], v[196:199]
buffer_store_dwordx2 v[126:127], v18, s[28:31], 0 offen nt
v_mfma_f32_16x16x32_bf16 v[200:203], a[252:255], a[232:235], v[200:203]
v_mfma_f32_16x16x32_bf16 v[204:207], a[252:255], a[236:239], v[204:207]
s_waitcnt lgkmcnt(1)
v_mul_f32 v160, v160, v24
v_mul_f32 v164, v164, v25
v_mfma_f32_16x16x32_bf16 v[224:227], a[240:243], a[176:179], v[224:227]
s_add_u32 s28, s28, 93184
ds_read_b128 a[248:251], v15 offset:43008
v_mul_f32 v168, v168, v26
v_mfma_f32_16x16x32_bf16 v[228:231], a[240:243], a[180:183], v[228:231]
s_addc_u32 s29, s29, 0
v_mul_f32 v172, v172, v27
v_cvt_pk_bf16_f32 v120, v160, v164
v_mfma_f32_16x16x32_bf16 v[232:235], a[240:243], a[184:187], v[232:235]
v_cvt_pk_bf16_f32 v121, v168, v172
v_mfma_f32_16x16x32_bf16 v[236:239], a[240:243], a[188:191], v[236:239]
s_waitcnt lgkmcnt(1)
v_mfma_f32_16x16x32_bf16 v[208:211], a[244:247], a[208:211], v[208:211]
ds_read_b128 a[252:255], v14 offset:53248
v_mfma_f32_16x16x32_bf16 v[212:215], a[244:247], a[212:215], v[212:215]
buffer_store_dwordx2 v[120:121], v18, s[28:31], 0 offen nt
v_mul_f32 v161, v161, v24
v_mfma_f32_16x16x32_bf16 v[216:219], a[244:247], a[216:219], v[216:219]
s_add_u32 s28, s28, 7168
v_mul_f32 v165, v165, v25
v_mul_f32 v169, v169, v26
v_mfma_f32_16x16x32_bf16 v[220:223], a[244:247], a[220:223], v[220:223]
s_waitcnt lgkmcnt(1)
v_mul_f32 v173, v173, v27
v_cvt_pk_bf16_f32 v122, v161, v165
v_mfma_f32_16x16x32_bf16 v[176:179], a[248:251], a[16:19], v[176:179]
s_addc_u32 s29, s29, 0
ds_read_b128 a[240:243], v17 offset:30720
v_cvt_pk_bf16_f32 v123, v169, v173
v_mfma_f32_16x16x32_bf16 v[180:183], a[248:251], a[20:23], v[180:183]
buffer_store_dwordx2 v[122:123], v18, s[28:31], 0 offen nt
v_mul_f32 v162, v162, v24
v_mfma_f32_16x16x32_bf16 v[184:187], a[248:251], a[24:27], v[184:187]
s_add_u32 s28, s28, 7168
v_mul_f32 v166, v166, v25
v_mul_f32 v170, v170, v26
v_mfma_f32_16x16x32_bf16 v[188:191], a[248:251], a[28:31], v[188:191]
s_waitcnt lgkmcnt(1)
v_mul_f32 v174, v174, v27
v_cvt_pk_bf16_f32 v124, v162, v166
v_mfma_f32_16x16x32_bf16 v[192:195], a[252:255], a[0:3], v[192:195]
s_addc_u32 s29, s29, 0
ds_read_b128 a[244:247], v15 offset:47104
v_cvt_pk_bf16_f32 v125, v170, v174
v_mfma_f32_16x16x32_bf16 v[196:199], a[252:255], a[4:7], v[196:199]
buffer_store_dwordx2 v[124:125], v18, s[28:31], 0 offen nt
v_mul_f32 v163, v163, v24
v_mfma_f32_16x16x32_bf16 v[200:203], a[252:255], a[8:11], v[200:203]
s_add_u32 s28, s28, 7168
v_mul_f32 v167, v167, v25
v_mul_f32 v171, v171, v26
v_mfma_f32_16x16x32_bf16 v[204:207], a[252:255], a[12:15], v[204:207]
s_waitcnt lgkmcnt(1)
v_mul_f32 v175, v175, v27
v_cvt_pk_bf16_f32 v126, v163, v167
v_mfma_f32_16x16x32_bf16 v[240:243], a[240:243], a[96:99], v[240:243]
s_addc_u32 s29, s29, 0
ds_read_b128 a[248:251], v15 offset:49152
v_cvt_pk_bf16_f32 v127, v171, v175
v_mfma_f32_16x16x32_bf16 v[244:247], a[240:243], a[100:103], v[244:247]
buffer_store_dwordx2 v[126:127], v18, s[28:31], 0 offen nt
v_mfma_f32_16x16x32_bf16 v[248:251], a[240:243], a[104:107], v[248:251]
v_mfma_f32_16x16x32_bf16 v[252:255], a[240:243], a[108:111], v[252:255]
s_waitcnt lgkmcnt(1)
v_mul_f32 v176, v176, v24
v_mul_f32 v180, v180, v25
v_mfma_f32_16x16x32_bf16 v[208:211], a[244:247], a[224:227], v[208:211]
s_add_u32 s28, s28, 93184
ds_read_b128 a[252:255], v15 offset:53248
v_mul_f32 v184, v184, v26
v_mfma_f32_16x16x32_bf16 v[212:215], a[244:247], a[228:231], v[212:215]
s_addc_u32 s29, s29, 0
v_mul_f32 v188, v188, v27
v_cvt_pk_bf16_f32 v120, v176, v180
v_mfma_f32_16x16x32_bf16 v[216:219], a[244:247], a[232:235], v[216:219]
v_cvt_pk_bf16_f32 v121, v184, v188
v_mfma_f32_16x16x32_bf16 v[220:223], a[244:247], a[236:239], v[220:223]
s_waitcnt lgkmcnt(1)
v_mfma_f32_16x16x32_bf16 v[224:227], a[248:251], a[192:195], v[224:227]
ds_read_b128 a[240:243], v14 offset:55296
v_mfma_f32_16x16x32_bf16 v[228:231], a[248:251], a[196:199], v[228:231]
buffer_store_dwordx2 v[120:121], v18, s[28:31], 0 offen nt
v_mul_f32 v177, v177, v24
v_mfma_f32_16x16x32_bf16 v[232:235], a[248:251], a[200:203], v[232:235]
s_add_u32 s28, s28, 7168
v_mul_f32 v181, v181, v25
v_mul_f32 v185, v185, v26
v_mfma_f32_16x16x32_bf16 v[236:239], a[248:251], a[204:207], v[236:239]
s_waitcnt lgkmcnt(1)
v_mul_f32 v189, v189, v27
v_cvt_pk_bf16_f32 v122, v177, v181
v_mfma_f32_16x16x32_bf16 v[192:195], a[252:255], a[16:19], v[192:195]
s_addc_u32 s29, s29, 0
ds_read_b128 a[244:247], v14 offset:57344
v_cvt_pk_bf16_f32 v123, v185, v189
v_mfma_f32_16x16x32_bf16 v[196:199], a[252:255], a[20:23], v[196:199]
buffer_store_dwordx2 v[122:123], v18, s[28:31], 0 offen nt
v_mul_f32 v178, v178, v24
v_mfma_f32_16x16x32_bf16 v[200:203], a[252:255], a[24:27], v[200:203]
s_add_u32 s28, s28, 7168
v_mul_f32 v182, v182, v25
v_mul_f32 v186, v186, v26
v_mfma_f32_16x16x32_bf16 v[204:207], a[252:255], a[28:31], v[204:207]
s_waitcnt lgkmcnt(1)
v_mul_f32 v190, v190, v27
v_cvt_pk_bf16_f32 v124, v178, v182
v_mfma_f32_16x16x32_bf16 v[208:211], a[240:243], a[0:3], v[208:211]
s_addc_u32 s29, s29, 0
ds_read_b128 a[248:251], v14 offset:18432
v_cvt_pk_bf16_f32 v125, v186, v190
v_mfma_f32_16x16x32_bf16 v[212:215], a[240:243], a[4:7], v[212:215]
buffer_store_dwordx2 v[124:125], v18, s[28:31], 0 offen nt
v_mul_f32 v179, v179, v24
v_mfma_f32_16x16x32_bf16 v[216:219], a[240:243], a[8:11], v[216:219]
s_add_u32 s28, s28, 7168
v_mul_f32 v183, v183, v25
v_mul_f32 v187, v187, v26
v_mfma_f32_16x16x32_bf16 v[220:223], a[240:243], a[12:15], v[220:223]
s_waitcnt lgkmcnt(1)
v_mul_f32 v191, v191, v27
v_cvt_pk_bf16_f32 v126, v179, v183
v_mfma_f32_16x16x32_bf16 v[224:227], a[244:247], a[208:211], v[224:227]
s_addc_u32 s29, s29, 0
ds_read_b128 a[252:255], v15 offset:55296
v_cvt_pk_bf16_f32 v127, v187, v191
v_mfma_f32_16x16x32_bf16 v[228:231], a[244:247], a[212:215], v[228:231]
buffer_store_dwordx2 v[126:127], v18, s[28:31], 0 offen nt
v_mfma_f32_16x16x32_bf16 v[232:235], a[244:247], a[216:219], v[232:235]
v_mfma_f32_16x16x32_bf16 v[236:239], a[244:247], a[220:223], v[236:239]
s_waitcnt lgkmcnt(1)
v_mul_f32 v192, v192, v24
v_mul_f32 v196, v196, v25
v_mfma_f32_16x16x32_bf16 v[240:243], a[248:251], a[112:115], v[240:243]
s_add_u32 s28, s28, 93184
ds_read_b128 a[240:243], v15 offset:57344
v_mul_f32 v200, v200, v26
v_mfma_f32_16x16x32_bf16 v[244:247], a[248:251], a[116:119], v[244:247]
s_addc_u32 s29, s29, 0
v_mul_f32 v204, v204, v27
v_cvt_pk_bf16_f32 v120, v192, v196
v_mfma_f32_16x16x32_bf16 v[248:251], a[248:251], a[120:123], v[248:251]
v_cvt_pk_bf16_f32 v121, v200, v204
v_mfma_f32_16x16x32_bf16 v[252:255], a[248:251], a[124:127], v[252:255]
s_waitcnt lgkmcnt(1)
v_mfma_f32_16x16x32_bf16 v[208:211], a[252:255], a[16:19], v[208:211]
ds_read_b128 a[244:247], v14 offset:61440
v_mfma_f32_16x16x32_bf16 v[212:215], a[252:255], a[20:23], v[212:215]
buffer_store_dwordx2 v[120:121], v18, s[28:31], 0 offen nt
v_mul_f32 v193, v193, v24
v_mfma_f32_16x16x32_bf16 v[216:219], a[252:255], a[24:27], v[216:219]
s_add_u32 s28, s28, 7168
v_mul_f32 v197, v197, v25
v_mul_f32 v201, v201, v26
v_mfma_f32_16x16x32_bf16 v[220:223], a[252:255], a[28:31], v[220:223]
s_waitcnt lgkmcnt(1)
v_mul_f32 v205, v205, v27
v_cvt_pk_bf16_f32 v122, v193, v197
v_mfma_f32_16x16x32_bf16 v[224:227], a[240:243], a[224:227], v[224:227]
s_addc_u32 s29, s29, 0
ds_read_b128 a[248:251], v15 offset:18432
v_cvt_pk_bf16_f32 v123, v201, v205
v_mfma_f32_16x16x32_bf16 v[228:231], a[240:243], a[228:231], v[228:231]
buffer_store_dwordx2 v[122:123], v18, s[28:31], 0 offen nt
v_mul_f32 v194, v194, v24
v_mfma_f32_16x16x32_bf16 v[232:235], a[240:243], a[232:235], v[232:235]
s_add_u32 s28, s28, 7168
v_mul_f32 v198, v198, v25
v_mul_f32 v202, v202, v26
v_mfma_f32_16x16x32_bf16 v[236:239], a[240:243], a[236:239], v[236:239]
s_waitcnt lgkmcnt(1)
v_mul_f32 v206, v206, v27
v_cvt_pk_bf16_f32 v124, v194, v198
v_mfma_f32_16x16x32_bf16 v[224:227], a[244:247], a[0:3], v[224:227]
s_addc_u32 s29, s29, 0
ds_read_b128 a[252:255], v15 offset:61440
v_cvt_pk_bf16_f32 v125, v202, v206
v_mfma_f32_16x16x32_bf16 v[228:231], a[244:247], a[4:7], v[228:231]
buffer_store_dwordx2 v[124:125], v18, s[28:31], 0 offen nt
v_mul_f32 v195, v195, v24
v_mfma_f32_16x16x32_bf16 v[232:235], a[244:247], a[8:11], v[232:235]
s_add_u32 s28, s28, 7168
v_mul_f32 v199, v199, v25
v_mul_f32 v203, v203, v26
v_mfma_f32_16x16x32_bf16 v[236:239], a[244:247], a[12:15], v[236:239]
s_waitcnt lgkmcnt(1)
v_mul_f32 v207, v207, v27
v_cvt_pk_bf16_f32 v126, v195, v199
v_mfma_f32_16x16x32_bf16 v[240:243], a[248:251], a[128:131], v[240:243]
s_addc_u32 s29, s29, 0
ds_read_b128 a[240:243], v14 offset:38912
v_cvt_pk_bf16_f32 v127, v203, v207
v_mfma_f32_16x16x32_bf16 v[244:247], a[248:251], a[132:135], v[244:247]
buffer_store_dwordx2 v[126:127], v18, s[28:31], 0 offen nt
v_mul_f32 v208, v208, v24
v_mfma_f32_16x16x32_bf16 v[248:251], a[248:251], a[136:139], v[248:251]
s_add_u32 s28, s28, 93184
v_mul_f32 v212, v212, v25
v_mul_f32 v216, v216, v26
v_mfma_f32_16x16x32_bf16 v[252:255], a[248:251], a[140:143], v[252:255]
s_waitcnt lgkmcnt(1)
v_mul_f32 v220, v220, v27
v_cvt_pk_bf16_f32 v120, v208, v212
v_mfma_f32_16x16x32_bf16 v[224:227], a[252:255], a[16:19], v[224:227]
s_addc_u32 s29, s29, 0
ds_read_b128 a[244:247], v15 offset:38912
v_cvt_pk_bf16_f32 v121, v216, v220
v_mfma_f32_16x16x32_bf16 v[228:231], a[252:255], a[20:23], v[228:231]
buffer_store_dwordx2 v[120:121], v18, s[28:31], 0 offen nt
v_mul_f32 v209, v209, v24
v_mfma_f32_16x16x32_bf16 v[232:235], a[252:255], a[24:27], v[232:235]
s_add_u32 s28, s28, 7168
v_mul_f32 v213, v213, v25
v_mul_f32 v217, v217, v26
v_mfma_f32_16x16x32_bf16 v[236:239], a[252:255], a[28:31], v[236:239]
s_waitcnt lgkmcnt(1)
v_mul_f32 v221, v221, v27
v_cvt_pk_bf16_f32 v122, v209, v213
v_mfma_f32_16x16x32_bf16 v[240:243], a[240:243], a[144:147], v[240:243]
s_addc_u32 s29, s29, 0
ds_read_b128 a[248:251], v14 offset:51200
v_cvt_pk_bf16_f32 v123, v217, v221
v_mfma_f32_16x16x32_bf16 v[244:247], a[240:243], a[148:151], v[244:247]
buffer_store_dwordx2 v[122:123], v18, s[28:31], 0 offen nt
v_mul_f32 v210, v210, v24
v_mfma_f32_16x16x32_bf16 v[248:251], a[240:243], a[152:155], v[248:251]
s_add_u32 s28, s28, 7168
v_mul_f32 v214, v214, v25
v_mul_f32 v218, v218, v26
v_mfma_f32_16x16x32_bf16 v[252:255], a[240:243], a[156:159], v[252:255]
s_waitcnt lgkmcnt(1)
v_mul_f32 v222, v222, v27
v_cvt_pk_bf16_f32 v124, v210, v214
v_mfma_f32_16x16x32_bf16 v[240:243], a[244:247], a[160:163], v[240:243]
s_addc_u32 s29, s29, 0
ds_read_b128 a[252:255], v15 offset:51200
v_cvt_pk_bf16_f32 v125, v218, v222
v_mfma_f32_16x16x32_bf16 v[244:247], a[244:247], a[164:167], v[244:247]
buffer_store_dwordx2 v[124:125], v18, s[28:31], 0 offen nt
v_mul_f32 v211, v211, v24
v_mfma_f32_16x16x32_bf16 v[248:251], a[244:247], a[168:171], v[248:251]
s_add_u32 s28, s28, 7168
v_mul_f32 v215, v215, v25
v_mul_f32 v219, v219, v26
v_mfma_f32_16x16x32_bf16 v[252:255], a[244:247], a[172:175], v[252:255]
s_waitcnt lgkmcnt(1)
v_mul_f32 v223, v223, v27
v_cvt_pk_bf16_f32 v126, v211, v215
v_mfma_f32_16x16x32_bf16 v[240:243], a[248:251], a[176:179], v[240:243]
s_addc_u32 s29, s29, 0
ds_read_b128 a[240:243], v14 offset:59392
v_cvt_pk_bf16_f32 v127, v219, v223
v_mfma_f32_16x16x32_bf16 v[244:247], a[248:251], a[180:183], v[244:247]
buffer_store_dwordx2 v[126:127], v18, s[28:31], 0 offen nt
v_mul_f32 v224, v224, v24
v_mfma_f32_16x16x32_bf16 v[248:251], a[248:251], a[184:187], v[248:251]
s_add_u32 s28, s28, 93184
v_mul_f32 v228, v228, v25
v_mul_f32 v232, v232, v26
v_mfma_f32_16x16x32_bf16 v[252:255], a[248:251], a[188:191], v[252:255]
s_waitcnt lgkmcnt(1)
v_mul_f32 v236, v236, v27
v_cvt_pk_bf16_f32 v120, v224, v228
v_mfma_f32_16x16x32_bf16 v[240:243], a[252:255], a[192:195], v[240:243]
s_addc_u32 s29, s29, 0
ds_read_b128 a[244:247], v15 offset:59392
v_cvt_pk_bf16_f32 v121, v232, v236
v_mfma_f32_16x16x32_bf16 v[244:247], a[252:255], a[196:199], v[244:247]
buffer_store_dwordx2 v[120:121], v18, s[28:31], 0 offen nt
v_mul_f32 v225, v225, v24
v_mfma_f32_16x16x32_bf16 v[248:251], a[252:255], a[200:203], v[248:251]
s_add_u32 s28, s28, 7168
v_mul_f32 v229, v229, v25
v_mul_f32 v233, v233, v26
v_mfma_f32_16x16x32_bf16 v[252:255], a[252:255], a[204:207], v[252:255]
s_waitcnt lgkmcnt(1)
v_mul_f32 v237, v237, v27
v_cvt_pk_bf16_f32 v122, v225, v229
v_mfma_f32_16x16x32_bf16 v[240:243], a[240:243], a[208:211], v[240:243]
s_addc_u32 s29, s29, 0
ds_read_b128 a[248:251], v14 offset:63488
v_cvt_pk_bf16_f32 v123, v233, v237
v_mfma_f32_16x16x32_bf16 v[244:247], a[240:243], a[212:215], v[244:247]
buffer_store_dwordx2 v[122:123], v18, s[28:31], 0 offen nt
v_mul_f32 v226, v226, v24
v_mfma_f32_16x16x32_bf16 v[248:251], a[240:243], a[216:219], v[248:251]
s_add_u32 s28, s28, 7168
v_mul_f32 v230, v230, v25
v_mul_f32 v234, v234, v26
v_mfma_f32_16x16x32_bf16 v[252:255], a[240:243], a[220:223], v[252:255]
s_waitcnt lgkmcnt(1)
v_mul_f32 v238, v238, v27
v_cvt_pk_bf16_f32 v124, v226, v230
v_mfma_f32_16x16x32_bf16 v[240:243], a[244:247], a[224:227], v[240:243]
s_addc_u32 s29, s29, 0
ds_read_b128 a[252:255], v15 offset:63488
v_cvt_pk_bf16_f32 v125, v234, v238
v_mfma_f32_16x16x32_bf16 v[244:247], a[244:247], a[228:231], v[244:247]
buffer_store_dwordx2 v[124:125], v18, s[28:31], 0 offen nt
v_mul_f32 v227, v227, v24
v_mfma_f32_16x16x32_bf16 v[248:251], a[244:247], a[232:235], v[248:251]
s_add_u32 s28, s28, 7168
v_mul_f32 v231, v231, v25
v_mul_f32 v235, v235, v26
v_mfma_f32_16x16x32_bf16 v[252:255], a[244:247], a[236:239], v[252:255]
s_waitcnt lgkmcnt(1)
v_mul_f32 v239, v239, v27
v_cvt_pk_bf16_f32 v126, v227, v231
v_mfma_f32_16x16x32_bf16 v[240:243], a[248:251], a[0:3], v[240:243]
s_addc_u32 s29, s29, 0
v_cvt_pk_bf16_f32 v127, v235, v239
v_mfma_f32_16x16x32_bf16 v[244:247], a[248:251], a[4:7], v[244:247]
buffer_store_dwordx2 v[126:127], v18, s[28:31], 0 offen nt
v_mfma_f32_16x16x32_bf16 v[248:251], a[248:251], a[8:11], v[248:251]
v_mfma_f32_16x16x32_bf16 v[252:255], a[248:251], a[12:15], v[252:255]
s_waitcnt lgkmcnt(0)
v_mfma_f32_16x16x32_bf16 v[240:243], a[252:255], a[16:19], v[240:243]
v_mfma_f32_16x16x32_bf16 v[244:247], a[252:255], a[20:23], v[244:247]
v_mfma_f32_16x16x32_bf16 v[248:251], a[252:255], a[24:27], v[248:251]
v_mfma_f32_16x16x32_bf16 v[252:255], a[252:255], a[28:31], v[252:255]
s_nop 7
v_pk_mul_f32 v[240:241], v[240:241], v[24:25] op_sel:[0,0] op_sel_hi:[1,0]
v_pk_mul_f32 v[244:245], v[244:245], v[24:25] op_sel:[0,1] op_sel_hi:[1,1]
v_pk_mul_f32 v[248:249], v[248:249], v[26:27] op_sel:[0,0] op_sel_hi:[1,0]
v_pk_mul_f32 v[252:253], v[252:253], v[26:27] op_sel:[0,1] op_sel_hi:[1,1]
v_cvt_pk_bf16_f32 v120, v240, v244
v_cvt_pk_bf16_f32 v121, v248, v252
s_add_u32 s28, s28, 93184
s_addc_u32 s29, s29, 0
buffer_store_dwordx2 v[120:121], v18, s[28:31], 0 offen nt
v_cvt_pk_bf16_f32 v122, v241, v245
v_cvt_pk_bf16_f32 v123, v249, v253
s_add_u32 s28, s28, 7168
s_addc_u32 s29, s29, 0
buffer_store_dwordx2 v[122:123], v18, s[28:31], 0 offen nt
v_pk_mul_f32 v[242:243], v[242:243], v[24:25] op_sel:[0,0] op_sel_hi:[1,0]
v_pk_mul_f32 v[246:247], v[246:247], v[24:25] op_sel:[0,1] op_sel_hi:[1,1]
v_pk_mul_f32 v[250:251], v[250:251], v[26:27] op_sel:[0,0] op_sel_hi:[1,0]
v_pk_mul_f32 v[254:255], v[254:255], v[26:27] op_sel:[0,1] op_sel_hi:[1,1]
v_cvt_pk_bf16_f32 v124, v242, v246
v_cvt_pk_bf16_f32 v125, v250, v254
s_add_u32 s28, s28, 7168
s_addc_u32 s29, s29, 0
buffer_store_dwordx2 v[124:125], v18, s[28:31], 0 offen nt
v_cvt_pk_bf16_f32 v126, v243, v247
v_cvt_pk_bf16_f32 v127, v251, v255
s_add_u32 s28, s28, 7168
s_addc_u32 s29, s29, 0
buffer_store_dwordx2 v[126:127], v18, s[28:31], 0 offen nt
s_endpgm
L_NOTAG:
buffer_load_dwordx2 v[22:23], off, s[80:83], 0 sc1
s_waitcnt vmcnt(0)
v_readfirstlane_b32 s88, v22
v_readfirstlane_b32 s89, v23
s_sub_u32 s90, s90, 1
s_nop 0
s_cmp_eq_u64 s[88:89], 0
s_cbranch_scc0 L_TAGOK
s_cmp_gt_i32 s90, 0
s_cbranch_scc1 L_NOTAG
s_mov_b32 s26, 0
s_mov_b32 s78, 0
s_mov_b64 s[88:89], 1
s_branch L_TAGOK
.p2align 6
L_PADS:
s_cbranch_vccnz L_PADRET
L_TRY:
s_waitcnt vmcnt(0)
v_cmp_ne_u64 s[50:51], s[88:89], v[122:123]
v_cmp_ne_u64 s[44:45], s[88:89], v[126:127]
s_sub_u32 s90, s90, 1
s_nop 0
s_or_b64 s[50:51], s[44:45], s[50:51]
s_cbranch_scc0 L_WRET
s_cmp_gt_i32 s90, 0
s_cbranch_scc0 L_SELF
L_WRET:
s_setpc_b64 s[100:101]
L_SLOW2:
s_lshr_b32 s91, s41, 6
s_add_u32 s91, s91, 0
s_lshl_b32 s47, s91, 11
buffer_load_dwordx4 v[120:123], v13, s[24:27], s47 offen offset:0 sc1
buffer_load_dwordx4 v[124:127], v13, s[24:27], s47 offen offset:1024 sc1
s_lshr_b32 s47, s41, 6
s_add_u32 s47, s47, 1
s_lshl_b32 s47, s47, 11
buffer_load_dwordx4 v[40:43], v13, s[24:27], s47 offen offset:0 sc1
buffer_load_dwordx4 v[44:47], v13, s[24:27], s47 offen offset:1024 sc1
s_lshr_b32 s47, s42, 6
s_add_u32 s47, s47, 0
s_lshl_b32 s47, s47, 11
buffer_load_dwordx4 v[48:51], v13, s[24:27], s47 offen offset:0 sc1
buffer_load_dwordx4 v[52:55], v13, s[24:27], s47 offen offset:1024 sc1
s_call_b64 s[100:101], L_TRY
s_cbranch_scc1 L_SLOW2
v_mov_b64 v[32:33], v[120:121]
v_mov_b64 v[36:37], v[124:125]
s_branch L_BACK2
L_SLOW3:
s_lshr_b32 s91, s41, 6
s_add_u32 s91, s91, 1
s_lshl_b32 s47, s91, 11
buffer_load_dwordx4 v[120:123], v13, s[24:27], s47 offen offset:0 sc1
buffer_load_dwordx4 v[124:127], v13, s[24:27], s47 offen offset:1024 sc1
s_lshr_b32 s47, s42, 6
s_add_u32 s47, s47, 0
s_lshl_b32 s47, s47, 11
buffer_load_dwordx4 v[48:51], v13, s[24:27], s47 offen offset:0 sc1
buffer_load_dwordx4 v[52:55], v13, s[24:27], s47 offen offset:1024 sc1
s_call_b64 s[100:101], L_TRY
s_cbranch_scc1 L_SLOW3
v_mov_b64 v[40:41], v[120:121]
v_mov_b64 v[44:45], v[124:125]
s_branch L_BACK3
L_SLOW4:
s_lshr_b32 s91, s42, 6
s_add_u32 s91, s91, 0
s_lshl_b32 s47, s91, 11
buffer_load_dwordx4 v[120:123], v13, s[24:27], s47 offen offset:0 sc1
buffer_load_dwordx4 v[124:127], v13, s[24:27], s47 offen offset:1024 sc1
s_lshr_b32 s47, s42, 6
s_add_u32 s47, s47, 1
s_lshl_b32 s47, s47, 11
buffer_load_dwordx4 v[96:99], v13, s[24:27], s47 offen offset:0 sc1
buffer_load_dwordx4 v[100:103], v13, s[24:27], s47 offen offset:1024 sc1
s_lshr_b32 s47, s43, 6
s_add_u32 s47, s47, 0
s_lshl_b32 s47, s47, 11
buffer_load_dwordx4 v[80:83], v13, s[24:27], s47 offen offset:0 sc1
buffer_load_dwordx4 v[84:87], v13, s[24:27], s47 offen offset:1024 sc1
s_call_b64 s[100:101], L_TRY
s_cbranch_scc1 L_SLOW4
v_mov_b64 v[48:49], v[120:121]
v_mov_b64 v[52:53], v[124:125]
s_branch L_BACK4
L_SLOW5:
s_lshr_b32 s91, s42, 6
s_add_u32 s91, s91, 1
s_lshl_b32 s47, s91, 11
buffer_load_dwordx4 v[120:123], v13, s[24:27], s47 offen offset:0 sc1
buffer_load_dwordx4 v[124:127], v13, s[24:27], s47 offen offset:1024 sc1
s_lshr_b32 s47, s43, 6
s_add_u32 s47, s47, 0
s_lshl_b32 s47, s47, 11
buffer_load_dwordx4 v[80:83], v13, s[24:27], s47 offen offset:0 sc1
buffer_load_dwordx4 v[84:87], v13, s[24:27], s47 offen offset:1024 sc1
s_lshr_b32 s47, s43, 6
s_add_u32 s47, s47, 1
s_lshl_b32 s47, s47, 11
buffer_load_dwordx4 v[88:91], v13, s[24:27], s47 offen offset:0 sc1
buffer_load_dwordx4 v[92:95], v13, s[24:27], s47 offen offset:1024 sc1
s_call_b64 s[100:101], L_TRY
s_cbranch_scc1 L_SLOW5
v_mov_b64 v[96:97], v[120:121]
v_mov_b64 v[100:101], v[124:125]
s_branch L_BACK5
L_SLOW6:
s_lshr_b32 s91, s43, 6
s_add_u32 s91, s91, 0
s_lshl_b32 s47, s91, 11
buffer_load_dwordx4 v[120:123], v13, s[24:27], s47 offen offset:0 sc1
buffer_load_dwordx4 v[124:127], v13, s[24:27], s47 offen offset:1024 sc1
s_lshr_b32 s47, s43, 6
s_add_u32 s47, s47, 1
s_lshl_b32 s47, s47, 11
buffer_load_dwordx4 v[88:91], v13, s[24:27], s47 offen offset:0 sc1
buffer_load_dwordx4 v[92:95], v13, s[24:27], s47 offen offset:1024 sc1
s_movk_i32 s47, 8
s_lshl_b32 s47, s47, 11
buffer_load_dwordx4 v[32:35], v13, s[24:27], s47 offen offset:0 sc1
buffer_load_dwordx4 v[36:39], v13, s[24:27], s47 offen offset:1024 sc1
s_call_b64 s[100:101], L_TRY
s_cbranch_scc1 L_SLOW6
v_mov_b64 v[80:81], v[120:121]
v_mov_b64 v[84:85], v[124:125]
s_branch L_BACK6
L_SLOW7:
s_lshr_b32 s91, s43, 6
s_add_u32 s91, s91, 1
s_lshl_b32 s47, s91, 11
buffer_load_dwordx4 v[120:123], v13, s[24:27], s47 offen offset:0 sc1
buffer_load_dwordx4 v[124:127], v13, s[24:27], s47 offen offset:1024 sc1
s_movk_i32 s47, 8
s_lshl_b32 s47, s47, 11
buffer_load_dwordx4 v[32:35], v13, s[24:27], s47 offen offset:0 sc1
buffer_load_dwordx4 v[36:39], v13, s[24:27], s47 offen offset:1024 sc1
s_movk_i32 s47, 9
s_lshl_b32 s47, s47, 11
buffer_load_dwordx4 v[40:43], v13, s[24:27], s47 offen offset:0 sc1
buffer_load_dwordx4 v[44:47], v13, s[24:27], s47 offen offset:1024 sc1
s_call_b64 s[100:101], L_TRY
s_cbranch_scc1 L_SLOW7
v_mov_b64 v[88:89], v[120:121]
v_mov_b64 v[92:93], v[124:125]
s_branch L_BACK7
L_SLOW8:
s_movk_i32 s91, 8
s_lshl_b32 s47, s91, 11
buffer_load_dwordx4 v[120:123], v13, s[24:27], s47 offen offset:0 sc1
buffer_load_dwordx4 v[124:127], v13, s[24:27], s47 offen offset:1024 sc1
s_movk_i32 s47, 9
s_lshl_b32 s47, s47, 11
buffer_load_dwordx4 v[40:43], v13, s[24:27], s47 offen offset:0 sc1
buffer_load_dwordx4 v[44:47], v13, s[24:27], s47 offen offset:1024 sc1
s_movk_i32 s47, 10
s_lshl_b32 s47, s47, 11
buffer_load_dwordx4 v[48:51], v13, s[24:27], s47 offen offset:0 sc1
buffer_load_dwordx4 v[52:55], v13, s[24:27], s47 offen offset:1024 sc1
s_call_b64 s[100:101], L_TRY
s_cbranch_scc1 L_SLOW8
v_mov_b64 v[32:33], v[120:121]
v_mov_b64 v[36:37], v[124:125]
s_branch L_BACK8
L_SLOW9:
s_movk_i32 s91, 9
s_lshl_b32 s47, s91, 11
buffer_load_dwordx4 v[120:123], v13, s[24:27], s47 offen offset:0 sc1
buffer_load_dwordx4 v[124:127], v13, s[24:27], s47 offen offset:1024 sc1
s_movk_i32 s47, 10
s_lshl_b32 s47, s47, 11
buffer_load_dwordx4 v[48:51], v13, s[24:27], s47 offen offset:0 sc1
buffer_load_dwordx4 v[52:55], v13, s[24:27], s47 offen offset:1024 sc1
s_movk_i32 s47, 11
s_lshl_b32 s47, s47, 11
buffer_load_dwordx4 v[96:99], v13, s[24:27], s47 offen offset:0 sc1
buffer_load_dwordx4 v[100:103], v13, s[24:27], s47 offen offset:1024 sc1
s_call_b64 s[100:101], L_TRY
s_cbranch_scc1 L_SLOW9
v_mov_b64 v[40:41], v[120:121]
v_mov_b64 v[44:45], v[124:125]
s_branch L_BACK9
L_SLOW10:
s_movk_i32 s91, 10
s_lshl_b32 s47, s91, 11
buffer_load_dwordx4 v[120:123], v13, s[24:27], s47 offen offset:0 sc1
buffer_load_dwordx4 v[124:127], v13, s[24:27], s47 offen offset:1024 sc1
s_movk_i32 s47, 11
s_lshl_b32 s47, s47, 11
buffer_load_dwordx4 v[96:99], v13, s[24:27], s47 offen offset:0 sc1
buffer_load_dwordx4 v[100:103], v13, s[24:27], s47 offen offset:1024 sc1
s_movk_i32 s47, 12
s_lshl_b32 s47, s47, 11
buffer_load_dwordx4 v[80:83], v13, s[24:27], s47 offen offset:0 sc1
buffer_load_dwordx4 v[84:87], v13, s[24:27], s47 offen offset:1024 sc1
s_call_b64 s[100:101], L_TRY
s_cbranch_scc1 L_SLOW10
v_mov_b64 v[48:49], v[120:121]
v_mov_b64 v[52:53], v[124:125]
s_branch L_BACK10
L_SLOW11:
s_movk_i32 s91, 11
s_lshl_b32 s47, s91, 11
buffer_load_dwordx4 v[120:123], v13, s[24:27], s47 offen offset:0 sc1
buffer_load_dwordx4 v[124:127], v13, s[24:27], s47 offen offset:1024 sc1
s_movk_i32 s47, 12
s_lshl_b32 s47, s47, 11
buffer_load_dwordx4 v[80:83], v13, s[24:27], s47 offen offset:0 sc1
buffer_load_dwordx4 v[84:87], v13, s[24:27], s47 offen offset:1024 sc1
s_movk_i32 s47, 13
s_lshl_b32 s47, s47, 11
buffer_load_dwordx4 v[88:91], v13, s[24:27], s47 offen offset:0 sc1
buffer_load_dwordx4 v[92:95], v13, s[24:27], s47 offen offset:1024 sc1
s_call_b64 s[100:101], L_TRY
s_cbranch_scc1 L_SLOW11
v_mov_b64 v[96:97], v[120:121]
v_mov_b64 v[100:101], v[124:125]
s_branch L_BACK11
L_SLOW12:
s_movk_i32 s91, 12
s_lshl_b32 s47, s91, 11
buffer_load_dwordx4 v[120:123], v13, s[24:27], s47 offen offset:0 sc1
buffer_load_dwordx4 v[124:127], v13, s[24:27], s47 offen offset:1024 sc1
s_movk_i32 s47, 13
s_lshl_b32 s47, s47, 11
buffer_load_dwordx4 v[88:91], v13, s[24:27], s47 offen offset:0 sc1
buffer_load_dwordx4 v[92:95], v13, s[24:27], s47 offen offset:1024 sc1
s_movk_i32 s47, 14
s_lshl_b32 s47, s47, 11
buffer_load_dwordx4 v[32:35], v13, s[24:27], s47 offen offset:0 sc1
buffer_load_dwordx4 v[36:39], v13, s[24:27], s47 offen offset:1024 sc1
s_call_b64 s[100:101], L_TRY
s_cbranch_scc1 L_SLOW12
v_mov_b64 v[80:81], v[120:121]
v_mov_b64 v[84:85], v[124:125]
s_branch L_BACK12
L_SLOW13:
s_movk_i32 s91, 13
s_lshl_b32 s47, s91, 11
buffer_load_dwordx4 v[120:123], v13, s[24:27], s47 offen offset:0 sc1
buffer_load_dwordx4 v[124:127], v13, s[24:27], s47 offen offset:1024 sc1
s_movk_i32 s47, 14
s_lshl_b32 s47, s47, 11
buffer_load_dwordx4 v[32:35], v13, s[24:27], s47 offen offset:0 sc1
buffer_load_dwordx4 v[36:39], v13, s[24:27], s47 offen offset:1024 sc1
s_movk_i32 s47, 15
s_lshl_b32 s47, s47, 11
buffer_load_dwordx4 v[40:43], v13, s[24:27], s47 offen offset:0 sc1
buffer_load_dwordx4 v[44:47], v13, s[24:27], s47 offen offset:1024 sc1
s_call_b64 s[100:101], L_TRY
s_cbranch_scc1 L_SLOW13
v_mov_b64 v[88:89], v[120:121]
v_mov_b64 v[92:93], v[124:125]
s_branch L_BACK13
L_SLOW14:
s_movk_i32 s91, 14
s_lshl_b32 s47, s91, 11
buffer_load_dwordx4 v[120:123], v13, s[24:27], s47 offen offset:0 sc1
buffer_load_dwordx4 v[124:127], v13, s[24:27], s47 offen offset:1024 sc1
s_movk_i32 s47, 15
s_lshl_b32 s47, s47, 11
buffer_load_dwordx4 v[40:43], v13, s[24:27], s47 offen offset:0 sc1
buffer_load_dwordx4 v[44:47], v13, s[24:27], s47 offen offset:1024 sc1
s_movk_i32 s47, 16
s_lshl_b32 s47, s47, 11
buffer_load_dwordx4 v[48:51], v13, s[24:27], s47 offen offset:0 sc1
buffer_load_dwordx4 v[52:55], v13, s[24:27], s47 offen offset:1024 sc1
s_call_b64 s[100:101], L_TRY
s_cbranch_scc1 L_SLOW14
v_mov_b64 v[32:33], v[120:121]
v_mov_b64 v[36:37], v[124:125]
s_branch L_BACK14
L_SLOW15:
s_movk_i32 s91, 15
s_lshl_b32 s47, s91, 11
buffer_load_dwordx4 v[120:123], v13, s[24:27], s47 offen offset:0 sc1
buffer_load_dwordx4 v[124:127], v13, s[24:27], s47 offen offset:1024 sc1
s_movk_i32 s47, 16
s_lshl_b32 s47, s47, 11
buffer_load_dwordx4 v[48:51], v13, s[24:27], s47 offen offset:0 sc1
buffer_load_dwordx4 v[52:55], v13, s[24:27], s47 offen offset:1024 sc1
s_movk_i32 s47, 17
s_lshl_b32 s47, s47, 11
buffer_load_dwordx4 v[96:99], v13, s[24:27], s47 offen offset:0 sc1
buffer_load_dwordx4 v[100:103], v13, s[24:27], s47 offen offset:1024 sc1
s_call_b64 s[100:101], L_TRY
s_cbranch_scc1 L_SLOW15
v_mov_b64 v[40:41], v[120:121]
v_mov_b64 v[44:45], v[124:125]
s_branch L_BACK15
L_SLOW16:
s_movk_i32 s91, 16
s_lshl_b32 s47, s91, 11
buffer_load_dwordx4 v[120:123], v13, s[24:27], s47 offen offset:0 sc1
buffer_load_dwordx4 v[124:127], v13, s[24:27], s47 offen offset:1024 sc1
s_movk_i32 s47, 17
s_lshl_b32 s47, s47, 11
buffer_load_dwordx4 v[96:99], v13, s[24:27], s47 offen offset:0 sc1
buffer_load_dwordx4 v[100:103], v13, s[24:27], s47 offen offset:1024 sc1
s_movk_i32 s47, 18
s_lshl_b32 s47, s47, 11
buffer_load_dwordx4 v[80:83], v13, s[24:27], s47 offen offset:0 sc1
buffer_load_dwordx4 v[84:87], v13, s[24:27], s47 offen offset:1024 sc1
s_call_b64 s[100:101], L_TRY
s_cbranch_scc1 L_SLOW16
v_mov_b64 v[48:49], v[120:121]
v_mov_b64 v[52:53], v[124:125]
s_branch L_BACK16
L_SLOW17:
s_movk_i32 s91, 17
s_lshl_b32 s47, s91, 11
buffer_load_dwordx4 v[120:123], v13, s[24:27], s47 offen offset:0 sc1
buffer_load_dwordx4 v[124:127], v13, s[24:27], s47 offen offset:1024 sc1
s_movk_i32 s47, 18
s_lshl_b32 s47, s47, 11
buffer_load_dwordx4 v[80:83], v13, s[24:27], s47 offen offset:0 sc1
buffer_load_dwordx4 v[84:87], v13, s[24:27], s47 offen offset:1024 sc1
s_movk_i32 s47, 19
s_lshl_b32 s47, s47, 11
buffer_load_dwordx4 v[88:91], v13, s[24:27], s47 offen offset:0 sc1
buffer_load_dwordx4 v[92:95], v13, s[24:27], s47 offen offset:1024 sc1
s_call_b64 s[100:101], L_TRY
s_cbranch_scc1 L_SLOW17
v_mov_b64 v[96:97], v[120:121]
v_mov_b64 v[100:101], v[124:125]
s_branch L_BACK17
L_SLOW18:
s_movk_i32 s91, 18
s_lshl_b32 s47, s91, 11
buffer_load_dwordx4 v[120:123], v13, s[24:27], s47 offen offset:0 sc1
buffer_load_dwordx4 v[124:127], v13, s[24:27], s47 offen offset:1024 sc1
s_movk_i32 s47, 19
s_lshl_b32 s47, s47, 11
buffer_load_dwordx4 v[88:91], v13, s[24:27], s47 offen offset:0 sc1
buffer_load_dwordx4 v[92:95], v13, s[24:27], s47 offen offset:1024 sc1
s_movk_i32 s47, 20
s_lshl_b32 s47, s47, 11
buffer_load_dwordx4 v[32:35], v13, s[24:27], s47 offen offset:0 sc1
buffer_load_dwordx4 v[36:39], v13, s[24:27], s47 offen offset:1024 sc1
s_call_b64 s[100:101], L_TRY
s_cbranch_scc1 L_SLOW18
v_mov_b64 v[80:81], v[120:121]
v_mov_b64 v[84:85], v[124:125]
s_branch L_BACK18
L_SLOW19:
s_movk_i32 s91, 19
s_lshl_b32 s47, s91, 11
buffer_load_dwordx4 v[120:123], v13, s[24:27], s47 offen offset:0 sc1
buffer_load_dwordx4 v[124:127], v13, s[24:27], s47 offen offset:1024 sc1
s_movk_i32 s47, 20
s_lshl_b32 s47, s47, 11
buffer_load_dwordx4 v[32:35], v13, s[24:27], s47 offen offset:0 sc1
buffer_load_dwordx4 v[36:39], v13, s[24:27], s47 offen offset:1024 sc1
s_movk_i32 s47, 21
s_lshl_b32 s47, s47, 11
buffer_load_dwordx4 v[40:43], v13, s[24:27], s47 offen offset:0 sc1
buffer_load_dwordx4 v[44:47], v13, s[24:27], s47 offen offset:1024 sc1
s_call_b64 s[100:101], L_TRY
s_cbranch_scc1 L_SLOW19
v_mov_b64 v[88:89], v[120:121]
v_mov_b64 v[92:93], v[124:125]
s_branch L_BACK19
L_SLOW20:
s_movk_i32 s91, 20
s_lshl_b32 s47, s91, 11
buffer_load_dwordx4 v[120:123], v13, s[24:27], s47 offen offset:0 sc1
buffer_load_dwordx4 v[124:127], v13, s[24:27], s47 offen offset:1024 sc1
s_movk_i32 s47, 21
s_lshl_b32 s47, s47, 11
buffer_load_dwordx4 v[40:43], v13, s[24:27], s47 offen offset:0 sc1
buffer_load_dwordx4 v[44:47], v13, s[24:27], s47 offen offset:1024 sc1
s_movk_i32 s47, 22
s_lshl_b32 s47, s47, 11
buffer_load_dwordx4 v[48:51], v13, s[24:27], s47 offen offset:0 sc1
buffer_load_dwordx4 v[52:55], v13, s[24:27], s47 offen offset:1024 sc1
s_call_b64 s[100:101], L_TRY
s_cbranch_scc1 L_SLOW20
v_mov_b64 v[32:33], v[120:121]
v_mov_b64 v[36:37], v[124:125]
s_branch L_BACK20
L_SLOW21:
s_movk_i32 s91, 21
s_lshl_b32 s47, s91, 11
buffer_load_dwordx4 v[120:123], v13, s[24:27], s47 offen offset:0 sc1
buffer_load_dwordx4 v[124:127], v13, s[24:27], s47 offen offset:1024 sc1
s_movk_i32 s47, 22
s_lshl_b32 s47, s47, 11
buffer_load_dwordx4 v[48:51], v13, s[24:27], s47 offen offset:0 sc1
buffer_load_dwordx4 v[52:55], v13, s[24:27], s47 offen offset:1024 sc1
s_movk_i32 s47, 23
s_lshl_b32 s47, s47, 11
buffer_load_dwordx4 v[96:99], v13, s[24:27], s47 offen offset:0 sc1
buffer_load_dwordx4 v[100:103], v13, s[24:27], s47 offen offset:1024 sc1
s_call_b64 s[100:101], L_TRY
s_cbranch_scc1 L_SLOW21
v_mov_b64 v[40:41], v[120:121]
v_mov_b64 v[44:45], v[124:125]
s_branch L_BACK21
L_SLOW22:
s_movk_i32 s91, 22
s_lshl_b32 s47, s91, 11
buffer_load_dwordx4 v[120:123], v13, s[24:27], s47 offen offset:0 sc1
buffer_load_dwordx4 v[124:127], v13, s[24:27], s47 offen offset:1024 sc1
s_movk_i32 s47, 23
s_lshl_b32 s47, s47, 11
buffer_load_dwordx4 v[96:99], v13, s[24:27], s47 offen offset:0 sc1
buffer_load_dwordx4 v[100:103], v13, s[24:27], s47 offen offset:1024 sc1
s_movk_i32 s47, 24
s_lshl_b32 s47, s47, 11
buffer_load_dwordx4 v[80:83], v13, s[24:27], s47 offen offset:0 sc1
buffer_load_dwordx4 v[84:87], v13, s[24:27], s47 offen offset:1024 sc1
s_call_b64 s[100:101], L_TRY
s_cbranch_scc1 L_SLOW22
v_mov_b64 v[48:49], v[120:121]
v_mov_b64 v[52:53], v[124:125]
s_branch L_BACK22
L_SLOW23:
s_movk_i32 s91, 23
s_lshl_b32 s47, s91, 11
buffer_load_dwordx4 v[120:123], v13, s[24:27], s47 offen offset:0 sc1
buffer_load_dwordx4 v[124:127], v13, s[24:27], s47 offen offset:1024 sc1
s_movk_i32 s47, 24
s_lshl_b32 s47, s47, 11
buffer_load_dwordx4 v[80:83], v13, s[24:27], s47 offen offset:0 sc1
buffer_load_dwordx4 v[84:87], v13, s[24:27], s47 offen offset:1024 sc1
s_movk_i32 s47, 25
s_lshl_b32 s47, s47, 11
buffer_load_dwordx4 v[88:91], v13, s[24:27], s47 offen offset:0 sc1
buffer_load_dwordx4 v[92:95], v13, s[24:27], s47 offen offset:1024 sc1
s_call_b64 s[100:101], L_TRY
s_cbranch_scc1 L_SLOW23
v_mov_b64 v[96:97], v[120:121]
v_mov_b64 v[100:101], v[124:125]
s_branch L_BACK23
L_SLOW24:
s_movk_i32 s91, 24
s_lshl_b32 s47, s91, 11
buffer_load_dwordx4 v[120:123], v13, s[24:27], s47 offen offset:0 sc1
buffer_load_dwordx4 v[124:127], v13, s[24:27], s47 offen offset:1024 sc1
s_movk_i32 s47, 25
s_lshl_b32 s47, s47, 11
buffer_load_dwordx4 v[88:91], v13, s[24:27], s47 offen offset:0 sc1
buffer_load_dwordx4 v[92:95], v13, s[24:27], s47 offen offset:1024 sc1
s_movk_i32 s47, 26
s_lshl_b32 s47, s47, 11
buffer_load_dwordx4 v[32:35], v13, s[24:27], s47 offen offset:0 sc1
buffer_load_dwordx4 v[36:39], v13, s[24:27], s47 offen offset:1024 sc1
s_call_b64 s[100:101], L_TRY
s_cbranch_scc1 L_SLOW24
v_mov_b64 v[80:81], v[120:121]
v_mov_b64 v[84:85], v[124:125]
s_branch L_BACK24
L_SLOW25:
s_movk_i32 s91, 25
s_lshl_b32 s47, s91, 11
buffer_load_dwordx4 v[120:123], v13, s[24:27], s47 offen offset:0 sc1
buffer_load_dwordx4 v[124:127], v13, s[24:27], s47 offen offset:1024 sc1
s_movk_i32 s47, 26
s_lshl_b32 s47, s47, 11
buffer_load_dwordx4 v[32:35], v13, s[24:27], s47 offen offset:0 sc1
buffer_load_dwordx4 v[36:39], v13, s[24:27], s47 offen offset:1024 sc1
s_movk_i32 s47, 27
s_lshl_b32 s47, s47, 11
buffer_load_dwordx4 v[40:43], v13, s[24:27], s47 offen offset:0 sc1
buffer_load_dwordx4 v[44:47], v13, s[24:27], s47 offen offset:1024 sc1
s_call_b64 s[100:101], L_TRY
s_cbranch_scc1 L_SLOW25
v_mov_b64 v[88:89], v[120:121]
v_mov_b64 v[92:93], v[124:125]
s_branch L_BACK25
L_SLOW26:
s_movk_i32 s91, 26
s_lshl_b32 s47, s91, 11
buffer_load_dwordx4 v[120:123], v13, s[24:27], s47 offen offset:0 sc1
buffer_load_dwordx4 v[124:127], v13, s[24:27], s47 offen offset:1024 sc1
s_movk_i32 s47, 27
s_lshl_b32 s47, s47, 11
buffer_load_dwordx4 v[40:43], v13, s[24:27], s47 offen offset:0 sc1
buffer_load_dwordx4 v[44:47], v13, s[24:27], s47 offen offset:1024 sc1
s_movk_i32 s47, 28
s_lshl_b32 s47, s47, 11
buffer_load_dwordx4 v[48:51], v13, s[24:27], s47 offen offset:0 sc1
buffer_load_dwordx4 v[52:55], v13, s[24:27], s47 offen offset:1024 sc1
s_call_b64 s[100:101], L_TRY
s_cbranch_scc1 L_SLOW26
v_mov_b64 v[32:33], v[120:121]
v_mov_b64 v[36:37], v[124:125]
s_branch L_BACK26
L_SLOW27:
s_movk_i32 s91, 27
s_lshl_b32 s47, s91, 11
buffer_load_dwordx4 v[120:123], v13, s[24:27], s47 offen offset:0 sc1
buffer_load_dwordx4 v[124:127], v13, s[24:27], s47 offen offset:1024 sc1
s_movk_i32 s47, 28
s_lshl_b32 s47, s47, 11
buffer_load_dwordx4 v[48:51], v13, s[24:27], s47 offen offset:0 sc1
buffer_load_dwordx4 v[52:55], v13, s[24:27], s47 offen offset:1024 sc1
s_movk_i32 s47, 29
s_lshl_b32 s47, s47, 11
buffer_load_dwordx4 v[96:99], v13, s[24:27], s47 offen offset:0 sc1
buffer_load_dwordx4 v[100:103], v13, s[24:27], s47 offen offset:1024 sc1
s_call_b64 s[100:101], L_TRY
s_cbranch_scc1 L_SLOW27
v_mov_b64 v[40:41], v[120:121]
v_mov_b64 v[44:45], v[124:125]
s_branch L_BACK27
L_SLOW28:
s_movk_i32 s91, 28
s_lshl_b32 s47, s91, 11
buffer_load_dwordx4 v[120:123], v13, s[24:27], s47 offen offset:0 sc1
buffer_load_dwordx4 v[124:127], v13, s[24:27], s47 offen offset:1024 sc1
s_movk_i32 s47, 29
s_lshl_b32 s47, s47, 11
buffer_load_dwordx4 v[96:99], v13, s[24:27], s47 offen offset:0 sc1
buffer_load_dwordx4 v[100:103], v13, s[24:27], s47 offen offset:1024 sc1
s_movk_i32 s47, 30
s_lshl_b32 s47, s47, 11
buffer_load_dwordx4 v[80:83], v13, s[24:27], s47 offen offset:0 sc1
buffer_load_dwordx4 v[84:87], v13, s[24:27], s47 offen offset:1024 sc1
s_call_b64 s[100:101], L_TRY
s_cbranch_scc1 L_SLOW28
v_mov_b64 v[48:49], v[120:121]
v_mov_b64 v[52:53], v[124:125]
s_branch L_BACK28
L_SLOW29:
s_movk_i32 s91, 29
s_lshl_b32 s47, s91, 11
buffer_load_dwordx4 v[120:123], v13, s[24:27], s47 offen offset:0 sc1
buffer_load_dwordx4 v[124:127], v13, s[24:27], s47 offen offset:1024 sc1
s_movk_i32 s47, 30
s_lshl_b32 s47, s47, 11
buffer_load_dwordx4 v[80:83], v13, s[24:27], s47 offen offset:0 sc1
buffer_load_dwordx4 v[84:87], v13, s[24:27], s47 offen offset:1024 sc1
s_movk_i32 s47, 31
s_lshl_b32 s47, s47, 11
buffer_load_dwordx4 v[88:91], v13, s[24:27], s47 offen offset:0 sc1
buffer_load_dwordx4 v[92:95], v13, s[24:27], s47 offen offset:1024 sc1
s_call_b64 s[100:101], L_TRY
s_cbranch_scc1 L_SLOW29
v_mov_b64 v[96:97], v[120:121]
v_mov_b64 v[100:101], v[124:125]
s_branch L_BACK29
L_SLOW30:
s_movk_i32 s91, 30
s_lshl_b32 s47, s91, 11
buffer_load_dwordx4 v[120:123], v13, s[24:27], s47 offen offset:0 sc1
buffer_load_dwordx4 v[124:127], v13, s[24:27], s47 offen offset:1024 sc1
s_movk_i32 s47, 31
s_lshl_b32 s47, s47, 11
buffer_load_dwordx4 v[88:91], v13, s[24:27], s47 offen offset:0 sc1
buffer_load_dwordx4 v[92:95], v13, s[24:27], s47 offen offset:1024 sc1
s_call_b64 s[100:101], L_TRY
s_cbranch_scc1 L_SLOW30
v_mov_b64 v[80:81], v[120:121]
v_mov_b64 v[84:85], v[124:125]
s_branch L_BACK30
L_SLOW31:
s_movk_i32 s91, 31
s_lshl_b32 s47, s91, 11
buffer_load_dwordx4 v[120:123], v13, s[24:27], s47 offen offset:0 sc1
buffer_load_dwordx4 v[124:127], v13, s[24:27], s47 offen offset:1024 sc1
s_call_b64 s[100:101], L_TRY
s_cbranch_scc1 L_SLOW31
v_mov_b64 v[88:89], v[120:121]
v_mov_b64 v[92:93], v[124:125]
s_branch L_BACK31
L_SELF:
s_mul_i32 s47, s91, 458752
s_lshl_b32 s46, s39, 8
s_add_u32 s47, s47, s46
s_add_u32 s84, s6, s47
s_addc_u32 s85, s7, 0
s_mov_b32 s86, 387328
s_mov_b32 s87, 0x20000
buffer_load_dwordx4 v[64:67], v30, s[84:87], 0 offen
buffer_load_dwordx4 v[68:71], v30, s[84:87], s92 offen
buffer_load_dwordx4 v[72:75], v30, s[84:87], s93 offen
buffer_load_dwordx4 v[76:79], v30, s[84:87], s94 offen
s_waitcnt vmcnt(0)
v_lshl_add_u64 v[64:65], v[68:69], 4, v[64:65]
v_lshl_add_u64 v[66:67], v[70:71], 4, v[66:67]
v_lshl_add_u64 v[72:73], v[76:77], 4, v[72:73]
v_lshl_add_u64 v[74:75], v[78:79], 4, v[74:75]
v_lshl_or_b32 v76, v72, 8, v64
v_lshl_or_b32 v77, v73, 8, v65
v_lshl_or_b32 v78, v74, 8, v66
v_lshl_or_b32 v79, v75, 8, v67
v_lshl_or_b32 v120, v77, 16, v76
v_lshl_or_b32 v121, v79, 16, v78
s_add_u32 s84, s84, 57344
s_addc_u32 s85, s85, 0
buffer_load_dwordx4 v[64:67], v30, s[84:87], 0 offen
buffer_load_dwordx4 v[68:71], v30, s[84:87], s92 offen
buffer_load_dwordx4 v[72:75], v30, s[84:87], s93 offen
buffer_load_dwordx4 v[76:79], v30, s[84:87], s94 offen
s_waitcnt vmcnt(0)
v_lshl_add_u64 v[64:65], v[68:69], 4, v[64:65]
v_lshl_add_u64 v[66:67], v[70:71], 4, v[66:67]
v_lshl_add_u64 v[72:73], v[76:77], 4, v[72:73]
v_lshl_add_u64 v[74:75], v[78:79], 4, v[74:75]
v_lshl_or_b32 v76, v72, 8, v64
v_lshl_or_b32 v77, v73, 8, v65
v_lshl_or_b32 v78, v74, 8, v66
v_lshl_or_b32 v79, v75, 8, v67
v_lshl_or_b32 v124, v77, 16, v76
v_lshl_or_b32 v125, v79, 16, v78
s_cmp_eq_u32 s39, -1
s_setpc_b64 s[100:101]
L_END:
s_endpgm
.section .rodata,"a"
.p2align 6
.amdhsa_kernel standalone__normalfloat_lut_af4__prompt_kernel
  .amdhsa_next_free_vgpr 512
  .amdhsa_next_free_sgpr 102
  .amdhsa_accum_offset 256
  .amdhsa_group_segment_fixed_size 0
  .amdhsa_kernarg_size 56
  .amdhsa_user_sgpr_count 2
  .amdhsa_user_sgpr_kernarg_segment_ptr 1
  .amdhsa_system_sgpr_workgroup_id_x 1
.end_amdhsa_kernel
```

```asm
; @launch grid=(256,1,1) block=(256,1,1) lds=163840
.amdgcn_target "amdgcn-amd-amdhsa--gfx950"
.text
.globl standalone__normalfloat_lut_af4__prompt_kernel
.p2align 12
.p2align 8
.type standalone__normalfloat_lut_af4__prompt_kernel,@function
standalone__normalfloat_lut_af4__prompt_kernel:
s_load_dwordx4 s[4:7], s[0:1], 0
s_load_dwordx4 s[12:15], s[0:1], 40
s_load_dwordx4 s[8:11], s[0:1], 24
s_load_dwordx2 s[50:51], s[0:1], 16
s_memrealtime s[56:57]
s_cmp_ge_u32 s2, 256
s_cbranch_scc1 L_END
s_getpc_b64 s[48:49]
L_PC0:
v_bfi_b32 v2, 7, v0, s2
v_lshlrev_b32 v2, 7, v2
v_min_u32 v2, L_END-L_PC0, v2
global_load_dword v7, v2, s[48:49]
v_lshrrev_b32 v1, 6, v0
s_cmp_lt_u32 s2, 32
v_readfirstlane_b32 s36, v1
s_cbranch_scc1 L_PACK
s_bfe_u32 s34, s2, 0x20001
s_bfe_u32 s37, s2, 0x20003
s_lshl2_add_u32 s37, s34, s37
s_and_b32 s43, s2, 1
s_mul_i32 s43, s43, 7
s_lshr_b32 s38, s2, 5
s_add_u32 s38, s38, s43
s_lshl2_add_u32 s39, s38, s36
s_sub_u32 s39, s39, 4
v_bfe_u32 v6, v0, 4, 2
v_and_b32 v3, 15, v0
v_mul_u32_u24 v2, 114688, v6
v_lshl_add_u32 v30, v3, 4, v2
s_lshr_b32 s46, s37, 1
s_and_b32 s45, s37, 1
s_lshl3_add_u32 s46, s46, s45
s_mul_i32 s46, s46, 57344
s_lshl_b32 s47, s39, 8
s_add_u32 s44, s46, s47
s_mov_b32 s18, 387328
s_mov_b32 s19, 0x20000
s_mov_b32 s92, 14336
s_mov_b32 s93, 28672
s_mov_b32 s94, 43008
s_waitcnt lgkmcnt(0)
s_load_dwordx8 s[64:71], s[50:51], 0
s_add_u32 s16, s6, s44
s_addc_u32 s17, s7, 0
buffer_load_dwordx4 v[104:107], v30, s[16:19], 0 offen
buffer_load_dwordx4 v[108:111], v30, s[16:19], s92 offen
buffer_load_dwordx4 v[112:115], v30, s[16:19], s93 offen
buffer_load_dwordx4 v[116:119], v30, s[16:19], s94 offen
s_branch L_MAIN
L_PACK:
v_lshrrev_b32 v2, 2, v0
v_and_b32 v3, 3, v0
s_lshl_b32 s45, s2, 17
v_lshl_add_u32 v2, v2, 11, s45
v_lshl_add_u32 v17, v3, 7, v2
s_mov_b32 s30, 4194304
s_mov_b32 s31, 0x20000
v_lshlrev_b32 v16, 3, v0
s_cmp_lt_u32 s2, 2
s_cselect_b32 s34, 8, 0
s_mov_b32 s35, 0x20000
v_mov_b64 v[22:23], 0
s_waitcnt lgkmcnt(0)
s_mov_b64 s[32:33], s[12:13]
v_mov_b64 v[20:21], s[56:57]
buffer_atomic_cmpswap_x2 v[20:23], v16, s[32:35], 0 offen sc1
s_mov_b64 s[28:29], s[4:5]
buffer_load_dword v19, v17, s[28:31], 0 offen offset:0
s_branch L_PACK1
L_MAIN:
s_mov_b64 s[20:21], s[4:5]
s_mov_b32 s22, 4194304
s_mov_b32 s23, 0x20000
s_lshl_b32 s46, s37, 18
v_lshrrev_b32 v5, 3, v0
v_lshl_add_u32 v2, v5, 11, s46
v_lshrrev_b32 v4, 4, v0
v_xor_b32 v4, v4, v0
v_and_b32 v4, 7, v4
v_lshl_add_u32 v8, v4, 4, v2
v_add_u32 v9, 65536, v8
v_add_u32 v10, 131072, v8
v_add_u32 v11, 196608, v8
s_lshl_b32 s33, s36, 10
s_mul_i32 s47, s45, 114688
s_sub_u32 s47, s44, s47
s_add_u32 s47, s47, 57344
s_add_u32 s84, s6, s47
s_addc_u32 s85, s7, 0
s_mov_b32 s86, 387328
s_mov_b32 s87, 0x20000
s_lshl_b32 s40, s34, 7
s_add_u32 m0, s33, 65536
s_nop 0
buffer_load_dwordx4 v8, s[20:23], s40 offen lds
s_add_u32 m0, s33, 69632
s_nop 0
buffer_load_dwordx4 v9, s[20:23], s40 offen lds
s_add_u32 m0, s33, 73728
s_nop 0
buffer_load_dwordx4 v10, s[20:23], s40 offen lds
s_add_u32 m0, s33, 77824
s_nop 0
buffer_load_dwordx4 v11, s[20:23], s40 offen lds
s_and_b32 s45, s36, 1
s_mul_i32 s45, s45, 0x0202
s_lshr_b32 s46, s36, 1
s_mul_i32 s46, s46, 0x02020000
s_add_u32 s45, s45, s46
s_add_u32 s45, s45, 0x05040100
v_mov_b32 v57, s45
v_lshlrev_b32 v5, 8, v5
v_and_b32 v58, 7, v0
v_lshl_add_u32 v58, v58, 4, v5
v_and_b32 v5, 31, v0
v_lshlrev_b32 v19, 2, v5
v_and_b32 v0, 63, v0
s_lshl_b32 s46, s39, 7
v_lshl_add_u32 v28, v3, 3, s46
s_mul_i32 s47, s37, 917504
s_add_u32 s47, s47, s46
s_add_u32 s28, s10, s47
s_addc_u32 s29, s11, 0
s_mov_b32 s30, 86144
s_mov_b32 s31, 0x20000
v_mul_u32_u24 v29, 28672, v6
v_lshl_add_u32 v18, v3, 3, v29
v_lshlrev_b32 v29, 7, v3
v_bfe_u32 v5, v0, 1, 3
v_xor_b32 v5, v5, v6
v_lshl_add_u32 v29, v5, 4, v29
v_add_u32 v14, 65536, v29
v_xor_b32 v15, 64, v14
v_add_u32 v16, 0x10000, v14
v_add_u32 v17, 0x10000, v15
s_mov_b32 s52, 0x0c0c0400
s_mov_b32 s53, 0x0c0c0500
s_mov_b32 s54, 0x0c0c0600
s_mov_b32 s55, 0x0c0c0700
v_lshlrev_b32 v13, 4, v0
s_lshl_b32 s47, s39, 16
s_add_u32 s24, s14, s47
s_addc_u32 s25, s15, 0
s_lshl_b32 s47, s37, 10
s_add_u32 s76, s24, s47
s_addc_u32 s77, s25, 0
s_movk_i32 s78, 1024
s_mov_b32 s79, 0x20000
s_lshl_b32 s47, s34, 3
s_lshr_b32 s47, 0x90d0b2d, s47
s_bfe_u32 s41, s47, 0x20000
s_lshl_b32 s41, s41, 7
s_bfe_u32 s42, s47, 0x20002
s_lshl_b32 s42, s42, 7
s_bfe_u32 s43, s47, 0x20004
s_lshl_b32 s43, s43, 7
s_lshl_b32 s47, s34, 1
s_lshr_b32 s47, 0x63, s47
s_and_b32 s47, s47, 3
s_sub_u32 s47, s47, s34
s_lshl1_add_u32 s3, s47, 14
s_mul_i32 s47, s3, 458752
s_add_u32 s16, s16, s47
s_addc_u32 s17, s17, 0
s_lshl_b32 s3, s3, 11
s_lshr_b32 s35, s37, 1
s_xor_b32 s35, s35, 1
v_lshl_add_u32 v12, s41, 5, v13
s_mul_i32 s47, s35, 458752
s_lshl_b32 s46, s39, 8
s_add_u32 s47, s47, s46
s_add_u32 s72, s6, s47
s_addc_u32 s73, s7, 0
s_mov_b32 s74, 444672
s_mov_b32 s75, 0x20000
v_add_u32 v31, 57344, v30
s_and_b32 s47, s37, 2
s_lshl_b32 s47, s47, 5
v_xor_b32 v2, s47, v14
v_xor_b32 v4, 64, v2
s_mov_b32 s26, 65536
s_mov_b32 s27, 0x20000
s_mov_b64 s[80:81], s[12:13]
s_movk_i32 s82, 128
s_mov_b32 s83, 0x20000
s_movk_i32 s90, 4096
s_waitcnt lgkmcnt(0)
s_pack_ll_b32_b16 s45, s64, s68
v_mov_b32 v56, s45
s_lshl_b64 exec, exec, 8
s_pack_hh_b32_b16 s45, s64, s68
v_mov_b32 v56, s45
s_lshl_b64 exec, exec, 8
s_pack_ll_b32_b16 s45, s65, s69
v_mov_b32 v56, s45
s_lshl_b64 exec, exec, 8
s_pack_hh_b32_b16 s45, s65, s69
v_mov_b32 v56, s45
s_lshl_b64 exec, exec, 8
s_pack_ll_b32_b16 s45, s66, s70
v_mov_b32 v56, s45
s_lshl_b64 exec, exec, 8
s_pack_hh_b32_b16 s45, s66, s70
v_mov_b32 v56, s45
s_lshl_b64 exec, exec, 8
s_pack_ll_b32_b16 s45, s67, s71
v_mov_b32 v56, s45
s_lshl_b64 exec, exec, 8
s_pack_hh_b32_b16 s45, s67, s71
v_mov_b32 v56, s45
s_mov_b64 exec, -1
v_perm_b32 v128, s64, v56, v57
v_mov_b32 v129, v128
v_mov_b64 v[130:131], v[128:129]
s_load_dwordx2 s[88:89], s[12:13], 0
ds_write_b128 v58, v[128:131] offset:0
v_perm_b32 v132, s65, v56, v57
v_mov_b32 v133, v132
v_mov_b64 v[134:135], v[132:133]
ds_write_b128 v58, v[132:135] offset:8192
v_perm_b32 v136, s66, v56, v57
v_mov_b32 v137, v136
v_mov_b64 v[138:139], v[136:137]
ds_write_b128 v58, v[136:139] offset:16384
v_perm_b32 v140, s67, v56, v57
v_mov_b32 v141, v140
v_mov_b64 v[142:143], v[140:141]
ds_write_b128 v58, v[140:143] offset:24576
v_perm_b32 v144, s68, v56, v57
v_mov_b32 v145, v144
v_mov_b64 v[146:147], v[144:145]
ds_write_b128 v58, v[144:147] offset:32768
v_perm_b32 v148, s69, v56, v57
v_mov_b32 v149, v148
v_mov_b64 v[150:151], v[148:149]
ds_write_b128 v58, v[148:151] offset:40960
v_perm_b32 v152, s70, v56, v57
v_mov_b32 v153, v152
v_mov_b64 v[154:155], v[152:153]
ds_write_b128 v58, v[152:155] offset:49152
v_perm_b32 v156, s71, v56, v57
v_mov_b32 v157, v156
v_mov_b64 v[158:159], v[156:157]
ds_write_b128 v58, v[156:159] offset:57344
buffer_load_dwordx4 v[64:67], v30, s[84:87], 0 offen
buffer_load_dwordx4 v[68:71], v30, s[84:87], s92 offen
buffer_load_dwordx4 v[72:75], v30, s[84:87], s93 offen
buffer_load_dwordx4 v[76:79], v30, s[84:87], s94 offen
s_mov_b64 vcc, -1
s_branch L_PAD0
L_PADRET0:
s_mov_b64 vcc, 0
s_waitcnt vmcnt(8)
v_lshl_add_u64 v[104:105], v[108:109], 4, v[104:105]
v_lshl_add_u64 v[106:107], v[110:111], 4, v[106:107]
v_lshl_add_u64 v[112:113], v[116:117], 4, v[112:113]
v_lshl_add_u64 v[114:115], v[118:119], 4, v[114:115]
v_lshl_or_b32 v116, v112, 8, v104
v_lshl_or_b32 v117, v113, 8, v105
v_lshl_or_b32 v118, v114, 8, v106
v_lshl_or_b32 v119, v115, 8, v107
v_lshl_or_b32 v108, v117, 16, v116
v_lshl_or_b32 v109, v119, 16, v118
s_waitcnt lgkmcnt(0)
s_cmp_eq_u64 s[88:89], 0
s_cbranch_scc1 L_NOTAG
L_TAGOK:
v_mov_b64 v[110:111], s[88:89]
buffer_store_dwordx4 v[108:111], v13, s[76:79], 0 offen sc1
s_add_u32 s76, s76, s3
s_addc_u32 s77, s77, 0
s_waitcnt lgkmcnt(0)
s_nop 0
s_branch L_STREAM
L_PACK1:
v_and_b32 v0, 63, v0
v_lshrrev_b32 v2, 4, v0
v_and_b32 v3, 15, v0
v_mul_u32_u24 v2, 114688, v2
v_lshl_add_u32 v8, v3, 4, v2
s_movk_i32 s47, 0x3800
v_add_u32 v9, s47, v8
v_add_u32 v10, s47, v9
v_add_u32 v11, s47, v10
v_add_u32 v12, s47, v11
v_add_u32 v13, s47, v12
v_add_u32 v14, s47, v13
v_add_u32 v15, s47, v14
s_sub_u32 s3, s2, 1
s_and_b32 s3, s3, 7
s_lshr_b32 s45, s2, 3
s_lshl2_add_u32 s3, s3, s45
s_mul_i32 s40, s3, 4682
s_lshr_b32 s40, s40, 16
s_mul_i32 s41, s40, 14
s_sub_u32 s41, s3, s41
s_add_u32 s40, s40, 8
s_mov_b32 s22, 14680064
s_mov_b32 s23, 0x20000
s_mov_b64 s[20:21], s[6:7]
s_cmp_ge_u32 s40, 14
s_cselect_b32 s45, 8, 0
s_add_u32 s45, s45, s40
s_lshl2_add_u32 s42, s41, s36
s_mul_i32 s43, s45, 458752
s_lshl_b32 s44, s42, 8
s_add_u32 s43, s43, s44
s_lshl_b32 s44, s42, 5
s_add_u32 s44, s44, s45
s_lshl_b32 s52, s44, 11
s_cmp_lt_u32 s45, 32
s_cselect_b32 s52, s52, 0x1000000
s_cselect_b32 s22, 14680064, 0
s_add_u32 s41, s41, 4
s_add_u32 s40, s40, 2
s_cmp_ge_u32 s41, 14
s_cselect_b32 s48, 14, 0
s_addc_u32 s40, s40, 0
s_sub_u32 s41, s41, s48
s_load_dwordx2 s[50:51], s[12:13], 0
buffer_load_dwordx4 v[32:35], v8, s[20:23], s43 offen
buffer_load_dwordx4 v[36:39], v9, s[20:23], s43 offen
buffer_load_dwordx4 v[40:43], v10, s[20:23], s43 offen
buffer_load_dwordx4 v[44:47], v11, s[20:23], s43 offen
buffer_load_dwordx4 v[48:51], v12, s[20:23], s43 offen
buffer_load_dwordx4 v[52:55], v13, s[20:23], s43 offen
buffer_load_dwordx4 v[56:59], v14, s[20:23], s43 offen
buffer_load_dwordx4 v[60:63], v15, s[20:23], s43 offen
s_mov_b64 s[24:25], s[14:15]
s_mov_b32 s26, 3670016
s_mov_b32 s27, 0x20000
s_movk_i32 s34, 128
v_mov_b32 v16, 0
v_lshlrev_b32 v18, 4, v0
s_movk_i32 s46, 4096
s_waitcnt vmcnt(4) lgkmcnt(0)
v_mov_b64 v[22:23], s[50:51]
s_nop 0
L_PKN:
v_cmp_ne_u64 vcc, 0, v[22:23]
s_sub_u32 s46, s46, 1
s_cmp_gt_i32 s46, 0
s_cbranch_vccnz L_PKGO
s_cbranch_scc0 L_END
buffer_load_dwordx2 v[22:23], v16, s[32:35], 0 offen sc1
s_waitcnt vmcnt(0)
s_branch L_PKN
L_PKGO:
s_call_b64 s[100:101], L_PK0
buffer_store_dwordx4 v[20:23], v18, s[24:27], s52 offen offset:0 sc1
s_waitcnt lgkmcnt(0)
s_call_b64 s[100:101], L_UNIT
s_mov_b32 s53, s49
buffer_load_dwordx4 v[64:67], v8, s[20:23], s43 offen
buffer_load_dwordx4 v[68:71], v9, s[20:23], s43 offen
buffer_load_dwordx4 v[72:75], v10, s[20:23], s43 offen
buffer_load_dwordx4 v[76:79], v11, s[20:23], s43 offen
s_waitcnt vmcnt(5)
s_call_b64 s[100:101], L_PK1
buffer_store_dwordx4 v[20:23], v18, s[24:27], s52 offen offset:1024 sc1
buffer_load_dwordx4 v[80:83], v12, s[20:23], s43 offen
buffer_load_dwordx4 v[84:87], v13, s[20:23], s43 offen
buffer_load_dwordx4 v[88:91], v14, s[20:23], s43 offen
buffer_load_dwordx4 v[92:95], v15, s[20:23], s43 offen
s_waitcnt vmcnt(5)
s_call_b64 s[100:101], L_PK2
buffer_store_dwordx4 v[20:23], v18, s[24:27], s53 offen offset:0 sc1
s_call_b64 s[100:101], L_UNIT
s_mov_b32 s54, s49
buffer_load_dwordx4 v[32:35], v8, s[20:23], s43 offen
buffer_load_dwordx4 v[36:39], v9, s[20:23], s43 offen
buffer_load_dwordx4 v[40:43], v10, s[20:23], s43 offen
buffer_load_dwordx4 v[44:47], v11, s[20:23], s43 offen
s_waitcnt vmcnt(5)
s_call_b64 s[100:101], L_PK3
buffer_store_dwordx4 v[20:23], v18, s[24:27], s53 offen offset:1024 sc1
buffer_load_dwordx4 v[48:51], v12, s[20:23], s43 offen
buffer_load_dwordx4 v[52:55], v13, s[20:23], s43 offen
buffer_load_dwordx4 v[56:59], v14, s[20:23], s43 offen
buffer_load_dwordx4 v[60:63], v15, s[20:23], s43 offen
s_waitcnt vmcnt(5)
s_call_b64 s[100:101], L_PK0
buffer_store_dwordx4 v[20:23], v18, s[24:27], s54 offen offset:0 sc1
s_call_b64 s[100:101], L_UNIT
s_mov_b32 s55, s49
buffer_load_dwordx4 v[64:67], v8, s[20:23], s43 offen
buffer_load_dwordx4 v[68:71], v9, s[20:23], s43 offen
buffer_load_dwordx4 v[72:75], v10, s[20:23], s43 offen
buffer_load_dwordx4 v[76:79], v11, s[20:23], s43 offen
s_waitcnt vmcnt(5)
s_call_b64 s[100:101], L_PK1
buffer_store_dwordx4 v[20:23], v18, s[24:27], s54 offen offset:1024 sc1
buffer_load_dwordx4 v[80:83], v12, s[20:23], s43 offen
buffer_load_dwordx4 v[84:87], v13, s[20:23], s43 offen
buffer_load_dwordx4 v[88:91], v14, s[20:23], s43 offen
buffer_load_dwordx4 v[92:95], v15, s[20:23], s43 offen
s_waitcnt vmcnt(5)
s_call_b64 s[100:101], L_PK2
buffer_store_dwordx4 v[20:23], v18, s[24:27], s55 offen offset:0 sc1
s_call_b64 s[100:101], L_UNIT
s_mov_b32 s52, s49
buffer_load_dwordx4 v[32:35], v8, s[20:23], s43 offen
buffer_load_dwordx4 v[36:39], v9, s[20:23], s43 offen
buffer_load_dwordx4 v[40:43], v10, s[20:23], s43 offen
buffer_load_dwordx4 v[44:47], v11, s[20:23], s43 offen
s_waitcnt vmcnt(5)
s_call_b64 s[100:101], L_PK3
buffer_store_dwordx4 v[20:23], v18, s[24:27], s55 offen offset:1024 sc1
buffer_load_dwordx4 v[48:51], v12, s[20:23], s43 offen
buffer_load_dwordx4 v[52:55], v13, s[20:23], s43 offen
buffer_load_dwordx4 v[56:59], v14, s[20:23], s43 offen
buffer_load_dwordx4 v[60:63], v15, s[20:23], s43 offen
s_waitcnt vmcnt(5)
s_call_b64 s[100:101], L_PK0
buffer_store_dwordx4 v[20:23], v18, s[24:27], s52 offen offset:0 sc1
buffer_load_dword v19, v17, s[28:31], 0 offen offset:1536
s_waitcnt vmcnt(2)
s_call_b64 s[100:101], L_PK1
buffer_store_dwordx4 v[20:23], v18, s[24:27], s52 offen offset:1024 sc1
s_call_b64 s[100:101], L_UNIT
s_mov_b32 s53, s49
buffer_load_dwordx4 v[64:67], v8, s[20:23], s43 offen
buffer_load_dwordx4 v[68:71], v9, s[20:23], s43 offen
buffer_load_dwordx4 v[72:75], v10, s[20:23], s43 offen
buffer_load_dwordx4 v[76:79], v11, s[20:23], s43 offen
buffer_load_dwordx4 v[80:83], v12, s[20:23], s43 offen
buffer_load_dwordx4 v[84:87], v13, s[20:23], s43 offen
buffer_load_dwordx4 v[88:91], v14, s[20:23], s43 offen
buffer_load_dwordx4 v[92:95], v15, s[20:23], s43 offen
s_waitcnt vmcnt(4)
s_call_b64 s[100:101], L_PK2
buffer_store_dwordx4 v[20:23], v18, s[24:27], s53 offen offset:0 sc1
s_call_b64 s[100:101], L_UNIT
s_mov_b32 s54, s49
buffer_load_dwordx4 v[32:35], v8, s[20:23], s43 offen
buffer_load_dwordx4 v[36:39], v9, s[20:23], s43 offen
buffer_load_dwordx4 v[40:43], v10, s[20:23], s43 offen
buffer_load_dwordx4 v[44:47], v11, s[20:23], s43 offen
s_waitcnt vmcnt(5)
s_call_b64 s[100:101], L_PK3
buffer_store_dwordx4 v[20:23], v18, s[24:27], s53 offen offset:1024 sc1
buffer_load_dwordx4 v[48:51], v12, s[20:23], s43 offen
buffer_load_dwordx4 v[52:55], v13, s[20:23], s43 offen
buffer_load_dwordx4 v[56:59], v14, s[20:23], s43 offen
buffer_load_dwordx4 v[60:63], v15, s[20:23], s43 offen
s_waitcnt vmcnt(5)
s_call_b64 s[100:101], L_PK0
buffer_store_dwordx4 v[20:23], v18, s[24:27], s54 offen offset:0 sc1
s_waitcnt vmcnt(1)
s_call_b64 s[100:101], L_PK1
buffer_store_dwordx4 v[20:23], v18, s[24:27], s54 offen offset:1024 sc1
s_endpgm
L_UNIT:
s_cmp_ge_u32 s40, 14
s_cselect_b32 s45, 8, 0
s_add_u32 s45, s45, s40
s_lshl2_add_u32 s42, s41, s36
s_mul_i32 s43, s45, 458752
s_lshl_b32 s44, s42, 8
s_add_u32 s43, s43, s44
s_lshl_b32 s44, s42, 5
s_add_u32 s44, s44, s45
s_lshl_b32 s49, s44, 11
s_cmp_lt_u32 s45, 32
s_cselect_b32 s49, s49, 0x1000000
s_cselect_b32 s22, 14680064, 0
s_add_u32 s41, s41, 4
s_add_u32 s40, s40, 2
s_cmp_ge_u32 s41, 14
s_cselect_b32 s48, 14, 0
s_addc_u32 s40, s40, 0
s_sub_u32 s41, s41, s48
s_setpc_b64 s[100:101]
L_PK0:
v_lshl_add_u64 v[32:33], v[36:37], 4, v[32:33]
v_lshl_add_u64 v[34:35], v[38:39], 4, v[34:35]
v_lshl_add_u64 v[40:41], v[44:45], 4, v[40:41]
v_lshl_add_u64 v[42:43], v[46:47], 4, v[42:43]
v_lshl_or_b32 v44, v40, 8, v32
v_lshl_or_b32 v45, v41, 8, v33
v_lshl_or_b32 v46, v42, 8, v34
v_lshl_or_b32 v47, v43, 8, v35
v_lshl_or_b32 v20, v45, 16, v44
v_lshl_or_b32 v21, v47, 16, v46
s_setpc_b64 s[100:101]
L_PK1:
v_lshl_add_u64 v[48:49], v[52:53], 4, v[48:49]
v_lshl_add_u64 v[50:51], v[54:55], 4, v[50:51]
v_lshl_add_u64 v[56:57], v[60:61], 4, v[56:57]
v_lshl_add_u64 v[58:59], v[62:63], 4, v[58:59]
v_lshl_or_b32 v60, v56, 8, v48
v_lshl_or_b32 v61, v57, 8, v49
v_lshl_or_b32 v62, v58, 8, v50
v_lshl_or_b32 v63, v59, 8, v51
v_lshl_or_b32 v20, v61, 16, v60
v_lshl_or_b32 v21, v63, 16, v62
s_setpc_b64 s[100:101]
L_PK2:
v_lshl_add_u64 v[64:65], v[68:69], 4, v[64:65]
v_lshl_add_u64 v[66:67], v[70:71], 4, v[66:67]
v_lshl_add_u64 v[72:73], v[76:77], 4, v[72:73]
v_lshl_add_u64 v[74:75], v[78:79], 4, v[74:75]
v_lshl_or_b32 v76, v72, 8, v64
v_lshl_or_b32 v77, v73, 8, v65
v_lshl_or_b32 v78, v74, 8, v66
v_lshl_or_b32 v79, v75, 8, v67
v_lshl_or_b32 v20, v77, 16, v76
v_lshl_or_b32 v21, v79, 16, v78
s_setpc_b64 s[100:101]
L_PK3:
v_lshl_add_u64 v[80:81], v[84:85], 4, v[80:81]
v_lshl_add_u64 v[82:83], v[86:87], 4, v[82:83]
v_lshl_add_u64 v[88:89], v[92:93], 4, v[88:89]
v_lshl_add_u64 v[90:91], v[94:95], 4, v[90:91]
v_lshl_or_b32 v92, v88, 8, v80
v_lshl_or_b32 v93, v89, 8, v81
v_lshl_or_b32 v94, v90, 8, v82
v_lshl_or_b32 v95, v91, 8, v83
v_lshl_or_b32 v20, v93, 16, v92
v_lshl_or_b32 v21, v95, 16, v94
s_setpc_b64 s[100:101]
.p2align 12
L_STREAM:
L_PAD0:
s_cbranch_vccnz L_PADRET0
buffer_load_dwordx4 v[80:83], v30, s[72:75], 0 offen
buffer_load_dwordx4 v[84:87], v30, s[72:75], s92 offen
buffer_load_dwordx4 v[88:91], v30, s[72:75], s93 offen
buffer_load_dwordx4 v[92:95], v30, s[72:75], s94 offen
s_waitcnt vmcnt(9)
s_barrier
ds_read_b128 a[240:243], v2 offset:0
ds_read_b128 a[244:247], v2 offset:2048
v_lshl_add_u32 v104, v104, 8, v19
v_lshl_add_u32 v105, v105, 8, v19
v_lshl_add_u32 v106, v106, 8, v19
v_lshl_add_u32 v107, v107, 8, v19
v_lshl_add_u32 v112, v112, 8, v19
v_lshl_add_u32 v113, v113, 8, v19
v_lshl_add_u32 v114, v114, 8, v19
v_lshl_add_u32 v115, v115, 8, v19
s_waitcnt vmcnt(5)
v_lshl_add_u64 v[64:65], v[68:69], 4, v[64:65]
v_lshl_add_u64 v[66:67], v[70:71], 4, v[66:67]
v_lshl_add_u64 v[72:73], v[76:77], 4, v[72:73]
v_lshl_add_u64 v[74:75], v[78:79], 4, v[74:75]
v_lshl_add_u32 v64, v64, 8, v19
v_lshl_add_u32 v65, v65, 8, v19
v_lshl_add_u32 v66, v66, 8, v19
v_lshl_add_u32 v67, v67, 8, v19
v_lshl_add_u32 v72, v72, 8, v19
v_lshl_add_u32 v73, v73, 8, v19
v_lshl_add_u32 v74, v74, 8, v19
v_lshl_add_u32 v75, v75, 8, v19
s_bitcmp1_b32 s37, 0
s_cbranch_scc0 L_NOSWAP
v_swap_b32 v104, v64
v_swap_b32 v105, v65
v_swap_b32 v106, v66
v_swap_b32 v107, v67
v_swap_b32 v112, v72
v_swap_b32 v113, v73
v_swap_b32 v114, v74
v_swap_b32 v115, v75
L_NOSWAP:
ds_read_b32 a0, v104
ds_read_b32 a1, v112
ds_read_b32 a2, v64
ds_read_b32 a3, v72
ds_read_b32 a4, v105
ds_read_b32 a5, v113
ds_read_b32 a6, v65
ds_read_b32 a7, v73
ds_read_b32 a8, v106
ds_read_b32 a9, v114
ds_read_b32 a10, v66
ds_read_b32 a11, v74
ds_read_b32 a12, v107
ds_read_b32 a13, v115
ds_read_b32 a14, v67
ds_read_b32 a15, v75
s_waitcnt lgkmcnt(12)
v_mfma_f32_16x16x32_bf16 v[128:131], a[240:243], a[0:3], 0
s_waitcnt lgkmcnt(8)
ds_read_b128 a[248:251], v2 offset:4096
buffer_load_dwordx4 v[40:43], v31, s[72:75], 0 offen
v_mfma_f32_16x16x32_bf16 v[132:135], a[240:243], a[4:7], 0
s_waitcnt lgkmcnt(5)
buffer_load_dwordx4 v[44:47], v31, s[72:75], s92 offen
v_mfma_f32_16x16x32_bf16 v[136:139], a[240:243], a[8:11], 0
s_waitcnt lgkmcnt(1)
buffer_load_dwordx4 v[48:51], v31, s[72:75], s93 offen
v_mfma_f32_16x16x32_bf16 v[140:143], a[240:243], a[12:15], 0
buffer_load_dwordx4 v[52:55], v31, s[72:75], s94 offen
v_mfma_f32_16x16x32_bf16 v[144:147], a[244:247], a[0:3], 0
ds_read_b128 a[252:255], v2 offset:6144
v_mfma_f32_16x16x32_bf16 v[148:151], a[244:247], a[4:7], 0
v_mfma_f32_16x16x32_bf16 v[152:155], a[244:247], a[8:11], 0
s_add_u32 m0, s33, 81920
v_mfma_f32_16x16x32_bf16 v[156:159], a[244:247], a[12:15], 0
s_waitcnt lgkmcnt(1)
v_mfma_f32_16x16x32_bf16 v[160:163], a[248:251], a[0:3], 0
ds_read_b128 a[240:243], v2 offset:8192
buffer_load_dwordx4 v8, s[20:23], s41 offen lds
v_mfma_f32_16x16x32_bf16 v[164:167], a[248:251], a[4:7], 0
v_mfma_f32_16x16x32_bf16 v[168:171], a[248:251], a[8:11], 0
s_add_u32 m0, s33, 86016
v_mfma_f32_16x16x32_bf16 v[172:175], a[248:251], a[12:15], 0
s_waitcnt lgkmcnt(1)
v_mfma_f32_16x16x32_bf16 v[176:179], a[252:255], a[0:3], 0
ds_read_b128 a[244:247], v2 offset:10240
buffer_load_dwordx4 v9, s[20:23], s41 offen lds
v_mfma_f32_16x16x32_bf16 v[180:183], a[252:255], a[4:7], 0
v_mfma_f32_16x16x32_bf16 v[184:187], a[252:255], a[8:11], 0
s_add_u32 m0, s33, 90112
v_mfma_f32_16x16x32_bf16 v[188:191], a[252:255], a[12:15], 0
s_waitcnt lgkmcnt(1)
v_mfma_f32_16x16x32_bf16 v[192:195], a[240:243], a[0:3], 0
buffer_load_dwordx4 v10, s[20:23], s41 offen lds
v_mfma_f32_16x16x32_bf16 v[196:199], a[240:243], a[4:7], 0
v_mfma_f32_16x16x32_bf16 v[200:203], a[240:243], a[8:11], 0
s_add_u32 m0, s33, 94208
v_mfma_f32_16x16x32_bf16 v[204:207], a[240:243], a[12:15], 0
s_waitcnt lgkmcnt(0)
v_mfma_f32_16x16x32_bf16 v[208:211], a[244:247], a[0:3], 0
ds_read_b128 a[248:251], v2 offset:12288
buffer_load_dwordx4 v11, s[20:23], s41 offen lds
v_mfma_f32_16x16x32_bf16 v[212:215], a[244:247], a[4:7], 0
v_mfma_f32_16x16x32_bf16 v[216:219], a[244:247], a[8:11], 0
v_mfma_f32_16x16x32_bf16 v[220:223], a[244:247], a[12:15], 0
s_waitcnt vmcnt(10)
ds_read_b128 a[252:255], v2 offset:14336
v_lshl_add_u64 v[80:81], v[84:85], 4, v[80:81]
v_lshl_add_u64 v[82:83], v[86:87], 4, v[82:83]
v_lshl_add_u32 v80, v80, 8, v19
v_lshl_add_u32 v81, v81, 8, v19
v_lshl_add_u32 v82, v82, 8, v19
v_lshl_add_u32 v83, v83, 8, v19
ds_read_b32 a16, v80
ds_read_b32 a20, v81
ds_read_b32 a24, v82
ds_read_b32 a28, v83
s_waitcnt vmcnt(8)
v_lshl_add_u64 v[88:89], v[92:93], 4, v[88:89]
v_lshl_add_u64 v[90:91], v[94:95], 4, v[90:91]
v_lshl_add_u32 v88, v88, 8, v19
v_lshl_add_u32 v89, v89, 8, v19
v_lshl_add_u32 v90, v90, 8, v19
v_lshl_add_u32 v91, v91, 8, v19
ds_read_b32 a17, v88
ds_read_b32 a21, v89
ds_read_b32 a25, v90
ds_read_b32 a29, v91
s_waitcnt vmcnt(6)
buffer_load_dwordx4 v[32:35], v12, s[24:27], 0 offen offset:0 sc1
v_lshl_add_u64 v[40:41], v[44:45], 4, v[40:41]
v_lshl_add_u64 v[42:43], v[46:47], 4, v[42:43]
v_lshl_add_u32 v40, v40, 8, v19
v_lshl_add_u32 v41, v41, 8, v19
v_lshl_add_u32 v42, v42, 8, v19
v_lshl_add_u32 v43, v43, 8, v19
ds_read_b32 a18, v40
ds_read_b32 a22, v41
ds_read_b32 a26, v42
ds_read_b32 a30, v43
s_waitcnt vmcnt(5) lgkmcnt(13)
buffer_load_dwordx4 v[36:39], v12, s[24:27], 0 offen offset:1024 sc1
v_lshl_add_u64 v[48:49], v[52:53], 4, v[48:49]
v_lshl_add_u64 v[50:51], v[54:55], 4, v[50:51]
v_lshl_add_u32 v48, v48, 8, v19
v_lshl_add_u32 v49, v49, 8, v19
v_lshl_add_u32 v50, v50, 8, v19
v_lshl_add_u32 v51, v51, 8, v19
ds_read_b32 a19, v48
ds_read_b32 a23, v49
ds_read_b32 a27, v50
ds_read_b32 a31, v51
v_mfma_f32_16x16x32_bf16 v[224:227], a[248:251], a[0:3], 0
ds_read_b128 a[240:243], v4 offset:0
v_mfma_f32_16x16x32_bf16 v[228:231], a[248:251], a[4:7], 0
v_mfma_f32_16x16x32_bf16 v[232:235], a[248:251], a[8:11], 0
global_load_dwordx2 v[20:21], v28, s[8:9]
v_mfma_f32_16x16x32_bf16 v[236:239], a[248:251], a[12:15], 0
s_waitcnt lgkmcnt(5)
v_mfma_f32_16x16x32_bf16 v[240:243], a[252:255], a[0:3], 0
ds_read_b128 a[244:247], v4 offset:2048
v_mfma_f32_16x16x32_bf16 v[244:247], a[252:255], a[4:7], 0
v_mfma_f32_16x16x32_bf16 v[248:251], a[252:255], a[8:11], 0
v_mfma_f32_16x16x32_bf16 v[252:255], a[252:255], a[12:15], 0
s_waitcnt lgkmcnt(1)
v_mfma_f32_16x16x32_bf16 v[128:131], a[240:243], a[16:19], v[128:131]
ds_read_b128 a[248:251], v4 offset:4096
v_mfma_f32_16x16x32_bf16 v[132:135], a[240:243], a[20:23], v[132:135]
v_mfma_f32_16x16x32_bf16 v[136:139], a[240:243], a[24:27], v[136:139]
buffer_load_dwordx4 v[40:43], v12, s[24:27], 0 offen offset:2048 sc1
v_mfma_f32_16x16x32_bf16 v[140:143], a[240:243], a[28:31], v[140:143]
s_waitcnt lgkmcnt(1)
buffer_load_dwordx4 v[44:47], v12, s[24:27], 0 offen offset:3072 sc1
v_mfma_f32_16x16x32_bf16 v[144:147], a[244:247], a[16:19], v[144:147]
ds_read_b128 a[252:255], v4 offset:6144
v_lshl_add_u32 v12, s42, 5, v13
v_mfma_f32_16x16x32_bf16 v[148:151], a[244:247], a[20:23], v[148:151]
v_mfma_f32_16x16x32_bf16 v[152:155], a[244:247], a[24:27], v[152:155]
v_mfma_f32_16x16x32_bf16 v[156:159], a[244:247], a[28:31], v[156:159]
s_waitcnt lgkmcnt(1)
v_mfma_f32_16x16x32_bf16 v[160:163], a[248:251], a[16:19], v[160:163]
ds_read_b128 a[240:243], v4 offset:8192
v_mfma_f32_16x16x32_bf16 v[164:167], a[248:251], a[20:23], v[164:167]
v_mfma_f32_16x16x32_bf16 v[168:171], a[248:251], a[24:27], v[168:171]
v_mfma_f32_16x16x32_bf16 v[172:175], a[248:251], a[28:31], v[172:175]
s_waitcnt lgkmcnt(1)
v_mfma_f32_16x16x32_bf16 v[176:179], a[252:255], a[16:19], v[176:179]
ds_read_b128 a[244:247], v4 offset:10240
buffer_load_dwordx4 v[48:51], v12, s[24:27], 0 offen offset:0 sc1
v_mfma_f32_16x16x32_bf16 v[180:183], a[252:255], a[20:23], v[180:183]
buffer_load_dwordx4 v[52:55], v12, s[24:27], 0 offen offset:1024 sc1
v_mfma_f32_16x16x32_bf16 v[184:187], a[252:255], a[24:27], v[184:187]
s_add_u32 m0, s33, 98304
v_mfma_f32_16x16x32_bf16 v[188:191], a[252:255], a[28:31], v[188:191]
s_waitcnt lgkmcnt(1)
v_mfma_f32_16x16x32_bf16 v[192:195], a[240:243], a[16:19], v[192:195]
buffer_load_dwordx4 v8, s[20:23], s42 offen lds
v_mfma_f32_16x16x32_bf16 v[196:199], a[240:243], a[20:23], v[196:199]
v_mfma_f32_16x16x32_bf16 v[200:203], a[240:243], a[24:27], v[200:203]
s_add_u32 m0, s33, 102400
v_mfma_f32_16x16x32_bf16 v[204:207], a[240:243], a[28:31], v[204:207]
s_waitcnt lgkmcnt(0)
v_mfma_f32_16x16x32_bf16 v[208:211], a[244:247], a[16:19], v[208:211]
s_waitcnt vmcnt(8)
s_barrier
ds_read_b128 a[248:251], v4 offset:12288
buffer_load_dwordx4 v9, s[20:23], s42 offen lds
v_mfma_f32_16x16x32_bf16 v[212:215], a[244:247], a[20:23], v[212:215]
v_mfma_f32_16x16x32_bf16 v[216:219], a[244:247], a[24:27], v[216:219]
s_add_u32 m0, s33, 106496
v_mfma_f32_16x16x32_bf16 v[220:223], a[244:247], a[28:31], v[220:223]
ds_read_b128 a[252:255], v4 offset:14336
buffer_load_dwordx4 v10, s[20:23], s42 offen lds
s_waitcnt vmcnt(8)
v_cmp_ne_u64 s[50:51], s[88:89], v[34:35]
v_cmp_ne_u64 s[44:45], s[88:89], v[38:39]
s_or_b64 s[50:51], s[44:45], s[50:51]
s_cbranch_scc1 L_SLOW2
L_BACK2:
v_perm_b32 v64, v32, v19, s52
v_perm_b32 v65, v32, v19, s53
v_perm_b32 v66, v36, v19, s52
v_perm_b32 v67, v36, v19, s53
v_perm_b32 v68, v32, v19, s54
v_perm_b32 v69, v32, v19, s55
v_perm_b32 v70, v36, v19, s54
v_perm_b32 v71, v36, v19, s55
ds_read_b32 a32, v64
ds_read_b32 a33, v65
ds_read_b32 a34, v66
ds_read_b32 a35, v67
ds_read_b32 a36, v68
ds_read_b32 a37, v69
ds_read_b32 a38, v70
ds_read_b32 a39, v71
v_perm_b32 v72, v33, v19, s52
v_perm_b32 v73, v33, v19, s53
v_perm_b32 v74, v37, v19, s52
v_perm_b32 v75, v37, v19, s53
v_perm_b32 v76, v33, v19, s54
v_perm_b32 v77, v33, v19, s55
v_perm_b32 v78, v37, v19, s54
v_perm_b32 v79, v37, v19, s55
ds_read_b32 a40, v72
ds_read_b32 a41, v73
ds_read_b32 a42, v74
ds_read_b32 a43, v75
ds_read_b32 a44, v76
ds_read_b32 a45, v77
ds_read_b32 a46, v78
ds_read_b32 a47, v79
s_add_u32 m0, s33, 110592
s_waitcnt lgkmcnt(15)
v_mfma_f32_16x16x32_bf16 v[224:227], a[248:251], a[16:19], v[224:227]
ds_read_b128 a[240:243], v14 offset:16384
buffer_load_dwordx4 v11, s[20:23], s42 offen lds
v_mfma_f32_16x16x32_bf16 v[228:231], a[248:251], a[20:23], v[228:231]
buffer_load_dwordx4 v[96:99], v12, s[24:27], 0 offen offset:2048 sc1
v_mfma_f32_16x16x32_bf16 v[232:235], a[248:251], a[24:27], v[232:235]
s_add_u32 m0, s33, 114688
buffer_load_dwordx4 v[100:103], v12, s[24:27], 0 offen offset:3072 sc1
v_mfma_f32_16x16x32_bf16 v[236:239], a[248:251], a[28:31], v[236:239]
v_lshl_add_u32 v12, s43, 5, v13
v_mfma_f32_16x16x32_bf16 v[240:243], a[252:255], a[16:19], v[240:243]
ds_read_b128 a[244:247], v14 offset:18432
buffer_load_dwordx4 v8, s[20:23], s43 offen lds
v_mfma_f32_16x16x32_bf16 v[244:247], a[252:255], a[20:23], v[244:247]
v_mfma_f32_16x16x32_bf16 v[248:251], a[252:255], a[24:27], v[248:251]
s_add_u32 m0, s33, 118784
v_mfma_f32_16x16x32_bf16 v[252:255], a[252:255], a[28:31], v[252:255]
s_waitcnt vmcnt(9) lgkmcnt(1)
v_cmp_ne_u64 s[50:51], s[88:89], v[42:43]
v_cmp_ne_u64 s[44:45], s[88:89], v[46:47]
v_mfma_f32_16x16x32_bf16 v[128:131], a[240:243], a[32:35], v[128:131]
ds_read_b128 a[248:251], v14 offset:20480
buffer_load_dwordx4 v9, s[20:23], s43 offen lds
v_mfma_f32_16x16x32_bf16 v[132:135], a[240:243], a[36:39], v[132:135]
s_or_b64 s[50:51], s[44:45], s[50:51]
v_mfma_f32_16x16x32_bf16 v[136:139], a[240:243], a[40:43], v[136:139]
s_cbranch_scc1 L_SLOW3
L_BACK3:
v_mfma_f32_16x16x32_bf16 v[140:143], a[240:243], a[44:47], v[140:143]
s_waitcnt lgkmcnt(1)
v_mfma_f32_16x16x32_bf16 v[144:147], a[244:247], a[32:35], v[144:147]
ds_read_b128 a[252:255], v14 offset:22528
v_perm_b32 v63, v40, v19, s52
v_mfma_f32_16x16x32_bf16 v[148:151], a[244:247], a[36:39], v[148:151]
ds_read_b32 a48, v63
v_perm_b32 v62, v40, v19, s53
v_mfma_f32_16x16x32_bf16 v[152:155], a[244:247], a[40:43], v[152:155]
s_add_u32 m0, s33, 122880
ds_read_b32 a49, v62
v_perm_b32 v61, v44, v19, s52
v_mfma_f32_16x16x32_bf16 v[156:159], a[244:247], a[44:47], v[156:159]
s_waitcnt lgkmcnt(3)
ds_read_b32 a50, v61
v_perm_b32 v60, v44, v19, s53
v_mfma_f32_16x16x32_bf16 v[160:163], a[248:251], a[32:35], v[160:163]
ds_read_b128 a[240:243], v14 offset:24576
buffer_load_dwordx4 v10, s[20:23], s43 offen lds
v_mfma_f32_16x16x32_bf16 v[164:167], a[248:251], a[36:39], v[164:167]
ds_read_b32 a51, v60
v_perm_b32 v59, v40, v19, s54
v_mfma_f32_16x16x32_bf16 v[168:171], a[248:251], a[40:43], v[168:171]
ds_read_b32 a52, v59
v_perm_b32 v58, v40, v19, s55
v_mfma_f32_16x16x32_bf16 v[172:175], a[248:251], a[44:47], v[172:175]
s_waitcnt lgkmcnt(4)
ds_read_b32 a53, v58
buffer_load_dwordx4 v[80:83], v12, s[24:27], 0 offen offset:0 sc1
v_mfma_f32_16x16x32_bf16 v[176:179], a[252:255], a[32:35], v[176:179]
ds_read_b128 a[244:247], v14 offset:26624
v_perm_b32 v57, v44, v19, s54
v_mfma_f32_16x16x32_bf16 v[180:183], a[252:255], a[36:39], v[180:183]
ds_read_b32 a54, v57
v_perm_b32 v56, v44, v19, s55
v_mfma_f32_16x16x32_bf16 v[184:187], a[252:255], a[40:43], v[184:187]
ds_read_b32 a55, v56
v_perm_b32 v63, v41, v19, s52
v_mfma_f32_16x16x32_bf16 v[188:191], a[252:255], a[44:47], v[188:191]
s_waitcnt lgkmcnt(4)
ds_read_b32 a56, v63
buffer_load_dwordx4 v[84:87], v12, s[24:27], 0 offen offset:1024 sc1
v_mfma_f32_16x16x32_bf16 v[192:195], a[240:243], a[32:35], v[192:195]
ds_read_b128 a[248:251], v14 offset:28672
v_perm_b32 v62, v41, v19, s53
v_mfma_f32_16x16x32_bf16 v[196:199], a[240:243], a[36:39], v[196:199]
ds_read_b32 a57, v62
v_perm_b32 v61, v45, v19, s52
v_mfma_f32_16x16x32_bf16 v[200:203], a[240:243], a[40:43], v[200:203]
s_add_u32 m0, s33, 126976
ds_read_b32 a58, v61
v_perm_b32 v60, v45, v19, s53
v_mfma_f32_16x16x32_bf16 v[204:207], a[240:243], a[44:47], v[204:207]
s_waitcnt lgkmcnt(4)
ds_read_b32 a59, v60
v_perm_b32 v59, v41, v19, s54
v_mfma_f32_16x16x32_bf16 v[208:211], a[244:247], a[32:35], v[208:211]
ds_read_b128 a[252:255], v14 offset:30720
buffer_load_dwordx4 v11, s[20:23], s43 offen lds
v_mfma_f32_16x16x32_bf16 v[212:215], a[244:247], a[36:39], v[212:215]
ds_read_b32 a60, v59
v_perm_b32 v58, v41, v19, s55
v_mfma_f32_16x16x32_bf16 v[216:219], a[244:247], a[40:43], v[216:219]
ds_read_b32 a61, v58
v_perm_b32 v57, v45, v19, s54
v_mfma_f32_16x16x32_bf16 v[220:223], a[244:247], a[44:47], v[220:223]
s_waitcnt lgkmcnt(4)
ds_read_b32 a62, v57
v_mfma_f32_16x16x32_bf16 v[224:227], a[248:251], a[32:35], v[224:227]
ds_read_b128 a[240:243], v15 offset:16384
v_perm_b32 v56, v45, v19, s55
v_mfma_f32_16x16x32_bf16 v[228:231], a[248:251], a[36:39], v[228:231]
buffer_load_dwordx4 v[104:107], v30, s[16:19], 0 offen
v_mfma_f32_16x16x32_bf16 v[232:235], a[248:251], a[40:43], v[232:235]
ds_read_b32 a63, v56
v_mfma_f32_16x16x32_bf16 v[236:239], a[248:251], a[44:47], v[236:239]
s_waitcnt vmcnt(13) lgkmcnt(3)
v_cmp_ne_u64 s[50:51], s[88:89], v[50:51]
v_cmp_ne_u64 s[44:45], s[88:89], v[54:55]
v_mfma_f32_16x16x32_bf16 v[240:243], a[252:255], a[32:35], v[240:243]
ds_read_b128 a[244:247], v15 offset:18432
v_lshlrev_b32 v24, 16, v20
s_mov_b64 vcc, -1
s_cmp_eq_u32 s36, 0
s_cbranch_scc1 L_PAD1
s_cmp_eq_u32 s36, 1
s_cbranch_scc1 L_PAD3
s_cmp_eq_u32 s36, 2
s_cbranch_scc1 L_PAD5
s_cmp_eq_u32 s36, 3
s_cbranch_scc1 L_PADS
L_PADRET:
s_mov_b64 vcc, 0
v_mfma_f32_16x16x32_bf16 v[244:247], a[252:255], a[36:39], v[244:247]
s_or_b64 s[50:51], s[44:45], s[50:51]
v_and_b32 v25, 0xffff0000, v20
v_lshlrev_b32 v26, 16, v21
v_mfma_f32_16x16x32_bf16 v[248:251], a[252:255], a[40:43], v[248:251]
s_cbranch_scc1 L_SLOW4
L_BACK4:
v_mfma_f32_16x16x32_bf16 v[252:255], a[252:255], a[44:47], v[252:255]
s_waitcnt lgkmcnt(1)
v_and_b32 v27, 0xffff0000, v21
v_mfma_f32_16x16x32_bf16 v[128:131], a[240:243], a[48:51], v[128:131]
ds_read_b128 a[248:251], v15 offset:20480
v_mfma_f32_16x16x32_bf16 v[132:135], a[240:243], a[52:55], v[132:135]
buffer_load_dwordx4 v[108:111], v30, s[16:19], s92 offen
v_mfma_f32_16x16x32_bf16 v[136:139], a[240:243], a[56:59], v[136:139]
buffer_load_dwordx4 v[88:91], v12, s[24:27], 0 offen offset:2048 sc1
v_perm_b32 v63, v48, v19, s52
v_mfma_f32_16x16x32_bf16 v[140:143], a[240:243], a[60:63], v[140:143]
s_waitcnt lgkmcnt(1)
ds_read_b32 a64, v63
buffer_load_dwordx4 v[92:95], v12, s[24:27], 0 offen offset:3072 sc1
v_mfma_f32_16x16x32_bf16 v[144:147], a[244:247], a[48:51], v[144:147]
ds_read_b128 a[252:255], v15 offset:22528
v_perm_b32 v62, v48, v19, s53
v_mfma_f32_16x16x32_bf16 v[148:151], a[244:247], a[52:55], v[148:151]
ds_read_b32 a65, v62
v_perm_b32 v61, v52, v19, s52
v_mfma_f32_16x16x32_bf16 v[152:155], a[244:247], a[56:59], v[152:155]
ds_read_b32 a66, v61
v_perm_b32 v60, v52, v19, s53
v_mfma_f32_16x16x32_bf16 v[156:159], a[244:247], a[60:63], v[156:159]
s_waitcnt lgkmcnt(4)
ds_read_b32 a67, v60
v_add_u32 v12, 16384, v13
v_mfma_f32_16x16x32_bf16 v[160:163], a[248:251], a[48:51], v[160:163]
ds_read_b128 a[240:243], v15 offset:24576
v_perm_b32 v59, v48, v19, s54
v_mfma_f32_16x16x32_bf16 v[164:167], a[248:251], a[52:55], v[164:167]
buffer_load_dwordx4 v[112:115], v30, s[16:19], s93 offen
v_mfma_f32_16x16x32_bf16 v[168:171], a[248:251], a[56:59], v[168:171]
s_add_u32 m0, s33, 130560
ds_read_b32 a68, v59
v_perm_b32 v58, v48, v19, s55
v_mfma_f32_16x16x32_bf16 v[172:175], a[248:251], a[60:63], v[172:175]
s_waitcnt lgkmcnt(3)
ds_read_b32 a69, v58
v_perm_b32 v57, v52, v19, s54
v_mfma_f32_16x16x32_bf16 v[176:179], a[252:255], a[48:51], v[176:179]
ds_read_b128 a[244:247], v15 offset:26624
buffer_load_dwordx4 v8, s[20:23], 0 offen offset:512 lds
v_mfma_f32_16x16x32_bf16 v[180:183], a[252:255], a[52:55], v[180:183]
ds_read_b32 a70, v57
v_perm_b32 v56, v52, v19, s55
v_mfma_f32_16x16x32_bf16 v[184:187], a[252:255], a[56:59], v[184:187]
ds_read_b32 a71, v56
v_perm_b32 v63, v49, v19, s52
v_mfma_f32_16x16x32_bf16 v[188:191], a[252:255], a[60:63], v[188:191]
s_waitcnt lgkmcnt(4)
ds_read_b32 a72, v63
v_mfma_f32_16x16x32_bf16 v[192:195], a[240:243], a[48:51], v[192:195]
s_waitcnt vmcnt(14)
s_barrier
ds_read_b128 a[248:251], v15 offset:28672
v_perm_b32 v62, v49, v19, s53
v_mfma_f32_16x16x32_bf16 v[196:199], a[240:243], a[52:55], v[196:199]
buffer_load_dwordx4 v[116:119], v30, s[16:19], s94 offen
v_mfma_f32_16x16x32_bf16 v[200:203], a[240:243], a[56:59], v[200:203]
ds_read_b32 a73, v62
v_perm_b32 v61, v53, v19, s52
v_mfma_f32_16x16x32_bf16 v[204:207], a[240:243], a[60:63], v[204:207]
s_waitcnt lgkmcnt(3)
ds_read_b32 a74, v61
v_mfma_f32_16x16x32_bf16 v[208:211], a[244:247], a[48:51], v[208:211]
ds_read_b128 a[252:255], v15 offset:30720
v_perm_b32 v60, v53, v19, s53
v_mfma_f32_16x16x32_bf16 v[212:215], a[244:247], a[52:55], v[212:215]
ds_read_b32 a75, v60
v_perm_b32 v59, v49, v19, s54
v_mfma_f32_16x16x32_bf16 v[216:219], a[244:247], a[56:59], v[216:219]
ds_read_b32 a76, v59
v_perm_b32 v58, v49, v19, s55
v_mfma_f32_16x16x32_bf16 v[220:223], a[244:247], a[60:63], v[220:223]
s_waitcnt lgkmcnt(4)
ds_read_b32 a77, v58
v_mfma_f32_16x16x32_bf16 v[224:227], a[248:251], a[48:51], v[224:227]
ds_read_b128 a[240:243], v14 offset:32768
v_perm_b32 v57, v53, v19, s54
v_mfma_f32_16x16x32_bf16 v[228:231], a[248:251], a[52:55], v[228:231]
ds_read_b32 a78, v57
v_perm_b32 v56, v53, v19, s55
v_mfma_f32_16x16x32_bf16 v[232:235], a[248:251], a[56:59], v[232:235]
s_add_u32 m0, s33, 134656
ds_read_b32 a79, v56
v_mfma_f32_16x16x32_bf16 v[236:239], a[248:251], a[60:63], v[236:239]
s_waitcnt lgkmcnt(4)
v_mfma_f32_16x16x32_bf16 v[240:243], a[252:255], a[48:51], v[240:243]
ds_read_b128 a[244:247], v14 offset:34816
buffer_load_dwordx4 v9, s[20:23], 0 offen offset:512 lds
v_mfma_f32_16x16x32_bf16 v[244:247], a[252:255], a[52:55], v[244:247]
v_mfma_f32_16x16x32_bf16 v[248:251], a[252:255], a[56:59], v[248:251]
v_mfma_f32_16x16x32_bf16 v[252:255], a[252:255], a[60:63], v[252:255]
s_waitcnt vmcnt(14) lgkmcnt(1)
v_cmp_ne_u64 s[50:51], s[88:89], v[98:99]
v_cmp_ne_u64 s[44:45], s[88:89], v[102:103]
v_mfma_f32_16x16x32_bf16 v[128:131], a[240:243], a[64:67], v[128:131]
ds_read_b128 a[248:251], v14 offset:36864
v_mfma_f32_16x16x32_bf16 v[132:135], a[240:243], a[68:71], v[132:135]
s_or_b64 s[50:51], s[44:45], s[50:51]
v_mfma_f32_16x16x32_bf16 v[136:139], a[240:243], a[72:75], v[136:139]
s_cbranch_scc1 L_SLOW5
L_BACK5:
v_mfma_f32_16x16x32_bf16 v[140:143], a[240:243], a[76:79], v[140:143]
s_waitcnt lgkmcnt(1)
v_mfma_f32_16x16x32_bf16 v[144:147], a[244:247], a[64:67], v[144:147]
ds_read_b128 a[252:255], v14 offset:38912
v_mfma_f32_16x16x32_bf16 v[148:151], a[244:247], a[68:71], v[148:151]
v_perm_b32 v63, v96, v19, s52
v_mfma_f32_16x16x32_bf16 v[152:155], a[244:247], a[72:75], v[152:155]
s_add_u32 m0, s33, 138752
ds_read_b32 a80, v63
v_perm_b32 v62, v96, v19, s53
v_mfma_f32_16x16x32_bf16 v[156:159], a[244:247], a[76:79], v[156:159]
s_waitcnt lgkmcnt(2)
ds_read_b32 a81, v62
v_perm_b32 v61, v100, v19, s52
v_mfma_f32_16x16x32_bf16 v[160:163], a[248:251], a[64:67], v[160:163]
ds_read_b128 a[240:243], v14 offset:40960
buffer_load_dwordx4 v10, s[20:23], 0 offen offset:512 lds
v_mfma_f32_16x16x32_bf16 v[164:167], a[248:251], a[68:71], v[164:167]
ds_read_b32 a82, v61
v_perm_b32 v60, v100, v19, s53
v_mfma_f32_16x16x32_bf16 v[168:171], a[248:251], a[72:75], v[168:171]
ds_read_b32 a83, v60
v_perm_b32 v59, v96, v19, s54
v_mfma_f32_16x16x32_bf16 v[172:175], a[248:251], a[76:79], v[172:175]
s_waitcnt lgkmcnt(4)
ds_read_b32 a84, v59
buffer_load_dwordx4 v[32:35], v12, s[24:27], 0 offen offset:0 sc1
v_mfma_f32_16x16x32_bf16 v[176:179], a[252:255], a[64:67], v[176:179]
ds_read_b128 a[244:247], v14 offset:43008
v_perm_b32 v58, v96, v19, s55
v_mfma_f32_16x16x32_bf16 v[180:183], a[252:255], a[68:71], v[180:183]
ds_read_b32 a85, v58
v_perm_b32 v57, v100, v19, s54
v_mfma_f32_16x16x32_bf16 v[184:187], a[252:255], a[72:75], v[184:187]
ds_read_b32 a86, v57
v_perm_b32 v56, v100, v19, s55
v_mfma_f32_16x16x32_bf16 v[188:191], a[252:255], a[76:79], v[188:191]
s_waitcnt lgkmcnt(4)
ds_read_b32 a87, v56
buffer_load_dwordx4 v[36:39], v12, s[24:27], 0 offen offset:1024 sc1
v_mfma_f32_16x16x32_bf16 v[192:195], a[240:243], a[64:67], v[192:195]
ds_read_b128 a[248:251], v14 offset:45056
v_perm_b32 v63, v97, v19, s52
v_mfma_f32_16x16x32_bf16 v[196:199], a[240:243], a[68:71], v[196:199]
ds_read_b32 a88, v63
v_perm_b32 v62, v97, v19, s53
v_mfma_f32_16x16x32_bf16 v[200:203], a[240:243], a[72:75], v[200:203]
s_add_u32 m0, s33, 142848
ds_read_b32 a89, v62
v_perm_b32 v61, v101, v19, s52
v_mfma_f32_16x16x32_bf16 v[204:207], a[240:243], a[76:79], v[204:207]
s_waitcnt lgkmcnt(4)
ds_read_b32 a90, v61
v_perm_b32 v60, v101, v19, s53
v_mfma_f32_16x16x32_bf16 v[208:211], a[244:247], a[64:67], v[208:211]
ds_read_b128 a[252:255], v14 offset:47104
buffer_load_dwordx4 v11, s[20:23], 0 offen offset:512 lds
v_mfma_f32_16x16x32_bf16 v[212:215], a[244:247], a[68:71], v[212:215]
ds_read_b32 a91, v60
v_perm_b32 v59, v97, v19, s54
v_mfma_f32_16x16x32_bf16 v[216:219], a[244:247], a[72:75], v[216:219]
ds_read_b32 a92, v59
v_perm_b32 v58, v97, v19, s55
v_mfma_f32_16x16x32_bf16 v[220:223], a[244:247], a[76:79], v[220:223]
s_waitcnt lgkmcnt(4)
ds_read_b32 a93, v58
v_mfma_f32_16x16x32_bf16 v[224:227], a[248:251], a[64:67], v[224:227]
ds_read_b128 a[240:243], v15 offset:32768
v_perm_b32 v57, v101, v19, s54
v_mfma_f32_16x16x32_bf16 v[228:231], a[248:251], a[68:71], v[228:231]
ds_read_b32 a94, v57
v_perm_b32 v56, v101, v19, s55
v_mfma_f32_16x16x32_bf16 v[232:235], a[248:251], a[72:75], v[232:235]
L_PAD1:
s_cbranch_vccnz L_PAD2
ds_read_b32 a95, v56
v_mfma_f32_16x16x32_bf16 v[236:239], a[248:251], a[76:79], v[236:239]
s_waitcnt lgkmcnt(4)
v_mfma_f32_16x16x32_bf16 v[240:243], a[252:255], a[64:67], v[240:243]
ds_read_b128 a[244:247], v15 offset:34816
v_mfma_f32_16x16x32_bf16 v[244:247], a[252:255], a[68:71], v[244:247]
v_mfma_f32_16x16x32_bf16 v[248:251], a[252:255], a[72:75], v[248:251]
s_waitcnt vmcnt(13)
v_cmp_ne_u64 s[50:51], s[88:89], v[82:83]
v_cmp_ne_u64 s[44:45], s[88:89], v[86:87]
v_mfma_f32_16x16x32_bf16 v[252:255], a[252:255], a[76:79], v[252:255]
s_waitcnt lgkmcnt(1)
v_mfma_f32_16x16x32_bf16 v[128:131], a[240:243], a[80:83], v[128:131]
s_or_b64 s[50:51], s[44:45], s[50:51]
ds_read_b128 a[248:251], v15 offset:36864
v_mfma_f32_16x16x32_bf16 v[132:135], a[240:243], a[84:87], v[132:135]
s_cbranch_scc1 L_SLOW6
L_BACK6:
v_mfma_f32_16x16x32_bf16 v[136:139], a[240:243], a[88:91], v[136:139]
v_perm_b32 v63, v80, v19, s52
v_mfma_f32_16x16x32_bf16 v[140:143], a[240:243], a[92:95], v[140:143]
s_waitcnt lgkmcnt(1)
ds_read_b32 a96, v63
v_mfma_f32_16x16x32_bf16 v[144:147], a[244:247], a[80:83], v[144:147]
ds_read_b128 a[252:255], v15 offset:38912
v_perm_b32 v62, v80, v19, s53
v_mfma_f32_16x16x32_bf16 v[148:151], a[244:247], a[84:87], v[148:151]
ds_read_b32 a97, v62
v_perm_b32 v61, v84, v19, s52
v_mfma_f32_16x16x32_bf16 v[152:155], a[244:247], a[88:91], v[152:155]
ds_read_b32 a98, v61
v_perm_b32 v60, v84, v19, s53
v_mfma_f32_16x16x32_bf16 v[156:159], a[244:247], a[92:95], v[156:159]
s_waitcnt lgkmcnt(4)
ds_read_b32 a99, v60
v_mfma_f32_16x16x32_bf16 v[160:163], a[248:251], a[80:83], v[160:163]
ds_read_b128 a[240:243], v15 offset:40960
v_perm_b32 v59, v80, v19, s54
v_mfma_f32_16x16x32_bf16 v[164:167], a[248:251], a[84:87], v[164:167]
ds_read_b32 a100, v59
v_perm_b32 v58, v80, v19, s55
v_mfma_f32_16x16x32_bf16 v[168:171], a[248:251], a[88:91], v[168:171]
s_add_u32 m0, s33, 146816
ds_read_b32 a101, v58
v_perm_b32 v57, v84, v19, s54
v_mfma_f32_16x16x32_bf16 v[172:175], a[248:251], a[92:95], v[172:175]
s_waitcnt lgkmcnt(4)
ds_read_b32 a102, v57
v_perm_b32 v56, v84, v19, s55
v_mfma_f32_16x16x32_bf16 v[176:179], a[252:255], a[80:83], v[176:179]
ds_read_b128 a[244:247], v15 offset:43008
buffer_load_dwordx4 v8, s[20:23], 0 offen offset:640 lds
v_mfma_f32_16x16x32_bf16 v[180:183], a[252:255], a[84:87], v[180:183]
ds_read_b32 a103, v56
v_perm_b32 v63, v81, v19, s52
v_mfma_f32_16x16x32_bf16 v[184:187], a[252:255], a[88:91], v[184:187]
ds_read_b32 a104, v63
v_perm_b32 v62, v81, v19, s53
v_mfma_f32_16x16x32_bf16 v[188:191], a[252:255], a[92:95], v[188:191]
s_waitcnt lgkmcnt(4)
ds_read_b32 a105, v62
buffer_load_dwordx4 v[40:43], v12, s[24:27], 0 offen offset:2048 sc1
v_mfma_f32_16x16x32_bf16 v[192:195], a[240:243], a[80:83], v[192:195]
s_waitcnt vmcnt(14)
s_barrier
ds_read_b128 a[248:251], v15 offset:45056
v_perm_b32 v61, v85, v19, s52
v_mfma_f32_16x16x32_bf16 v[196:199], a[240:243], a[84:87], v[196:199]
ds_read_b32 a106, v61
v_perm_b32 v60, v85, v19, s53
v_mfma_f32_16x16x32_bf16 v[200:203], a[240:243], a[88:91], v[200:203]
ds_read_b32 a107, v60
v_perm_b32 v59, v81, v19, s54
v_mfma_f32_16x16x32_bf16 v[204:207], a[240:243], a[92:95], v[204:207]
s_waitcnt lgkmcnt(4)
ds_read_b32 a108, v59
buffer_load_dwordx4 v[44:47], v12, s[24:27], 0 offen offset:3072 sc1
v_mfma_f32_16x16x32_bf16 v[208:211], a[244:247], a[80:83], v[208:211]
ds_read_b128 a[252:255], v15 offset:47104
v_perm_b32 v58, v81, v19, s55
v_mfma_f32_16x16x32_bf16 v[212:215], a[244:247], a[84:87], v[212:215]
ds_read_b32 a109, v58
v_perm_b32 v57, v85, v19, s54
v_mfma_f32_16x16x32_bf16 v[216:219], a[244:247], a[88:91], v[216:219]
s_waitcnt vmcnt(11)
v_cmp_ne_u64 s[50:51], s[88:89], v[90:91]
v_cmp_ne_u64 s[44:45], s[88:89], v[94:95]
v_mfma_f32_16x16x32_bf16 v[220:223], a[244:247], a[92:95], v[220:223]
s_waitcnt lgkmcnt(3)
ds_read_b32 a110, v57
v_add_u32 v12, 20480, v13
v_mfma_f32_16x16x32_bf16 v[224:227], a[248:251], a[80:83], v[224:227]
s_or_b64 s[50:51], s[44:45], s[50:51]
ds_read_b128 a[240:243], v14 offset:49152
v_perm_b32 v56, v85, v19, s55
v_mfma_f32_16x16x32_bf16 v[228:231], a[248:251], a[84:87], v[228:231]
s_cbranch_scc1 L_SLOW7
L_BACK7:
v_mfma_f32_16x16x32_bf16 v[232:235], a[248:251], a[88:91], v[232:235]
s_add_u32 m0, s33, 150912
ds_read_b32 a111, v56
v_mfma_f32_16x16x32_bf16 v[236:239], a[248:251], a[92:95], v[236:239]
s_waitcnt lgkmcnt(3)
v_perm_b32 v63, v88, v19, s52
v_mfma_f32_16x16x32_bf16 v[240:243], a[252:255], a[80:83], v[240:243]
ds_read_b128 a[244:247], v14 offset:51200
buffer_load_dwordx4 v9, s[20:23], 0 offen offset:640 lds
v_mfma_f32_16x16x32_bf16 v[244:247], a[252:255], a[84:87], v[244:247]
ds_read_b32 a112, v63
v_perm_b32 v62, v88, v19, s53
v_mfma_f32_16x16x32_bf16 v[248:251], a[252:255], a[88:91], v[248:251]
ds_read_b32 a113, v62
v_perm_b32 v61, v92, v19, s52
v_mfma_f32_16x16x32_bf16 v[252:255], a[252:255], a[92:95], v[252:255]
s_waitcnt lgkmcnt(3)
ds_read_b32 a114, v61
v_mfma_f32_16x16x32_bf16 v[128:131], a[240:243], a[96:99], v[128:131]
ds_read_b128 a[248:251], v14 offset:53248
v_mfma_f32_16x16x32_bf16 v[132:135], a[240:243], a[100:103], v[132:135]
s_waitcnt vmcnt(9)
v_perm_b32 v60, v92, v19, s53
v_lshl_add_u64 v[104:105], v[108:109], 4, v[104:105]
v_mfma_f32_16x16x32_bf16 v[136:139], a[240:243], a[104:107], v[136:139]
ds_read_b32 a115, v60
v_perm_b32 v59, v88, v19, s54
v_mfma_f32_16x16x32_bf16 v[140:143], a[240:243], a[108:111], v[140:143]
s_waitcnt lgkmcnt(3)
ds_read_b32 a116, v59
v_perm_b32 v58, v88, v19, s55
v_mfma_f32_16x16x32_bf16 v[144:147], a[244:247], a[96:99], v[144:147]
ds_read_b128 a[252:255], v14 offset:55296
v_lshl_add_u64 v[106:107], v[110:111], 4, v[106:107]
v_mfma_f32_16x16x32_bf16 v[148:151], a[244:247], a[100:103], v[148:151]
ds_read_b32 a117, v58
v_perm_b32 v57, v92, v19, s54
v_mfma_f32_16x16x32_bf16 v[152:155], a[244:247], a[104:107], v[152:155]
s_add_u32 m0, s33, 155008
ds_read_b32 a118, v57
v_mfma_f32_16x16x32_bf16 v[156:159], a[244:247], a[108:111], v[156:159]
s_waitcnt lgkmcnt(4)
v_perm_b32 v56, v92, v19, s55
v_lshl_add_u64 v[112:113], v[116:117], 4, v[112:113]
v_mfma_f32_16x16x32_bf16 v[160:163], a[248:251], a[96:99], v[160:163]
ds_read_b128 a[240:243], v14 offset:57344
buffer_load_dwordx4 v10, s[20:23], 0 offen offset:640 lds
v_mfma_f32_16x16x32_bf16 v[164:167], a[248:251], a[100:103], v[164:167]
ds_read_b32 a119, v56
v_mfma_f32_16x16x32_bf16 v[168:171], a[248:251], a[104:107], v[168:171]
v_perm_b32 v63, v89, v19, s52
v_lshl_add_u64 v[114:115], v[118:119], 4, v[114:115]
v_mfma_f32_16x16x32_bf16 v[172:175], a[248:251], a[108:111], v[172:175]
s_waitcnt lgkmcnt(2)
ds_read_b32 a120, v63
buffer_load_dwordx4 v[48:51], v12, s[24:27], 0 offen offset:0 sc1
v_mfma_f32_16x16x32_bf16 v[176:179], a[252:255], a[96:99], v[176:179]
ds_read_b128 a[244:247], v14 offset:59392
buffer_load_dwordx4 v[52:55], v12, s[24:27], 0 offen offset:1024 sc1
v_mfma_f32_16x16x32_bf16 v[180:183], a[252:255], a[100:103], v[180:183]
v_perm_b32 v62, v89, v19, s53
v_lshl_or_b32 v116, v112, 8, v104
v_mfma_f32_16x16x32_bf16 v[184:187], a[252:255], a[104:107], v[184:187]
ds_read_b32 a121, v62
v_perm_b32 v61, v93, v19, s52
v_mfma_f32_16x16x32_bf16 v[188:191], a[252:255], a[108:111], v[188:191]
s_waitcnt lgkmcnt(3)
ds_read_b32 a122, v61
v_perm_b32 v60, v93, v19, s53
v_mfma_f32_16x16x32_bf16 v[192:195], a[240:243], a[96:99], v[192:195]
ds_read_b128 a[248:251], v14 offset:61440
v_lshl_or_b32 v117, v113, 8, v105
v_mfma_f32_16x16x32_bf16 v[196:199], a[240:243], a[100:103], v[196:199]
ds_read_b32 a123, v60
v_perm_b32 v59, v89, v19, s54
v_mfma_f32_16x16x32_bf16 v[200:203], a[240:243], a[104:107], v[200:203]
s_add_u32 m0, s33, 159104
ds_read_b32 a124, v59
v_mfma_f32_16x16x32_bf16 v[204:207], a[240:243], a[108:111], v[204:207]
s_waitcnt lgkmcnt(4)
v_perm_b32 v58, v89, v19, s55
v_lshl_or_b32 v118, v114, 8, v106
v_mfma_f32_16x16x32_bf16 v[208:211], a[244:247], a[96:99], v[208:211]
ds_read_b128 a[252:255], v14 offset:63488
buffer_load_dwordx4 v11, s[20:23], 0 offen offset:640 lds
v_mfma_f32_16x16x32_bf16 v[212:215], a[244:247], a[100:103], v[212:215]
ds_read_b32 a125, v58
v_mfma_f32_16x16x32_bf16 v[216:219], a[244:247], a[104:107], v[216:219]
v_perm_b32 v57, v93, v19, s54
v_lshl_or_b32 v119, v115, 8, v107
v_mfma_f32_16x16x32_bf16 v[220:223], a[244:247], a[108:111], v[220:223]
s_waitcnt lgkmcnt(2)
ds_read_b32 a126, v57
v_mfma_f32_16x16x32_bf16 v[224:227], a[248:251], a[96:99], v[224:227]
ds_read_b128 a[240:243], v15 offset:49152
v_mfma_f32_16x16x32_bf16 v[228:231], a[248:251], a[100:103], v[228:231]
v_perm_b32 v56, v93, v19, s55
v_lshl_or_b32 v108, v117, 16, v116
v_mfma_f32_16x16x32_bf16 v[232:235], a[248:251], a[104:107], v[232:235]
ds_read_b32 a127, v56
v_mfma_f32_16x16x32_bf16 v[236:239], a[248:251], a[108:111], v[236:239]
s_waitcnt lgkmcnt(3)
v_mfma_f32_16x16x32_bf16 v[240:243], a[252:255], a[96:99], v[240:243]
ds_read_b128 a[244:247], v15 offset:51200
v_lshl_or_b32 v109, v119, 16, v118
v_mfma_f32_16x16x32_bf16 v[244:247], a[252:255], a[100:103], v[244:247]
v_mfma_f32_16x16x32_bf16 v[248:251], a[252:255], a[104:107], v[248:251]
s_waitcnt vmcnt(9)
v_cmp_ne_u64 s[50:51], s[88:89], v[34:35]
v_mfma_f32_16x16x32_bf16 v[252:255], a[252:255], a[108:111], v[252:255]
s_waitcnt lgkmcnt(1)
v_cmp_ne_u64 s[44:45], s[88:89], v[38:39]
v_mov_b64 v[110:111], s[88:89]
v_mfma_f32_16x16x32_bf16 v[128:131], a[240:243], a[112:115], v[128:131]
ds_read_b128 a[248:251], v15 offset:53248
v_mfma_f32_16x16x32_bf16 v[132:135], a[240:243], a[116:119], v[132:135]
s_or_b64 s[50:51], s[44:45], s[50:51]
v_mfma_f32_16x16x32_bf16 v[136:139], a[240:243], a[120:123], v[136:139]
s_cbranch_scc1 L_SLOW8
L_BACK8:
v_mfma_f32_16x16x32_bf16 v[140:143], a[240:243], a[124:127], v[140:143]
s_waitcnt lgkmcnt(1)
v_mfma_f32_16x16x32_bf16 v[144:147], a[244:247], a[112:115], v[144:147]
ds_read_b128 a[252:255], v15 offset:55296
v_perm_b32 v63, v32, v19, s52
v_mfma_f32_16x16x32_bf16 v[148:151], a[244:247], a[116:119], v[148:151]
buffer_store_dwordx4 v[108:111], v13, s[76:79], 0 offen sc1
v_mfma_f32_16x16x32_bf16 v[152:155], a[244:247], a[120:123], v[152:155]
ds_read_b32 a128, v63
v_perm_b32 v62, v32, v19, s53
v_mfma_f32_16x16x32_bf16 v[156:159], a[244:247], a[124:127], v[156:159]
s_waitcnt lgkmcnt(2)
ds_read_b32 a129, v62
v_mfma_f32_16x16x32_bf16 v[160:163], a[248:251], a[112:115], v[160:163]
ds_read_b128 a[240:243], v15 offset:57344
v_perm_b32 v61, v36, v19, s52
v_mfma_f32_16x16x32_bf16 v[164:167], a[248:251], a[116:119], v[164:167]
ds_read_b32 a130, v61
v_perm_b32 v60, v36, v19, s53
v_mfma_f32_16x16x32_bf16 v[168:171], a[248:251], a[120:123], v[168:171]
s_add_u32 m0, s33, 64768
ds_read_b32 a131, v60
v_perm_b32 v59, v32, v19, s54
v_mfma_f32_16x16x32_bf16 v[172:175], a[248:251], a[124:127], v[172:175]
s_waitcnt lgkmcnt(4)
ds_read_b32 a132, v59
v_perm_b32 v58, v32, v19, s55
v_mfma_f32_16x16x32_bf16 v[176:179], a[252:255], a[112:115], v[176:179]
ds_read_b128 a[244:247], v15 offset:59392
buffer_load_dwordx4 v8, s[20:23], 0 offen offset:768 lds
v_mfma_f32_16x16x32_bf16 v[180:183], a[252:255], a[116:119], v[180:183]
ds_read_b32 a133, v58
v_perm_b32 v57, v36, v19, s54
v_mfma_f32_16x16x32_bf16 v[184:187], a[252:255], a[120:123], v[184:187]
ds_read_b32 a134, v57
v_perm_b32 v56, v36, v19, s55
v_mfma_f32_16x16x32_bf16 v[188:191], a[252:255], a[124:127], v[188:191]
s_waitcnt lgkmcnt(4)
ds_read_b32 a135, v56
buffer_load_dwordx4 v[96:99], v12, s[24:27], 0 offen offset:2048 sc1
v_mfma_f32_16x16x32_bf16 v[192:195], a[240:243], a[112:115], v[192:195]
s_waitcnt vmcnt(11)
s_barrier
ds_read_b128 a[248:251], v15 offset:61440
v_perm_b32 v63, v33, v19, s52
v_mfma_f32_16x16x32_bf16 v[196:199], a[240:243], a[116:119], v[196:199]
ds_read_b32 a136, v63
v_perm_b32 v62, v33, v19, s53
v_mfma_f32_16x16x32_bf16 v[200:203], a[240:243], a[120:123], v[200:203]
ds_read_b32 a137, v62
v_perm_b32 v61, v37, v19, s52
v_mfma_f32_16x16x32_bf16 v[204:207], a[240:243], a[124:127], v[204:207]
s_waitcnt lgkmcnt(4)
ds_read_b32 a138, v61
buffer_load_dwordx4 v[100:103], v12, s[24:27], 0 offen offset:3072 sc1
v_mfma_f32_16x16x32_bf16 v[208:211], a[244:247], a[112:115], v[208:211]
ds_read_b128 a[252:255], v15 offset:63488
v_perm_b32 v60, v37, v19, s53
v_mfma_f32_16x16x32_bf16 v[212:215], a[244:247], a[116:119], v[212:215]
ds_read_b32 a139, v60
v_perm_b32 v59, v33, v19, s54
v_mfma_f32_16x16x32_bf16 v[216:219], a[244:247], a[120:123], v[216:219]
ds_read_b32 a140, v59
v_perm_b32 v58, v33, v19, s55
v_mfma_f32_16x16x32_bf16 v[220:223], a[244:247], a[124:127], v[220:223]
s_waitcnt lgkmcnt(4)
ds_read_b32 a141, v58
v_add_u32 v12, 24576, v13
v_mfma_f32_16x16x32_bf16 v[224:227], a[248:251], a[112:115], v[224:227]
ds_read_b128 a[240:243], v16 offset:0
v_perm_b32 v57, v37, v19, s54
v_mfma_f32_16x16x32_bf16 v[228:231], a[248:251], a[116:119], v[228:231]
ds_read_b32 a142, v57
v_perm_b32 v56, v37, v19, s55
v_mfma_f32_16x16x32_bf16 v[232:235], a[248:251], a[120:123], v[232:235]
s_add_u32 m0, s33, 68864
ds_read_b32 a143, v56
v_mfma_f32_16x16x32_bf16 v[236:239], a[248:251], a[124:127], v[236:239]
s_waitcnt lgkmcnt(4)
v_mfma_f32_16x16x32_bf16 v[240:243], a[252:255], a[112:115], v[240:243]
ds_read_b128 a[244:247], v16 offset:2048
buffer_load_dwordx4 v9, s[20:23], 0 offen offset:768 lds
v_mfma_f32_16x16x32_bf16 v[244:247], a[252:255], a[116:119], v[244:247]
v_mfma_f32_16x16x32_bf16 v[248:251], a[252:255], a[120:123], v[248:251]
v_mfma_f32_16x16x32_bf16 v[252:255], a[252:255], a[124:127], v[252:255]
s_waitcnt vmcnt(10) lgkmcnt(1)
v_cmp_ne_u64 s[50:51], s[88:89], v[42:43]
v_cmp_ne_u64 s[44:45], s[88:89], v[46:47]
v_mfma_f32_16x16x32_bf16 v[128:131], a[240:243], a[128:131], v[128:131]
ds_read_b128 a[248:251], v16 offset:4096
v_mfma_f32_16x16x32_bf16 v[132:135], a[240:243], a[132:135], v[132:135]
s_or_b64 s[50:51], s[44:45], s[50:51]
v_mfma_f32_16x16x32_bf16 v[136:139], a[240:243], a[136:139], v[136:139]
s_cbranch_scc1 L_SLOW9
L_BACK9:
v_mfma_f32_16x16x32_bf16 v[140:143], a[240:243], a[140:143], v[140:143]
s_waitcnt lgkmcnt(1)
v_mfma_f32_16x16x32_bf16 v[144:147], a[244:247], a[128:131], v[144:147]
ds_read_b128 a[252:255], v16 offset:6144
v_mfma_f32_16x16x32_bf16 v[148:151], a[244:247], a[132:135], v[148:151]
v_perm_b32 v63, v40, v19, s52
v_mfma_f32_16x16x32_bf16 v[152:155], a[244:247], a[136:139], v[152:155]
s_add_u32 m0, s33, 72960
ds_read_b32 a144, v63
v_perm_b32 v62, v40, v19, s53
v_mfma_f32_16x16x32_bf16 v[156:159], a[244:247], a[140:143], v[156:159]
s_waitcnt lgkmcnt(2)
ds_read_b32 a145, v62
v_perm_b32 v61, v44, v19, s52
v_mfma_f32_16x16x32_bf16 v[160:163], a[248:251], a[128:131], v[160:163]
ds_read_b128 a[240:243], v16 offset:8192
buffer_load_dwordx4 v10, s[20:23], 0 offen offset:768 lds
v_mfma_f32_16x16x32_bf16 v[164:167], a[248:251], a[132:135], v[164:167]
ds_read_b32 a146, v61
v_perm_b32 v60, v44, v19, s53
v_mfma_f32_16x16x32_bf16 v[168:171], a[248:251], a[136:139], v[168:171]
ds_read_b32 a147, v60
v_perm_b32 v59, v40, v19, s54
v_mfma_f32_16x16x32_bf16 v[172:175], a[248:251], a[140:143], v[172:175]
s_waitcnt lgkmcnt(4)
ds_read_b32 a148, v59
buffer_load_dwordx4 v[80:83], v12, s[24:27], 0 offen offset:0 sc1
v_mfma_f32_16x16x32_bf16 v[176:179], a[252:255], a[128:131], v[176:179]
ds_read_b128 a[244:247], v16 offset:10240
v_perm_b32 v58, v40, v19, s55
v_mfma_f32_16x16x32_bf16 v[180:183], a[252:255], a[132:135], v[180:183]
ds_read_b32 a149, v58
v_perm_b32 v57, v44, v19, s54
v_mfma_f32_16x16x32_bf16 v[184:187], a[252:255], a[136:139], v[184:187]
ds_read_b32 a150, v57
v_perm_b32 v56, v44, v19, s55
v_mfma_f32_16x16x32_bf16 v[188:191], a[252:255], a[140:143], v[188:191]
s_waitcnt lgkmcnt(4)
ds_read_b32 a151, v56
buffer_load_dwordx4 v[84:87], v12, s[24:27], 0 offen offset:1024 sc1
v_mfma_f32_16x16x32_bf16 v[192:195], a[240:243], a[128:131], v[192:195]
ds_read_b128 a[248:251], v16 offset:12288
v_perm_b32 v63, v41, v19, s52
v_mfma_f32_16x16x32_bf16 v[196:199], a[240:243], a[132:135], v[196:199]
ds_read_b32 a152, v63
v_perm_b32 v62, v41, v19, s53
v_mfma_f32_16x16x32_bf16 v[200:203], a[240:243], a[136:139], v[200:203]
s_add_u32 m0, s33, 77056
ds_read_b32 a153, v62
v_perm_b32 v61, v45, v19, s52
v_mfma_f32_16x16x32_bf16 v[204:207], a[240:243], a[140:143], v[204:207]
s_waitcnt lgkmcnt(4)
ds_read_b32 a154, v61
v_perm_b32 v60, v45, v19, s53
v_mfma_f32_16x16x32_bf16 v[208:211], a[244:247], a[128:131], v[208:211]
ds_read_b128 a[252:255], v16 offset:14336
buffer_load_dwordx4 v11, s[20:23], 0 offen offset:768 lds
v_mfma_f32_16x16x32_bf16 v[212:215], a[244:247], a[132:135], v[212:215]
ds_read_b32 a155, v60
v_perm_b32 v59, v41, v19, s54
v_mfma_f32_16x16x32_bf16 v[216:219], a[244:247], a[136:139], v[216:219]
ds_read_b32 a156, v59
v_perm_b32 v58, v41, v19, s55
v_mfma_f32_16x16x32_bf16 v[220:223], a[244:247], a[140:143], v[220:223]
s_waitcnt lgkmcnt(4)
ds_read_b32 a157, v58
v_mfma_f32_16x16x32_bf16 v[224:227], a[248:251], a[128:131], v[224:227]
ds_read_b128 a[240:243], v17 offset:0
v_perm_b32 v57, v45, v19, s54
v_mfma_f32_16x16x32_bf16 v[228:231], a[248:251], a[132:135], v[228:231]
ds_read_b32 a158, v57
v_perm_b32 v56, v45, v19, s55
v_mfma_f32_16x16x32_bf16 v[232:235], a[248:251], a[136:139], v[232:235]
ds_read_b32 a159, v56
v_mfma_f32_16x16x32_bf16 v[236:239], a[248:251], a[140:143], v[236:239]
s_waitcnt lgkmcnt(4)
v_mfma_f32_16x16x32_bf16 v[240:243], a[252:255], a[128:131], v[240:243]
ds_read_b128 a[244:247], v17 offset:2048
v_mfma_f32_16x16x32_bf16 v[244:247], a[252:255], a[132:135], v[244:247]
v_mfma_f32_16x16x32_bf16 v[248:251], a[252:255], a[136:139], v[248:251]
s_waitcnt vmcnt(10)
v_cmp_ne_u64 s[50:51], s[88:89], v[50:51]
v_cmp_ne_u64 s[44:45], s[88:89], v[54:55]
v_mfma_f32_16x16x32_bf16 v[252:255], a[252:255], a[140:143], v[252:255]
s_waitcnt lgkmcnt(1)
v_mfma_f32_16x16x32_bf16 v[128:131], a[240:243], a[144:147], v[128:131]
s_or_b64 s[50:51], s[44:45], s[50:51]
ds_read_b128 a[248:251], v17 offset:4096
v_mfma_f32_16x16x32_bf16 v[132:135], a[240:243], a[148:151], v[132:135]
s_cbranch_scc1 L_SLOW10
L_BACK10:
v_mfma_f32_16x16x32_bf16 v[136:139], a[240:243], a[152:155], v[136:139]
s_add_u32 m0, s33, 81024
v_mfma_f32_16x16x32_bf16 v[140:143], a[240:243], a[156:159], v[140:143]
s_waitcnt lgkmcnt(1)
v_mfma_f32_16x16x32_bf16 v[144:147], a[244:247], a[144:147], v[144:147]
ds_read_b128 a[252:255], v17 offset:6144
buffer_load_dwordx4 v8, s[20:23], 0 offen offset:896 lds
v_mfma_f32_16x16x32_bf16 v[148:151], a[244:247], a[148:151], v[148:151]
v_perm_b32 v63, v48, v19, s52
v_mfma_f32_16x16x32_bf16 v[152:155], a[244:247], a[152:155], v[152:155]
ds_read_b32 a160, v63
v_perm_b32 v62, v48, v19, s53
v_mfma_f32_16x16x32_bf16 v[156:159], a[244:247], a[156:159], v[156:159]
s_waitcnt lgkmcnt(2)
ds_read_b32 a161, v62
v_mfma_f32_16x16x32_bf16 v[160:163], a[248:251], a[144:147], v[160:163]
ds_read_b128 a[240:243], v17 offset:8192
v_perm_b32 v61, v52, v19, s52
v_mfma_f32_16x16x32_bf16 v[164:167], a[248:251], a[148:151], v[164:167]
ds_read_b32 a162, v61
v_perm_b32 v60, v52, v19, s53
v_mfma_f32_16x16x32_bf16 v[168:171], a[248:251], a[152:155], v[168:171]
s_add_u32 m0, s33, 85120
ds_read_b32 a163, v60
v_perm_b32 v59, v48, v19, s54
v_mfma_f32_16x16x32_bf16 v[172:175], a[248:251], a[156:159], v[172:175]
s_waitcnt lgkmcnt(4)
ds_read_b32 a164, v59
v_perm_b32 v58, v48, v19, s55
v_mfma_f32_16x16x32_bf16 v[176:179], a[252:255], a[144:147], v[176:179]
ds_read_b128 a[244:247], v17 offset:10240
buffer_load_dwordx4 v9, s[20:23], 0 offen offset:896 lds
v_mfma_f32_16x16x32_bf16 v[180:183], a[252:255], a[148:151], v[180:183]
ds_read_b32 a165, v58
v_perm_b32 v57, v52, v19, s54
v_mfma_f32_16x16x32_bf16 v[184:187], a[252:255], a[152:155], v[184:187]
ds_read_b32 a166, v57
v_perm_b32 v56, v52, v19, s55
v_mfma_f32_16x16x32_bf16 v[188:191], a[252:255], a[156:159], v[188:191]
s_waitcnt lgkmcnt(4)
ds_read_b32 a167, v56
buffer_load_dwordx4 v[88:91], v12, s[24:27], 0 offen offset:2048 sc1
v_mfma_f32_16x16x32_bf16 v[192:195], a[240:243], a[144:147], v[192:195]
s_waitcnt vmcnt(12)
s_barrier
ds_read_b128 a[248:251], v17 offset:12288
v_perm_b32 v63, v49, v19, s52
v_mfma_f32_16x16x32_bf16 v[196:199], a[240:243], a[148:151], v[196:199]
ds_read_b32 a168, v63
v_perm_b32 v62, v49, v19, s53
v_mfma_f32_16x16x32_bf16 v[200:203], a[240:243], a[152:155], v[200:203]
ds_read_b32 a169, v62
v_perm_b32 v61, v53, v19, s52
v_mfma_f32_16x16x32_bf16 v[204:207], a[240:243], a[156:159], v[204:207]
s_waitcnt lgkmcnt(4)
ds_read_b32 a170, v61
buffer_load_dwordx4 v[92:95], v12, s[24:27], 0 offen offset:3072 sc1
v_mfma_f32_16x16x32_bf16 v[208:211], a[244:247], a[144:147], v[208:211]
ds_read_b128 a[252:255], v17 offset:14336
v_perm_b32 v60, v53, v19, s53
v_mfma_f32_16x16x32_bf16 v[212:215], a[244:247], a[148:151], v[212:215]
ds_read_b32 a171, v60
v_perm_b32 v59, v49, v19, s54
v_mfma_f32_16x16x32_bf16 v[216:219], a[244:247], a[152:155], v[216:219]
ds_read_b32 a172, v59
v_perm_b32 v58, v49, v19, s55
v_mfma_f32_16x16x32_bf16 v[220:223], a[244:247], a[156:159], v[220:223]
s_waitcnt lgkmcnt(4)
ds_read_b32 a173, v58
v_add_u32 v12, 28672, v13
v_mfma_f32_16x16x32_bf16 v[224:227], a[248:251], a[144:147], v[224:227]
ds_read_b128 a[240:243], v16 offset:16384
v_perm_b32 v57, v53, v19, s54
v_mfma_f32_16x16x32_bf16 v[228:231], a[248:251], a[148:151], v[228:231]
ds_read_b32 a174, v57
v_perm_b32 v56, v53, v19, s55
v_mfma_f32_16x16x32_bf16 v[232:235], a[248:251], a[152:155], v[232:235]
s_add_u32 m0, s33, 89216
ds_read_b32 a175, v56
v_mfma_f32_16x16x32_bf16 v[236:239], a[248:251], a[156:159], v[236:239]
s_waitcnt lgkmcnt(4)
v_mfma_f32_16x16x32_bf16 v[240:243], a[252:255], a[144:147], v[240:243]
ds_read_b128 a[244:247], v16 offset:18432
buffer_load_dwordx4 v10, s[20:23], 0 offen offset:896 lds
v_mfma_f32_16x16x32_bf16 v[244:247], a[252:255], a[148:151], v[244:247]
v_mfma_f32_16x16x32_bf16 v[248:251], a[252:255], a[152:155], v[248:251]
v_mfma_f32_16x16x32_bf16 v[252:255], a[252:255], a[156:159], v[252:255]
s_waitcnt vmcnt(10) lgkmcnt(1)
v_cmp_ne_u64 s[50:51], s[88:89], v[98:99]
v_cmp_ne_u64 s[44:45], s[88:89], v[102:103]
v_mfma_f32_16x16x32_bf16 v[128:131], a[240:243], a[160:163], v[128:131]
ds_read_b128 a[248:251], v16 offset:20480
v_mfma_f32_16x16x32_bf16 v[132:135], a[240:243], a[164:167], v[132:135]
s_or_b64 s[50:51], s[44:45], s[50:51]
v_mfma_f32_16x16x32_bf16 v[136:139], a[240:243], a[168:171], v[136:139]
s_cbranch_scc1 L_SLOW11
L_BACK11:
v_mfma_f32_16x16x32_bf16 v[140:143], a[240:243], a[172:175], v[140:143]
s_waitcnt lgkmcnt(1)
v_mfma_f32_16x16x32_bf16 v[144:147], a[244:247], a[160:163], v[144:147]
ds_read_b128 a[252:255], v16 offset:22528
v_mfma_f32_16x16x32_bf16 v[148:151], a[244:247], a[164:167], v[148:151]
v_perm_b32 v63, v96, v19, s52
v_mfma_f32_16x16x32_bf16 v[152:155], a[244:247], a[168:171], v[152:155]
s_add_u32 m0, s33, 93312
ds_read_b32 a176, v63
v_perm_b32 v62, v96, v19, s53
v_mfma_f32_16x16x32_bf16 v[156:159], a[244:247], a[172:175], v[156:159]
s_waitcnt lgkmcnt(2)
ds_read_b32 a177, v62
v_perm_b32 v61, v100, v19, s52
v_mfma_f32_16x16x32_bf16 v[160:163], a[248:251], a[160:163], v[160:163]
ds_read_b128 a[240:243], v16 offset:24576
buffer_load_dwordx4 v11, s[20:23], 0 offen offset:896 lds
v_mfma_f32_16x16x32_bf16 v[164:167], a[248:251], a[164:167], v[164:167]
ds_read_b32 a178, v61
v_perm_b32 v60, v100, v19, s53
v_mfma_f32_16x16x32_bf16 v[168:171], a[248:251], a[168:171], v[168:171]
ds_read_b32 a179, v60
v_perm_b32 v59, v96, v19, s54
v_mfma_f32_16x16x32_bf16 v[172:175], a[248:251], a[172:175], v[172:175]
s_waitcnt lgkmcnt(4)
ds_read_b32 a180, v59
buffer_load_dwordx4 v[32:35], v12, s[24:27], 0 offen offset:0 sc1
v_mfma_f32_16x16x32_bf16 v[176:179], a[252:255], a[160:163], v[176:179]
ds_read_b128 a[244:247], v16 offset:26624
v_perm_b32 v58, v96, v19, s55
v_mfma_f32_16x16x32_bf16 v[180:183], a[252:255], a[164:167], v[180:183]
ds_read_b32 a181, v58
v_perm_b32 v57, v100, v19, s54
v_mfma_f32_16x16x32_bf16 v[184:187], a[252:255], a[168:171], v[184:187]
ds_read_b32 a182, v57
v_perm_b32 v56, v100, v19, s55
v_mfma_f32_16x16x32_bf16 v[188:191], a[252:255], a[172:175], v[188:191]
s_waitcnt lgkmcnt(4)
ds_read_b32 a183, v56
buffer_load_dwordx4 v[36:39], v12, s[24:27], 0 offen offset:1024 sc1
v_mfma_f32_16x16x32_bf16 v[192:195], a[240:243], a[160:163], v[192:195]
ds_read_b128 a[248:251], v16 offset:28672
v_perm_b32 v63, v97, v19, s52
v_mfma_f32_16x16x32_bf16 v[196:199], a[240:243], a[164:167], v[196:199]
ds_read_b32 a184, v63
v_perm_b32 v62, v97, v19, s53
v_mfma_f32_16x16x32_bf16 v[200:203], a[240:243], a[168:171], v[200:203]
s_add_u32 m0, s33, 97280
ds_read_b32 a185, v62
v_perm_b32 v61, v101, v19, s52
v_mfma_f32_16x16x32_bf16 v[204:207], a[240:243], a[172:175], v[204:207]
s_waitcnt lgkmcnt(4)
ds_read_b32 a186, v61
v_perm_b32 v60, v101, v19, s53
v_mfma_f32_16x16x32_bf16 v[208:211], a[244:247], a[160:163], v[208:211]
L_PAD2:
s_cbranch_vccnz L_PADRET
ds_read_b128 a[252:255], v16 offset:30720
buffer_load_dwordx4 v8, s[20:23], 0 offen offset:1024 lds
v_mfma_f32_16x16x32_bf16 v[212:215], a[244:247], a[164:167], v[212:215]
ds_read_b32 a187, v60
v_perm_b32 v59, v97, v19, s54
v_mfma_f32_16x16x32_bf16 v[216:219], a[244:247], a[168:171], v[216:219]
ds_read_b32 a188, v59
v_perm_b32 v58, v97, v19, s55
v_mfma_f32_16x16x32_bf16 v[220:223], a[244:247], a[172:175], v[220:223]
s_waitcnt lgkmcnt(4)
ds_read_b32 a189, v58
v_mfma_f32_16x16x32_bf16 v[224:227], a[248:251], a[160:163], v[224:227]
ds_read_b128 a[240:243], v17 offset:16384
v_perm_b32 v57, v101, v19, s54
v_mfma_f32_16x16x32_bf16 v[228:231], a[248:251], a[164:167], v[228:231]
ds_read_b32 a190, v57
v_perm_b32 v56, v101, v19, s55
v_mfma_f32_16x16x32_bf16 v[232:235], a[248:251], a[168:171], v[232:235]
ds_read_b32 a191, v56
v_mfma_f32_16x16x32_bf16 v[236:239], a[248:251], a[172:175], v[236:239]
s_waitcnt lgkmcnt(4)
v_mfma_f32_16x16x32_bf16 v[240:243], a[252:255], a[160:163], v[240:243]
ds_read_b128 a[244:247], v17 offset:18432
v_mfma_f32_16x16x32_bf16 v[244:247], a[252:255], a[164:167], v[244:247]
v_mfma_f32_16x16x32_bf16 v[248:251], a[252:255], a[168:171], v[248:251]
s_waitcnt vmcnt(10)
v_cmp_ne_u64 s[50:51], s[88:89], v[82:83]
v_cmp_ne_u64 s[44:45], s[88:89], v[86:87]
v_mfma_f32_16x16x32_bf16 v[252:255], a[252:255], a[172:175], v[252:255]
s_waitcnt lgkmcnt(1)
v_mfma_f32_16x16x32_bf16 v[128:131], a[240:243], a[176:179], v[128:131]
s_or_b64 s[50:51], s[44:45], s[50:51]
ds_read_b128 a[248:251], v17 offset:20480
v_mfma_f32_16x16x32_bf16 v[132:135], a[240:243], a[180:183], v[132:135]
s_cbranch_scc1 L_SLOW12
L_BACK12:
v_mfma_f32_16x16x32_bf16 v[136:139], a[240:243], a[184:187], v[136:139]
s_add_u32 m0, s33, 101376
buffer_load_dwordx4 v[40:43], v12, s[24:27], 0 offen offset:2048 sc1
v_mfma_f32_16x16x32_bf16 v[140:143], a[240:243], a[188:191], v[140:143]
s_waitcnt lgkmcnt(1)
buffer_load_dwordx4 v[44:47], v12, s[24:27], 0 offen offset:3072 sc1
v_mfma_f32_16x16x32_bf16 v[144:147], a[244:247], a[176:179], v[144:147]
ds_read_b128 a[252:255], v17 offset:22528
buffer_load_dwordx4 v9, s[20:23], 0 offen offset:1024 lds
v_mfma_f32_16x16x32_bf16 v[148:151], a[244:247], a[180:183], v[148:151]
v_perm_b32 v63, v80, v19, s52
v_add_u32 v12, 32768, v13
v_mfma_f32_16x16x32_bf16 v[152:155], a[244:247], a[184:187], v[152:155]
ds_read_b32 a192, v63
v_perm_b32 v62, v80, v19, s53
v_mfma_f32_16x16x32_bf16 v[156:159], a[244:247], a[188:191], v[156:159]
s_waitcnt lgkmcnt(2)
ds_read_b32 a193, v62
v_mfma_f32_16x16x32_bf16 v[160:163], a[248:251], a[176:179], v[160:163]
ds_read_b128 a[240:243], v17 offset:24576
v_perm_b32 v61, v84, v19, s52
v_mfma_f32_16x16x32_bf16 v[164:167], a[248:251], a[180:183], v[164:167]
ds_read_b32 a194, v61
v_perm_b32 v60, v84, v19, s53
v_mfma_f32_16x16x32_bf16 v[168:171], a[248:251], a[184:187], v[168:171]
s_add_u32 m0, s33, 105472
ds_read_b32 a195, v60
v_perm_b32 v59, v80, v19, s54
v_mfma_f32_16x16x32_bf16 v[172:175], a[248:251], a[188:191], v[172:175]
s_waitcnt lgkmcnt(4)
ds_read_b32 a196, v59
v_perm_b32 v58, v80, v19, s55
v_mfma_f32_16x16x32_bf16 v[176:179], a[252:255], a[176:179], v[176:179]
ds_read_b128 a[244:247], v17 offset:26624
buffer_load_dwordx4 v10, s[20:23], 0 offen offset:1024 lds
v_mfma_f32_16x16x32_bf16 v[180:183], a[252:255], a[180:183], v[180:183]
ds_read_b32 a197, v58
v_perm_b32 v57, v84, v19, s54
v_mfma_f32_16x16x32_bf16 v[184:187], a[252:255], a[184:187], v[184:187]
ds_read_b32 a198, v57
v_perm_b32 v56, v84, v19, s55
v_mfma_f32_16x16x32_bf16 v[188:191], a[252:255], a[188:191], v[188:191]
s_waitcnt lgkmcnt(4)
ds_read_b32 a199, v56
v_mfma_f32_16x16x32_bf16 v[192:195], a[240:243], a[176:179], v[192:195]
s_waitcnt vmcnt(13)
s_barrier
ds_read_b128 a[248:251], v17 offset:28672
v_perm_b32 v63, v81, v19, s52
v_mfma_f32_16x16x32_bf16 v[196:199], a[240:243], a[180:183], v[196:199]
ds_read_b32 a200, v63
v_perm_b32 v62, v81, v19, s53
v_mfma_f32_16x16x32_bf16 v[200:203], a[240:243], a[184:187], v[200:203]
ds_read_b32 a201, v62
v_perm_b32 v61, v85, v19, s52
v_mfma_f32_16x16x32_bf16 v[204:207], a[240:243], a[188:191], v[204:207]
s_waitcnt lgkmcnt(4)
ds_read_b32 a202, v61
v_mfma_f32_16x16x32_bf16 v[208:211], a[244:247], a[176:179], v[208:211]
ds_read_b128 a[252:255], v17 offset:30720
v_perm_b32 v60, v85, v19, s53
v_mfma_f32_16x16x32_bf16 v[212:215], a[244:247], a[180:183], v[212:215]
ds_read_b32 a203, v60
v_perm_b32 v59, v81, v19, s54
v_mfma_f32_16x16x32_bf16 v[216:219], a[244:247], a[184:187], v[216:219]
ds_read_b32 a204, v59
v_perm_b32 v58, v81, v19, s55
v_mfma_f32_16x16x32_bf16 v[220:223], a[244:247], a[188:191], v[220:223]
s_waitcnt lgkmcnt(4)
ds_read_b32 a205, v58
v_mfma_f32_16x16x32_bf16 v[224:227], a[248:251], a[176:179], v[224:227]
ds_read_b128 a[240:243], v14 offset:0
v_perm_b32 v57, v85, v19, s54
v_mfma_f32_16x16x32_bf16 v[228:231], a[248:251], a[180:183], v[228:231]
ds_read_b32 a206, v57
v_perm_b32 v56, v85, v19, s55
v_mfma_f32_16x16x32_bf16 v[232:235], a[248:251], a[184:187], v[232:235]
s_add_u32 m0, s33, 109440
ds_read_b32 a207, v56
buffer_load_dwordx4 v[48:51], v12, s[24:27], 0 offen offset:0 sc1
v_mfma_f32_16x16x32_bf16 v[236:239], a[248:251], a[188:191], v[236:239]
s_waitcnt lgkmcnt(4)
buffer_load_dwordx4 v[52:55], v12, s[24:27], 0 offen offset:1024 sc1
v_mfma_f32_16x16x32_bf16 v[240:243], a[252:255], a[176:179], v[240:243]
ds_read_b128 a[244:247], v14 offset:2048
buffer_load_dwordx4 v8, s[20:23], 0 offen offset:1152 lds
v_mfma_f32_16x16x32_bf16 v[244:247], a[252:255], a[180:183], v[244:247]
v_mfma_f32_16x16x32_bf16 v[248:251], a[252:255], a[184:187], v[248:251]
v_mfma_f32_16x16x32_bf16 v[252:255], a[252:255], a[188:191], v[252:255]
s_waitcnt vmcnt(12) lgkmcnt(1)
v_cmp_ne_u64 s[50:51], s[88:89], v[90:91]
v_cmp_ne_u64 s[44:45], s[88:89], v[94:95]
v_mfma_f32_16x16x32_bf16 v[128:131], a[240:243], a[192:195], v[128:131]
ds_read_b128 a[248:251], v14 offset:4096
v_mfma_f32_16x16x32_bf16 v[132:135], a[240:243], a[196:199], v[132:135]
s_or_b64 s[50:51], s[44:45], s[50:51]
v_mfma_f32_16x16x32_bf16 v[136:139], a[240:243], a[200:203], v[136:139]
s_cbranch_scc1 L_SLOW13
L_BACK13:
v_mfma_f32_16x16x32_bf16 v[140:143], a[240:243], a[204:207], v[140:143]
s_waitcnt lgkmcnt(1)
v_mfma_f32_16x16x32_bf16 v[144:147], a[244:247], a[192:195], v[144:147]
ds_read_b128 a[252:255], v14 offset:6144
v_mfma_f32_16x16x32_bf16 v[148:151], a[244:247], a[196:199], v[148:151]
v_perm_b32 v63, v88, v19, s52
v_mfma_f32_16x16x32_bf16 v[152:155], a[244:247], a[200:203], v[152:155]
s_add_u32 m0, s33, 113664
ds_read_b32 a208, v63
v_perm_b32 v62, v88, v19, s53
v_mfma_f32_16x16x32_bf16 v[156:159], a[244:247], a[204:207], v[156:159]
s_waitcnt lgkmcnt(2)
ds_read_b32 a209, v62
v_perm_b32 v61, v92, v19, s52
v_mfma_f32_16x16x32_bf16 v[160:163], a[248:251], a[192:195], v[160:163]
ds_read_b128 a[240:243], v14 offset:8192
buffer_load_dwordx4 v11, s[20:23], 0 offen offset:1024 lds
v_mfma_f32_16x16x32_bf16 v[164:167], a[248:251], a[196:199], v[164:167]
ds_read_b32 a210, v61
v_perm_b32 v60, v92, v19, s53
v_mfma_f32_16x16x32_bf16 v[168:171], a[248:251], a[200:203], v[168:171]
ds_read_b32 a211, v60
v_perm_b32 v59, v88, v19, s54
v_mfma_f32_16x16x32_bf16 v[172:175], a[248:251], a[204:207], v[172:175]
s_waitcnt lgkmcnt(4)
ds_read_b32 a212, v59
v_mfma_f32_16x16x32_bf16 v[176:179], a[252:255], a[192:195], v[176:179]
ds_read_b128 a[244:247], v14 offset:10240
v_perm_b32 v58, v88, v19, s55
v_mfma_f32_16x16x32_bf16 v[180:183], a[252:255], a[196:199], v[180:183]
ds_read_b32 a213, v58
v_perm_b32 v57, v92, v19, s54
v_mfma_f32_16x16x32_bf16 v[184:187], a[252:255], a[200:203], v[184:187]
ds_read_b32 a214, v57
v_perm_b32 v56, v92, v19, s55
v_mfma_f32_16x16x32_bf16 v[188:191], a[252:255], a[204:207], v[188:191]
s_waitcnt lgkmcnt(4)
ds_read_b32 a215, v56
v_mfma_f32_16x16x32_bf16 v[192:195], a[240:243], a[192:195], v[192:195]
ds_read_b128 a[248:251], v14 offset:12288
v_perm_b32 v63, v89, v19, s52
v_mfma_f32_16x16x32_bf16 v[196:199], a[240:243], a[196:199], v[196:199]
ds_read_b32 a216, v63
v_perm_b32 v62, v89, v19, s53
v_mfma_f32_16x16x32_bf16 v[200:203], a[240:243], a[200:203], v[200:203]
s_add_u32 m0, s33, 117632
ds_read_b32 a217, v62
v_perm_b32 v61, v93, v19, s52
v_mfma_f32_16x16x32_bf16 v[204:207], a[240:243], a[204:207], v[204:207]
s_waitcnt lgkmcnt(4)
ds_read_b32 a218, v61
v_perm_b32 v60, v93, v19, s53
v_mfma_f32_16x16x32_bf16 v[208:211], a[244:247], a[192:195], v[208:211]
ds_read_b128 a[252:255], v14 offset:14336
buffer_load_dwordx4 v9, s[20:23], 0 offen offset:1152 lds
v_mfma_f32_16x16x32_bf16 v[212:215], a[244:247], a[196:199], v[212:215]
ds_read_b32 a219, v60
v_perm_b32 v59, v89, v19, s54
v_mfma_f32_16x16x32_bf16 v[216:219], a[244:247], a[200:203], v[216:219]
ds_read_b32 a220, v59
v_perm_b32 v58, v89, v19, s55
v_mfma_f32_16x16x32_bf16 v[220:223], a[244:247], a[204:207], v[220:223]
s_waitcnt lgkmcnt(4)
ds_read_b32 a221, v58
buffer_load_dwordx4 v[96:99], v12, s[24:27], 0 offen offset:2048 sc1
v_mfma_f32_16x16x32_bf16 v[224:227], a[248:251], a[192:195], v[224:227]
ds_read_b128 a[240:243], v15 offset:0
v_perm_b32 v57, v93, v19, s54
v_mfma_f32_16x16x32_bf16 v[228:231], a[248:251], a[196:199], v[228:231]
ds_read_b32 a222, v57
v_perm_b32 v56, v93, v19, s55
v_mfma_f32_16x16x32_bf16 v[232:235], a[248:251], a[200:203], v[232:235]
ds_read_b32 a223, v56
buffer_load_dwordx4 v[100:103], v12, s[24:27], 0 offen offset:3072 sc1
v_mfma_f32_16x16x32_bf16 v[236:239], a[248:251], a[204:207], v[236:239]
s_waitcnt vmcnt(12) lgkmcnt(4)
v_cmp_ne_u64 s[50:51], s[88:89], v[34:35]
v_cmp_ne_u64 s[44:45], s[88:89], v[38:39]
v_mfma_f32_16x16x32_bf16 v[240:243], a[252:255], a[192:195], v[240:243]
ds_read_b128 a[244:247], v15 offset:2048
v_add_u32 v12, 36864, v13
v_mfma_f32_16x16x32_bf16 v[244:247], a[252:255], a[196:199], v[244:247]
s_or_b64 s[50:51], s[44:45], s[50:51]
v_mfma_f32_16x16x32_bf16 v[248:251], a[252:255], a[200:203], v[248:251]
s_cbranch_scc1 L_SLOW14
L_BACK14:
v_mfma_f32_16x16x32_bf16 v[252:255], a[252:255], a[204:207], v[252:255]
s_waitcnt lgkmcnt(1)
v_mfma_f32_16x16x32_bf16 v[128:131], a[240:243], a[208:211], v[128:131]
ds_read_b128 a[248:251], v15 offset:4096
v_perm_b32 v63, v32, v19, s52
v_mfma_f32_16x16x32_bf16 v[132:135], a[240:243], a[212:215], v[132:135]
ds_read_b32 a224, v63
v_perm_b32 v62, v32, v19, s53
v_mfma_f32_16x16x32_bf16 v[136:139], a[240:243], a[216:219], v[136:139]
ds_read_b32 a225, v62
v_perm_b32 v61, v36, v19, s52
v_mfma_f32_16x16x32_bf16 v[140:143], a[240:243], a[220:223], v[140:143]
s_waitcnt lgkmcnt(3)
ds_read_b32 a226, v61
v_mfma_f32_16x16x32_bf16 v[144:147], a[244:247], a[208:211], v[144:147]
ds_read_b128 a[252:255], v15 offset:6144
v_perm_b32 v60, v36, v19, s53
v_mfma_f32_16x16x32_bf16 v[148:151], a[244:247], a[212:215], v[148:151]
ds_read_b32 a227, v60
v_perm_b32 v59, v32, v19, s54
v_mfma_f32_16x16x32_bf16 v[152:155], a[244:247], a[216:219], v[152:155]
ds_read_b32 a228, v59
v_perm_b32 v58, v32, v19, s55
v_mfma_f32_16x16x32_bf16 v[156:159], a[244:247], a[220:223], v[156:159]
s_waitcnt lgkmcnt(4)
ds_read_b32 a229, v58
v_mfma_f32_16x16x32_bf16 v[160:163], a[248:251], a[208:211], v[160:163]
ds_read_b128 a[240:243], v15 offset:8192
v_perm_b32 v57, v36, v19, s54
v_mfma_f32_16x16x32_bf16 v[164:167], a[248:251], a[212:215], v[164:167]
ds_read_b32 a230, v57
v_perm_b32 v56, v36, v19, s55
v_mfma_f32_16x16x32_bf16 v[168:171], a[248:251], a[216:219], v[168:171]
ds_read_b32 a231, v56
v_perm_b32 v63, v33, v19, s52
v_mfma_f32_16x16x32_bf16 v[172:175], a[248:251], a[220:223], v[172:175]
s_waitcnt lgkmcnt(4)
ds_read_b32 a232, v63
v_mfma_f32_16x16x32_bf16 v[176:179], a[252:255], a[208:211], v[176:179]
ds_read_b128 a[244:247], v15 offset:10240
v_perm_b32 v62, v33, v19, s53
v_mfma_f32_16x16x32_bf16 v[180:183], a[252:255], a[212:215], v[180:183]
ds_read_b32 a233, v62
v_perm_b32 v61, v37, v19, s52
v_mfma_f32_16x16x32_bf16 v[184:187], a[252:255], a[216:219], v[184:187]
ds_read_b32 a234, v61
v_perm_b32 v60, v37, v19, s53
v_mfma_f32_16x16x32_bf16 v[188:191], a[252:255], a[220:223], v[188:191]
s_waitcnt lgkmcnt(4)
ds_read_b32 a235, v60
buffer_load_dwordx4 v[80:83], v12, s[24:27], 0 offen offset:0 sc1
v_mfma_f32_16x16x32_bf16 v[192:195], a[240:243], a[208:211], v[192:195]
s_waitcnt vmcnt(12)
s_barrier
ds_read_b128 a[248:251], v15 offset:12288
v_perm_b32 v59, v33, v19, s54
v_mfma_f32_16x16x32_bf16 v[196:199], a[240:243], a[212:215], v[196:199]
ds_read_b32 a236, v59
v_perm_b32 v58, v33, v19, s55
v_mfma_f32_16x16x32_bf16 v[200:203], a[240:243], a[216:219], v[200:203]
ds_read_b32 a237, v58
v_perm_b32 v57, v37, v19, s54
v_mfma_f32_16x16x32_bf16 v[204:207], a[240:243], a[220:223], v[204:207]
s_waitcnt lgkmcnt(4)
ds_read_b32 a238, v57
buffer_load_dwordx4 v[84:87], v12, s[24:27], 0 offen offset:1024 sc1
v_mfma_f32_16x16x32_bf16 v[208:211], a[244:247], a[208:211], v[208:211]
ds_read_b128 a[252:255], v14 offset:16384
v_perm_b32 v56, v37, v19, s55
v_mfma_f32_16x16x32_bf16 v[212:215], a[244:247], a[212:215], v[212:215]
ds_read_b32 a239, v56
v_mfma_f32_16x16x32_bf16 v[216:219], a[244:247], a[216:219], v[216:219]
s_waitcnt vmcnt(11)
v_cmp_ne_u64 s[50:51], s[88:89], v[42:43]
v_cmp_ne_u64 s[44:45], s[88:89], v[46:47]
v_mfma_f32_16x16x32_bf16 v[220:223], a[244:247], a[220:223], v[220:223]
s_waitcnt lgkmcnt(3)
v_mfma_f32_16x16x32_bf16 v[224:227], a[248:251], a[208:211], v[224:227]
s_or_b64 s[50:51], s[44:45], s[50:51]
ds_read_b128 a[240:243], v14 offset:18432
v_mfma_f32_16x16x32_bf16 v[228:231], a[248:251], a[212:215], v[228:231]
s_cbranch_scc1 L_SLOW15
L_BACK15:
v_mfma_f32_16x16x32_bf16 v[232:235], a[248:251], a[216:219], v[232:235]
s_add_u32 m0, s33, 121728
v_perm_b32 v63, v40, v19, s52
v_mfma_f32_16x16x32_bf16 v[236:239], a[248:251], a[220:223], v[236:239]
s_waitcnt lgkmcnt(1)
ds_read_b32 a0, v63
v_perm_b32 v62, v40, v19, s53
v_mfma_f32_16x16x32_bf16 v[128:131], a[252:255], a[224:227], v[128:131]
ds_read_b128 a[244:247], v14 offset:20480
buffer_load_dwordx4 v10, s[20:23], 0 offen offset:1152 lds
v_mfma_f32_16x16x32_bf16 v[132:135], a[252:255], a[228:231], v[132:135]
ds_read_b32 a1, v62
v_perm_b32 v61, v44, v19, s52
v_mfma_f32_16x16x32_bf16 v[136:139], a[252:255], a[232:235], v[136:139]
ds_read_b32 a2, v61
v_perm_b32 v60, v44, v19, s53
v_mfma_f32_16x16x32_bf16 v[140:143], a[252:255], a[236:239], v[140:143]
s_waitcnt lgkmcnt(4)
ds_read_b32 a3, v60
v_mfma_f32_16x16x32_bf16 v[144:147], a[240:243], a[224:227], v[144:147]
ds_read_b128 a[248:251], v14 offset:22528
v_perm_b32 v59, v40, v19, s54
v_mfma_f32_16x16x32_bf16 v[148:151], a[240:243], a[228:231], v[148:151]
ds_read_b32 a4, v59
v_perm_b32 v58, v40, v19, s55
v_mfma_f32_16x16x32_bf16 v[152:155], a[240:243], a[232:235], v[152:155]
ds_read_b32 a5, v58
v_perm_b32 v57, v44, v19, s54
v_mfma_f32_16x16x32_bf16 v[156:159], a[240:243], a[236:239], v[156:159]
s_waitcnt lgkmcnt(4)
ds_read_b32 a6, v57
v_mfma_f32_16x16x32_bf16 v[160:163], a[244:247], a[224:227], v[160:163]
ds_read_b128 a[252:255], v14 offset:24576
v_perm_b32 v56, v44, v19, s55
v_mfma_f32_16x16x32_bf16 v[164:167], a[244:247], a[228:231], v[164:167]
ds_read_b32 a7, v56
v_perm_b32 v63, v41, v19, s52
v_mfma_f32_16x16x32_bf16 v[168:171], a[244:247], a[232:235], v[168:171]
s_add_u32 m0, s33, 125696
ds_read_b32 a8, v63
v_perm_b32 v62, v41, v19, s53
v_mfma_f32_16x16x32_bf16 v[172:175], a[244:247], a[236:239], v[172:175]
s_waitcnt lgkmcnt(4)
ds_read_b32 a9, v62
v_perm_b32 v61, v45, v19, s52
v_mfma_f32_16x16x32_bf16 v[176:179], a[248:251], a[224:227], v[176:179]
ds_read_b128 a[240:243], v15 offset:14336
buffer_load_dwordx4 v8, s[20:23], 0 offen offset:1280 lds
v_mfma_f32_16x16x32_bf16 v[180:183], a[248:251], a[228:231], v[180:183]
ds_read_b32 a10, v61
v_perm_b32 v60, v45, v19, s53
v_mfma_f32_16x16x32_bf16 v[184:187], a[248:251], a[232:235], v[184:187]
ds_read_b32 a11, v60
v_perm_b32 v59, v41, v19, s54
v_mfma_f32_16x16x32_bf16 v[188:191], a[248:251], a[236:239], v[188:191]
s_waitcnt lgkmcnt(4)
ds_read_b32 a12, v59
buffer_load_dwordx4 v[88:91], v12, s[24:27], 0 offen offset:2048 sc1
v_mfma_f32_16x16x32_bf16 v[192:195], a[252:255], a[224:227], v[192:195]
ds_read_b128 a[244:247], v14 offset:26624
v_perm_b32 v58, v41, v19, s55
v_mfma_f32_16x16x32_bf16 v[196:199], a[252:255], a[228:231], v[196:199]
ds_read_b32 a13, v58
v_perm_b32 v57, v45, v19, s54
v_mfma_f32_16x16x32_bf16 v[200:203], a[252:255], a[232:235], v[200:203]
s_waitcnt vmcnt(10)
v_cmp_ne_u64 s[50:51], s[88:89], v[50:51]
v_cmp_ne_u64 s[44:45], s[88:89], v[54:55]
v_mfma_f32_16x16x32_bf16 v[204:207], a[252:255], a[236:239], v[204:207]
s_waitcnt lgkmcnt(3)
ds_read_b32 a14, v57
buffer_load_dwordx4 v[92:95], v12, s[24:27], 0 offen offset:3072 sc1
v_mfma_f32_16x16x32_bf16 v[240:243], a[240:243], a[208:211], v[240:243]
s_or_b64 s[50:51], s[44:45], s[50:51]
ds_read_b128 a[248:251], v15 offset:16384
v_perm_b32 v56, v45, v19, s55
v_mfma_f32_16x16x32_bf16 v[244:247], a[240:243], a[212:215], v[244:247]
s_cbranch_scc1 L_SLOW16
L_BACK16:
v_mfma_f32_16x16x32_bf16 v[248:251], a[240:243], a[216:219], v[248:251]
s_add_u32 m0, s33, 129792
ds_read_b32 a15, v56
v_add_u32 v12, 40960, v13
v_mfma_f32_16x16x32_bf16 v[252:255], a[240:243], a[220:223], v[252:255]
s_waitcnt lgkmcnt(3)
v_perm_b32 v63, v48, v19, s52
v_mfma_f32_16x16x32_bf16 v[208:211], a[244:247], a[224:227], v[208:211]
ds_read_b128 a[252:255], v14 offset:28672
buffer_load_dwordx4 v9, s[20:23], 0 offen offset:1280 lds
v_mfma_f32_16x16x32_bf16 v[212:215], a[244:247], a[228:231], v[212:215]
ds_read_b32 a16, v63
v_perm_b32 v62, v48, v19, s53
v_mfma_f32_16x16x32_bf16 v[216:219], a[244:247], a[232:235], v[216:219]
ds_read_b32 a17, v62
v_perm_b32 v61, v52, v19, s52
v_mfma_f32_16x16x32_bf16 v[220:223], a[244:247], a[236:239], v[220:223]
s_waitcnt lgkmcnt(3)
ds_read_b32 a18, v61
v_mfma_f32_16x16x32_bf16 v[128:131], a[248:251], a[0:3], v[128:131]
ds_read_b128 a[240:243], v15 offset:18432
v_perm_b32 v60, v52, v19, s53
v_mfma_f32_16x16x32_bf16 v[132:135], a[248:251], a[4:7], v[132:135]
ds_read_b32 a19, v60
v_perm_b32 v59, v48, v19, s54
v_mfma_f32_16x16x32_bf16 v[136:139], a[248:251], a[8:11], v[136:139]
ds_read_b32 a20, v59
v_perm_b32 v58, v48, v19, s55
v_mfma_f32_16x16x32_bf16 v[140:143], a[248:251], a[12:15], v[140:143]
s_waitcnt lgkmcnt(4)
ds_read_b32 a21, v58
v_mfma_f32_16x16x32_bf16 v[224:227], a[252:255], a[224:227], v[224:227]
ds_read_b128 a[244:247], v15 offset:20480
v_perm_b32 v57, v52, v19, s54
v_mfma_f32_16x16x32_bf16 v[228:231], a[252:255], a[228:231], v[228:231]
ds_read_b32 a22, v57
v_perm_b32 v56, v52, v19, s55
v_mfma_f32_16x16x32_bf16 v[232:235], a[252:255], a[232:235], v[232:235]
ds_read_b32 a23, v56
v_perm_b32 v63, v49, v19, s52
v_mfma_f32_16x16x32_bf16 v[236:239], a[252:255], a[236:239], v[236:239]
s_waitcnt lgkmcnt(4)
ds_read_b32 a24, v63
v_mfma_f32_16x16x32_bf16 v[144:147], a[240:243], a[0:3], v[144:147]
ds_read_b128 a[248:251], v15 offset:22528
v_perm_b32 v62, v49, v19, s53
v_mfma_f32_16x16x32_bf16 v[148:151], a[240:243], a[4:7], v[148:151]
ds_read_b32 a25, v62
v_perm_b32 v61, v53, v19, s52
v_mfma_f32_16x16x32_bf16 v[152:155], a[240:243], a[8:11], v[152:155]
ds_read_b32 a26, v61
v_perm_b32 v60, v53, v19, s53
v_mfma_f32_16x16x32_bf16 v[156:159], a[240:243], a[12:15], v[156:159]
s_waitcnt lgkmcnt(4)
ds_read_b32 a27, v60
buffer_load_dwordx4 v[32:35], v12, s[24:27], 0 offen offset:0 sc1
v_mfma_f32_16x16x32_bf16 v[160:163], a[244:247], a[0:3], v[160:163]
ds_read_b128 a[252:255], v15 offset:24576
v_perm_b32 v59, v49, v19, s54
v_mfma_f32_16x16x32_bf16 v[164:167], a[244:247], a[4:7], v[164:167]
ds_read_b32 a28, v59
v_perm_b32 v58, v49, v19, s55
v_mfma_f32_16x16x32_bf16 v[168:171], a[244:247], a[8:11], v[168:171]
ds_read_b32 a29, v58
v_perm_b32 v57, v53, v19, s54
v_mfma_f32_16x16x32_bf16 v[172:175], a[244:247], a[12:15], v[172:175]
s_waitcnt lgkmcnt(4)
ds_read_b32 a30, v57
buffer_load_dwordx4 v[36:39], v12, s[24:27], 0 offen offset:1024 sc1
v_mfma_f32_16x16x32_bf16 v[176:179], a[248:251], a[0:3], v[176:179]
ds_read_b128 a[240:243], v14 offset:32768
v_perm_b32 v56, v53, v19, s55
v_mfma_f32_16x16x32_bf16 v[180:183], a[248:251], a[4:7], v[180:183]
ds_read_b32 a31, v56
v_mfma_f32_16x16x32_bf16 v[184:187], a[248:251], a[8:11], v[184:187]
s_waitcnt vmcnt(9)
s_add_u32 m0, s33, 134016
v_cmp_ne_u64 s[50:51], s[88:89], v[98:99]
v_cmp_ne_u64 s[44:45], s[88:89], v[102:103]
v_mfma_f32_16x16x32_bf16 v[188:191], a[248:251], a[12:15], v[188:191]
s_waitcnt lgkmcnt(3)
v_mfma_f32_16x16x32_bf16 v[192:195], a[252:255], a[0:3], v[192:195]
s_or_b64 s[50:51], s[44:45], s[50:51]
ds_read_b128 a[244:247], v15 offset:26624
buffer_load_dwordx4 v11, s[20:23], 0 offen offset:1152 lds
v_mfma_f32_16x16x32_bf16 v[196:199], a[252:255], a[4:7], v[196:199]
s_cbranch_scc1 L_SLOW17
L_BACK17:
v_mfma_f32_16x16x32_bf16 v[200:203], a[252:255], a[8:11], v[200:203]
v_perm_b32 v63, v96, v19, s52
v_mfma_f32_16x16x32_bf16 v[204:207], a[252:255], a[12:15], v[204:207]
s_waitcnt lgkmcnt(1)
ds_read_b32 a32, v63
v_mfma_f32_16x16x32_bf16 v[128:131], a[240:243], a[16:19], v[128:131]
s_barrier
ds_read_b128 a[248:251], v14 offset:34816
v_perm_b32 v62, v96, v19, s53
v_mfma_f32_16x16x32_bf16 v[132:135], a[240:243], a[20:23], v[132:135]
ds_read_b32 a33, v62
v_perm_b32 v61, v100, v19, s52
v_mfma_f32_16x16x32_bf16 v[136:139], a[240:243], a[24:27], v[136:139]
ds_read_b32 a34, v61
v_perm_b32 v60, v100, v19, s53
v_mfma_f32_16x16x32_bf16 v[140:143], a[240:243], a[28:31], v[140:143]
s_waitcnt lgkmcnt(4)
ds_read_b32 a35, v60
v_mfma_f32_16x16x32_bf16 v[208:211], a[244:247], a[0:3], v[208:211]
ds_read_b128 a[252:255], v14 offset:36864
v_perm_b32 v59, v96, v19, s54
v_mfma_f32_16x16x32_bf16 v[212:215], a[244:247], a[4:7], v[212:215]
ds_read_b32 a36, v59
v_perm_b32 v58, v96, v19, s55
v_mfma_f32_16x16x32_bf16 v[216:219], a[244:247], a[8:11], v[216:219]
ds_read_b32 a37, v58
v_perm_b32 v57, v100, v19, s54
v_mfma_f32_16x16x32_bf16 v[220:223], a[244:247], a[12:15], v[220:223]
s_waitcnt lgkmcnt(4)
ds_read_b32 a38, v57
v_mfma_f32_16x16x32_bf16 v[144:147], a[248:251], a[16:19], v[144:147]
ds_read_b128 a[240:243], v14 offset:38912
v_perm_b32 v56, v100, v19, s55
v_mfma_f32_16x16x32_bf16 v[148:151], a[248:251], a[20:23], v[148:151]
ds_read_b32 a39, v56
v_perm_b32 v63, v97, v19, s52
v_mfma_f32_16x16x32_bf16 v[152:155], a[248:251], a[24:27], v[152:155]
s_add_u32 m0, s33, 137984
ds_read_b32 a40, v63
v_perm_b32 v62, v97, v19, s53
v_mfma_f32_16x16x32_bf16 v[156:159], a[248:251], a[28:31], v[156:159]
s_waitcnt lgkmcnt(4)
ds_read_b32 a41, v62
v_perm_b32 v61, v101, v19, s52
v_mfma_f32_16x16x32_bf16 v[160:163], a[252:255], a[16:19], v[160:163]
ds_read_b128 a[244:247], v15 offset:28672
buffer_load_dwordx4 v10, s[20:23], 0 offen offset:1280 lds
v_mfma_f32_16x16x32_bf16 v[164:167], a[252:255], a[20:23], v[164:167]
ds_read_b32 a42, v61
v_perm_b32 v60, v101, v19, s53
v_mfma_f32_16x16x32_bf16 v[168:171], a[252:255], a[24:27], v[168:171]
ds_read_b32 a43, v60
v_perm_b32 v59, v97, v19, s54
v_mfma_f32_16x16x32_bf16 v[172:175], a[252:255], a[28:31], v[172:175]
s_waitcnt lgkmcnt(4)
ds_read_b32 a44, v59
buffer_load_dwordx4 v[40:43], v12, s[24:27], 0 offen offset:2048 sc1
v_mfma_f32_16x16x32_bf16 v[176:179], a[240:243], a[16:19], v[176:179]
ds_read_b128 a[248:251], v14 offset:40960
v_perm_b32 v58, v97, v19, s55
v_mfma_f32_16x16x32_bf16 v[180:183], a[240:243], a[20:23], v[180:183]
ds_read_b32 a45, v58
v_perm_b32 v57, v101, v19, s54
v_mfma_f32_16x16x32_bf16 v[184:187], a[240:243], a[24:27], v[184:187]
s_waitcnt vmcnt(10)
v_cmp_ne_u64 s[50:51], s[88:89], v[82:83]
v_cmp_ne_u64 s[44:45], s[88:89], v[86:87]
v_mfma_f32_16x16x32_bf16 v[188:191], a[240:243], a[28:31], v[188:191]
s_waitcnt lgkmcnt(3)
ds_read_b32 a46, v57
buffer_load_dwordx4 v[44:47], v12, s[24:27], 0 offen offset:3072 sc1
v_mfma_f32_16x16x32_bf16 v[224:227], a[244:247], a[0:3], v[224:227]
s_or_b64 s[50:51], s[44:45], s[50:51]
ds_read_b128 a[252:255], v15 offset:32768
v_perm_b32 v56, v101, v19, s55
v_mfma_f32_16x16x32_bf16 v[228:231], a[244:247], a[4:7], v[228:231]
s_cbranch_scc1 L_SLOW18
L_BACK18:
v_mfma_f32_16x16x32_bf16 v[232:235], a[244:247], a[8:11], v[232:235]
L_PAD3:
s_cbranch_vccnz L_PAD4
s_add_u32 m0, s33, 141952
ds_read_b32 a47, v56
v_add_u32 v12, 45056, v13
v_mfma_f32_16x16x32_bf16 v[236:239], a[244:247], a[12:15], v[236:239]
s_waitcnt lgkmcnt(3)
v_perm_b32 v63, v80, v19, s52
v_mfma_f32_16x16x32_bf16 v[192:195], a[248:251], a[16:19], v[192:195]
ds_read_b128 a[240:243], v14 offset:30720
buffer_load_dwordx4 v8, s[20:23], 0 offen offset:1408 lds
v_mfma_f32_16x16x32_bf16 v[196:199], a[248:251], a[20:23], v[196:199]
ds_read_b32 a48, v63
v_perm_b32 v62, v80, v19, s53
v_mfma_f32_16x16x32_bf16 v[200:203], a[248:251], a[24:27], v[200:203]
ds_read_b32 a49, v62
v_perm_b32 v61, v84, v19, s52
v_mfma_f32_16x16x32_bf16 v[204:207], a[248:251], a[28:31], v[204:207]
s_waitcnt lgkmcnt(3)
ds_read_b32 a50, v61
v_mfma_f32_16x16x32_bf16 v[128:131], a[252:255], a[32:35], v[128:131]
ds_read_b128 a[244:247], v15 offset:34816
v_perm_b32 v60, v84, v19, s53
v_mfma_f32_16x16x32_bf16 v[132:135], a[252:255], a[36:39], v[132:135]
ds_read_b32 a51, v60
v_perm_b32 v59, v80, v19, s54
v_mfma_f32_16x16x32_bf16 v[136:139], a[252:255], a[40:43], v[136:139]
ds_read_b32 a52, v59
v_perm_b32 v58, v80, v19, s55
v_mfma_f32_16x16x32_bf16 v[140:143], a[252:255], a[44:47], v[140:143]
s_waitcnt lgkmcnt(4)
ds_read_b32 a53, v58
v_mfma_f32_16x16x32_bf16 v[240:243], a[240:243], a[224:227], v[240:243]
ds_read_b128 a[248:251], v15 offset:36864
v_perm_b32 v57, v84, v19, s54
v_mfma_f32_16x16x32_bf16 v[244:247], a[240:243], a[228:231], v[244:247]
ds_read_b32 a54, v57
v_perm_b32 v56, v84, v19, s55
v_mfma_f32_16x16x32_bf16 v[248:251], a[240:243], a[232:235], v[248:251]
s_add_u32 m0, s33, 146048
ds_read_b32 a55, v56
v_perm_b32 v63, v81, v19, s52
v_mfma_f32_16x16x32_bf16 v[252:255], a[240:243], a[236:239], v[252:255]
s_waitcnt lgkmcnt(4)
ds_read_b32 a56, v63
v_perm_b32 v62, v81, v19, s53
v_mfma_f32_16x16x32_bf16 v[144:147], a[244:247], a[32:35], v[144:147]
ds_read_b128 a[252:255], v14 offset:43008
buffer_load_dwordx4 v9, s[20:23], 0 offen offset:1408 lds
v_mfma_f32_16x16x32_bf16 v[148:151], a[244:247], a[36:39], v[148:151]
ds_read_b32 a57, v62
v_perm_b32 v61, v85, v19, s52
v_mfma_f32_16x16x32_bf16 v[152:155], a[244:247], a[40:43], v[152:155]
ds_read_b32 a58, v61
v_perm_b32 v60, v85, v19, s53
v_mfma_f32_16x16x32_bf16 v[156:159], a[244:247], a[44:47], v[156:159]
s_waitcnt lgkmcnt(4)
ds_read_b32 a59, v60
buffer_load_dwordx4 v[48:51], v12, s[24:27], 0 offen offset:0 sc1
v_mfma_f32_16x16x32_bf16 v[160:163], a[248:251], a[32:35], v[160:163]
ds_read_b128 a[240:243], v15 offset:38912
v_perm_b32 v59, v81, v19, s54
v_mfma_f32_16x16x32_bf16 v[164:167], a[248:251], a[36:39], v[164:167]
ds_read_b32 a60, v59
v_perm_b32 v58, v81, v19, s55
v_mfma_f32_16x16x32_bf16 v[168:171], a[248:251], a[40:43], v[168:171]
ds_read_b32 a61, v58
v_perm_b32 v57, v85, v19, s54
v_mfma_f32_16x16x32_bf16 v[172:175], a[248:251], a[44:47], v[172:175]
s_waitcnt lgkmcnt(4)
ds_read_b32 a62, v57
buffer_load_dwordx4 v[52:55], v12, s[24:27], 0 offen offset:1024 sc1
v_mfma_f32_16x16x32_bf16 v[208:211], a[252:255], a[16:19], v[208:211]
ds_read_b128 a[244:247], v14 offset:45056
v_perm_b32 v56, v85, v19, s55
v_mfma_f32_16x16x32_bf16 v[212:215], a[252:255], a[20:23], v[212:215]
ds_read_b32 a63, v56
v_mfma_f32_16x16x32_bf16 v[216:219], a[252:255], a[24:27], v[216:219]
s_waitcnt vmcnt(11)
v_cmp_ne_u64 s[50:51], s[88:89], v[90:91]
v_cmp_ne_u64 s[44:45], s[88:89], v[94:95]
v_mfma_f32_16x16x32_bf16 v[220:223], a[252:255], a[28:31], v[220:223]
s_waitcnt lgkmcnt(3)
v_mfma_f32_16x16x32_bf16 v[176:179], a[240:243], a[32:35], v[176:179]
s_or_b64 s[50:51], s[44:45], s[50:51]
ds_read_b128 a[248:251], v15 offset:40960
v_mfma_f32_16x16x32_bf16 v[180:183], a[240:243], a[36:39], v[180:183]
s_cbranch_scc1 L_SLOW19
L_BACK19:
v_mfma_f32_16x16x32_bf16 v[184:187], a[240:243], a[40:43], v[184:187]
s_add_u32 m0, s33, 150016
v_perm_b32 v63, v88, v19, s52
v_mfma_f32_16x16x32_bf16 v[188:191], a[240:243], a[44:47], v[188:191]
s_waitcnt lgkmcnt(1)
ds_read_b32 a64, v63
v_perm_b32 v62, v88, v19, s53
v_mfma_f32_16x16x32_bf16 v[128:131], a[244:247], a[48:51], v[128:131]
ds_read_b128 a[252:255], v14 offset:49152
buffer_load_dwordx4 v8, s[20:23], 0 offen offset:1536 lds
v_mfma_f32_16x16x32_bf16 v[132:135], a[244:247], a[52:55], v[132:135]
ds_read_b32 a65, v62
v_perm_b32 v61, v92, v19, s52
v_mfma_f32_16x16x32_bf16 v[136:139], a[244:247], a[56:59], v[136:139]
ds_read_b32 a66, v61
v_perm_b32 v60, v92, v19, s53
v_mfma_f32_16x16x32_bf16 v[140:143], a[244:247], a[60:63], v[140:143]
s_waitcnt lgkmcnt(4)
ds_read_b32 a67, v60
v_mfma_f32_16x16x32_bf16 v[192:195], a[248:251], a[32:35], v[192:195]
ds_read_b128 a[240:243], v14 offset:47104
v_perm_b32 v59, v88, v19, s54
v_mfma_f32_16x16x32_bf16 v[196:199], a[248:251], a[36:39], v[196:199]
ds_read_b32 a68, v59
v_perm_b32 v58, v88, v19, s55
v_mfma_f32_16x16x32_bf16 v[200:203], a[248:251], a[40:43], v[200:203]
s_add_u32 m0, s33, 154240
ds_read_b32 a69, v58
v_perm_b32 v57, v92, v19, s54
v_mfma_f32_16x16x32_bf16 v[204:207], a[248:251], a[44:47], v[204:207]
s_waitcnt lgkmcnt(4)
ds_read_b32 a70, v57
v_perm_b32 v56, v92, v19, s55
v_mfma_f32_16x16x32_bf16 v[224:227], a[252:255], a[16:19], v[224:227]
ds_read_b128 a[244:247], v14 offset:53248
buffer_load_dwordx4 v10, s[20:23], 0 offen offset:1408 lds
v_mfma_f32_16x16x32_bf16 v[228:231], a[252:255], a[20:23], v[228:231]
ds_read_b32 a71, v56
v_perm_b32 v63, v89, v19, s52
v_mfma_f32_16x16x32_bf16 v[232:235], a[252:255], a[24:27], v[232:235]
ds_read_b32 a72, v63
v_perm_b32 v62, v89, v19, s53
v_mfma_f32_16x16x32_bf16 v[236:239], a[252:255], a[28:31], v[236:239]
s_waitcnt lgkmcnt(4)
ds_read_b32 a73, v62
buffer_load_dwordx4 v[96:99], v12, s[24:27], 0 offen offset:2048 sc1
v_mfma_f32_16x16x32_bf16 v[144:147], a[240:243], a[48:51], v[144:147]
s_waitcnt vmcnt(13)
s_barrier
ds_read_b128 a[248:251], v15 offset:43008
v_perm_b32 v61, v93, v19, s52
v_mfma_f32_16x16x32_bf16 v[148:151], a[240:243], a[52:55], v[148:151]
ds_read_b32 a74, v61
v_perm_b32 v60, v93, v19, s53
v_mfma_f32_16x16x32_bf16 v[152:155], a[240:243], a[56:59], v[152:155]
ds_read_b32 a75, v60
v_perm_b32 v59, v89, v19, s54
v_mfma_f32_16x16x32_bf16 v[156:159], a[240:243], a[60:63], v[156:159]
s_waitcnt lgkmcnt(4)
ds_read_b32 a76, v59
buffer_load_dwordx4 v[100:103], v12, s[24:27], 0 offen offset:3072 sc1
v_mfma_f32_16x16x32_bf16 v[160:163], a[244:247], a[48:51], v[160:163]
ds_read_b128 a[252:255], v14 offset:55296
v_perm_b32 v58, v89, v19, s55
v_mfma_f32_16x16x32_bf16 v[164:167], a[244:247], a[52:55], v[164:167]
ds_read_b32 a77, v58
v_perm_b32 v57, v93, v19, s54
v_mfma_f32_16x16x32_bf16 v[168:171], a[244:247], a[56:59], v[168:171]
s_waitcnt vmcnt(12)
v_cmp_ne_u64 s[50:51], s[88:89], v[34:35]
v_cmp_ne_u64 s[44:45], s[88:89], v[38:39]
v_mfma_f32_16x16x32_bf16 v[172:175], a[244:247], a[60:63], v[172:175]
s_waitcnt lgkmcnt(3)
ds_read_b32 a78, v57
v_add_u32 v12, 49152, v13
v_mfma_f32_16x16x32_bf16 v[208:211], a[248:251], a[32:35], v[208:211]
s_or_b64 s[50:51], s[44:45], s[50:51]
ds_read_b128 a[240:243], v15 offset:45056
v_perm_b32 v56, v93, v19, s55
v_mfma_f32_16x16x32_bf16 v[212:215], a[248:251], a[36:39], v[212:215]
s_cbranch_scc1 L_SLOW20
L_BACK20:
v_mfma_f32_16x16x32_bf16 v[216:219], a[248:251], a[40:43], v[216:219]
s_add_u32 m0, s33, 158464
ds_read_b32 a79, v56
v_perm_b32 v63, v32, v19, s52
v_mfma_f32_16x16x32_bf16 v[220:223], a[248:251], a[44:47], v[220:223]
s_waitcnt lgkmcnt(3)
ds_read_b32 a80, v63
v_perm_b32 v62, v32, v19, s53
v_mfma_f32_16x16x32_bf16 v[176:179], a[252:255], a[48:51], v[176:179]
ds_read_b128 a[244:247], v15 offset:47104
buffer_load_dwordx4 v11, s[20:23], 0 offen offset:1280 lds
v_mfma_f32_16x16x32_bf16 v[180:183], a[252:255], a[52:55], v[180:183]
ds_read_b32 a81, v62
v_perm_b32 v61, v36, v19, s52
v_mfma_f32_16x16x32_bf16 v[184:187], a[252:255], a[56:59], v[184:187]
ds_read_b32 a82, v61
v_perm_b32 v60, v36, v19, s53
v_mfma_f32_16x16x32_bf16 v[188:191], a[252:255], a[60:63], v[188:191]
s_waitcnt lgkmcnt(4)
ds_read_b32 a83, v60
v_mfma_f32_16x16x32_bf16 v[128:131], a[240:243], a[64:67], v[128:131]
ds_read_b128 a[248:251], v14 offset:57344
v_perm_b32 v59, v32, v19, s54
v_mfma_f32_16x16x32_bf16 v[132:135], a[240:243], a[68:71], v[132:135]
ds_read_b32 a84, v59
v_perm_b32 v58, v32, v19, s55
v_mfma_f32_16x16x32_bf16 v[136:139], a[240:243], a[72:75], v[136:139]
ds_read_b32 a85, v58
v_perm_b32 v57, v36, v19, s54
v_mfma_f32_16x16x32_bf16 v[140:143], a[240:243], a[76:79], v[140:143]
s_waitcnt lgkmcnt(4)
ds_read_b32 a86, v57
buffer_load_dwordx4 v[80:83], v12, s[24:27], 0 offen offset:0 sc1
v_mfma_f32_16x16x32_bf16 v[144:147], a[244:247], a[64:67], v[144:147]
ds_read_b128 a[252:255], v15 offset:53248
v_perm_b32 v56, v36, v19, s55
v_mfma_f32_16x16x32_bf16 v[148:151], a[244:247], a[68:71], v[148:151]
ds_read_b32 a87, v56
v_perm_b32 v63, v33, v19, s52
v_mfma_f32_16x16x32_bf16 v[152:155], a[244:247], a[72:75], v[152:155]
s_add_u32 m0, s33, 64000
ds_read_b32 a88, v63
v_perm_b32 v62, v33, v19, s53
v_mfma_f32_16x16x32_bf16 v[156:159], a[244:247], a[76:79], v[156:159]
s_waitcnt lgkmcnt(4)
ds_read_b32 a89, v62
v_perm_b32 v61, v37, v19, s52
v_mfma_f32_16x16x32_bf16 v[192:195], a[248:251], a[48:51], v[192:195]
ds_read_b128 a[240:243], v15 offset:30720
buffer_load_dwordx4 v9, s[20:23], 0 offen offset:1536 lds
v_mfma_f32_16x16x32_bf16 v[196:199], a[248:251], a[52:55], v[196:199]
ds_read_b32 a90, v61
v_perm_b32 v60, v37, v19, s53
v_mfma_f32_16x16x32_bf16 v[200:203], a[248:251], a[56:59], v[200:203]
ds_read_b32 a91, v60
v_perm_b32 v59, v33, v19, s54
v_mfma_f32_16x16x32_bf16 v[204:207], a[248:251], a[60:63], v[204:207]
s_waitcnt lgkmcnt(4)
ds_read_b32 a92, v59
buffer_load_dwordx4 v[84:87], v12, s[24:27], 0 offen offset:1024 sc1
v_mfma_f32_16x16x32_bf16 v[160:163], a[252:255], a[64:67], v[160:163]
ds_read_b128 a[244:247], v15 offset:49152
v_perm_b32 v58, v33, v19, s55
v_mfma_f32_16x16x32_bf16 v[164:167], a[252:255], a[68:71], v[164:167]
ds_read_b32 a93, v58
v_perm_b32 v57, v37, v19, s54
v_mfma_f32_16x16x32_bf16 v[168:171], a[252:255], a[72:75], v[168:171]
s_waitcnt vmcnt(12)
v_cmp_ne_u64 s[50:51], s[88:89], v[42:43]
v_cmp_ne_u64 s[44:45], s[88:89], v[46:47]
v_mfma_f32_16x16x32_bf16 v[172:175], a[252:255], a[76:79], v[172:175]
s_waitcnt lgkmcnt(3)
ds_read_b32 a94, v57
v_mfma_f32_16x16x32_bf16 v[240:243], a[240:243], a[0:3], v[240:243]
s_or_b64 s[50:51], s[44:45], s[50:51]
ds_read_b128 a[248:251], v14 offset:61440
v_perm_b32 v56, v37, v19, s55
v_mfma_f32_16x16x32_bf16 v[244:247], a[240:243], a[4:7], v[244:247]
s_cbranch_scc1 L_SLOW21
L_BACK21:
v_mfma_f32_16x16x32_bf16 v[248:251], a[240:243], a[8:11], v[248:251]
s_add_u32 m0, s33, 67968
ds_read_b32 a95, v56
v_perm_b32 v63, v40, v19, s52
v_mfma_f32_16x16x32_bf16 v[252:255], a[240:243], a[12:15], v[252:255]
s_waitcnt lgkmcnt(3)
ds_read_b32 a96, v63
v_perm_b32 v62, v40, v19, s53
v_mfma_f32_16x16x32_bf16 v[224:227], a[244:247], a[32:35], v[224:227]
ds_read_b128 a[252:255], v15 offset:55296
buffer_load_dwordx4 v8, s[20:23], 0 offen offset:1664 lds
v_mfma_f32_16x16x32_bf16 v[228:231], a[244:247], a[36:39], v[228:231]
ds_read_b32 a97, v62
v_perm_b32 v61, v44, v19, s52
v_mfma_f32_16x16x32_bf16 v[232:235], a[244:247], a[40:43], v[232:235]
ds_read_b32 a98, v61
v_perm_b32 v60, v44, v19, s53
v_mfma_f32_16x16x32_bf16 v[236:239], a[244:247], a[44:47], v[236:239]
s_waitcnt lgkmcnt(4)
ds_read_b32 a99, v60
v_mfma_f32_16x16x32_bf16 v[128:131], a[248:251], a[80:83], v[128:131]
ds_read_b128 a[240:243], v14 offset:59392
v_perm_b32 v59, v40, v19, s54
v_mfma_f32_16x16x32_bf16 v[132:135], a[248:251], a[84:87], v[132:135]
ds_read_b32 a100, v59
v_perm_b32 v58, v40, v19, s55
v_mfma_f32_16x16x32_bf16 v[136:139], a[248:251], a[88:91], v[136:139]
ds_read_b32 a101, v58
v_perm_b32 v57, v44, v19, s54
v_mfma_f32_16x16x32_bf16 v[140:143], a[248:251], a[92:95], v[140:143]
s_waitcnt lgkmcnt(4)
ds_read_b32 a102, v57
v_mfma_f32_16x16x32_bf16 v[176:179], a[252:255], a[64:67], v[176:179]
ds_read_b128 a[244:247], v14 offset:63488
v_perm_b32 v56, v44, v19, s55
v_mfma_f32_16x16x32_bf16 v[180:183], a[252:255], a[68:71], v[180:183]
ds_read_b32 a103, v56
v_perm_b32 v63, v41, v19, s52
v_mfma_f32_16x16x32_bf16 v[184:187], a[252:255], a[72:75], v[184:187]
ds_read_b32 a104, v63
v_perm_b32 v62, v41, v19, s53
v_mfma_f32_16x16x32_bf16 v[188:191], a[252:255], a[76:79], v[188:191]
s_waitcnt lgkmcnt(4)
ds_read_b32 a105, v62
buffer_load_dwordx4 v[88:91], v12, s[24:27], 0 offen offset:2048 sc1
v_mfma_f32_16x16x32_bf16 v[208:211], a[240:243], a[48:51], v[208:211]
ds_read_b128 a[248:251], v15 offset:57344
v_perm_b32 v61, v45, v19, s52
v_mfma_f32_16x16x32_bf16 v[212:215], a[240:243], a[52:55], v[212:215]
ds_read_b32 a106, v61
v_perm_b32 v60, v45, v19, s53
v_mfma_f32_16x16x32_bf16 v[216:219], a[240:243], a[56:59], v[216:219]
ds_read_b32 a107, v60
v_perm_b32 v59, v41, v19, s54
v_mfma_f32_16x16x32_bf16 v[220:223], a[240:243], a[60:63], v[220:223]
s_waitcnt lgkmcnt(4)
ds_read_b32 a108, v59
buffer_load_dwordx4 v[92:95], v12, s[24:27], 0 offen offset:3072 sc1
v_mfma_f32_16x16x32_bf16 v[144:147], a[244:247], a[80:83], v[144:147]
ds_read_b128 a[252:255], v16 offset:0
v_perm_b32 v58, v41, v19, s55
v_mfma_f32_16x16x32_bf16 v[148:151], a[244:247], a[84:87], v[148:151]
ds_read_b32 a109, v58
v_perm_b32 v57, v45, v19, s54
v_mfma_f32_16x16x32_bf16 v[152:155], a[244:247], a[88:91], v[152:155]
s_waitcnt vmcnt(11)
v_cmp_ne_u64 s[50:51], s[88:89], v[50:51]
v_cmp_ne_u64 s[44:45], s[88:89], v[54:55]
v_mfma_f32_16x16x32_bf16 v[156:159], a[244:247], a[92:95], v[156:159]
s_waitcnt lgkmcnt(3)
ds_read_b32 a110, v57
v_add_u32 v12, 53248, v13
v_mfma_f32_16x16x32_bf16 v[192:195], a[248:251], a[64:67], v[192:195]
s_or_b64 s[50:51], s[44:45], s[50:51]
ds_read_b128 a[240:243], v15 offset:61440
v_perm_b32 v56, v45, v19, s55
v_mfma_f32_16x16x32_bf16 v[196:199], a[248:251], a[68:71], v[196:199]
s_cbranch_scc1 L_SLOW22
L_BACK22:
v_mfma_f32_16x16x32_bf16 v[200:203], a[248:251], a[72:75], v[200:203]
s_add_u32 m0, s33, 72192
ds_read_b32 a111, v56
v_mfma_f32_16x16x32_bf16 v[204:207], a[248:251], a[76:79], v[204:207]
s_waitcnt lgkmcnt(3)
v_mfma_f32_16x16x32_bf16 v[160:163], a[252:255], a[80:83], v[160:163]
ds_read_b128 a[244:247], v16 offset:2048
buffer_load_dwordx4 v10, s[20:23], 0 offen offset:1536 lds
v_mfma_f32_16x16x32_bf16 v[164:167], a[252:255], a[84:87], v[164:167]
v_perm_b32 v63, v48, v19, s52
v_mfma_f32_16x16x32_bf16 v[168:171], a[252:255], a[88:91], v[168:171]
ds_read_b32 a112, v63
v_perm_b32 v62, v48, v19, s53
v_mfma_f32_16x16x32_bf16 v[172:175], a[252:255], a[92:95], v[172:175]
s_waitcnt lgkmcnt(2)
ds_read_b32 a113, v62
v_mfma_f32_16x16x32_bf16 v[128:131], a[240:243], a[96:99], v[128:131]
s_barrier
ds_read_b128 a[248:251], v16 offset:4096
v_perm_b32 v61, v52, v19, s52
v_mfma_f32_16x16x32_bf16 v[132:135], a[240:243], a[100:103], v[132:135]
ds_read_b32 a114, v61
v_perm_b32 v60, v52, v19, s53
v_mfma_f32_16x16x32_bf16 v[136:139], a[240:243], a[104:107], v[136:139]
ds_read_b32 a115, v60
v_perm_b32 v59, v48, v19, s54
v_mfma_f32_16x16x32_bf16 v[140:143], a[240:243], a[108:111], v[140:143]
s_waitcnt lgkmcnt(4)
ds_read_b32 a116, v59
v_mfma_f32_16x16x32_bf16 v[176:179], a[244:247], a[80:83], v[176:179]
ds_read_b128 a[252:255], v15 offset:63488
v_perm_b32 v58, v48, v19, s55
v_mfma_f32_16x16x32_bf16 v[180:183], a[244:247], a[84:87], v[180:183]
ds_read_b32 a117, v58
v_perm_b32 v57, v52, v19, s54
v_mfma_f32_16x16x32_bf16 v[184:187], a[244:247], a[88:91], v[184:187]
ds_read_b32 a118, v57
v_perm_b32 v56, v52, v19, s55
v_mfma_f32_16x16x32_bf16 v[188:191], a[244:247], a[92:95], v[188:191]
s_waitcnt lgkmcnt(4)
ds_read_b32 a119, v56
buffer_load_dwordx4 v[32:35], v12, s[24:27], 0 offen offset:0 sc1
v_mfma_f32_16x16x32_bf16 v[224:227], a[248:251], a[48:51], v[224:227]
ds_read_b128 a[240:243], v15 offset:59392
v_perm_b32 v63, v49, v19, s52
v_mfma_f32_16x16x32_bf16 v[228:231], a[248:251], a[52:55], v[228:231]
ds_read_b32 a120, v63
v_perm_b32 v62, v49, v19, s53
v_mfma_f32_16x16x32_bf16 v[232:235], a[248:251], a[56:59], v[232:235]
s_add_u32 m0, s33, 76160
ds_read_b32 a121, v62
v_perm_b32 v61, v53, v19, s52
v_mfma_f32_16x16x32_bf16 v[236:239], a[248:251], a[60:63], v[236:239]
s_waitcnt lgkmcnt(4)
ds_read_b32 a122, v61
v_perm_b32 v60, v53, v19, s53
v_mfma_f32_16x16x32_bf16 v[144:147], a[252:255], a[96:99], v[144:147]
ds_read_b128 a[244:247], v17 offset:0
buffer_load_dwordx4 v9, s[20:23], 0 offen offset:1664 lds
v_mfma_f32_16x16x32_bf16 v[148:151], a[252:255], a[100:103], v[148:151]
ds_read_b32 a123, v60
v_perm_b32 v59, v49, v19, s54
v_mfma_f32_16x16x32_bf16 v[152:155], a[252:255], a[104:107], v[152:155]
ds_read_b32 a124, v59
buffer_load_dwordx4 v[36:39], v12, s[24:27], 0 offen offset:1024 sc1
v_mfma_f32_16x16x32_bf16 v[156:159], a[252:255], a[108:111], v[156:159]
s_waitcnt vmcnt(11) lgkmcnt(4)
v_cmp_ne_u64 s[50:51], s[88:89], v[98:99]
v_cmp_ne_u64 s[44:45], s[88:89], v[102:103]
v_mfma_f32_16x16x32_bf16 v[208:211], a[240:243], a[64:67], v[208:211]
ds_read_b128 a[248:251], v16 offset:8192
v_perm_b32 v58, v49, v19, s55
v_mfma_f32_16x16x32_bf16 v[212:215], a[240:243], a[68:71], v[212:215]
s_or_b64 s[50:51], s[44:45], s[50:51]
ds_read_b32 a125, v58
v_perm_b32 v57, v53, v19, s54
v_mfma_f32_16x16x32_bf16 v[216:219], a[240:243], a[72:75], v[216:219]
s_cbranch_scc1 L_SLOW23
L_BACK23:
v_mfma_f32_16x16x32_bf16 v[220:223], a[240:243], a[76:79], v[220:223]
s_waitcnt lgkmcnt(2)
ds_read_b32 a126, v57
v_mfma_f32_16x16x32_bf16 v[160:163], a[244:247], a[96:99], v[160:163]
ds_read_b128 a[252:255], v16 offset:12288
v_perm_b32 v56, v53, v19, s55
v_mfma_f32_16x16x32_bf16 v[164:167], a[244:247], a[100:103], v[164:167]
ds_read_b32 a127, v56
v_perm_b32 v63, v96, v19, s52
v_mfma_f32_16x16x32_bf16 v[168:171], a[244:247], a[104:107], v[168:171]
s_add_u32 m0, s33, 80512
ds_read_b32 a128, v63
v_perm_b32 v62, v96, v19, s53
v_mfma_f32_16x16x32_bf16 v[172:175], a[244:247], a[108:111], v[172:175]
s_waitcnt lgkmcnt(4)
ds_read_b32 a129, v62
v_perm_b32 v61, v100, v19, s52
v_mfma_f32_16x16x32_bf16 v[192:195], a[248:251], a[80:83], v[192:195]
ds_read_b128 a[240:243], v14 offset:51200
buffer_load_dwordx4 v11, s[20:23], 0 offen offset:1408 lds
v_mfma_f32_16x16x32_bf16 v[196:199], a[248:251], a[84:87], v[196:199]
ds_read_b32 a130, v61
v_perm_b32 v60, v100, v19, s53
v_mfma_f32_16x16x32_bf16 v[200:203], a[248:251], a[88:91], v[200:203]
ds_read_b32 a131, v60
v_perm_b32 v59, v96, v19, s54
v_mfma_f32_16x16x32_bf16 v[204:207], a[248:251], a[92:95], v[204:207]
s_waitcnt lgkmcnt(4)
ds_read_b32 a132, v59
v_mfma_f32_16x16x32_bf16 v[128:131], a[252:255], a[112:115], v[128:131]
ds_read_b128 a[244:247], v16 offset:14336
v_perm_b32 v58, v96, v19, s55
v_mfma_f32_16x16x32_bf16 v[132:135], a[252:255], a[116:119], v[132:135]
ds_read_b32 a133, v58
v_perm_b32 v57, v100, v19, s54
v_mfma_f32_16x16x32_bf16 v[136:139], a[252:255], a[120:123], v[136:139]
ds_read_b32 a134, v57
v_perm_b32 v56, v100, v19, s55
v_mfma_f32_16x16x32_bf16 v[140:143], a[252:255], a[124:127], v[140:143]
s_waitcnt lgkmcnt(4)
ds_read_b32 a135, v56
buffer_load_dwordx4 v[40:43], v12, s[24:27], 0 offen offset:2048 sc1
v_mfma_f32_16x16x32_bf16 v[240:243], a[240:243], a[16:19], v[240:243]
ds_read_b128 a[248:251], v17 offset:2048
v_perm_b32 v63, v97, v19, s52
v_mfma_f32_16x16x32_bf16 v[244:247], a[240:243], a[20:23], v[244:247]
ds_read_b32 a136, v63
v_perm_b32 v62, v97, v19, s53
v_mfma_f32_16x16x32_bf16 v[248:251], a[240:243], a[24:27], v[248:251]
s_add_u32 m0, s33, 84224
ds_read_b32 a137, v62
v_perm_b32 v61, v101, v19, s52
v_mfma_f32_16x16x32_bf16 v[252:255], a[240:243], a[28:31], v[252:255]
s_waitcnt lgkmcnt(4)
ds_read_b32 a138, v61
v_perm_b32 v60, v101, v19, s53
v_mfma_f32_16x16x32_bf16 v[144:147], a[244:247], a[112:115], v[144:147]
ds_read_b128 a[252:255], v17 offset:4096
buffer_load_dwordx4 v8, s[20:23], 0 offen offset:1792 lds
v_mfma_f32_16x16x32_bf16 v[148:151], a[244:247], a[116:119], v[148:151]
ds_read_b32 a139, v60
v_perm_b32 v59, v97, v19, s54
v_mfma_f32_16x16x32_bf16 v[152:155], a[244:247], a[120:123], v[152:155]
ds_read_b32 a140, v59
buffer_load_dwordx4 v[44:47], v12, s[24:27], 0 offen offset:3072 sc1
v_mfma_f32_16x16x32_bf16 v[156:159], a[244:247], a[124:127], v[156:159]
s_waitcnt vmcnt(11) lgkmcnt(4)
v_cmp_ne_u64 s[50:51], s[88:89], v[82:83]
v_cmp_ne_u64 s[44:45], s[88:89], v[86:87]
v_mfma_f32_16x16x32_bf16 v[176:179], a[248:251], a[96:99], v[176:179]
ds_read_b128 a[240:243], v16 offset:16384
v_perm_b32 v58, v97, v19, s55
v_mfma_f32_16x16x32_bf16 v[180:183], a[248:251], a[100:103], v[180:183]
s_or_b64 s[50:51], s[44:45], s[50:51]
ds_read_b32 a141, v58
v_perm_b32 v57, v101, v19, s54
v_mfma_f32_16x16x32_bf16 v[184:187], a[248:251], a[104:107], v[184:187]
s_cbranch_scc1 L_SLOW24
L_BACK24:
v_mfma_f32_16x16x32_bf16 v[188:191], a[248:251], a[108:111], v[188:191]
s_waitcnt lgkmcnt(2)
ds_read_b32 a142, v57
v_add_u32 v12, 57344, v13
v_mfma_f32_16x16x32_bf16 v[224:227], a[252:255], a[64:67], v[224:227]
ds_read_b128 a[244:247], v16 offset:10240
v_perm_b32 v56, v101, v19, s55
v_mfma_f32_16x16x32_bf16 v[228:231], a[252:255], a[68:71], v[228:231]
ds_read_b32 a143, v56
v_perm_b32 v63, v80, v19, s52
v_mfma_f32_16x16x32_bf16 v[232:235], a[252:255], a[72:75], v[232:235]
ds_read_b32 a144, v63
v_perm_b32 v62, v80, v19, s53
v_mfma_f32_16x16x32_bf16 v[236:239], a[252:255], a[76:79], v[236:239]
s_waitcnt lgkmcnt(4)
ds_read_b32 a145, v62
v_mfma_f32_16x16x32_bf16 v[160:163], a[240:243], a[112:115], v[160:163]
ds_read_b128 a[248:251], v17 offset:12288
v_perm_b32 v61, v84, v19, s52
v_mfma_f32_16x16x32_bf16 v[164:167], a[240:243], a[116:119], v[164:167]
ds_read_b32 a146, v61
v_perm_b32 v60, v84, v19, s53
v_mfma_f32_16x16x32_bf16 v[168:171], a[240:243], a[120:123], v[168:171]
s_add_u32 m0, s33, 88448
ds_read_b32 a147, v60
v_perm_b32 v59, v80, v19, s54
v_mfma_f32_16x16x32_bf16 v[172:175], a[240:243], a[124:127], v[172:175]
s_waitcnt lgkmcnt(4)
ds_read_b32 a148, v59
v_perm_b32 v58, v80, v19, s55
v_mfma_f32_16x16x32_bf16 v[208:211], a[244:247], a[80:83], v[208:211]
ds_read_b128 a[252:255], v17 offset:8192
buffer_load_dwordx4 v10, s[20:23], 0 offen offset:1664 lds
v_mfma_f32_16x16x32_bf16 v[212:215], a[244:247], a[84:87], v[212:215]
ds_read_b32 a149, v58
v_perm_b32 v57, v84, v19, s54
v_mfma_f32_16x16x32_bf16 v[216:219], a[244:247], a[88:91], v[216:219]
ds_read_b32 a150, v57
v_perm_b32 v56, v84, v19, s55
v_mfma_f32_16x16x32_bf16 v[220:223], a[244:247], a[92:95], v[220:223]
s_waitcnt lgkmcnt(4)
ds_read_b32 a151, v56
v_mfma_f32_16x16x32_bf16 v[128:131], a[248:251], a[128:131], v[128:131]
ds_read_b128 a[240:243], v17 offset:14336
v_perm_b32 v63, v81, v19, s52
v_mfma_f32_16x16x32_bf16 v[132:135], a[248:251], a[132:135], v[132:135]
ds_read_b32 a152, v63
v_perm_b32 v62, v81, v19, s53
v_mfma_f32_16x16x32_bf16 v[136:139], a[248:251], a[136:139], v[136:139]
s_add_u32 m0, s33, 92416
ds_read_b32 a153, v62
v_perm_b32 v61, v85, v19, s52
v_mfma_f32_16x16x32_bf16 v[140:143], a[248:251], a[140:143], v[140:143]
s_waitcnt lgkmcnt(4)
ds_read_b32 a154, v61
v_perm_b32 v60, v85, v19, s53
v_mfma_f32_16x16x32_bf16 v[192:195], a[252:255], a[96:99], v[192:195]
ds_read_b128 a[244:247], v16 offset:18432
buffer_load_dwordx4 v9, s[20:23], 0 offen offset:1792 lds
v_mfma_f32_16x16x32_bf16 v[196:199], a[252:255], a[100:103], v[196:199]
ds_read_b32 a155, v60
v_perm_b32 v59, v81, v19, s54
v_mfma_f32_16x16x32_bf16 v[200:203], a[252:255], a[104:107], v[200:203]
L_PAD4:
s_cbranch_vccnz L_PADRET
ds_read_b32 a156, v59
v_perm_b32 v58, v81, v19, s55
v_mfma_f32_16x16x32_bf16 v[204:207], a[252:255], a[108:111], v[204:207]
s_waitcnt lgkmcnt(4)
ds_read_b32 a157, v58
buffer_load_dwordx4 v[48:51], v12, s[24:27], 0 offen offset:0 sc1
v_mfma_f32_16x16x32_bf16 v[144:147], a[240:243], a[128:131], v[144:147]
s_waitcnt vmcnt(13)
s_barrier
ds_read_b128 a[248:251], v16 offset:20480
v_perm_b32 v57, v85, v19, s54
v_mfma_f32_16x16x32_bf16 v[148:151], a[240:243], a[132:135], v[148:151]
ds_read_b32 a158, v57
v_perm_b32 v56, v85, v19, s55
v_mfma_f32_16x16x32_bf16 v[152:155], a[240:243], a[136:139], v[152:155]
ds_read_b32 a159, v56
buffer_load_dwordx4 v[52:55], v12, s[24:27], 0 offen offset:1024 sc1
v_mfma_f32_16x16x32_bf16 v[156:159], a[240:243], a[140:143], v[156:159]
s_waitcnt vmcnt(12) lgkmcnt(4)
v_cmp_ne_u64 s[50:51], s[88:89], v[90:91]
v_cmp_ne_u64 s[44:45], s[88:89], v[94:95]
v_mfma_f32_16x16x32_bf16 v[176:179], a[244:247], a[112:115], v[176:179]
ds_read_b128 a[252:255], v17 offset:16384
v_mfma_f32_16x16x32_bf16 v[180:183], a[244:247], a[116:119], v[180:183]
s_or_b64 s[50:51], s[44:45], s[50:51]
v_mfma_f32_16x16x32_bf16 v[184:187], a[244:247], a[120:123], v[184:187]
s_cbranch_scc1 L_SLOW25
L_BACK25:
v_mfma_f32_16x16x32_bf16 v[188:191], a[244:247], a[124:127], v[188:191]
s_waitcnt lgkmcnt(1)
v_mfma_f32_16x16x32_bf16 v[128:131], a[248:251], a[144:147], v[128:131]
ds_read_b128 a[240:243], v17 offset:10240
v_perm_b32 v63, v88, v19, s52
v_mfma_f32_16x16x32_bf16 v[132:135], a[248:251], a[148:151], v[132:135]
ds_read_b32 a160, v63
v_perm_b32 v62, v88, v19, s53
v_mfma_f32_16x16x32_bf16 v[136:139], a[248:251], a[152:155], v[136:139]
s_add_u32 m0, s33, 96384
ds_read_b32 a161, v62
v_perm_b32 v61, v92, v19, s52
v_mfma_f32_16x16x32_bf16 v[140:143], a[248:251], a[156:159], v[140:143]
s_waitcnt lgkmcnt(3)
ds_read_b32 a162, v61
v_perm_b32 v60, v92, v19, s53
v_mfma_f32_16x16x32_bf16 v[160:163], a[252:255], a[128:131], v[160:163]
ds_read_b128 a[244:247], v16 offset:24576
buffer_load_dwordx4 v8, s[20:23], 0 offen offset:1920 lds
v_mfma_f32_16x16x32_bf16 v[164:167], a[252:255], a[132:135], v[164:167]
ds_read_b32 a163, v60
v_perm_b32 v59, v88, v19, s54
v_mfma_f32_16x16x32_bf16 v[168:171], a[252:255], a[136:139], v[168:171]
ds_read_b32 a164, v59
v_perm_b32 v58, v88, v19, s55
v_mfma_f32_16x16x32_bf16 v[172:175], a[252:255], a[140:143], v[172:175]
s_waitcnt lgkmcnt(4)
ds_read_b32 a165, v58
v_mfma_f32_16x16x32_bf16 v[208:211], a[240:243], a[96:99], v[208:211]
ds_read_b128 a[248:251], v16 offset:28672
v_perm_b32 v57, v92, v19, s54
v_mfma_f32_16x16x32_bf16 v[212:215], a[240:243], a[100:103], v[212:215]
ds_read_b32 a166, v57
v_perm_b32 v56, v92, v19, s55
v_mfma_f32_16x16x32_bf16 v[216:219], a[240:243], a[104:107], v[216:219]
ds_read_b32 a167, v56
v_perm_b32 v63, v89, v19, s52
v_mfma_f32_16x16x32_bf16 v[220:223], a[240:243], a[108:111], v[220:223]
s_waitcnt lgkmcnt(4)
ds_read_b32 a168, v63
buffer_load_dwordx4 v[96:99], v12, s[24:27], 0 offen offset:2048 sc1
v_mfma_f32_16x16x32_bf16 v[192:195], a[244:247], a[112:115], v[192:195]
ds_read_b128 a[252:255], v16 offset:22528
v_perm_b32 v62, v89, v19, s53
v_mfma_f32_16x16x32_bf16 v[196:199], a[244:247], a[116:119], v[196:199]
ds_read_b32 a169, v62
v_perm_b32 v61, v93, v19, s52
v_mfma_f32_16x16x32_bf16 v[200:203], a[244:247], a[120:123], v[200:203]
s_add_u32 m0, s33, 100864
ds_read_b32 a170, v61
v_perm_b32 v60, v93, v19, s53
v_mfma_f32_16x16x32_bf16 v[204:207], a[244:247], a[124:127], v[204:207]
s_waitcnt lgkmcnt(4)
ds_read_b32 a171, v60
v_perm_b32 v59, v89, v19, s54
v_mfma_f32_16x16x32_bf16 v[224:227], a[248:251], a[80:83], v[224:227]
ds_read_b128 a[240:243], v17 offset:18432
buffer_load_dwordx4 v11, s[20:23], 0 offen offset:1536 lds
v_mfma_f32_16x16x32_bf16 v[228:231], a[248:251], a[84:87], v[228:231]
ds_read_b32 a172, v59
v_perm_b32 v58, v89, v19, s55
v_mfma_f32_16x16x32_bf16 v[232:235], a[248:251], a[88:91], v[232:235]
ds_read_b32 a173, v58
buffer_load_dwordx4 v[100:103], v12, s[24:27], 0 offen offset:3072 sc1
v_mfma_f32_16x16x32_bf16 v[236:239], a[248:251], a[92:95], v[236:239]
s_waitcnt vmcnt(12) lgkmcnt(4)
v_cmp_ne_u64 s[50:51], s[88:89], v[34:35]
v_cmp_ne_u64 s[44:45], s[88:89], v[38:39]
v_mfma_f32_16x16x32_bf16 v[144:147], a[252:255], a[144:147], v[144:147]
ds_read_b128 a[244:247], v15 offset:51200
v_perm_b32 v57, v93, v19, s54
v_mfma_f32_16x16x32_bf16 v[148:151], a[252:255], a[148:151], v[148:151]
s_or_b64 s[50:51], s[44:45], s[50:51]
ds_read_b32 a174, v57
v_perm_b32 v56, v93, v19, s55
v_mfma_f32_16x16x32_bf16 v[152:155], a[252:255], a[152:155], v[152:155]
s_cbranch_scc1 L_SLOW26
L_BACK26:
v_mfma_f32_16x16x32_bf16 v[156:159], a[252:255], a[156:159], v[156:159]
s_waitcnt lgkmcnt(2)
ds_read_b32 a175, v56
v_add_u32 v12, 61440, v13
v_mfma_f32_16x16x32_bf16 v[176:179], a[240:243], a[128:131], v[176:179]
ds_read_b128 a[248:251], v17 offset:20480
v_perm_b32 v63, v32, v19, s52
v_mfma_f32_16x16x32_bf16 v[180:183], a[240:243], a[132:135], v[180:183]
ds_read_b32 a176, v63
v_perm_b32 v62, v32, v19, s53
v_mfma_f32_16x16x32_bf16 v[184:187], a[240:243], a[136:139], v[184:187]
s_add_u32 m0, s33, 104576
ds_read_b32 a177, v62
v_perm_b32 v61, v36, v19, s52
v_mfma_f32_16x16x32_bf16 v[188:191], a[240:243], a[140:143], v[188:191]
s_waitcnt lgkmcnt(4)
ds_read_b32 a178, v61
v_perm_b32 v60, v36, v19, s53
v_mfma_f32_16x16x32_bf16 v[240:243], a[244:247], a[32:35], v[240:243]
ds_read_b128 a[252:255], v14 offset:0
buffer_load_dwordx4 v9, s[20:23], 0 offen offset:1920 lds
v_mfma_f32_16x16x32_bf16 v[244:247], a[244:247], a[36:39], v[244:247]
ds_read_b32 a179, v60
v_perm_b32 v59, v32, v19, s54
v_mfma_f32_16x16x32_bf16 v[248:251], a[244:247], a[40:43], v[248:251]
ds_read_b32 a180, v59
v_perm_b32 v58, v32, v19, s55
v_mfma_f32_16x16x32_bf16 v[252:255], a[244:247], a[44:47], v[252:255]
s_waitcnt lgkmcnt(4)
ds_read_b32 a181, v58
v_mfma_f32_16x16x32_bf16 v[128:131], a[248:251], a[160:163], v[128:131]
ds_read_b128 a[240:243], v17 offset:22528
v_perm_b32 v57, v36, v19, s54
v_mfma_f32_16x16x32_bf16 v[132:135], a[248:251], a[164:167], v[132:135]
ds_read_b32 a182, v57
v_perm_b32 v56, v36, v19, s55
v_mfma_f32_16x16x32_bf16 v[136:139], a[248:251], a[168:171], v[136:139]
ds_read_b32 a183, v56
v_perm_b32 v63, v33, v19, s52
v_mfma_f32_16x16x32_bf16 v[140:143], a[248:251], a[172:175], v[140:143]
s_waitcnt lgkmcnt(4)
ds_read_b32 a184, v63
v_mfma_f32_16x16x32_bf16 v[160:163], a[252:255], a[144:147], v[160:163]
ds_read_b128 a[244:247], v17 offset:24576
v_perm_b32 v62, v33, v19, s53
v_mfma_f32_16x16x32_bf16 v[164:167], a[252:255], a[148:151], v[164:167]
ds_read_b32 a185, v62
v_perm_b32 v61, v37, v19, s52
v_mfma_f32_16x16x32_bf16 v[168:171], a[252:255], a[152:155], v[168:171]
ds_read_b32 a186, v61
v_perm_b32 v60, v37, v19, s53
v_mfma_f32_16x16x32_bf16 v[172:175], a[252:255], a[156:159], v[172:175]
s_waitcnt lgkmcnt(4)
ds_read_b32 a187, v60
buffer_load_dwordx4 v[80:83], v12, s[24:27], 0 offen offset:0 sc1
v_mfma_f32_16x16x32_bf16 v[144:147], a[240:243], a[160:163], v[144:147]
ds_read_b128 a[248:251], v16 offset:26624
v_perm_b32 v59, v33, v19, s54
v_mfma_f32_16x16x32_bf16 v[148:151], a[240:243], a[164:167], v[148:151]
ds_read_b32 a188, v59
v_perm_b32 v58, v33, v19, s55
v_mfma_f32_16x16x32_bf16 v[152:155], a[240:243], a[168:171], v[152:155]
ds_read_b32 a189, v58
buffer_load_dwordx4 v[84:87], v12, s[24:27], 0 offen offset:1024 sc1
v_mfma_f32_16x16x32_bf16 v[156:159], a[240:243], a[172:175], v[156:159]
s_waitcnt vmcnt(11) lgkmcnt(4)
v_cmp_ne_u64 s[50:51], s[88:89], v[42:43]
v_cmp_ne_u64 s[44:45], s[88:89], v[46:47]
v_mfma_f32_16x16x32_bf16 v[192:195], a[244:247], a[128:131], v[192:195]
ds_read_b128 a[252:255], v14 offset:2048
v_perm_b32 v57, v37, v19, s54
v_mfma_f32_16x16x32_bf16 v[196:199], a[244:247], a[132:135], v[196:199]
s_or_b64 s[50:51], s[44:45], s[50:51]
ds_read_b32 a190, v57
v_perm_b32 v56, v37, v19, s55
v_mfma_f32_16x16x32_bf16 v[200:203], a[244:247], a[136:139], v[200:203]
s_cbranch_scc1 L_SLOW27
L_BACK27:
v_mfma_f32_16x16x32_bf16 v[204:207], a[244:247], a[140:143], v[204:207]
s_waitcnt lgkmcnt(2)
ds_read_b32 a191, v56
v_mfma_f32_16x16x32_bf16 v[208:211], a[248:251], a[112:115], v[208:211]
ds_read_b128 a[240:243], v17 offset:28672
v_perm_b32 v63, v40, v19, s52
v_mfma_f32_16x16x32_bf16 v[212:215], a[248:251], a[116:119], v[212:215]
ds_read_b32 a192, v63
v_perm_b32 v62, v40, v19, s53
v_mfma_f32_16x16x32_bf16 v[216:219], a[248:251], a[120:123], v[216:219]
s_add_u32 m0, s33, 108800
ds_read_b32 a193, v62
v_perm_b32 v61, v44, v19, s52
v_mfma_f32_16x16x32_bf16 v[220:223], a[248:251], a[124:127], v[220:223]
s_waitcnt lgkmcnt(4)
ds_read_b32 a194, v61
v_perm_b32 v60, v44, v19, s53
v_mfma_f32_16x16x32_bf16 v[176:179], a[252:255], a[144:147], v[176:179]
ds_read_b128 a[244:247], v14 offset:4096
buffer_load_dwordx4 v10, s[20:23], 0 offen offset:1792 lds
v_mfma_f32_16x16x32_bf16 v[180:183], a[252:255], a[148:151], v[180:183]
ds_read_b32 a195, v60
v_perm_b32 v59, v40, v19, s54
v_mfma_f32_16x16x32_bf16 v[184:187], a[252:255], a[152:155], v[184:187]
ds_read_b32 a196, v59
v_perm_b32 v58, v40, v19, s55
v_mfma_f32_16x16x32_bf16 v[188:191], a[252:255], a[156:159], v[188:191]
s_waitcnt lgkmcnt(4)
ds_read_b32 a197, v58
v_mfma_f32_16x16x32_bf16 v[224:227], a[240:243], a[96:99], v[224:227]
s_barrier
ds_read_b128 a[248:251], v15 offset:0
v_perm_b32 v57, v44, v19, s54
v_mfma_f32_16x16x32_bf16 v[228:231], a[240:243], a[100:103], v[228:231]
ds_read_b32 a198, v57
v_perm_b32 v56, v44, v19, s55
v_mfma_f32_16x16x32_bf16 v[232:235], a[240:243], a[104:107], v[232:235]
ds_read_b32 a199, v56
v_perm_b32 v63, v41, v19, s52
v_mfma_f32_16x16x32_bf16 v[236:239], a[240:243], a[108:111], v[236:239]
s_waitcnt lgkmcnt(4)
ds_read_b32 a200, v63
v_mfma_f32_16x16x32_bf16 v[128:131], a[244:247], a[176:179], v[128:131]
ds_read_b128 a[252:255], v14 offset:6144
v_perm_b32 v62, v41, v19, s53
v_mfma_f32_16x16x32_bf16 v[132:135], a[244:247], a[180:183], v[132:135]
ds_read_b32 a201, v62
v_perm_b32 v61, v45, v19, s52
v_mfma_f32_16x16x32_bf16 v[136:139], a[244:247], a[184:187], v[136:139]
s_add_u32 m0, s33, 113024
ds_read_b32 a202, v61
v_perm_b32 v60, v45, v19, s53
v_mfma_f32_16x16x32_bf16 v[140:143], a[244:247], a[188:191], v[140:143]
s_waitcnt lgkmcnt(4)
ds_read_b32 a203, v60
v_perm_b32 v59, v41, v19, s54
v_mfma_f32_16x16x32_bf16 v[160:163], a[248:251], a[160:163], v[160:163]
ds_read_b128 a[240:243], v14 offset:8192
buffer_load_dwordx4 v11, s[20:23], 0 offen offset:1664 lds
v_mfma_f32_16x16x32_bf16 v[164:167], a[248:251], a[164:167], v[164:167]
ds_read_b32 a204, v59
v_perm_b32 v58, v41, v19, s55
v_mfma_f32_16x16x32_bf16 v[168:171], a[248:251], a[168:171], v[168:171]
ds_read_b32 a205, v58
v_perm_b32 v57, v45, v19, s54
v_mfma_f32_16x16x32_bf16 v[172:175], a[248:251], a[172:175], v[172:175]
s_waitcnt lgkmcnt(4)
ds_read_b32 a206, v57
buffer_load_dwordx4 v[88:91], v12, s[24:27], 0 offen offset:2048 sc1
v_mfma_f32_16x16x32_bf16 v[144:147], a[252:255], a[176:179], v[144:147]
ds_read_b128 a[244:247], v15 offset:4096
v_perm_b32 v56, v45, v19, s55
v_mfma_f32_16x16x32_bf16 v[148:151], a[252:255], a[180:183], v[148:151]
ds_read_b32 a207, v56
buffer_load_dwordx4 v[92:95], v12, s[24:27], 0 offen offset:3072 sc1
v_mfma_f32_16x16x32_bf16 v[152:155], a[252:255], a[184:187], v[152:155]
s_waitcnt vmcnt(11)
v_cmp_ne_u64 s[50:51], s[88:89], v[50:51]
v_cmp_ne_u64 s[44:45], s[88:89], v[54:55]
v_mfma_f32_16x16x32_bf16 v[156:159], a[252:255], a[188:191], v[156:159]
s_waitcnt lgkmcnt(3)
v_mfma_f32_16x16x32_bf16 v[192:195], a[240:243], a[144:147], v[192:195]
s_or_b64 s[50:51], s[44:45], s[50:51]
ds_read_b128 a[248:251], v15 offset:2048
v_mfma_f32_16x16x32_bf16 v[196:199], a[240:243], a[148:151], v[196:199]
s_cbranch_scc1 L_SLOW28
L_BACK28:
v_mfma_f32_16x16x32_bf16 v[200:203], a[240:243], a[152:155], v[200:203]
s_add_u32 m0, s33, 116864
v_perm_b32 v63, v48, v19, s52
v_mfma_f32_16x16x32_bf16 v[204:207], a[240:243], a[156:159], v[204:207]
s_waitcnt lgkmcnt(1)
ds_read_b32 a208, v63
v_perm_b32 v62, v48, v19, s53
v_mfma_f32_16x16x32_bf16 v[128:131], a[244:247], a[192:195], v[128:131]
ds_read_b128 a[252:255], v17 offset:26624
buffer_load_dwordx4 v10, s[20:23], 0 offen offset:1920 lds
v_mfma_f32_16x16x32_bf16 v[132:135], a[244:247], a[196:199], v[132:135]
ds_read_b32 a209, v62
v_perm_b32 v61, v52, v19, s52
v_mfma_f32_16x16x32_bf16 v[136:139], a[244:247], a[200:203], v[136:139]
ds_read_b32 a210, v61
v_perm_b32 v60, v52, v19, s53
v_mfma_f32_16x16x32_bf16 v[140:143], a[244:247], a[204:207], v[140:143]
s_waitcnt lgkmcnt(4)
ds_read_b32 a211, v60
v_mfma_f32_16x16x32_bf16 v[176:179], a[248:251], a[160:163], v[176:179]
ds_read_b128 a[240:243], v14 offset:12288
v_perm_b32 v59, v48, v19, s54
v_mfma_f32_16x16x32_bf16 v[180:183], a[248:251], a[164:167], v[180:183]
ds_read_b32 a212, v59
v_perm_b32 v58, v48, v19, s55
v_mfma_f32_16x16x32_bf16 v[184:187], a[248:251], a[168:171], v[184:187]
ds_read_b32 a213, v58
v_perm_b32 v57, v52, v19, s54
v_mfma_f32_16x16x32_bf16 v[188:191], a[248:251], a[172:175], v[188:191]
s_waitcnt lgkmcnt(4)
ds_read_b32 a214, v57
v_mfma_f32_16x16x32_bf16 v[208:211], a[252:255], a[128:131], v[208:211]
ds_read_b128 a[244:247], v16 offset:6144
v_perm_b32 v56, v52, v19, s55
v_mfma_f32_16x16x32_bf16 v[212:215], a[252:255], a[132:135], v[212:215]
ds_read_b32 a215, v56
v_perm_b32 v63, v49, v19, s52
v_mfma_f32_16x16x32_bf16 v[216:219], a[252:255], a[136:139], v[216:219]
s_add_u32 m0, s33, 121088
ds_read_b32 a216, v63
v_perm_b32 v62, v49, v19, s53
v_mfma_f32_16x16x32_bf16 v[220:223], a[252:255], a[140:143], v[220:223]
s_waitcnt lgkmcnt(4)
ds_read_b32 a217, v62
v_perm_b32 v61, v53, v19, s52
v_mfma_f32_16x16x32_bf16 v[160:163], a[240:243], a[176:179], v[160:163]
ds_read_b128 a[248:251], v14 offset:16384
buffer_load_dwordx4 v11, s[20:23], 0 offen offset:1792 lds
v_mfma_f32_16x16x32_bf16 v[164:167], a[240:243], a[180:183], v[164:167]
ds_read_b32 a218, v61
v_perm_b32 v60, v53, v19, s53
v_mfma_f32_16x16x32_bf16 v[168:171], a[240:243], a[184:187], v[168:171]
ds_read_b32 a219, v60
v_perm_b32 v59, v49, v19, s54
v_mfma_f32_16x16x32_bf16 v[172:175], a[240:243], a[188:191], v[172:175]
s_waitcnt lgkmcnt(4)
ds_read_b32 a220, v59
v_mfma_f32_16x16x32_bf16 v[240:243], a[244:247], a[48:51], v[240:243]
ds_read_b128 a[252:255], v15 offset:6144
v_perm_b32 v58, v49, v19, s55
v_mfma_f32_16x16x32_bf16 v[244:247], a[244:247], a[52:55], v[244:247]
ds_read_b32 a221, v58
v_perm_b32 v57, v53, v19, s54
v_mfma_f32_16x16x32_bf16 v[248:251], a[244:247], a[56:59], v[248:251]
s_waitcnt vmcnt(9)
v_cmp_ne_u64 s[50:51], s[88:89], v[98:99]
v_cmp_ne_u64 s[44:45], s[88:89], v[102:103]
v_mfma_f32_16x16x32_bf16 v[252:255], a[244:247], a[60:63], v[252:255]
s_waitcnt lgkmcnt(3)
ds_read_b32 a222, v57
v_mfma_f32_16x16x32_bf16 v[224:227], a[248:251], a[112:115], v[224:227]
s_or_b64 s[50:51], s[44:45], s[50:51]
ds_read_b128 a[240:243], v14 offset:20480
v_perm_b32 v56, v53, v19, s55
v_mfma_f32_16x16x32_bf16 v[228:231], a[248:251], a[116:119], v[228:231]
s_cbranch_scc1 L_SLOW29
L_BACK29:
v_mfma_f32_16x16x32_bf16 v[232:235], a[248:251], a[120:123], v[232:235]
s_add_u32 m0, s33, 125056
ds_read_b32 a223, v56
v_mfma_f32_16x16x32_bf16 v[236:239], a[248:251], a[124:127], v[236:239]
s_waitcnt lgkmcnt(3)
v_mfma_f32_16x16x32_bf16 v[144:147], a[252:255], a[192:195], v[144:147]
ds_read_b128 a[244:247], v15 offset:8192
buffer_load_dwordx4 v11, s[20:23], 0 offen offset:1920 lds
v_mfma_f32_16x16x32_bf16 v[148:151], a[252:255], a[196:199], v[148:151]
v_perm_b32 v63, v96, v19, s52
v_mfma_f32_16x16x32_bf16 v[152:155], a[252:255], a[200:203], v[152:155]
ds_read_b32 a224, v63
v_perm_b32 v62, v96, v19, s53
v_mfma_f32_16x16x32_bf16 v[156:159], a[252:255], a[204:207], v[156:159]
s_waitcnt lgkmcnt(2)
ds_read_b32 a225, v62
v_mfma_f32_16x16x32_bf16 v[128:131], a[240:243], a[208:211], v[128:131]
ds_read_b128 a[248:251], v14 offset:14336
v_perm_b32 v61, v100, v19, s52
v_mfma_f32_16x16x32_bf16 v[132:135], a[240:243], a[212:215], v[132:135]
ds_read_b32 a226, v61
v_perm_b32 v60, v100, v19, s53
v_mfma_f32_16x16x32_bf16 v[136:139], a[240:243], a[216:219], v[136:139]
ds_read_b32 a227, v60
v_perm_b32 v59, v96, v19, s54
v_mfma_f32_16x16x32_bf16 v[140:143], a[240:243], a[220:223], v[140:143]
s_waitcnt lgkmcnt(4)
ds_read_b32 a228, v59
v_mfma_f32_16x16x32_bf16 v[192:195], a[244:247], a[160:163], v[192:195]
ds_read_b128 a[252:255], v15 offset:12288
v_perm_b32 v58, v96, v19, s55
v_mfma_f32_16x16x32_bf16 v[196:199], a[244:247], a[164:167], v[196:199]
ds_read_b32 a229, v58
v_perm_b32 v57, v100, v19, s54
v_mfma_f32_16x16x32_bf16 v[200:203], a[244:247], a[168:171], v[200:203]
ds_read_b32 a230, v57
v_perm_b32 v56, v100, v19, s55
v_mfma_f32_16x16x32_bf16 v[204:207], a[244:247], a[172:175], v[204:207]
s_waitcnt lgkmcnt(4)
ds_read_b32 a231, v56
v_mfma_f32_16x16x32_bf16 v[176:179], a[248:251], a[176:179], v[176:179]
ds_read_b128 a[240:243], v14 offset:10240
v_perm_b32 v63, v97, v19, s52
v_mfma_f32_16x16x32_bf16 v[180:183], a[248:251], a[180:183], v[180:183]
ds_read_b32 a232, v63
v_perm_b32 v62, v97, v19, s53
v_mfma_f32_16x16x32_bf16 v[184:187], a[248:251], a[184:187], v[184:187]
ds_read_b32 a233, v62
v_perm_b32 v61, v101, v19, s52
v_mfma_f32_16x16x32_bf16 v[188:191], a[248:251], a[188:191], v[188:191]
s_waitcnt lgkmcnt(4)
ds_read_b32 a234, v61
v_mfma_f32_16x16x32_bf16 v[160:163], a[252:255], a[192:195], v[160:163]
ds_read_b128 a[244:247], v14 offset:22528
v_perm_b32 v60, v101, v19, s53
v_mfma_f32_16x16x32_bf16 v[164:167], a[252:255], a[196:199], v[164:167]
ds_read_b32 a235, v60
v_perm_b32 v59, v97, v19, s54
v_mfma_f32_16x16x32_bf16 v[168:171], a[252:255], a[200:203], v[168:171]
ds_read_b32 a236, v59
v_perm_b32 v58, v97, v19, s55
v_mfma_f32_16x16x32_bf16 v[172:175], a[252:255], a[204:207], v[172:175]
s_waitcnt lgkmcnt(4)
ds_read_b32 a237, v58
v_mfma_f32_16x16x32_bf16 v[208:211], a[240:243], a[144:147], v[208:211]
s_waitcnt vmcnt(9)
s_barrier
ds_read_b128 a[248:251], v15 offset:20480
v_perm_b32 v57, v101, v19, s54
v_mfma_f32_16x16x32_bf16 v[212:215], a[240:243], a[148:151], v[212:215]
ds_read_b32 a238, v57
v_perm_b32 v56, v101, v19, s55
v_mfma_f32_16x16x32_bf16 v[216:219], a[240:243], a[152:155], v[216:219]
ds_read_b32 a239, v56
v_mfma_f32_16x16x32_bf16 v[220:223], a[240:243], a[156:159], v[220:223]
s_waitcnt vmcnt(7) lgkmcnt(4)
v_cmp_ne_u64 s[50:51], s[88:89], v[82:83]
v_cmp_ne_u64 s[44:45], s[88:89], v[86:87]
v_mfma_f32_16x16x32_bf16 v[144:147], a[244:247], a[208:211], v[144:147]
ds_read_b128 a[252:255], v15 offset:16384
v_mfma_f32_16x16x32_bf16 v[148:151], a[244:247], a[212:215], v[148:151]
s_or_b64 s[50:51], s[44:45], s[50:51]
v_mfma_f32_16x16x32_bf16 v[152:155], a[244:247], a[216:219], v[152:155]
s_cbranch_scc1 L_SLOW30
L_BACK30:
v_mfma_f32_16x16x32_bf16 v[156:159], a[244:247], a[220:223], v[156:159]
s_waitcnt lgkmcnt(1)
v_mfma_f32_16x16x32_bf16 v[128:131], a[248:251], a[224:227], v[128:131]
ds_read_b128 a[240:243], v15 offset:14336
v_mfma_f32_16x16x32_bf16 v[132:135], a[248:251], a[228:231], v[132:135]
v_perm_b32 v63, v80, v19, s52
v_mfma_f32_16x16x32_bf16 v[136:139], a[248:251], a[232:235], v[136:139]
ds_read_b32 a0, v63
v_perm_b32 v62, v80, v19, s53
v_mfma_f32_16x16x32_bf16 v[140:143], a[248:251], a[236:239], v[140:143]
s_waitcnt lgkmcnt(2)
ds_read_b32 a1, v62
v_mfma_f32_16x16x32_bf16 v[224:227], a[252:255], a[128:131], v[224:227]
ds_read_b128 a[244:247], v14 offset:24576
v_perm_b32 v61, v84, v19, s52
v_mfma_f32_16x16x32_bf16 v[228:231], a[252:255], a[132:135], v[228:231]
ds_read_b32 a2, v61
v_perm_b32 v60, v84, v19, s53
v_mfma_f32_16x16x32_bf16 v[232:235], a[252:255], a[136:139], v[232:235]
ds_read_b32 a3, v60
v_perm_b32 v59, v80, v19, s54
v_mfma_f32_16x16x32_bf16 v[236:239], a[252:255], a[140:143], v[236:239]
s_waitcnt lgkmcnt(4)
ds_read_b32 a4, v59
v_mfma_f32_16x16x32_bf16 v[176:179], a[240:243], a[192:195], v[176:179]
ds_read_b128 a[248:251], v14 offset:28672
v_perm_b32 v58, v80, v19, s55
v_mfma_f32_16x16x32_bf16 v[180:183], a[240:243], a[196:199], v[180:183]
ds_read_b32 a5, v58
v_perm_b32 v57, v84, v19, s54
v_mfma_f32_16x16x32_bf16 v[184:187], a[240:243], a[200:203], v[184:187]
ds_read_b32 a6, v57
v_perm_b32 v56, v84, v19, s55
v_mfma_f32_16x16x32_bf16 v[188:191], a[240:243], a[204:207], v[188:191]
s_waitcnt lgkmcnt(4)
ds_read_b32 a7, v56
v_mfma_f32_16x16x32_bf16 v[192:195], a[244:247], a[176:179], v[192:195]
ds_read_b128 a[252:255], v15 offset:22528
v_perm_b32 v63, v81, v19, s52
v_mfma_f32_16x16x32_bf16 v[196:199], a[244:247], a[180:183], v[196:199]
ds_read_b32 a8, v63
v_perm_b32 v62, v81, v19, s53
v_mfma_f32_16x16x32_bf16 v[200:203], a[244:247], a[184:187], v[200:203]
ds_read_b32 a9, v62
v_perm_b32 v61, v85, v19, s52
v_mfma_f32_16x16x32_bf16 v[204:207], a[244:247], a[188:191], v[204:207]
s_waitcnt lgkmcnt(4)
ds_read_b32 a10, v61
v_mfma_f32_16x16x32_bf16 v[160:163], a[248:251], a[208:211], v[160:163]
ds_read_b128 a[240:243], v15 offset:10240
v_perm_b32 v60, v85, v19, s53
v_mfma_f32_16x16x32_bf16 v[164:167], a[248:251], a[212:215], v[164:167]
ds_read_b32 a11, v60
v_perm_b32 v59, v81, v19, s54
v_mfma_f32_16x16x32_bf16 v[168:171], a[248:251], a[216:219], v[168:171]
ds_read_b32 a12, v59
v_perm_b32 v58, v81, v19, s55
v_mfma_f32_16x16x32_bf16 v[172:175], a[248:251], a[220:223], v[172:175]
s_waitcnt lgkmcnt(4)
ds_read_b32 a13, v58
v_mfma_f32_16x16x32_bf16 v[144:147], a[252:255], a[224:227], v[144:147]
ds_read_b128 a[244:247], v14 offset:32768
v_perm_b32 v57, v85, v19, s54
v_mfma_f32_16x16x32_bf16 v[148:151], a[252:255], a[228:231], v[148:151]
ds_read_b32 a14, v57
v_perm_b32 v56, v85, v19, s55
v_mfma_f32_16x16x32_bf16 v[152:155], a[252:255], a[232:235], v[152:155]
ds_read_b32 a15, v56
v_mfma_f32_16x16x32_bf16 v[156:159], a[252:255], a[236:239], v[156:159]
s_waitcnt vmcnt(3) lgkmcnt(4)
v_cmp_ne_u64 s[50:51], s[88:89], v[90:91]
v_cmp_ne_u64 s[44:45], s[88:89], v[94:95]
v_mfma_f32_16x16x32_bf16 v[208:211], a[240:243], a[160:163], v[208:211]
ds_read_b128 a[248:251], v17 offset:6144
v_mfma_f32_16x16x32_bf16 v[212:215], a[240:243], a[164:167], v[212:215]
s_or_b64 s[50:51], s[44:45], s[50:51]
v_mfma_f32_16x16x32_bf16 v[216:219], a[240:243], a[168:171], v[216:219]
s_cbranch_scc1 L_SLOW31
L_BACK31:
v_mfma_f32_16x16x32_bf16 v[220:223], a[240:243], a[172:175], v[220:223]
s_waitcnt lgkmcnt(1)
v_mfma_f32_16x16x32_bf16 v[128:131], a[244:247], a[0:3], v[128:131]
ds_read_b128 a[252:255], v14 offset:30720
v_mfma_f32_16x16x32_bf16 v[132:135], a[244:247], a[4:7], v[132:135]
v_perm_b32 v63, v88, v19, s52
v_mfma_f32_16x16x32_bf16 v[136:139], a[244:247], a[8:11], v[136:139]
ds_read_b32 a16, v63
v_perm_b32 v62, v88, v19, s53
v_mfma_f32_16x16x32_bf16 v[140:143], a[244:247], a[12:15], v[140:143]
s_waitcnt lgkmcnt(2)
ds_read_b32 a17, v62
v_mfma_f32_16x16x32_bf16 v[240:243], a[248:251], a[64:67], v[240:243]
ds_read_b128 a[240:243], v15 offset:28672
v_perm_b32 v61, v92, v19, s52
v_mfma_f32_16x16x32_bf16 v[244:247], a[248:251], a[68:71], v[244:247]
ds_read_b32 a18, v61
v_perm_b32 v60, v92, v19, s53
v_mfma_f32_16x16x32_bf16 v[248:251], a[248:251], a[72:75], v[248:251]
ds_read_b32 a19, v60
v_perm_b32 v59, v88, v19, s54
v_mfma_f32_16x16x32_bf16 v[252:255], a[248:251], a[76:79], v[252:255]
s_waitcnt lgkmcnt(4)
ds_read_b32 a20, v59
v_mfma_f32_16x16x32_bf16 v[176:179], a[252:255], a[208:211], v[176:179]
ds_read_b128 a[244:247], v15 offset:24576
v_perm_b32 v58, v88, v19, s55
v_mfma_f32_16x16x32_bf16 v[180:183], a[252:255], a[212:215], v[180:183]
ds_read_b32 a21, v58
v_perm_b32 v57, v92, v19, s54
v_mfma_f32_16x16x32_bf16 v[184:187], a[252:255], a[216:219], v[184:187]
ds_read_b32 a22, v57
v_perm_b32 v56, v92, v19, s55
v_mfma_f32_16x16x32_bf16 v[188:191], a[252:255], a[220:223], v[188:191]
s_waitcnt lgkmcnt(4)
ds_read_b32 a23, v56
v_mfma_f32_16x16x32_bf16 v[160:163], a[240:243], a[224:227], v[160:163]
ds_read_b128 a[248:251], v14 offset:36864
v_perm_b32 v63, v89, v19, s52
v_mfma_f32_16x16x32_bf16 v[164:167], a[240:243], a[228:231], v[164:167]
L_PAD5:
s_cbranch_vccnz L_PADRET
ds_read_b32 a24, v63
v_perm_b32 v62, v89, v19, s53
v_mfma_f32_16x16x32_bf16 v[168:171], a[240:243], a[232:235], v[168:171]
ds_read_b32 a25, v62
v_perm_b32 v61, v93, v19, s52
v_mfma_f32_16x16x32_bf16 v[172:175], a[240:243], a[236:239], v[172:175]
s_waitcnt lgkmcnt(4)
ds_read_b32 a26, v61
v_mfma_f32_16x16x32_bf16 v[192:195], a[244:247], a[192:195], v[192:195]
ds_read_b128 a[252:255], v14 offset:34816
v_perm_b32 v60, v93, v19, s53
v_mfma_f32_16x16x32_bf16 v[196:199], a[244:247], a[196:199], v[196:199]
ds_read_b32 a27, v60
v_perm_b32 v59, v89, v19, s54
v_mfma_f32_16x16x32_bf16 v[200:203], a[244:247], a[200:203], v[200:203]
ds_read_b32 a28, v59
v_perm_b32 v58, v89, v19, s55
v_mfma_f32_16x16x32_bf16 v[204:207], a[244:247], a[204:207], v[204:207]
s_waitcnt lgkmcnt(4)
ds_read_b32 a29, v58
v_mfma_f32_16x16x32_bf16 v[224:227], a[248:251], a[144:147], v[224:227]
ds_read_b128 a[240:243], v15 offset:32768
v_perm_b32 v57, v93, v19, s54
v_mfma_f32_16x16x32_bf16 v[228:231], a[248:251], a[148:151], v[228:231]
ds_read_b32 a30, v57
v_perm_b32 v56, v93, v19, s55
v_mfma_f32_16x16x32_bf16 v[232:235], a[248:251], a[152:155], v[232:235]
ds_read_b32 a31, v56
v_mfma_f32_16x16x32_bf16 v[236:239], a[248:251], a[156:159], v[236:239]
s_waitcnt lgkmcnt(4)
v_mfma_f32_16x16x32_bf16 v[144:147], a[252:255], a[0:3], v[144:147]
ds_read_b128 a[244:247], v14 offset:26624
v_mfma_f32_16x16x32_bf16 v[148:151], a[252:255], a[4:7], v[148:151]
v_mfma_f32_16x16x32_bf16 v[152:155], a[252:255], a[8:11], v[152:155]
v_mfma_f32_16x16x32_bf16 v[156:159], a[252:255], a[12:15], v[156:159]
s_waitcnt lgkmcnt(1)
v_mfma_f32_16x16x32_bf16 v[128:131], a[240:243], a[16:19], v[128:131]
ds_read_b128 a[248:251], v15 offset:30720
v_mfma_f32_16x16x32_bf16 v[132:135], a[240:243], a[20:23], v[132:135]
v_mfma_f32_16x16x32_bf16 v[136:139], a[240:243], a[24:27], v[136:139]
v_mfma_f32_16x16x32_bf16 v[140:143], a[240:243], a[28:31], v[140:143]
s_waitcnt lgkmcnt(1)
v_mfma_f32_16x16x32_bf16 v[208:211], a[244:247], a[176:179], v[208:211]
ds_read_b128 a[252:255], v14 offset:40960
v_mfma_f32_16x16x32_bf16 v[212:215], a[244:247], a[180:183], v[212:215]
v_mfma_f32_16x16x32_bf16 v[216:219], a[244:247], a[184:187], v[216:219]
v_mfma_f32_16x16x32_bf16 v[220:223], a[244:247], a[188:191], v[220:223]
s_waitcnt lgkmcnt(1)
v_mfma_f32_16x16x32_bf16 v[176:179], a[248:251], a[224:227], v[176:179]
s_waitcnt vmcnt(0)
s_barrier
ds_read_b128 a[240:243], v15 offset:34816
v_mfma_f32_16x16x32_bf16 v[180:183], a[248:251], a[228:231], v[180:183]
v_mfma_f32_16x16x32_bf16 v[184:187], a[248:251], a[232:235], v[184:187]
v_mfma_f32_16x16x32_bf16 v[188:191], a[248:251], a[236:239], v[188:191]
s_waitcnt lgkmcnt(1)
v_mul_f32 v128, v128, v24
v_mul_f32 v132, v132, v25
v_mfma_f32_16x16x32_bf16 v[160:163], a[252:255], a[0:3], v[160:163]
ds_read_b128 a[244:247], v14 offset:45056
v_mul_f32 v136, v136, v26
v_mfma_f32_16x16x32_bf16 v[164:167], a[252:255], a[4:7], v[164:167]
v_mul_f32 v140, v140, v27
v_cvt_pk_bf16_f32 v120, v128, v132
v_mfma_f32_16x16x32_bf16 v[168:171], a[252:255], a[8:11], v[168:171]
v_cvt_pk_bf16_f32 v121, v136, v140
v_mfma_f32_16x16x32_bf16 v[172:175], a[252:255], a[12:15], v[172:175]
s_waitcnt lgkmcnt(1)
v_mfma_f32_16x16x32_bf16 v[144:147], a[240:243], a[16:19], v[144:147]
ds_read_b128 a[248:251], v15 offset:36864
v_mfma_f32_16x16x32_bf16 v[148:151], a[240:243], a[20:23], v[148:151]
buffer_store_dwordx2 v[120:121], v18, s[28:31], 0 offen nt
v_mul_f32 v129, v129, v24
v_mfma_f32_16x16x32_bf16 v[152:155], a[240:243], a[24:27], v[152:155]
s_add_u32 s28, s28, 7168
v_mul_f32 v133, v133, v25
v_mul_f32 v137, v137, v26
v_mfma_f32_16x16x32_bf16 v[156:159], a[240:243], a[28:31], v[156:159]
s_waitcnt lgkmcnt(1)
v_mul_f32 v141, v141, v27
v_cvt_pk_bf16_f32 v122, v129, v133
v_mfma_f32_16x16x32_bf16 v[192:195], a[244:247], a[208:211], v[192:195]
s_addc_u32 s29, s29, 0
ds_read_b128 a[252:255], v15 offset:26624
v_cvt_pk_bf16_f32 v123, v137, v141
v_mfma_f32_16x16x32_bf16 v[196:199], a[244:247], a[212:215], v[196:199]
buffer_store_dwordx2 v[122:123], v18, s[28:31], 0 offen nt
v_mul_f32 v130, v130, v24
v_mfma_f32_16x16x32_bf16 v[200:203], a[244:247], a[216:219], v[200:203]
s_add_u32 s28, s28, 7168
v_mul_f32 v134, v134, v25
v_mul_f32 v138, v138, v26
v_mfma_f32_16x16x32_bf16 v[204:207], a[244:247], a[220:223], v[204:207]
s_waitcnt lgkmcnt(1)
v_mul_f32 v142, v142, v27
v_cvt_pk_bf16_f32 v124, v130, v134
v_mfma_f32_16x16x32_bf16 v[224:227], a[248:251], a[160:163], v[224:227]
s_addc_u32 s29, s29, 0
ds_read_b128 a[240:243], v16 offset:30720
v_cvt_pk_bf16_f32 v125, v138, v142
v_mfma_f32_16x16x32_bf16 v[228:231], a[248:251], a[164:167], v[228:231]
buffer_store_dwordx2 v[124:125], v18, s[28:31], 0 offen nt
v_mul_f32 v131, v131, v24
v_mfma_f32_16x16x32_bf16 v[232:235], a[248:251], a[168:171], v[232:235]
s_add_u32 s28, s28, 7168
v_mul_f32 v135, v135, v25
v_mul_f32 v139, v139, v26
v_mfma_f32_16x16x32_bf16 v[236:239], a[248:251], a[172:175], v[236:239]
s_waitcnt lgkmcnt(1)
v_mul_f32 v143, v143, v27
v_cvt_pk_bf16_f32 v126, v131, v135
v_mfma_f32_16x16x32_bf16 v[208:211], a[252:255], a[192:195], v[208:211]
s_addc_u32 s29, s29, 0
ds_read_b128 a[244:247], v15 offset:40960
v_cvt_pk_bf16_f32 v127, v139, v143
v_mfma_f32_16x16x32_bf16 v[212:215], a[252:255], a[196:199], v[212:215]
buffer_store_dwordx2 v[126:127], v18, s[28:31], 0 offen nt
v_mul_f32 v144, v144, v24
v_mfma_f32_16x16x32_bf16 v[216:219], a[252:255], a[200:203], v[216:219]
s_add_u32 s28, s28, 93184
v_mul_f32 v148, v148, v25
v_mul_f32 v152, v152, v26
v_mfma_f32_16x16x32_bf16 v[220:223], a[252:255], a[204:207], v[220:223]
s_waitcnt lgkmcnt(1)
v_mul_f32 v156, v156, v27
v_cvt_pk_bf16_f32 v120, v144, v148
v_mfma_f32_16x16x32_bf16 v[240:243], a[240:243], a[80:83], v[240:243]
s_addc_u32 s29, s29, 0
ds_read_b128 a[248:251], v14 offset:43008
v_cvt_pk_bf16_f32 v121, v152, v156
v_mfma_f32_16x16x32_bf16 v[244:247], a[240:243], a[84:87], v[244:247]
buffer_store_dwordx2 v[120:121], v18, s[28:31], 0 offen nt
v_mul_f32 v145, v145, v24
v_mfma_f32_16x16x32_bf16 v[248:251], a[240:243], a[88:91], v[248:251]
s_add_u32 s28, s28, 7168
v_mul_f32 v149, v149, v25
v_mul_f32 v153, v153, v26
v_mfma_f32_16x16x32_bf16 v[252:255], a[240:243], a[92:95], v[252:255]
s_waitcnt lgkmcnt(1)
v_mul_f32 v157, v157, v27
v_cvt_pk_bf16_f32 v122, v145, v149
v_mfma_f32_16x16x32_bf16 v[160:163], a[244:247], a[16:19], v[160:163]
s_addc_u32 s29, s29, 0
ds_read_b128 a[252:255], v15 offset:45056
v_cvt_pk_bf16_f32 v123, v153, v157
v_mfma_f32_16x16x32_bf16 v[164:167], a[244:247], a[20:23], v[164:167]
buffer_store_dwordx2 v[122:123], v18, s[28:31], 0 offen nt
v_mul_f32 v146, v146, v24
v_mfma_f32_16x16x32_bf16 v[168:171], a[244:247], a[24:27], v[168:171]
s_add_u32 s28, s28, 7168
v_mul_f32 v150, v150, v25
v_mul_f32 v154, v154, v26
v_mfma_f32_16x16x32_bf16 v[172:175], a[244:247], a[28:31], v[172:175]
s_waitcnt lgkmcnt(1)
v_mul_f32 v158, v158, v27
v_cvt_pk_bf16_f32 v124, v146, v150
v_mfma_f32_16x16x32_bf16 v[176:179], a[248:251], a[0:3], v[176:179]
s_addc_u32 s29, s29, 0
ds_read_b128 a[240:243], v14 offset:49152
v_cvt_pk_bf16_f32 v125, v154, v158
v_mfma_f32_16x16x32_bf16 v[180:183], a[248:251], a[4:7], v[180:183]
buffer_store_dwordx2 v[124:125], v18, s[28:31], 0 offen nt
v_mul_f32 v147, v147, v24
v_mfma_f32_16x16x32_bf16 v[184:187], a[248:251], a[8:11], v[184:187]
s_add_u32 s28, s28, 7168
v_mul_f32 v151, v151, v25
v_mul_f32 v155, v155, v26
v_mfma_f32_16x16x32_bf16 v[188:191], a[248:251], a[12:15], v[188:191]
s_waitcnt lgkmcnt(1)
v_mul_f32 v159, v159, v27
v_cvt_pk_bf16_f32 v126, v147, v151
v_mfma_f32_16x16x32_bf16 v[192:195], a[252:255], a[224:227], v[192:195]
s_addc_u32 s29, s29, 0
ds_read_b128 a[244:247], v14 offset:47104
v_cvt_pk_bf16_f32 v127, v155, v159
v_mfma_f32_16x16x32_bf16 v[196:199], a[252:255], a[228:231], v[196:199]
buffer_store_dwordx2 v[126:127], v18, s[28:31], 0 offen nt
v_mfma_f32_16x16x32_bf16 v[200:203], a[252:255], a[232:235], v[200:203]
v_mfma_f32_16x16x32_bf16 v[204:207], a[252:255], a[236:239], v[204:207]
s_waitcnt lgkmcnt(1)
v_mul_f32 v160, v160, v24
v_mul_f32 v164, v164, v25
v_mfma_f32_16x16x32_bf16 v[224:227], a[240:243], a[176:179], v[224:227]
s_add_u32 s28, s28, 93184
ds_read_b128 a[248:251], v15 offset:43008
v_mul_f32 v168, v168, v26
v_mfma_f32_16x16x32_bf16 v[228:231], a[240:243], a[180:183], v[228:231]
s_addc_u32 s29, s29, 0
v_mul_f32 v172, v172, v27
v_cvt_pk_bf16_f32 v120, v160, v164
v_mfma_f32_16x16x32_bf16 v[232:235], a[240:243], a[184:187], v[232:235]
v_cvt_pk_bf16_f32 v121, v168, v172
v_mfma_f32_16x16x32_bf16 v[236:239], a[240:243], a[188:191], v[236:239]
s_waitcnt lgkmcnt(1)
v_mfma_f32_16x16x32_bf16 v[208:211], a[244:247], a[208:211], v[208:211]
ds_read_b128 a[252:255], v14 offset:53248
v_mfma_f32_16x16x32_bf16 v[212:215], a[244:247], a[212:215], v[212:215]
buffer_store_dwordx2 v[120:121], v18, s[28:31], 0 offen nt
v_mul_f32 v161, v161, v24
v_mfma_f32_16x16x32_bf16 v[216:219], a[244:247], a[216:219], v[216:219]
s_add_u32 s28, s28, 7168
v_mul_f32 v165, v165, v25
v_mul_f32 v169, v169, v26
v_mfma_f32_16x16x32_bf16 v[220:223], a[244:247], a[220:223], v[220:223]
s_waitcnt lgkmcnt(1)
v_mul_f32 v173, v173, v27
v_cvt_pk_bf16_f32 v122, v161, v165
v_mfma_f32_16x16x32_bf16 v[176:179], a[248:251], a[16:19], v[176:179]
s_addc_u32 s29, s29, 0
ds_read_b128 a[240:243], v17 offset:30720
v_cvt_pk_bf16_f32 v123, v169, v173
v_mfma_f32_16x16x32_bf16 v[180:183], a[248:251], a[20:23], v[180:183]
buffer_store_dwordx2 v[122:123], v18, s[28:31], 0 offen nt
v_mul_f32 v162, v162, v24
v_mfma_f32_16x16x32_bf16 v[184:187], a[248:251], a[24:27], v[184:187]
s_add_u32 s28, s28, 7168
v_mul_f32 v166, v166, v25
v_mul_f32 v170, v170, v26
v_mfma_f32_16x16x32_bf16 v[188:191], a[248:251], a[28:31], v[188:191]
s_waitcnt lgkmcnt(1)
v_mul_f32 v174, v174, v27
v_cvt_pk_bf16_f32 v124, v162, v166
v_mfma_f32_16x16x32_bf16 v[192:195], a[252:255], a[0:3], v[192:195]
s_addc_u32 s29, s29, 0
ds_read_b128 a[244:247], v15 offset:47104
v_cvt_pk_bf16_f32 v125, v170, v174
v_mfma_f32_16x16x32_bf16 v[196:199], a[252:255], a[4:7], v[196:199]
buffer_store_dwordx2 v[124:125], v18, s[28:31], 0 offen nt
v_mul_f32 v163, v163, v24
v_mfma_f32_16x16x32_bf16 v[200:203], a[252:255], a[8:11], v[200:203]
s_add_u32 s28, s28, 7168
v_mul_f32 v167, v167, v25
v_mul_f32 v171, v171, v26
v_mfma_f32_16x16x32_bf16 v[204:207], a[252:255], a[12:15], v[204:207]
s_waitcnt lgkmcnt(1)
v_mul_f32 v175, v175, v27
v_cvt_pk_bf16_f32 v126, v163, v167
v_mfma_f32_16x16x32_bf16 v[240:243], a[240:243], a[96:99], v[240:243]
s_addc_u32 s29, s29, 0
ds_read_b128 a[248:251], v15 offset:49152
v_cvt_pk_bf16_f32 v127, v171, v175
v_mfma_f32_16x16x32_bf16 v[244:247], a[240:243], a[100:103], v[244:247]
buffer_store_dwordx2 v[126:127], v18, s[28:31], 0 offen nt
v_mfma_f32_16x16x32_bf16 v[248:251], a[240:243], a[104:107], v[248:251]
v_mfma_f32_16x16x32_bf16 v[252:255], a[240:243], a[108:111], v[252:255]
s_waitcnt lgkmcnt(1)
v_mul_f32 v176, v176, v24
v_mul_f32 v180, v180, v25
v_mfma_f32_16x16x32_bf16 v[208:211], a[244:247], a[224:227], v[208:211]
s_add_u32 s28, s28, 93184
ds_read_b128 a[252:255], v15 offset:53248
v_mul_f32 v184, v184, v26
v_mfma_f32_16x16x32_bf16 v[212:215], a[244:247], a[228:231], v[212:215]
s_addc_u32 s29, s29, 0
v_mul_f32 v188, v188, v27
v_cvt_pk_bf16_f32 v120, v176, v180
v_mfma_f32_16x16x32_bf16 v[216:219], a[244:247], a[232:235], v[216:219]
v_cvt_pk_bf16_f32 v121, v184, v188
v_mfma_f32_16x16x32_bf16 v[220:223], a[244:247], a[236:239], v[220:223]
s_waitcnt lgkmcnt(1)
v_mfma_f32_16x16x32_bf16 v[224:227], a[248:251], a[192:195], v[224:227]
ds_read_b128 a[240:243], v14 offset:55296
v_mfma_f32_16x16x32_bf16 v[228:231], a[248:251], a[196:199], v[228:231]
buffer_store_dwordx2 v[120:121], v18, s[28:31], 0 offen nt
v_mul_f32 v177, v177, v24
v_mfma_f32_16x16x32_bf16 v[232:235], a[248:251], a[200:203], v[232:235]
s_add_u32 s28, s28, 7168
v_mul_f32 v181, v181, v25
v_mul_f32 v185, v185, v26
v_mfma_f32_16x16x32_bf16 v[236:239], a[248:251], a[204:207], v[236:239]
s_waitcnt lgkmcnt(1)
v_mul_f32 v189, v189, v27
v_cvt_pk_bf16_f32 v122, v177, v181
v_mfma_f32_16x16x32_bf16 v[192:195], a[252:255], a[16:19], v[192:195]
s_addc_u32 s29, s29, 0
ds_read_b128 a[244:247], v14 offset:57344
v_cvt_pk_bf16_f32 v123, v185, v189
v_mfma_f32_16x16x32_bf16 v[196:199], a[252:255], a[20:23], v[196:199]
buffer_store_dwordx2 v[122:123], v18, s[28:31], 0 offen nt
v_mul_f32 v178, v178, v24
v_mfma_f32_16x16x32_bf16 v[200:203], a[252:255], a[24:27], v[200:203]
s_add_u32 s28, s28, 7168
v_mul_f32 v182, v182, v25
v_mul_f32 v186, v186, v26
v_mfma_f32_16x16x32_bf16 v[204:207], a[252:255], a[28:31], v[204:207]
s_waitcnt lgkmcnt(1)
v_mul_f32 v190, v190, v27
v_cvt_pk_bf16_f32 v124, v178, v182
v_mfma_f32_16x16x32_bf16 v[208:211], a[240:243], a[0:3], v[208:211]
s_addc_u32 s29, s29, 0
ds_read_b128 a[248:251], v14 offset:18432
v_cvt_pk_bf16_f32 v125, v186, v190
v_mfma_f32_16x16x32_bf16 v[212:215], a[240:243], a[4:7], v[212:215]
buffer_store_dwordx2 v[124:125], v18, s[28:31], 0 offen nt
v_mul_f32 v179, v179, v24
v_mfma_f32_16x16x32_bf16 v[216:219], a[240:243], a[8:11], v[216:219]
s_add_u32 s28, s28, 7168
v_mul_f32 v183, v183, v25
v_mul_f32 v187, v187, v26
v_mfma_f32_16x16x32_bf16 v[220:223], a[240:243], a[12:15], v[220:223]
s_waitcnt lgkmcnt(1)
v_mul_f32 v191, v191, v27
v_cvt_pk_bf16_f32 v126, v179, v183
v_mfma_f32_16x16x32_bf16 v[224:227], a[244:247], a[208:211], v[224:227]
s_addc_u32 s29, s29, 0
ds_read_b128 a[252:255], v15 offset:55296
v_cvt_pk_bf16_f32 v127, v187, v191
v_mfma_f32_16x16x32_bf16 v[228:231], a[244:247], a[212:215], v[228:231]
buffer_store_dwordx2 v[126:127], v18, s[28:31], 0 offen nt
v_mfma_f32_16x16x32_bf16 v[232:235], a[244:247], a[216:219], v[232:235]
v_mfma_f32_16x16x32_bf16 v[236:239], a[244:247], a[220:223], v[236:239]
s_waitcnt lgkmcnt(1)
v_mul_f32 v192, v192, v24
v_mul_f32 v196, v196, v25
v_mfma_f32_16x16x32_bf16 v[240:243], a[248:251], a[112:115], v[240:243]
s_add_u32 s28, s28, 93184
ds_read_b128 a[240:243], v15 offset:57344
v_mul_f32 v200, v200, v26
v_mfma_f32_16x16x32_bf16 v[244:247], a[248:251], a[116:119], v[244:247]
s_addc_u32 s29, s29, 0
v_mul_f32 v204, v204, v27
v_cvt_pk_bf16_f32 v120, v192, v196
v_mfma_f32_16x16x32_bf16 v[248:251], a[248:251], a[120:123], v[248:251]
v_cvt_pk_bf16_f32 v121, v200, v204
v_mfma_f32_16x16x32_bf16 v[252:255], a[248:251], a[124:127], v[252:255]
s_waitcnt lgkmcnt(1)
v_mfma_f32_16x16x32_bf16 v[208:211], a[252:255], a[16:19], v[208:211]
ds_read_b128 a[244:247], v14 offset:61440
v_mfma_f32_16x16x32_bf16 v[212:215], a[252:255], a[20:23], v[212:215]
buffer_store_dwordx2 v[120:121], v18, s[28:31], 0 offen nt
v_mul_f32 v193, v193, v24
v_mfma_f32_16x16x32_bf16 v[216:219], a[252:255], a[24:27], v[216:219]
s_add_u32 s28, s28, 7168
v_mul_f32 v197, v197, v25
v_mul_f32 v201, v201, v26
v_mfma_f32_16x16x32_bf16 v[220:223], a[252:255], a[28:31], v[220:223]
s_waitcnt lgkmcnt(1)
v_mul_f32 v205, v205, v27
v_cvt_pk_bf16_f32 v122, v193, v197
v_mfma_f32_16x16x32_bf16 v[224:227], a[240:243], a[224:227], v[224:227]
s_addc_u32 s29, s29, 0
ds_read_b128 a[248:251], v15 offset:18432
v_cvt_pk_bf16_f32 v123, v201, v205
v_mfma_f32_16x16x32_bf16 v[228:231], a[240:243], a[228:231], v[228:231]
buffer_store_dwordx2 v[122:123], v18, s[28:31], 0 offen nt
v_mul_f32 v194, v194, v24
v_mfma_f32_16x16x32_bf16 v[232:235], a[240:243], a[232:235], v[232:235]
s_add_u32 s28, s28, 7168
v_mul_f32 v198, v198, v25
v_mul_f32 v202, v202, v26
v_mfma_f32_16x16x32_bf16 v[236:239], a[240:243], a[236:239], v[236:239]
s_waitcnt lgkmcnt(1)
v_mul_f32 v206, v206, v27
v_cvt_pk_bf16_f32 v124, v194, v198
v_mfma_f32_16x16x32_bf16 v[224:227], a[244:247], a[0:3], v[224:227]
s_addc_u32 s29, s29, 0
ds_read_b128 a[252:255], v15 offset:61440
v_cvt_pk_bf16_f32 v125, v202, v206
v_mfma_f32_16x16x32_bf16 v[228:231], a[244:247], a[4:7], v[228:231]
buffer_store_dwordx2 v[124:125], v18, s[28:31], 0 offen nt
v_mul_f32 v195, v195, v24
v_mfma_f32_16x16x32_bf16 v[232:235], a[244:247], a[8:11], v[232:235]
s_add_u32 s28, s28, 7168
v_mul_f32 v199, v199, v25
v_mul_f32 v203, v203, v26
v_mfma_f32_16x16x32_bf16 v[236:239], a[244:247], a[12:15], v[236:239]
s_waitcnt lgkmcnt(1)
v_mul_f32 v207, v207, v27
v_cvt_pk_bf16_f32 v126, v195, v199
v_mfma_f32_16x16x32_bf16 v[240:243], a[248:251], a[128:131], v[240:243]
s_addc_u32 s29, s29, 0
ds_read_b128 a[240:243], v14 offset:38912
v_cvt_pk_bf16_f32 v127, v203, v207
v_mfma_f32_16x16x32_bf16 v[244:247], a[248:251], a[132:135], v[244:247]
buffer_store_dwordx2 v[126:127], v18, s[28:31], 0 offen nt
v_mul_f32 v208, v208, v24
v_mfma_f32_16x16x32_bf16 v[248:251], a[248:251], a[136:139], v[248:251]
s_add_u32 s28, s28, 93184
v_mul_f32 v212, v212, v25
v_mul_f32 v216, v216, v26
v_mfma_f32_16x16x32_bf16 v[252:255], a[248:251], a[140:143], v[252:255]
s_waitcnt lgkmcnt(1)
v_mul_f32 v220, v220, v27
v_cvt_pk_bf16_f32 v120, v208, v212
v_mfma_f32_16x16x32_bf16 v[224:227], a[252:255], a[16:19], v[224:227]
s_addc_u32 s29, s29, 0
ds_read_b128 a[244:247], v15 offset:38912
v_cvt_pk_bf16_f32 v121, v216, v220
v_mfma_f32_16x16x32_bf16 v[228:231], a[252:255], a[20:23], v[228:231]
buffer_store_dwordx2 v[120:121], v18, s[28:31], 0 offen nt
v_mul_f32 v209, v209, v24
v_mfma_f32_16x16x32_bf16 v[232:235], a[252:255], a[24:27], v[232:235]
s_add_u32 s28, s28, 7168
v_mul_f32 v213, v213, v25
v_mul_f32 v217, v217, v26
v_mfma_f32_16x16x32_bf16 v[236:239], a[252:255], a[28:31], v[236:239]
s_waitcnt lgkmcnt(1)
v_mul_f32 v221, v221, v27
v_cvt_pk_bf16_f32 v122, v209, v213
v_mfma_f32_16x16x32_bf16 v[240:243], a[240:243], a[144:147], v[240:243]
s_addc_u32 s29, s29, 0
ds_read_b128 a[248:251], v14 offset:51200
v_cvt_pk_bf16_f32 v123, v217, v221
v_mfma_f32_16x16x32_bf16 v[244:247], a[240:243], a[148:151], v[244:247]
buffer_store_dwordx2 v[122:123], v18, s[28:31], 0 offen nt
v_mul_f32 v210, v210, v24
v_mfma_f32_16x16x32_bf16 v[248:251], a[240:243], a[152:155], v[248:251]
s_add_u32 s28, s28, 7168
v_mul_f32 v214, v214, v25
v_mul_f32 v218, v218, v26
v_mfma_f32_16x16x32_bf16 v[252:255], a[240:243], a[156:159], v[252:255]
s_waitcnt lgkmcnt(1)
v_mul_f32 v222, v222, v27
v_cvt_pk_bf16_f32 v124, v210, v214
v_mfma_f32_16x16x32_bf16 v[240:243], a[244:247], a[160:163], v[240:243]
s_addc_u32 s29, s29, 0
ds_read_b128 a[252:255], v15 offset:51200
v_cvt_pk_bf16_f32 v125, v218, v222
v_mfma_f32_16x16x32_bf16 v[244:247], a[244:247], a[164:167], v[244:247]
buffer_store_dwordx2 v[124:125], v18, s[28:31], 0 offen nt
v_mul_f32 v211, v211, v24
v_mfma_f32_16x16x32_bf16 v[248:251], a[244:247], a[168:171], v[248:251]
s_add_u32 s28, s28, 7168
v_mul_f32 v215, v215, v25
v_mul_f32 v219, v219, v26
v_mfma_f32_16x16x32_bf16 v[252:255], a[244:247], a[172:175], v[252:255]
s_waitcnt lgkmcnt(1)
v_mul_f32 v223, v223, v27
v_cvt_pk_bf16_f32 v126, v211, v215
v_mfma_f32_16x16x32_bf16 v[240:243], a[248:251], a[176:179], v[240:243]
s_addc_u32 s29, s29, 0
ds_read_b128 a[240:243], v14 offset:59392
v_cvt_pk_bf16_f32 v127, v219, v223
v_mfma_f32_16x16x32_bf16 v[244:247], a[248:251], a[180:183], v[244:247]
buffer_store_dwordx2 v[126:127], v18, s[28:31], 0 offen nt
v_mul_f32 v224, v224, v24
v_mfma_f32_16x16x32_bf16 v[248:251], a[248:251], a[184:187], v[248:251]
s_add_u32 s28, s28, 93184
v_mul_f32 v228, v228, v25
v_mul_f32 v232, v232, v26
v_mfma_f32_16x16x32_bf16 v[252:255], a[248:251], a[188:191], v[252:255]
s_waitcnt lgkmcnt(1)
v_mul_f32 v236, v236, v27
v_cvt_pk_bf16_f32 v120, v224, v228
v_mfma_f32_16x16x32_bf16 v[240:243], a[252:255], a[192:195], v[240:243]
s_addc_u32 s29, s29, 0
ds_read_b128 a[244:247], v15 offset:59392
v_cvt_pk_bf16_f32 v121, v232, v236
v_mfma_f32_16x16x32_bf16 v[244:247], a[252:255], a[196:199], v[244:247]
buffer_store_dwordx2 v[120:121], v18, s[28:31], 0 offen nt
v_mul_f32 v225, v225, v24
v_mfma_f32_16x16x32_bf16 v[248:251], a[252:255], a[200:203], v[248:251]
s_add_u32 s28, s28, 7168
v_mul_f32 v229, v229, v25
v_mul_f32 v233, v233, v26
v_mfma_f32_16x16x32_bf16 v[252:255], a[252:255], a[204:207], v[252:255]
s_waitcnt lgkmcnt(1)
v_mul_f32 v237, v237, v27
v_cvt_pk_bf16_f32 v122, v225, v229
v_mfma_f32_16x16x32_bf16 v[240:243], a[240:243], a[208:211], v[240:243]
s_addc_u32 s29, s29, 0
ds_read_b128 a[248:251], v14 offset:63488
v_cvt_pk_bf16_f32 v123, v233, v237
v_mfma_f32_16x16x32_bf16 v[244:247], a[240:243], a[212:215], v[244:247]
buffer_store_dwordx2 v[122:123], v18, s[28:31], 0 offen nt
v_mul_f32 v226, v226, v24
v_mfma_f32_16x16x32_bf16 v[248:251], a[240:243], a[216:219], v[248:251]
s_add_u32 s28, s28, 7168
v_mul_f32 v230, v230, v25
v_mul_f32 v234, v234, v26
v_mfma_f32_16x16x32_bf16 v[252:255], a[240:243], a[220:223], v[252:255]
s_waitcnt lgkmcnt(1)
v_mul_f32 v238, v238, v27
v_cvt_pk_bf16_f32 v124, v226, v230
v_mfma_f32_16x16x32_bf16 v[240:243], a[244:247], a[224:227], v[240:243]
s_addc_u32 s29, s29, 0
ds_read_b128 a[252:255], v15 offset:63488
v_cvt_pk_bf16_f32 v125, v234, v238
v_mfma_f32_16x16x32_bf16 v[244:247], a[244:247], a[228:231], v[244:247]
buffer_store_dwordx2 v[124:125], v18, s[28:31], 0 offen nt
v_mul_f32 v227, v227, v24
v_mfma_f32_16x16x32_bf16 v[248:251], a[244:247], a[232:235], v[248:251]
s_add_u32 s28, s28, 7168
v_mul_f32 v231, v231, v25
v_mul_f32 v235, v235, v26
v_mfma_f32_16x16x32_bf16 v[252:255], a[244:247], a[236:239], v[252:255]
s_waitcnt lgkmcnt(1)
v_mul_f32 v239, v239, v27
v_cvt_pk_bf16_f32 v126, v227, v231
v_mfma_f32_16x16x32_bf16 v[240:243], a[248:251], a[0:3], v[240:243]
s_addc_u32 s29, s29, 0
v_cvt_pk_bf16_f32 v127, v235, v239
v_mfma_f32_16x16x32_bf16 v[244:247], a[248:251], a[4:7], v[244:247]
buffer_store_dwordx2 v[126:127], v18, s[28:31], 0 offen nt
v_mfma_f32_16x16x32_bf16 v[248:251], a[248:251], a[8:11], v[248:251]
v_mfma_f32_16x16x32_bf16 v[252:255], a[248:251], a[12:15], v[252:255]
s_waitcnt lgkmcnt(0)
v_mfma_f32_16x16x32_bf16 v[240:243], a[252:255], a[16:19], v[240:243]
v_mfma_f32_16x16x32_bf16 v[244:247], a[252:255], a[20:23], v[244:247]
v_mfma_f32_16x16x32_bf16 v[248:251], a[252:255], a[24:27], v[248:251]
v_mfma_f32_16x16x32_bf16 v[252:255], a[252:255], a[28:31], v[252:255]
s_nop 7
v_pk_mul_f32 v[240:241], v[240:241], v[24:25] op_sel:[0,0] op_sel_hi:[1,0]
v_pk_mul_f32 v[244:245], v[244:245], v[24:25] op_sel:[0,1] op_sel_hi:[1,1]
v_pk_mul_f32 v[248:249], v[248:249], v[26:27] op_sel:[0,0] op_sel_hi:[1,0]
v_pk_mul_f32 v[252:253], v[252:253], v[26:27] op_sel:[0,1] op_sel_hi:[1,1]
v_cvt_pk_bf16_f32 v120, v240, v244
v_cvt_pk_bf16_f32 v121, v248, v252
s_add_u32 s28, s28, 93184
s_addc_u32 s29, s29, 0
buffer_store_dwordx2 v[120:121], v18, s[28:31], 0 offen nt
v_cvt_pk_bf16_f32 v122, v241, v245
v_cvt_pk_bf16_f32 v123, v249, v253
s_add_u32 s28, s28, 7168
s_addc_u32 s29, s29, 0
buffer_store_dwordx2 v[122:123], v18, s[28:31], 0 offen nt
v_pk_mul_f32 v[242:243], v[242:243], v[24:25] op_sel:[0,0] op_sel_hi:[1,0]
v_pk_mul_f32 v[246:247], v[246:247], v[24:25] op_sel:[0,1] op_sel_hi:[1,1]
v_pk_mul_f32 v[250:251], v[250:251], v[26:27] op_sel:[0,0] op_sel_hi:[1,0]
v_pk_mul_f32 v[254:255], v[254:255], v[26:27] op_sel:[0,1] op_sel_hi:[1,1]
v_cvt_pk_bf16_f32 v124, v242, v246
v_cvt_pk_bf16_f32 v125, v250, v254
s_add_u32 s28, s28, 7168
s_addc_u32 s29, s29, 0
buffer_store_dwordx2 v[124:125], v18, s[28:31], 0 offen nt
v_cvt_pk_bf16_f32 v126, v243, v247
v_cvt_pk_bf16_f32 v127, v251, v255
s_add_u32 s28, s28, 7168
s_addc_u32 s29, s29, 0
buffer_store_dwordx2 v[126:127], v18, s[28:31], 0 offen nt
s_endpgm
L_NOTAG:
buffer_load_dwordx2 v[22:23], off, s[80:83], 0 sc1
s_waitcnt vmcnt(0)
v_readfirstlane_b32 s88, v22
v_readfirstlane_b32 s89, v23
s_sub_u32 s90, s90, 1
s_nop 0
s_cmp_eq_u64 s[88:89], 0
s_cbranch_scc0 L_TAGOK
s_cmp_gt_i32 s90, 0
s_cbranch_scc1 L_NOTAG
s_mov_b32 s26, 0
s_mov_b32 s78, 0
s_mov_b64 s[88:89], 1
s_branch L_TAGOK
.p2align 6
L_PADS:
s_cbranch_vccnz L_PADRET
L_TRY:
s_waitcnt vmcnt(0)
v_cmp_ne_u64 s[50:51], s[88:89], v[122:123]
v_cmp_ne_u64 s[44:45], s[88:89], v[126:127]
s_sub_u32 s90, s90, 1
s_nop 0
s_or_b64 s[50:51], s[44:45], s[50:51]
s_cbranch_scc0 L_WRET
s_cmp_gt_i32 s90, 0
s_cbranch_scc0 L_SELF
L_WRET:
s_setpc_b64 s[100:101]
L_SLOW2:
s_lshr_b32 s91, s41, 6
s_add_u32 s91, s91, 0
s_lshl_b32 s47, s91, 11
buffer_load_dwordx4 v[120:123], v13, s[24:27], s47 offen offset:0 sc1
buffer_load_dwordx4 v[124:127], v13, s[24:27], s47 offen offset:1024 sc1
s_lshr_b32 s47, s41, 6
s_add_u32 s47, s47, 1
s_lshl_b32 s47, s47, 11
buffer_load_dwordx4 v[40:43], v13, s[24:27], s47 offen offset:0 sc1
buffer_load_dwordx4 v[44:47], v13, s[24:27], s47 offen offset:1024 sc1
s_lshr_b32 s47, s42, 6
s_add_u32 s47, s47, 0
s_lshl_b32 s47, s47, 11
buffer_load_dwordx4 v[48:51], v13, s[24:27], s47 offen offset:0 sc1
buffer_load_dwordx4 v[52:55], v13, s[24:27], s47 offen offset:1024 sc1
s_call_b64 s[100:101], L_TRY
s_cbranch_scc1 L_SLOW2
v_mov_b64 v[32:33], v[120:121]
v_mov_b64 v[36:37], v[124:125]
s_branch L_BACK2
L_SLOW3:
s_lshr_b32 s91, s41, 6
s_add_u32 s91, s91, 1
s_lshl_b32 s47, s91, 11
buffer_load_dwordx4 v[120:123], v13, s[24:27], s47 offen offset:0 sc1
buffer_load_dwordx4 v[124:127], v13, s[24:27], s47 offen offset:1024 sc1
s_lshr_b32 s47, s42, 6
s_add_u32 s47, s47, 0
s_lshl_b32 s47, s47, 11
buffer_load_dwordx4 v[48:51], v13, s[24:27], s47 offen offset:0 sc1
buffer_load_dwordx4 v[52:55], v13, s[24:27], s47 offen offset:1024 sc1
s_lshr_b32 s47, s42, 6
s_add_u32 s47, s47, 1
s_lshl_b32 s47, s47, 11
buffer_load_dwordx4 v[96:99], v13, s[24:27], s47 offen offset:0 sc1
buffer_load_dwordx4 v[100:103], v13, s[24:27], s47 offen offset:1024 sc1
s_call_b64 s[100:101], L_TRY
s_cbranch_scc1 L_SLOW3
v_mov_b64 v[40:41], v[120:121]
v_mov_b64 v[44:45], v[124:125]
s_branch L_BACK3
L_SLOW4:
s_lshr_b32 s91, s42, 6
s_add_u32 s91, s91, 0
s_lshl_b32 s47, s91, 11
buffer_load_dwordx4 v[120:123], v13, s[24:27], s47 offen offset:0 sc1
buffer_load_dwordx4 v[124:127], v13, s[24:27], s47 offen offset:1024 sc1
s_lshr_b32 s47, s42, 6
s_add_u32 s47, s47, 1
s_lshl_b32 s47, s47, 11
buffer_load_dwordx4 v[96:99], v13, s[24:27], s47 offen offset:0 sc1
buffer_load_dwordx4 v[100:103], v13, s[24:27], s47 offen offset:1024 sc1
s_lshr_b32 s47, s43, 6
s_add_u32 s47, s47, 0
s_lshl_b32 s47, s47, 11
buffer_load_dwordx4 v[80:83], v13, s[24:27], s47 offen offset:0 sc1
buffer_load_dwordx4 v[84:87], v13, s[24:27], s47 offen offset:1024 sc1
s_call_b64 s[100:101], L_TRY
s_cbranch_scc1 L_SLOW4
v_mov_b64 v[48:49], v[120:121]
v_mov_b64 v[52:53], v[124:125]
s_branch L_BACK4
L_SLOW5:
s_lshr_b32 s91, s42, 6
s_add_u32 s91, s91, 1
s_lshl_b32 s47, s91, 11
buffer_load_dwordx4 v[120:123], v13, s[24:27], s47 offen offset:0 sc1
buffer_load_dwordx4 v[124:127], v13, s[24:27], s47 offen offset:1024 sc1
s_lshr_b32 s47, s43, 6
s_add_u32 s47, s47, 0
s_lshl_b32 s47, s47, 11
buffer_load_dwordx4 v[80:83], v13, s[24:27], s47 offen offset:0 sc1
buffer_load_dwordx4 v[84:87], v13, s[24:27], s47 offen offset:1024 sc1
s_lshr_b32 s47, s43, 6
s_add_u32 s47, s47, 1
s_lshl_b32 s47, s47, 11
buffer_load_dwordx4 v[88:91], v13, s[24:27], s47 offen offset:0 sc1
buffer_load_dwordx4 v[92:95], v13, s[24:27], s47 offen offset:1024 sc1
s_call_b64 s[100:101], L_TRY
s_cbranch_scc1 L_SLOW5
v_mov_b64 v[96:97], v[120:121]
v_mov_b64 v[100:101], v[124:125]
s_branch L_BACK5
L_SLOW6:
s_lshr_b32 s91, s43, 6
s_add_u32 s91, s91, 0
s_lshl_b32 s47, s91, 11
buffer_load_dwordx4 v[120:123], v13, s[24:27], s47 offen offset:0 sc1
buffer_load_dwordx4 v[124:127], v13, s[24:27], s47 offen offset:1024 sc1
s_lshr_b32 s47, s43, 6
s_add_u32 s47, s47, 1
s_lshl_b32 s47, s47, 11
buffer_load_dwordx4 v[88:91], v13, s[24:27], s47 offen offset:0 sc1
buffer_load_dwordx4 v[92:95], v13, s[24:27], s47 offen offset:1024 sc1
s_movk_i32 s47, 8
s_lshl_b32 s47, s47, 11
buffer_load_dwordx4 v[32:35], v13, s[24:27], s47 offen offset:0 sc1
buffer_load_dwordx4 v[36:39], v13, s[24:27], s47 offen offset:1024 sc1
s_call_b64 s[100:101], L_TRY
s_cbranch_scc1 L_SLOW6
v_mov_b64 v[80:81], v[120:121]
v_mov_b64 v[84:85], v[124:125]
s_branch L_BACK6
L_SLOW7:
s_lshr_b32 s91, s43, 6
s_add_u32 s91, s91, 1
s_lshl_b32 s47, s91, 11
buffer_load_dwordx4 v[120:123], v13, s[24:27], s47 offen offset:0 sc1
buffer_load_dwordx4 v[124:127], v13, s[24:27], s47 offen offset:1024 sc1
s_movk_i32 s47, 8
s_lshl_b32 s47, s47, 11
buffer_load_dwordx4 v[32:35], v13, s[24:27], s47 offen offset:0 sc1
buffer_load_dwordx4 v[36:39], v13, s[24:27], s47 offen offset:1024 sc1
s_movk_i32 s47, 9
s_lshl_b32 s47, s47, 11
buffer_load_dwordx4 v[40:43], v13, s[24:27], s47 offen offset:0 sc1
buffer_load_dwordx4 v[44:47], v13, s[24:27], s47 offen offset:1024 sc1
s_call_b64 s[100:101], L_TRY
s_cbranch_scc1 L_SLOW7
v_mov_b64 v[88:89], v[120:121]
v_mov_b64 v[92:93], v[124:125]
s_branch L_BACK7
L_SLOW8:
s_movk_i32 s91, 8
s_lshl_b32 s47, s91, 11
buffer_load_dwordx4 v[120:123], v13, s[24:27], s47 offen offset:0 sc1
buffer_load_dwordx4 v[124:127], v13, s[24:27], s47 offen offset:1024 sc1
s_movk_i32 s47, 9
s_lshl_b32 s47, s47, 11
buffer_load_dwordx4 v[40:43], v13, s[24:27], s47 offen offset:0 sc1
buffer_load_dwordx4 v[44:47], v13, s[24:27], s47 offen offset:1024 sc1
s_movk_i32 s47, 10
s_lshl_b32 s47, s47, 11
buffer_load_dwordx4 v[48:51], v13, s[24:27], s47 offen offset:0 sc1
buffer_load_dwordx4 v[52:55], v13, s[24:27], s47 offen offset:1024 sc1
s_call_b64 s[100:101], L_TRY
s_cbranch_scc1 L_SLOW8
v_mov_b64 v[32:33], v[120:121]
v_mov_b64 v[36:37], v[124:125]
s_branch L_BACK8
L_SLOW9:
s_movk_i32 s91, 9
s_lshl_b32 s47, s91, 11
buffer_load_dwordx4 v[120:123], v13, s[24:27], s47 offen offset:0 sc1
buffer_load_dwordx4 v[124:127], v13, s[24:27], s47 offen offset:1024 sc1
s_movk_i32 s47, 10
s_lshl_b32 s47, s47, 11
buffer_load_dwordx4 v[48:51], v13, s[24:27], s47 offen offset:0 sc1
buffer_load_dwordx4 v[52:55], v13, s[24:27], s47 offen offset:1024 sc1
s_movk_i32 s47, 11
s_lshl_b32 s47, s47, 11
buffer_load_dwordx4 v[96:99], v13, s[24:27], s47 offen offset:0 sc1
buffer_load_dwordx4 v[100:103], v13, s[24:27], s47 offen offset:1024 sc1
s_call_b64 s[100:101], L_TRY
s_cbranch_scc1 L_SLOW9
v_mov_b64 v[40:41], v[120:121]
v_mov_b64 v[44:45], v[124:125]
s_branch L_BACK9
L_SLOW10:
s_movk_i32 s91, 10
s_lshl_b32 s47, s91, 11
buffer_load_dwordx4 v[120:123], v13, s[24:27], s47 offen offset:0 sc1
buffer_load_dwordx4 v[124:127], v13, s[24:27], s47 offen offset:1024 sc1
s_movk_i32 s47, 11
s_lshl_b32 s47, s47, 11
buffer_load_dwordx4 v[96:99], v13, s[24:27], s47 offen offset:0 sc1
buffer_load_dwordx4 v[100:103], v13, s[24:27], s47 offen offset:1024 sc1
s_movk_i32 s47, 12
s_lshl_b32 s47, s47, 11
buffer_load_dwordx4 v[80:83], v13, s[24:27], s47 offen offset:0 sc1
buffer_load_dwordx4 v[84:87], v13, s[24:27], s47 offen offset:1024 sc1
s_call_b64 s[100:101], L_TRY
s_cbranch_scc1 L_SLOW10
v_mov_b64 v[48:49], v[120:121]
v_mov_b64 v[52:53], v[124:125]
s_branch L_BACK10
L_SLOW11:
s_movk_i32 s91, 11
s_lshl_b32 s47, s91, 11
buffer_load_dwordx4 v[120:123], v13, s[24:27], s47 offen offset:0 sc1
buffer_load_dwordx4 v[124:127], v13, s[24:27], s47 offen offset:1024 sc1
s_movk_i32 s47, 12
s_lshl_b32 s47, s47, 11
buffer_load_dwordx4 v[80:83], v13, s[24:27], s47 offen offset:0 sc1
buffer_load_dwordx4 v[84:87], v13, s[24:27], s47 offen offset:1024 sc1
s_movk_i32 s47, 13
s_lshl_b32 s47, s47, 11
buffer_load_dwordx4 v[88:91], v13, s[24:27], s47 offen offset:0 sc1
buffer_load_dwordx4 v[92:95], v13, s[24:27], s47 offen offset:1024 sc1
s_call_b64 s[100:101], L_TRY
s_cbranch_scc1 L_SLOW11
v_mov_b64 v[96:97], v[120:121]
v_mov_b64 v[100:101], v[124:125]
s_branch L_BACK11
L_SLOW12:
s_movk_i32 s91, 12
s_lshl_b32 s47, s91, 11
buffer_load_dwordx4 v[120:123], v13, s[24:27], s47 offen offset:0 sc1
buffer_load_dwordx4 v[124:127], v13, s[24:27], s47 offen offset:1024 sc1
s_movk_i32 s47, 13
s_lshl_b32 s47, s47, 11
buffer_load_dwordx4 v[88:91], v13, s[24:27], s47 offen offset:0 sc1
buffer_load_dwordx4 v[92:95], v13, s[24:27], s47 offen offset:1024 sc1
s_movk_i32 s47, 14
s_lshl_b32 s47, s47, 11
buffer_load_dwordx4 v[32:35], v13, s[24:27], s47 offen offset:0 sc1
buffer_load_dwordx4 v[36:39], v13, s[24:27], s47 offen offset:1024 sc1
s_call_b64 s[100:101], L_TRY
s_cbranch_scc1 L_SLOW12
v_mov_b64 v[80:81], v[120:121]
v_mov_b64 v[84:85], v[124:125]
s_branch L_BACK12
L_SLOW13:
s_movk_i32 s91, 13
s_lshl_b32 s47, s91, 11
buffer_load_dwordx4 v[120:123], v13, s[24:27], s47 offen offset:0 sc1
buffer_load_dwordx4 v[124:127], v13, s[24:27], s47 offen offset:1024 sc1
s_movk_i32 s47, 14
s_lshl_b32 s47, s47, 11
buffer_load_dwordx4 v[32:35], v13, s[24:27], s47 offen offset:0 sc1
buffer_load_dwordx4 v[36:39], v13, s[24:27], s47 offen offset:1024 sc1
s_movk_i32 s47, 15
s_lshl_b32 s47, s47, 11
buffer_load_dwordx4 v[40:43], v13, s[24:27], s47 offen offset:0 sc1
buffer_load_dwordx4 v[44:47], v13, s[24:27], s47 offen offset:1024 sc1
s_call_b64 s[100:101], L_TRY
s_cbranch_scc1 L_SLOW13
v_mov_b64 v[88:89], v[120:121]
v_mov_b64 v[92:93], v[124:125]
s_branch L_BACK13
L_SLOW14:
s_movk_i32 s91, 14
s_lshl_b32 s47, s91, 11
buffer_load_dwordx4 v[120:123], v13, s[24:27], s47 offen offset:0 sc1
buffer_load_dwordx4 v[124:127], v13, s[24:27], s47 offen offset:1024 sc1
s_movk_i32 s47, 15
s_lshl_b32 s47, s47, 11
buffer_load_dwordx4 v[40:43], v13, s[24:27], s47 offen offset:0 sc1
buffer_load_dwordx4 v[44:47], v13, s[24:27], s47 offen offset:1024 sc1
s_movk_i32 s47, 16
s_lshl_b32 s47, s47, 11
buffer_load_dwordx4 v[48:51], v13, s[24:27], s47 offen offset:0 sc1
buffer_load_dwordx4 v[52:55], v13, s[24:27], s47 offen offset:1024 sc1
s_call_b64 s[100:101], L_TRY
s_cbranch_scc1 L_SLOW14
v_mov_b64 v[32:33], v[120:121]
v_mov_b64 v[36:37], v[124:125]
s_branch L_BACK14
L_SLOW15:
s_movk_i32 s91, 15
s_lshl_b32 s47, s91, 11
buffer_load_dwordx4 v[120:123], v13, s[24:27], s47 offen offset:0 sc1
buffer_load_dwordx4 v[124:127], v13, s[24:27], s47 offen offset:1024 sc1
s_movk_i32 s47, 16
s_lshl_b32 s47, s47, 11
buffer_load_dwordx4 v[48:51], v13, s[24:27], s47 offen offset:0 sc1
buffer_load_dwordx4 v[52:55], v13, s[24:27], s47 offen offset:1024 sc1
s_movk_i32 s47, 17
s_lshl_b32 s47, s47, 11
buffer_load_dwordx4 v[96:99], v13, s[24:27], s47 offen offset:0 sc1
buffer_load_dwordx4 v[100:103], v13, s[24:27], s47 offen offset:1024 sc1
s_call_b64 s[100:101], L_TRY
s_cbranch_scc1 L_SLOW15
v_mov_b64 v[40:41], v[120:121]
v_mov_b64 v[44:45], v[124:125]
s_branch L_BACK15
L_SLOW16:
s_movk_i32 s91, 16
s_lshl_b32 s47, s91, 11
buffer_load_dwordx4 v[120:123], v13, s[24:27], s47 offen offset:0 sc1
buffer_load_dwordx4 v[124:127], v13, s[24:27], s47 offen offset:1024 sc1
s_movk_i32 s47, 17
s_lshl_b32 s47, s47, 11
buffer_load_dwordx4 v[96:99], v13, s[24:27], s47 offen offset:0 sc1
buffer_load_dwordx4 v[100:103], v13, s[24:27], s47 offen offset:1024 sc1
s_movk_i32 s47, 18
s_lshl_b32 s47, s47, 11
buffer_load_dwordx4 v[80:83], v13, s[24:27], s47 offen offset:0 sc1
buffer_load_dwordx4 v[84:87], v13, s[24:27], s47 offen offset:1024 sc1
s_call_b64 s[100:101], L_TRY
s_cbranch_scc1 L_SLOW16
v_mov_b64 v[48:49], v[120:121]
v_mov_b64 v[52:53], v[124:125]
s_branch L_BACK16
L_SLOW17:
s_movk_i32 s91, 17
s_lshl_b32 s47, s91, 11
buffer_load_dwordx4 v[120:123], v13, s[24:27], s47 offen offset:0 sc1
buffer_load_dwordx4 v[124:127], v13, s[24:27], s47 offen offset:1024 sc1
s_movk_i32 s47, 18
s_lshl_b32 s47, s47, 11
buffer_load_dwordx4 v[80:83], v13, s[24:27], s47 offen offset:0 sc1
buffer_load_dwordx4 v[84:87], v13, s[24:27], s47 offen offset:1024 sc1
s_movk_i32 s47, 19
s_lshl_b32 s47, s47, 11
buffer_load_dwordx4 v[88:91], v13, s[24:27], s47 offen offset:0 sc1
buffer_load_dwordx4 v[92:95], v13, s[24:27], s47 offen offset:1024 sc1
s_call_b64 s[100:101], L_TRY
s_cbranch_scc1 L_SLOW17
v_mov_b64 v[96:97], v[120:121]
v_mov_b64 v[100:101], v[124:125]
s_branch L_BACK17
L_SLOW18:
s_movk_i32 s91, 18
s_lshl_b32 s47, s91, 11
buffer_load_dwordx4 v[120:123], v13, s[24:27], s47 offen offset:0 sc1
buffer_load_dwordx4 v[124:127], v13, s[24:27], s47 offen offset:1024 sc1
s_movk_i32 s47, 19
s_lshl_b32 s47, s47, 11
buffer_load_dwordx4 v[88:91], v13, s[24:27], s47 offen offset:0 sc1
buffer_load_dwordx4 v[92:95], v13, s[24:27], s47 offen offset:1024 sc1
s_movk_i32 s47, 20
s_lshl_b32 s47, s47, 11
buffer_load_dwordx4 v[32:35], v13, s[24:27], s47 offen offset:0 sc1
buffer_load_dwordx4 v[36:39], v13, s[24:27], s47 offen offset:1024 sc1
s_call_b64 s[100:101], L_TRY
s_cbranch_scc1 L_SLOW18
v_mov_b64 v[80:81], v[120:121]
v_mov_b64 v[84:85], v[124:125]
s_branch L_BACK18
L_SLOW19:
s_movk_i32 s91, 19
s_lshl_b32 s47, s91, 11
buffer_load_dwordx4 v[120:123], v13, s[24:27], s47 offen offset:0 sc1
buffer_load_dwordx4 v[124:127], v13, s[24:27], s47 offen offset:1024 sc1
s_movk_i32 s47, 20
s_lshl_b32 s47, s47, 11
buffer_load_dwordx4 v[32:35], v13, s[24:27], s47 offen offset:0 sc1
buffer_load_dwordx4 v[36:39], v13, s[24:27], s47 offen offset:1024 sc1
s_movk_i32 s47, 21
s_lshl_b32 s47, s47, 11
buffer_load_dwordx4 v[40:43], v13, s[24:27], s47 offen offset:0 sc1
buffer_load_dwordx4 v[44:47], v13, s[24:27], s47 offen offset:1024 sc1
s_call_b64 s[100:101], L_TRY
s_cbranch_scc1 L_SLOW19
v_mov_b64 v[88:89], v[120:121]
v_mov_b64 v[92:93], v[124:125]
s_branch L_BACK19
L_SLOW20:
s_movk_i32 s91, 20
s_lshl_b32 s47, s91, 11
buffer_load_dwordx4 v[120:123], v13, s[24:27], s47 offen offset:0 sc1
buffer_load_dwordx4 v[124:127], v13, s[24:27], s47 offen offset:1024 sc1
s_movk_i32 s47, 21
s_lshl_b32 s47, s47, 11
buffer_load_dwordx4 v[40:43], v13, s[24:27], s47 offen offset:0 sc1
buffer_load_dwordx4 v[44:47], v13, s[24:27], s47 offen offset:1024 sc1
s_movk_i32 s47, 22
s_lshl_b32 s47, s47, 11
buffer_load_dwordx4 v[48:51], v13, s[24:27], s47 offen offset:0 sc1
buffer_load_dwordx4 v[52:55], v13, s[24:27], s47 offen offset:1024 sc1
s_call_b64 s[100:101], L_TRY
s_cbranch_scc1 L_SLOW20
v_mov_b64 v[32:33], v[120:121]
v_mov_b64 v[36:37], v[124:125]
s_branch L_BACK20
L_SLOW21:
s_movk_i32 s91, 21
s_lshl_b32 s47, s91, 11
buffer_load_dwordx4 v[120:123], v13, s[24:27], s47 offen offset:0 sc1
buffer_load_dwordx4 v[124:127], v13, s[24:27], s47 offen offset:1024 sc1
s_movk_i32 s47, 22
s_lshl_b32 s47, s47, 11
buffer_load_dwordx4 v[48:51], v13, s[24:27], s47 offen offset:0 sc1
buffer_load_dwordx4 v[52:55], v13, s[24:27], s47 offen offset:1024 sc1
s_movk_i32 s47, 23
s_lshl_b32 s47, s47, 11
buffer_load_dwordx4 v[96:99], v13, s[24:27], s47 offen offset:0 sc1
buffer_load_dwordx4 v[100:103], v13, s[24:27], s47 offen offset:1024 sc1
s_call_b64 s[100:101], L_TRY
s_cbranch_scc1 L_SLOW21
v_mov_b64 v[40:41], v[120:121]
v_mov_b64 v[44:45], v[124:125]
s_branch L_BACK21
L_SLOW22:
s_movk_i32 s91, 22
s_lshl_b32 s47, s91, 11
buffer_load_dwordx4 v[120:123], v13, s[24:27], s47 offen offset:0 sc1
buffer_load_dwordx4 v[124:127], v13, s[24:27], s47 offen offset:1024 sc1
s_movk_i32 s47, 23
s_lshl_b32 s47, s47, 11
buffer_load_dwordx4 v[96:99], v13, s[24:27], s47 offen offset:0 sc1
buffer_load_dwordx4 v[100:103], v13, s[24:27], s47 offen offset:1024 sc1
s_movk_i32 s47, 24
s_lshl_b32 s47, s47, 11
buffer_load_dwordx4 v[80:83], v13, s[24:27], s47 offen offset:0 sc1
buffer_load_dwordx4 v[84:87], v13, s[24:27], s47 offen offset:1024 sc1
s_call_b64 s[100:101], L_TRY
s_cbranch_scc1 L_SLOW22
v_mov_b64 v[48:49], v[120:121]
v_mov_b64 v[52:53], v[124:125]
s_branch L_BACK22
L_SLOW23:
s_movk_i32 s91, 23
s_lshl_b32 s47, s91, 11
buffer_load_dwordx4 v[120:123], v13, s[24:27], s47 offen offset:0 sc1
buffer_load_dwordx4 v[124:127], v13, s[24:27], s47 offen offset:1024 sc1
s_movk_i32 s47, 24
s_lshl_b32 s47, s47, 11
buffer_load_dwordx4 v[80:83], v13, s[24:27], s47 offen offset:0 sc1
buffer_load_dwordx4 v[84:87], v13, s[24:27], s47 offen offset:1024 sc1
s_movk_i32 s47, 25
s_lshl_b32 s47, s47, 11
buffer_load_dwordx4 v[88:91], v13, s[24:27], s47 offen offset:0 sc1
buffer_load_dwordx4 v[92:95], v13, s[24:27], s47 offen offset:1024 sc1
s_call_b64 s[100:101], L_TRY
s_cbranch_scc1 L_SLOW23
v_mov_b64 v[96:97], v[120:121]
v_mov_b64 v[100:101], v[124:125]
s_branch L_BACK23
L_SLOW24:
s_movk_i32 s91, 24
s_lshl_b32 s47, s91, 11
buffer_load_dwordx4 v[120:123], v13, s[24:27], s47 offen offset:0 sc1
buffer_load_dwordx4 v[124:127], v13, s[24:27], s47 offen offset:1024 sc1
s_movk_i32 s47, 25
s_lshl_b32 s47, s47, 11
buffer_load_dwordx4 v[88:91], v13, s[24:27], s47 offen offset:0 sc1
buffer_load_dwordx4 v[92:95], v13, s[24:27], s47 offen offset:1024 sc1
s_movk_i32 s47, 26
s_lshl_b32 s47, s47, 11
buffer_load_dwordx4 v[32:35], v13, s[24:27], s47 offen offset:0 sc1
buffer_load_dwordx4 v[36:39], v13, s[24:27], s47 offen offset:1024 sc1
s_call_b64 s[100:101], L_TRY
s_cbranch_scc1 L_SLOW24
v_mov_b64 v[80:81], v[120:121]
v_mov_b64 v[84:85], v[124:125]
s_branch L_BACK24
L_SLOW25:
s_movk_i32 s91, 25
s_lshl_b32 s47, s91, 11
buffer_load_dwordx4 v[120:123], v13, s[24:27], s47 offen offset:0 sc1
buffer_load_dwordx4 v[124:127], v13, s[24:27], s47 offen offset:1024 sc1
s_movk_i32 s47, 26
s_lshl_b32 s47, s47, 11
buffer_load_dwordx4 v[32:35], v13, s[24:27], s47 offen offset:0 sc1
buffer_load_dwordx4 v[36:39], v13, s[24:27], s47 offen offset:1024 sc1
s_movk_i32 s47, 27
s_lshl_b32 s47, s47, 11
buffer_load_dwordx4 v[40:43], v13, s[24:27], s47 offen offset:0 sc1
buffer_load_dwordx4 v[44:47], v13, s[24:27], s47 offen offset:1024 sc1
s_call_b64 s[100:101], L_TRY
s_cbranch_scc1 L_SLOW25
v_mov_b64 v[88:89], v[120:121]
v_mov_b64 v[92:93], v[124:125]
s_branch L_BACK25
L_SLOW26:
s_movk_i32 s91, 26
s_lshl_b32 s47, s91, 11
buffer_load_dwordx4 v[120:123], v13, s[24:27], s47 offen offset:0 sc1
buffer_load_dwordx4 v[124:127], v13, s[24:27], s47 offen offset:1024 sc1
s_movk_i32 s47, 27
s_lshl_b32 s47, s47, 11
buffer_load_dwordx4 v[40:43], v13, s[24:27], s47 offen offset:0 sc1
buffer_load_dwordx4 v[44:47], v13, s[24:27], s47 offen offset:1024 sc1
s_movk_i32 s47, 28
s_lshl_b32 s47, s47, 11
buffer_load_dwordx4 v[48:51], v13, s[24:27], s47 offen offset:0 sc1
buffer_load_dwordx4 v[52:55], v13, s[24:27], s47 offen offset:1024 sc1
s_call_b64 s[100:101], L_TRY
s_cbranch_scc1 L_SLOW26
v_mov_b64 v[32:33], v[120:121]
v_mov_b64 v[36:37], v[124:125]
s_branch L_BACK26
L_SLOW27:
s_movk_i32 s91, 27
s_lshl_b32 s47, s91, 11
buffer_load_dwordx4 v[120:123], v13, s[24:27], s47 offen offset:0 sc1
buffer_load_dwordx4 v[124:127], v13, s[24:27], s47 offen offset:1024 sc1
s_movk_i32 s47, 28
s_lshl_b32 s47, s47, 11
buffer_load_dwordx4 v[48:51], v13, s[24:27], s47 offen offset:0 sc1
buffer_load_dwordx4 v[52:55], v13, s[24:27], s47 offen offset:1024 sc1
s_movk_i32 s47, 29
s_lshl_b32 s47, s47, 11
buffer_load_dwordx4 v[96:99], v13, s[24:27], s47 offen offset:0 sc1
buffer_load_dwordx4 v[100:103], v13, s[24:27], s47 offen offset:1024 sc1
s_call_b64 s[100:101], L_TRY
s_cbranch_scc1 L_SLOW27
v_mov_b64 v[40:41], v[120:121]
v_mov_b64 v[44:45], v[124:125]
s_branch L_BACK27
L_SLOW28:
s_movk_i32 s91, 28
s_lshl_b32 s47, s91, 11
buffer_load_dwordx4 v[120:123], v13, s[24:27], s47 offen offset:0 sc1
buffer_load_dwordx4 v[124:127], v13, s[24:27], s47 offen offset:1024 sc1
s_movk_i32 s47, 29
s_lshl_b32 s47, s47, 11
buffer_load_dwordx4 v[96:99], v13, s[24:27], s47 offen offset:0 sc1
buffer_load_dwordx4 v[100:103], v13, s[24:27], s47 offen offset:1024 sc1
s_movk_i32 s47, 30
s_lshl_b32 s47, s47, 11
buffer_load_dwordx4 v[80:83], v13, s[24:27], s47 offen offset:0 sc1
buffer_load_dwordx4 v[84:87], v13, s[24:27], s47 offen offset:1024 sc1
s_call_b64 s[100:101], L_TRY
s_cbranch_scc1 L_SLOW28
v_mov_b64 v[48:49], v[120:121]
v_mov_b64 v[52:53], v[124:125]
s_branch L_BACK28
L_SLOW29:
s_movk_i32 s91, 29
s_lshl_b32 s47, s91, 11
buffer_load_dwordx4 v[120:123], v13, s[24:27], s47 offen offset:0 sc1
buffer_load_dwordx4 v[124:127], v13, s[24:27], s47 offen offset:1024 sc1
s_movk_i32 s47, 30
s_lshl_b32 s47, s47, 11
buffer_load_dwordx4 v[80:83], v13, s[24:27], s47 offen offset:0 sc1
buffer_load_dwordx4 v[84:87], v13, s[24:27], s47 offen offset:1024 sc1
s_movk_i32 s47, 31
s_lshl_b32 s47, s47, 11
buffer_load_dwordx4 v[88:91], v13, s[24:27], s47 offen offset:0 sc1
buffer_load_dwordx4 v[92:95], v13, s[24:27], s47 offen offset:1024 sc1
s_call_b64 s[100:101], L_TRY
s_cbranch_scc1 L_SLOW29
v_mov_b64 v[96:97], v[120:121]
v_mov_b64 v[100:101], v[124:125]
s_branch L_BACK29
L_SLOW30:
s_movk_i32 s91, 30
s_lshl_b32 s47, s91, 11
buffer_load_dwordx4 v[120:123], v13, s[24:27], s47 offen offset:0 sc1
buffer_load_dwordx4 v[124:127], v13, s[24:27], s47 offen offset:1024 sc1
s_movk_i32 s47, 31
s_lshl_b32 s47, s47, 11
buffer_load_dwordx4 v[88:91], v13, s[24:27], s47 offen offset:0 sc1
buffer_load_dwordx4 v[92:95], v13, s[24:27], s47 offen offset:1024 sc1
s_call_b64 s[100:101], L_TRY
s_cbranch_scc1 L_SLOW30
v_mov_b64 v[80:81], v[120:121]
v_mov_b64 v[84:85], v[124:125]
s_branch L_BACK30
L_SLOW31:
s_movk_i32 s91, 31
s_lshl_b32 s47, s91, 11
buffer_load_dwordx4 v[120:123], v13, s[24:27], s47 offen offset:0 sc1
buffer_load_dwordx4 v[124:127], v13, s[24:27], s47 offen offset:1024 sc1
s_call_b64 s[100:101], L_TRY
s_cbranch_scc1 L_SLOW31
v_mov_b64 v[88:89], v[120:121]
v_mov_b64 v[92:93], v[124:125]
s_branch L_BACK31
L_SELF:
s_mul_i32 s47, s91, 458752
s_lshl_b32 s46, s39, 8
s_add_u32 s47, s47, s46
s_add_u32 s84, s6, s47
s_addc_u32 s85, s7, 0
s_mov_b32 s86, 387328
s_mov_b32 s87, 0x20000
buffer_load_dwordx4 v[64:67], v30, s[84:87], 0 offen
buffer_load_dwordx4 v[68:71], v30, s[84:87], s92 offen
buffer_load_dwordx4 v[72:75], v30, s[84:87], s93 offen
buffer_load_dwordx4 v[76:79], v30, s[84:87], s94 offen
s_waitcnt vmcnt(0)
v_lshl_add_u64 v[64:65], v[68:69], 4, v[64:65]
v_lshl_add_u64 v[66:67], v[70:71], 4, v[66:67]
v_lshl_add_u64 v[72:73], v[76:77], 4, v[72:73]
v_lshl_add_u64 v[74:75], v[78:79], 4, v[74:75]
v_lshl_or_b32 v76, v72, 8, v64
v_lshl_or_b32 v77, v73, 8, v65
v_lshl_or_b32 v78, v74, 8, v66
v_lshl_or_b32 v79, v75, 8, v67
v_lshl_or_b32 v120, v77, 16, v76
v_lshl_or_b32 v121, v79, 16, v78
s_add_u32 s84, s84, 57344
s_addc_u32 s85, s85, 0
buffer_load_dwordx4 v[64:67], v30, s[84:87], 0 offen
buffer_load_dwordx4 v[68:71], v30, s[84:87], s92 offen
buffer_load_dwordx4 v[72:75], v30, s[84:87], s93 offen
buffer_load_dwordx4 v[76:79], v30, s[84:87], s94 offen
s_waitcnt vmcnt(0)
v_lshl_add_u64 v[64:65], v[68:69], 4, v[64:65]
v_lshl_add_u64 v[66:67], v[70:71], 4, v[66:67]
v_lshl_add_u64 v[72:73], v[76:77], 4, v[72:73]
v_lshl_add_u64 v[74:75], v[78:79], 4, v[74:75]
v_lshl_or_b32 v76, v72, 8, v64
v_lshl_or_b32 v77, v73, 8, v65
v_lshl_or_b32 v78, v74, 8, v66
v_lshl_or_b32 v79, v75, 8, v67
v_lshl_or_b32 v124, v77, 16, v76
v_lshl_or_b32 v125, v79, 16, v78
s_cmp_eq_u32 s39, -1
s_setpc_b64 s[100:101]
L_END:
s_endpgm
.section .rodata,"a"
.p2align 6
.amdhsa_kernel standalone__normalfloat_lut_af4__prompt_kernel
  .amdhsa_next_free_vgpr 512
  .amdhsa_next_free_sgpr 102
  .amdhsa_accum_offset 256
  .amdhsa_group_segment_fixed_size 0
  .amdhsa_kernarg_size 56
  .amdhsa_user_sgpr_count 2
  .amdhsa_user_sgpr_kernarg_segment_ptr 1
  .amdhsa_system_sgpr_workgroup_id_x 1
.end_amdhsa_kernel
```

```asm
; @launch grid=(256,1,1) block=(256,1,1) lds=163840
.amdgcn_target "amdgcn-amd-amdhsa--gfx950"
.text
.globl standalone__normalfloat_lut_af4__prompt_kernel
.p2align 12
.p2align 8
.type standalone__normalfloat_lut_af4__prompt_kernel,@function
standalone__normalfloat_lut_af4__prompt_kernel:
s_load_dwordx4 s[4:7], s[0:1], 0
s_load_dwordx4 s[12:15], s[0:1], 40
s_load_dwordx4 s[8:11], s[0:1], 24
s_load_dwordx2 s[50:51], s[0:1], 16
s_memrealtime s[56:57]
s_cmp_ge_u32 s2, 256
s_cbranch_scc1 L_END
s_getpc_b64 s[48:49]
L_PC0:
v_bfi_b32 v2, 7, v0, s2
v_lshlrev_b32 v2, 7, v2
v_min_u32 v2, L_END-L_PC0, v2
global_load_dword v7, v2, s[48:49]
v_lshrrev_b32 v1, 6, v0
s_cmp_lt_u32 s2, 32
v_readfirstlane_b32 s36, v1
s_cbranch_scc1 L_PACK
s_bfe_u32 s34, s2, 0x20001
s_bfe_u32 s37, s2, 0x20003
s_lshl2_add_u32 s37, s34, s37
s_and_b32 s43, s2, 1
s_mul_i32 s43, s43, 7
s_lshr_b32 s38, s2, 5
s_add_u32 s38, s38, s43
s_lshl2_add_u32 s39, s38, s36
s_sub_u32 s39, s39, 4
v_bfe_u32 v6, v0, 4, 2
v_and_b32 v3, 15, v0
v_mul_u32_u24 v2, 114688, v6
v_lshl_add_u32 v30, v3, 4, v2
s_lshr_b32 s46, s37, 1
s_and_b32 s45, s37, 1
s_lshl3_add_u32 s46, s46, s45
s_mul_i32 s46, s46, 57344
s_lshl_b32 s47, s39, 8
s_add_u32 s44, s46, s47
s_mov_b32 s18, 387328
s_mov_b32 s19, 0x20000
s_mov_b32 s92, 14336
s_mov_b32 s93, 28672
s_mov_b32 s94, 43008
s_waitcnt lgkmcnt(0)
s_load_dwordx8 s[64:71], s[50:51], 0
s_add_u32 s16, s6, s44
s_addc_u32 s17, s7, 0
buffer_load_dwordx4 v[104:107], v30, s[16:19], 0 offen
buffer_load_dwordx4 v[108:111], v30, s[16:19], s92 offen
buffer_load_dwordx4 v[112:115], v30, s[16:19], s93 offen
buffer_load_dwordx4 v[116:119], v30, s[16:19], s94 offen
s_branch L_MAIN
L_PACK:
v_lshrrev_b32 v2, 2, v0
v_and_b32 v3, 3, v0
s_lshl_b32 s45, s2, 17
v_lshl_add_u32 v2, v2, 11, s45
v_lshl_add_u32 v17, v3, 7, v2
s_mov_b32 s30, 4194304
s_mov_b32 s31, 0x20000
v_lshlrev_b32 v16, 3, v0
s_cmp_lt_u32 s2, 2
s_cselect_b32 s34, 8, 0
s_mov_b32 s35, 0x20000
v_mov_b64 v[22:23], 0
s_waitcnt lgkmcnt(0)
s_mov_b64 s[32:33], s[12:13]
v_mov_b64 v[20:21], s[56:57]
buffer_atomic_cmpswap_x2 v[20:23], v16, s[32:35], 0 offen sc1
s_mov_b64 s[28:29], s[4:5]
buffer_load_dword v19, v17, s[28:31], 0 offen offset:0
s_branch L_PACK1
L_MAIN:
s_mov_b64 s[20:21], s[4:5]
s_mov_b32 s22, 4194304
s_mov_b32 s23, 0x20000
s_lshl_b32 s46, s37, 18
v_lshrrev_b32 v5, 3, v0
v_lshl_add_u32 v2, v5, 11, s46
v_lshrrev_b32 v4, 4, v0
v_xor_b32 v4, v4, v0
v_and_b32 v4, 7, v4
v_lshl_add_u32 v8, v4, 4, v2
v_add_u32 v9, 65536, v8
v_add_u32 v10, 131072, v8
v_add_u32 v11, 196608, v8
s_lshl_b32 s33, s36, 10
s_mul_i32 s47, s45, 114688
s_sub_u32 s47, s44, s47
s_add_u32 s47, s47, 57344
s_add_u32 s84, s6, s47
s_addc_u32 s85, s7, 0
s_mov_b32 s86, 387328
s_mov_b32 s87, 0x20000
s_lshl_b32 s40, s34, 7
s_add_u32 m0, s33, 65536
s_nop 0
buffer_load_dwordx4 v8, s[20:23], s40 offen lds
s_add_u32 m0, s33, 69632
s_nop 0
buffer_load_dwordx4 v9, s[20:23], s40 offen lds
s_add_u32 m0, s33, 73728
s_nop 0
buffer_load_dwordx4 v10, s[20:23], s40 offen lds
s_add_u32 m0, s33, 77824
s_nop 0
buffer_load_dwordx4 v11, s[20:23], s40 offen lds
s_and_b32 s45, s36, 1
s_mul_i32 s45, s45, 0x0202
s_lshr_b32 s46, s36, 1
s_mul_i32 s46, s46, 0x02020000
s_add_u32 s45, s45, s46
s_add_u32 s45, s45, 0x05040100
v_mov_b32 v57, s45
v_lshlrev_b32 v5, 8, v5
v_and_b32 v58, 7, v0
v_lshl_add_u32 v58, v58, 4, v5
v_and_b32 v5, 31, v0
v_lshlrev_b32 v19, 2, v5
v_and_b32 v0, 63, v0
s_lshl_b32 s46, s39, 7
v_lshl_add_u32 v28, v3, 3, s46
s_mul_i32 s47, s37, 917504
s_add_u32 s47, s47, s46
s_add_u32 s28, s10, s47
s_addc_u32 s29, s11, 0
s_mov_b32 s30, 86144
s_mov_b32 s31, 0x20000
v_mul_u32_u24 v29, 28672, v6
v_lshl_add_u32 v18, v3, 3, v29
v_lshlrev_b32 v29, 7, v3
v_bfe_u32 v5, v0, 1, 3
v_xor_b32 v5, v5, v6
v_lshl_add_u32 v29, v5, 4, v29
v_add_u32 v14, 65536, v29
v_xor_b32 v15, 64, v14
v_add_u32 v16, 0x10000, v14
v_add_u32 v17, 0x10000, v15
s_mov_b32 s52, 0x0c0c0400
s_mov_b32 s53, 0x0c0c0500
s_mov_b32 s54, 0x0c0c0600
s_mov_b32 s55, 0x0c0c0700
v_lshlrev_b32 v13, 4, v0
s_lshl_b32 s47, s39, 16
s_add_u32 s24, s14, s47
s_addc_u32 s25, s15, 0
s_lshl_b32 s47, s37, 10
s_add_u32 s76, s24, s47
s_addc_u32 s77, s25, 0
s_movk_i32 s78, 1024
s_mov_b32 s79, 0x20000
s_lshl_b32 s47, s34, 3
s_lshr_b32 s47, 0x90d0b2d, s47
s_bfe_u32 s41, s47, 0x20000
s_lshl_b32 s41, s41, 7
s_bfe_u32 s42, s47, 0x20002
s_lshl_b32 s42, s42, 7
s_bfe_u32 s43, s47, 0x20004
s_lshl_b32 s43, s43, 7
s_lshl_b32 s47, s34, 1
s_lshr_b32 s47, 0x63, s47
s_and_b32 s47, s47, 3
s_sub_u32 s47, s47, s34
s_lshl1_add_u32 s3, s47, 14
s_mul_i32 s47, s3, 458752
s_add_u32 s16, s16, s47
s_addc_u32 s17, s17, 0
s_lshl_b32 s3, s3, 11
s_lshr_b32 s35, s37, 1
s_xor_b32 s35, s35, 1
v_lshl_add_u32 v12, s41, 5, v13
s_mul_i32 s47, s35, 458752
s_lshl_b32 s46, s39, 8
s_add_u32 s47, s47, s46
s_add_u32 s72, s6, s47
s_addc_u32 s73, s7, 0
s_mov_b32 s74, 444672
s_mov_b32 s75, 0x20000
v_add_u32 v31, 57344, v30
s_and_b32 s47, s37, 2
s_lshl_b32 s47, s47, 5
v_xor_b32 v2, s47, v14
v_xor_b32 v4, 64, v2
s_mov_b32 s26, 65536
s_mov_b32 s27, 0x20000
s_mov_b64 s[80:81], s[12:13]
s_movk_i32 s82, 128
s_mov_b32 s83, 0x20000
s_movk_i32 s90, 4096
s_waitcnt lgkmcnt(0)
s_pack_ll_b32_b16 s45, s64, s68
v_mov_b32 v56, s45
s_lshl_b64 exec, exec, 8
s_pack_hh_b32_b16 s45, s64, s68
v_mov_b32 v56, s45
s_lshl_b64 exec, exec, 8
s_pack_ll_b32_b16 s45, s65, s69
v_mov_b32 v56, s45
s_lshl_b64 exec, exec, 8
s_pack_hh_b32_b16 s45, s65, s69
v_mov_b32 v56, s45
s_lshl_b64 exec, exec, 8
s_pack_ll_b32_b16 s45, s66, s70
v_mov_b32 v56, s45
s_lshl_b64 exec, exec, 8
s_pack_hh_b32_b16 s45, s66, s70
v_mov_b32 v56, s45
s_lshl_b64 exec, exec, 8
s_pack_ll_b32_b16 s45, s67, s71
v_mov_b32 v56, s45
s_lshl_b64 exec, exec, 8
s_pack_hh_b32_b16 s45, s67, s71
v_mov_b32 v56, s45
s_mov_b64 exec, -1
v_perm_b32 v128, s64, v56, v57
v_mov_b32 v129, v128
v_mov_b64 v[130:131], v[128:129]
s_load_dwordx2 s[88:89], s[12:13], 0
ds_write_b128 v58, v[128:131] offset:0
v_perm_b32 v132, s65, v56, v57
v_mov_b32 v133, v132
v_mov_b64 v[134:135], v[132:133]
ds_write_b128 v58, v[132:135] offset:8192
v_perm_b32 v136, s66, v56, v57
v_mov_b32 v137, v136
v_mov_b64 v[138:139], v[136:137]
ds_write_b128 v58, v[136:139] offset:16384
v_perm_b32 v140, s67, v56, v57
v_mov_b32 v141, v140
v_mov_b64 v[142:143], v[140:141]
ds_write_b128 v58, v[140:143] offset:24576
v_perm_b32 v144, s68, v56, v57
v_mov_b32 v145, v144
v_mov_b64 v[146:147], v[144:145]
ds_write_b128 v58, v[144:147] offset:32768
v_perm_b32 v148, s69, v56, v57
v_mov_b32 v149, v148
v_mov_b64 v[150:151], v[148:149]
ds_write_b128 v58, v[148:151] offset:40960
v_perm_b32 v152, s70, v56, v57
v_mov_b32 v153, v152
v_mov_b64 v[154:155], v[152:153]
ds_write_b128 v58, v[152:155] offset:49152
v_perm_b32 v156, s71, v56, v57
v_mov_b32 v157, v156
v_mov_b64 v[158:159], v[156:157]
ds_write_b128 v58, v[156:159] offset:57344
buffer_load_dwordx4 v[64:67], v30, s[84:87], 0 offen
buffer_load_dwordx4 v[68:71], v30, s[84:87], s92 offen
buffer_load_dwordx4 v[72:75], v30, s[84:87], s93 offen
buffer_load_dwordx4 v[76:79], v30, s[84:87], s94 offen
s_mov_b64 vcc, -1
s_branch L_PAD0
L_PADRET0:
s_mov_b64 vcc, 0
s_waitcnt vmcnt(8)
v_lshl_add_u64 v[104:105], v[108:109], 4, v[104:105]
v_lshl_add_u64 v[106:107], v[110:111], 4, v[106:107]
v_lshl_add_u64 v[112:113], v[116:117], 4, v[112:113]
v_lshl_add_u64 v[114:115], v[118:119], 4, v[114:115]
v_lshl_or_b32 v116, v112, 8, v104
v_lshl_or_b32 v117, v113, 8, v105
v_lshl_or_b32 v118, v114, 8, v106
v_lshl_or_b32 v119, v115, 8, v107
v_lshl_or_b32 v108, v117, 16, v116
v_lshl_or_b32 v109, v119, 16, v118
s_waitcnt lgkmcnt(0)
s_cmp_eq_u64 s[88:89], 0
s_cbranch_scc1 L_NOTAG
L_TAGOK:
v_mov_b64 v[110:111], s[88:89]
buffer_store_dwordx4 v[108:111], v13, s[76:79], 0 offen sc1
s_add_u32 s76, s76, s3
s_addc_u32 s77, s77, 0
s_waitcnt lgkmcnt(0)
s_nop 0
s_branch L_STREAM
L_PACK1:
v_and_b32 v0, 63, v0
v_lshrrev_b32 v2, 4, v0
v_and_b32 v3, 15, v0
v_mul_u32_u24 v2, 114688, v2
v_lshl_add_u32 v8, v3, 4, v2
s_movk_i32 s47, 0x3800
v_add_u32 v9, s47, v8
v_add_u32 v10, s47, v9
v_add_u32 v11, s47, v10
v_add_u32 v12, s47, v11
v_add_u32 v13, s47, v12
v_add_u32 v14, s47, v13
v_add_u32 v15, s47, v14
s_sub_u32 s3, s2, 1
s_and_b32 s3, s3, 7
s_lshr_b32 s45, s2, 3
s_lshl2_add_u32 s3, s3, s45
s_mul_i32 s40, s3, 4682
s_lshr_b32 s40, s40, 16
s_mul_i32 s41, s40, 14
s_sub_u32 s41, s3, s41
s_add_u32 s40, s40, 8
s_mov_b32 s22, 14680064
s_mov_b32 s23, 0x20000
s_mov_b64 s[20:21], s[6:7]
s_cmp_ge_u32 s40, 14
s_cselect_b32 s45, 8, 0
s_add_u32 s45, s45, s40
s_lshl2_add_u32 s42, s41, s36
s_mul_i32 s43, s45, 458752
s_lshl_b32 s44, s42, 8
s_add_u32 s43, s43, s44
s_lshl_b32 s44, s42, 5
s_add_u32 s44, s44, s45
s_lshl_b32 s52, s44, 11
s_cmp_lt_u32 s45, 32
s_cselect_b32 s52, s52, 0x1000000
s_cselect_b32 s22, 14680064, 0
s_add_u32 s41, s41, 4
s_add_u32 s40, s40, 2
s_cmp_ge_u32 s41, 14
s_cselect_b32 s48, 14, 0
s_addc_u32 s40, s40, 0
s_sub_u32 s41, s41, s48
s_load_dwordx2 s[50:51], s[12:13], 0
buffer_load_dwordx4 v[32:35], v8, s[20:23], s43 offen
buffer_load_dwordx4 v[36:39], v9, s[20:23], s43 offen
buffer_load_dwordx4 v[40:43], v10, s[20:23], s43 offen
buffer_load_dwordx4 v[44:47], v11, s[20:23], s43 offen
buffer_load_dwordx4 v[48:51], v12, s[20:23], s43 offen
buffer_load_dwordx4 v[52:55], v13, s[20:23], s43 offen
buffer_load_dwordx4 v[56:59], v14, s[20:23], s43 offen
buffer_load_dwordx4 v[60:63], v15, s[20:23], s43 offen
s_mov_b64 s[24:25], s[14:15]
s_mov_b32 s26, 3670016
s_mov_b32 s27, 0x20000
s_movk_i32 s34, 128
v_mov_b32 v16, 0
v_lshlrev_b32 v18, 4, v0
s_movk_i32 s46, 4096
s_waitcnt vmcnt(4) lgkmcnt(0)
v_mov_b64 v[22:23], s[50:51]
s_nop 0
L_PKN:
v_cmp_ne_u64 vcc, 0, v[22:23]
s_sub_u32 s46, s46, 1
s_cmp_gt_i32 s46, 0
s_cbranch_vccnz L_PKGO
s_cbranch_scc0 L_END
buffer_load_dwordx2 v[22:23], v16, s[32:35], 0 offen sc1
s_waitcnt vmcnt(0)
s_branch L_PKN
L_PKGO:
s_call_b64 s[100:101], L_PK0
buffer_store_dwordx4 v[20:23], v18, s[24:27], s52 offen offset:0 sc1
s_waitcnt lgkmcnt(0)
s_call_b64 s[100:101], L_UNIT
s_mov_b32 s53, s49
buffer_load_dwordx4 v[64:67], v8, s[20:23], s43 offen
buffer_load_dwordx4 v[68:71], v9, s[20:23], s43 offen
buffer_load_dwordx4 v[72:75], v10, s[20:23], s43 offen
buffer_load_dwordx4 v[76:79], v11, s[20:23], s43 offen
s_waitcnt vmcnt(5)
s_call_b64 s[100:101], L_PK1
buffer_store_dwordx4 v[20:23], v18, s[24:27], s52 offen offset:1024 sc1
buffer_load_dwordx4 v[80:83], v12, s[20:23], s43 offen
buffer_load_dwordx4 v[84:87], v13, s[20:23], s43 offen
buffer_load_dwordx4 v[88:91], v14, s[20:23], s43 offen
buffer_load_dwordx4 v[92:95], v15, s[20:23], s43 offen
s_waitcnt vmcnt(5)
s_call_b64 s[100:101], L_PK2
buffer_store_dwordx4 v[20:23], v18, s[24:27], s53 offen offset:0 sc1
s_call_b64 s[100:101], L_UNIT
s_mov_b32 s54, s49
buffer_load_dwordx4 v[32:35], v8, s[20:23], s43 offen
buffer_load_dwordx4 v[36:39], v9, s[20:23], s43 offen
buffer_load_dwordx4 v[40:43], v10, s[20:23], s43 offen
buffer_load_dwordx4 v[44:47], v11, s[20:23], s43 offen
s_waitcnt vmcnt(5)
s_call_b64 s[100:101], L_PK3
buffer_store_dwordx4 v[20:23], v18, s[24:27], s53 offen offset:1024 sc1
buffer_load_dwordx4 v[48:51], v12, s[20:23], s43 offen
buffer_load_dwordx4 v[52:55], v13, s[20:23], s43 offen
buffer_load_dwordx4 v[56:59], v14, s[20:23], s43 offen
buffer_load_dwordx4 v[60:63], v15, s[20:23], s43 offen
s_waitcnt vmcnt(5)
s_call_b64 s[100:101], L_PK0
buffer_store_dwordx4 v[20:23], v18, s[24:27], s54 offen offset:0 sc1
s_call_b64 s[100:101], L_UNIT
s_mov_b32 s55, s49
buffer_load_dwordx4 v[64:67], v8, s[20:23], s43 offen
buffer_load_dwordx4 v[68:71], v9, s[20:23], s43 offen
buffer_load_dwordx4 v[72:75], v10, s[20:23], s43 offen
buffer_load_dwordx4 v[76:79], v11, s[20:23], s43 offen
s_waitcnt vmcnt(5)
s_call_b64 s[100:101], L_PK1
buffer_store_dwordx4 v[20:23], v18, s[24:27], s54 offen offset:1024 sc1
buffer_load_dwordx4 v[80:83], v12, s[20:23], s43 offen
buffer_load_dwordx4 v[84:87], v13, s[20:23], s43 offen
buffer_load_dwordx4 v[88:91], v14, s[20:23], s43 offen
buffer_load_dwordx4 v[92:95], v15, s[20:23], s43 offen
s_waitcnt vmcnt(5)
s_call_b64 s[100:101], L_PK2
buffer_store_dwordx4 v[20:23], v18, s[24:27], s55 offen offset:0 sc1
s_call_b64 s[100:101], L_UNIT
s_mov_b32 s52, s49
buffer_load_dwordx4 v[32:35], v8, s[20:23], s43 offen
buffer_load_dwordx4 v[36:39], v9, s[20:23], s43 offen
buffer_load_dwordx4 v[40:43], v10, s[20:23], s43 offen
buffer_load_dwordx4 v[44:47], v11, s[20:23], s43 offen
s_waitcnt vmcnt(5)
s_call_b64 s[100:101], L_PK3
buffer_store_dwordx4 v[20:23], v18, s[24:27], s55 offen offset:1024 sc1
buffer_load_dwordx4 v[48:51], v12, s[20:23], s43 offen
buffer_load_dwordx4 v[52:55], v13, s[20:23], s43 offen
buffer_load_dwordx4 v[56:59], v14, s[20:23], s43 offen
buffer_load_dwordx4 v[60:63], v15, s[20:23], s43 offen
s_waitcnt vmcnt(5)
s_call_b64 s[100:101], L_PK0
buffer_store_dwordx4 v[20:23], v18, s[24:27], s52 offen offset:0 sc1
buffer_load_dword v19, v17, s[28:31], 0 offen offset:1536
s_waitcnt vmcnt(2)
s_call_b64 s[100:101], L_PK1
buffer_store_dwordx4 v[20:23], v18, s[24:27], s52 offen offset:1024 sc1
s_call_b64 s[100:101], L_UNIT
s_mov_b32 s53, s49
buffer_load_dwordx4 v[64:67], v8, s[20:23], s43 offen
buffer_load_dwordx4 v[68:71], v9, s[20:23], s43 offen
buffer_load_dwordx4 v[72:75], v10, s[20:23], s43 offen
buffer_load_dwordx4 v[76:79], v11, s[20:23], s43 offen
buffer_load_dwordx4 v[80:83], v12, s[20:23], s43 offen
buffer_load_dwordx4 v[84:87], v13, s[20:23], s43 offen
buffer_load_dwordx4 v[88:91], v14, s[20:23], s43 offen
buffer_load_dwordx4 v[92:95], v15, s[20:23], s43 offen
s_waitcnt vmcnt(4)
s_call_b64 s[100:101], L_PK2
buffer_store_dwordx4 v[20:23], v18, s[24:27], s53 offen offset:0 sc1
s_call_b64 s[100:101], L_UNIT
s_mov_b32 s54, s49
buffer_load_dwordx4 v[32:35], v8, s[20:23], s43 offen
buffer_load_dwordx4 v[36:39], v9, s[20:23], s43 offen
buffer_load_dwordx4 v[40:43], v10, s[20:23], s43 offen
buffer_load_dwordx4 v[44:47], v11, s[20:23], s43 offen
s_waitcnt vmcnt(5)
s_call_b64 s[100:101], L_PK3
buffer_store_dwordx4 v[20:23], v18, s[24:27], s53 offen offset:1024 sc1
buffer_load_dwordx4 v[48:51], v12, s[20:23], s43 offen
buffer_load_dwordx4 v[52:55], v13, s[20:23], s43 offen
buffer_load_dwordx4 v[56:59], v14, s[20:23], s43 offen
buffer_load_dwordx4 v[60:63], v15, s[20:23], s43 offen
s_waitcnt vmcnt(5)
s_call_b64 s[100:101], L_PK0
buffer_store_dwordx4 v[20:23], v18, s[24:27], s54 offen offset:0 sc1
s_waitcnt vmcnt(1)
s_call_b64 s[100:101], L_PK1
buffer_store_dwordx4 v[20:23], v18, s[24:27], s54 offen offset:1024 sc1
s_endpgm
L_UNIT:
s_cmp_ge_u32 s40, 14
s_cselect_b32 s45, 8, 0
s_add_u32 s45, s45, s40
s_lshl2_add_u32 s42, s41, s36
s_mul_i32 s43, s45, 458752
s_lshl_b32 s44, s42, 8
s_add_u32 s43, s43, s44
s_lshl_b32 s44, s42, 5
s_add_u32 s44, s44, s45
s_lshl_b32 s49, s44, 11
s_cmp_lt_u32 s45, 32
s_cselect_b32 s49, s49, 0x1000000
s_cselect_b32 s22, 14680064, 0
s_add_u32 s41, s41, 4
s_add_u32 s40, s40, 2
s_cmp_ge_u32 s41, 14
s_cselect_b32 s48, 14, 0
s_addc_u32 s40, s40, 0
s_sub_u32 s41, s41, s48
s_setpc_b64 s[100:101]
L_PK0:
v_lshl_add_u64 v[32:33], v[36:37], 4, v[32:33]
v_lshl_add_u64 v[34:35], v[38:39], 4, v[34:35]
v_lshl_add_u64 v[40:41], v[44:45], 4, v[40:41]
v_lshl_add_u64 v[42:43], v[46:47], 4, v[42:43]
v_lshl_or_b32 v44, v40, 8, v32
v_lshl_or_b32 v45, v41, 8, v33
v_lshl_or_b32 v46, v42, 8, v34
v_lshl_or_b32 v47, v43, 8, v35
v_lshl_or_b32 v20, v45, 16, v44
v_lshl_or_b32 v21, v47, 16, v46
s_setpc_b64 s[100:101]
L_PK1:
v_lshl_add_u64 v[48:49], v[52:53], 4, v[48:49]
v_lshl_add_u64 v[50:51], v[54:55], 4, v[50:51]
v_lshl_add_u64 v[56:57], v[60:61], 4, v[56:57]
v_lshl_add_u64 v[58:59], v[62:63], 4, v[58:59]
v_lshl_or_b32 v60, v56, 8, v48
v_lshl_or_b32 v61, v57, 8, v49
v_lshl_or_b32 v62, v58, 8, v50
v_lshl_or_b32 v63, v59, 8, v51
v_lshl_or_b32 v20, v61, 16, v60
v_lshl_or_b32 v21, v63, 16, v62
s_setpc_b64 s[100:101]
L_PK2:
v_lshl_add_u64 v[64:65], v[68:69], 4, v[64:65]
v_lshl_add_u64 v[66:67], v[70:71], 4, v[66:67]
v_lshl_add_u64 v[72:73], v[76:77], 4, v[72:73]
v_lshl_add_u64 v[74:75], v[78:79], 4, v[74:75]
v_lshl_or_b32 v76, v72, 8, v64
v_lshl_or_b32 v77, v73, 8, v65
v_lshl_or_b32 v78, v74, 8, v66
v_lshl_or_b32 v79, v75, 8, v67
v_lshl_or_b32 v20, v77, 16, v76
v_lshl_or_b32 v21, v79, 16, v78
s_setpc_b64 s[100:101]
L_PK3:
v_lshl_add_u64 v[80:81], v[84:85], 4, v[80:81]
v_lshl_add_u64 v[82:83], v[86:87], 4, v[82:83]
v_lshl_add_u64 v[88:89], v[92:93], 4, v[88:89]
v_lshl_add_u64 v[90:91], v[94:95], 4, v[90:91]
v_lshl_or_b32 v92, v88, 8, v80
v_lshl_or_b32 v93, v89, 8, v81
v_lshl_or_b32 v94, v90, 8, v82
v_lshl_or_b32 v95, v91, 8, v83
v_lshl_or_b32 v20, v93, 16, v92
v_lshl_or_b32 v21, v95, 16, v94
s_setpc_b64 s[100:101]
.p2align 12
L_STREAM:
L_PAD0:
s_cbranch_vccnz L_PADRET0
buffer_load_dwordx4 v[80:83], v30, s[72:75], 0 offen
buffer_load_dwordx4 v[84:87], v30, s[72:75], s92 offen
buffer_load_dwordx4 v[88:91], v30, s[72:75], s93 offen
buffer_load_dwordx4 v[92:95], v30, s[72:75], s94 offen
s_waitcnt vmcnt(9)
s_barrier
ds_read_b128 a[224:227], v2 offset:0
ds_read_b128 a[228:231], v2 offset:2048
v_lshl_add_u32 v104, v104, 8, v19
v_lshl_add_u32 v105, v105, 8, v19
v_lshl_add_u32 v106, v106, 8, v19
v_lshl_add_u32 v107, v107, 8, v19
v_lshl_add_u32 v112, v112, 8, v19
v_lshl_add_u32 v113, v113, 8, v19
v_lshl_add_u32 v114, v114, 8, v19
v_lshl_add_u32 v115, v115, 8, v19
s_waitcnt vmcnt(5)
v_lshl_add_u64 v[64:65], v[68:69], 4, v[64:65]
v_lshl_add_u64 v[66:67], v[70:71], 4, v[66:67]
v_lshl_add_u64 v[72:73], v[76:77], 4, v[72:73]
v_lshl_add_u64 v[74:75], v[78:79], 4, v[74:75]
v_lshl_add_u32 v64, v64, 8, v19
v_lshl_add_u32 v65, v65, 8, v19
v_lshl_add_u32 v66, v66, 8, v19
v_lshl_add_u32 v67, v67, 8, v19
v_lshl_add_u32 v72, v72, 8, v19
v_lshl_add_u32 v73, v73, 8, v19
v_lshl_add_u32 v74, v74, 8, v19
v_lshl_add_u32 v75, v75, 8, v19
s_bitcmp1_b32 s37, 0
s_cbranch_scc0 L_NOSWAP
v_swap_b32 v104, v64
v_swap_b32 v105, v65
v_swap_b32 v106, v66
v_swap_b32 v107, v67
v_swap_b32 v112, v72
v_swap_b32 v113, v73
v_swap_b32 v114, v74
v_swap_b32 v115, v75
L_NOSWAP:
ds_read_b32 a0, v104
ds_read_b32 a1, v112
ds_read_b32 a2, v64
ds_read_b32 a3, v72
ds_read_b32 a4, v105
ds_read_b32 a5, v113
ds_read_b32 a6, v65
ds_read_b32 a7, v73
ds_read_b32 a8, v106
ds_read_b32 a9, v114
ds_read_b32 a10, v66
ds_read_b32 a11, v74
ds_read_b32 a12, v107
ds_read_b32 a13, v115
ds_read_b32 a14, v67
ds_read_b32 a15, v75
s_waitcnt lgkmcnt(12)
v_mfma_f32_16x16x32_bf16 v[128:131], a[224:227], a[0:3], 0
s_waitcnt lgkmcnt(8)
ds_read_b128 a[232:235], v2 offset:4096
buffer_load_dwordx4 v[40:43], v31, s[72:75], 0 offen
v_mfma_f32_16x16x32_bf16 v[132:135], a[224:227], a[4:7], 0
s_waitcnt lgkmcnt(5)
buffer_load_dwordx4 v[44:47], v31, s[72:75], s92 offen
v_mfma_f32_16x16x32_bf16 v[136:139], a[224:227], a[8:11], 0
s_waitcnt lgkmcnt(1)
buffer_load_dwordx4 v[48:51], v31, s[72:75], s93 offen
v_mfma_f32_16x16x32_bf16 v[140:143], a[224:227], a[12:15], 0
buffer_load_dwordx4 v[52:55], v31, s[72:75], s94 offen
v_mfma_f32_16x16x32_bf16 v[144:147], a[228:231], a[0:3], 0
ds_read_b128 a[236:239], v2 offset:6144
v_mfma_f32_16x16x32_bf16 v[148:151], a[228:231], a[4:7], 0
v_mfma_f32_16x16x32_bf16 v[152:155], a[228:231], a[8:11], 0
s_add_u32 m0, s33, 81920
v_mfma_f32_16x16x32_bf16 v[156:159], a[228:231], a[12:15], 0
s_waitcnt lgkmcnt(1)
v_mfma_f32_16x16x32_bf16 v[160:163], a[232:235], a[0:3], 0
ds_read_b128 a[240:243], v2 offset:8192
buffer_load_dwordx4 v8, s[20:23], s41 offen lds
v_mfma_f32_16x16x32_bf16 v[164:167], a[232:235], a[4:7], 0
v_mfma_f32_16x16x32_bf16 v[168:171], a[232:235], a[8:11], 0
s_add_u32 m0, s33, 86016
v_mfma_f32_16x16x32_bf16 v[172:175], a[232:235], a[12:15], 0
s_waitcnt lgkmcnt(1)
v_mfma_f32_16x16x32_bf16 v[176:179], a[236:239], a[0:3], 0
ds_read_b128 a[244:247], v2 offset:10240
buffer_load_dwordx4 v9, s[20:23], s41 offen lds
v_mfma_f32_16x16x32_bf16 v[180:183], a[236:239], a[4:7], 0
v_mfma_f32_16x16x32_bf16 v[184:187], a[236:239], a[8:11], 0
s_add_u32 m0, s33, 90112
v_mfma_f32_16x16x32_bf16 v[188:191], a[236:239], a[12:15], 0
s_waitcnt lgkmcnt(1)
v_mfma_f32_16x16x32_bf16 v[192:195], a[240:243], a[0:3], 0
buffer_load_dwordx4 v10, s[20:23], s41 offen lds
v_mfma_f32_16x16x32_bf16 v[196:199], a[240:243], a[4:7], 0
v_mfma_f32_16x16x32_bf16 v[200:203], a[240:243], a[8:11], 0
s_add_u32 m0, s33, 94208
v_mfma_f32_16x16x32_bf16 v[204:207], a[240:243], a[12:15], 0
s_waitcnt lgkmcnt(0)
v_mfma_f32_16x16x32_bf16 v[208:211], a[244:247], a[0:3], 0
ds_read_b128 a[248:251], v2 offset:12288
buffer_load_dwordx4 v11, s[20:23], s41 offen lds
v_mfma_f32_16x16x32_bf16 v[212:215], a[244:247], a[4:7], 0
v_mfma_f32_16x16x32_bf16 v[216:219], a[244:247], a[8:11], 0
v_mfma_f32_16x16x32_bf16 v[220:223], a[244:247], a[12:15], 0
s_waitcnt vmcnt(10)
ds_read_b128 a[252:255], v2 offset:14336
v_lshl_add_u64 v[80:81], v[84:85], 4, v[80:81]
v_lshl_add_u64 v[82:83], v[86:87], 4, v[82:83]
v_lshl_add_u32 v80, v80, 8, v19
v_lshl_add_u32 v81, v81, 8, v19
v_lshl_add_u32 v82, v82, 8, v19
v_lshl_add_u32 v83, v83, 8, v19
ds_read_b32 a16, v80
ds_read_b32 a20, v81
ds_read_b32 a24, v82
ds_read_b32 a28, v83
s_waitcnt vmcnt(8)
v_lshl_add_u64 v[88:89], v[92:93], 4, v[88:89]
v_lshl_add_u64 v[90:91], v[94:95], 4, v[90:91]
v_lshl_add_u32 v88, v88, 8, v19
v_lshl_add_u32 v89, v89, 8, v19
v_lshl_add_u32 v90, v90, 8, v19
v_lshl_add_u32 v91, v91, 8, v19
ds_read_b32 a17, v88
ds_read_b32 a21, v89
ds_read_b32 a25, v90
ds_read_b32 a29, v91
s_waitcnt vmcnt(6)
buffer_load_dwordx4 v[32:35], v12, s[24:27], 0 offen offset:0 sc1
v_lshl_add_u64 v[40:41], v[44:45], 4, v[40:41]
v_lshl_add_u64 v[42:43], v[46:47], 4, v[42:43]
v_lshl_add_u32 v40, v40, 8, v19
v_lshl_add_u32 v41, v41, 8, v19
v_lshl_add_u32 v42, v42, 8, v19
v_lshl_add_u32 v43, v43, 8, v19
ds_read_b32 a18, v40
ds_read_b32 a22, v41
ds_read_b32 a26, v42
ds_read_b32 a30, v43
s_waitcnt vmcnt(5) lgkmcnt(13)
buffer_load_dwordx4 v[36:39], v12, s[24:27], 0 offen offset:1024 sc1
v_lshl_add_u64 v[48:49], v[52:53], 4, v[48:49]
v_lshl_add_u64 v[50:51], v[54:55], 4, v[50:51]
v_lshl_add_u32 v48, v48, 8, v19
v_lshl_add_u32 v49, v49, 8, v19
v_lshl_add_u32 v50, v50, 8, v19
v_lshl_add_u32 v51, v51, 8, v19
ds_read_b32 a19, v48
ds_read_b32 a23, v49
ds_read_b32 a27, v50
ds_read_b32 a31, v51
v_mfma_f32_16x16x32_bf16 v[224:227], a[248:251], a[0:3], 0
ds_read_b128 a[224:227], v4 offset:0
v_mfma_f32_16x16x32_bf16 v[228:231], a[248:251], a[4:7], 0
v_mfma_f32_16x16x32_bf16 v[232:235], a[248:251], a[8:11], 0
global_load_dwordx2 v[20:21], v28, s[8:9]
v_mfma_f32_16x16x32_bf16 v[236:239], a[248:251], a[12:15], 0
s_waitcnt lgkmcnt(5)
v_mfma_f32_16x16x32_bf16 v[240:243], a[252:255], a[0:3], 0
ds_read_b128 a[228:231], v4 offset:2048
v_mfma_f32_16x16x32_bf16 v[244:247], a[252:255], a[4:7], 0
v_mfma_f32_16x16x32_bf16 v[248:251], a[252:255], a[8:11], 0
v_mfma_f32_16x16x32_bf16 v[252:255], a[252:255], a[12:15], 0
s_waitcnt lgkmcnt(1)
v_mfma_f32_16x16x32_bf16 v[128:131], a[224:227], a[16:19], v[128:131]
ds_read_b128 a[232:235], v4 offset:4096
v_mfma_f32_16x16x32_bf16 v[132:135], a[224:227], a[20:23], v[132:135]
v_mfma_f32_16x16x32_bf16 v[136:139], a[224:227], a[24:27], v[136:139]
buffer_load_dwordx4 v[40:43], v12, s[24:27], 0 offen offset:2048 sc1
v_mfma_f32_16x16x32_bf16 v[140:143], a[224:227], a[28:31], v[140:143]
s_waitcnt lgkmcnt(1)
buffer_load_dwordx4 v[44:47], v12, s[24:27], 0 offen offset:3072 sc1
v_mfma_f32_16x16x32_bf16 v[144:147], a[228:231], a[16:19], v[144:147]
ds_read_b128 a[236:239], v4 offset:6144
v_lshl_add_u32 v12, s42, 5, v13
v_mfma_f32_16x16x32_bf16 v[148:151], a[228:231], a[20:23], v[148:151]
v_mfma_f32_16x16x32_bf16 v[152:155], a[228:231], a[24:27], v[152:155]
v_mfma_f32_16x16x32_bf16 v[156:159], a[228:231], a[28:31], v[156:159]
s_waitcnt lgkmcnt(1)
v_mfma_f32_16x16x32_bf16 v[160:163], a[232:235], a[16:19], v[160:163]
ds_read_b128 a[240:243], v4 offset:8192
v_mfma_f32_16x16x32_bf16 v[164:167], a[232:235], a[20:23], v[164:167]
v_mfma_f32_16x16x32_bf16 v[168:171], a[232:235], a[24:27], v[168:171]
v_mfma_f32_16x16x32_bf16 v[172:175], a[232:235], a[28:31], v[172:175]
s_waitcnt lgkmcnt(1)
v_mfma_f32_16x16x32_bf16 v[176:179], a[236:239], a[16:19], v[176:179]
ds_read_b128 a[244:247], v4 offset:10240
buffer_load_dwordx4 v[48:51], v12, s[24:27], 0 offen offset:0 sc1
v_mfma_f32_16x16x32_bf16 v[180:183], a[236:239], a[20:23], v[180:183]
buffer_load_dwordx4 v[52:55], v12, s[24:27], 0 offen offset:1024 sc1
v_mfma_f32_16x16x32_bf16 v[184:187], a[236:239], a[24:27], v[184:187]
s_add_u32 m0, s33, 98304
v_mfma_f32_16x16x32_bf16 v[188:191], a[236:239], a[28:31], v[188:191]
s_waitcnt lgkmcnt(1)
v_mfma_f32_16x16x32_bf16 v[192:195], a[240:243], a[16:19], v[192:195]
buffer_load_dwordx4 v8, s[20:23], s42 offen lds
v_mfma_f32_16x16x32_bf16 v[196:199], a[240:243], a[20:23], v[196:199]
v_mfma_f32_16x16x32_bf16 v[200:203], a[240:243], a[24:27], v[200:203]
s_add_u32 m0, s33, 102400
v_mfma_f32_16x16x32_bf16 v[204:207], a[240:243], a[28:31], v[204:207]
s_waitcnt lgkmcnt(0)
v_mfma_f32_16x16x32_bf16 v[208:211], a[244:247], a[16:19], v[208:211]
s_waitcnt vmcnt(8)
s_barrier
ds_read_b128 a[248:251], v4 offset:12288
buffer_load_dwordx4 v9, s[20:23], s42 offen lds
v_mfma_f32_16x16x32_bf16 v[212:215], a[244:247], a[20:23], v[212:215]
buffer_load_dwordx4 v[96:99], v12, s[24:27], 0 offen offset:2048 sc1
v_mfma_f32_16x16x32_bf16 v[216:219], a[244:247], a[24:27], v[216:219]
buffer_load_dwordx4 v[100:103], v12, s[24:27], 0 offen offset:3072 sc1
v_lshl_add_u32 v12, s43, 5, v13
v_mfma_f32_16x16x32_bf16 v[220:223], a[244:247], a[28:31], v[220:223]
s_add_u32 m0, s33, 106496
ds_read_b128 a[252:255], v4 offset:14336
buffer_load_dwordx4 v10, s[20:23], s42 offen lds
s_waitcnt vmcnt(10)
v_cmp_ne_u64 s[50:51], s[88:89], v[34:35]
v_cmp_ne_u64 s[44:45], s[88:89], v[38:39]
s_or_b64 s[50:51], s[44:45], s[50:51]
s_cbranch_scc1 L_SLOW2
L_BACK2:
v_perm_b32 v64, v32, v19, s52
v_perm_b32 v65, v32, v19, s53
v_perm_b32 v66, v36, v19, s52
v_perm_b32 v67, v36, v19, s53
v_perm_b32 v68, v32, v19, s54
v_perm_b32 v69, v32, v19, s55
v_perm_b32 v70, v36, v19, s54
v_perm_b32 v71, v36, v19, s55
ds_read_b32 a32, v64
ds_read_b32 a33, v65
ds_read_b32 a34, v66
ds_read_b32 a35, v67
ds_read_b32 a36, v68
ds_read_b32 a37, v69
ds_read_b32 a38, v70
ds_read_b32 a39, v71
v_perm_b32 v72, v33, v19, s52
v_perm_b32 v73, v33, v19, s53
v_perm_b32 v74, v37, v19, s52
v_perm_b32 v75, v37, v19, s53
v_perm_b32 v76, v33, v19, s54
v_perm_b32 v77, v33, v19, s55
v_perm_b32 v78, v37, v19, s54
v_perm_b32 v79, v37, v19, s55
ds_read_b32 a40, v72
ds_read_b32 a41, v73
ds_read_b32 a42, v74
ds_read_b32 a43, v75
ds_read_b32 a44, v76
ds_read_b32 a45, v77
ds_read_b32 a46, v78
ds_read_b32 a47, v79
s_add_u32 m0, s33, 110592
s_waitcnt lgkmcnt(15)
v_mfma_f32_16x16x32_bf16 v[224:227], a[248:251], a[16:19], v[224:227]
ds_read_b128 a[224:227], v14 offset:16384
buffer_load_dwordx4 v11, s[20:23], s42 offen lds
v_mfma_f32_16x16x32_bf16 v[228:231], a[248:251], a[20:23], v[228:231]
v_mfma_f32_16x16x32_bf16 v[232:235], a[248:251], a[24:27], v[232:235]
s_add_u32 m0, s33, 114688
v_mfma_f32_16x16x32_bf16 v[236:239], a[248:251], a[28:31], v[236:239]
v_mfma_f32_16x16x32_bf16 v[240:243], a[252:255], a[16:19], v[240:243]
ds_read_b128 a[228:231], v14 offset:18432
buffer_load_dwordx4 v8, s[20:23], s43 offen lds
v_mfma_f32_16x16x32_bf16 v[244:247], a[252:255], a[20:23], v[244:247]
v_mfma_f32_16x16x32_bf16 v[248:251], a[252:255], a[24:27], v[248:251]
s_waitcnt vmcnt(9)
s_add_u32 m0, s33, 118784
v_cmp_ne_u64 s[50:51], s[88:89], v[42:43]
v_cmp_ne_u64 s[44:45], s[88:89], v[46:47]
v_mfma_f32_16x16x32_bf16 v[252:255], a[252:255], a[28:31], v[252:255]
s_waitcnt lgkmcnt(1)
v_mfma_f32_16x16x32_bf16 v[128:131], a[224:227], a[32:35], v[128:131]
s_or_b64 s[50:51], s[44:45], s[50:51]
ds_read_b128 a[232:235], v14 offset:20480
buffer_load_dwordx4 v9, s[20:23], s43 offen lds
v_mfma_f32_16x16x32_bf16 v[132:135], a[224:227], a[36:39], v[132:135]
s_cbranch_scc1 L_SLOW3
L_BACK3:
v_mfma_f32_16x16x32_bf16 v[136:139], a[224:227], a[40:43], v[136:139]
s_add_u32 m0, s33, 122880
v_perm_b32 v63, v40, v19, s52
v_mfma_f32_16x16x32_bf16 v[140:143], a[224:227], a[44:47], v[140:143]
s_waitcnt lgkmcnt(1)
ds_read_b32 a48, v63
v_perm_b32 v62, v40, v19, s53
v_mfma_f32_16x16x32_bf16 v[144:147], a[228:231], a[32:35], v[144:147]
ds_read_b128 a[236:239], v14 offset:22528
buffer_load_dwordx4 v10, s[20:23], s43 offen lds
v_mfma_f32_16x16x32_bf16 v[148:151], a[228:231], a[36:39], v[148:151]
ds_read_b32 a49, v62
v_perm_b32 v61, v44, v19, s52
v_mfma_f32_16x16x32_bf16 v[152:155], a[228:231], a[40:43], v[152:155]
s_add_u32 m0, s33, 126976
ds_read_b32 a50, v61
v_perm_b32 v60, v44, v19, s53
v_mfma_f32_16x16x32_bf16 v[156:159], a[228:231], a[44:47], v[156:159]
s_waitcnt lgkmcnt(4)
ds_read_b32 a51, v60
v_perm_b32 v59, v40, v19, s54
v_mfma_f32_16x16x32_bf16 v[160:163], a[232:235], a[32:35], v[160:163]
ds_read_b128 a[240:243], v14 offset:24576
buffer_load_dwordx4 v11, s[20:23], s43 offen lds
v_mfma_f32_16x16x32_bf16 v[164:167], a[232:235], a[36:39], v[164:167]
ds_read_b32 a52, v59
v_perm_b32 v58, v40, v19, s55
v_mfma_f32_16x16x32_bf16 v[168:171], a[232:235], a[40:43], v[168:171]
ds_read_b32 a53, v58
v_perm_b32 v57, v44, v19, s54
v_mfma_f32_16x16x32_bf16 v[172:175], a[232:235], a[44:47], v[172:175]
s_waitcnt lgkmcnt(4)
ds_read_b32 a54, v57
buffer_load_dwordx4 v[80:83], v12, s[24:27], 0 offen offset:0 sc1
v_mfma_f32_16x16x32_bf16 v[176:179], a[236:239], a[32:35], v[176:179]
ds_read_b128 a[244:247], v14 offset:26624
v_perm_b32 v56, v44, v19, s55
v_mfma_f32_16x16x32_bf16 v[180:183], a[236:239], a[36:39], v[180:183]
ds_read_b32 a55, v56
v_perm_b32 v63, v41, v19, s52
v_mfma_f32_16x16x32_bf16 v[184:187], a[236:239], a[40:43], v[184:187]
ds_read_b32 a56, v63
v_perm_b32 v62, v41, v19, s53
v_mfma_f32_16x16x32_bf16 v[188:191], a[236:239], a[44:47], v[188:191]
s_waitcnt lgkmcnt(4)
ds_read_b32 a57, v62
buffer_load_dwordx4 v[84:87], v12, s[24:27], 0 offen offset:1024 sc1
v_mfma_f32_16x16x32_bf16 v[192:195], a[240:243], a[32:35], v[192:195]
ds_read_b128 a[248:251], v14 offset:28672
v_perm_b32 v61, v45, v19, s52
v_mfma_f32_16x16x32_bf16 v[196:199], a[240:243], a[36:39], v[196:199]
ds_read_b32 a58, v61
v_perm_b32 v60, v45, v19, s53
v_mfma_f32_16x16x32_bf16 v[200:203], a[240:243], a[40:43], v[200:203]
s_add_u32 m0, s33, 130560
ds_read_b32 a59, v60
v_perm_b32 v59, v41, v19, s54
v_mfma_f32_16x16x32_bf16 v[204:207], a[240:243], a[44:47], v[204:207]
s_waitcnt lgkmcnt(4)
ds_read_b32 a60, v59
v_perm_b32 v58, v41, v19, s55
v_mfma_f32_16x16x32_bf16 v[208:211], a[244:247], a[32:35], v[208:211]
ds_read_b128 a[252:255], v14 offset:30720
buffer_load_dwordx4 v8, s[20:23], 0 offen offset:512 lds
v_mfma_f32_16x16x32_bf16 v[212:215], a[244:247], a[36:39], v[212:215]
ds_read_b32 a61, v58
v_perm_b32 v57, v45, v19, s54
v_mfma_f32_16x16x32_bf16 v[216:219], a[244:247], a[40:43], v[216:219]
ds_read_b32 a62, v57
v_perm_b32 v56, v45, v19, s55
s_mov_b64 vcc, -1
s_cmp_eq_u32 s36, 0
s_cbranch_scc1 L_PAD1
s_cmp_eq_u32 s36, 1
s_cbranch_scc1 L_PAD3
s_cmp_eq_u32 s36, 2
s_cbranch_scc1 L_PAD5
s_cmp_eq_u32 s36, 3
s_cbranch_scc1 L_PADS
L_PADRET:
s_mov_b64 vcc, 0
v_mfma_f32_16x16x32_bf16 v[220:223], a[244:247], a[44:47], v[220:223]
s_waitcnt lgkmcnt(4)
ds_read_b32 a63, v56
v_mfma_f32_16x16x32_bf16 v[224:227], a[248:251], a[32:35], v[224:227]
ds_read_b128 a[224:227], v15 offset:16384
v_mfma_f32_16x16x32_bf16 v[228:231], a[248:251], a[36:39], v[228:231]
buffer_load_dwordx4 v[104:107], v30, s[16:19], 0 offen
v_mfma_f32_16x16x32_bf16 v[232:235], a[248:251], a[40:43], v[232:235]
s_waitcnt vmcnt(14)
v_cmp_ne_u64 s[50:51], s[88:89], v[50:51]
v_cmp_ne_u64 s[44:45], s[88:89], v[54:55]
v_mfma_f32_16x16x32_bf16 v[236:239], a[248:251], a[44:47], v[236:239]
s_waitcnt lgkmcnt(2)
v_mfma_f32_16x16x32_bf16 v[240:243], a[252:255], a[32:35], v[240:243]
s_or_b64 s[50:51], s[44:45], s[50:51]
ds_read_b128 a[228:231], v15 offset:18432
v_lshlrev_b32 v24, 16, v20
v_mfma_f32_16x16x32_bf16 v[244:247], a[252:255], a[36:39], v[244:247]
s_cbranch_scc1 L_SLOW4
L_BACK4:
v_mfma_f32_16x16x32_bf16 v[248:251], a[252:255], a[40:43], v[248:251]
v_perm_b32 v63, v48, v19, s52
v_and_b32 v25, 0xffff0000, v20
v_mfma_f32_16x16x32_bf16 v[252:255], a[252:255], a[44:47], v[252:255]
s_waitcnt lgkmcnt(1)
ds_read_b32 a64, v63
buffer_load_dwordx4 v[88:91], v12, s[24:27], 0 offen offset:2048 sc1
v_mfma_f32_16x16x32_bf16 v[128:131], a[224:227], a[48:51], v[128:131]
ds_read_b128 a[232:235], v15 offset:20480
v_perm_b32 v62, v48, v19, s53
v_mfma_f32_16x16x32_bf16 v[132:135], a[224:227], a[52:55], v[132:135]
buffer_load_dwordx4 v[108:111], v30, s[16:19], s92 offen
v_mfma_f32_16x16x32_bf16 v[136:139], a[224:227], a[56:59], v[136:139]
ds_read_b32 a65, v62
v_perm_b32 v61, v52, v19, s52
v_mfma_f32_16x16x32_bf16 v[140:143], a[224:227], a[60:63], v[140:143]
s_waitcnt lgkmcnt(3)
ds_read_b32 a66, v61
buffer_load_dwordx4 v[92:95], v12, s[24:27], 0 offen offset:3072 sc1
v_mfma_f32_16x16x32_bf16 v[144:147], a[228:231], a[48:51], v[144:147]
ds_read_b128 a[236:239], v15 offset:22528
v_perm_b32 v60, v52, v19, s53
v_mfma_f32_16x16x32_bf16 v[148:151], a[228:231], a[52:55], v[148:151]
ds_read_b32 a67, v60
v_perm_b32 v59, v48, v19, s54
v_mfma_f32_16x16x32_bf16 v[152:155], a[228:231], a[56:59], v[152:155]
ds_read_b32 a68, v59
v_perm_b32 v58, v48, v19, s55
v_mfma_f32_16x16x32_bf16 v[156:159], a[228:231], a[60:63], v[156:159]
s_waitcnt lgkmcnt(4)
ds_read_b32 a69, v58
v_add_u32 v12, 16384, v13
v_mfma_f32_16x16x32_bf16 v[160:163], a[232:235], a[48:51], v[160:163]
ds_read_b128 a[240:243], v15 offset:24576
v_perm_b32 v57, v52, v19, s54
v_mfma_f32_16x16x32_bf16 v[164:167], a[232:235], a[52:55], v[164:167]
buffer_load_dwordx4 v[112:115], v30, s[16:19], s93 offen
v_mfma_f32_16x16x32_bf16 v[168:171], a[232:235], a[56:59], v[168:171]
s_add_u32 m0, s33, 134656
ds_read_b32 a70, v57
v_perm_b32 v56, v52, v19, s55
v_mfma_f32_16x16x32_bf16 v[172:175], a[232:235], a[60:63], v[172:175]
s_waitcnt lgkmcnt(3)
ds_read_b32 a71, v56
v_perm_b32 v63, v49, v19, s52
v_mfma_f32_16x16x32_bf16 v[176:179], a[236:239], a[48:51], v[176:179]
ds_read_b128 a[244:247], v15 offset:26624
buffer_load_dwordx4 v9, s[20:23], 0 offen offset:512 lds
v_mfma_f32_16x16x32_bf16 v[180:183], a[236:239], a[52:55], v[180:183]
ds_read_b32 a72, v63
v_perm_b32 v62, v49, v19, s53
v_mfma_f32_16x16x32_bf16 v[184:187], a[236:239], a[56:59], v[184:187]
ds_read_b32 a73, v62
v_perm_b32 v61, v53, v19, s52
v_mfma_f32_16x16x32_bf16 v[188:191], a[236:239], a[60:63], v[188:191]
s_waitcnt lgkmcnt(4)
ds_read_b32 a74, v61
v_lshlrev_b32 v26, 16, v21
v_mfma_f32_16x16x32_bf16 v[192:195], a[240:243], a[48:51], v[192:195]
s_waitcnt vmcnt(12)
s_barrier
ds_read_b128 a[248:251], v15 offset:28672
v_perm_b32 v60, v53, v19, s53
v_mfma_f32_16x16x32_bf16 v[196:199], a[240:243], a[52:55], v[196:199]
buffer_load_dwordx4 v[116:119], v30, s[16:19], s94 offen
v_mfma_f32_16x16x32_bf16 v[200:203], a[240:243], a[56:59], v[200:203]
ds_read_b32 a75, v60
v_perm_b32 v59, v49, v19, s54
v_mfma_f32_16x16x32_bf16 v[204:207], a[240:243], a[60:63], v[204:207]
s_waitcnt lgkmcnt(3)
ds_read_b32 a76, v59
v_and_b32 v27, 0xffff0000, v21
v_mfma_f32_16x16x32_bf16 v[208:211], a[244:247], a[48:51], v[208:211]
ds_read_b128 a[252:255], v15 offset:30720
v_perm_b32 v58, v49, v19, s55
v_mfma_f32_16x16x32_bf16 v[212:215], a[244:247], a[52:55], v[212:215]
ds_read_b32 a77, v58
v_perm_b32 v57, v53, v19, s54
v_mfma_f32_16x16x32_bf16 v[216:219], a[244:247], a[56:59], v[216:219]
v_cmp_ne_u64 s[50:51], s[88:89], v[98:99]
v_cmp_ne_u64 s[44:45], s[88:89], v[102:103]
v_mfma_f32_16x16x32_bf16 v[220:223], a[244:247], a[60:63], v[220:223]
s_waitcnt lgkmcnt(3)
ds_read_b32 a78, v57
v_mfma_f32_16x16x32_bf16 v[224:227], a[248:251], a[48:51], v[224:227]
s_or_b64 s[50:51], s[44:45], s[50:51]
ds_read_b128 a[224:227], v14 offset:32768
v_perm_b32 v56, v53, v19, s55
v_mfma_f32_16x16x32_bf16 v[228:231], a[248:251], a[52:55], v[228:231]
s_cbranch_scc1 L_SLOW5
L_BACK5:
v_mfma_f32_16x16x32_bf16 v[232:235], a[248:251], a[56:59], v[232:235]
s_add_u32 m0, s33, 138752
ds_read_b32 a79, v56
v_mfma_f32_16x16x32_bf16 v[236:239], a[248:251], a[60:63], v[236:239]
s_waitcnt lgkmcnt(3)
v_perm_b32 v63, v96, v19, s52
v_mfma_f32_16x16x32_bf16 v[240:243], a[252:255], a[48:51], v[240:243]
ds_read_b128 a[228:231], v14 offset:34816
buffer_load_dwordx4 v10, s[20:23], 0 offen offset:512 lds
v_mfma_f32_16x16x32_bf16 v[244:247], a[252:255], a[52:55], v[244:247]
ds_read_b32 a80, v63
v_perm_b32 v62, v96, v19, s53
v_mfma_f32_16x16x32_bf16 v[248:251], a[252:255], a[56:59], v[248:251]
ds_read_b32 a81, v62
v_perm_b32 v61, v100, v19, s52
v_mfma_f32_16x16x32_bf16 v[252:255], a[252:255], a[60:63], v[252:255]
s_waitcnt lgkmcnt(3)
ds_read_b32 a82, v61
buffer_load_dwordx4 v[32:35], v12, s[24:27], 0 offen offset:0 sc1
v_mfma_f32_16x16x32_bf16 v[128:131], a[224:227], a[64:67], v[128:131]
ds_read_b128 a[232:235], v14 offset:36864
v_perm_b32 v60, v100, v19, s53
v_mfma_f32_16x16x32_bf16 v[132:135], a[224:227], a[68:71], v[132:135]
ds_read_b32 a83, v60
v_perm_b32 v59, v96, v19, s54
v_mfma_f32_16x16x32_bf16 v[136:139], a[224:227], a[72:75], v[136:139]
ds_read_b32 a84, v59
v_perm_b32 v58, v96, v19, s55
v_mfma_f32_16x16x32_bf16 v[140:143], a[224:227], a[76:79], v[140:143]
s_waitcnt lgkmcnt(4)
ds_read_b32 a85, v58
buffer_load_dwordx4 v[36:39], v12, s[24:27], 0 offen offset:1024 sc1
v_mfma_f32_16x16x32_bf16 v[144:147], a[228:231], a[64:67], v[144:147]
ds_read_b128 a[236:239], v14 offset:38912
v_perm_b32 v57, v100, v19, s54
v_mfma_f32_16x16x32_bf16 v[148:151], a[228:231], a[68:71], v[148:151]
ds_read_b32 a86, v57
v_perm_b32 v56, v100, v19, s55
v_mfma_f32_16x16x32_bf16 v[152:155], a[228:231], a[72:75], v[152:155]
s_add_u32 m0, s33, 142848
ds_read_b32 a87, v56
v_perm_b32 v63, v97, v19, s52
v_mfma_f32_16x16x32_bf16 v[156:159], a[228:231], a[76:79], v[156:159]
s_waitcnt lgkmcnt(4)
ds_read_b32 a88, v63
v_perm_b32 v62, v97, v19, s53
v_mfma_f32_16x16x32_bf16 v[160:163], a[232:235], a[64:67], v[160:163]
ds_read_b128 a[240:243], v14 offset:40960
buffer_load_dwordx4 v11, s[20:23], 0 offen offset:512 lds
v_mfma_f32_16x16x32_bf16 v[164:167], a[232:235], a[68:71], v[164:167]
ds_read_b32 a89, v62
v_perm_b32 v61, v101, v19, s52
v_mfma_f32_16x16x32_bf16 v[168:171], a[232:235], a[72:75], v[168:171]
ds_read_b32 a90, v61
v_perm_b32 v60, v101, v19, s53
v_mfma_f32_16x16x32_bf16 v[172:175], a[232:235], a[76:79], v[172:175]
s_waitcnt lgkmcnt(4)
ds_read_b32 a91, v60
v_mfma_f32_16x16x32_bf16 v[176:179], a[236:239], a[64:67], v[176:179]
ds_read_b128 a[244:247], v14 offset:43008
v_perm_b32 v59, v97, v19, s54
v_mfma_f32_16x16x32_bf16 v[180:183], a[236:239], a[68:71], v[180:183]
ds_read_b32 a92, v59
v_perm_b32 v58, v97, v19, s55
v_mfma_f32_16x16x32_bf16 v[184:187], a[236:239], a[72:75], v[184:187]
s_waitcnt vmcnt(12)
v_cmp_ne_u64 s[50:51], s[88:89], v[82:83]
v_cmp_ne_u64 s[44:45], s[88:89], v[86:87]
v_mfma_f32_16x16x32_bf16 v[188:191], a[236:239], a[76:79], v[188:191]
s_waitcnt lgkmcnt(3)
ds_read_b32 a93, v58
v_mfma_f32_16x16x32_bf16 v[192:195], a[240:243], a[64:67], v[192:195]
s_or_b64 s[50:51], s[44:45], s[50:51]
ds_read_b128 a[248:251], v14 offset:45056
v_perm_b32 v57, v101, v19, s54
v_mfma_f32_16x16x32_bf16 v[196:199], a[240:243], a[68:71], v[196:199]
s_cbranch_scc1 L_SLOW6
L_BACK6:
v_mfma_f32_16x16x32_bf16 v[200:203], a[240:243], a[72:75], v[200:203]
s_add_u32 m0, s33, 146816
ds_read_b32 a94, v57
v_perm_b32 v56, v101, v19, s55
v_mfma_f32_16x16x32_bf16 v[204:207], a[240:243], a[76:79], v[204:207]
s_waitcnt lgkmcnt(3)
ds_read_b32 a95, v56
v_perm_b32 v63, v80, v19, s52
v_mfma_f32_16x16x32_bf16 v[208:211], a[244:247], a[64:67], v[208:211]
ds_read_b128 a[252:255], v14 offset:47104
buffer_load_dwordx4 v8, s[20:23], 0 offen offset:640 lds
v_mfma_f32_16x16x32_bf16 v[212:215], a[244:247], a[68:71], v[212:215]
L_PAD1:
s_cbranch_vccnz L_PAD2
ds_read_b32 a96, v63
v_perm_b32 v62, v80, v19, s53
v_mfma_f32_16x16x32_bf16 v[216:219], a[244:247], a[72:75], v[216:219]
ds_read_b32 a97, v62
v_perm_b32 v61, v84, v19, s52
v_mfma_f32_16x16x32_bf16 v[220:223], a[244:247], a[76:79], v[220:223]
s_waitcnt lgkmcnt(4)
ds_read_b32 a98, v61
v_mfma_f32_16x16x32_bf16 v[224:227], a[248:251], a[64:67], v[224:227]
ds_read_b128 a[224:227], v15 offset:32768
v_perm_b32 v60, v84, v19, s53
v_mfma_f32_16x16x32_bf16 v[228:231], a[248:251], a[68:71], v[228:231]
ds_read_b32 a99, v60
v_perm_b32 v59, v80, v19, s54
v_mfma_f32_16x16x32_bf16 v[232:235], a[248:251], a[72:75], v[232:235]
ds_read_b32 a100, v59
v_perm_b32 v58, v80, v19, s55
v_mfma_f32_16x16x32_bf16 v[236:239], a[248:251], a[76:79], v[236:239]
s_waitcnt lgkmcnt(4)
ds_read_b32 a101, v58
v_mfma_f32_16x16x32_bf16 v[240:243], a[252:255], a[64:67], v[240:243]
ds_read_b128 a[228:231], v15 offset:36864
v_perm_b32 v57, v84, v19, s54
v_mfma_f32_16x16x32_bf16 v[244:247], a[252:255], a[68:71], v[244:247]
ds_read_b32 a102, v57
v_perm_b32 v56, v84, v19, s55
v_mfma_f32_16x16x32_bf16 v[248:251], a[252:255], a[72:75], v[248:251]
ds_read_b32 a103, v56
v_perm_b32 v63, v81, v19, s52
v_mfma_f32_16x16x32_bf16 v[252:255], a[252:255], a[76:79], v[252:255]
s_waitcnt lgkmcnt(4)
ds_read_b32 a104, v63
v_mfma_f32_16x16x32_bf16 v[128:131], a[224:227], a[80:83], v[128:131]
ds_read_b128 a[232:235], v15 offset:40960
v_perm_b32 v62, v81, v19, s53
v_mfma_f32_16x16x32_bf16 v[132:135], a[224:227], a[84:87], v[132:135]
ds_read_b32 a105, v62
v_perm_b32 v61, v85, v19, s52
v_mfma_f32_16x16x32_bf16 v[136:139], a[224:227], a[88:91], v[136:139]
ds_read_b32 a106, v61
v_perm_b32 v60, v85, v19, s53
v_mfma_f32_16x16x32_bf16 v[140:143], a[224:227], a[92:95], v[140:143]
s_waitcnt lgkmcnt(4)
ds_read_b32 a107, v60
buffer_load_dwordx4 v[40:43], v12, s[24:27], 0 offen offset:2048 sc1
v_mfma_f32_16x16x32_bf16 v[160:163], a[228:231], a[80:83], v[160:163]
ds_read_b128 a[236:239], v15 offset:45056
v_perm_b32 v59, v81, v19, s54
v_mfma_f32_16x16x32_bf16 v[164:167], a[228:231], a[84:87], v[164:167]
ds_read_b32 a108, v59
v_perm_b32 v58, v81, v19, s55
v_mfma_f32_16x16x32_bf16 v[168:171], a[228:231], a[88:91], v[168:171]
ds_read_b32 a109, v58
v_perm_b32 v57, v85, v19, s54
v_mfma_f32_16x16x32_bf16 v[172:175], a[228:231], a[92:95], v[172:175]
s_waitcnt lgkmcnt(4)
ds_read_b32 a110, v57
buffer_load_dwordx4 v[44:47], v12, s[24:27], 0 offen offset:3072 sc1
v_mfma_f32_16x16x32_bf16 v[192:195], a[232:235], a[80:83], v[192:195]
ds_read_b128 a[240:243], v15 offset:34816
v_perm_b32 v56, v85, v19, s55
v_mfma_f32_16x16x32_bf16 v[196:199], a[232:235], a[84:87], v[196:199]
ds_read_b32 a111, v56
v_add_u32 v12, 20480, v13
v_mfma_f32_16x16x32_bf16 v[200:203], a[232:235], a[88:91], v[200:203]
s_add_u32 m0, s33, 150912
ds_read_b128 a[244:247], v14 offset:51200
v_mfma_f32_16x16x32_bf16 v[204:207], a[232:235], a[92:95], v[204:207]
s_waitcnt vmcnt(10) lgkmcnt(4)
v_cmp_ne_u64 s[50:51], s[88:89], v[90:91]
v_cmp_ne_u64 s[44:45], s[88:89], v[94:95]
v_mfma_f32_16x16x32_bf16 v[224:227], a[236:239], a[80:83], v[224:227]
buffer_load_dwordx4 v9, s[20:23], 0 offen offset:640 lds
v_mfma_f32_16x16x32_bf16 v[228:231], a[236:239], a[84:87], v[228:231]
s_or_b64 s[50:51], s[44:45], s[50:51]
v_mfma_f32_16x16x32_bf16 v[232:235], a[236:239], a[88:91], v[232:235]
s_cbranch_scc1 L_SLOW7
L_BACK7:
v_mfma_f32_16x16x32_bf16 v[236:239], a[236:239], a[92:95], v[236:239]
s_waitcnt lgkmcnt(0)
v_mfma_f32_16x16x32_bf16 v[144:147], a[240:243], a[80:83], v[144:147]
s_barrier
ds_read_b128 a[248:251], v15 offset:38912
v_perm_b32 v63, v88, v19, s52
v_mfma_f32_16x16x32_bf16 v[144:147], a[244:247], a[96:99], v[144:147]
ds_read_b32 a112, v63
v_mfma_f32_16x16x32_bf16 v[148:151], a[244:247], a[100:103], v[148:151]
ds_read_b128 a[252:255], v14 offset:55296
v_perm_b32 v62, v88, v19, s53
v_mfma_f32_16x16x32_bf16 v[148:151], a[240:243], a[84:87], v[148:151]
ds_read_b32 a113, v62
v_perm_b32 v61, v92, v19, s52
v_mfma_f32_16x16x32_bf16 v[152:155], a[240:243], a[88:91], v[152:155]
ds_read_b32 a114, v61
v_perm_b32 v60, v92, v19, s53
v_mfma_f32_16x16x32_bf16 v[152:155], a[244:247], a[104:107], v[152:155]
ds_read_b32 a115, v60
v_perm_b32 v59, v88, v19, s54
v_mfma_f32_16x16x32_bf16 v[156:159], a[244:247], a[108:111], v[156:159]
ds_read_b32 a116, v59
v_perm_b32 v58, v88, v19, s55
v_mfma_f32_16x16x32_bf16 v[156:159], a[240:243], a[92:95], v[156:159]
s_waitcnt lgkmcnt(4)
ds_read_b32 a117, v58
v_mfma_f32_16x16x32_bf16 v[176:179], a[248:251], a[80:83], v[176:179]
ds_read_b128 a[224:227], v15 offset:43008
v_perm_b32 v57, v92, v19, s54
v_mfma_f32_16x16x32_bf16 v[176:179], a[252:255], a[96:99], v[176:179]
ds_read_b32 a118, v57
v_mfma_f32_16x16x32_bf16 v[180:183], a[252:255], a[100:103], v[180:183]
ds_read_b128 a[228:231], v14 offset:59392
v_perm_b32 v56, v92, v19, s55
v_mfma_f32_16x16x32_bf16 v[180:183], a[248:251], a[84:87], v[180:183]
s_add_u32 m0, s33, 155008
ds_read_b32 a119, v56
v_mfma_f32_16x16x32_bf16 v[184:187], a[248:251], a[88:91], v[184:187]
buffer_load_dwordx4 v10, s[20:23], 0 offen offset:640 lds
v_perm_b32 v63, v89, v19, s52
v_mfma_f32_16x16x32_bf16 v[184:187], a[252:255], a[104:107], v[184:187]
ds_read_b32 a120, v63
v_perm_b32 v62, v89, v19, s53
v_mfma_f32_16x16x32_bf16 v[188:191], a[252:255], a[108:111], v[188:191]
ds_read_b32 a121, v62
v_perm_b32 v61, v93, v19, s52
v_mfma_f32_16x16x32_bf16 v[188:191], a[248:251], a[92:95], v[188:191]
s_waitcnt lgkmcnt(3)
ds_read_b32 a122, v61
v_mfma_f32_16x16x32_bf16 v[208:211], a[224:227], a[80:83], v[208:211]
ds_read_b128 a[232:235], v15 offset:47104
v_perm_b32 v60, v93, v19, s53
v_mfma_f32_16x16x32_bf16 v[208:211], a[228:231], a[96:99], v[208:211]
s_waitcnt vmcnt(9)
ds_read_b32 a123, v60
v_lshl_add_u64 v[104:105], v[108:109], 4, v[104:105]
v_mfma_f32_16x16x32_bf16 v[212:215], a[228:231], a[100:103], v[212:215]
ds_read_b128 a[236:239], v14 offset:63488
v_perm_b32 v59, v89, v19, s54
v_mfma_f32_16x16x32_bf16 v[212:215], a[224:227], a[84:87], v[212:215]
ds_read_b32 a124, v59
buffer_load_dwordx4 v[48:51], v12, s[24:27], 0 offen offset:0 sc1
v_mfma_f32_16x16x32_bf16 v[216:219], a[224:227], a[88:91], v[216:219]
v_perm_b32 v58, v89, v19, s55
v_lshl_add_u64 v[106:107], v[110:111], 4, v[106:107]
v_mfma_f32_16x16x32_bf16 v[216:219], a[228:231], a[104:107], v[216:219]
ds_read_b32 a125, v58
v_perm_b32 v57, v93, v19, s54
v_mfma_f32_16x16x32_bf16 v[220:223], a[228:231], a[108:111], v[220:223]
s_add_u32 m0, s33, 159104
ds_read_b32 a126, v57
buffer_load_dwordx4 v[52:55], v12, s[24:27], 0 offen offset:1024 sc1
v_mfma_f32_16x16x32_bf16 v[220:223], a[224:227], a[92:95], v[220:223]
s_waitcnt lgkmcnt(3)
v_perm_b32 v56, v93, v19, s55
v_lshl_add_u64 v[112:113], v[116:117], 4, v[112:113]
v_mfma_f32_16x16x32_bf16 v[240:243], a[232:235], a[80:83], v[240:243]
ds_read_b128 a[240:243], v14 offset:49152
buffer_load_dwordx4 v11, s[20:23], 0 offen offset:640 lds
v_mfma_f32_16x16x32_bf16 v[240:243], a[236:239], a[96:99], v[240:243]
ds_read_b32 a127, v56
v_mfma_f32_16x16x32_bf16 v[244:247], a[236:239], a[100:103], v[244:247]
ds_read_b128 a[244:247], v15 offset:49152
v_lshl_add_u64 v[114:115], v[118:119], 4, v[114:115]
v_mfma_f32_16x16x32_bf16 v[244:247], a[232:235], a[84:87], v[244:247]
s_waitcnt vmcnt(9)
v_cmp_ne_u64 s[50:51], s[88:89], v[34:35]
v_cmp_ne_u64 s[44:45], s[88:89], v[38:39]
v_mfma_f32_16x16x32_bf16 v[248:251], a[232:235], a[88:91], v[248:251]
v_mfma_f32_16x16x32_bf16 v[248:251], a[236:239], a[104:107], v[248:251]
s_or_b64 s[50:51], s[44:45], s[50:51]
v_lshl_or_b32 v116, v112, 8, v104
v_mfma_f32_16x16x32_bf16 v[252:255], a[236:239], a[108:111], v[252:255]
s_cbranch_scc1 L_SLOW8
L_BACK8:
v_mfma_f32_16x16x32_bf16 v[252:255], a[232:235], a[92:95], v[252:255]
s_waitcnt lgkmcnt(0)
v_perm_b32 v63, v32, v19, s52
v_mfma_f32_16x16x32_bf16 v[128:131], a[240:243], a[96:99], v[128:131]
ds_read_b128 a[248:251], v14 offset:53248
v_lshl_or_b32 v117, v113, 8, v105
v_mfma_f32_16x16x32_bf16 v[128:131], a[244:247], a[112:115], v[128:131]
ds_read_b32 a128, v63
v_mfma_f32_16x16x32_bf16 v[132:135], a[244:247], a[116:119], v[132:135]
ds_read_b128 a[252:255], v15 offset:53248
v_perm_b32 v62, v32, v19, s53
v_mfma_f32_16x16x32_bf16 v[132:135], a[240:243], a[100:103], v[132:135]
s_add_u32 m0, s33, 64768
ds_read_b32 a129, v62
v_lshl_or_b32 v118, v114, 8, v106
v_mfma_f32_16x16x32_bf16 v[136:139], a[240:243], a[104:107], v[136:139]
buffer_load_dwordx4 v8, s[20:23], 0 offen offset:768 lds
v_perm_b32 v61, v36, v19, s52
v_mfma_f32_16x16x32_bf16 v[136:139], a[244:247], a[120:123], v[136:139]
ds_read_b32 a130, v61
v_mfma_f32_16x16x32_bf16 v[140:143], a[244:247], a[124:127], v[140:143]
v_perm_b32 v60, v36, v19, s53
v_lshl_or_b32 v119, v115, 8, v107
v_mfma_f32_16x16x32_bf16 v[140:143], a[240:243], a[108:111], v[140:143]
s_waitcnt lgkmcnt(2)
ds_read_b32 a131, v60
v_mfma_f32_16x16x32_bf16 v[160:163], a[248:251], a[96:99], v[160:163]
ds_read_b128 a[224:227], v14 offset:57344
v_perm_b32 v59, v32, v19, s54
v_mfma_f32_16x16x32_bf16 v[160:163], a[252:255], a[112:115], v[160:163]
ds_read_b32 a132, v59
v_lshl_or_b32 v108, v117, 16, v116
v_mfma_f32_16x16x32_bf16 v[164:167], a[252:255], a[116:119], v[164:167]
ds_read_b128 a[228:231], v15 offset:57344
v_perm_b32 v58, v32, v19, s55
v_mfma_f32_16x16x32_bf16 v[164:167], a[248:251], a[100:103], v[164:167]
ds_read_b32 a133, v58
v_mfma_f32_16x16x32_bf16 v[168:171], a[248:251], a[104:107], v[168:171]
v_perm_b32 v57, v36, v19, s54
v_lshl_or_b32 v109, v119, 16, v118
v_mfma_f32_16x16x32_bf16 v[168:171], a[252:255], a[120:123], v[168:171]
ds_read_b32 a134, v57
v_perm_b32 v56, v36, v19, s55
v_mfma_f32_16x16x32_bf16 v[172:175], a[252:255], a[124:127], v[172:175]
ds_read_b32 a135, v56
v_perm_b32 v63, v33, v19, s52
v_mfma_f32_16x16x32_bf16 v[172:175], a[248:251], a[108:111], v[172:175]
s_waitcnt lgkmcnt(3)
ds_read_b32 a136, v63
v_mov_b64 v[110:111], s[88:89]
v_mfma_f32_16x16x32_bf16 v[192:195], a[224:227], a[96:99], v[192:195]
ds_read_b128 a[232:235], v14 offset:61440
v_perm_b32 v62, v33, v19, s53
v_mfma_f32_16x16x32_bf16 v[192:195], a[228:231], a[112:115], v[192:195]
ds_read_b32 a137, v62
v_mfma_f32_16x16x32_bf16 v[196:199], a[228:231], a[116:119], v[196:199]
ds_read_b128 a[236:239], v15 offset:61440
v_perm_b32 v61, v37, v19, s52
v_mfma_f32_16x16x32_bf16 v[196:199], a[224:227], a[100:103], v[196:199]
buffer_store_dwordx4 v[108:111], v13, s[76:79], 0 offen sc1
v_mfma_f32_16x16x32_bf16 v[200:203], a[224:227], a[104:107], v[200:203]
ds_read_b32 a138, v61
v_perm_b32 v60, v37, v19, s53
v_mfma_f32_16x16x32_bf16 v[200:203], a[228:231], a[120:123], v[200:203]
ds_read_b32 a139, v60
v_perm_b32 v59, v33, v19, s54
v_mfma_f32_16x16x32_bf16 v[204:207], a[228:231], a[124:127], v[204:207]
ds_read_b32 a140, v59
v_perm_b32 v58, v33, v19, s55
v_mfma_f32_16x16x32_bf16 v[204:207], a[224:227], a[108:111], v[204:207]
s_waitcnt lgkmcnt(3)
ds_read_b32 a141, v58
buffer_load_dwordx4 v[96:99], v12, s[24:27], 0 offen offset:2048 sc1
v_mfma_f32_16x16x32_bf16 v[224:227], a[232:235], a[96:99], v[224:227]
ds_read_b128 a[240:243], v15 offset:51200
v_perm_b32 v57, v37, v19, s54
v_mfma_f32_16x16x32_bf16 v[224:227], a[236:239], a[112:115], v[224:227]
ds_read_b32 a142, v57
buffer_load_dwordx4 v[100:103], v12, s[24:27], 0 offen offset:3072 sc1
v_mfma_f32_16x16x32_bf16 v[228:231], a[236:239], a[116:119], v[228:231]
ds_read_b128 a[244:247], v16 offset:2048
v_perm_b32 v56, v37, v19, s55
v_mfma_f32_16x16x32_bf16 v[228:231], a[232:235], a[100:103], v[228:231]
s_add_u32 m0, s33, 68864
ds_read_b32 a143, v56
v_add_u32 v12, 24576, v13
v_mfma_f32_16x16x32_bf16 v[232:235], a[232:235], a[104:107], v[232:235]
buffer_load_dwordx4 v9, s[20:23], 0 offen offset:768 lds
v_mfma_f32_16x16x32_bf16 v[232:235], a[236:239], a[120:123], v[232:235]
v_mfma_f32_16x16x32_bf16 v[236:239], a[236:239], a[124:127], v[236:239]
v_mfma_f32_16x16x32_bf16 v[236:239], a[232:235], a[108:111], v[236:239]
s_waitcnt vmcnt(10) lgkmcnt(1)
v_cmp_ne_u64 s[50:51], s[88:89], v[42:43]
v_mfma_f32_16x16x32_bf16 v[144:147], a[240:243], a[112:115], v[144:147]
s_barrier
ds_read_b128 a[248:251], v15 offset:55296
v_cmp_ne_u64 s[44:45], s[88:89], v[46:47]
v_mfma_f32_16x16x32_bf16 v[144:147], a[244:247], a[128:131], v[144:147]
v_mfma_f32_16x16x32_bf16 v[148:151], a[244:247], a[132:135], v[148:151]
s_or_b64 s[50:51], s[44:45], s[50:51]
ds_read_b128 a[252:255], v16 offset:6144
v_mfma_f32_16x16x32_bf16 v[148:151], a[240:243], a[116:119], v[148:151]
s_cbranch_scc1 L_SLOW9
L_BACK9:
v_mfma_f32_16x16x32_bf16 v[152:155], a[240:243], a[120:123], v[152:155]
v_perm_b32 v63, v40, v19, s52
v_mfma_f32_16x16x32_bf16 v[152:155], a[244:247], a[136:139], v[152:155]
s_waitcnt lgkmcnt(1)
ds_read_b32 a144, v63
v_perm_b32 v62, v40, v19, s53
v_mfma_f32_16x16x32_bf16 v[156:159], a[244:247], a[140:143], v[156:159]
ds_read_b32 a145, v62
v_perm_b32 v61, v44, v19, s52
v_mfma_f32_16x16x32_bf16 v[156:159], a[240:243], a[124:127], v[156:159]
s_waitcnt lgkmcnt(2)
ds_read_b32 a146, v61
v_mfma_f32_16x16x32_bf16 v[176:179], a[248:251], a[112:115], v[176:179]
ds_read_b128 a[224:227], v15 offset:59392
v_perm_b32 v60, v44, v19, s53
v_mfma_f32_16x16x32_bf16 v[176:179], a[252:255], a[128:131], v[176:179]
ds_read_b32 a147, v60
v_mfma_f32_16x16x32_bf16 v[180:183], a[252:255], a[132:135], v[180:183]
ds_read_b128 a[228:231], v16 offset:10240
v_perm_b32 v59, v40, v19, s54
v_mfma_f32_16x16x32_bf16 v[180:183], a[248:251], a[116:119], v[180:183]
s_add_u32 m0, s33, 72960
ds_read_b32 a148, v59
v_mfma_f32_16x16x32_bf16 v[184:187], a[248:251], a[120:123], v[184:187]
buffer_load_dwordx4 v10, s[20:23], 0 offen offset:768 lds
v_perm_b32 v58, v40, v19, s55
v_mfma_f32_16x16x32_bf16 v[184:187], a[252:255], a[136:139], v[184:187]
ds_read_b32 a149, v58
v_perm_b32 v57, v44, v19, s54
v_mfma_f32_16x16x32_bf16 v[188:191], a[252:255], a[140:143], v[188:191]
ds_read_b32 a150, v57
v_perm_b32 v56, v44, v19, s55
v_mfma_f32_16x16x32_bf16 v[188:191], a[248:251], a[124:127], v[188:191]
s_waitcnt lgkmcnt(3)
ds_read_b32 a151, v56
v_mfma_f32_16x16x32_bf16 v[208:211], a[224:227], a[112:115], v[208:211]
ds_read_b128 a[232:235], v15 offset:63488
v_perm_b32 v63, v41, v19, s52
v_mfma_f32_16x16x32_bf16 v[208:211], a[228:231], a[128:131], v[208:211]
ds_read_b32 a152, v63
v_mfma_f32_16x16x32_bf16 v[212:215], a[228:231], a[132:135], v[212:215]
ds_read_b128 a[236:239], v16 offset:14336
v_perm_b32 v62, v41, v19, s53
v_mfma_f32_16x16x32_bf16 v[212:215], a[224:227], a[116:119], v[212:215]
ds_read_b32 a153, v62
v_perm_b32 v61, v45, v19, s52
v_mfma_f32_16x16x32_bf16 v[216:219], a[224:227], a[120:123], v[216:219]
ds_read_b32 a154, v61
v_perm_b32 v60, v45, v19, s53
v_mfma_f32_16x16x32_bf16 v[216:219], a[228:231], a[136:139], v[216:219]
ds_read_b32 a155, v60
v_perm_b32 v59, v41, v19, s54
v_mfma_f32_16x16x32_bf16 v[220:223], a[228:231], a[140:143], v[220:223]
s_add_u32 m0, s33, 77056
ds_read_b32 a156, v59
v_perm_b32 v58, v41, v19, s55
v_mfma_f32_16x16x32_bf16 v[220:223], a[224:227], a[124:127], v[220:223]
s_waitcnt lgkmcnt(4)
ds_read_b32 a157, v58
v_perm_b32 v57, v45, v19, s54
v_mfma_f32_16x16x32_bf16 v[240:243], a[232:235], a[112:115], v[240:243]
ds_read_b128 a[240:243], v16 offset:0
buffer_load_dwordx4 v11, s[20:23], 0 offen offset:768 lds
v_mfma_f32_16x16x32_bf16 v[240:243], a[236:239], a[128:131], v[240:243]
ds_read_b32 a158, v57
buffer_load_dwordx4 v[80:83], v12, s[24:27], 0 offen offset:0 sc1
v_mfma_f32_16x16x32_bf16 v[244:247], a[236:239], a[132:135], v[244:247]
ds_read_b128 a[244:247], v17 offset:0
v_perm_b32 v56, v45, v19, s55
v_mfma_f32_16x16x32_bf16 v[244:247], a[232:235], a[116:119], v[244:247]
ds_read_b32 a159, v56
buffer_load_dwordx4 v[84:87], v12, s[24:27], 0 offen offset:1024 sc1
v_mfma_f32_16x16x32_bf16 v[248:251], a[232:235], a[120:123], v[248:251]
v_mfma_f32_16x16x32_bf16 v[248:251], a[236:239], a[136:139], v[248:251]
v_mfma_f32_16x16x32_bf16 v[252:255], a[236:239], a[140:143], v[252:255]
s_waitcnt vmcnt(10)
v_cmp_ne_u64 s[50:51], s[88:89], v[50:51]
v_cmp_ne_u64 s[44:45], s[88:89], v[54:55]
v_mfma_f32_16x16x32_bf16 v[252:255], a[232:235], a[124:127], v[252:255]
s_waitcnt lgkmcnt(1)
v_mfma_f32_16x16x32_bf16 v[128:131], a[240:243], a[128:131], v[128:131]
s_or_b64 s[50:51], s[44:45], s[50:51]
ds_read_b128 a[248:251], v16 offset:4096
v_mfma_f32_16x16x32_bf16 v[128:131], a[244:247], a[144:147], v[128:131]
s_cbranch_scc1 L_SLOW10
L_BACK10:
v_mfma_f32_16x16x32_bf16 v[132:135], a[244:247], a[148:151], v[132:135]
ds_read_b128 a[252:255], v17 offset:4096
v_mfma_f32_16x16x32_bf16 v[132:135], a[240:243], a[132:135], v[132:135]
s_add_u32 m0, s33, 81024
v_mfma_f32_16x16x32_bf16 v[136:139], a[240:243], a[136:139], v[136:139]
buffer_load_dwordx4 v8, s[20:23], 0 offen offset:896 lds
v_perm_b32 v63, v48, v19, s52
v_mfma_f32_16x16x32_bf16 v[136:139], a[244:247], a[152:155], v[136:139]
s_waitcnt lgkmcnt(1)
ds_read_b32 a160, v63
v_perm_b32 v62, v48, v19, s53
v_mfma_f32_16x16x32_bf16 v[140:143], a[244:247], a[156:159], v[140:143]
ds_read_b32 a161, v62
v_perm_b32 v61, v52, v19, s52
v_mfma_f32_16x16x32_bf16 v[140:143], a[240:243], a[140:143], v[140:143]
s_waitcnt lgkmcnt(2)
ds_read_b32 a162, v61
v_mfma_f32_16x16x32_bf16 v[160:163], a[248:251], a[128:131], v[160:163]
ds_read_b128 a[224:227], v16 offset:8192
v_perm_b32 v60, v52, v19, s53
v_mfma_f32_16x16x32_bf16 v[160:163], a[252:255], a[144:147], v[160:163]
ds_read_b32 a163, v60
v_mfma_f32_16x16x32_bf16 v[164:167], a[252:255], a[148:151], v[164:167]
ds_read_b128 a[228:231], v17 offset:8192
v_perm_b32 v59, v48, v19, s54
v_mfma_f32_16x16x32_bf16 v[164:167], a[248:251], a[132:135], v[164:167]
ds_read_b32 a164, v59
v_perm_b32 v58, v48, v19, s55
v_mfma_f32_16x16x32_bf16 v[168:171], a[248:251], a[136:139], v[168:171]
ds_read_b32 a165, v58
v_perm_b32 v57, v52, v19, s54
v_mfma_f32_16x16x32_bf16 v[168:171], a[252:255], a[152:155], v[168:171]
ds_read_b32 a166, v57
v_perm_b32 v56, v52, v19, s55
v_mfma_f32_16x16x32_bf16 v[172:175], a[252:255], a[156:159], v[172:175]
ds_read_b32 a167, v56
v_perm_b32 v63, v49, v19, s52
v_mfma_f32_16x16x32_bf16 v[172:175], a[248:251], a[140:143], v[172:175]
s_waitcnt lgkmcnt(4)
ds_read_b32 a168, v63
v_mfma_f32_16x16x32_bf16 v[192:195], a[224:227], a[128:131], v[192:195]
ds_read_b128 a[232:235], v16 offset:12288
v_perm_b32 v62, v49, v19, s53
v_mfma_f32_16x16x32_bf16 v[192:195], a[228:231], a[144:147], v[192:195]
ds_read_b32 a169, v62
buffer_load_dwordx4 v[88:91], v12, s[24:27], 0 offen offset:2048 sc1
v_mfma_f32_16x16x32_bf16 v[196:199], a[228:231], a[148:151], v[196:199]
ds_read_b128 a[236:239], v17 offset:12288
v_perm_b32 v61, v53, v19, s52
v_mfma_f32_16x16x32_bf16 v[196:199], a[224:227], a[132:135], v[196:199]
s_add_u32 m0, s33, 85120
ds_read_b32 a170, v61
buffer_load_dwordx4 v[92:95], v12, s[24:27], 0 offen offset:3072 sc1
v_mfma_f32_16x16x32_bf16 v[200:203], a[224:227], a[136:139], v[200:203]
buffer_load_dwordx4 v9, s[20:23], 0 offen offset:896 lds
v_perm_b32 v60, v53, v19, s53
v_mfma_f32_16x16x32_bf16 v[200:203], a[228:231], a[152:155], v[200:203]
ds_read_b32 a171, v60
v_perm_b32 v59, v49, v19, s54
v_mfma_f32_16x16x32_bf16 v[204:207], a[228:231], a[156:159], v[204:207]
ds_read_b32 a172, v59
v_perm_b32 v58, v49, v19, s55
v_mfma_f32_16x16x32_bf16 v[204:207], a[224:227], a[140:143], v[204:207]
s_waitcnt lgkmcnt(3)
ds_read_b32 a173, v58
v_add_u32 v12, 28672, v13
v_mfma_f32_16x16x32_bf16 v[224:227], a[232:235], a[128:131], v[224:227]
ds_read_b128 a[240:243], v17 offset:2048
v_perm_b32 v57, v53, v19, s54
v_mfma_f32_16x16x32_bf16 v[224:227], a[236:239], a[144:147], v[224:227]
ds_read_b32 a174, v57
v_mfma_f32_16x16x32_bf16 v[228:231], a[236:239], a[148:151], v[228:231]
ds_read_b128 a[244:247], v16 offset:18432
v_perm_b32 v56, v53, v19, s55
v_mfma_f32_16x16x32_bf16 v[228:231], a[232:235], a[132:135], v[228:231]
s_add_u32 m0, s33, 89216
ds_read_b32 a175, v56
v_mfma_f32_16x16x32_bf16 v[232:235], a[232:235], a[136:139], v[232:235]
buffer_load_dwordx4 v10, s[20:23], 0 offen offset:896 lds
v_mfma_f32_16x16x32_bf16 v[232:235], a[236:239], a[152:155], v[232:235]
v_mfma_f32_16x16x32_bf16 v[236:239], a[236:239], a[156:159], v[236:239]
v_mfma_f32_16x16x32_bf16 v[236:239], a[232:235], a[140:143], v[236:239]
s_waitcnt vmcnt(10) lgkmcnt(1)
v_cmp_ne_u64 s[50:51], s[88:89], v[98:99]
v_mfma_f32_16x16x32_bf16 v[144:147], a[240:243], a[144:147], v[144:147]
s_barrier
ds_read_b128 a[248:251], v17 offset:6144
v_cmp_ne_u64 s[44:45], s[88:89], v[102:103]
v_mfma_f32_16x16x32_bf16 v[144:147], a[244:247], a[160:163], v[144:147]
v_mfma_f32_16x16x32_bf16 v[148:151], a[244:247], a[164:167], v[148:151]
s_or_b64 s[50:51], s[44:45], s[50:51]
ds_read_b128 a[252:255], v16 offset:22528
v_mfma_f32_16x16x32_bf16 v[148:151], a[240:243], a[148:151], v[148:151]
s_cbranch_scc1 L_SLOW11
L_BACK11:
v_mfma_f32_16x16x32_bf16 v[152:155], a[240:243], a[152:155], v[152:155]
v_perm_b32 v63, v96, v19, s52
v_mfma_f32_16x16x32_bf16 v[152:155], a[244:247], a[168:171], v[152:155]
s_waitcnt lgkmcnt(1)
ds_read_b32 a176, v63
v_perm_b32 v62, v96, v19, s53
v_mfma_f32_16x16x32_bf16 v[156:159], a[244:247], a[172:175], v[156:159]
ds_read_b32 a177, v62
v_perm_b32 v61, v100, v19, s52
v_mfma_f32_16x16x32_bf16 v[156:159], a[240:243], a[156:159], v[156:159]
s_waitcnt lgkmcnt(2)
ds_read_b32 a178, v61
v_mfma_f32_16x16x32_bf16 v[176:179], a[248:251], a[144:147], v[176:179]
ds_read_b128 a[224:227], v17 offset:10240
v_perm_b32 v60, v100, v19, s53
v_mfma_f32_16x16x32_bf16 v[176:179], a[252:255], a[160:163], v[176:179]
ds_read_b32 a179, v60
v_mfma_f32_16x16x32_bf16 v[180:183], a[252:255], a[164:167], v[180:183]
ds_read_b128 a[228:231], v16 offset:26624
v_perm_b32 v59, v96, v19, s54
v_mfma_f32_16x16x32_bf16 v[180:183], a[248:251], a[148:151], v[180:183]
s_add_u32 m0, s33, 93184
ds_read_b32 a180, v59
buffer_load_dwordx4 v[32:35], v12, s[24:27], 0 offen offset:0 sc1
v_mfma_f32_16x16x32_bf16 v[184:187], a[248:251], a[152:155], v[184:187]
buffer_load_dwordx4 v8, s[20:23], 0 offen offset:1024 lds
v_perm_b32 v58, v96, v19, s55
v_mfma_f32_16x16x32_bf16 v[184:187], a[252:255], a[168:171], v[184:187]
ds_read_b32 a181, v58
v_perm_b32 v57, v100, v19, s54
v_mfma_f32_16x16x32_bf16 v[188:191], a[252:255], a[172:175], v[188:191]
ds_read_b32 a182, v57
v_perm_b32 v56, v100, v19, s55
v_mfma_f32_16x16x32_bf16 v[188:191], a[248:251], a[156:159], v[188:191]
s_waitcnt lgkmcnt(3)
ds_read_b32 a183, v56
buffer_load_dwordx4 v[36:39], v12, s[24:27], 0 offen offset:1024 sc1
v_mfma_f32_16x16x32_bf16 v[208:211], a[224:227], a[144:147], v[208:211]
ds_read_b128 a[232:235], v17 offset:14336
v_perm_b32 v63, v97, v19, s52
v_mfma_f32_16x16x32_bf16 v[208:211], a[228:231], a[160:163], v[208:211]
ds_read_b32 a184, v63
v_mfma_f32_16x16x32_bf16 v[212:215], a[228:231], a[164:167], v[212:215]
ds_read_b128 a[236:239], v16 offset:30720
v_perm_b32 v62, v97, v19, s53
v_mfma_f32_16x16x32_bf16 v[212:215], a[224:227], a[148:151], v[212:215]
ds_read_b32 a185, v62
v_perm_b32 v61, v101, v19, s52
v_mfma_f32_16x16x32_bf16 v[216:219], a[224:227], a[152:155], v[216:219]
ds_read_b32 a186, v61
v_perm_b32 v60, v101, v19, s53
v_mfma_f32_16x16x32_bf16 v[216:219], a[228:231], a[168:171], v[216:219]
ds_read_b32 a187, v60
v_perm_b32 v59, v97, v19, s54
v_mfma_f32_16x16x32_bf16 v[220:223], a[228:231], a[172:175], v[220:223]
s_add_u32 m0, s33, 97280
ds_read_b32 a188, v59
v_perm_b32 v58, v97, v19, s55
v_mfma_f32_16x16x32_bf16 v[220:223], a[224:227], a[156:159], v[220:223]
s_waitcnt lgkmcnt(4)
ds_read_b32 a189, v58
v_perm_b32 v57, v101, v19, s54
v_mfma_f32_16x16x32_bf16 v[240:243], a[232:235], a[144:147], v[240:243]
ds_read_b128 a[240:243], v16 offset:16384
buffer_load_dwordx4 v9, s[20:23], 0 offen offset:1024 lds
v_mfma_f32_16x16x32_bf16 v[240:243], a[236:239], a[160:163], v[240:243]
ds_read_b32 a190, v57
v_mfma_f32_16x16x32_bf16 v[244:247], a[236:239], a[164:167], v[244:247]
ds_read_b128 a[244:247], v17 offset:16384
v_perm_b32 v56, v101, v19, s55
v_mfma_f32_16x16x32_bf16 v[244:247], a[232:235], a[148:151], v[244:247]
ds_read_b32 a191, v56
v_mfma_f32_16x16x32_bf16 v[248:251], a[232:235], a[152:155], v[248:251]
v_mfma_f32_16x16x32_bf16 v[248:251], a[236:239], a[168:171], v[248:251]
v_mfma_f32_16x16x32_bf16 v[252:255], a[236:239], a[172:175], v[252:255]
s_waitcnt vmcnt(9)
v_cmp_ne_u64 s[50:51], s[88:89], v[82:83]
v_cmp_ne_u64 s[44:45], s[88:89], v[86:87]
v_mfma_f32_16x16x32_bf16 v[252:255], a[232:235], a[156:159], v[252:255]
s_waitcnt lgkmcnt(1)
v_mfma_f32_16x16x32_bf16 v[128:131], a[240:243], a[160:163], v[128:131]
L_PAD2:
s_cbranch_vccnz L_PADRET
s_or_b64 s[50:51], s[44:45], s[50:51]
ds_read_b128 a[248:251], v16 offset:20480
v_mfma_f32_16x16x32_bf16 v[128:131], a[244:247], a[176:179], v[128:131]
s_cbranch_scc1 L_SLOW12
L_BACK12:
v_mfma_f32_16x16x32_bf16 v[132:135], a[244:247], a[180:183], v[132:135]
ds_read_b128 a[252:255], v17 offset:20480
v_mfma_f32_16x16x32_bf16 v[132:135], a[240:243], a[164:167], v[132:135]
s_add_u32 m0, s33, 101504
v_mfma_f32_16x16x32_bf16 v[136:139], a[240:243], a[168:171], v[136:139]
buffer_load_dwordx4 v11, s[20:23], 0 offen offset:896 lds
v_mfma_f32_16x16x32_bf16 v[136:139], a[244:247], a[184:187], v[136:139]
s_waitcnt lgkmcnt(1)
buffer_load_dwordx4 v[40:43], v12, s[24:27], 0 offen offset:2048 sc1
v_perm_b32 v63, v80, v19, s52
v_mfma_f32_16x16x32_bf16 v[140:143], a[244:247], a[188:191], v[140:143]
ds_read_b32 a192, v63
v_perm_b32 v62, v80, v19, s53
v_mfma_f32_16x16x32_bf16 v[140:143], a[240:243], a[172:175], v[140:143]
s_waitcnt lgkmcnt(1)
ds_read_b32 a193, v62
buffer_load_dwordx4 v[44:47], v12, s[24:27], 0 offen offset:3072 sc1
v_mfma_f32_16x16x32_bf16 v[160:163], a[248:251], a[160:163], v[160:163]
ds_read_b128 a[224:227], v16 offset:24576
v_perm_b32 v61, v84, v19, s52
v_mfma_f32_16x16x32_bf16 v[160:163], a[252:255], a[176:179], v[160:163]
ds_read_b32 a194, v61
v_add_u32 v12, 32768, v13
v_mfma_f32_16x16x32_bf16 v[164:167], a[252:255], a[180:183], v[164:167]
ds_read_b128 a[228:231], v17 offset:24576
v_perm_b32 v60, v84, v19, s53
v_mfma_f32_16x16x32_bf16 v[164:167], a[248:251], a[164:167], v[164:167]
ds_read_b32 a195, v60
v_perm_b32 v59, v80, v19, s54
v_mfma_f32_16x16x32_bf16 v[168:171], a[248:251], a[168:171], v[168:171]
ds_read_b32 a196, v59
v_perm_b32 v58, v80, v19, s55
v_mfma_f32_16x16x32_bf16 v[168:171], a[252:255], a[184:187], v[168:171]
ds_read_b32 a197, v58
v_perm_b32 v57, v84, v19, s54
v_mfma_f32_16x16x32_bf16 v[172:175], a[252:255], a[188:191], v[172:175]
ds_read_b32 a198, v57
v_perm_b32 v56, v84, v19, s55
v_mfma_f32_16x16x32_bf16 v[172:175], a[248:251], a[172:175], v[172:175]
s_waitcnt lgkmcnt(4)
ds_read_b32 a199, v56
v_mfma_f32_16x16x32_bf16 v[192:195], a[224:227], a[160:163], v[192:195]
ds_read_b128 a[232:235], v16 offset:28672
v_perm_b32 v63, v81, v19, s52
v_mfma_f32_16x16x32_bf16 v[192:195], a[228:231], a[176:179], v[192:195]
ds_read_b32 a200, v63
v_mfma_f32_16x16x32_bf16 v[196:199], a[228:231], a[180:183], v[196:199]
ds_read_b128 a[236:239], v17 offset:28672
v_perm_b32 v62, v81, v19, s53
v_mfma_f32_16x16x32_bf16 v[196:199], a[224:227], a[164:167], v[196:199]
ds_read_b32 a201, v62
v_perm_b32 v61, v85, v19, s52
v_mfma_f32_16x16x32_bf16 v[200:203], a[224:227], a[168:171], v[200:203]
ds_read_b32 a202, v61
v_perm_b32 v60, v85, v19, s53
v_mfma_f32_16x16x32_bf16 v[200:203], a[228:231], a[184:187], v[200:203]
ds_read_b32 a203, v60
v_perm_b32 v59, v81, v19, s54
v_mfma_f32_16x16x32_bf16 v[204:207], a[228:231], a[188:191], v[204:207]
ds_read_b32 a204, v59
v_perm_b32 v58, v81, v19, s55
v_mfma_f32_16x16x32_bf16 v[204:207], a[224:227], a[172:175], v[204:207]
s_waitcnt lgkmcnt(4)
ds_read_b32 a205, v58
v_mfma_f32_16x16x32_bf16 v[224:227], a[232:235], a[160:163], v[224:227]
ds_read_b128 a[240:243], v17 offset:18432
v_perm_b32 v57, v85, v19, s54
v_mfma_f32_16x16x32_bf16 v[224:227], a[236:239], a[176:179], v[224:227]
ds_read_b32 a206, v57
v_mfma_f32_16x16x32_bf16 v[228:231], a[236:239], a[180:183], v[228:231]
ds_read_b128 a[244:247], v14 offset:2048
v_perm_b32 v56, v85, v19, s55
v_mfma_f32_16x16x32_bf16 v[228:231], a[232:235], a[164:167], v[228:231]
ds_read_b32 a207, v56
v_mfma_f32_16x16x32_bf16 v[232:235], a[232:235], a[168:171], v[232:235]
s_waitcnt vmcnt(9)
v_cmp_ne_u64 s[50:51], s[88:89], v[90:91]
v_cmp_ne_u64 s[44:45], s[88:89], v[94:95]
v_mfma_f32_16x16x32_bf16 v[232:235], a[236:239], a[184:187], v[232:235]
buffer_load_dwordx4 v[48:51], v12, s[24:27], 0 offen offset:0 sc1
v_mfma_f32_16x16x32_bf16 v[236:239], a[236:239], a[188:191], v[236:239]
s_or_b64 s[50:51], s[44:45], s[50:51]
buffer_load_dwordx4 v[52:55], v12, s[24:27], 0 offen offset:1024 sc1
v_mfma_f32_16x16x32_bf16 v[236:239], a[232:235], a[172:175], v[236:239]
s_waitcnt lgkmcnt(1)
v_mfma_f32_16x16x32_bf16 v[144:147], a[240:243], a[176:179], v[144:147]
s_barrier
ds_read_b128 a[248:251], v17 offset:22528
v_mfma_f32_16x16x32_bf16 v[144:147], a[244:247], a[192:195], v[144:147]
s_cbranch_scc1 L_SLOW13
L_BACK13:
v_mfma_f32_16x16x32_bf16 v[148:151], a[244:247], a[196:199], v[148:151]
ds_read_b128 a[252:255], v14 offset:6144
v_perm_b32 v63, v88, v19, s52
v_mfma_f32_16x16x32_bf16 v[148:151], a[240:243], a[180:183], v[148:151]
ds_read_b32 a208, v63
v_perm_b32 v62, v88, v19, s53
v_mfma_f32_16x16x32_bf16 v[152:155], a[240:243], a[184:187], v[152:155]
ds_read_b32 a209, v62
v_perm_b32 v61, v92, v19, s52
v_mfma_f32_16x16x32_bf16 v[152:155], a[244:247], a[200:203], v[152:155]
s_waitcnt lgkmcnt(3)
ds_read_b32 a210, v61
v_perm_b32 v60, v92, v19, s53
v_mfma_f32_16x16x32_bf16 v[156:159], a[244:247], a[204:207], v[156:159]
ds_read_b32 a211, v60
v_perm_b32 v59, v88, v19, s54
v_mfma_f32_16x16x32_bf16 v[156:159], a[240:243], a[188:191], v[156:159]
s_waitcnt lgkmcnt(4)
ds_read_b32 a212, v59
v_mfma_f32_16x16x32_bf16 v[176:179], a[248:251], a[176:179], v[176:179]
ds_read_b128 a[224:227], v17 offset:26624
v_perm_b32 v58, v88, v19, s55
v_mfma_f32_16x16x32_bf16 v[176:179], a[252:255], a[192:195], v[176:179]
ds_read_b32 a213, v58
v_mfma_f32_16x16x32_bf16 v[180:183], a[252:255], a[196:199], v[180:183]
ds_read_b128 a[228:231], v14 offset:10240
v_perm_b32 v57, v92, v19, s54
v_mfma_f32_16x16x32_bf16 v[180:183], a[248:251], a[180:183], v[180:183]
s_add_u32 m0, s33, 105472
ds_read_b32 a214, v57
v_mfma_f32_16x16x32_bf16 v[184:187], a[248:251], a[184:187], v[184:187]
buffer_load_dwordx4 v10, s[20:23], 0 offen offset:1024 lds
v_perm_b32 v56, v92, v19, s55
v_mfma_f32_16x16x32_bf16 v[184:187], a[252:255], a[200:203], v[184:187]
ds_read_b32 a215, v56
v_perm_b32 v63, v89, v19, s52
v_mfma_f32_16x16x32_bf16 v[188:191], a[252:255], a[204:207], v[188:191]
ds_read_b32 a216, v63
v_perm_b32 v62, v89, v19, s53
v_mfma_f32_16x16x32_bf16 v[188:191], a[248:251], a[188:191], v[188:191]
s_waitcnt lgkmcnt(3)
ds_read_b32 a217, v62
v_mfma_f32_16x16x32_bf16 v[208:211], a[224:227], a[176:179], v[208:211]
ds_read_b128 a[232:235], v17 offset:30720
v_perm_b32 v61, v93, v19, s52
v_mfma_f32_16x16x32_bf16 v[208:211], a[228:231], a[192:195], v[208:211]
ds_read_b32 a218, v61
v_mfma_f32_16x16x32_bf16 v[212:215], a[228:231], a[196:199], v[212:215]
ds_read_b128 a[236:239], v14 offset:14336
v_perm_b32 v60, v93, v19, s53
v_mfma_f32_16x16x32_bf16 v[212:215], a[224:227], a[180:183], v[212:215]
ds_read_b32 a219, v60
v_perm_b32 v59, v89, v19, s54
v_mfma_f32_16x16x32_bf16 v[216:219], a[224:227], a[184:187], v[216:219]
ds_read_b32 a220, v59
v_perm_b32 v58, v89, v19, s55
v_mfma_f32_16x16x32_bf16 v[216:219], a[228:231], a[200:203], v[216:219]
ds_read_b32 a221, v58
v_perm_b32 v57, v93, v19, s54
v_mfma_f32_16x16x32_bf16 v[220:223], a[228:231], a[204:207], v[220:223]
s_add_u32 m0, s33, 109440
ds_read_b32 a222, v57
v_perm_b32 v56, v93, v19, s55
v_mfma_f32_16x16x32_bf16 v[220:223], a[224:227], a[188:191], v[220:223]
s_waitcnt vmcnt(7) lgkmcnt(4)
v_cmp_ne_u64 s[50:51], s[88:89], v[34:35]
v_cmp_ne_u64 s[44:45], s[88:89], v[38:39]
v_mfma_f32_16x16x32_bf16 v[240:243], a[232:235], a[176:179], v[240:243]
ds_read_b128 a[240:243], v14 offset:0
buffer_load_dwordx4 v8, s[20:23], 0 offen offset:1152 lds
v_mfma_f32_16x16x32_bf16 v[240:243], a[236:239], a[192:195], v[240:243]
ds_read_b32 a223, v56
buffer_load_dwordx4 v[96:99], v12, s[24:27], 0 offen offset:2048 sc1
v_mfma_f32_16x16x32_bf16 v[244:247], a[236:239], a[196:199], v[244:247]
s_or_b64 s[50:51], s[44:45], s[50:51]
ds_read_b128 a[244:247], v15 offset:0
buffer_load_dwordx4 v[100:103], v12, s[24:27], 0 offen offset:3072 sc1
v_mfma_f32_16x16x32_bf16 v[244:247], a[232:235], a[180:183], v[244:247]
s_cbranch_scc1 L_SLOW14
L_BACK14:
v_mfma_f32_16x16x32_bf16 v[248:251], a[232:235], a[184:187], v[248:251]
v_perm_b32 v63, v32, v19, s52
v_add_u32 v12, 36864, v13
v_mfma_f32_16x16x32_bf16 v[248:251], a[236:239], a[200:203], v[248:251]
ds_read_b32 a0, v63
v_perm_b32 v62, v32, v19, s53
v_mfma_f32_16x16x32_bf16 v[252:255], a[236:239], a[204:207], v[252:255]
ds_read_b32 a1, v62
v_perm_b32 v61, v36, v19, s52
v_mfma_f32_16x16x32_bf16 v[252:255], a[232:235], a[188:191], v[252:255]
s_waitcnt lgkmcnt(2)
ds_read_b32 a2, v61
v_mfma_f32_16x16x32_bf16 v[128:131], a[240:243], a[192:195], v[128:131]
ds_read_b128 a[248:251], v14 offset:4096
v_perm_b32 v60, v36, v19, s53
v_mfma_f32_16x16x32_bf16 v[128:131], a[244:247], a[208:211], v[128:131]
ds_read_b32 a3, v60
v_mfma_f32_16x16x32_bf16 v[132:135], a[244:247], a[212:215], v[132:135]
ds_read_b128 a[252:255], v15 offset:4096
v_perm_b32 v59, v32, v19, s54
v_mfma_f32_16x16x32_bf16 v[132:135], a[240:243], a[196:199], v[132:135]
s_add_u32 m0, s33, 113536
ds_read_b32 a4, v59
v_mfma_f32_16x16x32_bf16 v[136:139], a[240:243], a[200:203], v[136:139]
buffer_load_dwordx4 v9, s[20:23], 0 offen offset:1152 lds
v_perm_b32 v58, v32, v19, s55
v_mfma_f32_16x16x32_bf16 v[136:139], a[244:247], a[216:219], v[136:139]
ds_read_b32 a5, v58
v_perm_b32 v57, v36, v19, s54
v_mfma_f32_16x16x32_bf16 v[140:143], a[244:247], a[220:223], v[140:143]
ds_read_b32 a6, v57
v_perm_b32 v56, v36, v19, s55
v_mfma_f32_16x16x32_bf16 v[140:143], a[240:243], a[204:207], v[140:143]
s_waitcnt lgkmcnt(3)
ds_read_b32 a7, v56
v_mfma_f32_16x16x32_bf16 v[160:163], a[248:251], a[192:195], v[160:163]
ds_read_b128 a[224:227], v14 offset:8192
v_perm_b32 v63, v33, v19, s52
v_mfma_f32_16x16x32_bf16 v[160:163], a[252:255], a[208:211], v[160:163]
ds_read_b32 a8, v63
v_mfma_f32_16x16x32_bf16 v[164:167], a[252:255], a[212:215], v[164:167]
ds_read_b128 a[228:231], v15 offset:8192
v_perm_b32 v62, v33, v19, s53
v_mfma_f32_16x16x32_bf16 v[164:167], a[248:251], a[196:199], v[164:167]
ds_read_b32 a9, v62
v_perm_b32 v61, v37, v19, s52
v_mfma_f32_16x16x32_bf16 v[168:171], a[248:251], a[200:203], v[168:171]
ds_read_b32 a10, v61
v_perm_b32 v60, v37, v19, s53
v_mfma_f32_16x16x32_bf16 v[168:171], a[252:255], a[216:219], v[168:171]
ds_read_b32 a11, v60
v_perm_b32 v59, v33, v19, s54
v_mfma_f32_16x16x32_bf16 v[172:175], a[252:255], a[220:223], v[172:175]
ds_read_b32 a12, v59
v_perm_b32 v58, v33, v19, s55
v_mfma_f32_16x16x32_bf16 v[172:175], a[248:251], a[204:207], v[172:175]
s_waitcnt lgkmcnt(4)
ds_read_b32 a13, v58
buffer_load_dwordx4 v[80:83], v12, s[24:27], 0 offen offset:0 sc1
v_mfma_f32_16x16x32_bf16 v[192:195], a[224:227], a[192:195], v[192:195]
ds_read_b128 a[232:235], v14 offset:12288
buffer_load_dwordx4 v[84:87], v12, s[24:27], 0 offen offset:1024 sc1
v_mfma_f32_16x16x32_bf16 v[192:195], a[228:231], a[208:211], v[192:195]
s_waitcnt vmcnt(9)
v_cmp_ne_u64 s[50:51], s[88:89], v[42:43]
v_cmp_ne_u64 s[44:45], s[88:89], v[46:47]
v_mfma_f32_16x16x32_bf16 v[196:199], a[228:231], a[212:215], v[196:199]
ds_read_b128 a[236:239], v15 offset:12288
v_perm_b32 v57, v37, v19, s54
v_mfma_f32_16x16x32_bf16 v[196:199], a[224:227], a[196:199], v[196:199]
s_or_b64 s[50:51], s[44:45], s[50:51]
ds_read_b32 a14, v57
v_perm_b32 v56, v37, v19, s55
v_mfma_f32_16x16x32_bf16 v[200:203], a[224:227], a[200:203], v[200:203]
s_cbranch_scc1 L_SLOW15
L_BACK15:
v_mfma_f32_16x16x32_bf16 v[200:203], a[228:231], a[216:219], v[200:203]
ds_read_b32 a15, v56
v_perm_b32 v63, v40, v19, s52
v_mfma_f32_16x16x32_bf16 v[204:207], a[228:231], a[220:223], v[204:207]
ds_read_b32 a16, v63
v_perm_b32 v62, v40, v19, s53
v_mfma_f32_16x16x32_bf16 v[204:207], a[224:227], a[204:207], v[204:207]
s_waitcnt lgkmcnt(3)
ds_read_b32 a17, v62
v_mfma_f32_16x16x32_bf16 v[224:227], a[232:235], a[192:195], v[224:227]
ds_read_b128 a[240:243], v15 offset:2048
v_perm_b32 v61, v44, v19, s52
v_mfma_f32_16x16x32_bf16 v[224:227], a[236:239], a[208:211], v[224:227]
ds_read_b32 a18, v61
v_mfma_f32_16x16x32_bf16 v[228:231], a[236:239], a[212:215], v[228:231]
ds_read_b128 a[244:247], v14 offset:18432
v_perm_b32 v60, v44, v19, s53
v_mfma_f32_16x16x32_bf16 v[228:231], a[232:235], a[196:199], v[228:231]
s_add_u32 m0, s33, 117760
ds_read_b32 a19, v60
v_mfma_f32_16x16x32_bf16 v[232:235], a[232:235], a[200:203], v[232:235]
buffer_load_dwordx4 v11, s[20:23], 0 offen offset:1024 lds
v_perm_b32 v59, v40, v19, s54
v_mfma_f32_16x16x32_bf16 v[232:235], a[236:239], a[216:219], v[232:235]
ds_read_b32 a20, v59
v_perm_b32 v58, v40, v19, s55
v_mfma_f32_16x16x32_bf16 v[236:239], a[236:239], a[220:223], v[236:239]
ds_read_b32 a21, v58
v_perm_b32 v57, v44, v19, s54
v_mfma_f32_16x16x32_bf16 v[236:239], a[232:235], a[204:207], v[236:239]
s_waitcnt lgkmcnt(3)
ds_read_b32 a22, v57
v_mfma_f32_16x16x32_bf16 v[144:147], a[240:243], a[208:211], v[144:147]
s_barrier
ds_read_b128 a[248:251], v15 offset:6144
v_perm_b32 v56, v44, v19, s55
v_mfma_f32_16x16x32_bf16 v[144:147], a[244:247], a[0:3], v[144:147]
ds_read_b32 a23, v56
v_mfma_f32_16x16x32_bf16 v[148:151], a[244:247], a[4:7], v[148:151]
ds_read_b128 a[252:255], v14 offset:22528
v_perm_b32 v63, v41, v19, s52
v_mfma_f32_16x16x32_bf16 v[148:151], a[240:243], a[212:215], v[148:151]
ds_read_b32 a24, v63
v_perm_b32 v62, v41, v19, s53
v_mfma_f32_16x16x32_bf16 v[152:155], a[240:243], a[216:219], v[152:155]
ds_read_b32 a25, v62
v_perm_b32 v61, v45, v19, s52
v_mfma_f32_16x16x32_bf16 v[152:155], a[244:247], a[8:11], v[152:155]
ds_read_b32 a26, v61
v_perm_b32 v60, v45, v19, s53
v_mfma_f32_16x16x32_bf16 v[156:159], a[244:247], a[12:15], v[156:159]
ds_read_b32 a27, v60
v_perm_b32 v59, v41, v19, s54
v_mfma_f32_16x16x32_bf16 v[156:159], a[240:243], a[220:223], v[156:159]
s_waitcnt lgkmcnt(4)
ds_read_b32 a28, v59
v_mfma_f32_16x16x32_bf16 v[176:179], a[248:251], a[208:211], v[176:179]
ds_read_b128 a[224:227], v15 offset:10240
v_perm_b32 v58, v41, v19, s55
v_mfma_f32_16x16x32_bf16 v[176:179], a[252:255], a[0:3], v[176:179]
s_waitcnt vmcnt(8)
ds_read_b32 a29, v58
v_cmp_ne_u64 s[50:51], s[88:89], v[50:51]
v_mfma_f32_16x16x32_bf16 v[180:183], a[252:255], a[4:7], v[180:183]
ds_read_b128 a[228:231], v14 offset:26624
v_cmp_ne_u64 s[44:45], s[88:89], v[54:55]
v_mfma_f32_16x16x32_bf16 v[180:183], a[248:251], a[212:215], v[180:183]
s_add_u32 m0, s33, 121728
v_perm_b32 v57, v45, v19, s54
v_perm_b32 v56, v45, v19, s55
v_mfma_f32_16x16x32_bf16 v[184:187], a[248:251], a[216:219], v[184:187]
s_or_b64 s[50:51], s[44:45], s[50:51]
ds_read_b32 a30, v57
buffer_load_dwordx4 v10, s[20:23], 0 offen offset:1152 lds
v_mfma_f32_16x16x32_bf16 v[184:187], a[252:255], a[8:11], v[184:187]
s_cbranch_scc1 L_SLOW16
L_BACK16:
v_mfma_f32_16x16x32_bf16 v[188:191], a[252:255], a[12:15], v[188:191]
ds_read_b32 a31, v56
v_perm_b32 v63, v48, v19, s52
v_mfma_f32_16x16x32_bf16 v[188:191], a[248:251], a[220:223], v[188:191]
s_waitcnt lgkmcnt(2)
ds_read_b32 a32, v63
buffer_load_dwordx4 v[88:91], v12, s[24:27], 0 offen offset:2048 sc1
v_mfma_f32_16x16x32_bf16 v[208:211], a[224:227], a[208:211], v[208:211]
ds_read_b128 a[232:235], v14 offset:16384
v_perm_b32 v62, v48, v19, s53
v_mfma_f32_16x16x32_bf16 v[208:211], a[228:231], a[0:3], v[208:211]
ds_read_b32 a33, v62
buffer_load_dwordx4 v[92:95], v12, s[24:27], 0 offen offset:3072 sc1
v_mfma_f32_16x16x32_bf16 v[212:215], a[228:231], a[4:7], v[212:215]
ds_read_b128 a[236:239], v15 offset:16384
v_perm_b32 v61, v52, v19, s52
v_mfma_f32_16x16x32_bf16 v[212:215], a[224:227], a[212:215], v[212:215]
ds_read_b32 a34, v61
v_perm_b32 v60, v52, v19, s53
v_mfma_f32_16x16x32_bf16 v[216:219], a[224:227], a[216:219], v[216:219]
ds_read_b32 a35, v60
v_perm_b32 v59, v48, v19, s54
v_mfma_f32_16x16x32_bf16 v[216:219], a[228:231], a[8:11], v[216:219]
ds_read_b32 a36, v59
v_perm_b32 v58, v48, v19, s55
v_mfma_f32_16x16x32_bf16 v[220:223], a[228:231], a[12:15], v[220:223]
s_add_u32 m0, s33, 125696
ds_read_b32 a37, v58
v_perm_b32 v57, v52, v19, s54
v_mfma_f32_16x16x32_bf16 v[220:223], a[224:227], a[220:223], v[220:223]
s_waitcnt lgkmcnt(4)
ds_read_b32 a38, v57
v_perm_b32 v56, v52, v19, s55
v_mfma_f32_16x16x32_bf16 v[128:131], a[232:235], a[0:3], v[128:131]
ds_read_b128 a[240:243], v14 offset:20480
buffer_load_dwordx4 v8, s[20:23], 0 offen offset:1280 lds
v_mfma_f32_16x16x32_bf16 v[128:131], a[236:239], a[16:19], v[128:131]
ds_read_b32 a39, v56
v_add_u32 v12, 40960, v13
v_mfma_f32_16x16x32_bf16 v[132:135], a[236:239], a[20:23], v[132:135]
ds_read_b128 a[244:247], v15 offset:20480
v_perm_b32 v63, v49, v19, s52
v_mfma_f32_16x16x32_bf16 v[132:135], a[232:235], a[4:7], v[132:135]
ds_read_b32 a40, v63
v_perm_b32 v62, v49, v19, s53
v_mfma_f32_16x16x32_bf16 v[136:139], a[232:235], a[8:11], v[136:139]
ds_read_b32 a41, v62
v_perm_b32 v61, v53, v19, s52
v_mfma_f32_16x16x32_bf16 v[136:139], a[236:239], a[24:27], v[136:139]
ds_read_b32 a42, v61
v_perm_b32 v60, v53, v19, s53
v_mfma_f32_16x16x32_bf16 v[140:143], a[236:239], a[28:31], v[140:143]
ds_read_b32 a43, v60
v_perm_b32 v59, v49, v19, s54
v_mfma_f32_16x16x32_bf16 v[140:143], a[232:235], a[12:15], v[140:143]
s_waitcnt lgkmcnt(4)
ds_read_b32 a44, v59
v_mfma_f32_16x16x32_bf16 v[160:163], a[240:243], a[0:3], v[160:163]
ds_read_b128 a[248:251], v14 offset:24576
v_perm_b32 v58, v49, v19, s55
v_mfma_f32_16x16x32_bf16 v[160:163], a[244:247], a[16:19], v[160:163]
ds_read_b32 a45, v58
v_mfma_f32_16x16x32_bf16 v[164:167], a[244:247], a[20:23], v[164:167]
ds_read_b128 a[252:255], v15 offset:24576
buffer_load_dwordx4 v[32:35], v12, s[24:27], 0 offen offset:0 sc1
v_mfma_f32_16x16x32_bf16 v[164:167], a[240:243], a[4:7], v[164:167]
s_waitcnt vmcnt(9)
s_add_u32 m0, s33, 129792
v_cmp_ne_u64 s[50:51], s[88:89], v[98:99]
v_cmp_ne_u64 s[44:45], s[88:89], v[102:103]
v_mfma_f32_16x16x32_bf16 v[168:171], a[240:243], a[8:11], v[168:171]
buffer_load_dwordx4 v9, s[20:23], 0 offen offset:1280 lds
v_perm_b32 v57, v53, v19, s54
v_mfma_f32_16x16x32_bf16 v[168:171], a[244:247], a[24:27], v[168:171]
s_or_b64 s[50:51], s[44:45], s[50:51]
ds_read_b32 a46, v57
v_perm_b32 v56, v53, v19, s55
v_mfma_f32_16x16x32_bf16 v[172:175], a[244:247], a[28:31], v[172:175]
s_cbranch_scc1 L_SLOW17
L_BACK17:
v_mfma_f32_16x16x32_bf16 v[172:175], a[240:243], a[12:15], v[172:175]
s_waitcnt lgkmcnt(1)
ds_read_b32 a47, v56
buffer_load_dwordx4 v[36:39], v12, s[24:27], 0 offen offset:1024 sc1
v_mfma_f32_16x16x32_bf16 v[192:195], a[248:251], a[0:3], v[192:195]
ds_read_b128 a[224:227], v15 offset:18432
v_perm_b32 v63, v96, v19, s52
v_mfma_f32_16x16x32_bf16 v[192:195], a[252:255], a[16:19], v[192:195]
ds_read_b32 a48, v63
v_mfma_f32_16x16x32_bf16 v[196:199], a[252:255], a[20:23], v[196:199]
ds_read_b128 a[228:231], v14 offset:30720
v_perm_b32 v62, v96, v19, s53
v_mfma_f32_16x16x32_bf16 v[196:199], a[248:251], a[4:7], v[196:199]
ds_read_b32 a49, v62
v_perm_b32 v61, v100, v19, s52
v_mfma_f32_16x16x32_bf16 v[200:203], a[248:251], a[8:11], v[200:203]
ds_read_b32 a50, v61
v_perm_b32 v60, v100, v19, s53
v_mfma_f32_16x16x32_bf16 v[200:203], a[252:255], a[24:27], v[200:203]
ds_read_b32 a51, v60
v_perm_b32 v59, v96, v19, s54
v_mfma_f32_16x16x32_bf16 v[204:207], a[252:255], a[28:31], v[204:207]
ds_read_b32 a52, v59
v_perm_b32 v58, v96, v19, s55
v_mfma_f32_16x16x32_bf16 v[204:207], a[248:251], a[12:15], v[204:207]
s_waitcnt lgkmcnt(4)
ds_read_b32 a53, v58
v_mfma_f32_16x16x32_bf16 v[144:147], a[224:227], a[16:19], v[144:147]
ds_read_b128 a[232:235], v15 offset:22528
v_perm_b32 v57, v100, v19, s54
v_mfma_f32_16x16x32_bf16 v[144:147], a[228:231], a[32:35], v[144:147]
ds_read_b32 a54, v57
v_mfma_f32_16x16x32_bf16 v[148:151], a[228:231], a[36:39], v[148:151]
ds_read_b128 a[236:239], v14 offset:34816
v_perm_b32 v56, v100, v19, s55
v_mfma_f32_16x16x32_bf16 v[148:151], a[224:227], a[20:23], v[148:151]
ds_read_b32 a55, v56
v_perm_b32 v63, v97, v19, s52
v_mfma_f32_16x16x32_bf16 v[152:155], a[224:227], a[24:27], v[152:155]
ds_read_b32 a56, v63
v_perm_b32 v62, v97, v19, s53
v_mfma_f32_16x16x32_bf16 v[152:155], a[228:231], a[40:43], v[152:155]
ds_read_b32 a57, v62
v_perm_b32 v61, v101, v19, s52
v_mfma_f32_16x16x32_bf16 v[156:159], a[228:231], a[44:47], v[156:159]
ds_read_b32 a58, v61
v_perm_b32 v60, v101, v19, s53
v_mfma_f32_16x16x32_bf16 v[156:159], a[224:227], a[28:31], v[156:159]
s_waitcnt lgkmcnt(4)
ds_read_b32 a59, v60
v_mfma_f32_16x16x32_bf16 v[176:179], a[232:235], a[16:19], v[176:179]
ds_read_b128 a[240:243], v14 offset:36864
v_perm_b32 v59, v97, v19, s54
v_mfma_f32_16x16x32_bf16 v[176:179], a[236:239], a[32:35], v[176:179]
ds_read_b32 a60, v59
v_mfma_f32_16x16x32_bf16 v[180:183], a[236:239], a[36:39], v[180:183]
ds_read_b128 a[244:247], v15 offset:36864
v_mfma_f32_16x16x32_bf16 v[180:183], a[232:235], a[20:23], v[180:183]
s_waitcnt vmcnt(8)
s_add_u32 m0, s33, 133760
v_perm_b32 v58, v97, v19, s55
v_cmp_ne_u64 s[50:51], s[88:89], v[82:83]
v_mfma_f32_16x16x32_bf16 v[184:187], a[232:235], a[24:27], v[184:187]
buffer_load_dwordx4 v8, s[20:23], 0 offen offset:1408 lds
v_cmp_ne_u64 s[44:45], s[88:89], v[86:87]
v_mfma_f32_16x16x32_bf16 v[184:187], a[236:239], a[40:43], v[184:187]
ds_read_b32 a61, v58
v_perm_b32 v57, v101, v19, s54
v_mfma_f32_16x16x32_bf16 v[188:191], a[236:239], a[44:47], v[188:191]
s_or_b64 s[50:51], s[44:45], s[50:51]
ds_read_b32 a62, v57
v_perm_b32 v56, v101, v19, s55
v_mfma_f32_16x16x32_bf16 v[188:191], a[232:235], a[28:31], v[188:191]
s_waitcnt lgkmcnt(2)
ds_read_b32 a63, v56
buffer_load_dwordx4 v[40:43], v12, s[24:27], 0 offen offset:2048 sc1
v_mfma_f32_16x16x32_bf16 v[224:227], a[240:243], a[0:3], v[224:227]
s_barrier
ds_read_b128 a[248:251], v14 offset:28672
buffer_load_dwordx4 v[44:47], v12, s[24:27], 0 offen offset:3072 sc1
v_mfma_f32_16x16x32_bf16 v[224:227], a[244:247], a[16:19], v[224:227]
s_cbranch_scc1 L_SLOW18
L_BACK18:
v_mfma_f32_16x16x32_bf16 v[228:231], a[244:247], a[20:23], v[228:231]
ds_read_b128 a[252:255], v15 offset:28672
v_perm_b32 v63, v80, v19, s52
v_mfma_f32_16x16x32_bf16 v[228:231], a[240:243], a[4:7], v[228:231]
ds_read_b32 a64, v63
v_perm_b32 v62, v80, v19, s53
v_mfma_f32_16x16x32_bf16 v[232:235], a[240:243], a[8:11], v[232:235]
ds_read_b32 a65, v62
v_perm_b32 v61, v84, v19, s52
v_mfma_f32_16x16x32_bf16 v[232:235], a[244:247], a[24:27], v[232:235]
ds_read_b32 a66, v61
v_perm_b32 v60, v84, v19, s53
v_mfma_f32_16x16x32_bf16 v[236:239], a[244:247], a[28:31], v[236:239]
ds_read_b32 a67, v60
v_perm_b32 v59, v80, v19, s54
v_mfma_f32_16x16x32_bf16 v[236:239], a[240:243], a[12:15], v[236:239]
s_waitcnt lgkmcnt(4)
ds_read_b32 a68, v59
v_add_u32 v12, 45056, v13
v_mfma_f32_16x16x32_bf16 v[128:131], a[248:251], a[32:35], v[128:131]
ds_read_b128 a[224:227], v15 offset:14336
v_perm_b32 v58, v80, v19, s55
v_mfma_f32_16x16x32_bf16 v[128:131], a[252:255], a[48:51], v[128:131]
ds_read_b32 a69, v58
v_mfma_f32_16x16x32_bf16 v[132:135], a[252:255], a[52:55], v[132:135]
ds_read_b128 a[228:231], v14 offset:38912
v_perm_b32 v57, v84, v19, s54
v_mfma_f32_16x16x32_bf16 v[132:135], a[248:251], a[36:39], v[132:135]
s_add_u32 m0, s33, 138112
ds_read_b32 a70, v57
v_mfma_f32_16x16x32_bf16 v[136:139], a[248:251], a[40:43], v[136:139]
buffer_load_dwordx4 v11, s[20:23], 0 offen offset:1152 lds
v_perm_b32 v56, v84, v19, s55
v_mfma_f32_16x16x32_bf16 v[136:139], a[252:255], a[56:59], v[136:139]
ds_read_b32 a71, v56
v_perm_b32 v63, v81, v19, s52
v_mfma_f32_16x16x32_bf16 v[140:143], a[252:255], a[60:63], v[140:143]
ds_read_b32 a72, v63
v_perm_b32 v62, v81, v19, s53
v_mfma_f32_16x16x32_bf16 v[140:143], a[248:251], a[44:47], v[140:143]
s_waitcnt lgkmcnt(3)
ds_read_b32 a73, v62
v_mfma_f32_16x16x32_bf16 v[240:243], a[224:227], a[208:211], v[240:243]
ds_read_b128 a[232:235], v14 offset:32768
v_perm_b32 v61, v85, v19, s52
v_mfma_f32_16x16x32_bf16 v[240:243], a[228:231], a[0:3], v[240:243]
ds_read_b32 a74, v61
v_mfma_f32_16x16x32_bf16 v[244:247], a[228:231], a[4:7], v[244:247]
ds_read_b128 a[236:239], v15 offset:32768
v_perm_b32 v60, v85, v19, s53
v_mfma_f32_16x16x32_bf16 v[244:247], a[224:227], a[212:215], v[244:247]
L_PAD3:
s_cbranch_vccnz L_PAD4
ds_read_b32 a75, v60
v_perm_b32 v59, v81, v19, s54
v_mfma_f32_16x16x32_bf16 v[248:251], a[224:227], a[216:219], v[248:251]
ds_read_b32 a76, v59
v_perm_b32 v58, v81, v19, s55
v_mfma_f32_16x16x32_bf16 v[248:251], a[228:231], a[8:11], v[248:251]
ds_read_b32 a77, v58
v_perm_b32 v57, v85, v19, s54
v_mfma_f32_16x16x32_bf16 v[252:255], a[228:231], a[12:15], v[252:255]
s_waitcnt vmcnt(8)
s_add_u32 m0, s33, 142080
v_cmp_ne_u64 s[50:51], s[88:89], v[90:91]
v_cmp_ne_u64 s[44:45], s[88:89], v[94:95]
v_mfma_f32_16x16x32_bf16 v[252:255], a[224:227], a[220:223], v[252:255]
s_waitcnt lgkmcnt(3)
ds_read_b32 a78, v57
buffer_load_dwordx4 v[48:51], v12, s[24:27], 0 offen offset:0 sc1
v_mfma_f32_16x16x32_bf16 v[160:163], a[232:235], a[32:35], v[160:163]
s_or_b64 s[50:51], s[44:45], s[50:51]
ds_read_b128 a[240:243], v15 offset:26624
buffer_load_dwordx4 v10, s[20:23], 0 offen offset:1280 lds
v_mfma_f32_16x16x32_bf16 v[160:163], a[236:239], a[48:51], v[160:163]
s_cbranch_scc1 L_SLOW19
L_BACK19:
v_mfma_f32_16x16x32_bf16 v[164:167], a[236:239], a[52:55], v[164:167]
ds_read_b128 a[244:247], v14 offset:43008
v_perm_b32 v56, v85, v19, s55
v_mfma_f32_16x16x32_bf16 v[164:167], a[232:235], a[36:39], v[164:167]
ds_read_b32 a79, v56
v_perm_b32 v63, v88, v19, s52
v_mfma_f32_16x16x32_bf16 v[168:171], a[232:235], a[40:43], v[168:171]
ds_read_b32 a80, v63
v_perm_b32 v62, v88, v19, s53
v_mfma_f32_16x16x32_bf16 v[168:171], a[236:239], a[56:59], v[168:171]
ds_read_b32 a81, v62
v_perm_b32 v61, v92, v19, s52
v_mfma_f32_16x16x32_bf16 v[172:175], a[236:239], a[60:63], v[172:175]
ds_read_b32 a82, v61
v_perm_b32 v60, v92, v19, s53
v_mfma_f32_16x16x32_bf16 v[172:175], a[232:235], a[44:47], v[172:175]
s_waitcnt lgkmcnt(4)
ds_read_b32 a83, v60
buffer_load_dwordx4 v[52:55], v12, s[24:27], 0 offen offset:1024 sc1
v_mfma_f32_16x16x32_bf16 v[208:211], a[240:243], a[16:19], v[208:211]
ds_read_b128 a[248:251], v14 offset:40960
v_perm_b32 v59, v88, v19, s54
v_mfma_f32_16x16x32_bf16 v[208:211], a[244:247], a[32:35], v[208:211]
ds_read_b32 a84, v59
v_mfma_f32_16x16x32_bf16 v[212:215], a[244:247], a[36:39], v[212:215]
ds_read_b128 a[252:255], v15 offset:40960
v_perm_b32 v58, v88, v19, s55
v_mfma_f32_16x16x32_bf16 v[212:215], a[240:243], a[20:23], v[212:215]
s_add_u32 m0, s33, 146048
ds_read_b32 a85, v58
v_mfma_f32_16x16x32_bf16 v[216:219], a[240:243], a[24:27], v[216:219]
buffer_load_dwordx4 v9, s[20:23], 0 offen offset:1408 lds
v_perm_b32 v57, v92, v19, s54
v_mfma_f32_16x16x32_bf16 v[216:219], a[244:247], a[40:43], v[216:219]
ds_read_b32 a86, v57
v_perm_b32 v56, v92, v19, s55
v_mfma_f32_16x16x32_bf16 v[220:223], a[244:247], a[44:47], v[220:223]
ds_read_b32 a87, v56
v_perm_b32 v63, v89, v19, s52
v_mfma_f32_16x16x32_bf16 v[220:223], a[240:243], a[28:31], v[220:223]
s_waitcnt lgkmcnt(3)
ds_read_b32 a88, v63
v_mfma_f32_16x16x32_bf16 v[192:195], a[248:251], a[32:35], v[192:195]
ds_read_b128 a[224:227], v15 offset:30720
v_perm_b32 v62, v89, v19, s53
v_mfma_f32_16x16x32_bf16 v[192:195], a[252:255], a[48:51], v[192:195]
ds_read_b32 a89, v62
v_mfma_f32_16x16x32_bf16 v[196:199], a[252:255], a[52:55], v[196:199]
ds_read_b128 a[228:231], v14 offset:47104
v_perm_b32 v61, v93, v19, s52
v_mfma_f32_16x16x32_bf16 v[196:199], a[248:251], a[36:39], v[196:199]
ds_read_b32 a90, v61
v_perm_b32 v60, v93, v19, s53
v_mfma_f32_16x16x32_bf16 v[200:203], a[248:251], a[40:43], v[200:203]
ds_read_b32 a91, v60
v_perm_b32 v59, v89, v19, s54
v_mfma_f32_16x16x32_bf16 v[200:203], a[252:255], a[56:59], v[200:203]
ds_read_b32 a92, v59
v_perm_b32 v58, v89, v19, s55
v_mfma_f32_16x16x32_bf16 v[204:207], a[252:255], a[60:63], v[204:207]
s_waitcnt vmcnt(8)
v_cmp_ne_u64 s[50:51], s[88:89], v[34:35]
v_cmp_ne_u64 s[44:45], s[88:89], v[38:39]
v_mfma_f32_16x16x32_bf16 v[204:207], a[248:251], a[44:47], v[204:207]
s_waitcnt lgkmcnt(3)
ds_read_b32 a93, v58
buffer_load_dwordx4 v[96:99], v12, s[24:27], 0 offen offset:2048 sc1
v_mfma_f32_16x16x32_bf16 v[144:147], a[224:227], a[48:51], v[144:147]
s_or_b64 s[50:51], s[44:45], s[50:51]
ds_read_b128 a[232:235], v15 offset:34816
buffer_load_dwordx4 v[100:103], v12, s[24:27], 0 offen offset:3072 sc1
v_mfma_f32_16x16x32_bf16 v[144:147], a[228:231], a[64:67], v[144:147]
s_cbranch_scc1 L_SLOW20
L_BACK20:
v_mfma_f32_16x16x32_bf16 v[148:151], a[228:231], a[68:71], v[148:151]
ds_read_b128 a[236:239], v14 offset:51200
v_perm_b32 v57, v93, v19, s54
v_mfma_f32_16x16x32_bf16 v[148:151], a[224:227], a[52:55], v[148:151]
s_add_u32 m0, s33, 150016
ds_read_b32 a94, v57
v_add_u32 v12, 49152, v13
v_mfma_f32_16x16x32_bf16 v[152:155], a[224:227], a[56:59], v[152:155]
buffer_load_dwordx4 v8, s[20:23], 0 offen offset:1536 lds
v_perm_b32 v56, v93, v19, s55
v_mfma_f32_16x16x32_bf16 v[152:155], a[228:231], a[72:75], v[152:155]
ds_read_b32 a95, v56
v_perm_b32 v63, v32, v19, s52
v_mfma_f32_16x16x32_bf16 v[156:159], a[228:231], a[76:79], v[156:159]
ds_read_b32 a96, v63
v_perm_b32 v62, v32, v19, s53
v_mfma_f32_16x16x32_bf16 v[156:159], a[224:227], a[60:63], v[156:159]
s_waitcnt lgkmcnt(3)
ds_read_b32 a97, v62
v_mfma_f32_16x16x32_bf16 v[176:179], a[232:235], a[48:51], v[176:179]
ds_read_b128 a[240:243], v14 offset:45056
v_perm_b32 v61, v36, v19, s52
v_mfma_f32_16x16x32_bf16 v[176:179], a[236:239], a[64:67], v[176:179]
ds_read_b32 a98, v61
v_mfma_f32_16x16x32_bf16 v[180:183], a[236:239], a[68:71], v[180:183]
ds_read_b128 a[244:247], v15 offset:45056
v_perm_b32 v60, v36, v19, s53
v_mfma_f32_16x16x32_bf16 v[180:183], a[232:235], a[52:55], v[180:183]
s_add_u32 m0, s33, 154240
ds_read_b32 a99, v60
v_mfma_f32_16x16x32_bf16 v[184:187], a[232:235], a[56:59], v[184:187]
buffer_load_dwordx4 v10, s[20:23], 0 offen offset:1408 lds
v_perm_b32 v59, v32, v19, s54
v_mfma_f32_16x16x32_bf16 v[184:187], a[236:239], a[72:75], v[184:187]
ds_read_b32 a100, v59
v_perm_b32 v58, v32, v19, s55
v_mfma_f32_16x16x32_bf16 v[188:191], a[236:239], a[76:79], v[188:191]
ds_read_b32 a101, v58
v_perm_b32 v57, v36, v19, s54
v_mfma_f32_16x16x32_bf16 v[188:191], a[232:235], a[60:63], v[188:191]
s_waitcnt lgkmcnt(3)
ds_read_b32 a102, v57
v_mfma_f32_16x16x32_bf16 v[128:131], a[240:243], a[64:67], v[128:131]
s_barrier
ds_read_b128 a[248:251], v14 offset:49152
v_perm_b32 v56, v36, v19, s55
v_mfma_f32_16x16x32_bf16 v[128:131], a[244:247], a[80:83], v[128:131]
ds_read_b32 a103, v56
v_mfma_f32_16x16x32_bf16 v[132:135], a[244:247], a[84:87], v[132:135]
ds_read_b128 a[252:255], v15 offset:49152
v_perm_b32 v63, v33, v19, s52
v_mfma_f32_16x16x32_bf16 v[132:135], a[240:243], a[68:71], v[132:135]
ds_read_b32 a104, v63
v_perm_b32 v62, v33, v19, s53
v_mfma_f32_16x16x32_bf16 v[136:139], a[240:243], a[72:75], v[136:139]
ds_read_b32 a105, v62
v_perm_b32 v61, v37, v19, s52
v_mfma_f32_16x16x32_bf16 v[136:139], a[244:247], a[88:91], v[136:139]
ds_read_b32 a106, v61
v_perm_b32 v60, v37, v19, s53
v_mfma_f32_16x16x32_bf16 v[140:143], a[244:247], a[92:95], v[140:143]
ds_read_b32 a107, v60
v_perm_b32 v59, v33, v19, s54
v_mfma_f32_16x16x32_bf16 v[140:143], a[240:243], a[76:79], v[140:143]
s_waitcnt lgkmcnt(4)
ds_read_b32 a108, v59
v_mfma_f32_16x16x32_bf16 v[160:163], a[248:251], a[64:67], v[160:163]
ds_read_b128 a[224:227], v14 offset:53248
v_perm_b32 v58, v33, v19, s55
v_mfma_f32_16x16x32_bf16 v[160:163], a[252:255], a[80:83], v[160:163]
s_waitcnt vmcnt(9)
ds_read_b32 a109, v58
v_cmp_ne_u64 s[50:51], s[88:89], v[42:43]
v_mfma_f32_16x16x32_bf16 v[164:167], a[252:255], a[84:87], v[164:167]
ds_read_b128 a[228:231], v15 offset:53248
v_cmp_ne_u64 s[44:45], s[88:89], v[46:47]
v_mfma_f32_16x16x32_bf16 v[164:167], a[248:251], a[68:71], v[164:167]
s_add_u32 m0, s33, 158208
v_perm_b32 v57, v37, v19, s54
v_perm_b32 v56, v37, v19, s55
v_mfma_f32_16x16x32_bf16 v[168:171], a[248:251], a[72:75], v[168:171]
s_or_b64 s[50:51], s[44:45], s[50:51]
ds_read_b32 a110, v57
buffer_load_dwordx4 v9, s[20:23], 0 offen offset:1536 lds
v_mfma_f32_16x16x32_bf16 v[168:171], a[252:255], a[88:91], v[168:171]
s_cbranch_scc1 L_SLOW21
L_BACK21:
v_mfma_f32_16x16x32_bf16 v[172:175], a[252:255], a[92:95], v[172:175]
ds_read_b32 a111, v56
v_perm_b32 v63, v40, v19, s52
v_mfma_f32_16x16x32_bf16 v[172:175], a[248:251], a[76:79], v[172:175]
s_waitcnt lgkmcnt(2)
ds_read_b32 a112, v63
buffer_load_dwordx4 v[80:83], v12, s[24:27], 0 offen offset:0 sc1
v_mfma_f32_16x16x32_bf16 v[224:227], a[224:227], a[32:35], v[224:227]
ds_read_b128 a[232:235], v15 offset:43008
v_perm_b32 v62, v40, v19, s53
v_mfma_f32_16x16x32_bf16 v[224:227], a[228:231], a[48:51], v[224:227]
ds_read_b32 a113, v62
buffer_load_dwordx4 v[84:87], v12, s[24:27], 0 offen offset:1024 sc1
v_mfma_f32_16x16x32_bf16 v[228:231], a[228:231], a[52:55], v[228:231]
ds_read_b128 a[236:239], v14 offset:59392
v_perm_b32 v61, v44, v19, s52
v_mfma_f32_16x16x32_bf16 v[228:231], a[224:227], a[36:39], v[228:231]
ds_read_b32 a114, v61
v_perm_b32 v60, v44, v19, s53
v_mfma_f32_16x16x32_bf16 v[232:235], a[224:227], a[40:43], v[232:235]
ds_read_b32 a115, v60
v_perm_b32 v59, v40, v19, s54
v_mfma_f32_16x16x32_bf16 v[232:235], a[228:231], a[56:59], v[232:235]
ds_read_b32 a116, v59
v_perm_b32 v58, v40, v19, s55
v_mfma_f32_16x16x32_bf16 v[236:239], a[228:231], a[60:63], v[236:239]
s_add_u32 m0, s33, 64256
ds_read_b32 a117, v58
v_perm_b32 v57, v44, v19, s54
v_mfma_f32_16x16x32_bf16 v[236:239], a[224:227], a[44:47], v[236:239]
s_waitcnt lgkmcnt(4)
ds_read_b32 a118, v57
v_perm_b32 v56, v44, v19, s55
v_mfma_f32_16x16x32_bf16 v[208:211], a[232:235], a[48:51], v[208:211]
ds_read_b128 a[240:243], v15 offset:47104
buffer_load_dwordx4 v11, s[20:23], 0 offen offset:1280 lds
v_mfma_f32_16x16x32_bf16 v[208:211], a[236:239], a[64:67], v[208:211]
ds_read_b32 a119, v56
v_mfma_f32_16x16x32_bf16 v[212:215], a[236:239], a[68:71], v[212:215]
ds_read_b128 a[244:247], v14 offset:63488
v_perm_b32 v63, v41, v19, s52
v_mfma_f32_16x16x32_bf16 v[212:215], a[232:235], a[52:55], v[212:215]
ds_read_b32 a120, v63
v_perm_b32 v62, v41, v19, s53
v_mfma_f32_16x16x32_bf16 v[216:219], a[232:235], a[56:59], v[216:219]
ds_read_b32 a121, v62
v_perm_b32 v61, v45, v19, s52
v_mfma_f32_16x16x32_bf16 v[216:219], a[236:239], a[72:75], v[216:219]
ds_read_b32 a122, v61
v_perm_b32 v60, v45, v19, s53
v_mfma_f32_16x16x32_bf16 v[220:223], a[236:239], a[76:79], v[220:223]
ds_read_b32 a123, v60
v_perm_b32 v59, v41, v19, s54
v_mfma_f32_16x16x32_bf16 v[220:223], a[232:235], a[60:63], v[220:223]
s_waitcnt lgkmcnt(4)
ds_read_b32 a124, v59
v_mfma_f32_16x16x32_bf16 v[144:147], a[240:243], a[80:83], v[144:147]
ds_read_b128 a[248:251], v14 offset:57344
v_perm_b32 v58, v41, v19, s55
v_mfma_f32_16x16x32_bf16 v[144:147], a[244:247], a[96:99], v[144:147]
ds_read_b32 a125, v58
v_mfma_f32_16x16x32_bf16 v[148:151], a[244:247], a[100:103], v[148:151]
ds_read_b128 a[252:255], v15 offset:57344
buffer_load_dwordx4 v[88:91], v12, s[24:27], 0 offen offset:2048 sc1
v_mfma_f32_16x16x32_bf16 v[148:151], a[240:243], a[84:87], v[148:151]
s_waitcnt vmcnt(10)
s_add_u32 m0, s33, 67968
v_cmp_ne_u64 s[50:51], s[88:89], v[50:51]
v_cmp_ne_u64 s[44:45], s[88:89], v[54:55]
v_mfma_f32_16x16x32_bf16 v[152:155], a[240:243], a[88:91], v[152:155]
buffer_load_dwordx4 v8, s[20:23], 0 offen offset:1664 lds
v_perm_b32 v57, v45, v19, s54
v_mfma_f32_16x16x32_bf16 v[152:155], a[244:247], a[104:107], v[152:155]
s_or_b64 s[50:51], s[44:45], s[50:51]
ds_read_b32 a126, v57
v_perm_b32 v56, v45, v19, s55
v_mfma_f32_16x16x32_bf16 v[156:159], a[244:247], a[108:111], v[156:159]
s_cbranch_scc1 L_SLOW22
L_BACK22:
v_mfma_f32_16x16x32_bf16 v[156:159], a[240:243], a[92:95], v[156:159]
s_waitcnt lgkmcnt(1)
ds_read_b32 a127, v56
buffer_load_dwordx4 v[92:95], v12, s[24:27], 0 offen offset:3072 sc1
v_mfma_f32_16x16x32_bf16 v[192:195], a[248:251], a[64:67], v[192:195]
ds_read_b128 a[224:227], v14 offset:61440
v_perm_b32 v63, v48, v19, s52
v_mfma_f32_16x16x32_bf16 v[192:195], a[252:255], a[80:83], v[192:195]
ds_read_b32 a128, v63
v_add_u32 v12, 53248, v13
v_mfma_f32_16x16x32_bf16 v[196:199], a[252:255], a[84:87], v[196:199]
ds_read_b128 a[228:231], v15 offset:61440
v_perm_b32 v62, v48, v19, s53
v_mfma_f32_16x16x32_bf16 v[196:199], a[248:251], a[68:71], v[196:199]
ds_read_b32 a129, v62
v_perm_b32 v61, v52, v19, s52
v_mfma_f32_16x16x32_bf16 v[200:203], a[248:251], a[72:75], v[200:203]
ds_read_b32 a130, v61
v_perm_b32 v60, v52, v19, s53
v_mfma_f32_16x16x32_bf16 v[200:203], a[252:255], a[88:91], v[200:203]
ds_read_b32 a131, v60
v_perm_b32 v59, v48, v19, s54
v_mfma_f32_16x16x32_bf16 v[204:207], a[252:255], a[92:95], v[204:207]
ds_read_b32 a132, v59
v_perm_b32 v58, v48, v19, s55
v_mfma_f32_16x16x32_bf16 v[204:207], a[248:251], a[76:79], v[204:207]
s_waitcnt lgkmcnt(4)
ds_read_b32 a133, v58
v_mfma_f32_16x16x32_bf16 v[128:131], a[224:227], a[96:99], v[128:131]
ds_read_b128 a[232:235], v15 offset:51200
v_perm_b32 v57, v52, v19, s54
v_mfma_f32_16x16x32_bf16 v[128:131], a[228:231], a[112:115], v[128:131]
ds_read_b32 a134, v57
v_mfma_f32_16x16x32_bf16 v[132:135], a[228:231], a[116:119], v[132:135]
ds_read_b128 a[236:239], v16 offset:2048
v_perm_b32 v56, v52, v19, s55
v_mfma_f32_16x16x32_bf16 v[132:135], a[224:227], a[100:103], v[132:135]
ds_read_b32 a135, v56
v_perm_b32 v63, v49, v19, s52
v_mfma_f32_16x16x32_bf16 v[136:139], a[224:227], a[104:107], v[136:139]
ds_read_b32 a136, v63
v_perm_b32 v62, v49, v19, s53
v_mfma_f32_16x16x32_bf16 v[136:139], a[228:231], a[120:123], v[136:139]
ds_read_b32 a137, v62
v_perm_b32 v61, v53, v19, s52
v_mfma_f32_16x16x32_bf16 v[140:143], a[228:231], a[124:127], v[140:143]
ds_read_b32 a138, v61
v_perm_b32 v60, v53, v19, s53
v_mfma_f32_16x16x32_bf16 v[140:143], a[224:227], a[108:111], v[140:143]
s_waitcnt lgkmcnt(4)
ds_read_b32 a139, v60
v_mfma_f32_16x16x32_bf16 v[176:179], a[232:235], a[80:83], v[176:179]
ds_read_b128 a[240:243], v16 offset:0
v_perm_b32 v59, v49, v19, s54
v_mfma_f32_16x16x32_bf16 v[176:179], a[236:239], a[96:99], v[176:179]
ds_read_b32 a140, v59
v_mfma_f32_16x16x32_bf16 v[180:183], a[236:239], a[100:103], v[180:183]
ds_read_b128 a[244:247], v17 offset:0
v_perm_b32 v58, v49, v19, s55
v_mfma_f32_16x16x32_bf16 v[180:183], a[232:235], a[84:87], v[180:183]
s_waitcnt vmcnt(9)
v_cmp_ne_u64 s[50:51], s[88:89], v[98:99]
v_cmp_ne_u64 s[44:45], s[88:89], v[102:103]
v_mfma_f32_16x16x32_bf16 v[184:187], a[232:235], a[88:91], v[184:187]
ds_read_b32 a141, v58
v_perm_b32 v57, v53, v19, s54
v_mfma_f32_16x16x32_bf16 v[184:187], a[236:239], a[104:107], v[184:187]
s_or_b64 s[50:51], s[44:45], s[50:51]
ds_read_b32 a142, v57
v_perm_b32 v56, v53, v19, s55
v_mfma_f32_16x16x32_bf16 v[188:191], a[236:239], a[108:111], v[188:191]
s_cbranch_scc1 L_SLOW23
L_BACK23:
v_mfma_f32_16x16x32_bf16 v[188:191], a[232:235], a[92:95], v[188:191]
s_waitcnt lgkmcnt(2)
ds_read_b32 a143, v56
v_mfma_f32_16x16x32_bf16 v[160:163], a[240:243], a[96:99], v[160:163]
s_barrier
ds_read_b128 a[248:251], v15 offset:38912
v_perm_b32 v63, v96, v19, s52
v_mfma_f32_16x16x32_bf16 v[160:163], a[244:247], a[112:115], v[160:163]
ds_read_b32 a144, v63
v_mfma_f32_16x16x32_bf16 v[164:167], a[244:247], a[116:119], v[164:167]
ds_read_b128 a[252:255], v14 offset:55296
v_perm_b32 v62, v96, v19, s53
v_mfma_f32_16x16x32_bf16 v[164:167], a[240:243], a[100:103], v[164:167]
s_add_u32 m0, s33, 72192
ds_read_b32 a145, v62
buffer_load_dwordx4 v[32:35], v12, s[24:27], 0 offen offset:0 sc1
v_mfma_f32_16x16x32_bf16 v[168:171], a[240:243], a[104:107], v[168:171]
buffer_load_dwordx4 v10, s[20:23], 0 offen offset:1536 lds
v_perm_b32 v61, v100, v19, s52
v_mfma_f32_16x16x32_bf16 v[168:171], a[244:247], a[120:123], v[168:171]
ds_read_b32 a146, v61
v_perm_b32 v60, v100, v19, s53
v_mfma_f32_16x16x32_bf16 v[172:175], a[244:247], a[124:127], v[172:175]
ds_read_b32 a147, v60
v_perm_b32 v59, v96, v19, s54
v_mfma_f32_16x16x32_bf16 v[172:175], a[240:243], a[108:111], v[172:175]
s_waitcnt lgkmcnt(3)
ds_read_b32 a148, v59
buffer_load_dwordx4 v[36:39], v12, s[24:27], 0 offen offset:1024 sc1
v_mfma_f32_16x16x32_bf16 v[240:243], a[248:251], a[16:19], v[240:243]
ds_read_b128 a[224:227], v15 offset:63488
v_perm_b32 v58, v96, v19, s55
v_mfma_f32_16x16x32_bf16 v[240:243], a[252:255], a[32:35], v[240:243]
ds_read_b32 a149, v58
v_mfma_f32_16x16x32_bf16 v[244:247], a[252:255], a[36:39], v[244:247]
ds_read_b128 a[228:231], v16 offset:6144
v_perm_b32 v57, v100, v19, s54
v_mfma_f32_16x16x32_bf16 v[244:247], a[248:251], a[20:23], v[244:247]
ds_read_b32 a150, v57
v_perm_b32 v56, v100, v19, s55
v_mfma_f32_16x16x32_bf16 v[248:251], a[248:251], a[24:27], v[248:251]
ds_read_b32 a151, v56
v_perm_b32 v63, v97, v19, s52
v_mfma_f32_16x16x32_bf16 v[248:251], a[252:255], a[40:43], v[248:251]
ds_read_b32 a152, v63
v_perm_b32 v62, v97, v19, s53
v_mfma_f32_16x16x32_bf16 v[252:255], a[252:255], a[44:47], v[252:255]
s_add_u32 m0, s33, 80256
ds_read_b32 a153, v62
v_perm_b32 v61, v101, v19, s52
v_mfma_f32_16x16x32_bf16 v[252:255], a[248:251], a[28:31], v[252:255]
s_waitcnt lgkmcnt(4)
ds_read_b32 a154, v61
v_perm_b32 v60, v101, v19, s53
v_mfma_f32_16x16x32_bf16 v[144:147], a[224:227], a[112:115], v[144:147]
ds_read_b128 a[232:235], v16 offset:8192
buffer_load_dwordx4 v9, s[20:23], 0 offen offset:1664 lds
v_mfma_f32_16x16x32_bf16 v[144:147], a[228:231], a[128:131], v[144:147]
ds_read_b32 a155, v60
v_mfma_f32_16x16x32_bf16 v[148:151], a[228:231], a[132:135], v[148:151]
ds_read_b128 a[236:239], v17 offset:8192
v_perm_b32 v59, v97, v19, s54
v_mfma_f32_16x16x32_bf16 v[148:151], a[224:227], a[116:119], v[148:151]
ds_read_b32 a156, v59
v_perm_b32 v58, v97, v19, s55
v_mfma_f32_16x16x32_bf16 v[152:155], a[224:227], a[120:123], v[152:155]
ds_read_b32 a157, v58
v_perm_b32 v57, v101, v19, s54
v_mfma_f32_16x16x32_bf16 v[152:155], a[228:231], a[136:139], v[152:155]
ds_read_b32 a158, v57
v_perm_b32 v56, v101, v19, s55
v_mfma_f32_16x16x32_bf16 v[156:159], a[228:231], a[140:143], v[156:159]
s_waitcnt vmcnt(8)
v_cmp_ne_u64 s[50:51], s[88:89], v[82:83]
v_cmp_ne_u64 s[44:45], s[88:89], v[86:87]
v_mfma_f32_16x16x32_bf16 v[156:159], a[224:227], a[124:127], v[156:159]
s_waitcnt lgkmcnt(3)
ds_read_b32 a159, v56
v_mfma_f32_16x16x32_bf16 v[224:227], a[232:235], a[64:67], v[224:227]
s_or_b64 s[50:51], s[44:45], s[50:51]
ds_read_b128 a[240:243], v15 offset:59392
v_mfma_f32_16x16x32_bf16 v[224:227], a[236:239], a[80:83], v[224:227]
s_cbranch_scc1 L_SLOW24
L_BACK24:
v_mfma_f32_16x16x32_bf16 v[228:231], a[236:239], a[84:87], v[228:231]
ds_read_b128 a[244:247], v16 offset:14336
v_perm_b32 v63, v80, v19, s52
v_mfma_f32_16x16x32_bf16 v[228:231], a[232:235], a[68:71], v[228:231]
s_add_u32 m0, s33, 84224
ds_read_b32 a160, v63
buffer_load_dwordx4 v[40:43], v12, s[24:27], 0 offen offset:2048 sc1
v_mfma_f32_16x16x32_bf16 v[232:235], a[232:235], a[72:75], v[232:235]
buffer_load_dwordx4 v8, s[20:23], 0 offen offset:1792 lds
v_perm_b32 v62, v80, v19, s53
v_mfma_f32_16x16x32_bf16 v[232:235], a[236:239], a[88:91], v[232:235]
ds_read_b32 a161, v62
v_perm_b32 v61, v84, v19, s52
v_mfma_f32_16x16x32_bf16 v[236:239], a[236:239], a[92:95], v[236:239]
ds_read_b32 a162, v61
v_perm_b32 v60, v84, v19, s53
v_mfma_f32_16x16x32_bf16 v[236:239], a[232:235], a[76:79], v[236:239]
s_waitcnt lgkmcnt(3)
ds_read_b32 a163, v60
buffer_load_dwordx4 v[44:47], v12, s[24:27], 0 offen offset:3072 sc1
v_mfma_f32_16x16x32_bf16 v[208:211], a[240:243], a[80:83], v[208:211]
ds_read_b128 a[248:251], v16 offset:4096
v_perm_b32 v59, v80, v19, s54
v_mfma_f32_16x16x32_bf16 v[208:211], a[244:247], a[96:99], v[208:211]
ds_read_b32 a164, v59
v_add_u32 v12, 57344, v13
v_mfma_f32_16x16x32_bf16 v[212:215], a[244:247], a[100:103], v[212:215]
ds_read_b128 a[252:255], v17 offset:4096
v_perm_b32 v58, v80, v19, s55
v_mfma_f32_16x16x32_bf16 v[212:215], a[240:243], a[84:87], v[212:215]
ds_read_b32 a165, v58
v_perm_b32 v57, v84, v19, s54
v_mfma_f32_16x16x32_bf16 v[216:219], a[240:243], a[88:91], v[216:219]
ds_read_b32 a166, v57
v_perm_b32 v56, v84, v19, s55
v_mfma_f32_16x16x32_bf16 v[216:219], a[244:247], a[104:107], v[216:219]
ds_read_b32 a167, v56
v_perm_b32 v63, v81, v19, s52
v_mfma_f32_16x16x32_bf16 v[220:223], a[244:247], a[108:111], v[220:223]
s_add_u32 m0, s33, 76416
ds_read_b32 a168, v63
v_perm_b32 v62, v81, v19, s53
v_mfma_f32_16x16x32_bf16 v[220:223], a[240:243], a[92:95], v[220:223]
s_waitcnt lgkmcnt(4)
ds_read_b32 a169, v62
v_perm_b32 v61, v85, v19, s52
v_mfma_f32_16x16x32_bf16 v[128:131], a[248:251], a[128:131], v[128:131]
ds_read_b128 a[224:227], v16 offset:12288
buffer_load_dwordx4 v11, s[20:23], 0 offen offset:1408 lds
v_mfma_f32_16x16x32_bf16 v[128:131], a[252:255], a[144:147], v[128:131]
ds_read_b32 a170, v61
v_mfma_f32_16x16x32_bf16 v[132:135], a[252:255], a[148:151], v[132:135]
ds_read_b128 a[228:231], v17 offset:12288
v_perm_b32 v60, v85, v19, s53
v_mfma_f32_16x16x32_bf16 v[132:135], a[248:251], a[132:135], v[132:135]
ds_read_b32 a171, v60
v_perm_b32 v59, v81, v19, s54
v_mfma_f32_16x16x32_bf16 v[136:139], a[248:251], a[136:139], v[136:139]
ds_read_b32 a172, v59
v_perm_b32 v58, v81, v19, s55
v_mfma_f32_16x16x32_bf16 v[136:139], a[252:255], a[152:155], v[136:139]
ds_read_b32 a173, v58
v_perm_b32 v57, v85, v19, s54
v_mfma_f32_16x16x32_bf16 v[140:143], a[252:255], a[156:159], v[140:143]
s_waitcnt vmcnt(8)
v_cmp_ne_u64 s[50:51], s[88:89], v[90:91]
v_cmp_ne_u64 s[44:45], s[88:89], v[94:95]
v_mfma_f32_16x16x32_bf16 v[140:143], a[248:251], a[140:143], v[140:143]
s_waitcnt lgkmcnt(3)
ds_read_b32 a174, v57
v_mfma_f32_16x16x32_bf16 v[192:195], a[224:227], a[96:99], v[192:195]
s_or_b64 s[50:51], s[44:45], s[50:51]
ds_read_b128 a[232:235], v17 offset:2048
v_mfma_f32_16x16x32_bf16 v[192:195], a[228:231], a[112:115], v[192:195]
s_cbranch_scc1 L_SLOW25
L_BACK25:
v_mfma_f32_16x16x32_bf16 v[196:199], a[228:231], a[116:119], v[196:199]
ds_read_b128 a[236:239], v16 offset:18432
v_perm_b32 v56, v85, v19, s55
v_mfma_f32_16x16x32_bf16 v[196:199], a[224:227], a[100:103], v[196:199]
s_add_u32 m0, s33, 88320
ds_read_b32 a175, v56
v_mfma_f32_16x16x32_bf16 v[200:203], a[224:227], a[104:107], v[200:203]
buffer_load_dwordx4 v9, s[20:23], 0 offen offset:1792 lds
v_perm_b32 v63, v88, v19, s52
v_mfma_f32_16x16x32_bf16 v[200:203], a[228:231], a[120:123], v[200:203]
ds_read_b32 a176, v63
v_perm_b32 v62, v88, v19, s53
v_mfma_f32_16x16x32_bf16 v[204:207], a[228:231], a[124:127], v[204:207]
ds_read_b32 a177, v62
v_perm_b32 v61, v92, v19, s52
v_mfma_f32_16x16x32_bf16 v[204:207], a[224:227], a[108:111], v[204:207]
s_waitcnt lgkmcnt(3)
ds_read_b32 a178, v61
v_mfma_f32_16x16x32_bf16 v[176:179], a[232:235], a[112:115], v[176:179]
ds_read_b128 a[240:243], v16 offset:16384
v_perm_b32 v60, v92, v19, s53
v_mfma_f32_16x16x32_bf16 v[176:179], a[236:239], a[128:131], v[176:179]
ds_read_b32 a179, v60
v_mfma_f32_16x16x32_bf16 v[180:183], a[236:239], a[132:135], v[180:183]
ds_read_b128 a[244:247], v17 offset:16384
v_perm_b32 v59, v88, v19, s54
v_mfma_f32_16x16x32_bf16 v[180:183], a[232:235], a[116:119], v[180:183]
s_add_u32 m0, s33, 92544
ds_read_b32 a180, v59
buffer_load_dwordx4 v[48:51], v12, s[24:27], 0 offen offset:0 sc1
v_mfma_f32_16x16x32_bf16 v[184:187], a[232:235], a[120:123], v[184:187]
buffer_load_dwordx4 v10, s[20:23], 0 offen offset:1664 lds
v_perm_b32 v58, v88, v19, s55
v_mfma_f32_16x16x32_bf16 v[184:187], a[236:239], a[136:139], v[184:187]
ds_read_b32 a181, v58
v_perm_b32 v57, v92, v19, s54
v_mfma_f32_16x16x32_bf16 v[188:191], a[236:239], a[140:143], v[188:191]
ds_read_b32 a182, v57
v_perm_b32 v56, v92, v19, s55
v_mfma_f32_16x16x32_bf16 v[188:191], a[232:235], a[124:127], v[188:191]
s_waitcnt lgkmcnt(3)
ds_read_b32 a183, v56
buffer_load_dwordx4 v[52:55], v12, s[24:27], 0 offen offset:1024 sc1
v_mfma_f32_16x16x32_bf16 v[160:163], a[240:243], a[128:131], v[160:163]
L_PAD4:
s_cbranch_vccnz L_PADRET
s_barrier
ds_read_b128 a[248:251], v17 offset:6144
v_perm_b32 v63, v89, v19, s52
v_mfma_f32_16x16x32_bf16 v[160:163], a[244:247], a[144:147], v[160:163]
ds_read_b32 a184, v63
v_mfma_f32_16x16x32_bf16 v[164:167], a[244:247], a[148:151], v[164:167]
ds_read_b128 a[252:255], v16 offset:22528
v_perm_b32 v62, v89, v19, s53
v_mfma_f32_16x16x32_bf16 v[164:167], a[240:243], a[132:135], v[164:167]
ds_read_b32 a185, v62
v_perm_b32 v61, v93, v19, s52
v_mfma_f32_16x16x32_bf16 v[168:171], a[240:243], a[136:139], v[168:171]
ds_read_b32 a186, v61
v_perm_b32 v60, v93, v19, s53
v_mfma_f32_16x16x32_bf16 v[168:171], a[244:247], a[152:155], v[168:171]
ds_read_b32 a187, v60
v_perm_b32 v59, v89, v19, s54
v_mfma_f32_16x16x32_bf16 v[172:175], a[244:247], a[156:159], v[172:175]
ds_read_b32 a188, v59
v_perm_b32 v58, v89, v19, s55
v_mfma_f32_16x16x32_bf16 v[172:175], a[240:243], a[140:143], v[172:175]
s_waitcnt lgkmcnt(4)
ds_read_b32 a189, v58
v_mfma_f32_16x16x32_bf16 v[144:147], a[248:251], a[144:147], v[144:147]
ds_read_b128 a[224:227], v16 offset:20480
v_perm_b32 v57, v93, v19, s54
v_mfma_f32_16x16x32_bf16 v[144:147], a[252:255], a[160:163], v[144:147]
ds_read_b32 a190, v57
v_mfma_f32_16x16x32_bf16 v[148:151], a[252:255], a[164:167], v[148:151]
ds_read_b128 a[228:231], v17 offset:20480
v_perm_b32 v56, v93, v19, s55
v_mfma_f32_16x16x32_bf16 v[148:151], a[248:251], a[148:151], v[148:151]
s_add_u32 m0, s33, 96384
ds_read_b32 a191, v56
v_mfma_f32_16x16x32_bf16 v[152:155], a[248:251], a[152:155], v[152:155]
buffer_load_dwordx4 v8, s[20:23], 0 offen offset:1920 lds
v_mfma_f32_16x16x32_bf16 v[152:155], a[252:255], a[168:171], v[152:155]
v_mfma_f32_16x16x32_bf16 v[156:159], a[252:255], a[172:175], v[156:159]
s_waitcnt vmcnt(10)
v_cmp_ne_u64 s[50:51], s[88:89], v[34:35]
v_cmp_ne_u64 s[44:45], s[88:89], v[38:39]
v_mfma_f32_16x16x32_bf16 v[156:159], a[248:251], a[156:159], v[156:159]
s_waitcnt lgkmcnt(1)
v_mfma_f32_16x16x32_bf16 v[128:131], a[224:227], a[160:163], v[128:131]
s_or_b64 s[50:51], s[44:45], s[50:51]
ds_read_b128 a[232:235], v16 offset:24576
v_mfma_f32_16x16x32_bf16 v[128:131], a[228:231], a[176:179], v[128:131]
s_cbranch_scc1 L_SLOW26
L_BACK26:
v_mfma_f32_16x16x32_bf16 v[132:135], a[228:231], a[180:183], v[132:135]
ds_read_b128 a[236:239], v17 offset:24576
v_mfma_f32_16x16x32_bf16 v[132:135], a[224:227], a[164:167], v[132:135]
buffer_load_dwordx4 v[96:99], v12, s[24:27], 0 offen offset:2048 sc1
v_perm_b32 v63, v32, v19, s52
v_mfma_f32_16x16x32_bf16 v[136:139], a[224:227], a[168:171], v[136:139]
ds_read_b32 a192, v63
v_perm_b32 v62, v32, v19, s53
v_mfma_f32_16x16x32_bf16 v[136:139], a[228:231], a[184:187], v[136:139]
s_waitcnt lgkmcnt(2)
ds_read_b32 a193, v62
v_perm_b32 v61, v36, v19, s52
v_mfma_f32_16x16x32_bf16 v[140:143], a[228:231], a[188:191], v[140:143]
s_add_u32 m0, s33, 104960
ds_read_b32 a194, v61
v_perm_b32 v60, v36, v19, s53
v_mfma_f32_16x16x32_bf16 v[140:143], a[224:227], a[172:175], v[140:143]
s_waitcnt lgkmcnt(3)
ds_read_b32 a195, v60
v_perm_b32 v59, v32, v19, s54
v_mfma_f32_16x16x32_bf16 v[192:195], a[232:235], a[128:131], v[192:195]
ds_read_b128 a[240:243], v17 offset:14336
buffer_load_dwordx4 v11, s[20:23], 0 offen offset:1536 lds
v_mfma_f32_16x16x32_bf16 v[192:195], a[236:239], a[144:147], v[192:195]
ds_read_b32 a196, v59
buffer_load_dwordx4 v[100:103], v12, s[24:27], 0 offen offset:3072 sc1
v_mfma_f32_16x16x32_bf16 v[196:199], a[236:239], a[148:151], v[196:199]
ds_read_b128 a[244:247], v16 offset:26624
v_perm_b32 v58, v32, v19, s55
v_mfma_f32_16x16x32_bf16 v[196:199], a[232:235], a[132:135], v[196:199]
ds_read_b32 a197, v58
v_perm_b32 v57, v36, v19, s54
v_mfma_f32_16x16x32_bf16 v[200:203], a[232:235], a[136:139], v[200:203]
ds_read_b32 a198, v57
v_perm_b32 v56, v36, v19, s55
v_mfma_f32_16x16x32_bf16 v[200:203], a[236:239], a[152:155], v[200:203]
ds_read_b32 a199, v56
v_perm_b32 v63, v33, v19, s52
v_mfma_f32_16x16x32_bf16 v[204:207], a[236:239], a[156:159], v[204:207]
ds_read_b32 a200, v63
v_perm_b32 v62, v33, v19, s53
v_mfma_f32_16x16x32_bf16 v[204:207], a[232:235], a[140:143], v[204:207]
s_waitcnt lgkmcnt(4)
ds_read_b32 a201, v62
v_add_u32 v12, 61440, v13
v_mfma_f32_16x16x32_bf16 v[208:211], a[240:243], a[112:115], v[208:211]
ds_read_b128 a[248:251], v17 offset:18432
v_perm_b32 v61, v37, v19, s52
v_mfma_f32_16x16x32_bf16 v[208:211], a[244:247], a[128:131], v[208:211]
ds_read_b32 a202, v61
v_mfma_f32_16x16x32_bf16 v[212:215], a[244:247], a[132:135], v[212:215]
ds_read_b128 a[252:255], v16 offset:30720
v_perm_b32 v60, v37, v19, s53
v_mfma_f32_16x16x32_bf16 v[212:215], a[240:243], a[116:119], v[212:215]
s_add_u32 m0, s33, 108672
ds_read_b32 a203, v60
v_mfma_f32_16x16x32_bf16 v[216:219], a[240:243], a[120:123], v[216:219]
buffer_load_dwordx4 v9, s[20:23], 0 offen offset:1920 lds
v_perm_b32 v59, v33, v19, s54
v_mfma_f32_16x16x32_bf16 v[216:219], a[244:247], a[136:139], v[216:219]
ds_read_b32 a204, v59
v_perm_b32 v58, v33, v19, s55
v_mfma_f32_16x16x32_bf16 v[220:223], a[244:247], a[140:143], v[220:223]
ds_read_b32 a205, v58
v_mfma_f32_16x16x32_bf16 v[220:223], a[240:243], a[124:127], v[220:223]
s_waitcnt vmcnt(10) lgkmcnt(3)
v_perm_b32 v57, v37, v19, s54
v_cmp_ne_u64 s[50:51], s[88:89], v[42:43]
v_mfma_f32_16x16x32_bf16 v[176:179], a[248:251], a[144:147], v[176:179]
ds_read_b128 a[224:227], v14 offset:0
v_cmp_ne_u64 s[44:45], s[88:89], v[46:47]
v_mfma_f32_16x16x32_bf16 v[176:179], a[252:255], a[160:163], v[176:179]
ds_read_b32 a206, v57
v_mfma_f32_16x16x32_bf16 v[180:183], a[252:255], a[164:167], v[180:183]
s_or_b64 s[50:51], s[44:45], s[50:51]
ds_read_b128 a[228:231], v15 offset:0
v_perm_b32 v56, v37, v19, s55
v_mfma_f32_16x16x32_bf16 v[180:183], a[248:251], a[148:151], v[180:183]
s_cbranch_scc1 L_SLOW27
L_BACK27:
v_mfma_f32_16x16x32_bf16 v[184:187], a[248:251], a[152:155], v[184:187]
ds_read_b32 a207, v56
v_perm_b32 v63, v40, v19, s52
v_mfma_f32_16x16x32_bf16 v[184:187], a[252:255], a[168:171], v[184:187]
ds_read_b32 a208, v63
v_perm_b32 v62, v40, v19, s53
v_mfma_f32_16x16x32_bf16 v[188:191], a[252:255], a[172:175], v[188:191]
s_add_u32 m0, s33, 112896
ds_read_b32 a209, v62
v_perm_b32 v61, v44, v19, s52
v_mfma_f32_16x16x32_bf16 v[188:191], a[248:251], a[156:159], v[188:191]
s_waitcnt lgkmcnt(3)
ds_read_b32 a210, v61
v_perm_b32 v60, v44, v19, s53
v_mfma_f32_16x16x32_bf16 v[224:227], a[224:227], a[96:99], v[224:227]
ds_read_b128 a[232:235], v16 offset:28672
buffer_load_dwordx4 v10, s[20:23], 0 offen offset:1792 lds
v_mfma_f32_16x16x32_bf16 v[224:227], a[228:231], a[112:115], v[224:227]
ds_read_b32 a211, v60
buffer_load_dwordx4 v[80:83], v12, s[24:27], 0 offen offset:0 sc1
v_mfma_f32_16x16x32_bf16 v[228:231], a[228:231], a[116:119], v[228:231]
ds_read_b128 a[236:239], v17 offset:28672
v_perm_b32 v59, v40, v19, s54
v_mfma_f32_16x16x32_bf16 v[228:231], a[224:227], a[100:103], v[228:231]
ds_read_b32 a212, v59
v_perm_b32 v58, v40, v19, s55
v_mfma_f32_16x16x32_bf16 v[232:235], a[224:227], a[104:107], v[232:235]
ds_read_b32 a213, v58
v_perm_b32 v57, v44, v19, s54
v_mfma_f32_16x16x32_bf16 v[232:235], a[228:231], a[120:123], v[232:235]
ds_read_b32 a214, v57
v_perm_b32 v56, v44, v19, s55
v_mfma_f32_16x16x32_bf16 v[236:239], a[228:231], a[124:127], v[236:239]
ds_read_b32 a215, v56
v_perm_b32 v63, v41, v19, s52
v_mfma_f32_16x16x32_bf16 v[236:239], a[224:227], a[108:111], v[236:239]
s_waitcnt lgkmcnt(4)
ds_read_b32 a216, v63
buffer_load_dwordx4 v[84:87], v12, s[24:27], 0 offen offset:1024 sc1
v_mfma_f32_16x16x32_bf16 v[160:163], a[232:235], a[160:163], v[160:163]
ds_read_b128 a[240:243], v17 offset:22528
v_perm_b32 v62, v41, v19, s53
v_mfma_f32_16x16x32_bf16 v[160:163], a[236:239], a[176:179], v[160:163]
ds_read_b32 a217, v62
v_mfma_f32_16x16x32_bf16 v[164:167], a[236:239], a[180:183], v[164:167]
ds_read_b128 a[244:247], v14 offset:6144
v_perm_b32 v61, v45, v19, s52
v_mfma_f32_16x16x32_bf16 v[164:167], a[232:235], a[164:167], v[164:167]
s_add_u32 m0, s33, 100736
ds_read_b32 a218, v61
v_mfma_f32_16x16x32_bf16 v[168:171], a[232:235], a[168:171], v[168:171]
buffer_load_dwordx4 v11, s[20:23], 0 offen offset:1664 lds
v_perm_b32 v60, v45, v19, s53
v_mfma_f32_16x16x32_bf16 v[168:171], a[236:239], a[184:187], v[168:171]
ds_read_b32 a219, v60
v_perm_b32 v59, v41, v19, s54
v_mfma_f32_16x16x32_bf16 v[172:175], a[236:239], a[188:191], v[172:175]
ds_read_b32 a220, v59
v_perm_b32 v58, v41, v19, s55
v_mfma_f32_16x16x32_bf16 v[172:175], a[232:235], a[172:175], v[172:175]
s_waitcnt lgkmcnt(3)
ds_read_b32 a221, v58
v_mfma_f32_16x16x32_bf16 v[144:147], a[240:243], a[176:179], v[144:147]
s_barrier
ds_read_b128 a[248:251], v14 offset:4096
v_perm_b32 v57, v45, v19, s54
v_mfma_f32_16x16x32_bf16 v[144:147], a[244:247], a[192:195], v[144:147]
ds_read_b32 a222, v57
v_mfma_f32_16x16x32_bf16 v[148:151], a[244:247], a[196:199], v[148:151]
ds_read_b128 a[252:255], v15 offset:4096
v_perm_b32 v56, v45, v19, s55
v_mfma_f32_16x16x32_bf16 v[148:151], a[240:243], a[180:183], v[148:151]
ds_read_b32 a223, v56
v_mfma_f32_16x16x32_bf16 v[152:155], a[240:243], a[184:187], v[152:155]
v_mfma_f32_16x16x32_bf16 v[152:155], a[244:247], a[200:203], v[152:155]
buffer_load_dwordx4 v[88:91], v12, s[24:27], 0 offen offset:2048 sc1
v_mfma_f32_16x16x32_bf16 v[156:159], a[244:247], a[204:207], v[156:159]
s_waitcnt vmcnt(10)
s_add_u32 m0, s33, 125056
v_cmp_ne_u64 s[50:51], s[88:89], v[50:51]
v_cmp_ne_u64 s[44:45], s[88:89], v[54:55]
v_mfma_f32_16x16x32_bf16 v[156:159], a[240:243], a[188:191], v[156:159]
s_waitcnt lgkmcnt(1)
buffer_load_dwordx4 v[92:95], v12, s[24:27], 0 offen offset:3072 sc1
v_mfma_f32_16x16x32_bf16 v[128:131], a[248:251], a[192:195], v[128:131]
s_or_b64 s[50:51], s[44:45], s[50:51]
ds_read_b128 a[224:227], v15 offset:55296
buffer_load_dwordx4 v10, s[20:23], 0 offen offset:1920 lds
v_mfma_f32_16x16x32_bf16 v[128:131], a[252:255], a[208:211], v[128:131]
s_cbranch_scc1 L_SLOW28
L_BACK28:
v_mfma_f32_16x16x32_bf16 v[132:135], a[252:255], a[212:215], v[132:135]
ds_read_b128 a[228:231], v16 offset:10240
v_mfma_f32_16x16x32_bf16 v[132:135], a[248:251], a[196:199], v[132:135]
v_perm_b32 v63, v48, v19, s52
v_mfma_f32_16x16x32_bf16 v[136:139], a[248:251], a[200:203], v[136:139]
ds_read_b32 a0, v63
v_perm_b32 v62, v48, v19, s53
v_mfma_f32_16x16x32_bf16 v[136:139], a[252:255], a[216:219], v[136:139]
s_waitcnt lgkmcnt(2)
ds_read_b32 a1, v62
v_perm_b32 v61, v52, v19, s52
v_mfma_f32_16x16x32_bf16 v[140:143], a[252:255], a[220:223], v[140:143]
ds_read_b32 a2, v61
v_perm_b32 v60, v52, v19, s53
v_mfma_f32_16x16x32_bf16 v[140:143], a[248:251], a[204:207], v[140:143]
s_waitcnt lgkmcnt(3)
ds_read_b32 a3, v60
v_mfma_f32_16x16x32_bf16 v[240:243], a[224:227], a[48:51], v[240:243]
ds_read_b128 a[232:235], v14 offset:8192
v_perm_b32 v59, v48, v19, s54
v_mfma_f32_16x16x32_bf16 v[240:243], a[228:231], a[64:67], v[240:243]
ds_read_b32 a4, v59
v_mfma_f32_16x16x32_bf16 v[244:247], a[228:231], a[68:71], v[244:247]
ds_read_b128 a[236:239], v15 offset:8192
v_perm_b32 v58, v48, v19, s55
v_mfma_f32_16x16x32_bf16 v[244:247], a[224:227], a[52:55], v[244:247]
s_add_u32 m0, s33, 121088
ds_read_b32 a5, v58
v_mfma_f32_16x16x32_bf16 v[248:251], a[224:227], a[56:59], v[248:251]
buffer_load_dwordx4 v11, s[20:23], 0 offen offset:1792 lds
v_perm_b32 v57, v52, v19, s54
v_mfma_f32_16x16x32_bf16 v[248:251], a[228:231], a[72:75], v[248:251]
ds_read_b32 a6, v57
v_perm_b32 v56, v52, v19, s55
v_mfma_f32_16x16x32_bf16 v[252:255], a[228:231], a[76:79], v[252:255]
ds_read_b32 a7, v56
v_perm_b32 v63, v49, v19, s52
v_mfma_f32_16x16x32_bf16 v[252:255], a[224:227], a[60:63], v[252:255]
s_waitcnt lgkmcnt(3)
ds_read_b32 a8, v63
v_mfma_f32_16x16x32_bf16 v[192:195], a[232:235], a[160:163], v[192:195]
ds_read_b128 a[240:243], v17 offset:30720
v_perm_b32 v62, v49, v19, s53
v_mfma_f32_16x16x32_bf16 v[192:195], a[236:239], a[176:179], v[192:195]
ds_read_b32 a9, v62
v_mfma_f32_16x16x32_bf16 v[196:199], a[236:239], a[180:183], v[196:199]
ds_read_b128 a[244:247], v14 offset:18432
v_perm_b32 v61, v53, v19, s52
v_mfma_f32_16x16x32_bf16 v[196:199], a[232:235], a[164:167], v[196:199]
ds_read_b32 a10, v61
v_perm_b32 v60, v53, v19, s53
v_mfma_f32_16x16x32_bf16 v[200:203], a[232:235], a[168:171], v[200:203]
ds_read_b32 a11, v60
v_perm_b32 v59, v49, v19, s54
v_mfma_f32_16x16x32_bf16 v[200:203], a[236:239], a[184:187], v[200:203]
ds_read_b32 a12, v59
v_perm_b32 v58, v49, v19, s55
v_mfma_f32_16x16x32_bf16 v[204:207], a[236:239], a[188:191], v[204:207]
s_add_u32 m0, s33, 129152
ds_read_b32 a13, v58
v_perm_b32 v57, v53, v19, s54
v_mfma_f32_16x16x32_bf16 v[204:207], a[232:235], a[172:175], v[204:207]
s_waitcnt vmcnt(9) lgkmcnt(4)
v_cmp_ne_u64 s[50:51], s[88:89], v[98:99]
v_cmp_ne_u64 s[44:45], s[88:89], v[102:103]
v_mfma_f32_16x16x32_bf16 v[176:179], a[240:243], a[176:179], v[176:179]
ds_read_b128 a[248:251], v14 offset:16384
buffer_load_dwordx4 v11, s[20:23], 0 offen offset:1920 lds
v_mfma_f32_16x16x32_bf16 v[176:179], a[244:247], a[192:195], v[176:179]
ds_read_b32 a14, v57
v_mfma_f32_16x16x32_bf16 v[180:183], a[244:247], a[196:199], v[180:183]
s_or_b64 s[50:51], s[44:45], s[50:51]
ds_read_b128 a[252:255], v15 offset:16384
v_perm_b32 v56, v53, v19, s55
v_mfma_f32_16x16x32_bf16 v[180:183], a[240:243], a[180:183], v[180:183]
s_cbranch_scc1 L_SLOW29
L_BACK29:
v_mfma_f32_16x16x32_bf16 v[184:187], a[240:243], a[184:187], v[184:187]
ds_read_b32 a15, v56
v_perm_b32 v63, v96, v19, s52
v_mfma_f32_16x16x32_bf16 v[184:187], a[244:247], a[200:203], v[184:187]
ds_read_b32 a16, v63
v_perm_b32 v62, v96, v19, s53
v_mfma_f32_16x16x32_bf16 v[188:191], a[244:247], a[204:207], v[188:191]
ds_read_b32 a17, v62
v_perm_b32 v61, v100, v19, s52
v_mfma_f32_16x16x32_bf16 v[188:191], a[240:243], a[188:191], v[188:191]
s_waitcnt lgkmcnt(3)
ds_read_b32 a18, v61
v_mfma_f32_16x16x32_bf16 v[160:163], a[248:251], a[192:195], v[160:163]
ds_read_b128 a[224:227], v17 offset:26624
v_perm_b32 v60, v100, v19, s53
v_mfma_f32_16x16x32_bf16 v[160:163], a[252:255], a[208:211], v[160:163]
ds_read_b32 a19, v60
v_mfma_f32_16x16x32_bf16 v[164:167], a[252:255], a[212:215], v[164:167]
ds_read_b128 a[228:231], v14 offset:10240
v_perm_b32 v59, v96, v19, s54
v_mfma_f32_16x16x32_bf16 v[164:167], a[248:251], a[196:199], v[164:167]
ds_read_b32 a20, v59
v_perm_b32 v58, v96, v19, s55
v_mfma_f32_16x16x32_bf16 v[168:171], a[248:251], a[200:203], v[168:171]
ds_read_b32 a21, v58
v_perm_b32 v57, v100, v19, s54
v_mfma_f32_16x16x32_bf16 v[168:171], a[252:255], a[216:219], v[168:171]
ds_read_b32 a22, v57
v_perm_b32 v56, v100, v19, s55
v_mfma_f32_16x16x32_bf16 v[172:175], a[252:255], a[220:223], v[172:175]
ds_read_b32 a23, v56
v_perm_b32 v63, v97, v19, s52
v_mfma_f32_16x16x32_bf16 v[172:175], a[248:251], a[204:207], v[172:175]
s_waitcnt lgkmcnt(4)
ds_read_b32 a24, v63
v_mfma_f32_16x16x32_bf16 v[208:211], a[224:227], a[144:147], v[208:211]
ds_read_b128 a[232:235], v15 offset:6144
v_perm_b32 v62, v97, v19, s53
v_mfma_f32_16x16x32_bf16 v[208:211], a[228:231], a[160:163], v[208:211]
ds_read_b32 a25, v62
v_mfma_f32_16x16x32_bf16 v[212:215], a[228:231], a[164:167], v[212:215]
ds_read_b128 a[236:239], v14 offset:22528
v_perm_b32 v61, v101, v19, s52
v_mfma_f32_16x16x32_bf16 v[212:215], a[224:227], a[148:151], v[212:215]
ds_read_b32 a26, v61
v_perm_b32 v60, v101, v19, s53
v_mfma_f32_16x16x32_bf16 v[216:219], a[224:227], a[152:155], v[216:219]
ds_read_b32 a27, v60
v_perm_b32 v59, v97, v19, s54
v_mfma_f32_16x16x32_bf16 v[216:219], a[228:231], a[168:171], v[216:219]
ds_read_b32 a28, v59
v_perm_b32 v58, v97, v19, s55
v_mfma_f32_16x16x32_bf16 v[220:223], a[228:231], a[172:175], v[220:223]
ds_read_b32 a29, v58
v_perm_b32 v57, v101, v19, s54
v_mfma_f32_16x16x32_bf16 v[220:223], a[224:227], a[156:159], v[220:223]
s_waitcnt lgkmcnt(4)
ds_read_b32 a30, v57
v_mfma_f32_16x16x32_bf16 v[144:147], a[232:235], a[208:211], v[144:147]
ds_read_b128 a[240:243], v14 offset:20480
v_mfma_f32_16x16x32_bf16 v[144:147], a[236:239], a[0:3], v[144:147]
s_waitcnt vmcnt(6)
v_cmp_ne_u64 s[50:51], s[88:89], v[82:83]
v_cmp_ne_u64 s[44:45], s[88:89], v[86:87]
v_mfma_f32_16x16x32_bf16 v[148:151], a[236:239], a[4:7], v[148:151]
ds_read_b128 a[244:247], v15 offset:20480
v_perm_b32 v56, v101, v19, s55
v_mfma_f32_16x16x32_bf16 v[148:151], a[232:235], a[212:215], v[148:151]
s_or_b64 s[50:51], s[44:45], s[50:51]
ds_read_b32 a31, v56
v_mfma_f32_16x16x32_bf16 v[152:155], a[232:235], a[216:219], v[152:155]
s_cbranch_scc1 L_SLOW30
L_BACK30:
v_mfma_f32_16x16x32_bf16 v[152:155], a[236:239], a[8:11], v[152:155]
v_perm_b32 v63, v80, v19, s52
v_mfma_f32_16x16x32_bf16 v[156:159], a[236:239], a[12:15], v[156:159]
ds_read_b32 a32, v63
v_perm_b32 v62, v80, v19, s53
v_mfma_f32_16x16x32_bf16 v[156:159], a[232:235], a[220:223], v[156:159]
s_waitcnt lgkmcnt(2)
ds_read_b32 a33, v62
v_mfma_f32_16x16x32_bf16 v[128:131], a[240:243], a[0:3], v[128:131]
s_barrier
ds_read_b128 a[248:251], v14 offset:12288
v_perm_b32 v61, v84, v19, s52
v_mfma_f32_16x16x32_bf16 v[128:131], a[244:247], a[16:19], v[128:131]
ds_read_b32 a34, v61
v_mfma_f32_16x16x32_bf16 v[132:135], a[244:247], a[20:23], v[132:135]
ds_read_b128 a[252:255], v15 offset:12288
v_perm_b32 v60, v84, v19, s53
v_mfma_f32_16x16x32_bf16 v[132:135], a[240:243], a[4:7], v[132:135]
ds_read_b32 a35, v60
v_perm_b32 v59, v80, v19, s54
v_mfma_f32_16x16x32_bf16 v[136:139], a[240:243], a[8:11], v[136:139]
ds_read_b32 a36, v59
v_perm_b32 v58, v80, v19, s55
v_mfma_f32_16x16x32_bf16 v[136:139], a[244:247], a[24:27], v[136:139]
s_waitcnt lgkmcnt(4)
ds_read_b32 a37, v58
v_perm_b32 v57, v84, v19, s54
v_mfma_f32_16x16x32_bf16 v[140:143], a[244:247], a[28:31], v[140:143]
ds_read_b32 a38, v57
v_perm_b32 v56, v84, v19, s55
v_mfma_f32_16x16x32_bf16 v[140:143], a[240:243], a[12:15], v[140:143]
s_waitcnt lgkmcnt(4)
ds_read_b32 a39, v56
v_mfma_f32_16x16x32_bf16 v[224:227], a[248:251], a[128:131], v[224:227]
ds_read_b128 a[224:227], v15 offset:18432
v_perm_b32 v63, v81, v19, s52
v_mfma_f32_16x16x32_bf16 v[224:227], a[252:255], a[144:147], v[224:227]
ds_read_b32 a40, v63
v_mfma_f32_16x16x32_bf16 v[228:231], a[252:255], a[148:151], v[228:231]
ds_read_b128 a[228:231], v14 offset:26624
v_perm_b32 v62, v81, v19, s53
v_mfma_f32_16x16x32_bf16 v[228:231], a[248:251], a[132:135], v[228:231]
ds_read_b32 a41, v62
v_perm_b32 v61, v85, v19, s52
v_mfma_f32_16x16x32_bf16 v[232:235], a[248:251], a[136:139], v[232:235]
ds_read_b32 a42, v61
v_perm_b32 v60, v85, v19, s53
v_mfma_f32_16x16x32_bf16 v[232:235], a[252:255], a[152:155], v[232:235]
ds_read_b32 a43, v60
v_perm_b32 v59, v81, v19, s54
v_mfma_f32_16x16x32_bf16 v[236:239], a[252:255], a[156:159], v[236:239]
ds_read_b32 a44, v59
v_perm_b32 v58, v81, v19, s55
v_mfma_f32_16x16x32_bf16 v[236:239], a[248:251], a[140:143], v[236:239]
s_waitcnt lgkmcnt(4)
ds_read_b32 a45, v58
v_mfma_f32_16x16x32_bf16 v[176:179], a[224:227], a[208:211], v[176:179]
ds_read_b128 a[232:235], v14 offset:24576
v_mfma_f32_16x16x32_bf16 v[176:179], a[228:231], a[0:3], v[176:179]
s_waitcnt vmcnt(3)
v_cmp_ne_u64 s[50:51], s[88:89], v[90:91]
v_cmp_ne_u64 s[44:45], s[88:89], v[94:95]
v_mfma_f32_16x16x32_bf16 v[180:183], a[228:231], a[4:7], v[180:183]
ds_read_b128 a[236:239], v15 offset:24576
v_perm_b32 v57, v85, v19, s54
v_mfma_f32_16x16x32_bf16 v[180:183], a[224:227], a[212:215], v[180:183]
s_or_b64 s[50:51], s[44:45], s[50:51]
ds_read_b32 a46, v57
v_perm_b32 v56, v85, v19, s55
v_mfma_f32_16x16x32_bf16 v[184:187], a[224:227], a[216:219], v[184:187]
s_cbranch_scc1 L_SLOW31
L_BACK31:
v_mfma_f32_16x16x32_bf16 v[184:187], a[228:231], a[8:11], v[184:187]
ds_read_b32 a47, v56
v_perm_b32 v63, v88, v19, s52
v_mfma_f32_16x16x32_bf16 v[188:191], a[228:231], a[12:15], v[188:191]
ds_read_b32 a48, v63
v_perm_b32 v62, v88, v19, s53
v_mfma_f32_16x16x32_bf16 v[188:191], a[224:227], a[220:223], v[188:191]
s_waitcnt lgkmcnt(3)
ds_read_b32 a49, v62
v_mfma_f32_16x16x32_bf16 v[160:163], a[232:235], a[0:3], v[160:163]
ds_read_b128 a[240:243], v14 offset:28672
v_perm_b32 v61, v92, v19, s52
v_mfma_f32_16x16x32_bf16 v[160:163], a[236:239], a[16:19], v[160:163]
ds_read_b32 a50, v61
v_mfma_f32_16x16x32_bf16 v[164:167], a[236:239], a[20:23], v[164:167]
ds_read_b128 a[244:247], v15 offset:28672
v_perm_b32 v60, v92, v19, s53
v_mfma_f32_16x16x32_bf16 v[164:167], a[232:235], a[4:7], v[164:167]
ds_read_b32 a51, v60
v_perm_b32 v59, v88, v19, s54
v_mfma_f32_16x16x32_bf16 v[168:171], a[232:235], a[8:11], v[168:171]
ds_read_b32 a52, v59
v_perm_b32 v58, v88, v19, s55
v_mfma_f32_16x16x32_bf16 v[168:171], a[236:239], a[24:27], v[168:171]
ds_read_b32 a53, v58
v_perm_b32 v57, v92, v19, s54
v_mfma_f32_16x16x32_bf16 v[172:175], a[236:239], a[28:31], v[172:175]
ds_read_b32 a54, v57
v_perm_b32 v56, v92, v19, s55
v_mfma_f32_16x16x32_bf16 v[172:175], a[232:235], a[12:15], v[172:175]
s_waitcnt lgkmcnt(4)
ds_read_b32 a55, v56
v_mfma_f32_16x16x32_bf16 v[192:195], a[240:243], a[192:195], v[192:195]
ds_read_b128 a[248:251], v15 offset:22528
v_perm_b32 v63, v89, v19, s52
v_mfma_f32_16x16x32_bf16 v[192:195], a[244:247], a[208:211], v[192:195]
ds_read_b32 a56, v63
v_mfma_f32_16x16x32_bf16 v[196:199], a[244:247], a[212:215], v[196:199]
ds_read_b128 a[252:255], v14 offset:34816
v_perm_b32 v62, v89, v19, s53
v_mfma_f32_16x16x32_bf16 v[196:199], a[240:243], a[196:199], v[196:199]
ds_read_b32 a57, v62
v_perm_b32 v61, v93, v19, s52
v_mfma_f32_16x16x32_bf16 v[200:203], a[240:243], a[200:203], v[200:203]
ds_read_b32 a58, v61
v_perm_b32 v60, v93, v19, s53
v_mfma_f32_16x16x32_bf16 v[200:203], a[244:247], a[216:219], v[200:203]
ds_read_b32 a59, v60
v_perm_b32 v59, v89, v19, s54
v_mfma_f32_16x16x32_bf16 v[204:207], a[244:247], a[220:223], v[204:207]
ds_read_b32 a60, v59
v_perm_b32 v58, v89, v19, s55
v_mfma_f32_16x16x32_bf16 v[204:207], a[240:243], a[204:207], v[204:207]
s_waitcnt lgkmcnt(4)
ds_read_b32 a61, v58
v_mfma_f32_16x16x32_bf16 v[144:147], a[248:251], a[16:19], v[144:147]
ds_read_b128 a[224:227], v14 offset:32768
v_perm_b32 v57, v93, v19, s54
v_mfma_f32_16x16x32_bf16 v[144:147], a[252:255], a[32:35], v[144:147]
ds_read_b32 a62, v57
v_mfma_f32_16x16x32_bf16 v[148:151], a[252:255], a[36:39], v[148:151]
ds_read_b128 a[228:231], v15 offset:32768
v_perm_b32 v56, v93, v19, s55
v_mfma_f32_16x16x32_bf16 v[148:151], a[248:251], a[20:23], v[148:151]
ds_read_b32 a63, v56
v_mfma_f32_16x16x32_bf16 v[152:155], a[248:251], a[24:27], v[152:155]
v_mfma_f32_16x16x32_bf16 v[152:155], a[252:255], a[40:43], v[152:155]
v_mfma_f32_16x16x32_bf16 v[156:159], a[252:255], a[44:47], v[156:159]
v_mfma_f32_16x16x32_bf16 v[156:159], a[248:251], a[28:31], v[156:159]
s_waitcnt lgkmcnt(1)
v_mfma_f32_16x16x32_bf16 v[128:131], a[224:227], a[32:35], v[128:131]
ds_read_b128 a[232:235], v15 offset:10240
v_mfma_f32_16x16x32_bf16 v[128:131], a[228:231], a[48:51], v[128:131]
v_mfma_f32_16x16x32_bf16 v[132:135], a[228:231], a[52:55], v[132:135]
ds_read_b128 a[236:239], v14 offset:30720
v_mfma_f32_16x16x32_bf16 v[132:135], a[224:227], a[36:39], v[132:135]
v_mfma_f32_16x16x32_bf16 v[136:139], a[224:227], a[40:43], v[136:139]
v_mfma_f32_16x16x32_bf16 v[136:139], a[228:231], a[56:59], v[136:139]
s_waitcnt lgkmcnt(1)
v_mfma_f32_16x16x32_bf16 v[140:143], a[228:231], a[60:63], v[140:143]
v_mfma_f32_16x16x32_bf16 v[140:143], a[224:227], a[44:47], v[140:143]
s_waitcnt lgkmcnt(0)
v_mfma_f32_16x16x32_bf16 v[208:211], a[232:235], a[176:179], v[208:211]
ds_read_b128 a[240:243], v15 offset:34816
v_mfma_f32_16x16x32_bf16 v[208:211], a[236:239], a[192:195], v[208:211]
v_mfma_f32_16x16x32_bf16 v[212:215], a[236:239], a[196:199], v[212:215]
v_mfma_f32_16x16x32_bf16 v[212:215], a[232:235], a[180:183], v[212:215]
v_mfma_f32_16x16x32_bf16 v[216:219], a[232:235], a[184:187], v[216:219]
s_waitcnt vmcnt(0)
s_barrier
ds_read_b128 a[244:247], v14 offset:40960
v_mfma_f32_16x16x32_bf16 v[216:219], a[236:239], a[200:203], v[216:219]
v_mfma_f32_16x16x32_bf16 v[220:223], a[236:239], a[204:207], v[220:223]
ds_read_b128 a[248:251], v15 offset:40960
v_mfma_f32_16x16x32_bf16 v[220:223], a[232:235], a[188:191], v[220:223]
s_waitcnt lgkmcnt(2)
v_mul_f32 v128, v128, v24
v_mul_f32 v132, v132, v25
v_mfma_f32_16x16x32_bf16 v[144:147], a[240:243], a[48:51], v[144:147]
L_PAD5:
s_cbranch_vccnz L_PADRET
v_mul_f32 v136, v136, v26
v_mul_f32 v140, v140, v27
v_mfma_f32_16x16x32_bf16 v[148:151], a[240:243], a[52:55], v[148:151]
v_cvt_pk_bf16_f32 v120, v128, v132
v_cvt_pk_bf16_f32 v121, v136, v140
v_mfma_f32_16x16x32_bf16 v[152:155], a[240:243], a[56:59], v[152:155]
buffer_store_dwordx2 v[120:121], v18, s[28:31], 0 offen nt
v_mul_f32 v129, v129, v24
v_mfma_f32_16x16x32_bf16 v[156:159], a[240:243], a[60:63], v[156:159]
s_waitcnt lgkmcnt(0)
v_mul_f32 v133, v133, v25
v_mul_f32 v137, v137, v26
v_mfma_f32_16x16x32_bf16 v[224:227], a[244:247], a[160:163], v[224:227]
s_add_u32 s28, s28, 7168
ds_read_b128 a[252:255], v17 offset:10240
v_mul_f32 v141, v141, v27
v_mfma_f32_16x16x32_bf16 v[224:227], a[248:251], a[176:179], v[224:227]
s_addc_u32 s29, s29, 0
v_cvt_pk_bf16_f32 v122, v129, v133
v_cvt_pk_bf16_f32 v123, v137, v141
v_mfma_f32_16x16x32_bf16 v[228:231], a[248:251], a[180:183], v[228:231]
ds_read_b128 a[224:227], v14 offset:2048
v_mfma_f32_16x16x32_bf16 v[228:231], a[244:247], a[164:167], v[228:231]
buffer_store_dwordx2 v[122:123], v18, s[28:31], 0 offen nt
v_mul_f32 v130, v130, v24
v_mfma_f32_16x16x32_bf16 v[232:235], a[244:247], a[168:171], v[232:235]
s_add_u32 s28, s28, 7168
v_mul_f32 v134, v134, v25
v_mul_f32 v138, v138, v26
v_mfma_f32_16x16x32_bf16 v[232:235], a[248:251], a[184:187], v[232:235]
s_addc_u32 s29, s29, 0
v_mul_f32 v142, v142, v27
v_cvt_pk_bf16_f32 v124, v130, v134
v_mfma_f32_16x16x32_bf16 v[236:239], a[248:251], a[188:191], v[236:239]
v_cvt_pk_bf16_f32 v125, v138, v142
v_mfma_f32_16x16x32_bf16 v[236:239], a[244:247], a[172:175], v[236:239]
s_waitcnt lgkmcnt(0)
v_mfma_f32_16x16x32_bf16 v[240:243], a[252:255], a[80:83], v[240:243]
ds_read_b128 a[228:231], v14 offset:45056
v_mfma_f32_16x16x32_bf16 v[240:243], a[224:227], a[96:99], v[240:243]
buffer_store_dwordx2 v[124:125], v18, s[28:31], 0 offen nt
v_mul_f32 v131, v131, v24
v_mfma_f32_16x16x32_bf16 v[244:247], a[224:227], a[100:103], v[244:247]
s_add_u32 s28, s28, 7168
ds_read_b128 a[232:235], v15 offset:45056
v_mul_f32 v135, v135, v25
v_mfma_f32_16x16x32_bf16 v[244:247], a[252:255], a[84:87], v[244:247]
s_addc_u32 s29, s29, 0
v_mul_f32 v139, v139, v26
v_mul_f32 v143, v143, v27
v_mfma_f32_16x16x32_bf16 v[248:251], a[252:255], a[88:91], v[248:251]
v_cvt_pk_bf16_f32 v126, v131, v135
v_cvt_pk_bf16_f32 v127, v139, v143
v_mfma_f32_16x16x32_bf16 v[248:251], a[224:227], a[104:107], v[248:251]
buffer_store_dwordx2 v[126:127], v18, s[28:31], 0 offen nt
v_mul_f32 v144, v144, v24
v_mfma_f32_16x16x32_bf16 v[252:255], a[224:227], a[108:111], v[252:255]
s_add_u32 s28, s28, 93184
v_mul_f32 v148, v148, v25
v_mul_f32 v152, v152, v26
v_mfma_f32_16x16x32_bf16 v[252:255], a[252:255], a[92:95], v[252:255]
s_waitcnt lgkmcnt(0)
v_mul_f32 v156, v156, v27
v_cvt_pk_bf16_f32 v120, v144, v148
v_mfma_f32_16x16x32_bf16 v[160:163], a[228:231], a[32:35], v[160:163]
s_addc_u32 s29, s29, 0
ds_read_b128 a[236:239], v15 offset:26624
v_cvt_pk_bf16_f32 v121, v152, v156
v_mfma_f32_16x16x32_bf16 v[160:163], a[232:235], a[48:51], v[160:163]
buffer_store_dwordx2 v[120:121], v18, s[28:31], 0 offen nt
v_mul_f32 v145, v145, v24
v_mfma_f32_16x16x32_bf16 v[164:167], a[232:235], a[52:55], v[164:167]
s_add_u32 s28, s28, 7168
ds_read_b128 a[240:243], v14 offset:47104
v_mul_f32 v149, v149, v25
v_mfma_f32_16x16x32_bf16 v[164:167], a[228:231], a[36:39], v[164:167]
s_addc_u32 s29, s29, 0
v_mul_f32 v153, v153, v26
v_mul_f32 v157, v157, v27
v_mfma_f32_16x16x32_bf16 v[168:171], a[228:231], a[40:43], v[168:171]
v_cvt_pk_bf16_f32 v122, v145, v149
v_cvt_pk_bf16_f32 v123, v153, v157
v_mfma_f32_16x16x32_bf16 v[168:171], a[232:235], a[56:59], v[168:171]
buffer_store_dwordx2 v[122:123], v18, s[28:31], 0 offen nt
v_mul_f32 v146, v146, v24
v_mfma_f32_16x16x32_bf16 v[172:175], a[232:235], a[60:63], v[172:175]
s_add_u32 s28, s28, 7168
v_mul_f32 v150, v150, v25
v_mul_f32 v154, v154, v26
v_mfma_f32_16x16x32_bf16 v[172:175], a[228:231], a[44:47], v[172:175]
s_waitcnt lgkmcnt(0)
v_mul_f32 v158, v158, v27
v_cvt_pk_bf16_f32 v124, v146, v150
v_mfma_f32_16x16x32_bf16 v[176:179], a[236:239], a[16:19], v[176:179]
s_addc_u32 s29, s29, 0
ds_read_b128 a[244:247], v14 offset:49152
v_cvt_pk_bf16_f32 v125, v154, v158
v_mfma_f32_16x16x32_bf16 v[176:179], a[240:243], a[32:35], v[176:179]
buffer_store_dwordx2 v[124:125], v18, s[28:31], 0 offen nt
v_mul_f32 v147, v147, v24
v_mfma_f32_16x16x32_bf16 v[180:183], a[240:243], a[36:39], v[180:183]
s_add_u32 s28, s28, 7168
ds_read_b128 a[248:251], v15 offset:49152
v_mul_f32 v151, v151, v25
v_mfma_f32_16x16x32_bf16 v[180:183], a[236:239], a[20:23], v[180:183]
s_addc_u32 s29, s29, 0
v_mul_f32 v155, v155, v26
v_mul_f32 v159, v159, v27
v_mfma_f32_16x16x32_bf16 v[184:187], a[236:239], a[24:27], v[184:187]
v_cvt_pk_bf16_f32 v126, v147, v151
v_cvt_pk_bf16_f32 v127, v155, v159
v_mfma_f32_16x16x32_bf16 v[184:187], a[240:243], a[40:43], v[184:187]
buffer_store_dwordx2 v[126:127], v18, s[28:31], 0 offen nt
v_mfma_f32_16x16x32_bf16 v[188:191], a[240:243], a[44:47], v[188:191]
v_mfma_f32_16x16x32_bf16 v[188:191], a[236:239], a[28:31], v[188:191]
s_waitcnt lgkmcnt(0)
v_mul_f32 v160, v160, v24
v_mul_f32 v164, v164, v25
v_mfma_f32_16x16x32_bf16 v[192:195], a[244:247], a[0:3], v[192:195]
s_add_u32 s28, s28, 93184
ds_read_b128 a[252:255], v15 offset:30720
v_mul_f32 v168, v168, v26
v_mfma_f32_16x16x32_bf16 v[192:195], a[248:251], a[16:19], v[192:195]
s_addc_u32 s29, s29, 0
v_mul_f32 v172, v172, v27
v_cvt_pk_bf16_f32 v120, v160, v164
v_mfma_f32_16x16x32_bf16 v[196:199], a[248:251], a[20:23], v[196:199]
ds_read_b128 a[224:227], v14 offset:51200
v_cvt_pk_bf16_f32 v121, v168, v172
v_mfma_f32_16x16x32_bf16 v[196:199], a[244:247], a[4:7], v[196:199]
buffer_store_dwordx2 v[120:121], v18, s[28:31], 0 offen nt
v_mul_f32 v161, v161, v24
v_mfma_f32_16x16x32_bf16 v[200:203], a[244:247], a[8:11], v[200:203]
s_add_u32 s28, s28, 7168
v_mul_f32 v165, v165, v25
v_mul_f32 v169, v169, v26
v_mfma_f32_16x16x32_bf16 v[200:203], a[248:251], a[24:27], v[200:203]
s_addc_u32 s29, s29, 0
v_mul_f32 v173, v173, v27
v_cvt_pk_bf16_f32 v122, v161, v165
v_mfma_f32_16x16x32_bf16 v[204:207], a[248:251], a[28:31], v[204:207]
v_cvt_pk_bf16_f32 v123, v169, v173
v_mfma_f32_16x16x32_bf16 v[204:207], a[244:247], a[12:15], v[204:207]
s_waitcnt lgkmcnt(0)
v_mfma_f32_16x16x32_bf16 v[208:211], a[252:255], a[208:211], v[208:211]
ds_read_b128 a[228:231], v15 offset:47104
v_mfma_f32_16x16x32_bf16 v[208:211], a[224:227], a[0:3], v[208:211]
buffer_store_dwordx2 v[122:123], v18, s[28:31], 0 offen nt
v_mul_f32 v162, v162, v24
v_mfma_f32_16x16x32_bf16 v[212:215], a[224:227], a[4:7], v[212:215]
s_add_u32 s28, s28, 7168
v_mul_f32 v166, v166, v25
v_mul_f32 v170, v170, v26
v_mfma_f32_16x16x32_bf16 v[212:215], a[252:255], a[212:215], v[212:215]
s_addc_u32 s29, s29, 0
v_mul_f32 v174, v174, v27
v_cvt_pk_bf16_f32 v124, v162, v166
v_mfma_f32_16x16x32_bf16 v[216:219], a[252:255], a[216:219], v[216:219]
ds_read_b128 a[232:235], v14 offset:36864
v_cvt_pk_bf16_f32 v125, v170, v174
v_mfma_f32_16x16x32_bf16 v[216:219], a[224:227], a[8:11], v[216:219]
buffer_store_dwordx2 v[124:125], v18, s[28:31], 0 offen nt
v_mul_f32 v163, v163, v24
v_mfma_f32_16x16x32_bf16 v[220:223], a[224:227], a[12:15], v[220:223]
s_add_u32 s28, s28, 7168
ds_read_b128 a[236:239], v15 offset:36864
v_mul_f32 v167, v167, v25
v_mfma_f32_16x16x32_bf16 v[220:223], a[252:255], a[220:223], v[220:223]
s_waitcnt lgkmcnt(2)
v_mul_f32 v171, v171, v26
v_mul_f32 v175, v175, v27
v_mfma_f32_16x16x32_bf16 v[176:179], a[228:231], a[48:51], v[176:179]
s_addc_u32 s29, s29, 0
v_cvt_pk_bf16_f32 v126, v163, v167
v_cvt_pk_bf16_f32 v127, v171, v175
v_mfma_f32_16x16x32_bf16 v[180:183], a[228:231], a[52:55], v[180:183]
buffer_store_dwordx2 v[126:127], v18, s[28:31], 0 offen nt
v_mfma_f32_16x16x32_bf16 v[184:187], a[228:231], a[56:59], v[184:187]
v_mfma_f32_16x16x32_bf16 v[188:191], a[228:231], a[60:63], v[188:191]
s_waitcnt lgkmcnt(0)
v_mfma_f32_16x16x32_bf16 v[224:227], a[232:235], a[192:195], v[224:227]
ds_read_b128 a[240:243], v14 offset:61440
v_mfma_f32_16x16x32_bf16 v[224:227], a[236:239], a[208:211], v[224:227]
v_mfma_f32_16x16x32_bf16 v[228:231], a[236:239], a[212:215], v[228:231]
ds_read_b128 a[244:247], v15 offset:61440
v_mfma_f32_16x16x32_bf16 v[228:231], a[232:235], a[196:199], v[228:231]
v_mfma_f32_16x16x32_bf16 v[232:235], a[232:235], a[200:203], v[232:235]
v_mfma_f32_16x16x32_bf16 v[232:235], a[236:239], a[216:219], v[232:235]
v_mfma_f32_16x16x32_bf16 v[236:239], a[236:239], a[220:223], v[236:239]
v_mfma_f32_16x16x32_bf16 v[236:239], a[232:235], a[204:207], v[236:239]
s_waitcnt lgkmcnt(0)
v_mul_f32 v176, v176, v24
v_mul_f32 v180, v180, v25
v_mfma_f32_16x16x32_bf16 v[192:195], a[240:243], a[32:35], v[192:195]
s_add_u32 s28, s28, 93184
ds_read_b128 a[248:251], v15 offset:51200
v_mul_f32 v184, v184, v26
v_mfma_f32_16x16x32_bf16 v[192:195], a[244:247], a[48:51], v[192:195]
s_addc_u32 s29, s29, 0
v_mul_f32 v188, v188, v27
v_cvt_pk_bf16_f32 v120, v176, v180
v_mfma_f32_16x16x32_bf16 v[196:199], a[244:247], a[52:55], v[196:199]
ds_read_b128 a[252:255], v14 offset:63488
v_cvt_pk_bf16_f32 v121, v184, v188
v_mfma_f32_16x16x32_bf16 v[196:199], a[240:243], a[36:39], v[196:199]
buffer_store_dwordx2 v[120:121], v18, s[28:31], 0 offen nt
v_mul_f32 v177, v177, v24
v_mfma_f32_16x16x32_bf16 v[200:203], a[240:243], a[40:43], v[200:203]
s_add_u32 s28, s28, 7168
v_mul_f32 v181, v181, v25
v_mul_f32 v185, v185, v26
v_mfma_f32_16x16x32_bf16 v[200:203], a[244:247], a[56:59], v[200:203]
s_addc_u32 s29, s29, 0
v_mul_f32 v189, v189, v27
v_cvt_pk_bf16_f32 v122, v177, v181
v_mfma_f32_16x16x32_bf16 v[204:207], a[244:247], a[60:63], v[204:207]
v_cvt_pk_bf16_f32 v123, v185, v189
v_mfma_f32_16x16x32_bf16 v[204:207], a[240:243], a[44:47], v[204:207]
s_waitcnt lgkmcnt(0)
v_mfma_f32_16x16x32_bf16 v[208:211], a[248:251], a[16:19], v[208:211]
ds_read_b128 a[224:227], v15 offset:2048
v_mfma_f32_16x16x32_bf16 v[208:211], a[252:255], a[32:35], v[208:211]
buffer_store_dwordx2 v[122:123], v18, s[28:31], 0 offen nt
v_mul_f32 v178, v178, v24
v_mfma_f32_16x16x32_bf16 v[212:215], a[252:255], a[36:39], v[212:215]
s_add_u32 s28, s28, 7168
ds_read_b128 a[228:231], v14 offset:14336
v_mul_f32 v182, v182, v25
v_mfma_f32_16x16x32_bf16 v[212:215], a[248:251], a[20:23], v[212:215]
s_addc_u32 s29, s29, 0
v_mul_f32 v186, v186, v26
v_mul_f32 v190, v190, v27
v_mfma_f32_16x16x32_bf16 v[216:219], a[248:251], a[24:27], v[216:219]
v_cvt_pk_bf16_f32 v124, v178, v182
v_cvt_pk_bf16_f32 v125, v186, v190
v_mfma_f32_16x16x32_bf16 v[216:219], a[252:255], a[40:43], v[216:219]
buffer_store_dwordx2 v[124:125], v18, s[28:31], 0 offen nt
v_mul_f32 v179, v179, v24
v_mfma_f32_16x16x32_bf16 v[220:223], a[252:255], a[44:47], v[220:223]
s_add_u32 s28, s28, 7168
v_mul_f32 v183, v183, v25
v_mul_f32 v187, v187, v26
v_mfma_f32_16x16x32_bf16 v[220:223], a[248:251], a[28:31], v[220:223]
s_waitcnt lgkmcnt(0)
v_mul_f32 v191, v191, v27
v_cvt_pk_bf16_f32 v126, v179, v183
v_mfma_f32_16x16x32_bf16 v[240:243], a[224:227], a[112:115], v[240:243]
s_addc_u32 s29, s29, 0
ds_read_b128 a[232:235], v15 offset:63488
v_cvt_pk_bf16_f32 v127, v187, v191
v_mfma_f32_16x16x32_bf16 v[240:243], a[228:231], a[128:131], v[240:243]
buffer_store_dwordx2 v[126:127], v18, s[28:31], 0 offen nt
v_mul_f32 v192, v192, v24
v_mfma_f32_16x16x32_bf16 v[244:247], a[228:231], a[132:135], v[244:247]
s_add_u32 s28, s28, 93184
v_mul_f32 v196, v196, v25
v_mul_f32 v200, v200, v26
v_mfma_f32_16x16x32_bf16 v[244:247], a[224:227], a[116:119], v[244:247]
s_addc_u32 s29, s29, 0
v_mul_f32 v204, v204, v27
v_cvt_pk_bf16_f32 v120, v192, v196
v_mfma_f32_16x16x32_bf16 v[248:251], a[224:227], a[120:123], v[248:251]
ds_read_b128 a[236:239], v14 offset:57344
v_cvt_pk_bf16_f32 v121, v200, v204
v_mfma_f32_16x16x32_bf16 v[248:251], a[228:231], a[136:139], v[248:251]
buffer_store_dwordx2 v[120:121], v18, s[28:31], 0 offen nt
v_mul_f32 v193, v193, v24
v_mfma_f32_16x16x32_bf16 v[252:255], a[228:231], a[140:143], v[252:255]
s_add_u32 s28, s28, 7168
ds_read_b128 a[240:243], v15 offset:57344
v_mul_f32 v197, v197, v25
v_mfma_f32_16x16x32_bf16 v[252:255], a[224:227], a[124:127], v[252:255]
s_waitcnt lgkmcnt(2)
v_mul_f32 v201, v201, v26
v_mul_f32 v205, v205, v27
v_mfma_f32_16x16x32_bf16 v[208:211], a[232:235], a[48:51], v[208:211]
s_addc_u32 s29, s29, 0
v_cvt_pk_bf16_f32 v122, v193, v197
v_cvt_pk_bf16_f32 v123, v201, v205
v_mfma_f32_16x16x32_bf16 v[212:215], a[232:235], a[52:55], v[212:215]
buffer_store_dwordx2 v[122:123], v18, s[28:31], 0 offen nt
v_mul_f32 v194, v194, v24
v_mfma_f32_16x16x32_bf16 v[216:219], a[232:235], a[56:59], v[216:219]
s_add_u32 s28, s28, 7168
v_mul_f32 v198, v198, v25
v_mul_f32 v202, v202, v26
v_mfma_f32_16x16x32_bf16 v[220:223], a[232:235], a[60:63], v[220:223]
s_waitcnt lgkmcnt(0)
v_mul_f32 v206, v206, v27
v_cvt_pk_bf16_f32 v124, v194, v198
v_mfma_f32_16x16x32_bf16 v[224:227], a[236:239], a[0:3], v[224:227]
s_addc_u32 s29, s29, 0
ds_read_b128 a[244:247], v16 offset:0
v_cvt_pk_bf16_f32 v125, v202, v206
v_mfma_f32_16x16x32_bf16 v[224:227], a[240:243], a[16:19], v[224:227]
buffer_store_dwordx2 v[124:125], v18, s[28:31], 0 offen nt
v_mul_f32 v195, v195, v24
v_mfma_f32_16x16x32_bf16 v[228:231], a[240:243], a[20:23], v[228:231]
s_add_u32 s28, s28, 7168
ds_read_b128 a[248:251], v17 offset:0
v_mul_f32 v199, v199, v25
v_mfma_f32_16x16x32_bf16 v[228:231], a[236:239], a[4:7], v[228:231]
s_addc_u32 s29, s29, 0
v_mul_f32 v203, v203, v26
v_mul_f32 v207, v207, v27
v_mfma_f32_16x16x32_bf16 v[232:235], a[236:239], a[8:11], v[232:235]
v_cvt_pk_bf16_f32 v126, v195, v199
v_cvt_pk_bf16_f32 v127, v203, v207
v_mfma_f32_16x16x32_bf16 v[232:235], a[240:243], a[24:27], v[232:235]
buffer_store_dwordx2 v[126:127], v18, s[28:31], 0 offen nt
v_mfma_f32_16x16x32_bf16 v[236:239], a[240:243], a[28:31], v[236:239]
v_mfma_f32_16x16x32_bf16 v[236:239], a[236:239], a[12:15], v[236:239]
s_waitcnt lgkmcnt(0)
v_mul_f32 v208, v208, v24
v_mul_f32 v212, v212, v25
v_mfma_f32_16x16x32_bf16 v[224:227], a[244:247], a[32:35], v[224:227]
s_add_u32 s28, s28, 93184
ds_read_b128 a[252:255], v15 offset:14336
v_mul_f32 v216, v216, v26
v_mfma_f32_16x16x32_bf16 v[224:227], a[248:251], a[48:51], v[224:227]
s_addc_u32 s29, s29, 0
v_mul_f32 v220, v220, v27
v_cvt_pk_bf16_f32 v120, v208, v212
v_mfma_f32_16x16x32_bf16 v[228:231], a[248:251], a[52:55], v[228:231]
ds_read_b128 a[224:227], v14 offset:43008
v_cvt_pk_bf16_f32 v121, v216, v220
v_mfma_f32_16x16x32_bf16 v[228:231], a[244:247], a[36:39], v[228:231]
buffer_store_dwordx2 v[120:121], v18, s[28:31], 0 offen nt
v_mul_f32 v209, v209, v24
v_mfma_f32_16x16x32_bf16 v[232:235], a[244:247], a[40:43], v[232:235]
s_add_u32 s28, s28, 7168
v_mul_f32 v213, v213, v25
v_mul_f32 v217, v217, v26
v_mfma_f32_16x16x32_bf16 v[232:235], a[248:251], a[56:59], v[232:235]
s_addc_u32 s29, s29, 0
v_mul_f32 v221, v221, v27
v_cvt_pk_bf16_f32 v122, v209, v213
v_mfma_f32_16x16x32_bf16 v[236:239], a[248:251], a[60:63], v[236:239]
v_cvt_pk_bf16_f32 v123, v217, v221
v_mfma_f32_16x16x32_bf16 v[236:239], a[244:247], a[44:47], v[236:239]
s_waitcnt lgkmcnt(0)
v_mfma_f32_16x16x32_bf16 v[240:243], a[252:255], a[144:147], v[240:243]
ds_read_b128 a[228:231], v15 offset:43008
v_mfma_f32_16x16x32_bf16 v[240:243], a[224:227], a[160:163], v[240:243]
buffer_store_dwordx2 v[122:123], v18, s[28:31], 0 offen nt
v_mul_f32 v210, v210, v24
v_mfma_f32_16x16x32_bf16 v[244:247], a[224:227], a[164:167], v[244:247]
s_add_u32 s28, s28, 7168
ds_read_b128 a[232:235], v14 offset:38912
v_mul_f32 v214, v214, v25
v_mfma_f32_16x16x32_bf16 v[244:247], a[252:255], a[148:151], v[244:247]
s_addc_u32 s29, s29, 0
v_mul_f32 v218, v218, v26
v_mul_f32 v222, v222, v27
v_mfma_f32_16x16x32_bf16 v[248:251], a[252:255], a[152:155], v[248:251]
v_cvt_pk_bf16_f32 v124, v210, v214
v_cvt_pk_bf16_f32 v125, v218, v222
v_mfma_f32_16x16x32_bf16 v[248:251], a[224:227], a[168:171], v[248:251]
buffer_store_dwordx2 v[124:125], v18, s[28:31], 0 offen nt
v_mul_f32 v211, v211, v24
v_mfma_f32_16x16x32_bf16 v[252:255], a[224:227], a[172:175], v[252:255]
s_add_u32 s28, s28, 7168
v_mul_f32 v215, v215, v25
v_mul_f32 v219, v219, v26
v_mfma_f32_16x16x32_bf16 v[252:255], a[252:255], a[156:159], v[252:255]
s_waitcnt lgkmcnt(0)
v_mul_f32 v223, v223, v27
v_cvt_pk_bf16_f32 v126, v211, v215
v_mfma_f32_16x16x32_bf16 v[240:243], a[228:231], a[176:179], v[240:243]
s_addc_u32 s29, s29, 0
ds_read_b128 a[236:239], v15 offset:38912
v_cvt_pk_bf16_f32 v127, v219, v223
v_mfma_f32_16x16x32_bf16 v[240:243], a[232:235], a[192:195], v[240:243]
buffer_store_dwordx2 v[126:127], v18, s[28:31], 0 offen nt
v_mul_f32 v224, v224, v24
v_mfma_f32_16x16x32_bf16 v[244:247], a[232:235], a[196:199], v[244:247]
s_add_u32 s28, s28, 93184
ds_read_b128 a[240:243], v14 offset:59392
v_mul_f32 v228, v228, v25
v_mfma_f32_16x16x32_bf16 v[244:247], a[228:231], a[180:183], v[244:247]
s_addc_u32 s29, s29, 0
v_mul_f32 v232, v232, v26
v_mul_f32 v236, v236, v27
v_mfma_f32_16x16x32_bf16 v[248:251], a[228:231], a[184:187], v[248:251]
v_cvt_pk_bf16_f32 v120, v224, v228
v_cvt_pk_bf16_f32 v121, v232, v236
v_mfma_f32_16x16x32_bf16 v[248:251], a[232:235], a[200:203], v[248:251]
buffer_store_dwordx2 v[120:121], v18, s[28:31], 0 offen nt
v_mul_f32 v225, v225, v24
v_mfma_f32_16x16x32_bf16 v[252:255], a[232:235], a[204:207], v[252:255]
s_add_u32 s28, s28, 7168
v_mul_f32 v229, v229, v25
v_mul_f32 v233, v233, v26
v_mfma_f32_16x16x32_bf16 v[252:255], a[228:231], a[188:191], v[252:255]
s_waitcnt lgkmcnt(0)
v_mul_f32 v237, v237, v27
v_cvt_pk_bf16_f32 v122, v225, v229
v_mfma_f32_16x16x32_bf16 v[240:243], a[236:239], a[208:211], v[240:243]
s_addc_u32 s29, s29, 0
ds_read_b128 a[244:247], v15 offset:59392
v_cvt_pk_bf16_f32 v123, v233, v237
v_mfma_f32_16x16x32_bf16 v[240:243], a[240:243], a[0:3], v[240:243]
buffer_store_dwordx2 v[122:123], v18, s[28:31], 0 offen nt
v_mul_f32 v226, v226, v24
v_mfma_f32_16x16x32_bf16 v[244:247], a[240:243], a[4:7], v[244:247]
s_add_u32 s28, s28, 7168
ds_read_b128 a[248:251], v16 offset:2048
v_mul_f32 v230, v230, v25
v_mfma_f32_16x16x32_bf16 v[244:247], a[236:239], a[212:215], v[244:247]
s_addc_u32 s29, s29, 0
v_mul_f32 v234, v234, v26
v_mul_f32 v238, v238, v27
v_mfma_f32_16x16x32_bf16 v[248:251], a[236:239], a[216:219], v[248:251]
v_cvt_pk_bf16_f32 v124, v226, v230
v_cvt_pk_bf16_f32 v125, v234, v238
v_mfma_f32_16x16x32_bf16 v[248:251], a[240:243], a[8:11], v[248:251]
buffer_store_dwordx2 v[124:125], v18, s[28:31], 0 offen nt
v_mul_f32 v227, v227, v24
v_mfma_f32_16x16x32_bf16 v[252:255], a[240:243], a[12:15], v[252:255]
s_add_u32 s28, s28, 7168
v_mul_f32 v231, v231, v25
v_mul_f32 v235, v235, v26
v_mfma_f32_16x16x32_bf16 v[252:255], a[236:239], a[220:223], v[252:255]
s_waitcnt lgkmcnt(0)
v_mul_f32 v239, v239, v27
v_cvt_pk_bf16_f32 v126, v227, v231
v_mfma_f32_16x16x32_bf16 v[240:243], a[244:247], a[16:19], v[240:243]
s_addc_u32 s29, s29, 0
ds_read_b128 a[252:255], v17 offset:2048
v_cvt_pk_bf16_f32 v127, v235, v239
v_mfma_f32_16x16x32_bf16 v[240:243], a[248:251], a[32:35], v[240:243]
buffer_store_dwordx2 v[126:127], v18, s[28:31], 0 offen nt
v_mfma_f32_16x16x32_bf16 v[244:247], a[248:251], a[36:39], v[244:247]
v_mfma_f32_16x16x32_bf16 v[244:247], a[244:247], a[20:23], v[244:247]
v_mfma_f32_16x16x32_bf16 v[248:251], a[244:247], a[24:27], v[248:251]
v_mfma_f32_16x16x32_bf16 v[248:251], a[248:251], a[40:43], v[248:251]
v_mfma_f32_16x16x32_bf16 v[252:255], a[248:251], a[44:47], v[252:255]
v_mfma_f32_16x16x32_bf16 v[252:255], a[244:247], a[28:31], v[252:255]
s_waitcnt lgkmcnt(0)
v_mfma_f32_16x16x32_bf16 v[240:243], a[252:255], a[48:51], v[240:243]
v_mfma_f32_16x16x32_bf16 v[244:247], a[252:255], a[52:55], v[244:247]
v_mfma_f32_16x16x32_bf16 v[248:251], a[252:255], a[56:59], v[248:251]
v_mfma_f32_16x16x32_bf16 v[252:255], a[252:255], a[60:63], v[252:255]
s_nop 7
v_pk_mul_f32 v[240:241], v[240:241], v[24:25] op_sel:[0,0] op_sel_hi:[1,0]
v_pk_mul_f32 v[244:245], v[244:245], v[24:25] op_sel:[0,1] op_sel_hi:[1,1]
v_pk_mul_f32 v[248:249], v[248:249], v[26:27] op_sel:[0,0] op_sel_hi:[1,0]
v_pk_mul_f32 v[252:253], v[252:253], v[26:27] op_sel:[0,1] op_sel_hi:[1,1]
v_cvt_pk_bf16_f32 v120, v240, v244
v_cvt_pk_bf16_f32 v121, v248, v252
s_add_u32 s28, s28, 93184
s_addc_u32 s29, s29, 0
buffer_store_dwordx2 v[120:121], v18, s[28:31], 0 offen nt
v_cvt_pk_bf16_f32 v122, v241, v245
v_cvt_pk_bf16_f32 v123, v249, v253
s_add_u32 s28, s28, 7168
s_addc_u32 s29, s29, 0
buffer_store_dwordx2 v[122:123], v18, s[28:31], 0 offen nt
v_pk_mul_f32 v[242:243], v[242:243], v[24:25] op_sel:[0,0] op_sel_hi:[1,0]
v_pk_mul_f32 v[246:247], v[246:247], v[24:25] op_sel:[0,1] op_sel_hi:[1,1]
v_pk_mul_f32 v[250:251], v[250:251], v[26:27] op_sel:[0,0] op_sel_hi:[1,0]
v_pk_mul_f32 v[254:255], v[254:255], v[26:27] op_sel:[0,1] op_sel_hi:[1,1]
v_cvt_pk_bf16_f32 v124, v242, v246
v_cvt_pk_bf16_f32 v125, v250, v254
s_add_u32 s28, s28, 7168
s_addc_u32 s29, s29, 0
buffer_store_dwordx2 v[124:125], v18, s[28:31], 0 offen nt
v_cvt_pk_bf16_f32 v126, v243, v247
v_cvt_pk_bf16_f32 v127, v251, v255
s_add_u32 s28, s28, 7168
s_addc_u32 s29, s29, 0
buffer_store_dwordx2 v[126:127], v18, s[28:31], 0 offen nt
s_endpgm
L_NOTAG:
buffer_load_dwordx2 v[22:23], off, s[80:83], 0 sc1
s_waitcnt vmcnt(0)
v_readfirstlane_b32 s88, v22
v_readfirstlane_b32 s89, v23
s_sub_u32 s90, s90, 1
s_nop 0
s_cmp_eq_u64 s[88:89], 0
s_cbranch_scc0 L_TAGOK
s_cmp_gt_i32 s90, 0
s_cbranch_scc1 L_NOTAG
s_mov_b32 s26, 0
s_mov_b32 s78, 0
s_mov_b64 s[88:89], 1
s_branch L_TAGOK
.p2align 6
L_PADS:
s_cbranch_vccnz L_PADRET
L_TRY:
s_waitcnt vmcnt(0)
v_cmp_ne_u64 s[50:51], s[88:89], v[122:123]
v_cmp_ne_u64 s[44:45], s[88:89], v[126:127]
s_sub_u32 s90, s90, 1
s_nop 0
s_or_b64 s[50:51], s[44:45], s[50:51]
s_cbranch_scc0 L_WRET
s_cmp_gt_i32 s90, 0
s_cbranch_scc0 L_SELF
L_WRET:
s_setpc_b64 s[100:101]
L_SLOW2:
s_lshr_b32 s91, s41, 6
s_add_u32 s91, s91, 0
s_lshl_b32 s47, s91, 11
buffer_load_dwordx4 v[120:123], v13, s[24:27], s47 offen offset:0 sc1
buffer_load_dwordx4 v[124:127], v13, s[24:27], s47 offen offset:1024 sc1
s_lshr_b32 s47, s41, 6
s_add_u32 s47, s47, 1
s_lshl_b32 s47, s47, 11
buffer_load_dwordx4 v[40:43], v13, s[24:27], s47 offen offset:0 sc1
buffer_load_dwordx4 v[44:47], v13, s[24:27], s47 offen offset:1024 sc1
s_lshr_b32 s47, s42, 6
s_add_u32 s47, s47, 0
s_lshl_b32 s47, s47, 11
buffer_load_dwordx4 v[48:51], v13, s[24:27], s47 offen offset:0 sc1
buffer_load_dwordx4 v[52:55], v13, s[24:27], s47 offen offset:1024 sc1
s_call_b64 s[100:101], L_TRY
s_cbranch_scc1 L_SLOW2
v_mov_b64 v[32:33], v[120:121]
v_mov_b64 v[36:37], v[124:125]
s_branch L_BACK2
L_SLOW3:
s_lshr_b32 s91, s41, 6
s_add_u32 s91, s91, 1
s_lshl_b32 s47, s91, 11
buffer_load_dwordx4 v[120:123], v13, s[24:27], s47 offen offset:0 sc1
buffer_load_dwordx4 v[124:127], v13, s[24:27], s47 offen offset:1024 sc1
s_lshr_b32 s47, s42, 6
s_add_u32 s47, s47, 0
s_lshl_b32 s47, s47, 11
buffer_load_dwordx4 v[48:51], v13, s[24:27], s47 offen offset:0 sc1
buffer_load_dwordx4 v[52:55], v13, s[24:27], s47 offen offset:1024 sc1
s_lshr_b32 s47, s42, 6
s_add_u32 s47, s47, 1
s_lshl_b32 s47, s47, 11
buffer_load_dwordx4 v[96:99], v13, s[24:27], s47 offen offset:0 sc1
buffer_load_dwordx4 v[100:103], v13, s[24:27], s47 offen offset:1024 sc1
s_call_b64 s[100:101], L_TRY
s_cbranch_scc1 L_SLOW3
v_mov_b64 v[40:41], v[120:121]
v_mov_b64 v[44:45], v[124:125]
s_branch L_BACK3
L_SLOW4:
s_lshr_b32 s91, s42, 6
s_add_u32 s91, s91, 0
s_lshl_b32 s47, s91, 11
buffer_load_dwordx4 v[120:123], v13, s[24:27], s47 offen offset:0 sc1
buffer_load_dwordx4 v[124:127], v13, s[24:27], s47 offen offset:1024 sc1
s_lshr_b32 s47, s42, 6
s_add_u32 s47, s47, 1
s_lshl_b32 s47, s47, 11
buffer_load_dwordx4 v[96:99], v13, s[24:27], s47 offen offset:0 sc1
buffer_load_dwordx4 v[100:103], v13, s[24:27], s47 offen offset:1024 sc1
s_lshr_b32 s47, s43, 6
s_add_u32 s47, s47, 0
s_lshl_b32 s47, s47, 11
buffer_load_dwordx4 v[80:83], v13, s[24:27], s47 offen offset:0 sc1
buffer_load_dwordx4 v[84:87], v13, s[24:27], s47 offen offset:1024 sc1
s_call_b64 s[100:101], L_TRY
s_cbranch_scc1 L_SLOW4
v_mov_b64 v[48:49], v[120:121]
v_mov_b64 v[52:53], v[124:125]
s_branch L_BACK4
L_SLOW5:
s_lshr_b32 s91, s42, 6
s_add_u32 s91, s91, 1
s_lshl_b32 s47, s91, 11
buffer_load_dwordx4 v[120:123], v13, s[24:27], s47 offen offset:0 sc1
buffer_load_dwordx4 v[124:127], v13, s[24:27], s47 offen offset:1024 sc1
s_lshr_b32 s47, s43, 6
s_add_u32 s47, s47, 0
s_lshl_b32 s47, s47, 11
buffer_load_dwordx4 v[80:83], v13, s[24:27], s47 offen offset:0 sc1
buffer_load_dwordx4 v[84:87], v13, s[24:27], s47 offen offset:1024 sc1
s_lshr_b32 s47, s43, 6
s_add_u32 s47, s47, 1
s_lshl_b32 s47, s47, 11
buffer_load_dwordx4 v[88:91], v13, s[24:27], s47 offen offset:0 sc1
buffer_load_dwordx4 v[92:95], v13, s[24:27], s47 offen offset:1024 sc1
s_call_b64 s[100:101], L_TRY
s_cbranch_scc1 L_SLOW5
v_mov_b64 v[96:97], v[120:121]
v_mov_b64 v[100:101], v[124:125]
s_branch L_BACK5
L_SLOW6:
s_lshr_b32 s91, s43, 6
s_add_u32 s91, s91, 0
s_lshl_b32 s47, s91, 11
buffer_load_dwordx4 v[120:123], v13, s[24:27], s47 offen offset:0 sc1
buffer_load_dwordx4 v[124:127], v13, s[24:27], s47 offen offset:1024 sc1
s_lshr_b32 s47, s43, 6
s_add_u32 s47, s47, 1
s_lshl_b32 s47, s47, 11
buffer_load_dwordx4 v[88:91], v13, s[24:27], s47 offen offset:0 sc1
buffer_load_dwordx4 v[92:95], v13, s[24:27], s47 offen offset:1024 sc1
s_movk_i32 s47, 8
s_lshl_b32 s47, s47, 11
buffer_load_dwordx4 v[32:35], v13, s[24:27], s47 offen offset:0 sc1
buffer_load_dwordx4 v[36:39], v13, s[24:27], s47 offen offset:1024 sc1
s_call_b64 s[100:101], L_TRY
s_cbranch_scc1 L_SLOW6
v_mov_b64 v[80:81], v[120:121]
v_mov_b64 v[84:85], v[124:125]
s_branch L_BACK6
L_SLOW7:
s_lshr_b32 s91, s43, 6
s_add_u32 s91, s91, 1
s_lshl_b32 s47, s91, 11
buffer_load_dwordx4 v[120:123], v13, s[24:27], s47 offen offset:0 sc1
buffer_load_dwordx4 v[124:127], v13, s[24:27], s47 offen offset:1024 sc1
s_movk_i32 s47, 8
s_lshl_b32 s47, s47, 11
buffer_load_dwordx4 v[32:35], v13, s[24:27], s47 offen offset:0 sc1
buffer_load_dwordx4 v[36:39], v13, s[24:27], s47 offen offset:1024 sc1
s_movk_i32 s47, 9
s_lshl_b32 s47, s47, 11
buffer_load_dwordx4 v[40:43], v13, s[24:27], s47 offen offset:0 sc1
buffer_load_dwordx4 v[44:47], v13, s[24:27], s47 offen offset:1024 sc1
s_call_b64 s[100:101], L_TRY
s_cbranch_scc1 L_SLOW7
v_mov_b64 v[88:89], v[120:121]
v_mov_b64 v[92:93], v[124:125]
s_branch L_BACK7
L_SLOW8:
s_movk_i32 s91, 8
s_lshl_b32 s47, s91, 11
buffer_load_dwordx4 v[120:123], v13, s[24:27], s47 offen offset:0 sc1
buffer_load_dwordx4 v[124:127], v13, s[24:27], s47 offen offset:1024 sc1
s_movk_i32 s47, 9
s_lshl_b32 s47, s47, 11
buffer_load_dwordx4 v[40:43], v13, s[24:27], s47 offen offset:0 sc1
buffer_load_dwordx4 v[44:47], v13, s[24:27], s47 offen offset:1024 sc1
s_movk_i32 s47, 10
s_lshl_b32 s47, s47, 11
buffer_load_dwordx4 v[48:51], v13, s[24:27], s47 offen offset:0 sc1
buffer_load_dwordx4 v[52:55], v13, s[24:27], s47 offen offset:1024 sc1
s_call_b64 s[100:101], L_TRY
s_cbranch_scc1 L_SLOW8
v_mov_b64 v[32:33], v[120:121]
v_mov_b64 v[36:37], v[124:125]
s_branch L_BACK8
L_SLOW9:
s_movk_i32 s91, 9
s_lshl_b32 s47, s91, 11
buffer_load_dwordx4 v[120:123], v13, s[24:27], s47 offen offset:0 sc1
buffer_load_dwordx4 v[124:127], v13, s[24:27], s47 offen offset:1024 sc1
s_movk_i32 s47, 10
s_lshl_b32 s47, s47, 11
buffer_load_dwordx4 v[48:51], v13, s[24:27], s47 offen offset:0 sc1
buffer_load_dwordx4 v[52:55], v13, s[24:27], s47 offen offset:1024 sc1
s_movk_i32 s47, 11
s_lshl_b32 s47, s47, 11
buffer_load_dwordx4 v[96:99], v13, s[24:27], s47 offen offset:0 sc1
buffer_load_dwordx4 v[100:103], v13, s[24:27], s47 offen offset:1024 sc1
s_call_b64 s[100:101], L_TRY
s_cbranch_scc1 L_SLOW9
v_mov_b64 v[40:41], v[120:121]
v_mov_b64 v[44:45], v[124:125]
s_branch L_BACK9
L_SLOW10:
s_movk_i32 s91, 10
s_lshl_b32 s47, s91, 11
buffer_load_dwordx4 v[120:123], v13, s[24:27], s47 offen offset:0 sc1
buffer_load_dwordx4 v[124:127], v13, s[24:27], s47 offen offset:1024 sc1
s_movk_i32 s47, 11
s_lshl_b32 s47, s47, 11
buffer_load_dwordx4 v[96:99], v13, s[24:27], s47 offen offset:0 sc1
buffer_load_dwordx4 v[100:103], v13, s[24:27], s47 offen offset:1024 sc1
s_movk_i32 s47, 12
s_lshl_b32 s47, s47, 11
buffer_load_dwordx4 v[80:83], v13, s[24:27], s47 offen offset:0 sc1
buffer_load_dwordx4 v[84:87], v13, s[24:27], s47 offen offset:1024 sc1
s_call_b64 s[100:101], L_TRY
s_cbranch_scc1 L_SLOW10
v_mov_b64 v[48:49], v[120:121]
v_mov_b64 v[52:53], v[124:125]
s_branch L_BACK10
L_SLOW11:
s_movk_i32 s91, 11
s_lshl_b32 s47, s91, 11
buffer_load_dwordx4 v[120:123], v13, s[24:27], s47 offen offset:0 sc1
buffer_load_dwordx4 v[124:127], v13, s[24:27], s47 offen offset:1024 sc1
s_movk_i32 s47, 12
s_lshl_b32 s47, s47, 11
buffer_load_dwordx4 v[80:83], v13, s[24:27], s47 offen offset:0 sc1
buffer_load_dwordx4 v[84:87], v13, s[24:27], s47 offen offset:1024 sc1
s_movk_i32 s47, 13
s_lshl_b32 s47, s47, 11
buffer_load_dwordx4 v[88:91], v13, s[24:27], s47 offen offset:0 sc1
buffer_load_dwordx4 v[92:95], v13, s[24:27], s47 offen offset:1024 sc1
s_call_b64 s[100:101], L_TRY
s_cbranch_scc1 L_SLOW11
v_mov_b64 v[96:97], v[120:121]
v_mov_b64 v[100:101], v[124:125]
s_branch L_BACK11
L_SLOW12:
s_movk_i32 s91, 12
s_lshl_b32 s47, s91, 11
buffer_load_dwordx4 v[120:123], v13, s[24:27], s47 offen offset:0 sc1
buffer_load_dwordx4 v[124:127], v13, s[24:27], s47 offen offset:1024 sc1
s_movk_i32 s47, 13
s_lshl_b32 s47, s47, 11
buffer_load_dwordx4 v[88:91], v13, s[24:27], s47 offen offset:0 sc1
buffer_load_dwordx4 v[92:95], v13, s[24:27], s47 offen offset:1024 sc1
s_movk_i32 s47, 14
s_lshl_b32 s47, s47, 11
buffer_load_dwordx4 v[32:35], v13, s[24:27], s47 offen offset:0 sc1
buffer_load_dwordx4 v[36:39], v13, s[24:27], s47 offen offset:1024 sc1
s_call_b64 s[100:101], L_TRY
s_cbranch_scc1 L_SLOW12
v_mov_b64 v[80:81], v[120:121]
v_mov_b64 v[84:85], v[124:125]
s_branch L_BACK12
L_SLOW13:
s_movk_i32 s91, 13
s_lshl_b32 s47, s91, 11
buffer_load_dwordx4 v[120:123], v13, s[24:27], s47 offen offset:0 sc1
buffer_load_dwordx4 v[124:127], v13, s[24:27], s47 offen offset:1024 sc1
s_movk_i32 s47, 14
s_lshl_b32 s47, s47, 11
buffer_load_dwordx4 v[32:35], v13, s[24:27], s47 offen offset:0 sc1
buffer_load_dwordx4 v[36:39], v13, s[24:27], s47 offen offset:1024 sc1
s_movk_i32 s47, 15
s_lshl_b32 s47, s47, 11
buffer_load_dwordx4 v[40:43], v13, s[24:27], s47 offen offset:0 sc1
buffer_load_dwordx4 v[44:47], v13, s[24:27], s47 offen offset:1024 sc1
s_call_b64 s[100:101], L_TRY
s_cbranch_scc1 L_SLOW13
v_mov_b64 v[88:89], v[120:121]
v_mov_b64 v[92:93], v[124:125]
s_branch L_BACK13
L_SLOW14:
s_movk_i32 s91, 14
s_lshl_b32 s47, s91, 11
buffer_load_dwordx4 v[120:123], v13, s[24:27], s47 offen offset:0 sc1
buffer_load_dwordx4 v[124:127], v13, s[24:27], s47 offen offset:1024 sc1
s_movk_i32 s47, 15
s_lshl_b32 s47, s47, 11
buffer_load_dwordx4 v[40:43], v13, s[24:27], s47 offen offset:0 sc1
buffer_load_dwordx4 v[44:47], v13, s[24:27], s47 offen offset:1024 sc1
s_movk_i32 s47, 16
s_lshl_b32 s47, s47, 11
buffer_load_dwordx4 v[48:51], v13, s[24:27], s47 offen offset:0 sc1
buffer_load_dwordx4 v[52:55], v13, s[24:27], s47 offen offset:1024 sc1
s_call_b64 s[100:101], L_TRY
s_cbranch_scc1 L_SLOW14
v_mov_b64 v[32:33], v[120:121]
v_mov_b64 v[36:37], v[124:125]
s_branch L_BACK14
L_SLOW15:
s_movk_i32 s91, 15
s_lshl_b32 s47, s91, 11
buffer_load_dwordx4 v[120:123], v13, s[24:27], s47 offen offset:0 sc1
buffer_load_dwordx4 v[124:127], v13, s[24:27], s47 offen offset:1024 sc1
s_movk_i32 s47, 16
s_lshl_b32 s47, s47, 11
buffer_load_dwordx4 v[48:51], v13, s[24:27], s47 offen offset:0 sc1
buffer_load_dwordx4 v[52:55], v13, s[24:27], s47 offen offset:1024 sc1
s_movk_i32 s47, 17
s_lshl_b32 s47, s47, 11
buffer_load_dwordx4 v[96:99], v13, s[24:27], s47 offen offset:0 sc1
buffer_load_dwordx4 v[100:103], v13, s[24:27], s47 offen offset:1024 sc1
s_call_b64 s[100:101], L_TRY
s_cbranch_scc1 L_SLOW15
v_mov_b64 v[40:41], v[120:121]
v_mov_b64 v[44:45], v[124:125]
s_branch L_BACK15
L_SLOW16:
s_movk_i32 s91, 16
s_lshl_b32 s47, s91, 11
buffer_load_dwordx4 v[120:123], v13, s[24:27], s47 offen offset:0 sc1
buffer_load_dwordx4 v[124:127], v13, s[24:27], s47 offen offset:1024 sc1
s_movk_i32 s47, 17
s_lshl_b32 s47, s47, 11
buffer_load_dwordx4 v[96:99], v13, s[24:27], s47 offen offset:0 sc1
buffer_load_dwordx4 v[100:103], v13, s[24:27], s47 offen offset:1024 sc1
s_movk_i32 s47, 18
s_lshl_b32 s47, s47, 11
buffer_load_dwordx4 v[80:83], v13, s[24:27], s47 offen offset:0 sc1
buffer_load_dwordx4 v[84:87], v13, s[24:27], s47 offen offset:1024 sc1
s_call_b64 s[100:101], L_TRY
s_cbranch_scc1 L_SLOW16
v_mov_b64 v[48:49], v[120:121]
v_mov_b64 v[52:53], v[124:125]
s_branch L_BACK16
L_SLOW17:
s_movk_i32 s91, 17
s_lshl_b32 s47, s91, 11
buffer_load_dwordx4 v[120:123], v13, s[24:27], s47 offen offset:0 sc1
buffer_load_dwordx4 v[124:127], v13, s[24:27], s47 offen offset:1024 sc1
s_movk_i32 s47, 18
s_lshl_b32 s47, s47, 11
buffer_load_dwordx4 v[80:83], v13, s[24:27], s47 offen offset:0 sc1
buffer_load_dwordx4 v[84:87], v13, s[24:27], s47 offen offset:1024 sc1
s_movk_i32 s47, 19
s_lshl_b32 s47, s47, 11
buffer_load_dwordx4 v[88:91], v13, s[24:27], s47 offen offset:0 sc1
buffer_load_dwordx4 v[92:95], v13, s[24:27], s47 offen offset:1024 sc1
s_call_b64 s[100:101], L_TRY
s_cbranch_scc1 L_SLOW17
v_mov_b64 v[96:97], v[120:121]
v_mov_b64 v[100:101], v[124:125]
s_branch L_BACK17
L_SLOW18:
s_movk_i32 s91, 18
s_lshl_b32 s47, s91, 11
buffer_load_dwordx4 v[120:123], v13, s[24:27], s47 offen offset:0 sc1
buffer_load_dwordx4 v[124:127], v13, s[24:27], s47 offen offset:1024 sc1
s_movk_i32 s47, 19
s_lshl_b32 s47, s47, 11
buffer_load_dwordx4 v[88:91], v13, s[24:27], s47 offen offset:0 sc1
buffer_load_dwordx4 v[92:95], v13, s[24:27], s47 offen offset:1024 sc1
s_movk_i32 s47, 20
s_lshl_b32 s47, s47, 11
buffer_load_dwordx4 v[32:35], v13, s[24:27], s47 offen offset:0 sc1
buffer_load_dwordx4 v[36:39], v13, s[24:27], s47 offen offset:1024 sc1
s_call_b64 s[100:101], L_TRY
s_cbranch_scc1 L_SLOW18
v_mov_b64 v[80:81], v[120:121]
v_mov_b64 v[84:85], v[124:125]
s_branch L_BACK18
L_SLOW19:
s_movk_i32 s91, 19
s_lshl_b32 s47, s91, 11
buffer_load_dwordx4 v[120:123], v13, s[24:27], s47 offen offset:0 sc1
buffer_load_dwordx4 v[124:127], v13, s[24:27], s47 offen offset:1024 sc1
s_movk_i32 s47, 20
s_lshl_b32 s47, s47, 11
buffer_load_dwordx4 v[32:35], v13, s[24:27], s47 offen offset:0 sc1
buffer_load_dwordx4 v[36:39], v13, s[24:27], s47 offen offset:1024 sc1
s_movk_i32 s47, 21
s_lshl_b32 s47, s47, 11
buffer_load_dwordx4 v[40:43], v13, s[24:27], s47 offen offset:0 sc1
buffer_load_dwordx4 v[44:47], v13, s[24:27], s47 offen offset:1024 sc1
s_call_b64 s[100:101], L_TRY
s_cbranch_scc1 L_SLOW19
v_mov_b64 v[88:89], v[120:121]
v_mov_b64 v[92:93], v[124:125]
s_branch L_BACK19
L_SLOW20:
s_movk_i32 s91, 20
s_lshl_b32 s47, s91, 11
buffer_load_dwordx4 v[120:123], v13, s[24:27], s47 offen offset:0 sc1
buffer_load_dwordx4 v[124:127], v13, s[24:27], s47 offen offset:1024 sc1
s_movk_i32 s47, 21
s_lshl_b32 s47, s47, 11
buffer_load_dwordx4 v[40:43], v13, s[24:27], s47 offen offset:0 sc1
buffer_load_dwordx4 v[44:47], v13, s[24:27], s47 offen offset:1024 sc1
s_movk_i32 s47, 22
s_lshl_b32 s47, s47, 11
buffer_load_dwordx4 v[48:51], v13, s[24:27], s47 offen offset:0 sc1
buffer_load_dwordx4 v[52:55], v13, s[24:27], s47 offen offset:1024 sc1
s_call_b64 s[100:101], L_TRY
s_cbranch_scc1 L_SLOW20
v_mov_b64 v[32:33], v[120:121]
v_mov_b64 v[36:37], v[124:125]
s_branch L_BACK20
L_SLOW21:
s_movk_i32 s91, 21
s_lshl_b32 s47, s91, 11
buffer_load_dwordx4 v[120:123], v13, s[24:27], s47 offen offset:0 sc1
buffer_load_dwordx4 v[124:127], v13, s[24:27], s47 offen offset:1024 sc1
s_movk_i32 s47, 22
s_lshl_b32 s47, s47, 11
buffer_load_dwordx4 v[48:51], v13, s[24:27], s47 offen offset:0 sc1
buffer_load_dwordx4 v[52:55], v13, s[24:27], s47 offen offset:1024 sc1
s_movk_i32 s47, 23
s_lshl_b32 s47, s47, 11
buffer_load_dwordx4 v[96:99], v13, s[24:27], s47 offen offset:0 sc1
buffer_load_dwordx4 v[100:103], v13, s[24:27], s47 offen offset:1024 sc1
s_call_b64 s[100:101], L_TRY
s_cbranch_scc1 L_SLOW21
v_mov_b64 v[40:41], v[120:121]
v_mov_b64 v[44:45], v[124:125]
s_branch L_BACK21
L_SLOW22:
s_movk_i32 s91, 22
s_lshl_b32 s47, s91, 11
buffer_load_dwordx4 v[120:123], v13, s[24:27], s47 offen offset:0 sc1
buffer_load_dwordx4 v[124:127], v13, s[24:27], s47 offen offset:1024 sc1
s_movk_i32 s47, 23
s_lshl_b32 s47, s47, 11
buffer_load_dwordx4 v[96:99], v13, s[24:27], s47 offen offset:0 sc1
buffer_load_dwordx4 v[100:103], v13, s[24:27], s47 offen offset:1024 sc1
s_movk_i32 s47, 24
s_lshl_b32 s47, s47, 11
buffer_load_dwordx4 v[80:83], v13, s[24:27], s47 offen offset:0 sc1
buffer_load_dwordx4 v[84:87], v13, s[24:27], s47 offen offset:1024 sc1
s_call_b64 s[100:101], L_TRY
s_cbranch_scc1 L_SLOW22
v_mov_b64 v[48:49], v[120:121]
v_mov_b64 v[52:53], v[124:125]
s_branch L_BACK22
L_SLOW23:
s_movk_i32 s91, 23
s_lshl_b32 s47, s91, 11
buffer_load_dwordx4 v[120:123], v13, s[24:27], s47 offen offset:0 sc1
buffer_load_dwordx4 v[124:127], v13, s[24:27], s47 offen offset:1024 sc1
s_movk_i32 s47, 24
s_lshl_b32 s47, s47, 11
buffer_load_dwordx4 v[80:83], v13, s[24:27], s47 offen offset:0 sc1
buffer_load_dwordx4 v[84:87], v13, s[24:27], s47 offen offset:1024 sc1
s_movk_i32 s47, 25
s_lshl_b32 s47, s47, 11
buffer_load_dwordx4 v[88:91], v13, s[24:27], s47 offen offset:0 sc1
buffer_load_dwordx4 v[92:95], v13, s[24:27], s47 offen offset:1024 sc1
s_call_b64 s[100:101], L_TRY
s_cbranch_scc1 L_SLOW23
v_mov_b64 v[96:97], v[120:121]
v_mov_b64 v[100:101], v[124:125]
s_branch L_BACK23
L_SLOW24:
s_movk_i32 s91, 24
s_lshl_b32 s47, s91, 11
buffer_load_dwordx4 v[120:123], v13, s[24:27], s47 offen offset:0 sc1
buffer_load_dwordx4 v[124:127], v13, s[24:27], s47 offen offset:1024 sc1
s_movk_i32 s47, 25
s_lshl_b32 s47, s47, 11
buffer_load_dwordx4 v[88:91], v13, s[24:27], s47 offen offset:0 sc1
buffer_load_dwordx4 v[92:95], v13, s[24:27], s47 offen offset:1024 sc1
s_movk_i32 s47, 26
s_lshl_b32 s47, s47, 11
buffer_load_dwordx4 v[32:35], v13, s[24:27], s47 offen offset:0 sc1
buffer_load_dwordx4 v[36:39], v13, s[24:27], s47 offen offset:1024 sc1
s_call_b64 s[100:101], L_TRY
s_cbranch_scc1 L_SLOW24
v_mov_b64 v[80:81], v[120:121]
v_mov_b64 v[84:85], v[124:125]
s_branch L_BACK24
L_SLOW25:
s_movk_i32 s91, 25
s_lshl_b32 s47, s91, 11
buffer_load_dwordx4 v[120:123], v13, s[24:27], s47 offen offset:0 sc1
buffer_load_dwordx4 v[124:127], v13, s[24:27], s47 offen offset:1024 sc1
s_movk_i32 s47, 26
s_lshl_b32 s47, s47, 11
buffer_load_dwordx4 v[32:35], v13, s[24:27], s47 offen offset:0 sc1
buffer_load_dwordx4 v[36:39], v13, s[24:27], s47 offen offset:1024 sc1
s_movk_i32 s47, 27
s_lshl_b32 s47, s47, 11
buffer_load_dwordx4 v[40:43], v13, s[24:27], s47 offen offset:0 sc1
buffer_load_dwordx4 v[44:47], v13, s[24:27], s47 offen offset:1024 sc1
s_call_b64 s[100:101], L_TRY
s_cbranch_scc1 L_SLOW25
v_mov_b64 v[88:89], v[120:121]
v_mov_b64 v[92:93], v[124:125]
s_branch L_BACK25
L_SLOW26:
s_movk_i32 s91, 26
s_lshl_b32 s47, s91, 11
buffer_load_dwordx4 v[120:123], v13, s[24:27], s47 offen offset:0 sc1
buffer_load_dwordx4 v[124:127], v13, s[24:27], s47 offen offset:1024 sc1
s_movk_i32 s47, 27
s_lshl_b32 s47, s47, 11
buffer_load_dwordx4 v[40:43], v13, s[24:27], s47 offen offset:0 sc1
buffer_load_dwordx4 v[44:47], v13, s[24:27], s47 offen offset:1024 sc1
s_movk_i32 s47, 28
s_lshl_b32 s47, s47, 11
buffer_load_dwordx4 v[48:51], v13, s[24:27], s47 offen offset:0 sc1
buffer_load_dwordx4 v[52:55], v13, s[24:27], s47 offen offset:1024 sc1
s_call_b64 s[100:101], L_TRY
s_cbranch_scc1 L_SLOW26
v_mov_b64 v[32:33], v[120:121]
v_mov_b64 v[36:37], v[124:125]
s_branch L_BACK26
L_SLOW27:
s_movk_i32 s91, 27
s_lshl_b32 s47, s91, 11
buffer_load_dwordx4 v[120:123], v13, s[24:27], s47 offen offset:0 sc1
buffer_load_dwordx4 v[124:127], v13, s[24:27], s47 offen offset:1024 sc1
s_movk_i32 s47, 28
s_lshl_b32 s47, s47, 11
buffer_load_dwordx4 v[48:51], v13, s[24:27], s47 offen offset:0 sc1
buffer_load_dwordx4 v[52:55], v13, s[24:27], s47 offen offset:1024 sc1
s_movk_i32 s47, 29
s_lshl_b32 s47, s47, 11
buffer_load_dwordx4 v[96:99], v13, s[24:27], s47 offen offset:0 sc1
buffer_load_dwordx4 v[100:103], v13, s[24:27], s47 offen offset:1024 sc1
s_call_b64 s[100:101], L_TRY
s_cbranch_scc1 L_SLOW27
v_mov_b64 v[40:41], v[120:121]
v_mov_b64 v[44:45], v[124:125]
s_branch L_BACK27
L_SLOW28:
s_movk_i32 s91, 28
s_lshl_b32 s47, s91, 11
buffer_load_dwordx4 v[120:123], v13, s[24:27], s47 offen offset:0 sc1
buffer_load_dwordx4 v[124:127], v13, s[24:27], s47 offen offset:1024 sc1
s_movk_i32 s47, 29
s_lshl_b32 s47, s47, 11
buffer_load_dwordx4 v[96:99], v13, s[24:27], s47 offen offset:0 sc1
buffer_load_dwordx4 v[100:103], v13, s[24:27], s47 offen offset:1024 sc1
s_movk_i32 s47, 30
s_lshl_b32 s47, s47, 11
buffer_load_dwordx4 v[80:83], v13, s[24:27], s47 offen offset:0 sc1
buffer_load_dwordx4 v[84:87], v13, s[24:27], s47 offen offset:1024 sc1
s_call_b64 s[100:101], L_TRY
s_cbranch_scc1 L_SLOW28
v_mov_b64 v[48:49], v[120:121]
v_mov_b64 v[52:53], v[124:125]
s_branch L_BACK28
L_SLOW29:
s_movk_i32 s91, 29
s_lshl_b32 s47, s91, 11
buffer_load_dwordx4 v[120:123], v13, s[24:27], s47 offen offset:0 sc1
buffer_load_dwordx4 v[124:127], v13, s[24:27], s47 offen offset:1024 sc1
s_movk_i32 s47, 30
s_lshl_b32 s47, s47, 11
buffer_load_dwordx4 v[80:83], v13, s[24:27], s47 offen offset:0 sc1
buffer_load_dwordx4 v[84:87], v13, s[24:27], s47 offen offset:1024 sc1
s_movk_i32 s47, 31
s_lshl_b32 s47, s47, 11
buffer_load_dwordx4 v[88:91], v13, s[24:27], s47 offen offset:0 sc1
buffer_load_dwordx4 v[92:95], v13, s[24:27], s47 offen offset:1024 sc1
s_call_b64 s[100:101], L_TRY
s_cbranch_scc1 L_SLOW29
v_mov_b64 v[96:97], v[120:121]
v_mov_b64 v[100:101], v[124:125]
s_branch L_BACK29
L_SLOW30:
s_movk_i32 s91, 30
s_lshl_b32 s47, s91, 11
buffer_load_dwordx4 v[120:123], v13, s[24:27], s47 offen offset:0 sc1
buffer_load_dwordx4 v[124:127], v13, s[24:27], s47 offen offset:1024 sc1
s_movk_i32 s47, 31
s_lshl_b32 s47, s47, 11
buffer_load_dwordx4 v[88:91], v13, s[24:27], s47 offen offset:0 sc1
buffer_load_dwordx4 v[92:95], v13, s[24:27], s47 offen offset:1024 sc1
s_call_b64 s[100:101], L_TRY
s_cbranch_scc1 L_SLOW30
v_mov_b64 v[80:81], v[120:121]
v_mov_b64 v[84:85], v[124:125]
s_branch L_BACK30
L_SLOW31:
s_movk_i32 s91, 31
s_lshl_b32 s47, s91, 11
buffer_load_dwordx4 v[120:123], v13, s[24:27], s47 offen offset:0 sc1
buffer_load_dwordx4 v[124:127], v13, s[24:27], s47 offen offset:1024 sc1
s_call_b64 s[100:101], L_TRY
s_cbranch_scc1 L_SLOW31
v_mov_b64 v[88:89], v[120:121]
v_mov_b64 v[92:93], v[124:125]
s_branch L_BACK31
L_SELF:
s_mul_i32 s47, s91, 458752
s_lshl_b32 s46, s39, 8
s_add_u32 s47, s47, s46
s_add_u32 s84, s6, s47
s_addc_u32 s85, s7, 0
s_mov_b32 s86, 387328
s_mov_b32 s87, 0x20000
buffer_load_dwordx4 v[64:67], v30, s[84:87], 0 offen
buffer_load_dwordx4 v[68:71], v30, s[84:87], s92 offen
buffer_load_dwordx4 v[72:75], v30, s[84:87], s93 offen
buffer_load_dwordx4 v[76:79], v30, s[84:87], s94 offen
s_waitcnt vmcnt(0)
v_lshl_add_u64 v[64:65], v[68:69], 4, v[64:65]
v_lshl_add_u64 v[66:67], v[70:71], 4, v[66:67]
v_lshl_add_u64 v[72:73], v[76:77], 4, v[72:73]
v_lshl_add_u64 v[74:75], v[78:79], 4, v[74:75]
v_lshl_or_b32 v76, v72, 8, v64
v_lshl_or_b32 v77, v73, 8, v65
v_lshl_or_b32 v78, v74, 8, v66
v_lshl_or_b32 v79, v75, 8, v67
v_lshl_or_b32 v120, v77, 16, v76
v_lshl_or_b32 v121, v79, 16, v78
s_add_u32 s84, s84, 57344
s_addc_u32 s85, s85, 0
buffer_load_dwordx4 v[64:67], v30, s[84:87], 0 offen
buffer_load_dwordx4 v[68:71], v30, s[84:87], s92 offen
buffer_load_dwordx4 v[72:75], v30, s[84:87], s93 offen
buffer_load_dwordx4 v[76:79], v30, s[84:87], s94 offen
s_waitcnt vmcnt(0)
v_lshl_add_u64 v[64:65], v[68:69], 4, v[64:65]
v_lshl_add_u64 v[66:67], v[70:71], 4, v[66:67]
v_lshl_add_u64 v[72:73], v[76:77], 4, v[72:73]
v_lshl_add_u64 v[74:75], v[78:79], 4, v[74:75]
v_lshl_or_b32 v76, v72, 8, v64
v_lshl_or_b32 v77, v73, 8, v65
v_lshl_or_b32 v78, v74, 8, v66
v_lshl_or_b32 v79, v75, 8, v67
v_lshl_or_b32 v124, v77, 16, v76
v_lshl_or_b32 v125, v79, 16, v78
s_cmp_eq_u32 s39, -1
s_setpc_b64 s[100:101]
L_END:
s_endpgm
.section .rodata,"a"
.p2align 6
.amdhsa_kernel standalone__normalfloat_lut_af4__prompt_kernel
  .amdhsa_next_free_vgpr 512
  .amdhsa_next_free_sgpr 102
  .amdhsa_accum_offset 256
  .amdhsa_group_segment_fixed_size 0
  .amdhsa_kernarg_size 56
  .amdhsa_user_sgpr_count 2
  .amdhsa_user_sgpr_kernarg_segment_ptr 1
  .amdhsa_system_sgpr_workgroup_id_x 1
.end_amdhsa_kernel
```

```asm
; @launch grid=(256,1,1) block=(256,1,1) lds=163840
.amdgcn_target "amdgcn-amd-amdhsa--gfx950"
.text
.globl standalone__normalfloat_lut_af4__prompt_kernel
.p2align 12
.p2align 8
.type standalone__normalfloat_lut_af4__prompt_kernel,@function
standalone__normalfloat_lut_af4__prompt_kernel:
s_load_dwordx4 s[4:7], s[0:1], 0
s_load_dwordx4 s[12:15], s[0:1], 40
s_load_dwordx4 s[8:11], s[0:1], 24
s_load_dwordx2 s[50:51], s[0:1], 16
s_memrealtime s[56:57]
s_cmp_ge_u32 s2, 256
s_cbranch_scc1 L_END
s_getpc_b64 s[48:49]
L_PC0:
v_bfi_b32 v2, 7, v0, s2
v_lshlrev_b32 v2, 7, v2
v_min_u32 v2, L_END-L_PC0, v2
global_load_dword v7, v2, s[48:49]
v_lshrrev_b32 v1, 6, v0
s_cmp_lt_u32 s2, 32
v_readfirstlane_b32 s36, v1
s_cbranch_scc1 L_PACK
s_bfe_u32 s34, s2, 0x20001
s_bfe_u32 s37, s2, 0x20003
s_lshl2_add_u32 s37, s34, s37
s_and_b32 s43, s2, 1
s_mul_i32 s43, s43, 7
s_lshr_b32 s38, s2, 5
s_add_u32 s38, s38, s43
s_lshl2_add_u32 s39, s38, s36
s_sub_u32 s39, s39, 4
v_bfe_u32 v6, v0, 4, 2
v_and_b32 v3, 15, v0
v_mul_u32_u24 v2, 114688, v6
v_lshl_add_u32 v30, v3, 4, v2
s_lshr_b32 s46, s37, 1
s_and_b32 s45, s37, 1
s_lshl3_add_u32 s46, s46, s45
s_mul_i32 s46, s46, 57344
s_lshl_b32 s47, s39, 8
s_add_u32 s44, s46, s47
s_mov_b32 s18, 387328
s_mov_b32 s19, 0x20000
s_mov_b32 s92, 14336
s_mov_b32 s93, 28672
s_mov_b32 s94, 43008
s_waitcnt lgkmcnt(0)
s_load_dwordx8 s[64:71], s[50:51], 0
s_add_u32 s16, s6, s44
s_addc_u32 s17, s7, 0
buffer_load_dwordx4 v[104:107], v30, s[16:19], 0 offen
buffer_load_dwordx4 v[108:111], v30, s[16:19], s92 offen
buffer_load_dwordx4 v[112:115], v30, s[16:19], s93 offen
buffer_load_dwordx4 v[116:119], v30, s[16:19], s94 offen
s_branch L_MAIN
L_PACK:
v_lshrrev_b32 v2, 2, v0
v_and_b32 v3, 3, v0
s_lshl_b32 s45, s2, 17
v_lshl_add_u32 v2, v2, 11, s45
v_lshl_add_u32 v17, v3, 7, v2
s_mov_b32 s30, 4194304
s_mov_b32 s31, 0x20000
v_lshlrev_b32 v16, 3, v0
s_cmp_lt_u32 s2, 2
s_cselect_b32 s34, 8, 0
s_mov_b32 s35, 0x20000
v_mov_b64 v[22:23], 0
s_waitcnt lgkmcnt(0)
s_mov_b64 s[32:33], s[12:13]
v_mov_b64 v[20:21], s[56:57]
buffer_atomic_cmpswap_x2 v[20:23], v16, s[32:35], 0 offen sc1
s_mov_b64 s[28:29], s[4:5]
buffer_load_dword v19, v17, s[28:31], 0 offen offset:0
s_branch L_PACK1
L_MAIN:
s_mov_b64 s[20:21], s[4:5]
s_mov_b32 s22, 4194304
s_mov_b32 s23, 0x20000
s_lshl_b32 s46, s37, 18
v_lshrrev_b32 v5, 3, v0
v_lshl_add_u32 v2, v5, 11, s46
v_lshrrev_b32 v4, 4, v0
v_xor_b32 v4, v4, v0
v_and_b32 v4, 7, v4
v_lshl_add_u32 v8, v4, 4, v2
v_add_u32 v9, 65536, v8
v_add_u32 v10, 131072, v8
v_add_u32 v11, 196608, v8
s_lshl_b32 s33, s36, 10
s_mul_i32 s47, s45, 114688
s_sub_u32 s47, s44, s47
s_add_u32 s47, s47, 57344
s_add_u32 s84, s6, s47
s_addc_u32 s85, s7, 0
s_mov_b32 s86, 387328
s_mov_b32 s87, 0x20000
s_lshl_b32 s40, s34, 7
s_add_u32 m0, s33, 65536
s_nop 0
buffer_load_dwordx4 v8, s[20:23], s40 offen lds
s_add_u32 m0, s33, 69632
s_nop 0
buffer_load_dwordx4 v9, s[20:23], s40 offen lds
s_add_u32 m0, s33, 73728
s_nop 0
buffer_load_dwordx4 v10, s[20:23], s40 offen lds
s_add_u32 m0, s33, 77824
s_nop 0
buffer_load_dwordx4 v11, s[20:23], s40 offen lds
s_and_b32 s45, s36, 1
s_mul_i32 s45, s45, 0x0202
s_lshr_b32 s46, s36, 1
s_mul_i32 s46, s46, 0x02020000
s_add_u32 s45, s45, s46
s_add_u32 s45, s45, 0x05040100
v_mov_b32 v57, s45
v_lshlrev_b32 v5, 8, v5
v_and_b32 v58, 7, v0
v_lshl_add_u32 v58, v58, 4, v5
v_and_b32 v5, 31, v0
v_lshlrev_b32 v19, 2, v5
v_and_b32 v0, 63, v0
s_lshl_b32 s46, s39, 7
v_lshl_add_u32 v28, v3, 3, s46
s_mul_i32 s47, s37, 917504
s_add_u32 s47, s47, s46
s_add_u32 s28, s10, s47
s_addc_u32 s29, s11, 0
s_mov_b32 s30, 86144
s_mov_b32 s31, 0x20000
v_mul_u32_u24 v29, 28672, v6
v_lshl_add_u32 v18, v3, 3, v29
v_lshlrev_b32 v29, 7, v3
v_bfe_u32 v5, v0, 1, 3
v_xor_b32 v5, v5, v6
v_lshl_add_u32 v29, v5, 4, v29
v_add_u32 v14, 65536, v29
v_xor_b32 v15, 64, v14
v_add_u32 v16, 0x10000, v14
v_add_u32 v17, 0x10000, v15
s_mov_b32 s52, 0x0c0c0400
s_mov_b32 s53, 0x0c0c0500
s_mov_b32 s54, 0x0c0c0600
s_mov_b32 s55, 0x0c0c0700
v_lshlrev_b32 v13, 4, v0
s_lshl_b32 s47, s39, 16
s_add_u32 s24, s14, s47
s_addc_u32 s25, s15, 0
s_lshl_b32 s47, s37, 10
s_add_u32 s76, s24, s47
s_addc_u32 s77, s25, 0
s_movk_i32 s78, 1024
s_mov_b32 s79, 0x20000
s_lshl_b32 s47, s34, 3
s_lshr_b32 s47, 0x90d0b2d, s47
s_bfe_u32 s41, s47, 0x20000
s_lshl_b32 s41, s41, 7
s_bfe_u32 s42, s47, 0x20002
s_lshl_b32 s42, s42, 7
s_bfe_u32 s43, s47, 0x20004
s_lshl_b32 s43, s43, 7
s_lshl_b32 s47, s34, 1
s_lshr_b32 s47, 0x63, s47
s_and_b32 s47, s47, 3
s_sub_u32 s47, s47, s34
s_lshl1_add_u32 s3, s47, 12
s_mul_i32 s47, s3, 458752
s_add_u32 s16, s16, s47
s_addc_u32 s17, s17, 0
s_lshl_b32 s3, s3, 11
s_lshr_b32 s35, s37, 1
s_xor_b32 s35, s35, 1
v_lshl_add_u32 v12, s41, 5, v13
s_mul_i32 s47, s35, 458752
s_lshl_b32 s46, s39, 8
s_add_u32 s47, s47, s46
s_add_u32 s72, s6, s47
s_addc_u32 s73, s7, 0
s_mov_b32 s74, 444672
s_mov_b32 s75, 0x20000
v_add_u32 v31, 57344, v30
s_and_b32 s47, s37, 2
s_lshl_b32 s47, s47, 5
v_xor_b32 v2, s47, v14
v_xor_b32 v4, 64, v2
s_mov_b32 s26, 65536
s_mov_b32 s27, 0x20000
s_mov_b64 s[80:81], s[12:13]
s_movk_i32 s82, 128
s_mov_b32 s83, 0x20000
s_movk_i32 s90, 4096
s_waitcnt lgkmcnt(0)
s_pack_ll_b32_b16 s45, s64, s68
v_mov_b32 v56, s45
s_lshl_b64 exec, exec, 8
s_pack_hh_b32_b16 s45, s64, s68
v_mov_b32 v56, s45
s_lshl_b64 exec, exec, 8
s_pack_ll_b32_b16 s45, s65, s69
v_mov_b32 v56, s45
s_lshl_b64 exec, exec, 8
s_pack_hh_b32_b16 s45, s65, s69
v_mov_b32 v56, s45
s_lshl_b64 exec, exec, 8
s_pack_ll_b32_b16 s45, s66, s70
v_mov_b32 v56, s45
s_lshl_b64 exec, exec, 8
s_pack_hh_b32_b16 s45, s66, s70
v_mov_b32 v56, s45
s_lshl_b64 exec, exec, 8
s_pack_ll_b32_b16 s45, s67, s71
v_mov_b32 v56, s45
s_lshl_b64 exec, exec, 8
s_pack_hh_b32_b16 s45, s67, s71
v_mov_b32 v56, s45
s_mov_b64 exec, -1
v_perm_b32 v128, s64, v56, v57
v_mov_b32 v129, v128
v_mov_b64 v[130:131], v[128:129]
s_load_dwordx2 s[88:89], s[12:13], 0
ds_write_b128 v58, v[128:131] offset:0
v_perm_b32 v132, s65, v56, v57
v_mov_b32 v133, v132
v_mov_b64 v[134:135], v[132:133]
ds_write_b128 v58, v[132:135] offset:8192
v_perm_b32 v136, s66, v56, v57
v_mov_b32 v137, v136
v_mov_b64 v[138:139], v[136:137]
ds_write_b128 v58, v[136:139] offset:16384
v_perm_b32 v140, s67, v56, v57
v_mov_b32 v141, v140
v_mov_b64 v[142:143], v[140:141]
ds_write_b128 v58, v[140:143] offset:24576
v_perm_b32 v144, s68, v56, v57
v_mov_b32 v145, v144
v_mov_b64 v[146:147], v[144:145]
ds_write_b128 v58, v[144:147] offset:32768
v_perm_b32 v148, s69, v56, v57
v_mov_b32 v149, v148
v_mov_b64 v[150:151], v[148:149]
ds_write_b128 v58, v[148:151] offset:40960
v_perm_b32 v152, s70, v56, v57
v_mov_b32 v153, v152
v_mov_b64 v[154:155], v[152:153]
ds_write_b128 v58, v[152:155] offset:49152
v_perm_b32 v156, s71, v56, v57
v_mov_b32 v157, v156
v_mov_b64 v[158:159], v[156:157]
ds_write_b128 v58, v[156:159] offset:57344
buffer_load_dwordx4 v[64:67], v30, s[84:87], 0 offen
buffer_load_dwordx4 v[68:71], v30, s[84:87], s92 offen
buffer_load_dwordx4 v[72:75], v30, s[84:87], s93 offen
buffer_load_dwordx4 v[76:79], v30, s[84:87], s94 offen
s_mov_b64 vcc, -1
s_branch L_PAD0
L_PADRET0:
s_mov_b64 vcc, 0
s_waitcnt vmcnt(8)
v_lshl_add_u64 v[104:105], v[108:109], 4, v[104:105]
v_lshl_add_u64 v[106:107], v[110:111], 4, v[106:107]
v_lshl_add_u64 v[112:113], v[116:117], 4, v[112:113]
v_lshl_add_u64 v[114:115], v[118:119], 4, v[114:115]
v_lshl_or_b32 v116, v112, 8, v104
v_lshl_or_b32 v117, v113, 8, v105
v_lshl_or_b32 v118, v114, 8, v106
v_lshl_or_b32 v119, v115, 8, v107
v_lshl_or_b32 v108, v117, 16, v116
v_lshl_or_b32 v109, v119, 16, v118
s_waitcnt lgkmcnt(0)
s_cmp_eq_u64 s[88:89], 0
s_cbranch_scc1 L_NOTAG
L_TAGOK:
v_mov_b64 v[110:111], s[88:89]
buffer_store_dwordx4 v[108:111], v13, s[76:79], 0 offen sc1
s_add_u32 s76, s76, s3
s_addc_u32 s77, s77, 0
s_waitcnt lgkmcnt(0)
s_nop 0
s_branch L_STREAM
L_PACK1:
v_and_b32 v0, 63, v0
v_lshrrev_b32 v2, 4, v0
v_and_b32 v3, 15, v0
v_mul_u32_u24 v2, 114688, v2
v_lshl_add_u32 v8, v3, 4, v2
s_movk_i32 s47, 0x3800
v_add_u32 v9, s47, v8
v_add_u32 v10, s47, v9
v_add_u32 v11, s47, v10
v_add_u32 v12, s47, v11
v_add_u32 v13, s47, v12
v_add_u32 v14, s47, v13
v_add_u32 v15, s47, v14
s_sub_u32 s3, s2, 1
s_and_b32 s3, s3, 7
s_lshr_b32 s45, s2, 3
s_lshl2_add_u32 s3, s3, s45
s_mul_i32 s40, s3, 4682
s_lshr_b32 s40, s40, 16
s_mul_i32 s41, s40, 14
s_sub_u32 s41, s3, s41
s_add_u32 s40, s40, 8
s_mov_b32 s22, 14680064
s_mov_b32 s23, 0x20000
s_mov_b64 s[20:21], s[6:7]
s_cmp_ge_u32 s40, 12
s_cselect_b32 s45, 8, 0
s_add_u32 s45, s45, s40
s_lshl2_add_u32 s42, s41, s36
s_mul_i32 s43, s45, 458752
s_lshl_b32 s44, s42, 8
s_add_u32 s43, s43, s44
s_lshl_b32 s44, s42, 5
s_add_u32 s44, s44, s45
s_lshl_b32 s52, s44, 11
s_cmp_lt_u32 s45, 32
s_cselect_b32 s52, s52, 0x1000000
s_cselect_b32 s22, 14680064, 0
s_add_u32 s41, s41, 4
s_add_u32 s40, s40, 2
s_cmp_ge_u32 s41, 14
s_cselect_b32 s48, 14, 0
s_addc_u32 s40, s40, 0
s_sub_u32 s41, s41, s48
s_load_dwordx2 s[50:51], s[12:13], 0
buffer_load_dwordx4 v[32:35], v8, s[20:23], s43 offen
buffer_load_dwordx4 v[36:39], v9, s[20:23], s43 offen
buffer_load_dwordx4 v[40:43], v10, s[20:23], s43 offen
buffer_load_dwordx4 v[44:47], v11, s[20:23], s43 offen
buffer_load_dwordx4 v[48:51], v12, s[20:23], s43 offen
buffer_load_dwordx4 v[52:55], v13, s[20:23], s43 offen
buffer_load_dwordx4 v[56:59], v14, s[20:23], s43 offen
buffer_load_dwordx4 v[60:63], v15, s[20:23], s43 offen
s_mov_b64 s[24:25], s[14:15]
s_mov_b32 s26, 3670016
s_mov_b32 s27, 0x20000
s_movk_i32 s34, 128
v_mov_b32 v16, 0
v_lshlrev_b32 v18, 4, v0
s_movk_i32 s46, 4096
s_waitcnt vmcnt(4) lgkmcnt(0)
v_mov_b64 v[22:23], s[50:51]
s_nop 0
L_PKN:
v_cmp_ne_u64 vcc, 0, v[22:23]
s_sub_u32 s46, s46, 1
s_cmp_gt_i32 s46, 0
s_cbranch_vccnz L_PKGO
s_cbranch_scc0 L_END
buffer_load_dwordx2 v[22:23], v16, s[32:35], 0 offen sc1
s_waitcnt vmcnt(0)
s_branch L_PKN
L_PKGO:
s_call_b64 s[100:101], L_PK0
buffer_store_dwordx4 v[20:23], v18, s[24:27], s52 offen offset:0 sc1
s_waitcnt lgkmcnt(0)
s_call_b64 s[100:101], L_UNIT
s_mov_b32 s53, s49
buffer_load_dwordx4 v[64:67], v8, s[20:23], s43 offen
buffer_load_dwordx4 v[68:71], v9, s[20:23], s43 offen
buffer_load_dwordx4 v[72:75], v10, s[20:23], s43 offen
buffer_load_dwordx4 v[76:79], v11, s[20:23], s43 offen
s_waitcnt vmcnt(5)
s_call_b64 s[100:101], L_PK1
buffer_store_dwordx4 v[20:23], v18, s[24:27], s52 offen offset:1024 sc1
buffer_load_dwordx4 v[80:83], v12, s[20:23], s43 offen
buffer_load_dwordx4 v[84:87], v13, s[20:23], s43 offen
buffer_load_dwordx4 v[88:91], v14, s[20:23], s43 offen
buffer_load_dwordx4 v[92:95], v15, s[20:23], s43 offen
s_waitcnt vmcnt(5)
s_call_b64 s[100:101], L_PK2
buffer_store_dwordx4 v[20:23], v18, s[24:27], s53 offen offset:0 sc1
s_call_b64 s[100:101], L_UNIT
s_mov_b32 s54, s49
buffer_load_dwordx4 v[32:35], v8, s[20:23], s43 offen
buffer_load_dwordx4 v[36:39], v9, s[20:23], s43 offen
buffer_load_dwordx4 v[40:43], v10, s[20:23], s43 offen
buffer_load_dwordx4 v[44:47], v11, s[20:23], s43 offen
s_waitcnt vmcnt(5)
s_call_b64 s[100:101], L_PK3
buffer_store_dwordx4 v[20:23], v18, s[24:27], s53 offen offset:1024 sc1
buffer_load_dwordx4 v[48:51], v12, s[20:23], s43 offen
buffer_load_dwordx4 v[52:55], v13, s[20:23], s43 offen
buffer_load_dwordx4 v[56:59], v14, s[20:23], s43 offen
buffer_load_dwordx4 v[60:63], v15, s[20:23], s43 offen
s_waitcnt vmcnt(5)
s_call_b64 s[100:101], L_PK0
buffer_store_dwordx4 v[20:23], v18, s[24:27], s54 offen offset:0 sc1
s_call_b64 s[100:101], L_UNIT
s_mov_b32 s55, s49
buffer_load_dwordx4 v[64:67], v8, s[20:23], s43 offen
buffer_load_dwordx4 v[68:71], v9, s[20:23], s43 offen
buffer_load_dwordx4 v[72:75], v10, s[20:23], s43 offen
buffer_load_dwordx4 v[76:79], v11, s[20:23], s43 offen
s_waitcnt vmcnt(5)
s_call_b64 s[100:101], L_PK1
buffer_store_dwordx4 v[20:23], v18, s[24:27], s54 offen offset:1024 sc1
buffer_load_dwordx4 v[80:83], v12, s[20:23], s43 offen
buffer_load_dwordx4 v[84:87], v13, s[20:23], s43 offen
buffer_load_dwordx4 v[88:91], v14, s[20:23], s43 offen
buffer_load_dwordx4 v[92:95], v15, s[20:23], s43 offen
s_waitcnt vmcnt(5)
s_call_b64 s[100:101], L_PK2
buffer_store_dwordx4 v[20:23], v18, s[24:27], s55 offen offset:0 sc1
buffer_load_dword v19, v17, s[28:31], 0 offen offset:1152
s_waitcnt vmcnt(2)
s_call_b64 s[100:101], L_PK3
buffer_store_dwordx4 v[20:23], v18, s[24:27], s55 offen offset:1024 sc1
s_call_b64 s[100:101], L_UNIT
s_mov_b32 s52, s49
buffer_load_dwordx4 v[32:35], v8, s[20:23], s43 offen
buffer_load_dwordx4 v[36:39], v9, s[20:23], s43 offen
buffer_load_dwordx4 v[40:43], v10, s[20:23], s43 offen
buffer_load_dwordx4 v[44:47], v11, s[20:23], s43 offen
buffer_load_dwordx4 v[48:51], v12, s[20:23], s43 offen
buffer_load_dwordx4 v[52:55], v13, s[20:23], s43 offen
buffer_load_dwordx4 v[56:59], v14, s[20:23], s43 offen
buffer_load_dwordx4 v[60:63], v15, s[20:23], s43 offen
s_waitcnt vmcnt(4)
s_call_b64 s[100:101], L_PK0
buffer_store_dwordx4 v[20:23], v18, s[24:27], s52 offen offset:0 sc1
s_call_b64 s[100:101], L_UNIT
s_mov_b32 s53, s49
buffer_load_dwordx4 v[64:67], v8, s[20:23], s43 offen
buffer_load_dwordx4 v[68:71], v9, s[20:23], s43 offen
buffer_load_dwordx4 v[72:75], v10, s[20:23], s43 offen
buffer_load_dwordx4 v[76:79], v11, s[20:23], s43 offen
s_waitcnt vmcnt(5)
s_call_b64 s[100:101], L_PK1
buffer_store_dwordx4 v[20:23], v18, s[24:27], s52 offen offset:1024 sc1
buffer_load_dwordx4 v[80:83], v12, s[20:23], s43 offen
buffer_load_dwordx4 v[84:87], v13, s[20:23], s43 offen
buffer_load_dwordx4 v[88:91], v14, s[20:23], s43 offen
buffer_load_dwordx4 v[92:95], v15, s[20:23], s43 offen
s_waitcnt vmcnt(5)
s_call_b64 s[100:101], L_PK2
buffer_store_dwordx4 v[20:23], v18, s[24:27], s53 offen offset:0 sc1
s_call_b64 s[100:101], L_UNIT
s_mov_b32 s54, s49
buffer_load_dwordx4 v[32:35], v8, s[20:23], s43 offen
buffer_load_dwordx4 v[36:39], v9, s[20:23], s43 offen
buffer_load_dwordx4 v[40:43], v10, s[20:23], s43 offen
buffer_load_dwordx4 v[44:47], v11, s[20:23], s43 offen
s_waitcnt vmcnt(5)
s_call_b64 s[100:101], L_PK3
buffer_store_dwordx4 v[20:23], v18, s[24:27], s53 offen offset:1024 sc1
buffer_load_dwordx4 v[48:51], v12, s[20:23], s43 offen
buffer_load_dwordx4 v[52:55], v13, s[20:23], s43 offen
buffer_load_dwordx4 v[56:59], v14, s[20:23], s43 offen
buffer_load_dwordx4 v[60:63], v15, s[20:23], s43 offen
s_waitcnt vmcnt(5)
s_call_b64 s[100:101], L_PK0
buffer_store_dwordx4 v[20:23], v18, s[24:27], s54 offen offset:0 sc1
buffer_load_dword v19, v17, s[28:31], 0 offen offset:1536
s_waitcnt vmcnt(2)
s_call_b64 s[100:101], L_PK1
buffer_store_dwordx4 v[20:23], v18, s[24:27], s54 offen offset:1024 sc1
s_endpgm
L_UNIT:
s_cmp_ge_u32 s40, 12
s_cselect_b32 s45, 8, 0
s_add_u32 s45, s45, s40
s_lshl2_add_u32 s42, s41, s36
s_mul_i32 s43, s45, 458752
s_lshl_b32 s44, s42, 8
s_add_u32 s43, s43, s44
s_lshl_b32 s44, s42, 5
s_add_u32 s44, s44, s45
s_lshl_b32 s49, s44, 11
s_cmp_lt_u32 s45, 32
s_cselect_b32 s49, s49, 0x1000000
s_cselect_b32 s22, 14680064, 0
s_add_u32 s41, s41, 4
s_add_u32 s40, s40, 2
s_cmp_ge_u32 s41, 14
s_cselect_b32 s48, 14, 0
s_addc_u32 s40, s40, 0
s_sub_u32 s41, s41, s48
s_setpc_b64 s[100:101]
L_PK0:
v_lshl_add_u64 v[32:33], v[36:37], 4, v[32:33]
v_lshl_add_u64 v[34:35], v[38:39], 4, v[34:35]
v_lshl_add_u64 v[40:41], v[44:45], 4, v[40:41]
v_lshl_add_u64 v[42:43], v[46:47], 4, v[42:43]
v_lshl_or_b32 v44, v40, 8, v32
v_lshl_or_b32 v45, v41, 8, v33
v_lshl_or_b32 v46, v42, 8, v34
v_lshl_or_b32 v47, v43, 8, v35
v_lshl_or_b32 v20, v45, 16, v44
v_lshl_or_b32 v21, v47, 16, v46
s_setpc_b64 s[100:101]
L_PK1:
v_lshl_add_u64 v[48:49], v[52:53], 4, v[48:49]
v_lshl_add_u64 v[50:51], v[54:55], 4, v[50:51]
v_lshl_add_u64 v[56:57], v[60:61], 4, v[56:57]
v_lshl_add_u64 v[58:59], v[62:63], 4, v[58:59]
v_lshl_or_b32 v60, v56, 8, v48
v_lshl_or_b32 v61, v57, 8, v49
v_lshl_or_b32 v62, v58, 8, v50
v_lshl_or_b32 v63, v59, 8, v51
v_lshl_or_b32 v20, v61, 16, v60
v_lshl_or_b32 v21, v63, 16, v62
s_setpc_b64 s[100:101]
L_PK2:
v_lshl_add_u64 v[64:65], v[68:69], 4, v[64:65]
v_lshl_add_u64 v[66:67], v[70:71], 4, v[66:67]
v_lshl_add_u64 v[72:73], v[76:77], 4, v[72:73]
v_lshl_add_u64 v[74:75], v[78:79], 4, v[74:75]
v_lshl_or_b32 v76, v72, 8, v64
v_lshl_or_b32 v77, v73, 8, v65
v_lshl_or_b32 v78, v74, 8, v66
v_lshl_or_b32 v79, v75, 8, v67
v_lshl_or_b32 v20, v77, 16, v76
v_lshl_or_b32 v21, v79, 16, v78
s_setpc_b64 s[100:101]
L_PK3:
v_lshl_add_u64 v[80:81], v[84:85], 4, v[80:81]
v_lshl_add_u64 v[82:83], v[86:87], 4, v[82:83]
v_lshl_add_u64 v[88:89], v[92:93], 4, v[88:89]
v_lshl_add_u64 v[90:91], v[94:95], 4, v[90:91]
v_lshl_or_b32 v92, v88, 8, v80
v_lshl_or_b32 v93, v89, 8, v81
v_lshl_or_b32 v94, v90, 8, v82
v_lshl_or_b32 v95, v91, 8, v83
v_lshl_or_b32 v20, v93, 16, v92
v_lshl_or_b32 v21, v95, 16, v94
s_setpc_b64 s[100:101]
.p2align 12
L_STREAM:
L_PAD0:
s_cbranch_vccnz L_PADRET0
buffer_load_dwordx4 v[80:83], v30, s[72:75], 0 offen
buffer_load_dwordx4 v[84:87], v30, s[72:75], s92 offen
buffer_load_dwordx4 v[88:91], v30, s[72:75], s93 offen
buffer_load_dwordx4 v[92:95], v30, s[72:75], s94 offen
buffer_load_dwordx4 v[40:43], v31, s[72:75], 0 offen
buffer_load_dwordx4 v[44:47], v31, s[72:75], s92 offen
buffer_load_dwordx4 v[48:51], v31, s[72:75], s93 offen
buffer_load_dwordx4 v[52:55], v31, s[72:75], s94 offen
s_waitcnt vmcnt(13)
s_barrier
ds_read_b128 a[224:227], v2 offset:0
ds_read_b128 a[228:231], v2 offset:2048
v_lshl_add_u32 v104, v104, 8, v19
v_lshl_add_u32 v105, v105, 8, v19
v_lshl_add_u32 v106, v106, 8, v19
v_lshl_add_u32 v107, v107, 8, v19
v_lshl_add_u32 v112, v112, 8, v19
v_lshl_add_u32 v113, v113, 8, v19
v_lshl_add_u32 v114, v114, 8, v19
v_lshl_add_u32 v115, v115, 8, v19
s_waitcnt vmcnt(9)
s_add_u32 m0, s33, 81920
v_lshl_add_u64 v[64:65], v[68:69], 4, v[64:65]
v_lshl_add_u64 v[66:67], v[70:71], 4, v[66:67]
v_lshl_add_u64 v[72:73], v[76:77], 4, v[72:73]
v_lshl_add_u64 v[74:75], v[78:79], 4, v[74:75]
v_lshl_add_u32 v64, v64, 8, v19
v_lshl_add_u32 v65, v65, 8, v19
v_lshl_add_u32 v66, v66, 8, v19
v_lshl_add_u32 v67, v67, 8, v19
v_lshl_add_u32 v72, v72, 8, v19
v_lshl_add_u32 v73, v73, 8, v19
v_lshl_add_u32 v74, v74, 8, v19
v_lshl_add_u32 v75, v75, 8, v19
s_bitcmp1_b32 s37, 0
s_cbranch_scc0 L_NOSWAP
v_swap_b32 v104, v64
v_swap_b32 v105, v65
v_swap_b32 v106, v66
v_swap_b32 v107, v67
v_swap_b32 v112, v72
v_swap_b32 v113, v73
v_swap_b32 v114, v74
v_swap_b32 v115, v75
L_NOSWAP:
ds_read_b32 a0, v104
ds_read_b32 a1, v112
ds_read_b32 a2, v64
ds_read_b32 a3, v72
ds_read_b32 a4, v105
ds_read_b32 a5, v113
ds_read_b32 a6, v65
ds_read_b32 a7, v73
ds_read_b32 a8, v106
ds_read_b32 a9, v114
ds_read_b32 a10, v66
ds_read_b32 a11, v74
ds_read_b32 a12, v107
ds_read_b32 a13, v115
ds_read_b32 a14, v67
ds_read_b32 a15, v75
s_waitcnt lgkmcnt(12)
v_mfma_f32_16x16x32_bf16 v[128:131], a[224:227], a[0:3], 0
s_waitcnt lgkmcnt(8)
ds_read_b128 a[232:235], v2 offset:4096
buffer_load_dwordx4 v8, s[20:23], s41 offen lds
v_mfma_f32_16x16x32_bf16 v[132:135], a[224:227], a[4:7], 0
s_waitcnt lgkmcnt(5)
v_mfma_f32_16x16x32_bf16 v[136:139], a[224:227], a[8:11], 0
s_waitcnt lgkmcnt(1)
s_add_u32 m0, s33, 86016
v_mfma_f32_16x16x32_bf16 v[140:143], a[224:227], a[12:15], 0
v_mfma_f32_16x16x32_bf16 v[144:147], a[228:231], a[0:3], 0
ds_read_b128 a[236:239], v2 offset:6144
buffer_load_dwordx4 v9, s[20:23], s41 offen lds
v_mfma_f32_16x16x32_bf16 v[148:151], a[228:231], a[4:7], 0
v_mfma_f32_16x16x32_bf16 v[152:155], a[228:231], a[8:11], 0
s_add_u32 m0, s33, 90112
v_mfma_f32_16x16x32_bf16 v[156:159], a[228:231], a[12:15], 0
s_waitcnt lgkmcnt(1)
v_mfma_f32_16x16x32_bf16 v[160:163], a[232:235], a[0:3], 0
ds_read_b128 a[240:243], v2 offset:8192
buffer_load_dwordx4 v10, s[20:23], s41 offen lds
v_mfma_f32_16x16x32_bf16 v[164:167], a[232:235], a[4:7], 0
v_mfma_f32_16x16x32_bf16 v[168:171], a[232:235], a[8:11], 0
s_add_u32 m0, s33, 94208
v_mfma_f32_16x16x32_bf16 v[172:175], a[232:235], a[12:15], 0
s_waitcnt lgkmcnt(1)
v_mfma_f32_16x16x32_bf16 v[176:179], a[236:239], a[0:3], 0
ds_read_b128 a[244:247], v2 offset:10240
buffer_load_dwordx4 v11, s[20:23], s41 offen lds
v_mfma_f32_16x16x32_bf16 v[180:183], a[236:239], a[4:7], 0
v_mfma_f32_16x16x32_bf16 v[184:187], a[236:239], a[8:11], 0
v_mfma_f32_16x16x32_bf16 v[188:191], a[236:239], a[12:15], 0
s_waitcnt lgkmcnt(1)
v_mfma_f32_16x16x32_bf16 v[192:195], a[240:243], a[0:3], 0
v_mfma_f32_16x16x32_bf16 v[196:199], a[240:243], a[4:7], 0
v_mfma_f32_16x16x32_bf16 v[200:203], a[240:243], a[8:11], 0
v_mfma_f32_16x16x32_bf16 v[204:207], a[240:243], a[12:15], 0
s_waitcnt lgkmcnt(0)
v_mfma_f32_16x16x32_bf16 v[208:211], a[244:247], a[0:3], 0
ds_read_b128 a[248:251], v2 offset:12288
v_mfma_f32_16x16x32_bf16 v[212:215], a[244:247], a[4:7], 0
v_mfma_f32_16x16x32_bf16 v[216:219], a[244:247], a[8:11], 0
v_mfma_f32_16x16x32_bf16 v[220:223], a[244:247], a[12:15], 0
s_waitcnt vmcnt(10)
ds_read_b128 a[252:255], v2 offset:14336
v_lshl_add_u64 v[80:81], v[84:85], 4, v[80:81]
v_lshl_add_u64 v[82:83], v[86:87], 4, v[82:83]
v_lshl_add_u32 v80, v80, 8, v19
v_lshl_add_u32 v81, v81, 8, v19
v_lshl_add_u32 v82, v82, 8, v19
v_lshl_add_u32 v83, v83, 8, v19
ds_read_b32 a16, v80
ds_read_b32 a20, v81
ds_read_b32 a24, v82
ds_read_b32 a28, v83
s_waitcnt vmcnt(8)
v_lshl_add_u64 v[88:89], v[92:93], 4, v[88:89]
v_lshl_add_u64 v[90:91], v[94:95], 4, v[90:91]
v_lshl_add_u32 v88, v88, 8, v19
v_lshl_add_u32 v89, v89, 8, v19
v_lshl_add_u32 v90, v90, 8, v19
v_lshl_add_u32 v91, v91, 8, v19
ds_read_b32 a17, v88
ds_read_b32 a21, v89
ds_read_b32 a25, v90
ds_read_b32 a29, v91
s_waitcnt vmcnt(6)
buffer_load_dwordx4 v[32:35], v12, s[24:27], 0 offen offset:0 sc1
v_lshl_add_u64 v[40:41], v[44:45], 4, v[40:41]
v_lshl_add_u64 v[42:43], v[46:47], 4, v[42:43]
v_lshl_add_u32 v40, v40, 8, v19
v_lshl_add_u32 v41, v41, 8, v19
v_lshl_add_u32 v42, v42, 8, v19
v_lshl_add_u32 v43, v43, 8, v19
ds_read_b32 a18, v40
ds_read_b32 a22, v41
ds_read_b32 a26, v42
ds_read_b32 a30, v43
s_waitcnt vmcnt(5) lgkmcnt(13)
buffer_load_dwordx4 v[36:39], v12, s[24:27], 0 offen offset:1024 sc1
v_lshl_add_u64 v[48:49], v[52:53], 4, v[48:49]
v_lshl_add_u64 v[50:51], v[54:55], 4, v[50:51]
v_lshl_add_u32 v48, v48, 8, v19
v_lshl_add_u32 v49, v49, 8, v19
v_lshl_add_u32 v50, v50, 8, v19
v_lshl_add_u32 v51, v51, 8, v19
ds_read_b32 a19, v48
ds_read_b32 a23, v49
ds_read_b32 a27, v50
ds_read_b32 a31, v51
v_mfma_f32_16x16x32_bf16 v[224:227], a[248:251], a[0:3], 0
ds_read_b128 a[224:227], v4 offset:0
v_mfma_f32_16x16x32_bf16 v[228:231], a[248:251], a[4:7], 0
v_mfma_f32_16x16x32_bf16 v[232:235], a[248:251], a[8:11], 0
global_load_dwordx2 v[20:21], v28, s[8:9]
v_mfma_f32_16x16x32_bf16 v[236:239], a[248:251], a[12:15], 0
s_waitcnt lgkmcnt(5)
v_mfma_f32_16x16x32_bf16 v[240:243], a[252:255], a[0:3], 0
ds_read_b128 a[228:231], v4 offset:2048
v_mfma_f32_16x16x32_bf16 v[244:247], a[252:255], a[4:7], 0
v_mfma_f32_16x16x32_bf16 v[248:251], a[252:255], a[8:11], 0
v_mfma_f32_16x16x32_bf16 v[252:255], a[252:255], a[12:15], 0
s_waitcnt lgkmcnt(1)
v_mfma_f32_16x16x32_bf16 v[128:131], a[224:227], a[16:19], v[128:131]
ds_read_b128 a[232:235], v4 offset:4096
v_mfma_f32_16x16x32_bf16 v[132:135], a[224:227], a[20:23], v[132:135]
v_mfma_f32_16x16x32_bf16 v[136:139], a[224:227], a[24:27], v[136:139]
buffer_load_dwordx4 v[40:43], v12, s[24:27], 0 offen offset:2048 sc1
v_mfma_f32_16x16x32_bf16 v[140:143], a[224:227], a[28:31], v[140:143]
s_waitcnt lgkmcnt(1)
buffer_load_dwordx4 v[44:47], v12, s[24:27], 0 offen offset:3072 sc1
v_mfma_f32_16x16x32_bf16 v[144:147], a[228:231], a[16:19], v[144:147]
ds_read_b128 a[236:239], v4 offset:6144
v_lshl_add_u32 v12, s42, 5, v13
v_mfma_f32_16x16x32_bf16 v[148:151], a[228:231], a[20:23], v[148:151]
v_mfma_f32_16x16x32_bf16 v[152:155], a[228:231], a[24:27], v[152:155]
v_mfma_f32_16x16x32_bf16 v[156:159], a[228:231], a[28:31], v[156:159]
s_waitcnt lgkmcnt(1)
v_mfma_f32_16x16x32_bf16 v[160:163], a[232:235], a[16:19], v[160:163]
ds_read_b128 a[240:243], v4 offset:8192
v_mfma_f32_16x16x32_bf16 v[164:167], a[232:235], a[20:23], v[164:167]
v_mfma_f32_16x16x32_bf16 v[168:171], a[232:235], a[24:27], v[168:171]
v_mfma_f32_16x16x32_bf16 v[172:175], a[232:235], a[28:31], v[172:175]
s_waitcnt lgkmcnt(1)
v_mfma_f32_16x16x32_bf16 v[176:179], a[236:239], a[16:19], v[176:179]
ds_read_b128 a[244:247], v4 offset:10240
buffer_load_dwordx4 v[48:51], v12, s[24:27], 0 offen offset:0 sc1
v_mfma_f32_16x16x32_bf16 v[180:183], a[236:239], a[20:23], v[180:183]
buffer_load_dwordx4 v[52:55], v12, s[24:27], 0 offen offset:1024 sc1
v_mfma_f32_16x16x32_bf16 v[184:187], a[236:239], a[24:27], v[184:187]
s_add_u32 m0, s33, 98304
v_mfma_f32_16x16x32_bf16 v[188:191], a[236:239], a[28:31], v[188:191]
s_waitcnt lgkmcnt(1)
v_mfma_f32_16x16x32_bf16 v[192:195], a[240:243], a[16:19], v[192:195]
buffer_load_dwordx4 v8, s[20:23], s42 offen lds
v_mfma_f32_16x16x32_bf16 v[196:199], a[240:243], a[20:23], v[196:199]
v_mfma_f32_16x16x32_bf16 v[200:203], a[240:243], a[24:27], v[200:203]
s_add_u32 m0, s33, 102400
v_mfma_f32_16x16x32_bf16 v[204:207], a[240:243], a[28:31], v[204:207]
s_waitcnt lgkmcnt(0)
v_mfma_f32_16x16x32_bf16 v[208:211], a[244:247], a[16:19], v[208:211]
s_waitcnt vmcnt(8)
s_barrier
ds_read_b128 a[248:251], v4 offset:12288
buffer_load_dwordx4 v9, s[20:23], s42 offen lds
v_mfma_f32_16x16x32_bf16 v[212:215], a[244:247], a[20:23], v[212:215]
buffer_load_dwordx4 v[96:99], v12, s[24:27], 0 offen offset:2048 sc1
v_mfma_f32_16x16x32_bf16 v[216:219], a[244:247], a[24:27], v[216:219]
buffer_load_dwordx4 v[100:103], v12, s[24:27], 0 offen offset:3072 sc1
v_lshl_add_u32 v12, s43, 5, v13
v_mfma_f32_16x16x32_bf16 v[220:223], a[244:247], a[28:31], v[220:223]
s_add_u32 m0, s33, 106496
ds_read_b128 a[252:255], v4 offset:14336
buffer_load_dwordx4 v10, s[20:23], s42 offen lds
s_waitcnt vmcnt(10)
v_cmp_ne_u64 s[50:51], s[88:89], v[34:35]
v_cmp_ne_u64 s[44:45], s[88:89], v[38:39]
s_or_b64 s[50:51], s[44:45], s[50:51]
s_cbranch_scc1 L_SLOW2
L_BACK2:
v_perm_b32 v64, v32, v19, s52
v_perm_b32 v65, v32, v19, s53
v_perm_b32 v66, v36, v19, s52
v_perm_b32 v67, v36, v19, s53
v_perm_b32 v68, v32, v19, s54
v_perm_b32 v69, v32, v19, s55
v_perm_b32 v70, v36, v19, s54
v_perm_b32 v71, v36, v19, s55
ds_read_b32 a32, v64
ds_read_b32 a33, v65
ds_read_b32 a34, v66
ds_read_b32 a35, v67
ds_read_b32 a36, v68
ds_read_b32 a37, v69
ds_read_b32 a38, v70
ds_read_b32 a39, v71
v_perm_b32 v72, v33, v19, s52
v_perm_b32 v73, v33, v19, s53
v_perm_b32 v74, v37, v19, s52
v_perm_b32 v75, v37, v19, s53
v_perm_b32 v76, v33, v19, s54
v_perm_b32 v77, v33, v19, s55
v_perm_b32 v78, v37, v19, s54
v_perm_b32 v79, v37, v19, s55
ds_read_b32 a40, v72
ds_read_b32 a41, v73
ds_read_b32 a42, v74
ds_read_b32 a43, v75
ds_read_b32 a44, v76
ds_read_b32 a45, v77
ds_read_b32 a46, v78
ds_read_b32 a47, v79
s_waitcnt vmcnt(7)
s_add_u32 m0, s33, 110592
v_cmp_ne_u64 s[50:51], s[88:89], v[42:43]
v_cmp_ne_u64 s[44:45], s[88:89], v[46:47]
s_waitcnt lgkmcnt(15)
v_mfma_f32_16x16x32_bf16 v[224:227], a[248:251], a[16:19], v[224:227]
s_or_b64 s[50:51], s[44:45], s[50:51]
ds_read_b128 a[224:227], v14 offset:16384
buffer_load_dwordx4 v11, s[20:23], s42 offen lds
v_mfma_f32_16x16x32_bf16 v[228:231], a[248:251], a[20:23], v[228:231]
s_cbranch_scc1 L_SLOW3
L_BACK3:
v_mfma_f32_16x16x32_bf16 v[232:235], a[248:251], a[24:27], v[232:235]
s_add_u32 m0, s33, 114688
v_mfma_f32_16x16x32_bf16 v[236:239], a[248:251], a[28:31], v[236:239]
v_mfma_f32_16x16x32_bf16 v[240:243], a[252:255], a[16:19], v[240:243]
ds_read_b128 a[228:231], v14 offset:18432
buffer_load_dwordx4 v8, s[20:23], s43 offen lds
v_mfma_f32_16x16x32_bf16 v[244:247], a[252:255], a[20:23], v[244:247]
buffer_load_dwordx4 v[104:107], v30, s[16:19], 0 offen
v_mfma_f32_16x16x32_bf16 v[248:251], a[252:255], a[24:27], v[248:251]
s_add_u32 m0, s33, 118784
v_mfma_f32_16x16x32_bf16 v[252:255], a[252:255], a[28:31], v[252:255]
s_waitcnt lgkmcnt(1)
v_mfma_f32_16x16x32_bf16 v[128:131], a[224:227], a[32:35], v[128:131]
ds_read_b128 a[232:235], v14 offset:20480
buffer_load_dwordx4 v9, s[20:23], s43 offen lds
v_mfma_f32_16x16x32_bf16 v[132:135], a[224:227], a[36:39], v[132:135]
v_perm_b32 v63, v40, v19, s52
v_mfma_f32_16x16x32_bf16 v[136:139], a[224:227], a[40:43], v[136:139]
s_add_u32 m0, s33, 122880
ds_read_b32 a48, v63
v_perm_b32 v62, v40, v19, s53
v_mfma_f32_16x16x32_bf16 v[140:143], a[224:227], a[44:47], v[140:143]
s_waitcnt lgkmcnt(2)
ds_read_b32 a49, v62
v_perm_b32 v61, v44, v19, s52
v_mfma_f32_16x16x32_bf16 v[144:147], a[228:231], a[32:35], v[144:147]
ds_read_b128 a[236:239], v14 offset:22528
buffer_load_dwordx4 v10, s[20:23], s43 offen lds
v_mfma_f32_16x16x32_bf16 v[148:151], a[228:231], a[36:39], v[148:151]
buffer_load_dwordx4 v[108:111], v30, s[16:19], s92 offen
v_mfma_f32_16x16x32_bf16 v[152:155], a[228:231], a[40:43], v[152:155]
s_add_u32 m0, s33, 126976
ds_read_b32 a50, v61
v_perm_b32 v60, v44, v19, s53
v_mfma_f32_16x16x32_bf16 v[156:159], a[228:231], a[44:47], v[156:159]
s_waitcnt lgkmcnt(3)
ds_read_b32 a51, v60
v_perm_b32 v59, v40, v19, s54
v_mfma_f32_16x16x32_bf16 v[160:163], a[232:235], a[32:35], v[160:163]
ds_read_b128 a[240:243], v14 offset:24576
buffer_load_dwordx4 v11, s[20:23], s43 offen lds
v_mfma_f32_16x16x32_bf16 v[164:167], a[232:235], a[36:39], v[164:167]
ds_read_b32 a52, v59
v_perm_b32 v58, v40, v19, s55
v_mfma_f32_16x16x32_bf16 v[168:171], a[232:235], a[40:43], v[168:171]
ds_read_b32 a53, v58
v_perm_b32 v57, v44, v19, s54
v_mfma_f32_16x16x32_bf16 v[172:175], a[232:235], a[44:47], v[172:175]
s_waitcnt lgkmcnt(4)
ds_read_b32 a54, v57
buffer_load_dwordx4 v[80:83], v12, s[24:27], 0 offen offset:0 sc1
v_mfma_f32_16x16x32_bf16 v[176:179], a[236:239], a[32:35], v[176:179]
ds_read_b128 a[244:247], v14 offset:26624
v_perm_b32 v56, v44, v19, s55
v_mfma_f32_16x16x32_bf16 v[180:183], a[236:239], a[36:39], v[180:183]
buffer_load_dwordx4 v[112:115], v30, s[16:19], s93 offen
v_mfma_f32_16x16x32_bf16 v[184:187], a[236:239], a[40:43], v[184:187]
ds_read_b32 a55, v56
v_perm_b32 v63, v41, v19, s52
v_mfma_f32_16x16x32_bf16 v[188:191], a[236:239], a[44:47], v[188:191]
s_waitcnt lgkmcnt(3)
ds_read_b32 a56, v63
buffer_load_dwordx4 v[84:87], v12, s[24:27], 0 offen offset:1024 sc1
v_mfma_f32_16x16x32_bf16 v[192:195], a[240:243], a[32:35], v[192:195]
ds_read_b128 a[248:251], v14 offset:28672
v_perm_b32 v62, v41, v19, s53
v_mfma_f32_16x16x32_bf16 v[196:199], a[240:243], a[36:39], v[196:199]
ds_read_b32 a57, v62
v_perm_b32 v61, v45, v19, s52
v_mfma_f32_16x16x32_bf16 v[200:203], a[240:243], a[40:43], v[200:203]
s_add_u32 m0, s33, 130560
ds_read_b32 a58, v61
v_perm_b32 v60, v45, v19, s53
v_mfma_f32_16x16x32_bf16 v[204:207], a[240:243], a[44:47], v[204:207]
s_waitcnt lgkmcnt(4)
ds_read_b32 a59, v60
v_perm_b32 v59, v41, v19, s54
v_mfma_f32_16x16x32_bf16 v[208:211], a[244:247], a[32:35], v[208:211]
ds_read_b128 a[252:255], v14 offset:30720
buffer_load_dwordx4 v8, s[20:23], 0 offen offset:512 lds
v_mfma_f32_16x16x32_bf16 v[212:215], a[244:247], a[36:39], v[212:215]
buffer_load_dwordx4 v[116:119], v30, s[16:19], s94 offen
v_mfma_f32_16x16x32_bf16 v[216:219], a[244:247], a[40:43], v[216:219]
ds_read_b32 a60, v59
v_perm_b32 v58, v41, v19, s55
s_mov_b64 vcc, -1
s_cmp_eq_u32 s36, 0
s_cbranch_scc1 L_PAD1
s_cmp_eq_u32 s36, 1
s_cbranch_scc1 L_PAD3
s_cmp_eq_u32 s36, 2
s_cbranch_scc1 L_PAD5
s_cmp_eq_u32 s36, 3
s_cbranch_scc1 L_PADS
L_PADRET:
s_mov_b64 vcc, 0
v_mfma_f32_16x16x32_bf16 v[220:223], a[244:247], a[44:47], v[220:223]
s_waitcnt lgkmcnt(3)
ds_read_b32 a61, v58
v_mfma_f32_16x16x32_bf16 v[224:227], a[248:251], a[32:35], v[224:227]
ds_read_b128 a[224:227], v15 offset:16384
v_perm_b32 v57, v45, v19, s54
v_mfma_f32_16x16x32_bf16 v[228:231], a[248:251], a[36:39], v[228:231]
ds_read_b32 a62, v57
v_perm_b32 v56, v45, v19, s55
v_mfma_f32_16x16x32_bf16 v[232:235], a[248:251], a[40:43], v[232:235]
ds_read_b32 a63, v56
v_mfma_f32_16x16x32_bf16 v[236:239], a[248:251], a[44:47], v[236:239]
s_waitcnt lgkmcnt(4)
v_mfma_f32_16x16x32_bf16 v[240:243], a[252:255], a[32:35], v[240:243]
ds_read_b128 a[228:231], v15 offset:18432
v_lshlrev_b32 v24, 16, v20
v_mfma_f32_16x16x32_bf16 v[244:247], a[252:255], a[36:39], v[244:247]
v_and_b32 v25, 0xffff0000, v20
v_lshlrev_b32 v26, 16, v21
v_mfma_f32_16x16x32_bf16 v[248:251], a[252:255], a[40:43], v[248:251]
s_waitcnt vmcnt(17)
v_cmp_ne_u64 s[50:51], s[88:89], v[50:51]
v_cmp_ne_u64 s[44:45], s[88:89], v[54:55]
v_mfma_f32_16x16x32_bf16 v[252:255], a[252:255], a[44:47], v[252:255]
s_waitcnt lgkmcnt(1)
v_and_b32 v27, 0xffff0000, v21
v_mfma_f32_16x16x32_bf16 v[128:131], a[224:227], a[48:51], v[128:131]
s_or_b64 s[50:51], s[44:45], s[50:51]
ds_read_b128 a[232:235], v15 offset:20480
v_mfma_f32_16x16x32_bf16 v[132:135], a[224:227], a[52:55], v[132:135]
s_cbranch_scc1 L_SLOW4
L_BACK4:
v_mfma_f32_16x16x32_bf16 v[136:139], a[224:227], a[56:59], v[136:139]
v_perm_b32 v63, v48, v19, s52
v_mfma_f32_16x16x32_bf16 v[140:143], a[224:227], a[60:63], v[140:143]
s_waitcnt lgkmcnt(1)
ds_read_b32 a64, v63
buffer_load_dwordx4 v[88:91], v12, s[24:27], 0 offen offset:2048 sc1
v_mfma_f32_16x16x32_bf16 v[144:147], a[228:231], a[48:51], v[144:147]
ds_read_b128 a[236:239], v15 offset:22528
v_perm_b32 v62, v48, v19, s53
v_mfma_f32_16x16x32_bf16 v[148:151], a[228:231], a[52:55], v[148:151]
ds_read_b32 a65, v62
v_perm_b32 v61, v52, v19, s52
v_mfma_f32_16x16x32_bf16 v[152:155], a[228:231], a[56:59], v[152:155]
ds_read_b32 a66, v61
v_perm_b32 v60, v52, v19, s53
v_mfma_f32_16x16x32_bf16 v[156:159], a[228:231], a[60:63], v[156:159]
s_waitcnt lgkmcnt(4)
ds_read_b32 a67, v60
buffer_load_dwordx4 v[92:95], v12, s[24:27], 0 offen offset:3072 sc1
v_mfma_f32_16x16x32_bf16 v[160:163], a[232:235], a[48:51], v[160:163]
ds_read_b128 a[240:243], v15 offset:24576
v_perm_b32 v59, v48, v19, s54
v_mfma_f32_16x16x32_bf16 v[164:167], a[232:235], a[52:55], v[164:167]
ds_read_b32 a68, v59
v_perm_b32 v58, v48, v19, s55
v_mfma_f32_16x16x32_bf16 v[168:171], a[232:235], a[56:59], v[168:171]
s_add_u32 m0, s33, 134656
ds_read_b32 a69, v58
v_perm_b32 v57, v52, v19, s54
v_mfma_f32_16x16x32_bf16 v[172:175], a[232:235], a[60:63], v[172:175]
s_waitcnt lgkmcnt(4)
ds_read_b32 a70, v57
v_perm_b32 v56, v52, v19, s55
v_mfma_f32_16x16x32_bf16 v[176:179], a[236:239], a[48:51], v[176:179]
ds_read_b128 a[244:247], v15 offset:26624
buffer_load_dwordx4 v9, s[20:23], 0 offen offset:512 lds
v_mfma_f32_16x16x32_bf16 v[180:183], a[236:239], a[52:55], v[180:183]
ds_read_b32 a71, v56
v_perm_b32 v63, v49, v19, s52
v_mfma_f32_16x16x32_bf16 v[184:187], a[236:239], a[56:59], v[184:187]
ds_read_b32 a72, v63
v_perm_b32 v62, v49, v19, s53
v_mfma_f32_16x16x32_bf16 v[188:191], a[236:239], a[60:63], v[188:191]
s_waitcnt lgkmcnt(4)
ds_read_b32 a73, v62
v_add_u32 v12, 16384, v13
v_mfma_f32_16x16x32_bf16 v[192:195], a[240:243], a[48:51], v[192:195]
s_waitcnt vmcnt(13)
s_barrier
ds_read_b128 a[248:251], v15 offset:28672
v_perm_b32 v61, v53, v19, s52
v_mfma_f32_16x16x32_bf16 v[196:199], a[240:243], a[52:55], v[196:199]
ds_read_b32 a74, v61
v_perm_b32 v60, v53, v19, s53
v_mfma_f32_16x16x32_bf16 v[200:203], a[240:243], a[56:59], v[200:203]
ds_read_b32 a75, v60
v_perm_b32 v59, v49, v19, s54
v_mfma_f32_16x16x32_bf16 v[204:207], a[240:243], a[60:63], v[204:207]
s_waitcnt lgkmcnt(4)
ds_read_b32 a76, v59
v_mfma_f32_16x16x32_bf16 v[208:211], a[244:247], a[48:51], v[208:211]
ds_read_b128 a[252:255], v15 offset:30720
v_perm_b32 v58, v49, v19, s55
v_mfma_f32_16x16x32_bf16 v[212:215], a[244:247], a[52:55], v[212:215]
ds_read_b32 a77, v58
v_perm_b32 v57, v53, v19, s54
v_mfma_f32_16x16x32_bf16 v[216:219], a[244:247], a[56:59], v[216:219]
v_cmp_ne_u64 s[50:51], s[88:89], v[98:99]
v_cmp_ne_u64 s[44:45], s[88:89], v[102:103]
v_mfma_f32_16x16x32_bf16 v[220:223], a[244:247], a[60:63], v[220:223]
s_waitcnt lgkmcnt(3)
ds_read_b32 a78, v57
v_mfma_f32_16x16x32_bf16 v[224:227], a[248:251], a[48:51], v[224:227]
s_or_b64 s[50:51], s[44:45], s[50:51]
ds_read_b128 a[224:227], v14 offset:32768
v_perm_b32 v56, v53, v19, s55
v_mfma_f32_16x16x32_bf16 v[228:231], a[248:251], a[52:55], v[228:231]
s_cbranch_scc1 L_SLOW5
L_BACK5:
v_mfma_f32_16x16x32_bf16 v[232:235], a[248:251], a[56:59], v[232:235]
s_add_u32 m0, s33, 138752
ds_read_b32 a79, v56
v_mfma_f32_16x16x32_bf16 v[236:239], a[248:251], a[60:63], v[236:239]
s_waitcnt lgkmcnt(3)
v_perm_b32 v63, v96, v19, s52
v_mfma_f32_16x16x32_bf16 v[240:243], a[252:255], a[48:51], v[240:243]
ds_read_b128 a[228:231], v14 offset:34816
buffer_load_dwordx4 v10, s[20:23], 0 offen offset:512 lds
v_mfma_f32_16x16x32_bf16 v[244:247], a[252:255], a[52:55], v[244:247]
ds_read_b32 a80, v63
v_perm_b32 v62, v96, v19, s53
v_mfma_f32_16x16x32_bf16 v[248:251], a[252:255], a[56:59], v[248:251]
ds_read_b32 a81, v62
v_perm_b32 v61, v100, v19, s52
v_mfma_f32_16x16x32_bf16 v[252:255], a[252:255], a[60:63], v[252:255]
s_waitcnt lgkmcnt(3)
ds_read_b32 a82, v61
v_mfma_f32_16x16x32_bf16 v[128:131], a[224:227], a[64:67], v[128:131]
ds_read_b128 a[232:235], v14 offset:36864
v_perm_b32 v60, v100, v19, s53
v_mfma_f32_16x16x32_bf16 v[132:135], a[224:227], a[68:71], v[132:135]
ds_read_b32 a83, v60
v_perm_b32 v59, v96, v19, s54
v_mfma_f32_16x16x32_bf16 v[136:139], a[224:227], a[72:75], v[136:139]
ds_read_b32 a84, v59
v_perm_b32 v58, v96, v19, s55
v_mfma_f32_16x16x32_bf16 v[140:143], a[224:227], a[76:79], v[140:143]
s_waitcnt lgkmcnt(4)
ds_read_b32 a85, v58
buffer_load_dwordx4 v[32:35], v12, s[24:27], 0 offen offset:0 sc1
v_mfma_f32_16x16x32_bf16 v[144:147], a[228:231], a[64:67], v[144:147]
ds_read_b128 a[236:239], v14 offset:38912
v_perm_b32 v57, v100, v19, s54
v_mfma_f32_16x16x32_bf16 v[148:151], a[228:231], a[68:71], v[148:151]
ds_read_b32 a86, v57
v_perm_b32 v56, v100, v19, s55
v_mfma_f32_16x16x32_bf16 v[152:155], a[228:231], a[72:75], v[152:155]
s_add_u32 m0, s33, 142848
ds_read_b32 a87, v56
v_perm_b32 v63, v97, v19, s52
v_mfma_f32_16x16x32_bf16 v[156:159], a[228:231], a[76:79], v[156:159]
s_waitcnt lgkmcnt(4)
ds_read_b32 a88, v63
v_perm_b32 v62, v97, v19, s53
v_mfma_f32_16x16x32_bf16 v[160:163], a[232:235], a[64:67], v[160:163]
ds_read_b128 a[240:243], v14 offset:40960
buffer_load_dwordx4 v11, s[20:23], 0 offen offset:512 lds
v_mfma_f32_16x16x32_bf16 v[164:167], a[232:235], a[68:71], v[164:167]
ds_read_b32 a89, v62
v_perm_b32 v61, v101, v19, s52
v_mfma_f32_16x16x32_bf16 v[168:171], a[232:235], a[72:75], v[168:171]
ds_read_b32 a90, v61
v_perm_b32 v60, v101, v19, s53
v_mfma_f32_16x16x32_bf16 v[172:175], a[232:235], a[76:79], v[172:175]
s_waitcnt lgkmcnt(4)
ds_read_b32 a91, v60
buffer_load_dwordx4 v[36:39], v12, s[24:27], 0 offen offset:1024 sc1
v_mfma_f32_16x16x32_bf16 v[176:179], a[236:239], a[64:67], v[176:179]
ds_read_b128 a[244:247], v14 offset:43008
v_perm_b32 v59, v97, v19, s54
v_mfma_f32_16x16x32_bf16 v[180:183], a[236:239], a[68:71], v[180:183]
ds_read_b32 a92, v59
v_perm_b32 v58, v97, v19, s55
v_mfma_f32_16x16x32_bf16 v[184:187], a[236:239], a[72:75], v[184:187]
s_waitcnt vmcnt(9)
v_cmp_ne_u64 s[50:51], s[88:89], v[82:83]
v_cmp_ne_u64 s[44:45], s[88:89], v[86:87]
v_mfma_f32_16x16x32_bf16 v[188:191], a[236:239], a[76:79], v[188:191]
s_waitcnt lgkmcnt(3)
ds_read_b32 a93, v58
v_mfma_f32_16x16x32_bf16 v[192:195], a[240:243], a[64:67], v[192:195]
s_or_b64 s[50:51], s[44:45], s[50:51]
ds_read_b128 a[248:251], v14 offset:45056
v_perm_b32 v57, v101, v19, s54
v_mfma_f32_16x16x32_bf16 v[196:199], a[240:243], a[68:71], v[196:199]
s_cbranch_scc1 L_SLOW6
L_BACK6:
v_mfma_f32_16x16x32_bf16 v[200:203], a[240:243], a[72:75], v[200:203]
s_add_u32 m0, s33, 146816
ds_read_b32 a94, v57
v_perm_b32 v56, v101, v19, s55
v_mfma_f32_16x16x32_bf16 v[204:207], a[240:243], a[76:79], v[204:207]
s_waitcnt lgkmcnt(3)
ds_read_b32 a95, v56
v_perm_b32 v63, v80, v19, s52
v_mfma_f32_16x16x32_bf16 v[208:211], a[244:247], a[64:67], v[208:211]
ds_read_b128 a[252:255], v14 offset:47104
buffer_load_dwordx4 v8, s[20:23], 0 offen offset:640 lds
v_mfma_f32_16x16x32_bf16 v[212:215], a[244:247], a[68:71], v[212:215]
L_PAD1:
s_cbranch_vccnz L_PAD2
ds_read_b32 a96, v63
v_perm_b32 v62, v80, v19, s53
v_mfma_f32_16x16x32_bf16 v[216:219], a[244:247], a[72:75], v[216:219]
ds_read_b32 a97, v62
v_perm_b32 v61, v84, v19, s52
v_mfma_f32_16x16x32_bf16 v[220:223], a[244:247], a[76:79], v[220:223]
s_waitcnt lgkmcnt(4)
ds_read_b32 a98, v61
v_mfma_f32_16x16x32_bf16 v[224:227], a[248:251], a[64:67], v[224:227]
ds_read_b128 a[224:227], v15 offset:32768
v_perm_b32 v60, v84, v19, s53
v_mfma_f32_16x16x32_bf16 v[228:231], a[248:251], a[68:71], v[228:231]
ds_read_b32 a99, v60
v_perm_b32 v59, v80, v19, s54
v_mfma_f32_16x16x32_bf16 v[232:235], a[248:251], a[72:75], v[232:235]
ds_read_b32 a100, v59
v_perm_b32 v58, v80, v19, s55
v_mfma_f32_16x16x32_bf16 v[236:239], a[248:251], a[76:79], v[236:239]
s_waitcnt lgkmcnt(4)
ds_read_b32 a101, v58
v_mfma_f32_16x16x32_bf16 v[240:243], a[252:255], a[64:67], v[240:243]
ds_read_b128 a[228:231], v15 offset:36864
v_perm_b32 v57, v84, v19, s54
v_mfma_f32_16x16x32_bf16 v[244:247], a[252:255], a[68:71], v[244:247]
ds_read_b32 a102, v57
v_perm_b32 v56, v84, v19, s55
v_mfma_f32_16x16x32_bf16 v[248:251], a[252:255], a[72:75], v[248:251]
ds_read_b32 a103, v56
v_perm_b32 v63, v81, v19, s52
v_mfma_f32_16x16x32_bf16 v[252:255], a[252:255], a[76:79], v[252:255]
s_waitcnt lgkmcnt(4)
ds_read_b32 a104, v63
v_mfma_f32_16x16x32_bf16 v[128:131], a[224:227], a[80:83], v[128:131]
ds_read_b128 a[232:235], v15 offset:40960
v_perm_b32 v62, v81, v19, s53
v_mfma_f32_16x16x32_bf16 v[132:135], a[224:227], a[84:87], v[132:135]
ds_read_b32 a105, v62
v_perm_b32 v61, v85, v19, s52
v_mfma_f32_16x16x32_bf16 v[136:139], a[224:227], a[88:91], v[136:139]
ds_read_b32 a106, v61
v_perm_b32 v60, v85, v19, s53
v_mfma_f32_16x16x32_bf16 v[140:143], a[224:227], a[92:95], v[140:143]
s_waitcnt lgkmcnt(4)
ds_read_b32 a107, v60
buffer_load_dwordx4 v[40:43], v12, s[24:27], 0 offen offset:2048 sc1
v_mfma_f32_16x16x32_bf16 v[160:163], a[228:231], a[80:83], v[160:163]
ds_read_b128 a[236:239], v15 offset:45056
v_perm_b32 v59, v81, v19, s54
v_mfma_f32_16x16x32_bf16 v[164:167], a[228:231], a[84:87], v[164:167]
s_waitcnt vmcnt(9)
ds_read_b32 a108, v59
v_perm_b32 v58, v81, v19, s55
v_lshl_add_u64 v[104:105], v[108:109], 4, v[104:105]
v_lshl_add_u64 v[106:107], v[110:111], 4, v[106:107]
v_lshl_add_u64 v[112:113], v[116:117], 4, v[112:113]
v_lshl_add_u64 v[114:115], v[118:119], 4, v[114:115]
v_lshl_or_b32 v116, v112, 8, v104
v_lshl_or_b32 v117, v113, 8, v105
v_lshl_or_b32 v118, v114, 8, v106
v_lshl_or_b32 v119, v115, 8, v107
v_lshl_or_b32 v108, v117, 16, v116
v_lshl_or_b32 v109, v119, 16, v118
v_mov_b64 v[110:111], s[88:89]
v_mfma_f32_16x16x32_bf16 v[168:171], a[228:231], a[88:91], v[168:171]
buffer_store_dwordx4 v[108:111], v13, s[76:79], 0 offen sc1
v_mfma_f32_16x16x32_bf16 v[172:175], a[228:231], a[92:95], v[172:175]
s_waitcnt lgkmcnt(3)
ds_read_b32 a109, v58
buffer_load_dwordx4 v[44:47], v12, s[24:27], 0 offen offset:3072 sc1
v_mfma_f32_16x16x32_bf16 v[192:195], a[232:235], a[80:83], v[192:195]
ds_read_b128 a[240:243], v15 offset:34816
v_perm_b32 v57, v85, v19, s54
v_mfma_f32_16x16x32_bf16 v[196:199], a[232:235], a[84:87], v[196:199]
ds_read_b32 a110, v57
v_add_u32 v12, 20480, v13
v_mfma_f32_16x16x32_bf16 v[200:203], a[232:235], a[88:91], v[200:203]
s_add_u32 m0, s33, 150912
ds_read_b128 a[244:247], v14 offset:51200
v_perm_b32 v56, v85, v19, s55
v_mfma_f32_16x16x32_bf16 v[204:207], a[232:235], a[92:95], v[204:207]
s_waitcnt lgkmcnt(4)
ds_read_b32 a111, v56
v_mfma_f32_16x16x32_bf16 v[224:227], a[236:239], a[80:83], v[224:227]
buffer_load_dwordx4 v9, s[20:23], 0 offen offset:640 lds
v_mfma_f32_16x16x32_bf16 v[228:231], a[236:239], a[84:87], v[228:231]
v_mfma_f32_16x16x32_bf16 v[232:235], a[236:239], a[88:91], v[232:235]
v_mfma_f32_16x16x32_bf16 v[236:239], a[236:239], a[92:95], v[236:239]
s_waitcnt vmcnt(10) lgkmcnt(1)
v_cmp_ne_u64 s[50:51], s[88:89], v[90:91]
v_mfma_f32_16x16x32_bf16 v[144:147], a[240:243], a[80:83], v[144:147]
s_barrier
ds_read_b128 a[248:251], v15 offset:38912
v_cmp_ne_u64 s[44:45], s[88:89], v[94:95]
v_mfma_f32_16x16x32_bf16 v[144:147], a[244:247], a[96:99], v[144:147]
v_mfma_f32_16x16x32_bf16 v[148:151], a[244:247], a[100:103], v[148:151]
s_or_b64 s[50:51], s[44:45], s[50:51]
ds_read_b128 a[252:255], v14 offset:55296
v_mfma_f32_16x16x32_bf16 v[148:151], a[240:243], a[84:87], v[148:151]
s_cbranch_scc1 L_SLOW7
L_BACK7:
v_mfma_f32_16x16x32_bf16 v[152:155], a[240:243], a[88:91], v[152:155]
v_perm_b32 v63, v88, v19, s52
v_mfma_f32_16x16x32_bf16 v[152:155], a[244:247], a[104:107], v[152:155]
s_waitcnt lgkmcnt(1)
ds_read_b32 a112, v63
v_perm_b32 v62, v88, v19, s53
v_mfma_f32_16x16x32_bf16 v[156:159], a[244:247], a[108:111], v[156:159]
ds_read_b32 a113, v62
v_perm_b32 v61, v92, v19, s52
v_mfma_f32_16x16x32_bf16 v[156:159], a[240:243], a[92:95], v[156:159]
s_waitcnt lgkmcnt(2)
ds_read_b32 a114, v61
v_mfma_f32_16x16x32_bf16 v[176:179], a[248:251], a[80:83], v[176:179]
ds_read_b128 a[224:227], v15 offset:43008
v_perm_b32 v60, v92, v19, s53
v_mfma_f32_16x16x32_bf16 v[176:179], a[252:255], a[96:99], v[176:179]
ds_read_b32 a115, v60
v_mfma_f32_16x16x32_bf16 v[180:183], a[252:255], a[100:103], v[180:183]
ds_read_b128 a[228:231], v14 offset:59392
v_perm_b32 v59, v88, v19, s54
v_mfma_f32_16x16x32_bf16 v[180:183], a[248:251], a[84:87], v[180:183]
s_add_u32 m0, s33, 155008
ds_read_b32 a116, v59
v_mfma_f32_16x16x32_bf16 v[184:187], a[248:251], a[88:91], v[184:187]
buffer_load_dwordx4 v10, s[20:23], 0 offen offset:640 lds
v_perm_b32 v58, v88, v19, s55
v_mfma_f32_16x16x32_bf16 v[184:187], a[252:255], a[104:107], v[184:187]
ds_read_b32 a117, v58
v_perm_b32 v57, v92, v19, s54
v_mfma_f32_16x16x32_bf16 v[188:191], a[252:255], a[108:111], v[188:191]
ds_read_b32 a118, v57
v_perm_b32 v56, v92, v19, s55
v_mfma_f32_16x16x32_bf16 v[188:191], a[248:251], a[92:95], v[188:191]
s_waitcnt lgkmcnt(3)
ds_read_b32 a119, v56
v_mfma_f32_16x16x32_bf16 v[208:211], a[224:227], a[80:83], v[208:211]
ds_read_b128 a[232:235], v15 offset:47104
v_perm_b32 v63, v89, v19, s52
v_mfma_f32_16x16x32_bf16 v[208:211], a[228:231], a[96:99], v[208:211]
ds_read_b32 a120, v63
v_mfma_f32_16x16x32_bf16 v[212:215], a[228:231], a[100:103], v[212:215]
ds_read_b128 a[236:239], v14 offset:63488
v_perm_b32 v62, v89, v19, s53
v_mfma_f32_16x16x32_bf16 v[212:215], a[224:227], a[84:87], v[212:215]
ds_read_b32 a121, v62
v_perm_b32 v61, v93, v19, s52
v_mfma_f32_16x16x32_bf16 v[216:219], a[224:227], a[88:91], v[216:219]
ds_read_b32 a122, v61
v_perm_b32 v60, v93, v19, s53
v_mfma_f32_16x16x32_bf16 v[216:219], a[228:231], a[104:107], v[216:219]
ds_read_b32 a123, v60
v_perm_b32 v59, v89, v19, s54
v_mfma_f32_16x16x32_bf16 v[220:223], a[228:231], a[108:111], v[220:223]
s_add_u32 m0, s33, 159104
ds_read_b32 a124, v59
v_perm_b32 v58, v89, v19, s55
v_mfma_f32_16x16x32_bf16 v[220:223], a[224:227], a[92:95], v[220:223]
s_waitcnt lgkmcnt(4)
ds_read_b32 a125, v58
v_perm_b32 v57, v93, v19, s54
v_mfma_f32_16x16x32_bf16 v[240:243], a[232:235], a[80:83], v[240:243]
ds_read_b128 a[240:243], v14 offset:49152
buffer_load_dwordx4 v11, s[20:23], 0 offen offset:640 lds
v_mfma_f32_16x16x32_bf16 v[240:243], a[236:239], a[96:99], v[240:243]
ds_read_b32 a126, v57
buffer_load_dwordx4 v[48:51], v12, s[24:27], 0 offen offset:0 sc1
v_mfma_f32_16x16x32_bf16 v[244:247], a[236:239], a[100:103], v[244:247]
ds_read_b128 a[244:247], v15 offset:49152
v_perm_b32 v56, v93, v19, s55
v_mfma_f32_16x16x32_bf16 v[244:247], a[232:235], a[84:87], v[244:247]
ds_read_b32 a127, v56
buffer_load_dwordx4 v[52:55], v12, s[24:27], 0 offen offset:1024 sc1
v_mfma_f32_16x16x32_bf16 v[248:251], a[232:235], a[88:91], v[248:251]
v_mfma_f32_16x16x32_bf16 v[248:251], a[236:239], a[104:107], v[248:251]
v_mfma_f32_16x16x32_bf16 v[252:255], a[236:239], a[108:111], v[252:255]
s_waitcnt vmcnt(9)
v_cmp_ne_u64 s[50:51], s[88:89], v[34:35]
v_cmp_ne_u64 s[44:45], s[88:89], v[38:39]
v_mfma_f32_16x16x32_bf16 v[252:255], a[232:235], a[92:95], v[252:255]
s_waitcnt lgkmcnt(1)
v_mfma_f32_16x16x32_bf16 v[128:131], a[240:243], a[96:99], v[128:131]
s_or_b64 s[50:51], s[44:45], s[50:51]
ds_read_b128 a[248:251], v14 offset:53248
v_mfma_f32_16x16x32_bf16 v[128:131], a[244:247], a[112:115], v[128:131]
s_cbranch_scc1 L_SLOW8
L_BACK8:
v_mfma_f32_16x16x32_bf16 v[132:135], a[244:247], a[116:119], v[132:135]
ds_read_b128 a[252:255], v15 offset:53248
v_mfma_f32_16x16x32_bf16 v[132:135], a[240:243], a[100:103], v[132:135]
s_add_u32 m0, s33, 64768
v_mfma_f32_16x16x32_bf16 v[136:139], a[240:243], a[104:107], v[136:139]
buffer_load_dwordx4 v8, s[20:23], 0 offen offset:768 lds
v_mfma_f32_16x16x32_bf16 v[136:139], a[244:247], a[120:123], v[136:139]
s_waitcnt lgkmcnt(1)
v_perm_b32 v63, v32, v19, s52
v_mfma_f32_16x16x32_bf16 v[140:143], a[244:247], a[124:127], v[140:143]
ds_read_b32 a128, v63
v_perm_b32 v62, v32, v19, s53
v_mfma_f32_16x16x32_bf16 v[140:143], a[240:243], a[108:111], v[140:143]
s_waitcnt lgkmcnt(1)
ds_read_b32 a129, v62
v_mfma_f32_16x16x32_bf16 v[160:163], a[248:251], a[96:99], v[160:163]
ds_read_b128 a[224:227], v14 offset:57344
v_perm_b32 v61, v36, v19, s52
v_mfma_f32_16x16x32_bf16 v[160:163], a[252:255], a[112:115], v[160:163]
ds_read_b32 a130, v61
v_mfma_f32_16x16x32_bf16 v[164:167], a[252:255], a[116:119], v[164:167]
ds_read_b128 a[228:231], v15 offset:57344
v_perm_b32 v60, v36, v19, s53
v_mfma_f32_16x16x32_bf16 v[164:167], a[248:251], a[100:103], v[164:167]
ds_read_b32 a131, v60
v_perm_b32 v59, v32, v19, s54
v_mfma_f32_16x16x32_bf16 v[168:171], a[248:251], a[104:107], v[168:171]
ds_read_b32 a132, v59
v_perm_b32 v58, v32, v19, s55
v_mfma_f32_16x16x32_bf16 v[168:171], a[252:255], a[120:123], v[168:171]
ds_read_b32 a133, v58
v_perm_b32 v57, v36, v19, s54
v_mfma_f32_16x16x32_bf16 v[172:175], a[252:255], a[124:127], v[172:175]
ds_read_b32 a134, v57
v_perm_b32 v56, v36, v19, s55
v_mfma_f32_16x16x32_bf16 v[172:175], a[248:251], a[108:111], v[172:175]
s_waitcnt lgkmcnt(4)
ds_read_b32 a135, v56
v_mfma_f32_16x16x32_bf16 v[192:195], a[224:227], a[96:99], v[192:195]
ds_read_b128 a[232:235], v14 offset:61440
v_perm_b32 v63, v33, v19, s52
v_mfma_f32_16x16x32_bf16 v[192:195], a[228:231], a[112:115], v[192:195]
ds_read_b32 a136, v63
v_mfma_f32_16x16x32_bf16 v[196:199], a[228:231], a[116:119], v[196:199]
ds_read_b128 a[236:239], v15 offset:61440
v_perm_b32 v62, v33, v19, s53
v_mfma_f32_16x16x32_bf16 v[196:199], a[224:227], a[100:103], v[196:199]
ds_read_b32 a137, v62
v_perm_b32 v61, v37, v19, s52
v_mfma_f32_16x16x32_bf16 v[200:203], a[224:227], a[104:107], v[200:203]
ds_read_b32 a138, v61
v_perm_b32 v60, v37, v19, s53
v_mfma_f32_16x16x32_bf16 v[200:203], a[228:231], a[120:123], v[200:203]
ds_read_b32 a139, v60
v_perm_b32 v59, v33, v19, s54
v_mfma_f32_16x16x32_bf16 v[204:207], a[228:231], a[124:127], v[204:207]
ds_read_b32 a140, v59
v_perm_b32 v58, v33, v19, s55
v_mfma_f32_16x16x32_bf16 v[204:207], a[224:227], a[108:111], v[204:207]
s_waitcnt lgkmcnt(4)
ds_read_b32 a141, v58
buffer_load_dwordx4 v[96:99], v12, s[24:27], 0 offen offset:2048 sc1
v_mfma_f32_16x16x32_bf16 v[224:227], a[232:235], a[96:99], v[224:227]
ds_read_b128 a[240:243], v15 offset:51200
v_perm_b32 v57, v37, v19, s54
v_mfma_f32_16x16x32_bf16 v[224:227], a[236:239], a[112:115], v[224:227]
ds_read_b32 a142, v57
buffer_load_dwordx4 v[100:103], v12, s[24:27], 0 offen offset:3072 sc1
v_mfma_f32_16x16x32_bf16 v[228:231], a[236:239], a[116:119], v[228:231]
ds_read_b128 a[244:247], v16 offset:2048
v_perm_b32 v56, v37, v19, s55
v_mfma_f32_16x16x32_bf16 v[228:231], a[232:235], a[100:103], v[228:231]
s_add_u32 m0, s33, 68864
ds_read_b32 a143, v56
v_add_u32 v12, 24576, v13
v_mfma_f32_16x16x32_bf16 v[232:235], a[232:235], a[104:107], v[232:235]
buffer_load_dwordx4 v9, s[20:23], 0 offen offset:768 lds
v_mfma_f32_16x16x32_bf16 v[232:235], a[236:239], a[120:123], v[232:235]
v_mfma_f32_16x16x32_bf16 v[236:239], a[236:239], a[124:127], v[236:239]
v_mfma_f32_16x16x32_bf16 v[236:239], a[232:235], a[108:111], v[236:239]
s_waitcnt vmcnt(9) lgkmcnt(1)
v_cmp_ne_u64 s[50:51], s[88:89], v[42:43]
v_mfma_f32_16x16x32_bf16 v[144:147], a[240:243], a[112:115], v[144:147]
s_barrier
ds_read_b128 a[248:251], v15 offset:55296
v_cmp_ne_u64 s[44:45], s[88:89], v[46:47]
v_mfma_f32_16x16x32_bf16 v[144:147], a[244:247], a[128:131], v[144:147]
v_mfma_f32_16x16x32_bf16 v[148:151], a[244:247], a[132:135], v[148:151]
s_or_b64 s[50:51], s[44:45], s[50:51]
ds_read_b128 a[252:255], v16 offset:6144
v_mfma_f32_16x16x32_bf16 v[148:151], a[240:243], a[116:119], v[148:151]
s_cbranch_scc1 L_SLOW9
L_BACK9:
v_mfma_f32_16x16x32_bf16 v[152:155], a[240:243], a[120:123], v[152:155]
v_perm_b32 v63, v40, v19, s52
v_mfma_f32_16x16x32_bf16 v[152:155], a[244:247], a[136:139], v[152:155]
s_waitcnt lgkmcnt(1)
ds_read_b32 a144, v63
v_perm_b32 v62, v40, v19, s53
v_mfma_f32_16x16x32_bf16 v[156:159], a[244:247], a[140:143], v[156:159]
ds_read_b32 a145, v62
v_perm_b32 v61, v44, v19, s52
v_mfma_f32_16x16x32_bf16 v[156:159], a[240:243], a[124:127], v[156:159]
s_waitcnt lgkmcnt(2)
ds_read_b32 a146, v61
v_mfma_f32_16x16x32_bf16 v[176:179], a[248:251], a[112:115], v[176:179]
ds_read_b128 a[224:227], v15 offset:59392
v_perm_b32 v60, v44, v19, s53
v_mfma_f32_16x16x32_bf16 v[176:179], a[252:255], a[128:131], v[176:179]
ds_read_b32 a147, v60
v_mfma_f32_16x16x32_bf16 v[180:183], a[252:255], a[132:135], v[180:183]
ds_read_b128 a[228:231], v16 offset:10240
v_perm_b32 v59, v40, v19, s54
v_mfma_f32_16x16x32_bf16 v[180:183], a[248:251], a[116:119], v[180:183]
s_add_u32 m0, s33, 72960
ds_read_b32 a148, v59
v_mfma_f32_16x16x32_bf16 v[184:187], a[248:251], a[120:123], v[184:187]
buffer_load_dwordx4 v10, s[20:23], 0 offen offset:768 lds
v_perm_b32 v58, v40, v19, s55
v_mfma_f32_16x16x32_bf16 v[184:187], a[252:255], a[136:139], v[184:187]
ds_read_b32 a149, v58
v_perm_b32 v57, v44, v19, s54
v_mfma_f32_16x16x32_bf16 v[188:191], a[252:255], a[140:143], v[188:191]
ds_read_b32 a150, v57
v_perm_b32 v56, v44, v19, s55
v_mfma_f32_16x16x32_bf16 v[188:191], a[248:251], a[124:127], v[188:191]
s_waitcnt lgkmcnt(3)
ds_read_b32 a151, v56
v_mfma_f32_16x16x32_bf16 v[208:211], a[224:227], a[112:115], v[208:211]
ds_read_b128 a[232:235], v15 offset:63488
v_perm_b32 v63, v41, v19, s52
v_mfma_f32_16x16x32_bf16 v[208:211], a[228:231], a[128:131], v[208:211]
ds_read_b32 a152, v63
v_mfma_f32_16x16x32_bf16 v[212:215], a[228:231], a[132:135], v[212:215]
ds_read_b128 a[236:239], v16 offset:14336
v_perm_b32 v62, v41, v19, s53
v_mfma_f32_16x16x32_bf16 v[212:215], a[224:227], a[116:119], v[212:215]
ds_read_b32 a153, v62
v_perm_b32 v61, v45, v19, s52
v_mfma_f32_16x16x32_bf16 v[216:219], a[224:227], a[120:123], v[216:219]
ds_read_b32 a154, v61
v_perm_b32 v60, v45, v19, s53
v_mfma_f32_16x16x32_bf16 v[216:219], a[228:231], a[136:139], v[216:219]
ds_read_b32 a155, v60
v_perm_b32 v59, v41, v19, s54
v_mfma_f32_16x16x32_bf16 v[220:223], a[228:231], a[140:143], v[220:223]
s_add_u32 m0, s33, 77056
ds_read_b32 a156, v59
v_perm_b32 v58, v41, v19, s55
v_mfma_f32_16x16x32_bf16 v[220:223], a[224:227], a[124:127], v[220:223]
s_waitcnt lgkmcnt(4)
ds_read_b32 a157, v58
v_perm_b32 v57, v45, v19, s54
v_mfma_f32_16x16x32_bf16 v[240:243], a[232:235], a[112:115], v[240:243]
ds_read_b128 a[240:243], v16 offset:0
buffer_load_dwordx4 v11, s[20:23], 0 offen offset:768 lds
v_mfma_f32_16x16x32_bf16 v[240:243], a[236:239], a[128:131], v[240:243]
ds_read_b32 a158, v57
buffer_load_dwordx4 v[80:83], v12, s[24:27], 0 offen offset:0 sc1
v_mfma_f32_16x16x32_bf16 v[244:247], a[236:239], a[132:135], v[244:247]
ds_read_b128 a[244:247], v17 offset:0
v_perm_b32 v56, v45, v19, s55
v_mfma_f32_16x16x32_bf16 v[244:247], a[232:235], a[116:119], v[244:247]
ds_read_b32 a159, v56
buffer_load_dwordx4 v[84:87], v12, s[24:27], 0 offen offset:1024 sc1
v_mfma_f32_16x16x32_bf16 v[248:251], a[232:235], a[120:123], v[248:251]
v_mfma_f32_16x16x32_bf16 v[248:251], a[236:239], a[136:139], v[248:251]
v_mfma_f32_16x16x32_bf16 v[252:255], a[236:239], a[140:143], v[252:255]
s_waitcnt vmcnt(8)
v_cmp_ne_u64 s[50:51], s[88:89], v[50:51]
v_cmp_ne_u64 s[44:45], s[88:89], v[54:55]
v_mfma_f32_16x16x32_bf16 v[252:255], a[232:235], a[124:127], v[252:255]
s_waitcnt lgkmcnt(1)
v_mfma_f32_16x16x32_bf16 v[128:131], a[240:243], a[128:131], v[128:131]
s_or_b64 s[50:51], s[44:45], s[50:51]
ds_read_b128 a[248:251], v16 offset:4096
v_mfma_f32_16x16x32_bf16 v[128:131], a[244:247], a[144:147], v[128:131]
s_cbranch_scc1 L_SLOW10
L_BACK10:
v_mfma_f32_16x16x32_bf16 v[132:135], a[244:247], a[148:151], v[132:135]
ds_read_b128 a[252:255], v17 offset:4096
v_mfma_f32_16x16x32_bf16 v[132:135], a[240:243], a[132:135], v[132:135]
s_add_u32 m0, s33, 81024
v_mfma_f32_16x16x32_bf16 v[136:139], a[240:243], a[136:139], v[136:139]
buffer_load_dwordx4 v8, s[20:23], 0 offen offset:896 lds
v_perm_b32 v63, v48, v19, s52
v_mfma_f32_16x16x32_bf16 v[136:139], a[244:247], a[152:155], v[136:139]
s_waitcnt lgkmcnt(1)
ds_read_b32 a160, v63
v_perm_b32 v62, v48, v19, s53
v_mfma_f32_16x16x32_bf16 v[140:143], a[244:247], a[156:159], v[140:143]
ds_read_b32 a161, v62
v_perm_b32 v61, v52, v19, s52
v_mfma_f32_16x16x32_bf16 v[140:143], a[240:243], a[140:143], v[140:143]
s_waitcnt lgkmcnt(2)
ds_read_b32 a162, v61
v_mfma_f32_16x16x32_bf16 v[160:163], a[248:251], a[128:131], v[160:163]
ds_read_b128 a[224:227], v16 offset:8192
v_perm_b32 v60, v52, v19, s53
v_mfma_f32_16x16x32_bf16 v[160:163], a[252:255], a[144:147], v[160:163]
ds_read_b32 a163, v60
v_mfma_f32_16x16x32_bf16 v[164:167], a[252:255], a[148:151], v[164:167]
ds_read_b128 a[228:231], v17 offset:8192
v_perm_b32 v59, v48, v19, s54
v_mfma_f32_16x16x32_bf16 v[164:167], a[248:251], a[132:135], v[164:167]
ds_read_b32 a164, v59
v_perm_b32 v58, v48, v19, s55
v_mfma_f32_16x16x32_bf16 v[168:171], a[248:251], a[136:139], v[168:171]
ds_read_b32 a165, v58
v_perm_b32 v57, v52, v19, s54
v_mfma_f32_16x16x32_bf16 v[168:171], a[252:255], a[152:155], v[168:171]
ds_read_b32 a166, v57
v_perm_b32 v56, v52, v19, s55
v_mfma_f32_16x16x32_bf16 v[172:175], a[252:255], a[156:159], v[172:175]
ds_read_b32 a167, v56
v_perm_b32 v63, v49, v19, s52
v_mfma_f32_16x16x32_bf16 v[172:175], a[248:251], a[140:143], v[172:175]
s_waitcnt lgkmcnt(4)
ds_read_b32 a168, v63
v_mfma_f32_16x16x32_bf16 v[192:195], a[224:227], a[128:131], v[192:195]
ds_read_b128 a[232:235], v16 offset:12288
v_perm_b32 v62, v49, v19, s53
v_mfma_f32_16x16x32_bf16 v[192:195], a[228:231], a[144:147], v[192:195]
ds_read_b32 a169, v62
buffer_load_dwordx4 v[88:91], v12, s[24:27], 0 offen offset:2048 sc1
v_mfma_f32_16x16x32_bf16 v[196:199], a[228:231], a[148:151], v[196:199]
ds_read_b128 a[236:239], v17 offset:12288
v_perm_b32 v61, v53, v19, s52
v_mfma_f32_16x16x32_bf16 v[196:199], a[224:227], a[132:135], v[196:199]
s_add_u32 m0, s33, 85120
ds_read_b32 a170, v61
buffer_load_dwordx4 v[92:95], v12, s[24:27], 0 offen offset:3072 sc1
v_mfma_f32_16x16x32_bf16 v[200:203], a[224:227], a[136:139], v[200:203]
buffer_load_dwordx4 v9, s[20:23], 0 offen offset:896 lds
v_perm_b32 v60, v53, v19, s53
v_mfma_f32_16x16x32_bf16 v[200:203], a[228:231], a[152:155], v[200:203]
ds_read_b32 a171, v60
v_perm_b32 v59, v49, v19, s54
v_mfma_f32_16x16x32_bf16 v[204:207], a[228:231], a[156:159], v[204:207]
ds_read_b32 a172, v59
v_perm_b32 v58, v49, v19, s55
v_mfma_f32_16x16x32_bf16 v[204:207], a[224:227], a[140:143], v[204:207]
s_waitcnt lgkmcnt(3)
ds_read_b32 a173, v58
v_add_u32 v12, 28672, v13
v_mfma_f32_16x16x32_bf16 v[224:227], a[232:235], a[128:131], v[224:227]
ds_read_b128 a[240:243], v17 offset:2048
v_perm_b32 v57, v53, v19, s54
v_mfma_f32_16x16x32_bf16 v[224:227], a[236:239], a[144:147], v[224:227]
ds_read_b32 a174, v57
v_mfma_f32_16x16x32_bf16 v[228:231], a[236:239], a[148:151], v[228:231]
ds_read_b128 a[244:247], v16 offset:18432
v_perm_b32 v56, v53, v19, s55
v_mfma_f32_16x16x32_bf16 v[228:231], a[232:235], a[132:135], v[228:231]
s_add_u32 m0, s33, 89216
ds_read_b32 a175, v56
v_mfma_f32_16x16x32_bf16 v[232:235], a[232:235], a[136:139], v[232:235]
buffer_load_dwordx4 v10, s[20:23], 0 offen offset:896 lds
v_mfma_f32_16x16x32_bf16 v[232:235], a[236:239], a[152:155], v[232:235]
v_mfma_f32_16x16x32_bf16 v[236:239], a[236:239], a[156:159], v[236:239]
v_mfma_f32_16x16x32_bf16 v[236:239], a[232:235], a[140:143], v[236:239]
s_waitcnt vmcnt(10) lgkmcnt(1)
v_cmp_ne_u64 s[50:51], s[88:89], v[98:99]
v_mfma_f32_16x16x32_bf16 v[144:147], a[240:243], a[144:147], v[144:147]
s_barrier
ds_read_b128 a[248:251], v17 offset:6144
v_cmp_ne_u64 s[44:45], s[88:89], v[102:103]
v_mfma_f32_16x16x32_bf16 v[144:147], a[244:247], a[160:163], v[144:147]
v_mfma_f32_16x16x32_bf16 v[148:151], a[244:247], a[164:167], v[148:151]
s_or_b64 s[50:51], s[44:45], s[50:51]
ds_read_b128 a[252:255], v16 offset:22528
v_mfma_f32_16x16x32_bf16 v[148:151], a[240:243], a[148:151], v[148:151]
s_cbranch_scc1 L_SLOW11
L_BACK11:
v_mfma_f32_16x16x32_bf16 v[152:155], a[240:243], a[152:155], v[152:155]
v_perm_b32 v63, v96, v19, s52
v_mfma_f32_16x16x32_bf16 v[152:155], a[244:247], a[168:171], v[152:155]
s_waitcnt lgkmcnt(1)
ds_read_b32 a176, v63
v_perm_b32 v62, v96, v19, s53
v_mfma_f32_16x16x32_bf16 v[156:159], a[244:247], a[172:175], v[156:159]
ds_read_b32 a177, v62
v_perm_b32 v61, v100, v19, s52
v_mfma_f32_16x16x32_bf16 v[156:159], a[240:243], a[156:159], v[156:159]
s_waitcnt lgkmcnt(2)
ds_read_b32 a178, v61
v_mfma_f32_16x16x32_bf16 v[176:179], a[248:251], a[144:147], v[176:179]
ds_read_b128 a[224:227], v17 offset:10240
v_perm_b32 v60, v100, v19, s53
v_mfma_f32_16x16x32_bf16 v[176:179], a[252:255], a[160:163], v[176:179]
ds_read_b32 a179, v60
v_mfma_f32_16x16x32_bf16 v[180:183], a[252:255], a[164:167], v[180:183]
ds_read_b128 a[228:231], v16 offset:26624
v_perm_b32 v59, v96, v19, s54
v_mfma_f32_16x16x32_bf16 v[180:183], a[248:251], a[148:151], v[180:183]
s_add_u32 m0, s33, 93184
ds_read_b32 a180, v59
buffer_load_dwordx4 v[32:35], v12, s[24:27], 0 offen offset:0 sc1
v_mfma_f32_16x16x32_bf16 v[184:187], a[248:251], a[152:155], v[184:187]
buffer_load_dwordx4 v8, s[20:23], 0 offen offset:1024 lds
v_perm_b32 v58, v96, v19, s55
v_mfma_f32_16x16x32_bf16 v[184:187], a[252:255], a[168:171], v[184:187]
ds_read_b32 a181, v58
v_perm_b32 v57, v100, v19, s54
v_mfma_f32_16x16x32_bf16 v[188:191], a[252:255], a[172:175], v[188:191]
ds_read_b32 a182, v57
v_perm_b32 v56, v100, v19, s55
v_mfma_f32_16x16x32_bf16 v[188:191], a[248:251], a[156:159], v[188:191]
s_waitcnt lgkmcnt(3)
ds_read_b32 a183, v56
buffer_load_dwordx4 v[36:39], v12, s[24:27], 0 offen offset:1024 sc1
v_mfma_f32_16x16x32_bf16 v[208:211], a[224:227], a[144:147], v[208:211]
ds_read_b128 a[232:235], v17 offset:14336
v_perm_b32 v63, v97, v19, s52
v_mfma_f32_16x16x32_bf16 v[208:211], a[228:231], a[160:163], v[208:211]
ds_read_b32 a184, v63
v_mfma_f32_16x16x32_bf16 v[212:215], a[228:231], a[164:167], v[212:215]
ds_read_b128 a[236:239], v16 offset:30720
v_perm_b32 v62, v97, v19, s53
v_mfma_f32_16x16x32_bf16 v[212:215], a[224:227], a[148:151], v[212:215]
ds_read_b32 a185, v62
v_perm_b32 v61, v101, v19, s52
v_mfma_f32_16x16x32_bf16 v[216:219], a[224:227], a[152:155], v[216:219]
ds_read_b32 a186, v61
v_perm_b32 v60, v101, v19, s53
v_mfma_f32_16x16x32_bf16 v[216:219], a[228:231], a[168:171], v[216:219]
ds_read_b32 a187, v60
v_perm_b32 v59, v97, v19, s54
v_mfma_f32_16x16x32_bf16 v[220:223], a[228:231], a[172:175], v[220:223]
s_add_u32 m0, s33, 97280
ds_read_b32 a188, v59
v_perm_b32 v58, v97, v19, s55
v_mfma_f32_16x16x32_bf16 v[220:223], a[224:227], a[156:159], v[220:223]
s_waitcnt lgkmcnt(4)
ds_read_b32 a189, v58
v_perm_b32 v57, v101, v19, s54
v_mfma_f32_16x16x32_bf16 v[240:243], a[232:235], a[144:147], v[240:243]
ds_read_b128 a[240:243], v16 offset:16384
buffer_load_dwordx4 v9, s[20:23], 0 offen offset:1024 lds
v_mfma_f32_16x16x32_bf16 v[240:243], a[236:239], a[160:163], v[240:243]
ds_read_b32 a190, v57
v_mfma_f32_16x16x32_bf16 v[244:247], a[236:239], a[164:167], v[244:247]
ds_read_b128 a[244:247], v17 offset:16384
v_perm_b32 v56, v101, v19, s55
v_mfma_f32_16x16x32_bf16 v[244:247], a[232:235], a[148:151], v[244:247]
ds_read_b32 a191, v56
v_mfma_f32_16x16x32_bf16 v[248:251], a[232:235], a[152:155], v[248:251]
v_mfma_f32_16x16x32_bf16 v[248:251], a[236:239], a[168:171], v[248:251]
v_mfma_f32_16x16x32_bf16 v[252:255], a[236:239], a[172:175], v[252:255]
s_waitcnt vmcnt(9)
v_cmp_ne_u64 s[50:51], s[88:89], v[82:83]
v_cmp_ne_u64 s[44:45], s[88:89], v[86:87]
v_mfma_f32_16x16x32_bf16 v[252:255], a[232:235], a[156:159], v[252:255]
L_PAD2:
s_cbranch_vccnz L_PADRET
s_waitcnt lgkmcnt(1)
v_mfma_f32_16x16x32_bf16 v[128:131], a[240:243], a[160:163], v[128:131]
s_or_b64 s[50:51], s[44:45], s[50:51]
ds_read_b128 a[248:251], v16 offset:20480
v_mfma_f32_16x16x32_bf16 v[128:131], a[244:247], a[176:179], v[128:131]
s_cbranch_scc1 L_SLOW12
L_BACK12:
v_mfma_f32_16x16x32_bf16 v[132:135], a[244:247], a[180:183], v[132:135]
ds_read_b128 a[252:255], v17 offset:20480
v_mfma_f32_16x16x32_bf16 v[132:135], a[240:243], a[164:167], v[132:135]
s_add_u32 m0, s33, 101504
v_mfma_f32_16x16x32_bf16 v[136:139], a[240:243], a[168:171], v[136:139]
buffer_load_dwordx4 v11, s[20:23], 0 offen offset:896 lds
v_mfma_f32_16x16x32_bf16 v[136:139], a[244:247], a[184:187], v[136:139]
s_waitcnt lgkmcnt(1)
buffer_load_dwordx4 v[40:43], v12, s[24:27], 0 offen offset:2048 sc1
v_perm_b32 v63, v80, v19, s52
v_mfma_f32_16x16x32_bf16 v[140:143], a[244:247], a[188:191], v[140:143]
ds_read_b32 a192, v63
v_perm_b32 v62, v80, v19, s53
v_mfma_f32_16x16x32_bf16 v[140:143], a[240:243], a[172:175], v[140:143]
s_waitcnt lgkmcnt(1)
ds_read_b32 a193, v62
buffer_load_dwordx4 v[44:47], v12, s[24:27], 0 offen offset:3072 sc1
v_mfma_f32_16x16x32_bf16 v[160:163], a[248:251], a[160:163], v[160:163]
ds_read_b128 a[224:227], v16 offset:24576
v_perm_b32 v61, v84, v19, s52
v_mfma_f32_16x16x32_bf16 v[160:163], a[252:255], a[176:179], v[160:163]
ds_read_b32 a194, v61
v_add_u32 v12, 32768, v13
v_mfma_f32_16x16x32_bf16 v[164:167], a[252:255], a[180:183], v[164:167]
ds_read_b128 a[228:231], v17 offset:24576
v_perm_b32 v60, v84, v19, s53
v_mfma_f32_16x16x32_bf16 v[164:167], a[248:251], a[164:167], v[164:167]
ds_read_b32 a195, v60
v_perm_b32 v59, v80, v19, s54
v_mfma_f32_16x16x32_bf16 v[168:171], a[248:251], a[168:171], v[168:171]
ds_read_b32 a196, v59
v_perm_b32 v58, v80, v19, s55
v_mfma_f32_16x16x32_bf16 v[168:171], a[252:255], a[184:187], v[168:171]
ds_read_b32 a197, v58
v_perm_b32 v57, v84, v19, s54
v_mfma_f32_16x16x32_bf16 v[172:175], a[252:255], a[188:191], v[172:175]
ds_read_b32 a198, v57
v_perm_b32 v56, v84, v19, s55
v_mfma_f32_16x16x32_bf16 v[172:175], a[248:251], a[172:175], v[172:175]
s_waitcnt lgkmcnt(4)
ds_read_b32 a199, v56
v_mfma_f32_16x16x32_bf16 v[192:195], a[224:227], a[160:163], v[192:195]
ds_read_b128 a[232:235], v16 offset:28672
v_perm_b32 v63, v81, v19, s52
v_mfma_f32_16x16x32_bf16 v[192:195], a[228:231], a[176:179], v[192:195]
ds_read_b32 a200, v63
v_mfma_f32_16x16x32_bf16 v[196:199], a[228:231], a[180:183], v[196:199]
ds_read_b128 a[236:239], v17 offset:28672
v_perm_b32 v62, v81, v19, s53
v_mfma_f32_16x16x32_bf16 v[196:199], a[224:227], a[164:167], v[196:199]
ds_read_b32 a201, v62
v_perm_b32 v61, v85, v19, s52
v_mfma_f32_16x16x32_bf16 v[200:203], a[224:227], a[168:171], v[200:203]
ds_read_b32 a202, v61
v_perm_b32 v60, v85, v19, s53
v_mfma_f32_16x16x32_bf16 v[200:203], a[228:231], a[184:187], v[200:203]
ds_read_b32 a203, v60
v_perm_b32 v59, v81, v19, s54
v_mfma_f32_16x16x32_bf16 v[204:207], a[228:231], a[188:191], v[204:207]
ds_read_b32 a204, v59
v_perm_b32 v58, v81, v19, s55
v_mfma_f32_16x16x32_bf16 v[204:207], a[224:227], a[172:175], v[204:207]
s_waitcnt lgkmcnt(4)
ds_read_b32 a205, v58
v_mfma_f32_16x16x32_bf16 v[224:227], a[232:235], a[160:163], v[224:227]
ds_read_b128 a[240:243], v17 offset:18432
v_perm_b32 v57, v85, v19, s54
v_mfma_f32_16x16x32_bf16 v[224:227], a[236:239], a[176:179], v[224:227]
ds_read_b32 a206, v57
v_mfma_f32_16x16x32_bf16 v[228:231], a[236:239], a[180:183], v[228:231]
ds_read_b128 a[244:247], v14 offset:2048
v_perm_b32 v56, v85, v19, s55
v_mfma_f32_16x16x32_bf16 v[228:231], a[232:235], a[164:167], v[228:231]
ds_read_b32 a207, v56
v_mfma_f32_16x16x32_bf16 v[232:235], a[232:235], a[168:171], v[232:235]
s_waitcnt vmcnt(9)
v_cmp_ne_u64 s[50:51], s[88:89], v[90:91]
v_cmp_ne_u64 s[44:45], s[88:89], v[94:95]
v_mfma_f32_16x16x32_bf16 v[232:235], a[236:239], a[184:187], v[232:235]
buffer_load_dwordx4 v[48:51], v12, s[24:27], 0 offen offset:0 sc1
v_mfma_f32_16x16x32_bf16 v[236:239], a[236:239], a[188:191], v[236:239]
s_or_b64 s[50:51], s[44:45], s[50:51]
buffer_load_dwordx4 v[52:55], v12, s[24:27], 0 offen offset:1024 sc1
v_mfma_f32_16x16x32_bf16 v[236:239], a[232:235], a[172:175], v[236:239]
s_waitcnt lgkmcnt(1)
v_mfma_f32_16x16x32_bf16 v[144:147], a[240:243], a[176:179], v[144:147]
s_barrier
ds_read_b128 a[248:251], v17 offset:22528
v_mfma_f32_16x16x32_bf16 v[144:147], a[244:247], a[192:195], v[144:147]
s_cbranch_scc1 L_SLOW13
L_BACK13:
v_mfma_f32_16x16x32_bf16 v[148:151], a[244:247], a[196:199], v[148:151]
ds_read_b128 a[252:255], v14 offset:6144
v_perm_b32 v63, v88, v19, s52
v_mfma_f32_16x16x32_bf16 v[148:151], a[240:243], a[180:183], v[148:151]
ds_read_b32 a208, v63
v_perm_b32 v62, v88, v19, s53
v_mfma_f32_16x16x32_bf16 v[152:155], a[240:243], a[184:187], v[152:155]
ds_read_b32 a209, v62
v_perm_b32 v61, v92, v19, s52
v_mfma_f32_16x16x32_bf16 v[152:155], a[244:247], a[200:203], v[152:155]
s_waitcnt lgkmcnt(3)
ds_read_b32 a210, v61
v_perm_b32 v60, v92, v19, s53
v_mfma_f32_16x16x32_bf16 v[156:159], a[244:247], a[204:207], v[156:159]
ds_read_b32 a211, v60
v_perm_b32 v59, v88, v19, s54
v_mfma_f32_16x16x32_bf16 v[156:159], a[240:243], a[188:191], v[156:159]
s_waitcnt lgkmcnt(4)
ds_read_b32 a212, v59
v_mfma_f32_16x16x32_bf16 v[176:179], a[248:251], a[176:179], v[176:179]
ds_read_b128 a[224:227], v17 offset:26624
v_perm_b32 v58, v88, v19, s55
v_mfma_f32_16x16x32_bf16 v[176:179], a[252:255], a[192:195], v[176:179]
ds_read_b32 a213, v58
v_mfma_f32_16x16x32_bf16 v[180:183], a[252:255], a[196:199], v[180:183]
ds_read_b128 a[228:231], v14 offset:10240
v_perm_b32 v57, v92, v19, s54
v_mfma_f32_16x16x32_bf16 v[180:183], a[248:251], a[180:183], v[180:183]
s_add_u32 m0, s33, 105472
ds_read_b32 a214, v57
v_mfma_f32_16x16x32_bf16 v[184:187], a[248:251], a[184:187], v[184:187]
buffer_load_dwordx4 v10, s[20:23], 0 offen offset:1024 lds
v_perm_b32 v56, v92, v19, s55
v_mfma_f32_16x16x32_bf16 v[184:187], a[252:255], a[200:203], v[184:187]
ds_read_b32 a215, v56
v_perm_b32 v63, v89, v19, s52
v_mfma_f32_16x16x32_bf16 v[188:191], a[252:255], a[204:207], v[188:191]
ds_read_b32 a216, v63
v_perm_b32 v62, v89, v19, s53
v_mfma_f32_16x16x32_bf16 v[188:191], a[248:251], a[188:191], v[188:191]
s_waitcnt lgkmcnt(3)
ds_read_b32 a217, v62
v_mfma_f32_16x16x32_bf16 v[208:211], a[224:227], a[176:179], v[208:211]
ds_read_b128 a[232:235], v17 offset:30720
v_perm_b32 v61, v93, v19, s52
v_mfma_f32_16x16x32_bf16 v[208:211], a[228:231], a[192:195], v[208:211]
ds_read_b32 a218, v61
v_mfma_f32_16x16x32_bf16 v[212:215], a[228:231], a[196:199], v[212:215]
ds_read_b128 a[236:239], v14 offset:14336
v_perm_b32 v60, v93, v19, s53
v_mfma_f32_16x16x32_bf16 v[212:215], a[224:227], a[180:183], v[212:215]
ds_read_b32 a219, v60
v_perm_b32 v59, v89, v19, s54
v_mfma_f32_16x16x32_bf16 v[216:219], a[224:227], a[184:187], v[216:219]
ds_read_b32 a220, v59
v_perm_b32 v58, v89, v19, s55
v_mfma_f32_16x16x32_bf16 v[216:219], a[228:231], a[200:203], v[216:219]
ds_read_b32 a221, v58
v_perm_b32 v57, v93, v19, s54
v_mfma_f32_16x16x32_bf16 v[220:223], a[228:231], a[204:207], v[220:223]
s_add_u32 m0, s33, 109440
ds_read_b32 a222, v57
v_perm_b32 v56, v93, v19, s55
v_mfma_f32_16x16x32_bf16 v[220:223], a[224:227], a[188:191], v[220:223]
s_waitcnt vmcnt(7) lgkmcnt(4)
v_cmp_ne_u64 s[50:51], s[88:89], v[34:35]
v_cmp_ne_u64 s[44:45], s[88:89], v[38:39]
v_mfma_f32_16x16x32_bf16 v[240:243], a[232:235], a[176:179], v[240:243]
ds_read_b128 a[240:243], v14 offset:0
buffer_load_dwordx4 v8, s[20:23], 0 offen offset:1152 lds
v_mfma_f32_16x16x32_bf16 v[240:243], a[236:239], a[192:195], v[240:243]
ds_read_b32 a223, v56
buffer_load_dwordx4 v[96:99], v12, s[24:27], 0 offen offset:2048 sc1
v_mfma_f32_16x16x32_bf16 v[244:247], a[236:239], a[196:199], v[244:247]
s_or_b64 s[50:51], s[44:45], s[50:51]
ds_read_b128 a[244:247], v15 offset:0
buffer_load_dwordx4 v[100:103], v12, s[24:27], 0 offen offset:3072 sc1
v_mfma_f32_16x16x32_bf16 v[244:247], a[232:235], a[180:183], v[244:247]
s_cbranch_scc1 L_SLOW14
L_BACK14:
v_mfma_f32_16x16x32_bf16 v[248:251], a[232:235], a[184:187], v[248:251]
v_perm_b32 v63, v32, v19, s52
v_add_u32 v12, 36864, v13
v_mfma_f32_16x16x32_bf16 v[248:251], a[236:239], a[200:203], v[248:251]
ds_read_b32 a0, v63
v_perm_b32 v62, v32, v19, s53
v_mfma_f32_16x16x32_bf16 v[252:255], a[236:239], a[204:207], v[252:255]
ds_read_b32 a1, v62
v_perm_b32 v61, v36, v19, s52
v_mfma_f32_16x16x32_bf16 v[252:255], a[232:235], a[188:191], v[252:255]
s_waitcnt lgkmcnt(2)
ds_read_b32 a2, v61
v_mfma_f32_16x16x32_bf16 v[128:131], a[240:243], a[192:195], v[128:131]
ds_read_b128 a[248:251], v14 offset:4096
v_perm_b32 v60, v36, v19, s53
v_mfma_f32_16x16x32_bf16 v[128:131], a[244:247], a[208:211], v[128:131]
ds_read_b32 a3, v60
v_mfma_f32_16x16x32_bf16 v[132:135], a[244:247], a[212:215], v[132:135]
ds_read_b128 a[252:255], v15 offset:4096
v_perm_b32 v59, v32, v19, s54
v_mfma_f32_16x16x32_bf16 v[132:135], a[240:243], a[196:199], v[132:135]
s_add_u32 m0, s33, 113536
ds_read_b32 a4, v59
v_mfma_f32_16x16x32_bf16 v[136:139], a[240:243], a[200:203], v[136:139]
buffer_load_dwordx4 v9, s[20:23], 0 offen offset:1152 lds
v_perm_b32 v58, v32, v19, s55
v_mfma_f32_16x16x32_bf16 v[136:139], a[244:247], a[216:219], v[136:139]
ds_read_b32 a5, v58
v_perm_b32 v57, v36, v19, s54
v_mfma_f32_16x16x32_bf16 v[140:143], a[244:247], a[220:223], v[140:143]
ds_read_b32 a6, v57
v_perm_b32 v56, v36, v19, s55
v_mfma_f32_16x16x32_bf16 v[140:143], a[240:243], a[204:207], v[140:143]
s_waitcnt lgkmcnt(3)
ds_read_b32 a7, v56
v_mfma_f32_16x16x32_bf16 v[160:163], a[248:251], a[192:195], v[160:163]
ds_read_b128 a[224:227], v14 offset:8192
v_perm_b32 v63, v33, v19, s52
v_mfma_f32_16x16x32_bf16 v[160:163], a[252:255], a[208:211], v[160:163]
ds_read_b32 a8, v63
v_mfma_f32_16x16x32_bf16 v[164:167], a[252:255], a[212:215], v[164:167]
ds_read_b128 a[228:231], v15 offset:8192
v_perm_b32 v62, v33, v19, s53
v_mfma_f32_16x16x32_bf16 v[164:167], a[248:251], a[196:199], v[164:167]
ds_read_b32 a9, v62
v_perm_b32 v61, v37, v19, s52
v_mfma_f32_16x16x32_bf16 v[168:171], a[248:251], a[200:203], v[168:171]
ds_read_b32 a10, v61
v_perm_b32 v60, v37, v19, s53
v_mfma_f32_16x16x32_bf16 v[168:171], a[252:255], a[216:219], v[168:171]
ds_read_b32 a11, v60
v_perm_b32 v59, v33, v19, s54
v_mfma_f32_16x16x32_bf16 v[172:175], a[252:255], a[220:223], v[172:175]
ds_read_b32 a12, v59
v_perm_b32 v58, v33, v19, s55
v_mfma_f32_16x16x32_bf16 v[172:175], a[248:251], a[204:207], v[172:175]
s_waitcnt lgkmcnt(4)
ds_read_b32 a13, v58
buffer_load_dwordx4 v[80:83], v12, s[24:27], 0 offen offset:0 sc1
v_mfma_f32_16x16x32_bf16 v[192:195], a[224:227], a[192:195], v[192:195]
ds_read_b128 a[232:235], v14 offset:12288
buffer_load_dwordx4 v[84:87], v12, s[24:27], 0 offen offset:1024 sc1
v_mfma_f32_16x16x32_bf16 v[192:195], a[228:231], a[208:211], v[192:195]
s_waitcnt vmcnt(9)
v_cmp_ne_u64 s[50:51], s[88:89], v[42:43]
v_cmp_ne_u64 s[44:45], s[88:89], v[46:47]
v_mfma_f32_16x16x32_bf16 v[196:199], a[228:231], a[212:215], v[196:199]
ds_read_b128 a[236:239], v15 offset:12288
v_perm_b32 v57, v37, v19, s54
v_mfma_f32_16x16x32_bf16 v[196:199], a[224:227], a[196:199], v[196:199]
s_or_b64 s[50:51], s[44:45], s[50:51]
ds_read_b32 a14, v57
v_perm_b32 v56, v37, v19, s55
v_mfma_f32_16x16x32_bf16 v[200:203], a[224:227], a[200:203], v[200:203]
s_cbranch_scc1 L_SLOW15
L_BACK15:
v_mfma_f32_16x16x32_bf16 v[200:203], a[228:231], a[216:219], v[200:203]
ds_read_b32 a15, v56
v_perm_b32 v63, v40, v19, s52
v_mfma_f32_16x16x32_bf16 v[204:207], a[228:231], a[220:223], v[204:207]
ds_read_b32 a16, v63
v_perm_b32 v62, v40, v19, s53
v_mfma_f32_16x16x32_bf16 v[204:207], a[224:227], a[204:207], v[204:207]
s_waitcnt lgkmcnt(3)
ds_read_b32 a17, v62
v_mfma_f32_16x16x32_bf16 v[224:227], a[232:235], a[192:195], v[224:227]
ds_read_b128 a[240:243], v15 offset:2048
v_perm_b32 v61, v44, v19, s52
v_mfma_f32_16x16x32_bf16 v[224:227], a[236:239], a[208:211], v[224:227]
ds_read_b32 a18, v61
v_mfma_f32_16x16x32_bf16 v[228:231], a[236:239], a[212:215], v[228:231]
ds_read_b128 a[244:247], v14 offset:18432
v_perm_b32 v60, v44, v19, s53
v_mfma_f32_16x16x32_bf16 v[228:231], a[232:235], a[196:199], v[228:231]
s_add_u32 m0, s33, 117760
ds_read_b32 a19, v60
v_mfma_f32_16x16x32_bf16 v[232:235], a[232:235], a[200:203], v[232:235]
buffer_load_dwordx4 v11, s[20:23], 0 offen offset:1024 lds
v_perm_b32 v59, v40, v19, s54
v_mfma_f32_16x16x32_bf16 v[232:235], a[236:239], a[216:219], v[232:235]
ds_read_b32 a20, v59
v_perm_b32 v58, v40, v19, s55
v_mfma_f32_16x16x32_bf16 v[236:239], a[236:239], a[220:223], v[236:239]
ds_read_b32 a21, v58
v_perm_b32 v57, v44, v19, s54
v_mfma_f32_16x16x32_bf16 v[236:239], a[232:235], a[204:207], v[236:239]
s_waitcnt lgkmcnt(3)
ds_read_b32 a22, v57
v_mfma_f32_16x16x32_bf16 v[144:147], a[240:243], a[208:211], v[144:147]
s_barrier
ds_read_b128 a[248:251], v15 offset:6144
v_perm_b32 v56, v44, v19, s55
v_mfma_f32_16x16x32_bf16 v[144:147], a[244:247], a[0:3], v[144:147]
ds_read_b32 a23, v56
v_mfma_f32_16x16x32_bf16 v[148:151], a[244:247], a[4:7], v[148:151]
ds_read_b128 a[252:255], v14 offset:22528
v_perm_b32 v63, v41, v19, s52
v_mfma_f32_16x16x32_bf16 v[148:151], a[240:243], a[212:215], v[148:151]
ds_read_b32 a24, v63
v_perm_b32 v62, v41, v19, s53
v_mfma_f32_16x16x32_bf16 v[152:155], a[240:243], a[216:219], v[152:155]
ds_read_b32 a25, v62
v_perm_b32 v61, v45, v19, s52
v_mfma_f32_16x16x32_bf16 v[152:155], a[244:247], a[8:11], v[152:155]
ds_read_b32 a26, v61
v_perm_b32 v60, v45, v19, s53
v_mfma_f32_16x16x32_bf16 v[156:159], a[244:247], a[12:15], v[156:159]
ds_read_b32 a27, v60
v_perm_b32 v59, v41, v19, s54
v_mfma_f32_16x16x32_bf16 v[156:159], a[240:243], a[220:223], v[156:159]
s_waitcnt lgkmcnt(4)
ds_read_b32 a28, v59
v_mfma_f32_16x16x32_bf16 v[176:179], a[248:251], a[208:211], v[176:179]
ds_read_b128 a[224:227], v15 offset:10240
v_perm_b32 v58, v41, v19, s55
v_mfma_f32_16x16x32_bf16 v[176:179], a[252:255], a[0:3], v[176:179]
s_waitcnt vmcnt(8)
ds_read_b32 a29, v58
v_cmp_ne_u64 s[50:51], s[88:89], v[50:51]
v_mfma_f32_16x16x32_bf16 v[180:183], a[252:255], a[4:7], v[180:183]
ds_read_b128 a[228:231], v14 offset:26624
v_cmp_ne_u64 s[44:45], s[88:89], v[54:55]
v_mfma_f32_16x16x32_bf16 v[180:183], a[248:251], a[212:215], v[180:183]
s_add_u32 m0, s33, 121728
v_perm_b32 v57, v45, v19, s54
v_perm_b32 v56, v45, v19, s55
v_mfma_f32_16x16x32_bf16 v[184:187], a[248:251], a[216:219], v[184:187]
s_or_b64 s[50:51], s[44:45], s[50:51]
ds_read_b32 a30, v57
buffer_load_dwordx4 v10, s[20:23], 0 offen offset:1152 lds
v_mfma_f32_16x16x32_bf16 v[184:187], a[252:255], a[8:11], v[184:187]
s_cbranch_scc1 L_SLOW16
L_BACK16:
v_mfma_f32_16x16x32_bf16 v[188:191], a[252:255], a[12:15], v[188:191]
ds_read_b32 a31, v56
v_perm_b32 v63, v48, v19, s52
v_mfma_f32_16x16x32_bf16 v[188:191], a[248:251], a[220:223], v[188:191]
s_waitcnt lgkmcnt(2)
ds_read_b32 a32, v63
buffer_load_dwordx4 v[88:91], v12, s[24:27], 0 offen offset:2048 sc1
v_mfma_f32_16x16x32_bf16 v[208:211], a[224:227], a[208:211], v[208:211]
ds_read_b128 a[232:235], v14 offset:16384
v_perm_b32 v62, v48, v19, s53
v_mfma_f32_16x16x32_bf16 v[208:211], a[228:231], a[0:3], v[208:211]
ds_read_b32 a33, v62
buffer_load_dwordx4 v[92:95], v12, s[24:27], 0 offen offset:3072 sc1
v_mfma_f32_16x16x32_bf16 v[212:215], a[228:231], a[4:7], v[212:215]
ds_read_b128 a[236:239], v15 offset:16384
v_perm_b32 v61, v52, v19, s52
v_mfma_f32_16x16x32_bf16 v[212:215], a[224:227], a[212:215], v[212:215]
ds_read_b32 a34, v61
v_perm_b32 v60, v52, v19, s53
v_mfma_f32_16x16x32_bf16 v[216:219], a[224:227], a[216:219], v[216:219]
ds_read_b32 a35, v60
v_perm_b32 v59, v48, v19, s54
v_mfma_f32_16x16x32_bf16 v[216:219], a[228:231], a[8:11], v[216:219]
ds_read_b32 a36, v59
v_perm_b32 v58, v48, v19, s55
v_mfma_f32_16x16x32_bf16 v[220:223], a[228:231], a[12:15], v[220:223]
s_add_u32 m0, s33, 125696
ds_read_b32 a37, v58
v_perm_b32 v57, v52, v19, s54
v_mfma_f32_16x16x32_bf16 v[220:223], a[224:227], a[220:223], v[220:223]
s_waitcnt lgkmcnt(4)
ds_read_b32 a38, v57
v_perm_b32 v56, v52, v19, s55
v_mfma_f32_16x16x32_bf16 v[128:131], a[232:235], a[0:3], v[128:131]
ds_read_b128 a[240:243], v14 offset:20480
buffer_load_dwordx4 v8, s[20:23], 0 offen offset:1280 lds
v_mfma_f32_16x16x32_bf16 v[128:131], a[236:239], a[16:19], v[128:131]
ds_read_b32 a39, v56
v_add_u32 v12, 40960, v13
v_mfma_f32_16x16x32_bf16 v[132:135], a[236:239], a[20:23], v[132:135]
ds_read_b128 a[244:247], v15 offset:20480
v_perm_b32 v63, v49, v19, s52
v_mfma_f32_16x16x32_bf16 v[132:135], a[232:235], a[4:7], v[132:135]
ds_read_b32 a40, v63
v_perm_b32 v62, v49, v19, s53
v_mfma_f32_16x16x32_bf16 v[136:139], a[232:235], a[8:11], v[136:139]
ds_read_b32 a41, v62
v_perm_b32 v61, v53, v19, s52
v_mfma_f32_16x16x32_bf16 v[136:139], a[236:239], a[24:27], v[136:139]
ds_read_b32 a42, v61
v_perm_b32 v60, v53, v19, s53
v_mfma_f32_16x16x32_bf16 v[140:143], a[236:239], a[28:31], v[140:143]
ds_read_b32 a43, v60
v_perm_b32 v59, v49, v19, s54
v_mfma_f32_16x16x32_bf16 v[140:143], a[232:235], a[12:15], v[140:143]
s_waitcnt lgkmcnt(4)
ds_read_b32 a44, v59
v_mfma_f32_16x16x32_bf16 v[160:163], a[240:243], a[0:3], v[160:163]
ds_read_b128 a[248:251], v14 offset:24576
v_perm_b32 v58, v49, v19, s55
v_mfma_f32_16x16x32_bf16 v[160:163], a[244:247], a[16:19], v[160:163]
ds_read_b32 a45, v58
v_mfma_f32_16x16x32_bf16 v[164:167], a[244:247], a[20:23], v[164:167]
ds_read_b128 a[252:255], v15 offset:24576
buffer_load_dwordx4 v[32:35], v12, s[24:27], 0 offen offset:0 sc1
v_mfma_f32_16x16x32_bf16 v[164:167], a[240:243], a[4:7], v[164:167]
s_waitcnt vmcnt(9)
s_add_u32 m0, s33, 129792
v_cmp_ne_u64 s[50:51], s[88:89], v[98:99]
v_cmp_ne_u64 s[44:45], s[88:89], v[102:103]
v_mfma_f32_16x16x32_bf16 v[168:171], a[240:243], a[8:11], v[168:171]
buffer_load_dwordx4 v9, s[20:23], 0 offen offset:1280 lds
v_perm_b32 v57, v53, v19, s54
v_mfma_f32_16x16x32_bf16 v[168:171], a[244:247], a[24:27], v[168:171]
s_or_b64 s[50:51], s[44:45], s[50:51]
ds_read_b32 a46, v57
v_perm_b32 v56, v53, v19, s55
v_mfma_f32_16x16x32_bf16 v[172:175], a[244:247], a[28:31], v[172:175]
s_cbranch_scc1 L_SLOW17
L_BACK17:
v_mfma_f32_16x16x32_bf16 v[172:175], a[240:243], a[12:15], v[172:175]
s_waitcnt lgkmcnt(1)
ds_read_b32 a47, v56
buffer_load_dwordx4 v[36:39], v12, s[24:27], 0 offen offset:1024 sc1
v_mfma_f32_16x16x32_bf16 v[192:195], a[248:251], a[0:3], v[192:195]
ds_read_b128 a[224:227], v15 offset:18432
v_perm_b32 v63, v96, v19, s52
v_mfma_f32_16x16x32_bf16 v[192:195], a[252:255], a[16:19], v[192:195]
ds_read_b32 a48, v63
v_mfma_f32_16x16x32_bf16 v[196:199], a[252:255], a[20:23], v[196:199]
ds_read_b128 a[228:231], v14 offset:30720
v_perm_b32 v62, v96, v19, s53
v_mfma_f32_16x16x32_bf16 v[196:199], a[248:251], a[4:7], v[196:199]
ds_read_b32 a49, v62
v_perm_b32 v61, v100, v19, s52
v_mfma_f32_16x16x32_bf16 v[200:203], a[248:251], a[8:11], v[200:203]
ds_read_b32 a50, v61
v_perm_b32 v60, v100, v19, s53
v_mfma_f32_16x16x32_bf16 v[200:203], a[252:255], a[24:27], v[200:203]
ds_read_b32 a51, v60
v_perm_b32 v59, v96, v19, s54
v_mfma_f32_16x16x32_bf16 v[204:207], a[252:255], a[28:31], v[204:207]
ds_read_b32 a52, v59
v_perm_b32 v58, v96, v19, s55
v_mfma_f32_16x16x32_bf16 v[204:207], a[248:251], a[12:15], v[204:207]
s_waitcnt lgkmcnt(4)
ds_read_b32 a53, v58
v_mfma_f32_16x16x32_bf16 v[144:147], a[224:227], a[16:19], v[144:147]
ds_read_b128 a[232:235], v15 offset:22528
v_perm_b32 v57, v100, v19, s54
v_mfma_f32_16x16x32_bf16 v[144:147], a[228:231], a[32:35], v[144:147]
ds_read_b32 a54, v57
v_mfma_f32_16x16x32_bf16 v[148:151], a[228:231], a[36:39], v[148:151]
ds_read_b128 a[236:239], v14 offset:34816
v_perm_b32 v56, v100, v19, s55
v_mfma_f32_16x16x32_bf16 v[148:151], a[224:227], a[20:23], v[148:151]
ds_read_b32 a55, v56
v_perm_b32 v63, v97, v19, s52
v_mfma_f32_16x16x32_bf16 v[152:155], a[224:227], a[24:27], v[152:155]
ds_read_b32 a56, v63
v_perm_b32 v62, v97, v19, s53
v_mfma_f32_16x16x32_bf16 v[152:155], a[228:231], a[40:43], v[152:155]
ds_read_b32 a57, v62
v_perm_b32 v61, v101, v19, s52
v_mfma_f32_16x16x32_bf16 v[156:159], a[228:231], a[44:47], v[156:159]
ds_read_b32 a58, v61
v_perm_b32 v60, v101, v19, s53
v_mfma_f32_16x16x32_bf16 v[156:159], a[224:227], a[28:31], v[156:159]
s_waitcnt lgkmcnt(4)
ds_read_b32 a59, v60
v_mfma_f32_16x16x32_bf16 v[176:179], a[232:235], a[16:19], v[176:179]
ds_read_b128 a[240:243], v14 offset:36864
v_perm_b32 v59, v97, v19, s54
v_mfma_f32_16x16x32_bf16 v[176:179], a[236:239], a[32:35], v[176:179]
ds_read_b32 a60, v59
v_mfma_f32_16x16x32_bf16 v[180:183], a[236:239], a[36:39], v[180:183]
ds_read_b128 a[244:247], v15 offset:36864
v_mfma_f32_16x16x32_bf16 v[180:183], a[232:235], a[20:23], v[180:183]
s_waitcnt vmcnt(8)
s_add_u32 m0, s33, 133760
v_perm_b32 v58, v97, v19, s55
v_cmp_ne_u64 s[50:51], s[88:89], v[82:83]
v_mfma_f32_16x16x32_bf16 v[184:187], a[232:235], a[24:27], v[184:187]
buffer_load_dwordx4 v8, s[20:23], 0 offen offset:1408 lds
v_cmp_ne_u64 s[44:45], s[88:89], v[86:87]
v_mfma_f32_16x16x32_bf16 v[184:187], a[236:239], a[40:43], v[184:187]
ds_read_b32 a61, v58
v_perm_b32 v57, v101, v19, s54
v_mfma_f32_16x16x32_bf16 v[188:191], a[236:239], a[44:47], v[188:191]
s_or_b64 s[50:51], s[44:45], s[50:51]
ds_read_b32 a62, v57
v_perm_b32 v56, v101, v19, s55
v_mfma_f32_16x16x32_bf16 v[188:191], a[232:235], a[28:31], v[188:191]
s_waitcnt lgkmcnt(2)
ds_read_b32 a63, v56
buffer_load_dwordx4 v[40:43], v12, s[24:27], 0 offen offset:2048 sc1
v_mfma_f32_16x16x32_bf16 v[224:227], a[240:243], a[0:3], v[224:227]
s_barrier
ds_read_b128 a[248:251], v14 offset:28672
buffer_load_dwordx4 v[44:47], v12, s[24:27], 0 offen offset:3072 sc1
v_mfma_f32_16x16x32_bf16 v[224:227], a[244:247], a[16:19], v[224:227]
s_cbranch_scc1 L_SLOW18
L_BACK18:
v_mfma_f32_16x16x32_bf16 v[228:231], a[244:247], a[20:23], v[228:231]
ds_read_b128 a[252:255], v15 offset:28672
v_perm_b32 v63, v80, v19, s52
v_mfma_f32_16x16x32_bf16 v[228:231], a[240:243], a[4:7], v[228:231]
ds_read_b32 a64, v63
v_perm_b32 v62, v80, v19, s53
v_mfma_f32_16x16x32_bf16 v[232:235], a[240:243], a[8:11], v[232:235]
ds_read_b32 a65, v62
v_perm_b32 v61, v84, v19, s52
v_mfma_f32_16x16x32_bf16 v[232:235], a[244:247], a[24:27], v[232:235]
ds_read_b32 a66, v61
v_perm_b32 v60, v84, v19, s53
v_mfma_f32_16x16x32_bf16 v[236:239], a[244:247], a[28:31], v[236:239]
ds_read_b32 a67, v60
v_perm_b32 v59, v80, v19, s54
v_mfma_f32_16x16x32_bf16 v[236:239], a[240:243], a[12:15], v[236:239]
s_waitcnt lgkmcnt(4)
ds_read_b32 a68, v59
v_add_u32 v12, 45056, v13
v_mfma_f32_16x16x32_bf16 v[128:131], a[248:251], a[32:35], v[128:131]
ds_read_b128 a[224:227], v15 offset:14336
v_perm_b32 v58, v80, v19, s55
v_mfma_f32_16x16x32_bf16 v[128:131], a[252:255], a[48:51], v[128:131]
ds_read_b32 a69, v58
v_mfma_f32_16x16x32_bf16 v[132:135], a[252:255], a[52:55], v[132:135]
ds_read_b128 a[228:231], v14 offset:38912
v_perm_b32 v57, v84, v19, s54
v_mfma_f32_16x16x32_bf16 v[132:135], a[248:251], a[36:39], v[132:135]
s_add_u32 m0, s33, 138112
ds_read_b32 a70, v57
v_mfma_f32_16x16x32_bf16 v[136:139], a[248:251], a[40:43], v[136:139]
buffer_load_dwordx4 v11, s[20:23], 0 offen offset:1152 lds
v_perm_b32 v56, v84, v19, s55
v_mfma_f32_16x16x32_bf16 v[136:139], a[252:255], a[56:59], v[136:139]
ds_read_b32 a71, v56
v_perm_b32 v63, v81, v19, s52
v_mfma_f32_16x16x32_bf16 v[140:143], a[252:255], a[60:63], v[140:143]
ds_read_b32 a72, v63
v_perm_b32 v62, v81, v19, s53
v_mfma_f32_16x16x32_bf16 v[140:143], a[248:251], a[44:47], v[140:143]
s_waitcnt lgkmcnt(3)
ds_read_b32 a73, v62
v_mfma_f32_16x16x32_bf16 v[240:243], a[224:227], a[208:211], v[240:243]
ds_read_b128 a[232:235], v14 offset:32768
v_perm_b32 v61, v85, v19, s52
v_mfma_f32_16x16x32_bf16 v[240:243], a[228:231], a[0:3], v[240:243]
ds_read_b32 a74, v61
v_mfma_f32_16x16x32_bf16 v[244:247], a[228:231], a[4:7], v[244:247]
L_PAD3:
s_cbranch_vccnz L_PAD4
ds_read_b128 a[236:239], v15 offset:32768
v_perm_b32 v60, v85, v19, s53
v_mfma_f32_16x16x32_bf16 v[244:247], a[224:227], a[212:215], v[244:247]
ds_read_b32 a75, v60
v_perm_b32 v59, v81, v19, s54
v_mfma_f32_16x16x32_bf16 v[248:251], a[224:227], a[216:219], v[248:251]
ds_read_b32 a76, v59
v_perm_b32 v58, v81, v19, s55
v_mfma_f32_16x16x32_bf16 v[248:251], a[228:231], a[8:11], v[248:251]
ds_read_b32 a77, v58
v_perm_b32 v57, v85, v19, s54
v_mfma_f32_16x16x32_bf16 v[252:255], a[228:231], a[12:15], v[252:255]
s_waitcnt vmcnt(8)
s_add_u32 m0, s33, 142080
v_cmp_ne_u64 s[50:51], s[88:89], v[90:91]
v_cmp_ne_u64 s[44:45], s[88:89], v[94:95]
v_mfma_f32_16x16x32_bf16 v[252:255], a[224:227], a[220:223], v[252:255]
s_waitcnt lgkmcnt(3)
ds_read_b32 a78, v57
buffer_load_dwordx4 v[48:51], v12, s[24:27], 0 offen offset:0 sc1
v_mfma_f32_16x16x32_bf16 v[160:163], a[232:235], a[32:35], v[160:163]
s_or_b64 s[50:51], s[44:45], s[50:51]
ds_read_b128 a[240:243], v15 offset:26624
buffer_load_dwordx4 v10, s[20:23], 0 offen offset:1280 lds
v_mfma_f32_16x16x32_bf16 v[160:163], a[236:239], a[48:51], v[160:163]
s_cbranch_scc1 L_SLOW19
L_BACK19:
v_mfma_f32_16x16x32_bf16 v[164:167], a[236:239], a[52:55], v[164:167]
ds_read_b128 a[244:247], v14 offset:43008
v_perm_b32 v56, v85, v19, s55
v_mfma_f32_16x16x32_bf16 v[164:167], a[232:235], a[36:39], v[164:167]
ds_read_b32 a79, v56
v_perm_b32 v63, v88, v19, s52
v_mfma_f32_16x16x32_bf16 v[168:171], a[232:235], a[40:43], v[168:171]
ds_read_b32 a80, v63
v_perm_b32 v62, v88, v19, s53
v_mfma_f32_16x16x32_bf16 v[168:171], a[236:239], a[56:59], v[168:171]
ds_read_b32 a81, v62
v_perm_b32 v61, v92, v19, s52
v_mfma_f32_16x16x32_bf16 v[172:175], a[236:239], a[60:63], v[172:175]
ds_read_b32 a82, v61
v_perm_b32 v60, v92, v19, s53
v_mfma_f32_16x16x32_bf16 v[172:175], a[232:235], a[44:47], v[172:175]
s_waitcnt lgkmcnt(4)
ds_read_b32 a83, v60
buffer_load_dwordx4 v[52:55], v12, s[24:27], 0 offen offset:1024 sc1
v_mfma_f32_16x16x32_bf16 v[208:211], a[240:243], a[16:19], v[208:211]
ds_read_b128 a[248:251], v14 offset:40960
v_perm_b32 v59, v88, v19, s54
v_mfma_f32_16x16x32_bf16 v[208:211], a[244:247], a[32:35], v[208:211]
ds_read_b32 a84, v59
v_mfma_f32_16x16x32_bf16 v[212:215], a[244:247], a[36:39], v[212:215]
ds_read_b128 a[252:255], v15 offset:40960
v_perm_b32 v58, v88, v19, s55
v_mfma_f32_16x16x32_bf16 v[212:215], a[240:243], a[20:23], v[212:215]
s_add_u32 m0, s33, 146048
ds_read_b32 a85, v58
v_mfma_f32_16x16x32_bf16 v[216:219], a[240:243], a[24:27], v[216:219]
buffer_load_dwordx4 v9, s[20:23], 0 offen offset:1408 lds
v_perm_b32 v57, v92, v19, s54
v_mfma_f32_16x16x32_bf16 v[216:219], a[244:247], a[40:43], v[216:219]
ds_read_b32 a86, v57
v_perm_b32 v56, v92, v19, s55
v_mfma_f32_16x16x32_bf16 v[220:223], a[244:247], a[44:47], v[220:223]
ds_read_b32 a87, v56
v_perm_b32 v63, v89, v19, s52
v_mfma_f32_16x16x32_bf16 v[220:223], a[240:243], a[28:31], v[220:223]
s_waitcnt lgkmcnt(3)
ds_read_b32 a88, v63
v_mfma_f32_16x16x32_bf16 v[192:195], a[248:251], a[32:35], v[192:195]
ds_read_b128 a[224:227], v15 offset:30720
v_perm_b32 v62, v89, v19, s53
v_mfma_f32_16x16x32_bf16 v[192:195], a[252:255], a[48:51], v[192:195]
ds_read_b32 a89, v62
v_mfma_f32_16x16x32_bf16 v[196:199], a[252:255], a[52:55], v[196:199]
ds_read_b128 a[228:231], v14 offset:47104
v_perm_b32 v61, v93, v19, s52
v_mfma_f32_16x16x32_bf16 v[196:199], a[248:251], a[36:39], v[196:199]
ds_read_b32 a90, v61
v_perm_b32 v60, v93, v19, s53
v_mfma_f32_16x16x32_bf16 v[200:203], a[248:251], a[40:43], v[200:203]
ds_read_b32 a91, v60
v_perm_b32 v59, v89, v19, s54
v_mfma_f32_16x16x32_bf16 v[200:203], a[252:255], a[56:59], v[200:203]
ds_read_b32 a92, v59
v_perm_b32 v58, v89, v19, s55
v_mfma_f32_16x16x32_bf16 v[204:207], a[252:255], a[60:63], v[204:207]
s_waitcnt vmcnt(8)
v_cmp_ne_u64 s[50:51], s[88:89], v[34:35]
v_cmp_ne_u64 s[44:45], s[88:89], v[38:39]
v_mfma_f32_16x16x32_bf16 v[204:207], a[248:251], a[44:47], v[204:207]
s_waitcnt lgkmcnt(3)
ds_read_b32 a93, v58
buffer_load_dwordx4 v[96:99], v12, s[24:27], 0 offen offset:2048 sc1
v_mfma_f32_16x16x32_bf16 v[144:147], a[224:227], a[48:51], v[144:147]
s_or_b64 s[50:51], s[44:45], s[50:51]
ds_read_b128 a[232:235], v15 offset:34816
buffer_load_dwordx4 v[100:103], v12, s[24:27], 0 offen offset:3072 sc1
v_mfma_f32_16x16x32_bf16 v[144:147], a[228:231], a[64:67], v[144:147]
s_cbranch_scc1 L_SLOW20
L_BACK20:
v_mfma_f32_16x16x32_bf16 v[148:151], a[228:231], a[68:71], v[148:151]
ds_read_b128 a[236:239], v14 offset:51200
v_perm_b32 v57, v93, v19, s54
v_mfma_f32_16x16x32_bf16 v[148:151], a[224:227], a[52:55], v[148:151]
s_add_u32 m0, s33, 150016
ds_read_b32 a94, v57
v_add_u32 v12, 49152, v13
v_mfma_f32_16x16x32_bf16 v[152:155], a[224:227], a[56:59], v[152:155]
buffer_load_dwordx4 v8, s[20:23], 0 offen offset:1536 lds
v_perm_b32 v56, v93, v19, s55
v_mfma_f32_16x16x32_bf16 v[152:155], a[228:231], a[72:75], v[152:155]
ds_read_b32 a95, v56
v_perm_b32 v63, v32, v19, s52
v_mfma_f32_16x16x32_bf16 v[156:159], a[228:231], a[76:79], v[156:159]
ds_read_b32 a96, v63
v_perm_b32 v62, v32, v19, s53
v_mfma_f32_16x16x32_bf16 v[156:159], a[224:227], a[60:63], v[156:159]
s_waitcnt lgkmcnt(3)
ds_read_b32 a97, v62
v_mfma_f32_16x16x32_bf16 v[176:179], a[232:235], a[48:51], v[176:179]
ds_read_b128 a[240:243], v14 offset:45056
v_perm_b32 v61, v36, v19, s52
v_mfma_f32_16x16x32_bf16 v[176:179], a[236:239], a[64:67], v[176:179]
ds_read_b32 a98, v61
v_mfma_f32_16x16x32_bf16 v[180:183], a[236:239], a[68:71], v[180:183]
ds_read_b128 a[244:247], v15 offset:45056
v_perm_b32 v60, v36, v19, s53
v_mfma_f32_16x16x32_bf16 v[180:183], a[232:235], a[52:55], v[180:183]
s_add_u32 m0, s33, 154240
ds_read_b32 a99, v60
v_mfma_f32_16x16x32_bf16 v[184:187], a[232:235], a[56:59], v[184:187]
buffer_load_dwordx4 v10, s[20:23], 0 offen offset:1408 lds
v_perm_b32 v59, v32, v19, s54
v_mfma_f32_16x16x32_bf16 v[184:187], a[236:239], a[72:75], v[184:187]
ds_read_b32 a100, v59
v_perm_b32 v58, v32, v19, s55
v_mfma_f32_16x16x32_bf16 v[188:191], a[236:239], a[76:79], v[188:191]
ds_read_b32 a101, v58
v_perm_b32 v57, v36, v19, s54
v_mfma_f32_16x16x32_bf16 v[188:191], a[232:235], a[60:63], v[188:191]
s_waitcnt lgkmcnt(3)
ds_read_b32 a102, v57
v_mfma_f32_16x16x32_bf16 v[128:131], a[240:243], a[64:67], v[128:131]
s_barrier
ds_read_b128 a[248:251], v14 offset:49152
v_perm_b32 v56, v36, v19, s55
v_mfma_f32_16x16x32_bf16 v[128:131], a[244:247], a[80:83], v[128:131]
ds_read_b32 a103, v56
v_mfma_f32_16x16x32_bf16 v[132:135], a[244:247], a[84:87], v[132:135]
ds_read_b128 a[252:255], v15 offset:49152
v_perm_b32 v63, v33, v19, s52
v_mfma_f32_16x16x32_bf16 v[132:135], a[240:243], a[68:71], v[132:135]
ds_read_b32 a104, v63
v_perm_b32 v62, v33, v19, s53
v_mfma_f32_16x16x32_bf16 v[136:139], a[240:243], a[72:75], v[136:139]
ds_read_b32 a105, v62
v_perm_b32 v61, v37, v19, s52
v_mfma_f32_16x16x32_bf16 v[136:139], a[244:247], a[88:91], v[136:139]
ds_read_b32 a106, v61
v_perm_b32 v60, v37, v19, s53
v_mfma_f32_16x16x32_bf16 v[140:143], a[244:247], a[92:95], v[140:143]
ds_read_b32 a107, v60
v_perm_b32 v59, v33, v19, s54
v_mfma_f32_16x16x32_bf16 v[140:143], a[240:243], a[76:79], v[140:143]
s_waitcnt lgkmcnt(4)
ds_read_b32 a108, v59
v_mfma_f32_16x16x32_bf16 v[160:163], a[248:251], a[64:67], v[160:163]
ds_read_b128 a[224:227], v14 offset:53248
v_perm_b32 v58, v33, v19, s55
v_mfma_f32_16x16x32_bf16 v[160:163], a[252:255], a[80:83], v[160:163]
s_waitcnt vmcnt(9)
ds_read_b32 a109, v58
v_cmp_ne_u64 s[50:51], s[88:89], v[42:43]
v_mfma_f32_16x16x32_bf16 v[164:167], a[252:255], a[84:87], v[164:167]
ds_read_b128 a[228:231], v15 offset:53248
v_cmp_ne_u64 s[44:45], s[88:89], v[46:47]
v_mfma_f32_16x16x32_bf16 v[164:167], a[248:251], a[68:71], v[164:167]
s_add_u32 m0, s33, 158208
v_perm_b32 v57, v37, v19, s54
v_perm_b32 v56, v37, v19, s55
v_mfma_f32_16x16x32_bf16 v[168:171], a[248:251], a[72:75], v[168:171]
s_or_b64 s[50:51], s[44:45], s[50:51]
ds_read_b32 a110, v57
buffer_load_dwordx4 v9, s[20:23], 0 offen offset:1536 lds
v_mfma_f32_16x16x32_bf16 v[168:171], a[252:255], a[88:91], v[168:171]
s_cbranch_scc1 L_SLOW21
L_BACK21:
v_mfma_f32_16x16x32_bf16 v[172:175], a[252:255], a[92:95], v[172:175]
ds_read_b32 a111, v56
v_perm_b32 v63, v40, v19, s52
v_mfma_f32_16x16x32_bf16 v[172:175], a[248:251], a[76:79], v[172:175]
s_waitcnt lgkmcnt(2)
ds_read_b32 a112, v63
buffer_load_dwordx4 v[80:83], v12, s[24:27], 0 offen offset:0 sc1
v_mfma_f32_16x16x32_bf16 v[224:227], a[224:227], a[32:35], v[224:227]
ds_read_b128 a[232:235], v15 offset:43008
v_perm_b32 v62, v40, v19, s53
v_mfma_f32_16x16x32_bf16 v[224:227], a[228:231], a[48:51], v[224:227]
ds_read_b32 a113, v62
buffer_load_dwordx4 v[84:87], v12, s[24:27], 0 offen offset:1024 sc1
v_mfma_f32_16x16x32_bf16 v[228:231], a[228:231], a[52:55], v[228:231]
ds_read_b128 a[236:239], v14 offset:59392
v_perm_b32 v61, v44, v19, s52
v_mfma_f32_16x16x32_bf16 v[228:231], a[224:227], a[36:39], v[228:231]
ds_read_b32 a114, v61
v_perm_b32 v60, v44, v19, s53
v_mfma_f32_16x16x32_bf16 v[232:235], a[224:227], a[40:43], v[232:235]
ds_read_b32 a115, v60
v_perm_b32 v59, v40, v19, s54
v_mfma_f32_16x16x32_bf16 v[232:235], a[228:231], a[56:59], v[232:235]
ds_read_b32 a116, v59
v_perm_b32 v58, v40, v19, s55
v_mfma_f32_16x16x32_bf16 v[236:239], a[228:231], a[60:63], v[236:239]
s_add_u32 m0, s33, 64256
ds_read_b32 a117, v58
v_perm_b32 v57, v44, v19, s54
v_mfma_f32_16x16x32_bf16 v[236:239], a[224:227], a[44:47], v[236:239]
s_waitcnt lgkmcnt(4)
ds_read_b32 a118, v57
v_perm_b32 v56, v44, v19, s55
v_mfma_f32_16x16x32_bf16 v[208:211], a[232:235], a[48:51], v[208:211]
ds_read_b128 a[240:243], v15 offset:47104
buffer_load_dwordx4 v11, s[20:23], 0 offen offset:1280 lds
v_mfma_f32_16x16x32_bf16 v[208:211], a[236:239], a[64:67], v[208:211]
ds_read_b32 a119, v56
v_mfma_f32_16x16x32_bf16 v[212:215], a[236:239], a[68:71], v[212:215]
ds_read_b128 a[244:247], v14 offset:63488
v_perm_b32 v63, v41, v19, s52
v_mfma_f32_16x16x32_bf16 v[212:215], a[232:235], a[52:55], v[212:215]
ds_read_b32 a120, v63
v_perm_b32 v62, v41, v19, s53
v_mfma_f32_16x16x32_bf16 v[216:219], a[232:235], a[56:59], v[216:219]
ds_read_b32 a121, v62
v_perm_b32 v61, v45, v19, s52
v_mfma_f32_16x16x32_bf16 v[216:219], a[236:239], a[72:75], v[216:219]
ds_read_b32 a122, v61
v_perm_b32 v60, v45, v19, s53
v_mfma_f32_16x16x32_bf16 v[220:223], a[236:239], a[76:79], v[220:223]
ds_read_b32 a123, v60
v_perm_b32 v59, v41, v19, s54
v_mfma_f32_16x16x32_bf16 v[220:223], a[232:235], a[60:63], v[220:223]
s_waitcnt lgkmcnt(4)
ds_read_b32 a124, v59
v_mfma_f32_16x16x32_bf16 v[144:147], a[240:243], a[80:83], v[144:147]
ds_read_b128 a[248:251], v14 offset:57344
v_perm_b32 v58, v41, v19, s55
v_mfma_f32_16x16x32_bf16 v[144:147], a[244:247], a[96:99], v[144:147]
ds_read_b32 a125, v58
v_mfma_f32_16x16x32_bf16 v[148:151], a[244:247], a[100:103], v[148:151]
ds_read_b128 a[252:255], v15 offset:57344
buffer_load_dwordx4 v[88:91], v12, s[24:27], 0 offen offset:2048 sc1
v_mfma_f32_16x16x32_bf16 v[148:151], a[240:243], a[84:87], v[148:151]
s_waitcnt vmcnt(10)
s_add_u32 m0, s33, 67968
v_cmp_ne_u64 s[50:51], s[88:89], v[50:51]
v_cmp_ne_u64 s[44:45], s[88:89], v[54:55]
v_mfma_f32_16x16x32_bf16 v[152:155], a[240:243], a[88:91], v[152:155]
buffer_load_dwordx4 v8, s[20:23], 0 offen offset:1664 lds
v_perm_b32 v57, v45, v19, s54
v_mfma_f32_16x16x32_bf16 v[152:155], a[244:247], a[104:107], v[152:155]
s_or_b64 s[50:51], s[44:45], s[50:51]
ds_read_b32 a126, v57
v_perm_b32 v56, v45, v19, s55
v_mfma_f32_16x16x32_bf16 v[156:159], a[244:247], a[108:111], v[156:159]
s_cbranch_scc1 L_SLOW22
L_BACK22:
v_mfma_f32_16x16x32_bf16 v[156:159], a[240:243], a[92:95], v[156:159]
s_waitcnt lgkmcnt(1)
ds_read_b32 a127, v56
buffer_load_dwordx4 v[92:95], v12, s[24:27], 0 offen offset:3072 sc1
v_mfma_f32_16x16x32_bf16 v[192:195], a[248:251], a[64:67], v[192:195]
ds_read_b128 a[224:227], v14 offset:61440
v_perm_b32 v63, v48, v19, s52
v_mfma_f32_16x16x32_bf16 v[192:195], a[252:255], a[80:83], v[192:195]
ds_read_b32 a128, v63
v_add_u32 v12, 53248, v13
v_mfma_f32_16x16x32_bf16 v[196:199], a[252:255], a[84:87], v[196:199]
ds_read_b128 a[228:231], v15 offset:61440
v_perm_b32 v62, v48, v19, s53
v_mfma_f32_16x16x32_bf16 v[196:199], a[248:251], a[68:71], v[196:199]
ds_read_b32 a129, v62
v_perm_b32 v61, v52, v19, s52
v_mfma_f32_16x16x32_bf16 v[200:203], a[248:251], a[72:75], v[200:203]
ds_read_b32 a130, v61
v_perm_b32 v60, v52, v19, s53
v_mfma_f32_16x16x32_bf16 v[200:203], a[252:255], a[88:91], v[200:203]
ds_read_b32 a131, v60
v_perm_b32 v59, v48, v19, s54
v_mfma_f32_16x16x32_bf16 v[204:207], a[252:255], a[92:95], v[204:207]
ds_read_b32 a132, v59
v_perm_b32 v58, v48, v19, s55
v_mfma_f32_16x16x32_bf16 v[204:207], a[248:251], a[76:79], v[204:207]
s_waitcnt lgkmcnt(4)
ds_read_b32 a133, v58
v_mfma_f32_16x16x32_bf16 v[128:131], a[224:227], a[96:99], v[128:131]
ds_read_b128 a[232:235], v15 offset:51200
v_perm_b32 v57, v52, v19, s54
v_mfma_f32_16x16x32_bf16 v[128:131], a[228:231], a[112:115], v[128:131]
ds_read_b32 a134, v57
v_mfma_f32_16x16x32_bf16 v[132:135], a[228:231], a[116:119], v[132:135]
ds_read_b128 a[236:239], v16 offset:2048
v_perm_b32 v56, v52, v19, s55
v_mfma_f32_16x16x32_bf16 v[132:135], a[224:227], a[100:103], v[132:135]
ds_read_b32 a135, v56
v_perm_b32 v63, v49, v19, s52
v_mfma_f32_16x16x32_bf16 v[136:139], a[224:227], a[104:107], v[136:139]
ds_read_b32 a136, v63
v_perm_b32 v62, v49, v19, s53
v_mfma_f32_16x16x32_bf16 v[136:139], a[228:231], a[120:123], v[136:139]
ds_read_b32 a137, v62
v_perm_b32 v61, v53, v19, s52
v_mfma_f32_16x16x32_bf16 v[140:143], a[228:231], a[124:127], v[140:143]
ds_read_b32 a138, v61
v_perm_b32 v60, v53, v19, s53
v_mfma_f32_16x16x32_bf16 v[140:143], a[224:227], a[108:111], v[140:143]
s_waitcnt lgkmcnt(4)
ds_read_b32 a139, v60
v_mfma_f32_16x16x32_bf16 v[176:179], a[232:235], a[80:83], v[176:179]
ds_read_b128 a[240:243], v16 offset:0
v_perm_b32 v59, v49, v19, s54
v_mfma_f32_16x16x32_bf16 v[176:179], a[236:239], a[96:99], v[176:179]
ds_read_b32 a140, v59
v_mfma_f32_16x16x32_bf16 v[180:183], a[236:239], a[100:103], v[180:183]
ds_read_b128 a[244:247], v17 offset:0
v_perm_b32 v58, v49, v19, s55
v_mfma_f32_16x16x32_bf16 v[180:183], a[232:235], a[84:87], v[180:183]
s_waitcnt vmcnt(9)
v_cmp_ne_u64 s[50:51], s[88:89], v[98:99]
v_cmp_ne_u64 s[44:45], s[88:89], v[102:103]
v_mfma_f32_16x16x32_bf16 v[184:187], a[232:235], a[88:91], v[184:187]
ds_read_b32 a141, v58
v_perm_b32 v57, v53, v19, s54
v_mfma_f32_16x16x32_bf16 v[184:187], a[236:239], a[104:107], v[184:187]
s_or_b64 s[50:51], s[44:45], s[50:51]
ds_read_b32 a142, v57
v_perm_b32 v56, v53, v19, s55
v_mfma_f32_16x16x32_bf16 v[188:191], a[236:239], a[108:111], v[188:191]
s_cbranch_scc1 L_SLOW23
L_BACK23:
v_mfma_f32_16x16x32_bf16 v[188:191], a[232:235], a[92:95], v[188:191]
s_waitcnt lgkmcnt(2)
ds_read_b32 a143, v56
v_mfma_f32_16x16x32_bf16 v[160:163], a[240:243], a[96:99], v[160:163]
s_barrier
ds_read_b128 a[248:251], v15 offset:38912
v_perm_b32 v63, v96, v19, s52
v_mfma_f32_16x16x32_bf16 v[160:163], a[244:247], a[112:115], v[160:163]
ds_read_b32 a144, v63
v_mfma_f32_16x16x32_bf16 v[164:167], a[244:247], a[116:119], v[164:167]
ds_read_b128 a[252:255], v14 offset:55296
v_perm_b32 v62, v96, v19, s53
v_mfma_f32_16x16x32_bf16 v[164:167], a[240:243], a[100:103], v[164:167]
s_add_u32 m0, s33, 72192
ds_read_b32 a145, v62
buffer_load_dwordx4 v[32:35], v12, s[24:27], 0 offen offset:0 sc1
v_mfma_f32_16x16x32_bf16 v[168:171], a[240:243], a[104:107], v[168:171]
buffer_load_dwordx4 v10, s[20:23], 0 offen offset:1536 lds
v_perm_b32 v61, v100, v19, s52
v_mfma_f32_16x16x32_bf16 v[168:171], a[244:247], a[120:123], v[168:171]
ds_read_b32 a146, v61
v_perm_b32 v60, v100, v19, s53
v_mfma_f32_16x16x32_bf16 v[172:175], a[244:247], a[124:127], v[172:175]
ds_read_b32 a147, v60
v_perm_b32 v59, v96, v19, s54
v_mfma_f32_16x16x32_bf16 v[172:175], a[240:243], a[108:111], v[172:175]
s_waitcnt lgkmcnt(3)
ds_read_b32 a148, v59
buffer_load_dwordx4 v[36:39], v12, s[24:27], 0 offen offset:1024 sc1
v_mfma_f32_16x16x32_bf16 v[240:243], a[248:251], a[16:19], v[240:243]
ds_read_b128 a[224:227], v15 offset:63488
v_perm_b32 v58, v96, v19, s55
v_mfma_f32_16x16x32_bf16 v[240:243], a[252:255], a[32:35], v[240:243]
ds_read_b32 a149, v58
v_mfma_f32_16x16x32_bf16 v[244:247], a[252:255], a[36:39], v[244:247]
ds_read_b128 a[228:231], v16 offset:6144
v_perm_b32 v57, v100, v19, s54
v_mfma_f32_16x16x32_bf16 v[244:247], a[248:251], a[20:23], v[244:247]
ds_read_b32 a150, v57
v_perm_b32 v56, v100, v19, s55
v_mfma_f32_16x16x32_bf16 v[248:251], a[248:251], a[24:27], v[248:251]
ds_read_b32 a151, v56
v_perm_b32 v63, v97, v19, s52
v_mfma_f32_16x16x32_bf16 v[248:251], a[252:255], a[40:43], v[248:251]
ds_read_b32 a152, v63
v_perm_b32 v62, v97, v19, s53
v_mfma_f32_16x16x32_bf16 v[252:255], a[252:255], a[44:47], v[252:255]
s_add_u32 m0, s33, 80256
ds_read_b32 a153, v62
v_perm_b32 v61, v101, v19, s52
v_mfma_f32_16x16x32_bf16 v[252:255], a[248:251], a[28:31], v[252:255]
s_waitcnt lgkmcnt(4)
ds_read_b32 a154, v61
v_perm_b32 v60, v101, v19, s53
v_mfma_f32_16x16x32_bf16 v[144:147], a[224:227], a[112:115], v[144:147]
ds_read_b128 a[232:235], v16 offset:8192
buffer_load_dwordx4 v9, s[20:23], 0 offen offset:1664 lds
v_mfma_f32_16x16x32_bf16 v[144:147], a[228:231], a[128:131], v[144:147]
ds_read_b32 a155, v60
v_mfma_f32_16x16x32_bf16 v[148:151], a[228:231], a[132:135], v[148:151]
ds_read_b128 a[236:239], v17 offset:8192
v_perm_b32 v59, v97, v19, s54
v_mfma_f32_16x16x32_bf16 v[148:151], a[224:227], a[116:119], v[148:151]
ds_read_b32 a156, v59
v_perm_b32 v58, v97, v19, s55
v_mfma_f32_16x16x32_bf16 v[152:155], a[224:227], a[120:123], v[152:155]
ds_read_b32 a157, v58
v_perm_b32 v57, v101, v19, s54
v_mfma_f32_16x16x32_bf16 v[152:155], a[228:231], a[136:139], v[152:155]
ds_read_b32 a158, v57
v_perm_b32 v56, v101, v19, s55
v_mfma_f32_16x16x32_bf16 v[156:159], a[228:231], a[140:143], v[156:159]
s_waitcnt vmcnt(8)
v_cmp_ne_u64 s[50:51], s[88:89], v[82:83]
v_cmp_ne_u64 s[44:45], s[88:89], v[86:87]
v_mfma_f32_16x16x32_bf16 v[156:159], a[224:227], a[124:127], v[156:159]
s_waitcnt lgkmcnt(3)
ds_read_b32 a159, v56
v_mfma_f32_16x16x32_bf16 v[224:227], a[232:235], a[64:67], v[224:227]
s_or_b64 s[50:51], s[44:45], s[50:51]
ds_read_b128 a[240:243], v15 offset:59392
v_mfma_f32_16x16x32_bf16 v[224:227], a[236:239], a[80:83], v[224:227]
s_cbranch_scc1 L_SLOW24
L_BACK24:
v_mfma_f32_16x16x32_bf16 v[228:231], a[236:239], a[84:87], v[228:231]
ds_read_b128 a[244:247], v16 offset:14336
v_perm_b32 v63, v80, v19, s52
v_mfma_f32_16x16x32_bf16 v[228:231], a[232:235], a[68:71], v[228:231]
s_add_u32 m0, s33, 84224
ds_read_b32 a160, v63
buffer_load_dwordx4 v[40:43], v12, s[24:27], 0 offen offset:2048 sc1
v_mfma_f32_16x16x32_bf16 v[232:235], a[232:235], a[72:75], v[232:235]
buffer_load_dwordx4 v8, s[20:23], 0 offen offset:1792 lds
v_perm_b32 v62, v80, v19, s53
v_mfma_f32_16x16x32_bf16 v[232:235], a[236:239], a[88:91], v[232:235]
ds_read_b32 a161, v62
v_perm_b32 v61, v84, v19, s52
v_mfma_f32_16x16x32_bf16 v[236:239], a[236:239], a[92:95], v[236:239]
ds_read_b32 a162, v61
v_perm_b32 v60, v84, v19, s53
v_mfma_f32_16x16x32_bf16 v[236:239], a[232:235], a[76:79], v[236:239]
s_waitcnt lgkmcnt(3)
ds_read_b32 a163, v60
buffer_load_dwordx4 v[44:47], v12, s[24:27], 0 offen offset:3072 sc1
v_mfma_f32_16x16x32_bf16 v[208:211], a[240:243], a[80:83], v[208:211]
ds_read_b128 a[248:251], v16 offset:4096
v_perm_b32 v59, v80, v19, s54
v_mfma_f32_16x16x32_bf16 v[208:211], a[244:247], a[96:99], v[208:211]
ds_read_b32 a164, v59
v_add_u32 v12, 57344, v13
v_mfma_f32_16x16x32_bf16 v[212:215], a[244:247], a[100:103], v[212:215]
ds_read_b128 a[252:255], v17 offset:4096
v_perm_b32 v58, v80, v19, s55
v_mfma_f32_16x16x32_bf16 v[212:215], a[240:243], a[84:87], v[212:215]
ds_read_b32 a165, v58
v_perm_b32 v57, v84, v19, s54
v_mfma_f32_16x16x32_bf16 v[216:219], a[240:243], a[88:91], v[216:219]
ds_read_b32 a166, v57
v_perm_b32 v56, v84, v19, s55
v_mfma_f32_16x16x32_bf16 v[216:219], a[244:247], a[104:107], v[216:219]
ds_read_b32 a167, v56
v_perm_b32 v63, v81, v19, s52
v_mfma_f32_16x16x32_bf16 v[220:223], a[244:247], a[108:111], v[220:223]
s_add_u32 m0, s33, 76416
ds_read_b32 a168, v63
v_perm_b32 v62, v81, v19, s53
v_mfma_f32_16x16x32_bf16 v[220:223], a[240:243], a[92:95], v[220:223]
s_waitcnt lgkmcnt(4)
ds_read_b32 a169, v62
v_perm_b32 v61, v85, v19, s52
v_mfma_f32_16x16x32_bf16 v[128:131], a[248:251], a[128:131], v[128:131]
ds_read_b128 a[224:227], v16 offset:12288
buffer_load_dwordx4 v11, s[20:23], 0 offen offset:1408 lds
v_mfma_f32_16x16x32_bf16 v[128:131], a[252:255], a[144:147], v[128:131]
ds_read_b32 a170, v61
v_mfma_f32_16x16x32_bf16 v[132:135], a[252:255], a[148:151], v[132:135]
ds_read_b128 a[228:231], v17 offset:12288
v_perm_b32 v60, v85, v19, s53
v_mfma_f32_16x16x32_bf16 v[132:135], a[248:251], a[132:135], v[132:135]
ds_read_b32 a171, v60
v_perm_b32 v59, v81, v19, s54
v_mfma_f32_16x16x32_bf16 v[136:139], a[248:251], a[136:139], v[136:139]
ds_read_b32 a172, v59
v_perm_b32 v58, v81, v19, s55
v_mfma_f32_16x16x32_bf16 v[136:139], a[252:255], a[152:155], v[136:139]
ds_read_b32 a173, v58
v_perm_b32 v57, v85, v19, s54
v_mfma_f32_16x16x32_bf16 v[140:143], a[252:255], a[156:159], v[140:143]
s_waitcnt vmcnt(8)
v_cmp_ne_u64 s[50:51], s[88:89], v[90:91]
v_cmp_ne_u64 s[44:45], s[88:89], v[94:95]
v_mfma_f32_16x16x32_bf16 v[140:143], a[248:251], a[140:143], v[140:143]
s_waitcnt lgkmcnt(3)
ds_read_b32 a174, v57
v_mfma_f32_16x16x32_bf16 v[192:195], a[224:227], a[96:99], v[192:195]
s_or_b64 s[50:51], s[44:45], s[50:51]
ds_read_b128 a[232:235], v17 offset:2048
v_mfma_f32_16x16x32_bf16 v[192:195], a[228:231], a[112:115], v[192:195]
s_cbranch_scc1 L_SLOW25
L_BACK25:
v_mfma_f32_16x16x32_bf16 v[196:199], a[228:231], a[116:119], v[196:199]
ds_read_b128 a[236:239], v16 offset:18432
v_perm_b32 v56, v85, v19, s55
v_mfma_f32_16x16x32_bf16 v[196:199], a[224:227], a[100:103], v[196:199]
s_add_u32 m0, s33, 88320
ds_read_b32 a175, v56
v_mfma_f32_16x16x32_bf16 v[200:203], a[224:227], a[104:107], v[200:203]
buffer_load_dwordx4 v9, s[20:23], 0 offen offset:1792 lds
v_perm_b32 v63, v88, v19, s52
v_mfma_f32_16x16x32_bf16 v[200:203], a[228:231], a[120:123], v[200:203]
ds_read_b32 a176, v63
v_perm_b32 v62, v88, v19, s53
v_mfma_f32_16x16x32_bf16 v[204:207], a[228:231], a[124:127], v[204:207]
ds_read_b32 a177, v62
v_perm_b32 v61, v92, v19, s52
v_mfma_f32_16x16x32_bf16 v[204:207], a[224:227], a[108:111], v[204:207]
s_waitcnt lgkmcnt(3)
ds_read_b32 a178, v61
v_mfma_f32_16x16x32_bf16 v[176:179], a[232:235], a[112:115], v[176:179]
ds_read_b128 a[240:243], v16 offset:16384
v_perm_b32 v60, v92, v19, s53
v_mfma_f32_16x16x32_bf16 v[176:179], a[236:239], a[128:131], v[176:179]
ds_read_b32 a179, v60
v_mfma_f32_16x16x32_bf16 v[180:183], a[236:239], a[132:135], v[180:183]
ds_read_b128 a[244:247], v17 offset:16384
v_perm_b32 v59, v88, v19, s54
v_mfma_f32_16x16x32_bf16 v[180:183], a[232:235], a[116:119], v[180:183]
s_add_u32 m0, s33, 92544
ds_read_b32 a180, v59
buffer_load_dwordx4 v[48:51], v12, s[24:27], 0 offen offset:0 sc1
v_mfma_f32_16x16x32_bf16 v[184:187], a[232:235], a[120:123], v[184:187]
buffer_load_dwordx4 v10, s[20:23], 0 offen offset:1664 lds
v_perm_b32 v58, v88, v19, s55
v_mfma_f32_16x16x32_bf16 v[184:187], a[236:239], a[136:139], v[184:187]
ds_read_b32 a181, v58
v_perm_b32 v57, v92, v19, s54
v_mfma_f32_16x16x32_bf16 v[188:191], a[236:239], a[140:143], v[188:191]
ds_read_b32 a182, v57
v_perm_b32 v56, v92, v19, s55
v_mfma_f32_16x16x32_bf16 v[188:191], a[232:235], a[124:127], v[188:191]
s_waitcnt lgkmcnt(3)
ds_read_b32 a183, v56
buffer_load_dwordx4 v[52:55], v12, s[24:27], 0 offen offset:1024 sc1
v_mfma_f32_16x16x32_bf16 v[160:163], a[240:243], a[128:131], v[160:163]
L_PAD4:
s_cbranch_vccnz L_PADRET
s_barrier
ds_read_b128 a[248:251], v17 offset:6144
v_perm_b32 v63, v89, v19, s52
v_mfma_f32_16x16x32_bf16 v[160:163], a[244:247], a[144:147], v[160:163]
ds_read_b32 a184, v63
v_mfma_f32_16x16x32_bf16 v[164:167], a[244:247], a[148:151], v[164:167]
ds_read_b128 a[252:255], v16 offset:22528
v_perm_b32 v62, v89, v19, s53
v_mfma_f32_16x16x32_bf16 v[164:167], a[240:243], a[132:135], v[164:167]
ds_read_b32 a185, v62
v_perm_b32 v61, v93, v19, s52
v_mfma_f32_16x16x32_bf16 v[168:171], a[240:243], a[136:139], v[168:171]
ds_read_b32 a186, v61
v_perm_b32 v60, v93, v19, s53
v_mfma_f32_16x16x32_bf16 v[168:171], a[244:247], a[152:155], v[168:171]
ds_read_b32 a187, v60
v_perm_b32 v59, v89, v19, s54
v_mfma_f32_16x16x32_bf16 v[172:175], a[244:247], a[156:159], v[172:175]
ds_read_b32 a188, v59
v_perm_b32 v58, v89, v19, s55
v_mfma_f32_16x16x32_bf16 v[172:175], a[240:243], a[140:143], v[172:175]
s_waitcnt lgkmcnt(4)
ds_read_b32 a189, v58
v_mfma_f32_16x16x32_bf16 v[144:147], a[248:251], a[144:147], v[144:147]
ds_read_b128 a[224:227], v16 offset:20480
v_perm_b32 v57, v93, v19, s54
v_mfma_f32_16x16x32_bf16 v[144:147], a[252:255], a[160:163], v[144:147]
ds_read_b32 a190, v57
v_mfma_f32_16x16x32_bf16 v[148:151], a[252:255], a[164:167], v[148:151]
ds_read_b128 a[228:231], v17 offset:20480
v_perm_b32 v56, v93, v19, s55
v_mfma_f32_16x16x32_bf16 v[148:151], a[248:251], a[148:151], v[148:151]
s_add_u32 m0, s33, 96384
ds_read_b32 a191, v56
v_mfma_f32_16x16x32_bf16 v[152:155], a[248:251], a[152:155], v[152:155]
buffer_load_dwordx4 v8, s[20:23], 0 offen offset:1920 lds
v_mfma_f32_16x16x32_bf16 v[152:155], a[252:255], a[168:171], v[152:155]
v_mfma_f32_16x16x32_bf16 v[156:159], a[252:255], a[172:175], v[156:159]
s_waitcnt vmcnt(10)
v_cmp_ne_u64 s[50:51], s[88:89], v[34:35]
v_cmp_ne_u64 s[44:45], s[88:89], v[38:39]
v_mfma_f32_16x16x32_bf16 v[156:159], a[248:251], a[156:159], v[156:159]
s_waitcnt lgkmcnt(1)
v_mfma_f32_16x16x32_bf16 v[128:131], a[224:227], a[160:163], v[128:131]
s_or_b64 s[50:51], s[44:45], s[50:51]
ds_read_b128 a[232:235], v16 offset:24576
v_mfma_f32_16x16x32_bf16 v[128:131], a[228:231], a[176:179], v[128:131]
s_cbranch_scc1 L_SLOW26
L_BACK26:
v_mfma_f32_16x16x32_bf16 v[132:135], a[228:231], a[180:183], v[132:135]
ds_read_b128 a[236:239], v17 offset:24576
v_mfma_f32_16x16x32_bf16 v[132:135], a[224:227], a[164:167], v[132:135]
buffer_load_dwordx4 v[96:99], v12, s[24:27], 0 offen offset:2048 sc1
v_perm_b32 v63, v32, v19, s52
v_mfma_f32_16x16x32_bf16 v[136:139], a[224:227], a[168:171], v[136:139]
ds_read_b32 a192, v63
v_perm_b32 v62, v32, v19, s53
v_mfma_f32_16x16x32_bf16 v[136:139], a[228:231], a[184:187], v[136:139]
s_waitcnt lgkmcnt(2)
ds_read_b32 a193, v62
v_perm_b32 v61, v36, v19, s52
v_mfma_f32_16x16x32_bf16 v[140:143], a[228:231], a[188:191], v[140:143]
s_add_u32 m0, s33, 104960
ds_read_b32 a194, v61
v_perm_b32 v60, v36, v19, s53
v_mfma_f32_16x16x32_bf16 v[140:143], a[224:227], a[172:175], v[140:143]
s_waitcnt lgkmcnt(3)
ds_read_b32 a195, v60
v_perm_b32 v59, v32, v19, s54
v_mfma_f32_16x16x32_bf16 v[192:195], a[232:235], a[128:131], v[192:195]
ds_read_b128 a[240:243], v17 offset:14336
buffer_load_dwordx4 v11, s[20:23], 0 offen offset:1536 lds
v_mfma_f32_16x16x32_bf16 v[192:195], a[236:239], a[144:147], v[192:195]
ds_read_b32 a196, v59
buffer_load_dwordx4 v[100:103], v12, s[24:27], 0 offen offset:3072 sc1
v_mfma_f32_16x16x32_bf16 v[196:199], a[236:239], a[148:151], v[196:199]
ds_read_b128 a[244:247], v16 offset:26624
v_perm_b32 v58, v32, v19, s55
v_mfma_f32_16x16x32_bf16 v[196:199], a[232:235], a[132:135], v[196:199]
ds_read_b32 a197, v58
v_perm_b32 v57, v36, v19, s54
v_mfma_f32_16x16x32_bf16 v[200:203], a[232:235], a[136:139], v[200:203]
ds_read_b32 a198, v57
v_perm_b32 v56, v36, v19, s55
v_mfma_f32_16x16x32_bf16 v[200:203], a[236:239], a[152:155], v[200:203]
ds_read_b32 a199, v56
v_perm_b32 v63, v33, v19, s52
v_mfma_f32_16x16x32_bf16 v[204:207], a[236:239], a[156:159], v[204:207]
ds_read_b32 a200, v63
v_perm_b32 v62, v33, v19, s53
v_mfma_f32_16x16x32_bf16 v[204:207], a[232:235], a[140:143], v[204:207]
s_waitcnt lgkmcnt(4)
ds_read_b32 a201, v62
v_add_u32 v12, 61440, v13
v_mfma_f32_16x16x32_bf16 v[208:211], a[240:243], a[112:115], v[208:211]
ds_read_b128 a[248:251], v17 offset:18432
v_perm_b32 v61, v37, v19, s52
v_mfma_f32_16x16x32_bf16 v[208:211], a[244:247], a[128:131], v[208:211]
ds_read_b32 a202, v61
v_mfma_f32_16x16x32_bf16 v[212:215], a[244:247], a[132:135], v[212:215]
ds_read_b128 a[252:255], v16 offset:30720
v_perm_b32 v60, v37, v19, s53
v_mfma_f32_16x16x32_bf16 v[212:215], a[240:243], a[116:119], v[212:215]
s_add_u32 m0, s33, 108672
ds_read_b32 a203, v60
v_mfma_f32_16x16x32_bf16 v[216:219], a[240:243], a[120:123], v[216:219]
buffer_load_dwordx4 v9, s[20:23], 0 offen offset:1920 lds
v_perm_b32 v59, v33, v19, s54
v_mfma_f32_16x16x32_bf16 v[216:219], a[244:247], a[136:139], v[216:219]
ds_read_b32 a204, v59
v_perm_b32 v58, v33, v19, s55
v_mfma_f32_16x16x32_bf16 v[220:223], a[244:247], a[140:143], v[220:223]
ds_read_b32 a205, v58
v_mfma_f32_16x16x32_bf16 v[220:223], a[240:243], a[124:127], v[220:223]
s_waitcnt vmcnt(10) lgkmcnt(3)
v_perm_b32 v57, v37, v19, s54
v_cmp_ne_u64 s[50:51], s[88:89], v[42:43]
v_mfma_f32_16x16x32_bf16 v[176:179], a[248:251], a[144:147], v[176:179]
ds_read_b128 a[224:227], v14 offset:0
v_cmp_ne_u64 s[44:45], s[88:89], v[46:47]
v_mfma_f32_16x16x32_bf16 v[176:179], a[252:255], a[160:163], v[176:179]
ds_read_b32 a206, v57
v_mfma_f32_16x16x32_bf16 v[180:183], a[252:255], a[164:167], v[180:183]
s_or_b64 s[50:51], s[44:45], s[50:51]
ds_read_b128 a[228:231], v15 offset:0
v_perm_b32 v56, v37, v19, s55
v_mfma_f32_16x16x32_bf16 v[180:183], a[248:251], a[148:151], v[180:183]
s_cbranch_scc1 L_SLOW27
L_BACK27:
v_mfma_f32_16x16x32_bf16 v[184:187], a[248:251], a[152:155], v[184:187]
ds_read_b32 a207, v56
v_perm_b32 v63, v40, v19, s52
v_mfma_f32_16x16x32_bf16 v[184:187], a[252:255], a[168:171], v[184:187]
ds_read_b32 a208, v63
v_perm_b32 v62, v40, v19, s53
v_mfma_f32_16x16x32_bf16 v[188:191], a[252:255], a[172:175], v[188:191]
s_add_u32 m0, s33, 112896
ds_read_b32 a209, v62
v_perm_b32 v61, v44, v19, s52
v_mfma_f32_16x16x32_bf16 v[188:191], a[248:251], a[156:159], v[188:191]
s_waitcnt lgkmcnt(3)
ds_read_b32 a210, v61
v_perm_b32 v60, v44, v19, s53
v_mfma_f32_16x16x32_bf16 v[224:227], a[224:227], a[96:99], v[224:227]
ds_read_b128 a[232:235], v16 offset:28672
buffer_load_dwordx4 v10, s[20:23], 0 offen offset:1792 lds
v_mfma_f32_16x16x32_bf16 v[224:227], a[228:231], a[112:115], v[224:227]
ds_read_b32 a211, v60
buffer_load_dwordx4 v[80:83], v12, s[24:27], 0 offen offset:0 sc1
v_mfma_f32_16x16x32_bf16 v[228:231], a[228:231], a[116:119], v[228:231]
ds_read_b128 a[236:239], v17 offset:28672
v_perm_b32 v59, v40, v19, s54
v_mfma_f32_16x16x32_bf16 v[228:231], a[224:227], a[100:103], v[228:231]
ds_read_b32 a212, v59
v_perm_b32 v58, v40, v19, s55
v_mfma_f32_16x16x32_bf16 v[232:235], a[224:227], a[104:107], v[232:235]
ds_read_b32 a213, v58
v_perm_b32 v57, v44, v19, s54
v_mfma_f32_16x16x32_bf16 v[232:235], a[228:231], a[120:123], v[232:235]
ds_read_b32 a214, v57
v_perm_b32 v56, v44, v19, s55
v_mfma_f32_16x16x32_bf16 v[236:239], a[228:231], a[124:127], v[236:239]
ds_read_b32 a215, v56
v_perm_b32 v63, v41, v19, s52
v_mfma_f32_16x16x32_bf16 v[236:239], a[224:227], a[108:111], v[236:239]
s_waitcnt lgkmcnt(4)
ds_read_b32 a216, v63
buffer_load_dwordx4 v[84:87], v12, s[24:27], 0 offen offset:1024 sc1
v_mfma_f32_16x16x32_bf16 v[160:163], a[232:235], a[160:163], v[160:163]
ds_read_b128 a[240:243], v17 offset:22528
v_perm_b32 v62, v41, v19, s53
v_mfma_f32_16x16x32_bf16 v[160:163], a[236:239], a[176:179], v[160:163]
ds_read_b32 a217, v62
v_mfma_f32_16x16x32_bf16 v[164:167], a[236:239], a[180:183], v[164:167]
ds_read_b128 a[244:247], v14 offset:6144
v_perm_b32 v61, v45, v19, s52
v_mfma_f32_16x16x32_bf16 v[164:167], a[232:235], a[164:167], v[164:167]
s_add_u32 m0, s33, 100736
ds_read_b32 a218, v61
v_mfma_f32_16x16x32_bf16 v[168:171], a[232:235], a[168:171], v[168:171]
buffer_load_dwordx4 v11, s[20:23], 0 offen offset:1664 lds
v_perm_b32 v60, v45, v19, s53
v_mfma_f32_16x16x32_bf16 v[168:171], a[236:239], a[184:187], v[168:171]
ds_read_b32 a219, v60
v_perm_b32 v59, v41, v19, s54
v_mfma_f32_16x16x32_bf16 v[172:175], a[236:239], a[188:191], v[172:175]
ds_read_b32 a220, v59
v_perm_b32 v58, v41, v19, s55
v_mfma_f32_16x16x32_bf16 v[172:175], a[232:235], a[172:175], v[172:175]
s_waitcnt lgkmcnt(3)
ds_read_b32 a221, v58
v_mfma_f32_16x16x32_bf16 v[144:147], a[240:243], a[176:179], v[144:147]
s_barrier
ds_read_b128 a[248:251], v14 offset:4096
v_perm_b32 v57, v45, v19, s54
v_mfma_f32_16x16x32_bf16 v[144:147], a[244:247], a[192:195], v[144:147]
ds_read_b32 a222, v57
v_mfma_f32_16x16x32_bf16 v[148:151], a[244:247], a[196:199], v[148:151]
ds_read_b128 a[252:255], v15 offset:4096
v_perm_b32 v56, v45, v19, s55
v_mfma_f32_16x16x32_bf16 v[148:151], a[240:243], a[180:183], v[148:151]
ds_read_b32 a223, v56
v_mfma_f32_16x16x32_bf16 v[152:155], a[240:243], a[184:187], v[152:155]
v_mfma_f32_16x16x32_bf16 v[152:155], a[244:247], a[200:203], v[152:155]
buffer_load_dwordx4 v[88:91], v12, s[24:27], 0 offen offset:2048 sc1
v_mfma_f32_16x16x32_bf16 v[156:159], a[244:247], a[204:207], v[156:159]
s_waitcnt vmcnt(10)
s_add_u32 m0, s33, 125056
v_cmp_ne_u64 s[50:51], s[88:89], v[50:51]
v_cmp_ne_u64 s[44:45], s[88:89], v[54:55]
v_mfma_f32_16x16x32_bf16 v[156:159], a[240:243], a[188:191], v[156:159]
s_waitcnt lgkmcnt(1)
buffer_load_dwordx4 v[92:95], v12, s[24:27], 0 offen offset:3072 sc1
v_mfma_f32_16x16x32_bf16 v[128:131], a[248:251], a[192:195], v[128:131]
s_or_b64 s[50:51], s[44:45], s[50:51]
ds_read_b128 a[224:227], v15 offset:55296
buffer_load_dwordx4 v10, s[20:23], 0 offen offset:1920 lds
v_mfma_f32_16x16x32_bf16 v[128:131], a[252:255], a[208:211], v[128:131]
s_cbranch_scc1 L_SLOW28
L_BACK28:
v_mfma_f32_16x16x32_bf16 v[132:135], a[252:255], a[212:215], v[132:135]
ds_read_b128 a[228:231], v16 offset:10240
v_mfma_f32_16x16x32_bf16 v[132:135], a[248:251], a[196:199], v[132:135]
v_perm_b32 v63, v48, v19, s52
v_mfma_f32_16x16x32_bf16 v[136:139], a[248:251], a[200:203], v[136:139]
ds_read_b32 a0, v63
v_perm_b32 v62, v48, v19, s53
v_mfma_f32_16x16x32_bf16 v[136:139], a[252:255], a[216:219], v[136:139]
s_waitcnt lgkmcnt(2)
ds_read_b32 a1, v62
v_perm_b32 v61, v52, v19, s52
v_mfma_f32_16x16x32_bf16 v[140:143], a[252:255], a[220:223], v[140:143]
ds_read_b32 a2, v61
v_perm_b32 v60, v52, v19, s53
v_mfma_f32_16x16x32_bf16 v[140:143], a[248:251], a[204:207], v[140:143]
s_waitcnt lgkmcnt(3)
ds_read_b32 a3, v60
v_mfma_f32_16x16x32_bf16 v[240:243], a[224:227], a[48:51], v[240:243]
ds_read_b128 a[232:235], v14 offset:8192
v_perm_b32 v59, v48, v19, s54
v_mfma_f32_16x16x32_bf16 v[240:243], a[228:231], a[64:67], v[240:243]
ds_read_b32 a4, v59
v_mfma_f32_16x16x32_bf16 v[244:247], a[228:231], a[68:71], v[244:247]
ds_read_b128 a[236:239], v15 offset:8192
v_perm_b32 v58, v48, v19, s55
v_mfma_f32_16x16x32_bf16 v[244:247], a[224:227], a[52:55], v[244:247]
s_add_u32 m0, s33, 121088
ds_read_b32 a5, v58
v_mfma_f32_16x16x32_bf16 v[248:251], a[224:227], a[56:59], v[248:251]
buffer_load_dwordx4 v11, s[20:23], 0 offen offset:1792 lds
v_perm_b32 v57, v52, v19, s54
v_mfma_f32_16x16x32_bf16 v[248:251], a[228:231], a[72:75], v[248:251]
ds_read_b32 a6, v57
v_perm_b32 v56, v52, v19, s55
v_mfma_f32_16x16x32_bf16 v[252:255], a[228:231], a[76:79], v[252:255]
ds_read_b32 a7, v56
v_perm_b32 v63, v49, v19, s52
v_mfma_f32_16x16x32_bf16 v[252:255], a[224:227], a[60:63], v[252:255]
s_waitcnt lgkmcnt(3)
ds_read_b32 a8, v63
v_mfma_f32_16x16x32_bf16 v[192:195], a[232:235], a[160:163], v[192:195]
ds_read_b128 a[240:243], v17 offset:30720
v_perm_b32 v62, v49, v19, s53
v_mfma_f32_16x16x32_bf16 v[192:195], a[236:239], a[176:179], v[192:195]
ds_read_b32 a9, v62
v_mfma_f32_16x16x32_bf16 v[196:199], a[236:239], a[180:183], v[196:199]
ds_read_b128 a[244:247], v14 offset:18432
v_perm_b32 v61, v53, v19, s52
v_mfma_f32_16x16x32_bf16 v[196:199], a[232:235], a[164:167], v[196:199]
ds_read_b32 a10, v61
v_perm_b32 v60, v53, v19, s53
v_mfma_f32_16x16x32_bf16 v[200:203], a[232:235], a[168:171], v[200:203]
ds_read_b32 a11, v60
v_perm_b32 v59, v49, v19, s54
v_mfma_f32_16x16x32_bf16 v[200:203], a[236:239], a[184:187], v[200:203]
ds_read_b32 a12, v59
v_perm_b32 v58, v49, v19, s55
v_mfma_f32_16x16x32_bf16 v[204:207], a[236:239], a[188:191], v[204:207]
s_add_u32 m0, s33, 129152
ds_read_b32 a13, v58
v_perm_b32 v57, v53, v19, s54
v_mfma_f32_16x16x32_bf16 v[204:207], a[232:235], a[172:175], v[204:207]
s_waitcnt vmcnt(9) lgkmcnt(4)
v_cmp_ne_u64 s[50:51], s[88:89], v[98:99]
v_cmp_ne_u64 s[44:45], s[88:89], v[102:103]
v_mfma_f32_16x16x32_bf16 v[176:179], a[240:243], a[176:179], v[176:179]
ds_read_b128 a[248:251], v14 offset:16384
buffer_load_dwordx4 v11, s[20:23], 0 offen offset:1920 lds
v_mfma_f32_16x16x32_bf16 v[176:179], a[244:247], a[192:195], v[176:179]
ds_read_b32 a14, v57
v_mfma_f32_16x16x32_bf16 v[180:183], a[244:247], a[196:199], v[180:183]
s_or_b64 s[50:51], s[44:45], s[50:51]
ds_read_b128 a[252:255], v15 offset:16384
v_perm_b32 v56, v53, v19, s55
v_mfma_f32_16x16x32_bf16 v[180:183], a[240:243], a[180:183], v[180:183]
s_cbranch_scc1 L_SLOW29
L_BACK29:
v_mfma_f32_16x16x32_bf16 v[184:187], a[240:243], a[184:187], v[184:187]
ds_read_b32 a15, v56
v_perm_b32 v63, v96, v19, s52
v_mfma_f32_16x16x32_bf16 v[184:187], a[244:247], a[200:203], v[184:187]
ds_read_b32 a16, v63
v_perm_b32 v62, v96, v19, s53
v_mfma_f32_16x16x32_bf16 v[188:191], a[244:247], a[204:207], v[188:191]
ds_read_b32 a17, v62
v_perm_b32 v61, v100, v19, s52
v_mfma_f32_16x16x32_bf16 v[188:191], a[240:243], a[188:191], v[188:191]
s_waitcnt lgkmcnt(3)
ds_read_b32 a18, v61
v_mfma_f32_16x16x32_bf16 v[160:163], a[248:251], a[192:195], v[160:163]
ds_read_b128 a[224:227], v17 offset:26624
v_perm_b32 v60, v100, v19, s53
v_mfma_f32_16x16x32_bf16 v[160:163], a[252:255], a[208:211], v[160:163]
ds_read_b32 a19, v60
v_mfma_f32_16x16x32_bf16 v[164:167], a[252:255], a[212:215], v[164:167]
ds_read_b128 a[228:231], v14 offset:10240
v_perm_b32 v59, v96, v19, s54
v_mfma_f32_16x16x32_bf16 v[164:167], a[248:251], a[196:199], v[164:167]
ds_read_b32 a20, v59
v_perm_b32 v58, v96, v19, s55
v_mfma_f32_16x16x32_bf16 v[168:171], a[248:251], a[200:203], v[168:171]
ds_read_b32 a21, v58
v_perm_b32 v57, v100, v19, s54
v_mfma_f32_16x16x32_bf16 v[168:171], a[252:255], a[216:219], v[168:171]
ds_read_b32 a22, v57
v_perm_b32 v56, v100, v19, s55
v_mfma_f32_16x16x32_bf16 v[172:175], a[252:255], a[220:223], v[172:175]
ds_read_b32 a23, v56
v_perm_b32 v63, v97, v19, s52
v_mfma_f32_16x16x32_bf16 v[172:175], a[248:251], a[204:207], v[172:175]
s_waitcnt lgkmcnt(4)
ds_read_b32 a24, v63
v_mfma_f32_16x16x32_bf16 v[208:211], a[224:227], a[144:147], v[208:211]
ds_read_b128 a[232:235], v15 offset:6144
v_perm_b32 v62, v97, v19, s53
v_mfma_f32_16x16x32_bf16 v[208:211], a[228:231], a[160:163], v[208:211]
ds_read_b32 a25, v62
v_mfma_f32_16x16x32_bf16 v[212:215], a[228:231], a[164:167], v[212:215]
ds_read_b128 a[236:239], v14 offset:22528
v_perm_b32 v61, v101, v19, s52
v_mfma_f32_16x16x32_bf16 v[212:215], a[224:227], a[148:151], v[212:215]
ds_read_b32 a26, v61
v_perm_b32 v60, v101, v19, s53
v_mfma_f32_16x16x32_bf16 v[216:219], a[224:227], a[152:155], v[216:219]
ds_read_b32 a27, v60
v_perm_b32 v59, v97, v19, s54
v_mfma_f32_16x16x32_bf16 v[216:219], a[228:231], a[168:171], v[216:219]
ds_read_b32 a28, v59
v_perm_b32 v58, v97, v19, s55
v_mfma_f32_16x16x32_bf16 v[220:223], a[228:231], a[172:175], v[220:223]
ds_read_b32 a29, v58
v_perm_b32 v57, v101, v19, s54
v_mfma_f32_16x16x32_bf16 v[220:223], a[224:227], a[156:159], v[220:223]
s_waitcnt lgkmcnt(4)
ds_read_b32 a30, v57
v_mfma_f32_16x16x32_bf16 v[144:147], a[232:235], a[208:211], v[144:147]
ds_read_b128 a[240:243], v14 offset:20480
v_mfma_f32_16x16x32_bf16 v[144:147], a[236:239], a[0:3], v[144:147]
s_waitcnt vmcnt(6)
v_cmp_ne_u64 s[50:51], s[88:89], v[82:83]
v_cmp_ne_u64 s[44:45], s[88:89], v[86:87]
v_mfma_f32_16x16x32_bf16 v[148:151], a[236:239], a[4:7], v[148:151]
ds_read_b128 a[244:247], v15 offset:20480
v_perm_b32 v56, v101, v19, s55
v_mfma_f32_16x16x32_bf16 v[148:151], a[232:235], a[212:215], v[148:151]
s_or_b64 s[50:51], s[44:45], s[50:51]
ds_read_b32 a31, v56
v_mfma_f32_16x16x32_bf16 v[152:155], a[232:235], a[216:219], v[152:155]
s_cbranch_scc1 L_SLOW30
L_BACK30:
v_mfma_f32_16x16x32_bf16 v[152:155], a[236:239], a[8:11], v[152:155]
v_perm_b32 v63, v80, v19, s52
v_mfma_f32_16x16x32_bf16 v[156:159], a[236:239], a[12:15], v[156:159]
ds_read_b32 a32, v63
v_perm_b32 v62, v80, v19, s53
v_mfma_f32_16x16x32_bf16 v[156:159], a[232:235], a[220:223], v[156:159]
s_waitcnt lgkmcnt(2)
ds_read_b32 a33, v62
v_mfma_f32_16x16x32_bf16 v[128:131], a[240:243], a[0:3], v[128:131]
s_barrier
ds_read_b128 a[248:251], v14 offset:12288
v_perm_b32 v61, v84, v19, s52
v_mfma_f32_16x16x32_bf16 v[128:131], a[244:247], a[16:19], v[128:131]
ds_read_b32 a34, v61
v_mfma_f32_16x16x32_bf16 v[132:135], a[244:247], a[20:23], v[132:135]
ds_read_b128 a[252:255], v15 offset:12288
v_perm_b32 v60, v84, v19, s53
v_mfma_f32_16x16x32_bf16 v[132:135], a[240:243], a[4:7], v[132:135]
ds_read_b32 a35, v60
v_perm_b32 v59, v80, v19, s54
v_mfma_f32_16x16x32_bf16 v[136:139], a[240:243], a[8:11], v[136:139]
ds_read_b32 a36, v59
v_perm_b32 v58, v80, v19, s55
v_mfma_f32_16x16x32_bf16 v[136:139], a[244:247], a[24:27], v[136:139]
s_waitcnt lgkmcnt(4)
ds_read_b32 a37, v58
v_perm_b32 v57, v84, v19, s54
v_mfma_f32_16x16x32_bf16 v[140:143], a[244:247], a[28:31], v[140:143]
ds_read_b32 a38, v57
v_perm_b32 v56, v84, v19, s55
v_mfma_f32_16x16x32_bf16 v[140:143], a[240:243], a[12:15], v[140:143]
s_waitcnt lgkmcnt(4)
ds_read_b32 a39, v56
v_mfma_f32_16x16x32_bf16 v[224:227], a[248:251], a[128:131], v[224:227]
ds_read_b128 a[224:227], v15 offset:18432
v_perm_b32 v63, v81, v19, s52
v_mfma_f32_16x16x32_bf16 v[224:227], a[252:255], a[144:147], v[224:227]
ds_read_b32 a40, v63
v_mfma_f32_16x16x32_bf16 v[228:231], a[252:255], a[148:151], v[228:231]
ds_read_b128 a[228:231], v14 offset:26624
v_perm_b32 v62, v81, v19, s53
v_mfma_f32_16x16x32_bf16 v[228:231], a[248:251], a[132:135], v[228:231]
ds_read_b32 a41, v62
v_perm_b32 v61, v85, v19, s52
v_mfma_f32_16x16x32_bf16 v[232:235], a[248:251], a[136:139], v[232:235]
ds_read_b32 a42, v61
v_perm_b32 v60, v85, v19, s53
v_mfma_f32_16x16x32_bf16 v[232:235], a[252:255], a[152:155], v[232:235]
ds_read_b32 a43, v60
v_perm_b32 v59, v81, v19, s54
v_mfma_f32_16x16x32_bf16 v[236:239], a[252:255], a[156:159], v[236:239]
ds_read_b32 a44, v59
v_perm_b32 v58, v81, v19, s55
v_mfma_f32_16x16x32_bf16 v[236:239], a[248:251], a[140:143], v[236:239]
s_waitcnt lgkmcnt(4)
ds_read_b32 a45, v58
v_mfma_f32_16x16x32_bf16 v[176:179], a[224:227], a[208:211], v[176:179]
ds_read_b128 a[232:235], v14 offset:24576
v_mfma_f32_16x16x32_bf16 v[176:179], a[228:231], a[0:3], v[176:179]
s_waitcnt vmcnt(3)
v_cmp_ne_u64 s[50:51], s[88:89], v[90:91]
v_cmp_ne_u64 s[44:45], s[88:89], v[94:95]
v_mfma_f32_16x16x32_bf16 v[180:183], a[228:231], a[4:7], v[180:183]
ds_read_b128 a[236:239], v15 offset:24576
v_perm_b32 v57, v85, v19, s54
v_mfma_f32_16x16x32_bf16 v[180:183], a[224:227], a[212:215], v[180:183]
s_or_b64 s[50:51], s[44:45], s[50:51]
ds_read_b32 a46, v57
v_perm_b32 v56, v85, v19, s55
v_mfma_f32_16x16x32_bf16 v[184:187], a[224:227], a[216:219], v[184:187]
s_cbranch_scc1 L_SLOW31
L_BACK31:
v_mfma_f32_16x16x32_bf16 v[184:187], a[228:231], a[8:11], v[184:187]
ds_read_b32 a47, v56
v_perm_b32 v63, v88, v19, s52
v_mfma_f32_16x16x32_bf16 v[188:191], a[228:231], a[12:15], v[188:191]
ds_read_b32 a48, v63
v_perm_b32 v62, v88, v19, s53
v_mfma_f32_16x16x32_bf16 v[188:191], a[224:227], a[220:223], v[188:191]
s_waitcnt lgkmcnt(3)
ds_read_b32 a49, v62
v_mfma_f32_16x16x32_bf16 v[160:163], a[232:235], a[0:3], v[160:163]
ds_read_b128 a[240:243], v14 offset:28672
v_perm_b32 v61, v92, v19, s52
v_mfma_f32_16x16x32_bf16 v[160:163], a[236:239], a[16:19], v[160:163]
ds_read_b32 a50, v61
v_mfma_f32_16x16x32_bf16 v[164:167], a[236:239], a[20:23], v[164:167]
ds_read_b128 a[244:247], v15 offset:28672
v_perm_b32 v60, v92, v19, s53
v_mfma_f32_16x16x32_bf16 v[164:167], a[232:235], a[4:7], v[164:167]
ds_read_b32 a51, v60
v_perm_b32 v59, v88, v19, s54
v_mfma_f32_16x16x32_bf16 v[168:171], a[232:235], a[8:11], v[168:171]
ds_read_b32 a52, v59
v_perm_b32 v58, v88, v19, s55
v_mfma_f32_16x16x32_bf16 v[168:171], a[236:239], a[24:27], v[168:171]
ds_read_b32 a53, v58
v_perm_b32 v57, v92, v19, s54
v_mfma_f32_16x16x32_bf16 v[172:175], a[236:239], a[28:31], v[172:175]
ds_read_b32 a54, v57
v_perm_b32 v56, v92, v19, s55
v_mfma_f32_16x16x32_bf16 v[172:175], a[232:235], a[12:15], v[172:175]
s_waitcnt lgkmcnt(4)
ds_read_b32 a55, v56
v_mfma_f32_16x16x32_bf16 v[192:195], a[240:243], a[192:195], v[192:195]
ds_read_b128 a[248:251], v15 offset:22528
v_perm_b32 v63, v89, v19, s52
v_mfma_f32_16x16x32_bf16 v[192:195], a[244:247], a[208:211], v[192:195]
ds_read_b32 a56, v63
v_mfma_f32_16x16x32_bf16 v[196:199], a[244:247], a[212:215], v[196:199]
ds_read_b128 a[252:255], v14 offset:34816
v_perm_b32 v62, v89, v19, s53
v_mfma_f32_16x16x32_bf16 v[196:199], a[240:243], a[196:199], v[196:199]
ds_read_b32 a57, v62
v_perm_b32 v61, v93, v19, s52
v_mfma_f32_16x16x32_bf16 v[200:203], a[240:243], a[200:203], v[200:203]
ds_read_b32 a58, v61
v_perm_b32 v60, v93, v19, s53
v_mfma_f32_16x16x32_bf16 v[200:203], a[244:247], a[216:219], v[200:203]
ds_read_b32 a59, v60
v_perm_b32 v59, v89, v19, s54
v_mfma_f32_16x16x32_bf16 v[204:207], a[244:247], a[220:223], v[204:207]
ds_read_b32 a60, v59
v_perm_b32 v58, v89, v19, s55
v_mfma_f32_16x16x32_bf16 v[204:207], a[240:243], a[204:207], v[204:207]
s_waitcnt lgkmcnt(4)
ds_read_b32 a61, v58
v_mfma_f32_16x16x32_bf16 v[144:147], a[248:251], a[16:19], v[144:147]
ds_read_b128 a[224:227], v14 offset:32768
v_perm_b32 v57, v93, v19, s54
v_mfma_f32_16x16x32_bf16 v[144:147], a[252:255], a[32:35], v[144:147]
ds_read_b32 a62, v57
v_mfma_f32_16x16x32_bf16 v[148:151], a[252:255], a[36:39], v[148:151]
ds_read_b128 a[228:231], v15 offset:32768
v_perm_b32 v56, v93, v19, s55
v_mfma_f32_16x16x32_bf16 v[148:151], a[248:251], a[20:23], v[148:151]
ds_read_b32 a63, v56
v_mfma_f32_16x16x32_bf16 v[152:155], a[248:251], a[24:27], v[152:155]
v_mfma_f32_16x16x32_bf16 v[152:155], a[252:255], a[40:43], v[152:155]
v_mfma_f32_16x16x32_bf16 v[156:159], a[252:255], a[44:47], v[156:159]
v_mfma_f32_16x16x32_bf16 v[156:159], a[248:251], a[28:31], v[156:159]
s_waitcnt lgkmcnt(1)
v_mfma_f32_16x16x32_bf16 v[128:131], a[224:227], a[32:35], v[128:131]
ds_read_b128 a[232:235], v15 offset:10240
v_mfma_f32_16x16x32_bf16 v[128:131], a[228:231], a[48:51], v[128:131]
v_mfma_f32_16x16x32_bf16 v[132:135], a[228:231], a[52:55], v[132:135]
ds_read_b128 a[236:239], v14 offset:30720
v_mfma_f32_16x16x32_bf16 v[132:135], a[224:227], a[36:39], v[132:135]
v_mfma_f32_16x16x32_bf16 v[136:139], a[224:227], a[40:43], v[136:139]
v_mfma_f32_16x16x32_bf16 v[136:139], a[228:231], a[56:59], v[136:139]
s_waitcnt lgkmcnt(1)
v_mfma_f32_16x16x32_bf16 v[140:143], a[228:231], a[60:63], v[140:143]
v_mfma_f32_16x16x32_bf16 v[140:143], a[224:227], a[44:47], v[140:143]
s_waitcnt lgkmcnt(0)
v_mfma_f32_16x16x32_bf16 v[208:211], a[232:235], a[176:179], v[208:211]
ds_read_b128 a[240:243], v15 offset:34816
v_mfma_f32_16x16x32_bf16 v[208:211], a[236:239], a[192:195], v[208:211]
v_mfma_f32_16x16x32_bf16 v[212:215], a[236:239], a[196:199], v[212:215]
v_mfma_f32_16x16x32_bf16 v[212:215], a[232:235], a[180:183], v[212:215]
v_mfma_f32_16x16x32_bf16 v[216:219], a[232:235], a[184:187], v[216:219]
s_waitcnt vmcnt(0)
s_barrier
ds_read_b128 a[244:247], v14 offset:40960
v_mfma_f32_16x16x32_bf16 v[216:219], a[236:239], a[200:203], v[216:219]
v_mfma_f32_16x16x32_bf16 v[220:223], a[236:239], a[204:207], v[220:223]
ds_read_b128 a[248:251], v15 offset:40960
v_mfma_f32_16x16x32_bf16 v[220:223], a[232:235], a[188:191], v[220:223]
s_waitcnt lgkmcnt(2)
v_mul_f32 v128, v128, v24
v_mul_f32 v132, v132, v25
v_mfma_f32_16x16x32_bf16 v[144:147], a[240:243], a[48:51], v[144:147]
L_PAD5:
s_cbranch_vccnz L_PADRET
v_mul_f32 v136, v136, v26
v_mul_f32 v140, v140, v27
v_mfma_f32_16x16x32_bf16 v[148:151], a[240:243], a[52:55], v[148:151]
v_cvt_pk_bf16_f32 v120, v128, v132
v_cvt_pk_bf16_f32 v121, v136, v140
v_mfma_f32_16x16x32_bf16 v[152:155], a[240:243], a[56:59], v[152:155]
buffer_store_dwordx2 v[120:121], v18, s[28:31], 0 offen nt
v_mul_f32 v129, v129, v24
v_mfma_f32_16x16x32_bf16 v[156:159], a[240:243], a[60:63], v[156:159]
s_waitcnt lgkmcnt(0)
v_mul_f32 v133, v133, v25
v_mul_f32 v137, v137, v26
v_mfma_f32_16x16x32_bf16 v[224:227], a[244:247], a[160:163], v[224:227]
s_add_u32 s28, s28, 7168
ds_read_b128 a[252:255], v17 offset:10240
v_mul_f32 v141, v141, v27
v_mfma_f32_16x16x32_bf16 v[224:227], a[248:251], a[176:179], v[224:227]
s_addc_u32 s29, s29, 0
v_cvt_pk_bf16_f32 v122, v129, v133
v_cvt_pk_bf16_f32 v123, v137, v141
v_mfma_f32_16x16x32_bf16 v[228:231], a[248:251], a[180:183], v[228:231]
ds_read_b128 a[224:227], v14 offset:2048
v_mfma_f32_16x16x32_bf16 v[228:231], a[244:247], a[164:167], v[228:231]
buffer_store_dwordx2 v[122:123], v18, s[28:31], 0 offen nt
v_mul_f32 v130, v130, v24
v_mfma_f32_16x16x32_bf16 v[232:235], a[244:247], a[168:171], v[232:235]
s_add_u32 s28, s28, 7168
v_mul_f32 v134, v134, v25
v_mul_f32 v138, v138, v26
v_mfma_f32_16x16x32_bf16 v[232:235], a[248:251], a[184:187], v[232:235]
s_addc_u32 s29, s29, 0
v_mul_f32 v142, v142, v27
v_cvt_pk_bf16_f32 v124, v130, v134
v_mfma_f32_16x16x32_bf16 v[236:239], a[248:251], a[188:191], v[236:239]
v_cvt_pk_bf16_f32 v125, v138, v142
v_mfma_f32_16x16x32_bf16 v[236:239], a[244:247], a[172:175], v[236:239]
s_waitcnt lgkmcnt(0)
v_mfma_f32_16x16x32_bf16 v[240:243], a[252:255], a[80:83], v[240:243]
ds_read_b128 a[228:231], v14 offset:45056
v_mfma_f32_16x16x32_bf16 v[240:243], a[224:227], a[96:99], v[240:243]
buffer_store_dwordx2 v[124:125], v18, s[28:31], 0 offen nt
v_mul_f32 v131, v131, v24
v_mfma_f32_16x16x32_bf16 v[244:247], a[224:227], a[100:103], v[244:247]
s_add_u32 s28, s28, 7168
ds_read_b128 a[232:235], v15 offset:45056
v_mul_f32 v135, v135, v25
v_mfma_f32_16x16x32_bf16 v[244:247], a[252:255], a[84:87], v[244:247]
s_addc_u32 s29, s29, 0
v_mul_f32 v139, v139, v26
v_mul_f32 v143, v143, v27
v_mfma_f32_16x16x32_bf16 v[248:251], a[252:255], a[88:91], v[248:251]
v_cvt_pk_bf16_f32 v126, v131, v135
v_cvt_pk_bf16_f32 v127, v139, v143
v_mfma_f32_16x16x32_bf16 v[248:251], a[224:227], a[104:107], v[248:251]
buffer_store_dwordx2 v[126:127], v18, s[28:31], 0 offen nt
v_mul_f32 v144, v144, v24
v_mfma_f32_16x16x32_bf16 v[252:255], a[224:227], a[108:111], v[252:255]
s_add_u32 s28, s28, 93184
v_mul_f32 v148, v148, v25
v_mul_f32 v152, v152, v26
v_mfma_f32_16x16x32_bf16 v[252:255], a[252:255], a[92:95], v[252:255]
s_waitcnt lgkmcnt(0)
v_mul_f32 v156, v156, v27
v_cvt_pk_bf16_f32 v120, v144, v148
v_mfma_f32_16x16x32_bf16 v[160:163], a[228:231], a[32:35], v[160:163]
s_addc_u32 s29, s29, 0
ds_read_b128 a[236:239], v15 offset:26624
v_cvt_pk_bf16_f32 v121, v152, v156
v_mfma_f32_16x16x32_bf16 v[160:163], a[232:235], a[48:51], v[160:163]
buffer_store_dwordx2 v[120:121], v18, s[28:31], 0 offen nt
v_mul_f32 v145, v145, v24
v_mfma_f32_16x16x32_bf16 v[164:167], a[232:235], a[52:55], v[164:167]
s_add_u32 s28, s28, 7168
ds_read_b128 a[240:243], v14 offset:47104
v_mul_f32 v149, v149, v25
v_mfma_f32_16x16x32_bf16 v[164:167], a[228:231], a[36:39], v[164:167]
s_addc_u32 s29, s29, 0
v_mul_f32 v153, v153, v26
v_mul_f32 v157, v157, v27
v_mfma_f32_16x16x32_bf16 v[168:171], a[228:231], a[40:43], v[168:171]
v_cvt_pk_bf16_f32 v122, v145, v149
v_cvt_pk_bf16_f32 v123, v153, v157
v_mfma_f32_16x16x32_bf16 v[168:171], a[232:235], a[56:59], v[168:171]
buffer_store_dwordx2 v[122:123], v18, s[28:31], 0 offen nt
v_mul_f32 v146, v146, v24
v_mfma_f32_16x16x32_bf16 v[172:175], a[232:235], a[60:63], v[172:175]
s_add_u32 s28, s28, 7168
v_mul_f32 v150, v150, v25
v_mul_f32 v154, v154, v26
v_mfma_f32_16x16x32_bf16 v[172:175], a[228:231], a[44:47], v[172:175]
s_waitcnt lgkmcnt(0)
v_mul_f32 v158, v158, v27
v_cvt_pk_bf16_f32 v124, v146, v150
v_mfma_f32_16x16x32_bf16 v[176:179], a[236:239], a[16:19], v[176:179]
s_addc_u32 s29, s29, 0
ds_read_b128 a[244:247], v14 offset:49152
v_cvt_pk_bf16_f32 v125, v154, v158
v_mfma_f32_16x16x32_bf16 v[176:179], a[240:243], a[32:35], v[176:179]
buffer_store_dwordx2 v[124:125], v18, s[28:31], 0 offen nt
v_mul_f32 v147, v147, v24
v_mfma_f32_16x16x32_bf16 v[180:183], a[240:243], a[36:39], v[180:183]
s_add_u32 s28, s28, 7168
ds_read_b128 a[248:251], v15 offset:49152
v_mul_f32 v151, v151, v25
v_mfma_f32_16x16x32_bf16 v[180:183], a[236:239], a[20:23], v[180:183]
s_addc_u32 s29, s29, 0
v_mul_f32 v155, v155, v26
v_mul_f32 v159, v159, v27
v_mfma_f32_16x16x32_bf16 v[184:187], a[236:239], a[24:27], v[184:187]
v_cvt_pk_bf16_f32 v126, v147, v151
v_cvt_pk_bf16_f32 v127, v155, v159
v_mfma_f32_16x16x32_bf16 v[184:187], a[240:243], a[40:43], v[184:187]
buffer_store_dwordx2 v[126:127], v18, s[28:31], 0 offen nt
v_mfma_f32_16x16x32_bf16 v[188:191], a[240:243], a[44:47], v[188:191]
v_mfma_f32_16x16x32_bf16 v[188:191], a[236:239], a[28:31], v[188:191]
s_waitcnt lgkmcnt(0)
v_mul_f32 v160, v160, v24
v_mul_f32 v164, v164, v25
v_mfma_f32_16x16x32_bf16 v[192:195], a[244:247], a[0:3], v[192:195]
s_add_u32 s28, s28, 93184
ds_read_b128 a[252:255], v15 offset:30720
v_mul_f32 v168, v168, v26
v_mfma_f32_16x16x32_bf16 v[192:195], a[248:251], a[16:19], v[192:195]
s_addc_u32 s29, s29, 0
v_mul_f32 v172, v172, v27
v_cvt_pk_bf16_f32 v120, v160, v164
v_mfma_f32_16x16x32_bf16 v[196:199], a[248:251], a[20:23], v[196:199]
ds_read_b128 a[224:227], v14 offset:51200
v_cvt_pk_bf16_f32 v121, v168, v172
v_mfma_f32_16x16x32_bf16 v[196:199], a[244:247], a[4:7], v[196:199]
buffer_store_dwordx2 v[120:121], v18, s[28:31], 0 offen nt
v_mul_f32 v161, v161, v24
v_mfma_f32_16x16x32_bf16 v[200:203], a[244:247], a[8:11], v[200:203]
s_add_u32 s28, s28, 7168
v_mul_f32 v165, v165, v25
v_mul_f32 v169, v169, v26
v_mfma_f32_16x16x32_bf16 v[200:203], a[248:251], a[24:27], v[200:203]
s_addc_u32 s29, s29, 0
v_mul_f32 v173, v173, v27
v_cvt_pk_bf16_f32 v122, v161, v165
v_mfma_f32_16x16x32_bf16 v[204:207], a[248:251], a[28:31], v[204:207]
v_cvt_pk_bf16_f32 v123, v169, v173
v_mfma_f32_16x16x32_bf16 v[204:207], a[244:247], a[12:15], v[204:207]
s_waitcnt lgkmcnt(0)
v_mfma_f32_16x16x32_bf16 v[208:211], a[252:255], a[208:211], v[208:211]
ds_read_b128 a[228:231], v15 offset:47104
v_mfma_f32_16x16x32_bf16 v[208:211], a[224:227], a[0:3], v[208:211]
buffer_store_dwordx2 v[122:123], v18, s[28:31], 0 offen nt
v_mul_f32 v162, v162, v24
v_mfma_f32_16x16x32_bf16 v[212:215], a[224:227], a[4:7], v[212:215]
s_add_u32 s28, s28, 7168
v_mul_f32 v166, v166, v25
v_mul_f32 v170, v170, v26
v_mfma_f32_16x16x32_bf16 v[212:215], a[252:255], a[212:215], v[212:215]
s_addc_u32 s29, s29, 0
v_mul_f32 v174, v174, v27
v_cvt_pk_bf16_f32 v124, v162, v166
v_mfma_f32_16x16x32_bf16 v[216:219], a[252:255], a[216:219], v[216:219]
ds_read_b128 a[232:235], v14 offset:36864
v_cvt_pk_bf16_f32 v125, v170, v174
v_mfma_f32_16x16x32_bf16 v[216:219], a[224:227], a[8:11], v[216:219]
buffer_store_dwordx2 v[124:125], v18, s[28:31], 0 offen nt
v_mul_f32 v163, v163, v24
v_mfma_f32_16x16x32_bf16 v[220:223], a[224:227], a[12:15], v[220:223]
s_add_u32 s28, s28, 7168
ds_read_b128 a[236:239], v15 offset:36864
v_mul_f32 v167, v167, v25
v_mfma_f32_16x16x32_bf16 v[220:223], a[252:255], a[220:223], v[220:223]
s_waitcnt lgkmcnt(2)
v_mul_f32 v171, v171, v26
v_mul_f32 v175, v175, v27
v_mfma_f32_16x16x32_bf16 v[176:179], a[228:231], a[48:51], v[176:179]
s_addc_u32 s29, s29, 0
v_cvt_pk_bf16_f32 v126, v163, v167
v_cvt_pk_bf16_f32 v127, v171, v175
v_mfma_f32_16x16x32_bf16 v[180:183], a[228:231], a[52:55], v[180:183]
buffer_store_dwordx2 v[126:127], v18, s[28:31], 0 offen nt
v_mfma_f32_16x16x32_bf16 v[184:187], a[228:231], a[56:59], v[184:187]
v_mfma_f32_16x16x32_bf16 v[188:191], a[228:231], a[60:63], v[188:191]
s_waitcnt lgkmcnt(0)
v_mfma_f32_16x16x32_bf16 v[224:227], a[232:235], a[192:195], v[224:227]
ds_read_b128 a[240:243], v14 offset:61440
v_mfma_f32_16x16x32_bf16 v[224:227], a[236:239], a[208:211], v[224:227]
v_mfma_f32_16x16x32_bf16 v[228:231], a[236:239], a[212:215], v[228:231]
ds_read_b128 a[244:247], v15 offset:61440
v_mfma_f32_16x16x32_bf16 v[228:231], a[232:235], a[196:199], v[228:231]
v_mfma_f32_16x16x32_bf16 v[232:235], a[232:235], a[200:203], v[232:235]
v_mfma_f32_16x16x32_bf16 v[232:235], a[236:239], a[216:219], v[232:235]
v_mfma_f32_16x16x32_bf16 v[236:239], a[236:239], a[220:223], v[236:239]
v_mfma_f32_16x16x32_bf16 v[236:239], a[232:235], a[204:207], v[236:239]
s_waitcnt lgkmcnt(0)
v_mul_f32 v176, v176, v24
v_mul_f32 v180, v180, v25
v_mfma_f32_16x16x32_bf16 v[192:195], a[240:243], a[32:35], v[192:195]
s_add_u32 s28, s28, 93184
ds_read_b128 a[248:251], v15 offset:51200
v_mul_f32 v184, v184, v26
v_mfma_f32_16x16x32_bf16 v[192:195], a[244:247], a[48:51], v[192:195]
s_addc_u32 s29, s29, 0
v_mul_f32 v188, v188, v27
v_cvt_pk_bf16_f32 v120, v176, v180
v_mfma_f32_16x16x32_bf16 v[196:199], a[244:247], a[52:55], v[196:199]
ds_read_b128 a[252:255], v14 offset:63488
v_cvt_pk_bf16_f32 v121, v184, v188
v_mfma_f32_16x16x32_bf16 v[196:199], a[240:243], a[36:39], v[196:199]
buffer_store_dwordx2 v[120:121], v18, s[28:31], 0 offen nt
v_mul_f32 v177, v177, v24
v_mfma_f32_16x16x32_bf16 v[200:203], a[240:243], a[40:43], v[200:203]
s_add_u32 s28, s28, 7168
v_mul_f32 v181, v181, v25
v_mul_f32 v185, v185, v26
v_mfma_f32_16x16x32_bf16 v[200:203], a[244:247], a[56:59], v[200:203]
s_addc_u32 s29, s29, 0
v_mul_f32 v189, v189, v27
v_cvt_pk_bf16_f32 v122, v177, v181
v_mfma_f32_16x16x32_bf16 v[204:207], a[244:247], a[60:63], v[204:207]
v_cvt_pk_bf16_f32 v123, v185, v189
v_mfma_f32_16x16x32_bf16 v[204:207], a[240:243], a[44:47], v[204:207]
s_waitcnt lgkmcnt(0)
v_mfma_f32_16x16x32_bf16 v[208:211], a[248:251], a[16:19], v[208:211]
ds_read_b128 a[224:227], v15 offset:2048
v_mfma_f32_16x16x32_bf16 v[208:211], a[252:255], a[32:35], v[208:211]
buffer_store_dwordx2 v[122:123], v18, s[28:31], 0 offen nt
v_mul_f32 v178, v178, v24
v_mfma_f32_16x16x32_bf16 v[212:215], a[252:255], a[36:39], v[212:215]
s_add_u32 s28, s28, 7168
ds_read_b128 a[228:231], v14 offset:14336
v_mul_f32 v182, v182, v25
v_mfma_f32_16x16x32_bf16 v[212:215], a[248:251], a[20:23], v[212:215]
s_addc_u32 s29, s29, 0
v_mul_f32 v186, v186, v26
v_mul_f32 v190, v190, v27
v_mfma_f32_16x16x32_bf16 v[216:219], a[248:251], a[24:27], v[216:219]
v_cvt_pk_bf16_f32 v124, v178, v182
v_cvt_pk_bf16_f32 v125, v186, v190
v_mfma_f32_16x16x32_bf16 v[216:219], a[252:255], a[40:43], v[216:219]
buffer_store_dwordx2 v[124:125], v18, s[28:31], 0 offen nt
v_mul_f32 v179, v179, v24
v_mfma_f32_16x16x32_bf16 v[220:223], a[252:255], a[44:47], v[220:223]
s_add_u32 s28, s28, 7168
v_mul_f32 v183, v183, v25
v_mul_f32 v187, v187, v26
v_mfma_f32_16x16x32_bf16 v[220:223], a[248:251], a[28:31], v[220:223]
s_waitcnt lgkmcnt(0)
v_mul_f32 v191, v191, v27
v_cvt_pk_bf16_f32 v126, v179, v183
v_mfma_f32_16x16x32_bf16 v[240:243], a[224:227], a[112:115], v[240:243]
s_addc_u32 s29, s29, 0
ds_read_b128 a[232:235], v15 offset:63488
v_cvt_pk_bf16_f32 v127, v187, v191
v_mfma_f32_16x16x32_bf16 v[240:243], a[228:231], a[128:131], v[240:243]
buffer_store_dwordx2 v[126:127], v18, s[28:31], 0 offen nt
v_mul_f32 v192, v192, v24
v_mfma_f32_16x16x32_bf16 v[244:247], a[228:231], a[132:135], v[244:247]
s_add_u32 s28, s28, 93184
v_mul_f32 v196, v196, v25
v_mul_f32 v200, v200, v26
v_mfma_f32_16x16x32_bf16 v[244:247], a[224:227], a[116:119], v[244:247]
s_addc_u32 s29, s29, 0
v_mul_f32 v204, v204, v27
v_cvt_pk_bf16_f32 v120, v192, v196
v_mfma_f32_16x16x32_bf16 v[248:251], a[224:227], a[120:123], v[248:251]
ds_read_b128 a[236:239], v14 offset:57344
v_cvt_pk_bf16_f32 v121, v200, v204
v_mfma_f32_16x16x32_bf16 v[248:251], a[228:231], a[136:139], v[248:251]
buffer_store_dwordx2 v[120:121], v18, s[28:31], 0 offen nt
v_mul_f32 v193, v193, v24
v_mfma_f32_16x16x32_bf16 v[252:255], a[228:231], a[140:143], v[252:255]
s_add_u32 s28, s28, 7168
ds_read_b128 a[240:243], v15 offset:57344
v_mul_f32 v197, v197, v25
v_mfma_f32_16x16x32_bf16 v[252:255], a[224:227], a[124:127], v[252:255]
s_waitcnt lgkmcnt(2)
v_mul_f32 v201, v201, v26
v_mul_f32 v205, v205, v27
v_mfma_f32_16x16x32_bf16 v[208:211], a[232:235], a[48:51], v[208:211]
s_addc_u32 s29, s29, 0
v_cvt_pk_bf16_f32 v122, v193, v197
v_cvt_pk_bf16_f32 v123, v201, v205
v_mfma_f32_16x16x32_bf16 v[212:215], a[232:235], a[52:55], v[212:215]
buffer_store_dwordx2 v[122:123], v18, s[28:31], 0 offen nt
v_mul_f32 v194, v194, v24
v_mfma_f32_16x16x32_bf16 v[216:219], a[232:235], a[56:59], v[216:219]
s_add_u32 s28, s28, 7168
v_mul_f32 v198, v198, v25
v_mul_f32 v202, v202, v26
v_mfma_f32_16x16x32_bf16 v[220:223], a[232:235], a[60:63], v[220:223]
s_waitcnt lgkmcnt(0)
v_mul_f32 v206, v206, v27
v_cvt_pk_bf16_f32 v124, v194, v198
v_mfma_f32_16x16x32_bf16 v[224:227], a[236:239], a[0:3], v[224:227]
s_addc_u32 s29, s29, 0
ds_read_b128 a[244:247], v16 offset:0
v_cvt_pk_bf16_f32 v125, v202, v206
v_mfma_f32_16x16x32_bf16 v[224:227], a[240:243], a[16:19], v[224:227]
buffer_store_dwordx2 v[124:125], v18, s[28:31], 0 offen nt
v_mul_f32 v195, v195, v24
v_mfma_f32_16x16x32_bf16 v[228:231], a[240:243], a[20:23], v[228:231]
s_add_u32 s28, s28, 7168
ds_read_b128 a[248:251], v17 offset:0
v_mul_f32 v199, v199, v25
v_mfma_f32_16x16x32_bf16 v[228:231], a[236:239], a[4:7], v[228:231]
s_addc_u32 s29, s29, 0
v_mul_f32 v203, v203, v26
v_mul_f32 v207, v207, v27
v_mfma_f32_16x16x32_bf16 v[232:235], a[236:239], a[8:11], v[232:235]
v_cvt_pk_bf16_f32 v126, v195, v199
v_cvt_pk_bf16_f32 v127, v203, v207
v_mfma_f32_16x16x32_bf16 v[232:235], a[240:243], a[24:27], v[232:235]
buffer_store_dwordx2 v[126:127], v18, s[28:31], 0 offen nt
v_mfma_f32_16x16x32_bf16 v[236:239], a[240:243], a[28:31], v[236:239]
v_mfma_f32_16x16x32_bf16 v[236:239], a[236:239], a[12:15], v[236:239]
s_waitcnt lgkmcnt(0)
v_mul_f32 v208, v208, v24
v_mul_f32 v212, v212, v25
v_mfma_f32_16x16x32_bf16 v[224:227], a[244:247], a[32:35], v[224:227]
s_add_u32 s28, s28, 93184
ds_read_b128 a[252:255], v15 offset:14336
v_mul_f32 v216, v216, v26
v_mfma_f32_16x16x32_bf16 v[224:227], a[248:251], a[48:51], v[224:227]
s_addc_u32 s29, s29, 0
v_mul_f32 v220, v220, v27
v_cvt_pk_bf16_f32 v120, v208, v212
v_mfma_f32_16x16x32_bf16 v[228:231], a[248:251], a[52:55], v[228:231]
ds_read_b128 a[224:227], v14 offset:43008
v_cvt_pk_bf16_f32 v121, v216, v220
v_mfma_f32_16x16x32_bf16 v[228:231], a[244:247], a[36:39], v[228:231]
buffer_store_dwordx2 v[120:121], v18, s[28:31], 0 offen nt
v_mul_f32 v209, v209, v24
v_mfma_f32_16x16x32_bf16 v[232:235], a[244:247], a[40:43], v[232:235]
s_add_u32 s28, s28, 7168
v_mul_f32 v213, v213, v25
v_mul_f32 v217, v217, v26
v_mfma_f32_16x16x32_bf16 v[232:235], a[248:251], a[56:59], v[232:235]
s_addc_u32 s29, s29, 0
v_mul_f32 v221, v221, v27
v_cvt_pk_bf16_f32 v122, v209, v213
v_mfma_f32_16x16x32_bf16 v[236:239], a[248:251], a[60:63], v[236:239]
v_cvt_pk_bf16_f32 v123, v217, v221
v_mfma_f32_16x16x32_bf16 v[236:239], a[244:247], a[44:47], v[236:239]
s_waitcnt lgkmcnt(0)
v_mfma_f32_16x16x32_bf16 v[240:243], a[252:255], a[144:147], v[240:243]
ds_read_b128 a[228:231], v15 offset:43008
v_mfma_f32_16x16x32_bf16 v[240:243], a[224:227], a[160:163], v[240:243]
buffer_store_dwordx2 v[122:123], v18, s[28:31], 0 offen nt
v_mul_f32 v210, v210, v24
v_mfma_f32_16x16x32_bf16 v[244:247], a[224:227], a[164:167], v[244:247]
s_add_u32 s28, s28, 7168
ds_read_b128 a[232:235], v14 offset:38912
v_mul_f32 v214, v214, v25
v_mfma_f32_16x16x32_bf16 v[244:247], a[252:255], a[148:151], v[244:247]
s_addc_u32 s29, s29, 0
v_mul_f32 v218, v218, v26
v_mul_f32 v222, v222, v27
v_mfma_f32_16x16x32_bf16 v[248:251], a[252:255], a[152:155], v[248:251]
v_cvt_pk_bf16_f32 v124, v210, v214
v_cvt_pk_bf16_f32 v125, v218, v222
v_mfma_f32_16x16x32_bf16 v[248:251], a[224:227], a[168:171], v[248:251]
buffer_store_dwordx2 v[124:125], v18, s[28:31], 0 offen nt
v_mul_f32 v211, v211, v24
v_mfma_f32_16x16x32_bf16 v[252:255], a[224:227], a[172:175], v[252:255]
s_add_u32 s28, s28, 7168
v_mul_f32 v215, v215, v25
v_mul_f32 v219, v219, v26
v_mfma_f32_16x16x32_bf16 v[252:255], a[252:255], a[156:159], v[252:255]
s_waitcnt lgkmcnt(0)
v_mul_f32 v223, v223, v27
v_cvt_pk_bf16_f32 v126, v211, v215
v_mfma_f32_16x16x32_bf16 v[240:243], a[228:231], a[176:179], v[240:243]
s_addc_u32 s29, s29, 0
ds_read_b128 a[236:239], v15 offset:38912
v_cvt_pk_bf16_f32 v127, v219, v223
v_mfma_f32_16x16x32_bf16 v[240:243], a[232:235], a[192:195], v[240:243]
buffer_store_dwordx2 v[126:127], v18, s[28:31], 0 offen nt
v_mul_f32 v224, v224, v24
v_mfma_f32_16x16x32_bf16 v[244:247], a[232:235], a[196:199], v[244:247]
s_add_u32 s28, s28, 93184
ds_read_b128 a[240:243], v14 offset:59392
v_mul_f32 v228, v228, v25
v_mfma_f32_16x16x32_bf16 v[244:247], a[228:231], a[180:183], v[244:247]
s_addc_u32 s29, s29, 0
v_mul_f32 v232, v232, v26
v_mul_f32 v236, v236, v27
v_mfma_f32_16x16x32_bf16 v[248:251], a[228:231], a[184:187], v[248:251]
v_cvt_pk_bf16_f32 v120, v224, v228
v_cvt_pk_bf16_f32 v121, v232, v236
v_mfma_f32_16x16x32_bf16 v[248:251], a[232:235], a[200:203], v[248:251]
buffer_store_dwordx2 v[120:121], v18, s[28:31], 0 offen nt
v_mul_f32 v225, v225, v24
v_mfma_f32_16x16x32_bf16 v[252:255], a[232:235], a[204:207], v[252:255]
s_add_u32 s28, s28, 7168
v_mul_f32 v229, v229, v25
v_mul_f32 v233, v233, v26
v_mfma_f32_16x16x32_bf16 v[252:255], a[228:231], a[188:191], v[252:255]
s_waitcnt lgkmcnt(0)
v_mul_f32 v237, v237, v27
v_cvt_pk_bf16_f32 v122, v225, v229
v_mfma_f32_16x16x32_bf16 v[240:243], a[236:239], a[208:211], v[240:243]
s_addc_u32 s29, s29, 0
ds_read_b128 a[244:247], v15 offset:59392
v_cvt_pk_bf16_f32 v123, v233, v237
v_mfma_f32_16x16x32_bf16 v[240:243], a[240:243], a[0:3], v[240:243]
buffer_store_dwordx2 v[122:123], v18, s[28:31], 0 offen nt
v_mul_f32 v226, v226, v24
v_mfma_f32_16x16x32_bf16 v[244:247], a[240:243], a[4:7], v[244:247]
s_add_u32 s28, s28, 7168
ds_read_b128 a[248:251], v16 offset:2048
v_mul_f32 v230, v230, v25
v_mfma_f32_16x16x32_bf16 v[244:247], a[236:239], a[212:215], v[244:247]
s_addc_u32 s29, s29, 0
v_mul_f32 v234, v234, v26
v_mul_f32 v238, v238, v27
v_mfma_f32_16x16x32_bf16 v[248:251], a[236:239], a[216:219], v[248:251]
v_cvt_pk_bf16_f32 v124, v226, v230
v_cvt_pk_bf16_f32 v125, v234, v238
v_mfma_f32_16x16x32_bf16 v[248:251], a[240:243], a[8:11], v[248:251]
buffer_store_dwordx2 v[124:125], v18, s[28:31], 0 offen nt
v_mul_f32 v227, v227, v24
v_mfma_f32_16x16x32_bf16 v[252:255], a[240:243], a[12:15], v[252:255]
s_add_u32 s28, s28, 7168
v_mul_f32 v231, v231, v25
v_mul_f32 v235, v235, v26
v_mfma_f32_16x16x32_bf16 v[252:255], a[236:239], a[220:223], v[252:255]
s_waitcnt lgkmcnt(0)
v_mul_f32 v239, v239, v27
v_cvt_pk_bf16_f32 v126, v227, v231
v_mfma_f32_16x16x32_bf16 v[240:243], a[244:247], a[16:19], v[240:243]
s_addc_u32 s29, s29, 0
ds_read_b128 a[252:255], v17 offset:2048
v_cvt_pk_bf16_f32 v127, v235, v239
v_mfma_f32_16x16x32_bf16 v[240:243], a[248:251], a[32:35], v[240:243]
buffer_store_dwordx2 v[126:127], v18, s[28:31], 0 offen nt
v_mfma_f32_16x16x32_bf16 v[244:247], a[248:251], a[36:39], v[244:247]
v_mfma_f32_16x16x32_bf16 v[244:247], a[244:247], a[20:23], v[244:247]
v_mfma_f32_16x16x32_bf16 v[248:251], a[244:247], a[24:27], v[248:251]
v_mfma_f32_16x16x32_bf16 v[248:251], a[248:251], a[40:43], v[248:251]
v_mfma_f32_16x16x32_bf16 v[252:255], a[248:251], a[44:47], v[252:255]
v_mfma_f32_16x16x32_bf16 v[252:255], a[244:247], a[28:31], v[252:255]
s_waitcnt lgkmcnt(0)
v_mfma_f32_16x16x32_bf16 v[240:243], a[252:255], a[48:51], v[240:243]
v_mfma_f32_16x16x32_bf16 v[244:247], a[252:255], a[52:55], v[244:247]
v_mfma_f32_16x16x32_bf16 v[248:251], a[252:255], a[56:59], v[248:251]
v_mfma_f32_16x16x32_bf16 v[252:255], a[252:255], a[60:63], v[252:255]
s_nop 7
v_pk_mul_f32 v[240:241], v[240:241], v[24:25] op_sel:[0,0] op_sel_hi:[1,0]
v_pk_mul_f32 v[244:245], v[244:245], v[24:25] op_sel:[0,1] op_sel_hi:[1,1]
v_pk_mul_f32 v[248:249], v[248:249], v[26:27] op_sel:[0,0] op_sel_hi:[1,0]
v_pk_mul_f32 v[252:253], v[252:253], v[26:27] op_sel:[0,1] op_sel_hi:[1,1]
v_cvt_pk_bf16_f32 v120, v240, v244
v_cvt_pk_bf16_f32 v121, v248, v252
s_add_u32 s28, s28, 93184
s_addc_u32 s29, s29, 0
buffer_store_dwordx2 v[120:121], v18, s[28:31], 0 offen nt
v_cvt_pk_bf16_f32 v122, v241, v245
v_cvt_pk_bf16_f32 v123, v249, v253
s_add_u32 s28, s28, 7168
s_addc_u32 s29, s29, 0
buffer_store_dwordx2 v[122:123], v18, s[28:31], 0 offen nt
v_pk_mul_f32 v[242:243], v[242:243], v[24:25] op_sel:[0,0] op_sel_hi:[1,0]
v_pk_mul_f32 v[246:247], v[246:247], v[24:25] op_sel:[0,1] op_sel_hi:[1,1]
v_pk_mul_f32 v[250:251], v[250:251], v[26:27] op_sel:[0,0] op_sel_hi:[1,0]
v_pk_mul_f32 v[254:255], v[254:255], v[26:27] op_sel:[0,1] op_sel_hi:[1,1]
v_cvt_pk_bf16_f32 v124, v242, v246
v_cvt_pk_bf16_f32 v125, v250, v254
s_add_u32 s28, s28, 7168
s_addc_u32 s29, s29, 0
buffer_store_dwordx2 v[124:125], v18, s[28:31], 0 offen nt
v_cvt_pk_bf16_f32 v126, v243, v247
v_cvt_pk_bf16_f32 v127, v251, v255
s_add_u32 s28, s28, 7168
s_addc_u32 s29, s29, 0
buffer_store_dwordx2 v[126:127], v18, s[28:31], 0 offen nt
s_endpgm
L_NOTAG:
buffer_load_dwordx2 v[22:23], off, s[80:83], 0 sc1
s_waitcnt vmcnt(0)
v_readfirstlane_b32 s88, v22
v_readfirstlane_b32 s89, v23
s_sub_u32 s90, s90, 1
s_nop 0
s_cmp_eq_u64 s[88:89], 0
s_cbranch_scc0 L_TAGOK
s_cmp_gt_i32 s90, 0
s_cbranch_scc1 L_NOTAG
s_mov_b32 s26, 0
s_mov_b32 s78, 0
s_mov_b64 s[88:89], 1
s_branch L_TAGOK
.p2align 6
L_PADS:
s_cbranch_vccnz L_PADRET
L_TRY:
s_waitcnt vmcnt(0)
v_cmp_ne_u64 s[50:51], s[88:89], v[122:123]
v_cmp_ne_u64 s[44:45], s[88:89], v[126:127]
s_sub_u32 s90, s90, 1
s_nop 0
s_or_b64 s[50:51], s[44:45], s[50:51]
s_cbranch_scc0 L_WRET
s_cmp_gt_i32 s90, 0
s_cbranch_scc0 L_SELF
L_WRET:
s_setpc_b64 s[100:101]
L_SLOW2:
s_lshr_b32 s91, s41, 6
s_add_u32 s91, s91, 0
s_lshl_b32 s47, s91, 11
buffer_load_dwordx4 v[120:123], v13, s[24:27], s47 offen offset:0 sc1
buffer_load_dwordx4 v[124:127], v13, s[24:27], s47 offen offset:1024 sc1
s_lshr_b32 s47, s41, 6
s_add_u32 s47, s47, 1
s_lshl_b32 s47, s47, 11
buffer_load_dwordx4 v[40:43], v13, s[24:27], s47 offen offset:0 sc1
buffer_load_dwordx4 v[44:47], v13, s[24:27], s47 offen offset:1024 sc1
s_lshr_b32 s47, s42, 6
s_add_u32 s47, s47, 0
s_lshl_b32 s47, s47, 11
buffer_load_dwordx4 v[48:51], v13, s[24:27], s47 offen offset:0 sc1
buffer_load_dwordx4 v[52:55], v13, s[24:27], s47 offen offset:1024 sc1
s_call_b64 s[100:101], L_TRY
s_cbranch_scc1 L_SLOW2
v_mov_b64 v[32:33], v[120:121]
v_mov_b64 v[36:37], v[124:125]
s_branch L_BACK2
L_SLOW3:
s_lshr_b32 s91, s41, 6
s_add_u32 s91, s91, 1
s_lshl_b32 s47, s91, 11
buffer_load_dwordx4 v[120:123], v13, s[24:27], s47 offen offset:0 sc1
buffer_load_dwordx4 v[124:127], v13, s[24:27], s47 offen offset:1024 sc1
s_lshr_b32 s47, s42, 6
s_add_u32 s47, s47, 0
s_lshl_b32 s47, s47, 11
buffer_load_dwordx4 v[48:51], v13, s[24:27], s47 offen offset:0 sc1
buffer_load_dwordx4 v[52:55], v13, s[24:27], s47 offen offset:1024 sc1
s_lshr_b32 s47, s42, 6
s_add_u32 s47, s47, 1
s_lshl_b32 s47, s47, 11
buffer_load_dwordx4 v[96:99], v13, s[24:27], s47 offen offset:0 sc1
buffer_load_dwordx4 v[100:103], v13, s[24:27], s47 offen offset:1024 sc1
s_call_b64 s[100:101], L_TRY
s_cbranch_scc1 L_SLOW3
v_mov_b64 v[40:41], v[120:121]
v_mov_b64 v[44:45], v[124:125]
s_branch L_BACK3
L_SLOW4:
s_lshr_b32 s91, s42, 6
s_add_u32 s91, s91, 0
s_lshl_b32 s47, s91, 11
buffer_load_dwordx4 v[120:123], v13, s[24:27], s47 offen offset:0 sc1
buffer_load_dwordx4 v[124:127], v13, s[24:27], s47 offen offset:1024 sc1
s_lshr_b32 s47, s42, 6
s_add_u32 s47, s47, 1
s_lshl_b32 s47, s47, 11
buffer_load_dwordx4 v[96:99], v13, s[24:27], s47 offen offset:0 sc1
buffer_load_dwordx4 v[100:103], v13, s[24:27], s47 offen offset:1024 sc1
s_lshr_b32 s47, s43, 6
s_add_u32 s47, s47, 0
s_lshl_b32 s47, s47, 11
buffer_load_dwordx4 v[80:83], v13, s[24:27], s47 offen offset:0 sc1
buffer_load_dwordx4 v[84:87], v13, s[24:27], s47 offen offset:1024 sc1
s_call_b64 s[100:101], L_TRY
s_cbranch_scc1 L_SLOW4
v_mov_b64 v[48:49], v[120:121]
v_mov_b64 v[52:53], v[124:125]
s_branch L_BACK4
L_SLOW5:
s_lshr_b32 s91, s42, 6
s_add_u32 s91, s91, 1
s_lshl_b32 s47, s91, 11
buffer_load_dwordx4 v[120:123], v13, s[24:27], s47 offen offset:0 sc1
buffer_load_dwordx4 v[124:127], v13, s[24:27], s47 offen offset:1024 sc1
s_lshr_b32 s47, s43, 6
s_add_u32 s47, s47, 0
s_lshl_b32 s47, s47, 11
buffer_load_dwordx4 v[80:83], v13, s[24:27], s47 offen offset:0 sc1
buffer_load_dwordx4 v[84:87], v13, s[24:27], s47 offen offset:1024 sc1
s_lshr_b32 s47, s43, 6
s_add_u32 s47, s47, 1
s_lshl_b32 s47, s47, 11
buffer_load_dwordx4 v[88:91], v13, s[24:27], s47 offen offset:0 sc1
buffer_load_dwordx4 v[92:95], v13, s[24:27], s47 offen offset:1024 sc1
s_call_b64 s[100:101], L_TRY
s_cbranch_scc1 L_SLOW5
v_mov_b64 v[96:97], v[120:121]
v_mov_b64 v[100:101], v[124:125]
s_branch L_BACK5
L_SLOW6:
s_lshr_b32 s91, s43, 6
s_add_u32 s91, s91, 0
s_lshl_b32 s47, s91, 11
buffer_load_dwordx4 v[120:123], v13, s[24:27], s47 offen offset:0 sc1
buffer_load_dwordx4 v[124:127], v13, s[24:27], s47 offen offset:1024 sc1
s_lshr_b32 s47, s43, 6
s_add_u32 s47, s47, 1
s_lshl_b32 s47, s47, 11
buffer_load_dwordx4 v[88:91], v13, s[24:27], s47 offen offset:0 sc1
buffer_load_dwordx4 v[92:95], v13, s[24:27], s47 offen offset:1024 sc1
s_movk_i32 s47, 8
s_lshl_b32 s47, s47, 11
buffer_load_dwordx4 v[32:35], v13, s[24:27], s47 offen offset:0 sc1
buffer_load_dwordx4 v[36:39], v13, s[24:27], s47 offen offset:1024 sc1
s_call_b64 s[100:101], L_TRY
s_cbranch_scc1 L_SLOW6
v_mov_b64 v[80:81], v[120:121]
v_mov_b64 v[84:85], v[124:125]
s_branch L_BACK6
L_SLOW7:
s_lshr_b32 s91, s43, 6
s_add_u32 s91, s91, 1
s_lshl_b32 s47, s91, 11
buffer_load_dwordx4 v[120:123], v13, s[24:27], s47 offen offset:0 sc1
buffer_load_dwordx4 v[124:127], v13, s[24:27], s47 offen offset:1024 sc1
s_movk_i32 s47, 8
s_lshl_b32 s47, s47, 11
buffer_load_dwordx4 v[32:35], v13, s[24:27], s47 offen offset:0 sc1
buffer_load_dwordx4 v[36:39], v13, s[24:27], s47 offen offset:1024 sc1
s_movk_i32 s47, 9
s_lshl_b32 s47, s47, 11
buffer_load_dwordx4 v[40:43], v13, s[24:27], s47 offen offset:0 sc1
buffer_load_dwordx4 v[44:47], v13, s[24:27], s47 offen offset:1024 sc1
s_call_b64 s[100:101], L_TRY
s_cbranch_scc1 L_SLOW7
v_mov_b64 v[88:89], v[120:121]
v_mov_b64 v[92:93], v[124:125]
s_branch L_BACK7
L_SLOW8:
s_movk_i32 s91, 8
s_lshl_b32 s47, s91, 11
buffer_load_dwordx4 v[120:123], v13, s[24:27], s47 offen offset:0 sc1
buffer_load_dwordx4 v[124:127], v13, s[24:27], s47 offen offset:1024 sc1
s_movk_i32 s47, 9
s_lshl_b32 s47, s47, 11
buffer_load_dwordx4 v[40:43], v13, s[24:27], s47 offen offset:0 sc1
buffer_load_dwordx4 v[44:47], v13, s[24:27], s47 offen offset:1024 sc1
s_movk_i32 s47, 10
s_lshl_b32 s47, s47, 11
buffer_load_dwordx4 v[48:51], v13, s[24:27], s47 offen offset:0 sc1
buffer_load_dwordx4 v[52:55], v13, s[24:27], s47 offen offset:1024 sc1
s_call_b64 s[100:101], L_TRY
s_cbranch_scc1 L_SLOW8
v_mov_b64 v[32:33], v[120:121]
v_mov_b64 v[36:37], v[124:125]
s_branch L_BACK8
L_SLOW9:
s_movk_i32 s91, 9
s_lshl_b32 s47, s91, 11
buffer_load_dwordx4 v[120:123], v13, s[24:27], s47 offen offset:0 sc1
buffer_load_dwordx4 v[124:127], v13, s[24:27], s47 offen offset:1024 sc1
s_movk_i32 s47, 10
s_lshl_b32 s47, s47, 11
buffer_load_dwordx4 v[48:51], v13, s[24:27], s47 offen offset:0 sc1
buffer_load_dwordx4 v[52:55], v13, s[24:27], s47 offen offset:1024 sc1
s_movk_i32 s47, 11
s_lshl_b32 s47, s47, 11
buffer_load_dwordx4 v[96:99], v13, s[24:27], s47 offen offset:0 sc1
buffer_load_dwordx4 v[100:103], v13, s[24:27], s47 offen offset:1024 sc1
s_call_b64 s[100:101], L_TRY
s_cbranch_scc1 L_SLOW9
v_mov_b64 v[40:41], v[120:121]
v_mov_b64 v[44:45], v[124:125]
s_branch L_BACK9
L_SLOW10:
s_movk_i32 s91, 10
s_lshl_b32 s47, s91, 11
buffer_load_dwordx4 v[120:123], v13, s[24:27], s47 offen offset:0 sc1
buffer_load_dwordx4 v[124:127], v13, s[24:27], s47 offen offset:1024 sc1
s_movk_i32 s47, 11
s_lshl_b32 s47, s47, 11
buffer_load_dwordx4 v[96:99], v13, s[24:27], s47 offen offset:0 sc1
buffer_load_dwordx4 v[100:103], v13, s[24:27], s47 offen offset:1024 sc1
s_movk_i32 s47, 12
s_lshl_b32 s47, s47, 11
buffer_load_dwordx4 v[80:83], v13, s[24:27], s47 offen offset:0 sc1
buffer_load_dwordx4 v[84:87], v13, s[24:27], s47 offen offset:1024 sc1
s_call_b64 s[100:101], L_TRY
s_cbranch_scc1 L_SLOW10
v_mov_b64 v[48:49], v[120:121]
v_mov_b64 v[52:53], v[124:125]
s_branch L_BACK10
L_SLOW11:
s_movk_i32 s91, 11
s_lshl_b32 s47, s91, 11
buffer_load_dwordx4 v[120:123], v13, s[24:27], s47 offen offset:0 sc1
buffer_load_dwordx4 v[124:127], v13, s[24:27], s47 offen offset:1024 sc1
s_movk_i32 s47, 12
s_lshl_b32 s47, s47, 11
buffer_load_dwordx4 v[80:83], v13, s[24:27], s47 offen offset:0 sc1
buffer_load_dwordx4 v[84:87], v13, s[24:27], s47 offen offset:1024 sc1
s_movk_i32 s47, 13
s_lshl_b32 s47, s47, 11
buffer_load_dwordx4 v[88:91], v13, s[24:27], s47 offen offset:0 sc1
buffer_load_dwordx4 v[92:95], v13, s[24:27], s47 offen offset:1024 sc1
s_call_b64 s[100:101], L_TRY
s_cbranch_scc1 L_SLOW11
v_mov_b64 v[96:97], v[120:121]
v_mov_b64 v[100:101], v[124:125]
s_branch L_BACK11
L_SLOW12:
s_movk_i32 s91, 12
s_lshl_b32 s47, s91, 11
buffer_load_dwordx4 v[120:123], v13, s[24:27], s47 offen offset:0 sc1
buffer_load_dwordx4 v[124:127], v13, s[24:27], s47 offen offset:1024 sc1
s_movk_i32 s47, 13
s_lshl_b32 s47, s47, 11
buffer_load_dwordx4 v[88:91], v13, s[24:27], s47 offen offset:0 sc1
buffer_load_dwordx4 v[92:95], v13, s[24:27], s47 offen offset:1024 sc1
s_movk_i32 s47, 14
s_lshl_b32 s47, s47, 11
buffer_load_dwordx4 v[32:35], v13, s[24:27], s47 offen offset:0 sc1
buffer_load_dwordx4 v[36:39], v13, s[24:27], s47 offen offset:1024 sc1
s_call_b64 s[100:101], L_TRY
s_cbranch_scc1 L_SLOW12
v_mov_b64 v[80:81], v[120:121]
v_mov_b64 v[84:85], v[124:125]
s_branch L_BACK12
L_SLOW13:
s_movk_i32 s91, 13
s_lshl_b32 s47, s91, 11
buffer_load_dwordx4 v[120:123], v13, s[24:27], s47 offen offset:0 sc1
buffer_load_dwordx4 v[124:127], v13, s[24:27], s47 offen offset:1024 sc1
s_movk_i32 s47, 14
s_lshl_b32 s47, s47, 11
buffer_load_dwordx4 v[32:35], v13, s[24:27], s47 offen offset:0 sc1
buffer_load_dwordx4 v[36:39], v13, s[24:27], s47 offen offset:1024 sc1
s_movk_i32 s47, 15
s_lshl_b32 s47, s47, 11
buffer_load_dwordx4 v[40:43], v13, s[24:27], s47 offen offset:0 sc1
buffer_load_dwordx4 v[44:47], v13, s[24:27], s47 offen offset:1024 sc1
s_call_b64 s[100:101], L_TRY
s_cbranch_scc1 L_SLOW13
v_mov_b64 v[88:89], v[120:121]
v_mov_b64 v[92:93], v[124:125]
s_branch L_BACK13
L_SLOW14:
s_movk_i32 s91, 14
s_lshl_b32 s47, s91, 11
buffer_load_dwordx4 v[120:123], v13, s[24:27], s47 offen offset:0 sc1
buffer_load_dwordx4 v[124:127], v13, s[24:27], s47 offen offset:1024 sc1
s_movk_i32 s47, 15
s_lshl_b32 s47, s47, 11
buffer_load_dwordx4 v[40:43], v13, s[24:27], s47 offen offset:0 sc1
buffer_load_dwordx4 v[44:47], v13, s[24:27], s47 offen offset:1024 sc1
s_movk_i32 s47, 16
s_lshl_b32 s47, s47, 11
buffer_load_dwordx4 v[48:51], v13, s[24:27], s47 offen offset:0 sc1
buffer_load_dwordx4 v[52:55], v13, s[24:27], s47 offen offset:1024 sc1
s_call_b64 s[100:101], L_TRY
s_cbranch_scc1 L_SLOW14
v_mov_b64 v[32:33], v[120:121]
v_mov_b64 v[36:37], v[124:125]
s_branch L_BACK14
L_SLOW15:
s_movk_i32 s91, 15
s_lshl_b32 s47, s91, 11
buffer_load_dwordx4 v[120:123], v13, s[24:27], s47 offen offset:0 sc1
buffer_load_dwordx4 v[124:127], v13, s[24:27], s47 offen offset:1024 sc1
s_movk_i32 s47, 16
s_lshl_b32 s47, s47, 11
buffer_load_dwordx4 v[48:51], v13, s[24:27], s47 offen offset:0 sc1
buffer_load_dwordx4 v[52:55], v13, s[24:27], s47 offen offset:1024 sc1
s_movk_i32 s47, 17
s_lshl_b32 s47, s47, 11
buffer_load_dwordx4 v[96:99], v13, s[24:27], s47 offen offset:0 sc1
buffer_load_dwordx4 v[100:103], v13, s[24:27], s47 offen offset:1024 sc1
s_call_b64 s[100:101], L_TRY
s_cbranch_scc1 L_SLOW15
v_mov_b64 v[40:41], v[120:121]
v_mov_b64 v[44:45], v[124:125]
s_branch L_BACK15
L_SLOW16:
s_movk_i32 s91, 16
s_lshl_b32 s47, s91, 11
buffer_load_dwordx4 v[120:123], v13, s[24:27], s47 offen offset:0 sc1
buffer_load_dwordx4 v[124:127], v13, s[24:27], s47 offen offset:1024 sc1
s_movk_i32 s47, 17
s_lshl_b32 s47, s47, 11
buffer_load_dwordx4 v[96:99], v13, s[24:27], s47 offen offset:0 sc1
buffer_load_dwordx4 v[100:103], v13, s[24:27], s47 offen offset:1024 sc1
s_movk_i32 s47, 18
s_lshl_b32 s47, s47, 11
buffer_load_dwordx4 v[80:83], v13, s[24:27], s47 offen offset:0 sc1
buffer_load_dwordx4 v[84:87], v13, s[24:27], s47 offen offset:1024 sc1
s_call_b64 s[100:101], L_TRY
s_cbranch_scc1 L_SLOW16
v_mov_b64 v[48:49], v[120:121]
v_mov_b64 v[52:53], v[124:125]
s_branch L_BACK16
L_SLOW17:
s_movk_i32 s91, 17
s_lshl_b32 s47, s91, 11
buffer_load_dwordx4 v[120:123], v13, s[24:27], s47 offen offset:0 sc1
buffer_load_dwordx4 v[124:127], v13, s[24:27], s47 offen offset:1024 sc1
s_movk_i32 s47, 18
s_lshl_b32 s47, s47, 11
buffer_load_dwordx4 v[80:83], v13, s[24:27], s47 offen offset:0 sc1
buffer_load_dwordx4 v[84:87], v13, s[24:27], s47 offen offset:1024 sc1
s_movk_i32 s47, 19
s_lshl_b32 s47, s47, 11
buffer_load_dwordx4 v[88:91], v13, s[24:27], s47 offen offset:0 sc1
buffer_load_dwordx4 v[92:95], v13, s[24:27], s47 offen offset:1024 sc1
s_call_b64 s[100:101], L_TRY
s_cbranch_scc1 L_SLOW17
v_mov_b64 v[96:97], v[120:121]
v_mov_b64 v[100:101], v[124:125]
s_branch L_BACK17
L_SLOW18:
s_movk_i32 s91, 18
s_lshl_b32 s47, s91, 11
buffer_load_dwordx4 v[120:123], v13, s[24:27], s47 offen offset:0 sc1
buffer_load_dwordx4 v[124:127], v13, s[24:27], s47 offen offset:1024 sc1
s_movk_i32 s47, 19
s_lshl_b32 s47, s47, 11
buffer_load_dwordx4 v[88:91], v13, s[24:27], s47 offen offset:0 sc1
buffer_load_dwordx4 v[92:95], v13, s[24:27], s47 offen offset:1024 sc1
s_movk_i32 s47, 20
s_lshl_b32 s47, s47, 11
buffer_load_dwordx4 v[32:35], v13, s[24:27], s47 offen offset:0 sc1
buffer_load_dwordx4 v[36:39], v13, s[24:27], s47 offen offset:1024 sc1
s_call_b64 s[100:101], L_TRY
s_cbranch_scc1 L_SLOW18
v_mov_b64 v[80:81], v[120:121]
v_mov_b64 v[84:85], v[124:125]
s_branch L_BACK18
L_SLOW19:
s_movk_i32 s91, 19
s_lshl_b32 s47, s91, 11
buffer_load_dwordx4 v[120:123], v13, s[24:27], s47 offen offset:0 sc1
buffer_load_dwordx4 v[124:127], v13, s[24:27], s47 offen offset:1024 sc1
s_movk_i32 s47, 20
s_lshl_b32 s47, s47, 11
buffer_load_dwordx4 v[32:35], v13, s[24:27], s47 offen offset:0 sc1
buffer_load_dwordx4 v[36:39], v13, s[24:27], s47 offen offset:1024 sc1
s_movk_i32 s47, 21
s_lshl_b32 s47, s47, 11
buffer_load_dwordx4 v[40:43], v13, s[24:27], s47 offen offset:0 sc1
buffer_load_dwordx4 v[44:47], v13, s[24:27], s47 offen offset:1024 sc1
s_call_b64 s[100:101], L_TRY
s_cbranch_scc1 L_SLOW19
v_mov_b64 v[88:89], v[120:121]
v_mov_b64 v[92:93], v[124:125]
s_branch L_BACK19
L_SLOW20:
s_movk_i32 s91, 20
s_lshl_b32 s47, s91, 11
buffer_load_dwordx4 v[120:123], v13, s[24:27], s47 offen offset:0 sc1
buffer_load_dwordx4 v[124:127], v13, s[24:27], s47 offen offset:1024 sc1
s_movk_i32 s47, 21
s_lshl_b32 s47, s47, 11
buffer_load_dwordx4 v[40:43], v13, s[24:27], s47 offen offset:0 sc1
buffer_load_dwordx4 v[44:47], v13, s[24:27], s47 offen offset:1024 sc1
s_movk_i32 s47, 22
s_lshl_b32 s47, s47, 11
buffer_load_dwordx4 v[48:51], v13, s[24:27], s47 offen offset:0 sc1
buffer_load_dwordx4 v[52:55], v13, s[24:27], s47 offen offset:1024 sc1
s_call_b64 s[100:101], L_TRY
s_cbranch_scc1 L_SLOW20
v_mov_b64 v[32:33], v[120:121]
v_mov_b64 v[36:37], v[124:125]
s_branch L_BACK20
L_SLOW21:
s_movk_i32 s91, 21
s_lshl_b32 s47, s91, 11
buffer_load_dwordx4 v[120:123], v13, s[24:27], s47 offen offset:0 sc1
buffer_load_dwordx4 v[124:127], v13, s[24:27], s47 offen offset:1024 sc1
s_movk_i32 s47, 22
s_lshl_b32 s47, s47, 11
buffer_load_dwordx4 v[48:51], v13, s[24:27], s47 offen offset:0 sc1
buffer_load_dwordx4 v[52:55], v13, s[24:27], s47 offen offset:1024 sc1
s_movk_i32 s47, 23
s_lshl_b32 s47, s47, 11
buffer_load_dwordx4 v[96:99], v13, s[24:27], s47 offen offset:0 sc1
buffer_load_dwordx4 v[100:103], v13, s[24:27], s47 offen offset:1024 sc1
s_call_b64 s[100:101], L_TRY
s_cbranch_scc1 L_SLOW21
v_mov_b64 v[40:41], v[120:121]
v_mov_b64 v[44:45], v[124:125]
s_branch L_BACK21
L_SLOW22:
s_movk_i32 s91, 22
s_lshl_b32 s47, s91, 11
buffer_load_dwordx4 v[120:123], v13, s[24:27], s47 offen offset:0 sc1
buffer_load_dwordx4 v[124:127], v13, s[24:27], s47 offen offset:1024 sc1
s_movk_i32 s47, 23
s_lshl_b32 s47, s47, 11
buffer_load_dwordx4 v[96:99], v13, s[24:27], s47 offen offset:0 sc1
buffer_load_dwordx4 v[100:103], v13, s[24:27], s47 offen offset:1024 sc1
s_movk_i32 s47, 24
s_lshl_b32 s47, s47, 11
buffer_load_dwordx4 v[80:83], v13, s[24:27], s47 offen offset:0 sc1
buffer_load_dwordx4 v[84:87], v13, s[24:27], s47 offen offset:1024 sc1
s_call_b64 s[100:101], L_TRY
s_cbranch_scc1 L_SLOW22
v_mov_b64 v[48:49], v[120:121]
v_mov_b64 v[52:53], v[124:125]
s_branch L_BACK22
L_SLOW23:
s_movk_i32 s91, 23
s_lshl_b32 s47, s91, 11
buffer_load_dwordx4 v[120:123], v13, s[24:27], s47 offen offset:0 sc1
buffer_load_dwordx4 v[124:127], v13, s[24:27], s47 offen offset:1024 sc1
s_movk_i32 s47, 24
s_lshl_b32 s47, s47, 11
buffer_load_dwordx4 v[80:83], v13, s[24:27], s47 offen offset:0 sc1
buffer_load_dwordx4 v[84:87], v13, s[24:27], s47 offen offset:1024 sc1
s_movk_i32 s47, 25
s_lshl_b32 s47, s47, 11
buffer_load_dwordx4 v[88:91], v13, s[24:27], s47 offen offset:0 sc1
buffer_load_dwordx4 v[92:95], v13, s[24:27], s47 offen offset:1024 sc1
s_call_b64 s[100:101], L_TRY
s_cbranch_scc1 L_SLOW23
v_mov_b64 v[96:97], v[120:121]
v_mov_b64 v[100:101], v[124:125]
s_branch L_BACK23
L_SLOW24:
s_movk_i32 s91, 24
s_lshl_b32 s47, s91, 11
buffer_load_dwordx4 v[120:123], v13, s[24:27], s47 offen offset:0 sc1
buffer_load_dwordx4 v[124:127], v13, s[24:27], s47 offen offset:1024 sc1
s_movk_i32 s47, 25
s_lshl_b32 s47, s47, 11
buffer_load_dwordx4 v[88:91], v13, s[24:27], s47 offen offset:0 sc1
buffer_load_dwordx4 v[92:95], v13, s[24:27], s47 offen offset:1024 sc1
s_movk_i32 s47, 26
s_lshl_b32 s47, s47, 11
buffer_load_dwordx4 v[32:35], v13, s[24:27], s47 offen offset:0 sc1
buffer_load_dwordx4 v[36:39], v13, s[24:27], s47 offen offset:1024 sc1
s_call_b64 s[100:101], L_TRY
s_cbranch_scc1 L_SLOW24
v_mov_b64 v[80:81], v[120:121]
v_mov_b64 v[84:85], v[124:125]
s_branch L_BACK24
L_SLOW25:
s_movk_i32 s91, 25
s_lshl_b32 s47, s91, 11
buffer_load_dwordx4 v[120:123], v13, s[24:27], s47 offen offset:0 sc1
buffer_load_dwordx4 v[124:127], v13, s[24:27], s47 offen offset:1024 sc1
s_movk_i32 s47, 26
s_lshl_b32 s47, s47, 11
buffer_load_dwordx4 v[32:35], v13, s[24:27], s47 offen offset:0 sc1
buffer_load_dwordx4 v[36:39], v13, s[24:27], s47 offen offset:1024 sc1
s_movk_i32 s47, 27
s_lshl_b32 s47, s47, 11
buffer_load_dwordx4 v[40:43], v13, s[24:27], s47 offen offset:0 sc1
buffer_load_dwordx4 v[44:47], v13, s[24:27], s47 offen offset:1024 sc1
s_call_b64 s[100:101], L_TRY
s_cbranch_scc1 L_SLOW25
v_mov_b64 v[88:89], v[120:121]
v_mov_b64 v[92:93], v[124:125]
s_branch L_BACK25
L_SLOW26:
s_movk_i32 s91, 26
s_lshl_b32 s47, s91, 11
buffer_load_dwordx4 v[120:123], v13, s[24:27], s47 offen offset:0 sc1
buffer_load_dwordx4 v[124:127], v13, s[24:27], s47 offen offset:1024 sc1
s_movk_i32 s47, 27
s_lshl_b32 s47, s47, 11
buffer_load_dwordx4 v[40:43], v13, s[24:27], s47 offen offset:0 sc1
buffer_load_dwordx4 v[44:47], v13, s[24:27], s47 offen offset:1024 sc1
s_movk_i32 s47, 28
s_lshl_b32 s47, s47, 11
buffer_load_dwordx4 v[48:51], v13, s[24:27], s47 offen offset:0 sc1
buffer_load_dwordx4 v[52:55], v13, s[24:27], s47 offen offset:1024 sc1
s_call_b64 s[100:101], L_TRY
s_cbranch_scc1 L_SLOW26
v_mov_b64 v[32:33], v[120:121]
v_mov_b64 v[36:37], v[124:125]
s_branch L_BACK26
L_SLOW27:
s_movk_i32 s91, 27
s_lshl_b32 s47, s91, 11
buffer_load_dwordx4 v[120:123], v13, s[24:27], s47 offen offset:0 sc1
buffer_load_dwordx4 v[124:127], v13, s[24:27], s47 offen offset:1024 sc1
s_movk_i32 s47, 28
s_lshl_b32 s47, s47, 11
buffer_load_dwordx4 v[48:51], v13, s[24:27], s47 offen offset:0 sc1
buffer_load_dwordx4 v[52:55], v13, s[24:27], s47 offen offset:1024 sc1
s_movk_i32 s47, 29
s_lshl_b32 s47, s47, 11
buffer_load_dwordx4 v[96:99], v13, s[24:27], s47 offen offset:0 sc1
buffer_load_dwordx4 v[100:103], v13, s[24:27], s47 offen offset:1024 sc1
s_call_b64 s[100:101], L_TRY
s_cbranch_scc1 L_SLOW27
v_mov_b64 v[40:41], v[120:121]
v_mov_b64 v[44:45], v[124:125]
s_branch L_BACK27
L_SLOW28:
s_movk_i32 s91, 28
s_lshl_b32 s47, s91, 11
buffer_load_dwordx4 v[120:123], v13, s[24:27], s47 offen offset:0 sc1
buffer_load_dwordx4 v[124:127], v13, s[24:27], s47 offen offset:1024 sc1
s_movk_i32 s47, 29
s_lshl_b32 s47, s47, 11
buffer_load_dwordx4 v[96:99], v13, s[24:27], s47 offen offset:0 sc1
buffer_load_dwordx4 v[100:103], v13, s[24:27], s47 offen offset:1024 sc1
s_movk_i32 s47, 30
s_lshl_b32 s47, s47, 11
buffer_load_dwordx4 v[80:83], v13, s[24:27], s47 offen offset:0 sc1
buffer_load_dwordx4 v[84:87], v13, s[24:27], s47 offen offset:1024 sc1
s_call_b64 s[100:101], L_TRY
s_cbranch_scc1 L_SLOW28
v_mov_b64 v[48:49], v[120:121]
v_mov_b64 v[52:53], v[124:125]
s_branch L_BACK28
L_SLOW29:
s_movk_i32 s91, 29
s_lshl_b32 s47, s91, 11
buffer_load_dwordx4 v[120:123], v13, s[24:27], s47 offen offset:0 sc1
buffer_load_dwordx4 v[124:127], v13, s[24:27], s47 offen offset:1024 sc1
s_movk_i32 s47, 30
s_lshl_b32 s47, s47, 11
buffer_load_dwordx4 v[80:83], v13, s[24:27], s47 offen offset:0 sc1
buffer_load_dwordx4 v[84:87], v13, s[24:27], s47 offen offset:1024 sc1
s_movk_i32 s47, 31
s_lshl_b32 s47, s47, 11
buffer_load_dwordx4 v[88:91], v13, s[24:27], s47 offen offset:0 sc1
buffer_load_dwordx4 v[92:95], v13, s[24:27], s47 offen offset:1024 sc1
s_call_b64 s[100:101], L_TRY
s_cbranch_scc1 L_SLOW29
v_mov_b64 v[96:97], v[120:121]
v_mov_b64 v[100:101], v[124:125]
s_branch L_BACK29
L_SLOW30:
s_movk_i32 s91, 30
s_lshl_b32 s47, s91, 11
buffer_load_dwordx4 v[120:123], v13, s[24:27], s47 offen offset:0 sc1
buffer_load_dwordx4 v[124:127], v13, s[24:27], s47 offen offset:1024 sc1
s_movk_i32 s47, 31
s_lshl_b32 s47, s47, 11
buffer_load_dwordx4 v[88:91], v13, s[24:27], s47 offen offset:0 sc1
buffer_load_dwordx4 v[92:95], v13, s[24:27], s47 offen offset:1024 sc1
s_call_b64 s[100:101], L_TRY
s_cbranch_scc1 L_SLOW30
v_mov_b64 v[80:81], v[120:121]
v_mov_b64 v[84:85], v[124:125]
s_branch L_BACK30
L_SLOW31:
s_movk_i32 s91, 31
s_lshl_b32 s47, s91, 11
buffer_load_dwordx4 v[120:123], v13, s[24:27], s47 offen offset:0 sc1
buffer_load_dwordx4 v[124:127], v13, s[24:27], s47 offen offset:1024 sc1
s_call_b64 s[100:101], L_TRY
s_cbranch_scc1 L_SLOW31
v_mov_b64 v[88:89], v[120:121]
v_mov_b64 v[92:93], v[124:125]
s_branch L_BACK31
L_SELF:
s_mul_i32 s47, s91, 458752
s_lshl_b32 s46, s39, 8
s_add_u32 s47, s47, s46
s_add_u32 s84, s6, s47
s_addc_u32 s85, s7, 0
s_mov_b32 s86, 387328
s_mov_b32 s87, 0x20000
buffer_load_dwordx4 v[64:67], v30, s[84:87], 0 offen
buffer_load_dwordx4 v[68:71], v30, s[84:87], s92 offen
buffer_load_dwordx4 v[72:75], v30, s[84:87], s93 offen
buffer_load_dwordx4 v[76:79], v30, s[84:87], s94 offen
s_waitcnt vmcnt(0)
v_lshl_add_u64 v[64:65], v[68:69], 4, v[64:65]
v_lshl_add_u64 v[66:67], v[70:71], 4, v[66:67]
v_lshl_add_u64 v[72:73], v[76:77], 4, v[72:73]
v_lshl_add_u64 v[74:75], v[78:79], 4, v[74:75]
v_lshl_or_b32 v76, v72, 8, v64
v_lshl_or_b32 v77, v73, 8, v65
v_lshl_or_b32 v78, v74, 8, v66
v_lshl_or_b32 v79, v75, 8, v67
v_lshl_or_b32 v120, v77, 16, v76
v_lshl_or_b32 v121, v79, 16, v78
s_add_u32 s84, s84, 57344
s_addc_u32 s85, s85, 0
buffer_load_dwordx4 v[64:67], v30, s[84:87], 0 offen
buffer_load_dwordx4 v[68:71], v30, s[84:87], s92 offen
buffer_load_dwordx4 v[72:75], v30, s[84:87], s93 offen
buffer_load_dwordx4 v[76:79], v30, s[84:87], s94 offen
s_waitcnt vmcnt(0)
v_lshl_add_u64 v[64:65], v[68:69], 4, v[64:65]
v_lshl_add_u64 v[66:67], v[70:71], 4, v[66:67]
v_lshl_add_u64 v[72:73], v[76:77], 4, v[72:73]
v_lshl_add_u64 v[74:75], v[78:79], 4, v[74:75]
v_lshl_or_b32 v76, v72, 8, v64
v_lshl_or_b32 v77, v73, 8, v65
v_lshl_or_b32 v78, v74, 8, v66
v_lshl_or_b32 v79, v75, 8, v67
v_lshl_or_b32 v124, v77, 16, v76
v_lshl_or_b32 v125, v79, 16, v78
s_cmp_eq_u32 s39, -1
s_setpc_b64 s[100:101]
L_END:
s_endpgm
.section .rodata,"a"
.p2align 6
.amdhsa_kernel standalone__normalfloat_lut_af4__prompt_kernel
  .amdhsa_next_free_vgpr 512
  .amdhsa_next_free_sgpr 102
  .amdhsa_accum_offset 256
  .amdhsa_group_segment_fixed_size 0
  .amdhsa_kernarg_size 56
  .amdhsa_user_sgpr_count 2
  .amdhsa_user_sgpr_kernarg_segment_ptr 1
  .amdhsa_system_sgpr_workgroup_id_x 1
.end_amdhsa_kernel
```

```asm
; @launch grid=(256,1,1) block=(256,1,1) lds=163840
.amdgcn_target "amdgcn-amd-amdhsa--gfx950"
.text
.globl standalone__normalfloat_lut_af4__prompt_kernel
.p2align 12
.p2align 8
.type standalone__normalfloat_lut_af4__prompt_kernel,@function
standalone__normalfloat_lut_af4__prompt_kernel:
s_load_dwordx4 s[4:7], s[0:1], 0
s_load_dwordx4 s[12:15], s[0:1], 40
s_load_dwordx4 s[8:11], s[0:1], 24
s_load_dwordx2 s[50:51], s[0:1], 16
s_memrealtime s[56:57]
s_cmp_ge_u32 s2, 256
s_cbranch_scc1 L_END
s_getpc_b64 s[48:49]
L_PC0:
v_bfi_b32 v2, 7, v0, s2
v_lshlrev_b32 v2, 7, v2
v_min_u32 v2, L_END-L_PC0, v2
global_load_dword v7, v2, s[48:49]
v_lshrrev_b32 v1, 6, v0
s_cmp_lt_u32 s2, 32
v_readfirstlane_b32 s36, v1
s_cbranch_scc1 L_PACK
s_bfe_u32 s34, s2, 0x20001
s_bfe_u32 s37, s2, 0x20003
s_lshl2_add_u32 s37, s34, s37
s_and_b32 s43, s2, 1
s_mul_i32 s43, s43, 7
s_lshr_b32 s38, s2, 5
s_add_u32 s38, s38, s43
s_lshl2_add_u32 s39, s38, s36
s_sub_u32 s39, s39, 4
v_bfe_u32 v6, v0, 4, 2
v_and_b32 v3, 15, v0
v_mul_u32_u24 v2, 114688, v6
v_lshl_add_u32 v30, v3, 4, v2
s_lshr_b32 s46, s37, 1
s_and_b32 s45, s37, 1
s_lshl3_add_u32 s46, s46, s45
s_mul_i32 s46, s46, 57344
s_lshl_b32 s47, s39, 8
s_add_u32 s44, s46, s47
s_mov_b32 s18, 387328
s_mov_b32 s19, 0x20000
s_mov_b32 s92, 14336
s_mov_b32 s93, 28672
s_mov_b32 s94, 43008
s_waitcnt lgkmcnt(0)
s_load_dwordx8 s[64:71], s[50:51], 0
s_add_u32 s16, s6, s44
s_addc_u32 s17, s7, 0
buffer_load_dwordx4 v[104:107], v30, s[16:19], 0 offen
buffer_load_dwordx4 v[108:111], v30, s[16:19], s92 offen
buffer_load_dwordx4 v[112:115], v30, s[16:19], s93 offen
buffer_load_dwordx4 v[116:119], v30, s[16:19], s94 offen
s_branch L_MAIN
L_PACK:
v_lshrrev_b32 v2, 2, v0
v_and_b32 v3, 3, v0
s_lshl_b32 s45, s2, 17
v_lshl_add_u32 v2, v2, 11, s45
v_lshl_add_u32 v17, v3, 7, v2
s_mov_b32 s30, 4194304
s_mov_b32 s31, 0x20000
v_lshlrev_b32 v16, 3, v0
s_cmp_lt_u32 s2, 2
s_cselect_b32 s34, 8, 0
s_mov_b32 s35, 0x20000
v_mov_b64 v[22:23], 0
s_waitcnt lgkmcnt(0)
s_mov_b64 s[32:33], s[12:13]
v_mov_b64 v[20:21], s[56:57]
buffer_atomic_cmpswap_x2 v[20:23], v16, s[32:35], 0 offen sc1
s_mov_b64 s[28:29], s[4:5]
buffer_load_dword v19, v17, s[28:31], 0 offen offset:0
s_branch L_PACK1
L_MAIN:
s_mov_b64 s[20:21], s[4:5]
s_mov_b32 s22, 4194304
s_mov_b32 s23, 0x20000
s_lshl_b32 s46, s37, 18
v_lshrrev_b32 v5, 3, v0
v_lshl_add_u32 v2, v5, 11, s46
v_lshrrev_b32 v4, 4, v0
v_xor_b32 v4, v4, v0
v_and_b32 v4, 7, v4
v_lshl_add_u32 v8, v4, 4, v2
v_add_u32 v9, 65536, v8
v_add_u32 v10, 131072, v8
v_add_u32 v11, 196608, v8
s_lshl_b32 s33, s36, 10
s_mul_i32 s47, s45, 114688
s_sub_u32 s47, s44, s47
s_add_u32 s47, s47, 57344
s_add_u32 s84, s6, s47
s_addc_u32 s85, s7, 0
s_mov_b32 s86, 387328
s_mov_b32 s87, 0x20000
s_lshl_b32 s40, s34, 7
s_add_u32 m0, s33, 65536
s_nop 0
buffer_load_dwordx4 v8, s[20:23], s40 offen lds
s_add_u32 m0, s33, 69632
s_nop 0
buffer_load_dwordx4 v9, s[20:23], s40 offen lds
s_add_u32 m0, s33, 73728
s_nop 0
buffer_load_dwordx4 v10, s[20:23], s40 offen lds
s_add_u32 m0, s33, 77824
s_nop 0
buffer_load_dwordx4 v11, s[20:23], s40 offen lds
s_and_b32 s45, s36, 1
s_mul_i32 s45, s45, 0x0202
s_lshr_b32 s46, s36, 1
s_mul_i32 s46, s46, 0x02020000
s_add_u32 s45, s45, s46
s_add_u32 s45, s45, 0x05040100
v_mov_b32 v57, s45
v_lshlrev_b32 v5, 8, v5
v_and_b32 v58, 7, v0
v_lshl_add_u32 v58, v58, 4, v5
v_and_b32 v5, 31, v0
v_lshlrev_b32 v19, 2, v5
v_and_b32 v0, 63, v0
s_lshl_b32 s46, s39, 7
v_lshl_add_u32 v28, v3, 3, s46
s_mul_i32 s47, s37, 917504
s_add_u32 s47, s47, s46
s_add_u32 s28, s10, s47
s_addc_u32 s29, s11, 0
s_mov_b32 s30, 86144
s_mov_b32 s31, 0x20000
v_mul_u32_u24 v29, 28672, v6
v_lshl_add_u32 v18, v3, 3, v29
v_lshlrev_b32 v29, 7, v3
v_bfe_u32 v5, v0, 1, 3
v_xor_b32 v5, v5, v6
v_lshl_add_u32 v29, v5, 4, v29
v_add_u32 v14, 65536, v29
v_xor_b32 v15, 64, v14
v_add_u32 v16, 0x10000, v14
v_add_u32 v17, 0x10000, v15
s_mov_b32 s52, 0x0c0c0400
s_mov_b32 s53, 0x0c0c0500
s_mov_b32 s54, 0x0c0c0600
s_mov_b32 s55, 0x0c0c0700
v_lshlrev_b32 v13, 4, v0
s_lshl_b32 s47, s39, 16
s_add_u32 s24, s14, s47
s_addc_u32 s25, s15, 0
s_lshl_b32 s47, s37, 10
s_add_u32 s76, s24, s47
s_addc_u32 s77, s25, 0
s_movk_i32 s78, 1024
s_mov_b32 s79, 0x20000
s_lshl_b32 s47, s34, 3
s_lshr_b32 s47, 0x90d0b2d, s47
s_bfe_u32 s41, s47, 0x20000
s_lshl_b32 s41, s41, 7
s_bfe_u32 s42, s47, 0x20002
s_lshl_b32 s42, s42, 7
s_bfe_u32 s43, s47, 0x20004
s_lshl_b32 s43, s43, 7
s_lshl_b32 s47, s34, 1
s_lshr_b32 s47, 0x63, s47
s_and_b32 s47, s47, 3
s_sub_u32 s47, s47, s34
s_lshl1_add_u32 s3, s47, 12
s_mul_i32 s47, s3, 458752
s_add_u32 s16, s16, s47
s_addc_u32 s17, s17, 0
s_lshl_b32 s3, s3, 11
s_lshr_b32 s35, s37, 1
s_xor_b32 s35, s35, 1
v_lshl_add_u32 v12, s41, 5, v13
s_mul_i32 s47, s35, 458752
s_lshl_b32 s46, s39, 8
s_add_u32 s47, s47, s46
s_add_u32 s72, s6, s47
s_addc_u32 s73, s7, 0
s_mov_b32 s74, 444672
s_mov_b32 s75, 0x20000
v_add_u32 v31, 57344, v30
s_and_b32 s47, s37, 2
s_lshl_b32 s47, s47, 5
v_xor_b32 v2, s47, v14
v_xor_b32 v4, 64, v2
s_mov_b32 s26, 65536
s_mov_b32 s27, 0x20000
s_mov_b64 s[80:81], s[12:13]
s_movk_i32 s82, 128
s_mov_b32 s83, 0x20000
s_movk_i32 s90, 4096
s_waitcnt lgkmcnt(0)
s_pack_ll_b32_b16 s45, s64, s68
v_mov_b32 v56, s45
s_lshl_b64 exec, exec, 8
s_pack_hh_b32_b16 s45, s64, s68
v_mov_b32 v56, s45
s_lshl_b64 exec, exec, 8
s_pack_ll_b32_b16 s45, s65, s69
v_mov_b32 v56, s45
s_lshl_b64 exec, exec, 8
s_pack_hh_b32_b16 s45, s65, s69
v_mov_b32 v56, s45
s_lshl_b64 exec, exec, 8
s_pack_ll_b32_b16 s45, s66, s70
v_mov_b32 v56, s45
s_lshl_b64 exec, exec, 8
s_pack_hh_b32_b16 s45, s66, s70
v_mov_b32 v56, s45
s_lshl_b64 exec, exec, 8
s_pack_ll_b32_b16 s45, s67, s71
v_mov_b32 v56, s45
s_lshl_b64 exec, exec, 8
s_pack_hh_b32_b16 s45, s67, s71
v_mov_b32 v56, s45
s_mov_b64 exec, -1
v_perm_b32 v128, s64, v56, v57
v_mov_b32 v129, v128
v_mov_b64 v[130:131], v[128:129]
s_load_dwordx2 s[88:89], s[12:13], 0
ds_write_b128 v58, v[128:131] offset:0
v_perm_b32 v132, s65, v56, v57
v_mov_b32 v133, v132
v_mov_b64 v[134:135], v[132:133]
ds_write_b128 v58, v[132:135] offset:8192
v_perm_b32 v136, s66, v56, v57
v_mov_b32 v137, v136
v_mov_b64 v[138:139], v[136:137]
ds_write_b128 v58, v[136:139] offset:16384
v_perm_b32 v140, s67, v56, v57
v_mov_b32 v141, v140
v_mov_b64 v[142:143], v[140:141]
ds_write_b128 v58, v[140:143] offset:24576
v_perm_b32 v144, s68, v56, v57
v_mov_b32 v145, v144
v_mov_b64 v[146:147], v[144:145]
ds_write_b128 v58, v[144:147] offset:32768
v_perm_b32 v148, s69, v56, v57
v_mov_b32 v149, v148
v_mov_b64 v[150:151], v[148:149]
ds_write_b128 v58, v[148:151] offset:40960
v_perm_b32 v152, s70, v56, v57
v_mov_b32 v153, v152
v_mov_b64 v[154:155], v[152:153]
ds_write_b128 v58, v[152:155] offset:49152
v_perm_b32 v156, s71, v56, v57
v_mov_b32 v157, v156
v_mov_b64 v[158:159], v[156:157]
ds_write_b128 v58, v[156:159] offset:57344
buffer_load_dwordx4 v[64:67], v30, s[84:87], 0 offen
buffer_load_dwordx4 v[68:71], v30, s[84:87], s92 offen
buffer_load_dwordx4 v[72:75], v30, s[84:87], s93 offen
buffer_load_dwordx4 v[76:79], v30, s[84:87], s94 offen
s_mov_b64 vcc, -1
s_branch L_PAD0
L_PADRET0:
s_mov_b64 vcc, 0
s_waitcnt vmcnt(8)
v_lshl_add_u64 v[104:105], v[108:109], 4, v[104:105]
v_lshl_add_u64 v[106:107], v[110:111], 4, v[106:107]
v_lshl_add_u64 v[112:113], v[116:117], 4, v[112:113]
v_lshl_add_u64 v[114:115], v[118:119], 4, v[114:115]
v_lshl_or_b32 v116, v112, 8, v104
v_lshl_or_b32 v117, v113, 8, v105
v_lshl_or_b32 v118, v114, 8, v106
v_lshl_or_b32 v119, v115, 8, v107
v_lshl_or_b32 v108, v117, 16, v116
v_lshl_or_b32 v109, v119, 16, v118
s_waitcnt lgkmcnt(0)
s_cmp_eq_u64 s[88:89], 0
s_cbranch_scc1 L_NOTAG
L_TAGOK:
v_mov_b64 v[110:111], s[88:89]
buffer_store_dwordx4 v[108:111], v13, s[76:79], 0 offen sc1
s_add_u32 s76, s76, s3
s_addc_u32 s77, s77, 0
s_waitcnt lgkmcnt(0)
s_nop 0
s_branch L_STREAM
L_PACK1:
v_and_b32 v0, 63, v0
v_lshrrev_b32 v2, 4, v0
v_and_b32 v3, 15, v0
v_mul_u32_u24 v2, 114688, v2
v_lshl_add_u32 v8, v3, 4, v2
s_movk_i32 s47, 0x3800
v_add_u32 v9, s47, v8
v_add_u32 v10, s47, v9
v_add_u32 v11, s47, v10
v_add_u32 v12, s47, v11
v_add_u32 v13, s47, v12
v_add_u32 v14, s47, v13
v_add_u32 v15, s47, v14
s_sub_u32 s3, s2, 1
s_and_b32 s3, s3, 7
s_lshr_b32 s45, s2, 3
s_lshl2_add_u32 s3, s3, s45
s_mul_i32 s40, s3, 4682
s_lshr_b32 s40, s40, 16
s_mul_i32 s41, s40, 14
s_sub_u32 s41, s3, s41
s_add_u32 s40, s40, 8
s_mov_b32 s22, 14680064
s_mov_b32 s23, 0x20000
s_mov_b64 s[20:21], s[6:7]
s_cmp_ge_u32 s40, 12
s_cselect_b32 s45, 8, 0
s_add_u32 s45, s45, s40
s_lshl2_add_u32 s42, s41, s36
s_mul_i32 s43, s45, 458752
s_lshl_b32 s44, s42, 8
s_add_u32 s43, s43, s44
s_lshl_b32 s44, s42, 5
s_add_u32 s44, s44, s45
s_lshl_b32 s52, s44, 11
s_cmp_lt_u32 s45, 32
s_cselect_b32 s52, s52, 0x1000000
s_cselect_b32 s22, 14680064, 0
s_add_u32 s41, s41, 4
s_add_u32 s40, s40, 2
s_cmp_ge_u32 s41, 14
s_cselect_b32 s48, 14, 0
s_addc_u32 s40, s40, 0
s_sub_u32 s41, s41, s48
s_load_dwordx2 s[50:51], s[12:13], 0
buffer_load_dwordx4 v[32:35], v8, s[20:23], s43 offen
buffer_load_dwordx4 v[36:39], v9, s[20:23], s43 offen
buffer_load_dwordx4 v[40:43], v10, s[20:23], s43 offen
buffer_load_dwordx4 v[44:47], v11, s[20:23], s43 offen
buffer_load_dwordx4 v[48:51], v12, s[20:23], s43 offen
buffer_load_dwordx4 v[52:55], v13, s[20:23], s43 offen
buffer_load_dwordx4 v[56:59], v14, s[20:23], s43 offen
buffer_load_dwordx4 v[60:63], v15, s[20:23], s43 offen
s_mov_b64 s[24:25], s[14:15]
s_mov_b32 s26, 3670016
s_mov_b32 s27, 0x20000
s_movk_i32 s34, 128
v_mov_b32 v16, 0
v_lshlrev_b32 v18, 4, v0
s_movk_i32 s46, 4096
s_waitcnt vmcnt(4) lgkmcnt(0)
v_mov_b64 v[22:23], s[50:51]
s_nop 0
L_PKN:
v_cmp_ne_u64 vcc, 0, v[22:23]
s_sub_u32 s46, s46, 1
s_cmp_gt_i32 s46, 0
s_cbranch_vccnz L_PKGO
s_cbranch_scc0 L_END
buffer_load_dwordx2 v[22:23], v16, s[32:35], 0 offen sc1
s_waitcnt vmcnt(0)
s_branch L_PKN
L_PKGO:
s_call_b64 s[100:101], L_PK0
buffer_store_dwordx4 v[20:23], v18, s[24:27], s52 offen offset:0 sc1
s_waitcnt lgkmcnt(0)
s_call_b64 s[100:101], L_UNIT
s_mov_b32 s53, s49
buffer_load_dwordx4 v[64:67], v8, s[20:23], s43 offen
buffer_load_dwordx4 v[68:71], v9, s[20:23], s43 offen
buffer_load_dwordx4 v[72:75], v10, s[20:23], s43 offen
buffer_load_dwordx4 v[76:79], v11, s[20:23], s43 offen
s_waitcnt vmcnt(5)
s_call_b64 s[100:101], L_PK1
buffer_store_dwordx4 v[20:23], v18, s[24:27], s52 offen offset:1024 sc1
buffer_load_dwordx4 v[80:83], v12, s[20:23], s43 offen
buffer_load_dwordx4 v[84:87], v13, s[20:23], s43 offen
buffer_load_dwordx4 v[88:91], v14, s[20:23], s43 offen
buffer_load_dwordx4 v[92:95], v15, s[20:23], s43 offen
s_waitcnt vmcnt(5)
s_call_b64 s[100:101], L_PK2
buffer_store_dwordx4 v[20:23], v18, s[24:27], s53 offen offset:0 sc1
s_call_b64 s[100:101], L_UNIT
s_mov_b32 s54, s49
buffer_load_dwordx4 v[32:35], v8, s[20:23], s43 offen
buffer_load_dwordx4 v[36:39], v9, s[20:23], s43 offen
buffer_load_dwordx4 v[40:43], v10, s[20:23], s43 offen
buffer_load_dwordx4 v[44:47], v11, s[20:23], s43 offen
s_waitcnt vmcnt(5)
s_call_b64 s[100:101], L_PK3
buffer_store_dwordx4 v[20:23], v18, s[24:27], s53 offen offset:1024 sc1
buffer_load_dwordx4 v[48:51], v12, s[20:23], s43 offen
buffer_load_dwordx4 v[52:55], v13, s[20:23], s43 offen
buffer_load_dwordx4 v[56:59], v14, s[20:23], s43 offen
buffer_load_dwordx4 v[60:63], v15, s[20:23], s43 offen
s_waitcnt vmcnt(5)
s_call_b64 s[100:101], L_PK0
buffer_store_dwordx4 v[20:23], v18, s[24:27], s54 offen offset:0 sc1
s_call_b64 s[100:101], L_UNIT
s_mov_b32 s55, s49
buffer_load_dwordx4 v[64:67], v8, s[20:23], s43 offen
buffer_load_dwordx4 v[68:71], v9, s[20:23], s43 offen
buffer_load_dwordx4 v[72:75], v10, s[20:23], s43 offen
buffer_load_dwordx4 v[76:79], v11, s[20:23], s43 offen
s_waitcnt vmcnt(5)
s_call_b64 s[100:101], L_PK1
buffer_store_dwordx4 v[20:23], v18, s[24:27], s54 offen offset:1024 sc1
buffer_load_dwordx4 v[80:83], v12, s[20:23], s43 offen
buffer_load_dwordx4 v[84:87], v13, s[20:23], s43 offen
buffer_load_dwordx4 v[88:91], v14, s[20:23], s43 offen
buffer_load_dwordx4 v[92:95], v15, s[20:23], s43 offen
s_waitcnt vmcnt(5)
s_call_b64 s[100:101], L_PK2
buffer_store_dwordx4 v[20:23], v18, s[24:27], s55 offen offset:0 sc1
buffer_load_dword v19, v17, s[28:31], 0 offen offset:1152
s_waitcnt vmcnt(2)
s_call_b64 s[100:101], L_PK3
buffer_store_dwordx4 v[20:23], v18, s[24:27], s55 offen offset:1024 sc1
s_call_b64 s[100:101], L_UNIT
s_mov_b32 s52, s49
buffer_load_dwordx4 v[32:35], v8, s[20:23], s43 offen
buffer_load_dwordx4 v[36:39], v9, s[20:23], s43 offen
buffer_load_dwordx4 v[40:43], v10, s[20:23], s43 offen
buffer_load_dwordx4 v[44:47], v11, s[20:23], s43 offen
buffer_load_dwordx4 v[48:51], v12, s[20:23], s43 offen
buffer_load_dwordx4 v[52:55], v13, s[20:23], s43 offen
buffer_load_dwordx4 v[56:59], v14, s[20:23], s43 offen
buffer_load_dwordx4 v[60:63], v15, s[20:23], s43 offen
s_waitcnt vmcnt(4)
s_call_b64 s[100:101], L_PK0
buffer_store_dwordx4 v[20:23], v18, s[24:27], s52 offen offset:0 sc1
s_call_b64 s[100:101], L_UNIT
s_mov_b32 s53, s49
buffer_load_dwordx4 v[64:67], v8, s[20:23], s43 offen
buffer_load_dwordx4 v[68:71], v9, s[20:23], s43 offen
buffer_load_dwordx4 v[72:75], v10, s[20:23], s43 offen
buffer_load_dwordx4 v[76:79], v11, s[20:23], s43 offen
s_waitcnt vmcnt(5)
s_call_b64 s[100:101], L_PK1
buffer_store_dwordx4 v[20:23], v18, s[24:27], s52 offen offset:1024 sc1
buffer_load_dwordx4 v[80:83], v12, s[20:23], s43 offen
buffer_load_dwordx4 v[84:87], v13, s[20:23], s43 offen
buffer_load_dwordx4 v[88:91], v14, s[20:23], s43 offen
buffer_load_dwordx4 v[92:95], v15, s[20:23], s43 offen
s_waitcnt vmcnt(5)
s_call_b64 s[100:101], L_PK2
buffer_store_dwordx4 v[20:23], v18, s[24:27], s53 offen offset:0 sc1
s_call_b64 s[100:101], L_UNIT
s_mov_b32 s54, s49
buffer_load_dwordx4 v[32:35], v8, s[20:23], s43 offen
buffer_load_dwordx4 v[36:39], v9, s[20:23], s43 offen
buffer_load_dwordx4 v[40:43], v10, s[20:23], s43 offen
buffer_load_dwordx4 v[44:47], v11, s[20:23], s43 offen
s_waitcnt vmcnt(5)
s_call_b64 s[100:101], L_PK3
buffer_store_dwordx4 v[20:23], v18, s[24:27], s53 offen offset:1024 sc1
buffer_load_dwordx4 v[48:51], v12, s[20:23], s43 offen
buffer_load_dwordx4 v[52:55], v13, s[20:23], s43 offen
buffer_load_dwordx4 v[56:59], v14, s[20:23], s43 offen
buffer_load_dwordx4 v[60:63], v15, s[20:23], s43 offen
s_waitcnt vmcnt(5)
s_call_b64 s[100:101], L_PK0
buffer_store_dwordx4 v[20:23], v18, s[24:27], s54 offen offset:0 sc1
buffer_load_dword v19, v17, s[28:31], 0 offen offset:1536
s_waitcnt vmcnt(2)
s_call_b64 s[100:101], L_PK1
buffer_store_dwordx4 v[20:23], v18, s[24:27], s54 offen offset:1024 sc1
s_endpgm
L_UNIT:
s_cmp_ge_u32 s40, 12
s_cselect_b32 s45, 8, 0
s_add_u32 s45, s45, s40
s_lshl2_add_u32 s42, s41, s36
s_mul_i32 s43, s45, 458752
s_lshl_b32 s44, s42, 8
s_add_u32 s43, s43, s44
s_lshl_b32 s44, s42, 5
s_add_u32 s44, s44, s45
s_lshl_b32 s49, s44, 11
s_cmp_lt_u32 s45, 32
s_cselect_b32 s49, s49, 0x1000000
s_cselect_b32 s22, 14680064, 0
s_add_u32 s41, s41, 4
s_add_u32 s40, s40, 2
s_cmp_ge_u32 s41, 14
s_cselect_b32 s48, 14, 0
s_addc_u32 s40, s40, 0
s_sub_u32 s41, s41, s48
s_setpc_b64 s[100:101]
L_PK0:
v_lshl_add_u64 v[32:33], v[36:37], 4, v[32:33]
v_lshl_add_u64 v[34:35], v[38:39], 4, v[34:35]
v_lshl_add_u64 v[40:41], v[44:45], 4, v[40:41]
v_lshl_add_u64 v[42:43], v[46:47], 4, v[42:43]
v_lshl_or_b32 v44, v40, 8, v32
v_lshl_or_b32 v45, v41, 8, v33
v_lshl_or_b32 v46, v42, 8, v34
v_lshl_or_b32 v47, v43, 8, v35
v_lshl_or_b32 v20, v45, 16, v44
v_lshl_or_b32 v21, v47, 16, v46
s_setpc_b64 s[100:101]
L_PK1:
v_lshl_add_u64 v[48:49], v[52:53], 4, v[48:49]
v_lshl_add_u64 v[50:51], v[54:55], 4, v[50:51]
v_lshl_add_u64 v[56:57], v[60:61], 4, v[56:57]
v_lshl_add_u64 v[58:59], v[62:63], 4, v[58:59]
v_lshl_or_b32 v60, v56, 8, v48
v_lshl_or_b32 v61, v57, 8, v49
v_lshl_or_b32 v62, v58, 8, v50
v_lshl_or_b32 v63, v59, 8, v51
v_lshl_or_b32 v20, v61, 16, v60
v_lshl_or_b32 v21, v63, 16, v62
s_setpc_b64 s[100:101]
L_PK2:
v_lshl_add_u64 v[64:65], v[68:69], 4, v[64:65]
v_lshl_add_u64 v[66:67], v[70:71], 4, v[66:67]
v_lshl_add_u64 v[72:73], v[76:77], 4, v[72:73]
v_lshl_add_u64 v[74:75], v[78:79], 4, v[74:75]
v_lshl_or_b32 v76, v72, 8, v64
v_lshl_or_b32 v77, v73, 8, v65
v_lshl_or_b32 v78, v74, 8, v66
v_lshl_or_b32 v79, v75, 8, v67
v_lshl_or_b32 v20, v77, 16, v76
v_lshl_or_b32 v21, v79, 16, v78
s_setpc_b64 s[100:101]
L_PK3:
v_lshl_add_u64 v[80:81], v[84:85], 4, v[80:81]
v_lshl_add_u64 v[82:83], v[86:87], 4, v[82:83]
v_lshl_add_u64 v[88:89], v[92:93], 4, v[88:89]
v_lshl_add_u64 v[90:91], v[94:95], 4, v[90:91]
v_lshl_or_b32 v92, v88, 8, v80
v_lshl_or_b32 v93, v89, 8, v81
v_lshl_or_b32 v94, v90, 8, v82
v_lshl_or_b32 v95, v91, 8, v83
v_lshl_or_b32 v20, v93, 16, v92
v_lshl_or_b32 v21, v95, 16, v94
s_setpc_b64 s[100:101]
.p2align 12
L_STREAM:
L_PAD0:
s_cbranch_vccnz L_PADRET0
buffer_load_dwordx4 v[80:83], v30, s[72:75], 0 offen
buffer_load_dwordx4 v[84:87], v30, s[72:75], s92 offen
buffer_load_dwordx4 v[88:91], v30, s[72:75], s93 offen
buffer_load_dwordx4 v[92:95], v30, s[72:75], s94 offen
buffer_load_dwordx4 v[40:43], v31, s[72:75], 0 offen
buffer_load_dwordx4 v[44:47], v31, s[72:75], s92 offen
buffer_load_dwordx4 v[48:51], v31, s[72:75], s93 offen
buffer_load_dwordx4 v[52:55], v31, s[72:75], s94 offen
s_waitcnt vmcnt(13)
s_barrier
ds_read_b128 a[224:227], v2 offset:0
ds_read_b128 a[228:231], v2 offset:2048
v_lshl_add_u32 v104, v104, 8, v19
v_lshl_add_u32 v105, v105, 8, v19
v_lshl_add_u32 v106, v106, 8, v19
v_lshl_add_u32 v107, v107, 8, v19
v_lshl_add_u32 v112, v112, 8, v19
v_lshl_add_u32 v113, v113, 8, v19
v_lshl_add_u32 v114, v114, 8, v19
v_lshl_add_u32 v115, v115, 8, v19
s_waitcnt vmcnt(9)
s_add_u32 m0, s33, 81920
v_lshl_add_u64 v[64:65], v[68:69], 4, v[64:65]
v_lshl_add_u64 v[66:67], v[70:71], 4, v[66:67]
v_lshl_add_u64 v[72:73], v[76:77], 4, v[72:73]
v_lshl_add_u64 v[74:75], v[78:79], 4, v[74:75]
v_lshl_add_u32 v64, v64, 8, v19
v_lshl_add_u32 v65, v65, 8, v19
v_lshl_add_u32 v66, v66, 8, v19
v_lshl_add_u32 v67, v67, 8, v19
v_lshl_add_u32 v72, v72, 8, v19
v_lshl_add_u32 v73, v73, 8, v19
v_lshl_add_u32 v74, v74, 8, v19
v_lshl_add_u32 v75, v75, 8, v19
s_bitcmp1_b32 s37, 0
s_cbranch_scc0 L_NOSWAP
v_swap_b32 v104, v64
v_swap_b32 v105, v65
v_swap_b32 v106, v66
v_swap_b32 v107, v67
v_swap_b32 v112, v72
v_swap_b32 v113, v73
v_swap_b32 v114, v74
v_swap_b32 v115, v75
L_NOSWAP:
ds_read_b32 a0, v104
ds_read_b32 a1, v112
ds_read_b32 a2, v64
ds_read_b32 a3, v72
ds_read_b32 a4, v105
ds_read_b32 a5, v113
ds_read_b32 a6, v65
ds_read_b32 a7, v73
ds_read_b32 a8, v106
ds_read_b32 a9, v114
ds_read_b32 a10, v66
ds_read_b32 a11, v74
ds_read_b32 a12, v107
ds_read_b32 a13, v115
ds_read_b32 a14, v67
ds_read_b32 a15, v75
s_waitcnt lgkmcnt(12)
v_mfma_f32_16x16x32_bf16 v[128:131], a[224:227], a[0:3], 0
s_waitcnt lgkmcnt(8)
ds_read_b128 a[232:235], v2 offset:4096
buffer_load_dwordx4 v8, s[20:23], s41 offen lds
v_mfma_f32_16x16x32_bf16 v[132:135], a[224:227], a[4:7], 0
s_waitcnt lgkmcnt(5)
v_mfma_f32_16x16x32_bf16 v[136:139], a[224:227], a[8:11], 0
s_waitcnt lgkmcnt(1)
s_add_u32 m0, s33, 86016
v_mfma_f32_16x16x32_bf16 v[140:143], a[224:227], a[12:15], 0
v_mfma_f32_16x16x32_bf16 v[144:147], a[228:231], a[0:3], 0
ds_read_b128 a[236:239], v2 offset:6144
buffer_load_dwordx4 v9, s[20:23], s41 offen lds
v_mfma_f32_16x16x32_bf16 v[148:151], a[228:231], a[4:7], 0
v_mfma_f32_16x16x32_bf16 v[152:155], a[228:231], a[8:11], 0
s_add_u32 m0, s33, 90112
v_mfma_f32_16x16x32_bf16 v[156:159], a[228:231], a[12:15], 0
s_waitcnt lgkmcnt(1)
v_mfma_f32_16x16x32_bf16 v[160:163], a[232:235], a[0:3], 0
ds_read_b128 a[240:243], v2 offset:8192
buffer_load_dwordx4 v10, s[20:23], s41 offen lds
v_mfma_f32_16x16x32_bf16 v[164:167], a[232:235], a[4:7], 0
v_mfma_f32_16x16x32_bf16 v[168:171], a[232:235], a[8:11], 0
s_add_u32 m0, s33, 94208
v_mfma_f32_16x16x32_bf16 v[172:175], a[232:235], a[12:15], 0
s_waitcnt lgkmcnt(1)
v_mfma_f32_16x16x32_bf16 v[176:179], a[236:239], a[0:3], 0
ds_read_b128 a[244:247], v2 offset:10240
buffer_load_dwordx4 v11, s[20:23], s41 offen lds
v_mfma_f32_16x16x32_bf16 v[180:183], a[236:239], a[4:7], 0
v_mfma_f32_16x16x32_bf16 v[184:187], a[236:239], a[8:11], 0
v_mfma_f32_16x16x32_bf16 v[188:191], a[236:239], a[12:15], 0
s_waitcnt lgkmcnt(1)
v_mfma_f32_16x16x32_bf16 v[192:195], a[240:243], a[0:3], 0
v_mfma_f32_16x16x32_bf16 v[196:199], a[240:243], a[4:7], 0
v_mfma_f32_16x16x32_bf16 v[200:203], a[240:243], a[8:11], 0
v_mfma_f32_16x16x32_bf16 v[204:207], a[240:243], a[12:15], 0
s_waitcnt lgkmcnt(0)
v_mfma_f32_16x16x32_bf16 v[208:211], a[244:247], a[0:3], 0
ds_read_b128 a[248:251], v2 offset:12288
v_mfma_f32_16x16x32_bf16 v[212:215], a[244:247], a[4:7], 0
v_mfma_f32_16x16x32_bf16 v[216:219], a[244:247], a[8:11], 0
v_mfma_f32_16x16x32_bf16 v[220:223], a[244:247], a[12:15], 0
s_waitcnt vmcnt(10)
ds_read_b128 a[252:255], v2 offset:14336
v_lshl_add_u64 v[80:81], v[84:85], 4, v[80:81]
v_lshl_add_u64 v[82:83], v[86:87], 4, v[82:83]
v_lshl_add_u32 v80, v80, 8, v19
v_lshl_add_u32 v81, v81, 8, v19
v_lshl_add_u32 v82, v82, 8, v19
v_lshl_add_u32 v83, v83, 8, v19
ds_read_b32 a16, v80
ds_read_b32 a20, v81
ds_read_b32 a24, v82
ds_read_b32 a28, v83
s_waitcnt vmcnt(8)
v_lshl_add_u64 v[88:89], v[92:93], 4, v[88:89]
v_lshl_add_u64 v[90:91], v[94:95], 4, v[90:91]
v_lshl_add_u32 v88, v88, 8, v19
v_lshl_add_u32 v89, v89, 8, v19
v_lshl_add_u32 v90, v90, 8, v19
v_lshl_add_u32 v91, v91, 8, v19
ds_read_b32 a17, v88
ds_read_b32 a21, v89
ds_read_b32 a25, v90
ds_read_b32 a29, v91
s_waitcnt vmcnt(6)
buffer_load_dwordx4 v[32:35], v12, s[24:27], 0 offen offset:0 sc1
v_lshl_add_u64 v[40:41], v[44:45], 4, v[40:41]
v_lshl_add_u64 v[42:43], v[46:47], 4, v[42:43]
v_lshl_add_u32 v40, v40, 8, v19
v_lshl_add_u32 v41, v41, 8, v19
v_lshl_add_u32 v42, v42, 8, v19
v_lshl_add_u32 v43, v43, 8, v19
ds_read_b32 a18, v40
ds_read_b32 a22, v41
ds_read_b32 a26, v42
ds_read_b32 a30, v43
s_waitcnt vmcnt(5) lgkmcnt(13)
buffer_load_dwordx4 v[36:39], v12, s[24:27], 0 offen offset:1024 sc1
v_lshl_add_u64 v[48:49], v[52:53], 4, v[48:49]
v_lshl_add_u64 v[50:51], v[54:55], 4, v[50:51]
v_lshl_add_u32 v48, v48, 8, v19
v_lshl_add_u32 v49, v49, 8, v19
v_lshl_add_u32 v50, v50, 8, v19
v_lshl_add_u32 v51, v51, 8, v19
ds_read_b32 a19, v48
ds_read_b32 a23, v49
ds_read_b32 a27, v50
ds_read_b32 a31, v51
v_mfma_f32_16x16x32_bf16 v[224:227], a[248:251], a[0:3], 0
ds_read_b128 a[224:227], v4 offset:0
v_mfma_f32_16x16x32_bf16 v[228:231], a[248:251], a[4:7], 0
v_mfma_f32_16x16x32_bf16 v[232:235], a[248:251], a[8:11], 0
global_load_dwordx2 v[20:21], v28, s[8:9]
v_mfma_f32_16x16x32_bf16 v[236:239], a[248:251], a[12:15], 0
s_waitcnt lgkmcnt(5)
v_mfma_f32_16x16x32_bf16 v[240:243], a[252:255], a[0:3], 0
ds_read_b128 a[228:231], v4 offset:2048
v_mfma_f32_16x16x32_bf16 v[244:247], a[252:255], a[4:7], 0
v_mfma_f32_16x16x32_bf16 v[248:251], a[252:255], a[8:11], 0
v_mfma_f32_16x16x32_bf16 v[252:255], a[252:255], a[12:15], 0
s_waitcnt lgkmcnt(1)
v_mfma_f32_16x16x32_bf16 v[128:131], a[224:227], a[16:19], v[128:131]
ds_read_b128 a[232:235], v4 offset:4096
v_mfma_f32_16x16x32_bf16 v[132:135], a[224:227], a[20:23], v[132:135]
v_mfma_f32_16x16x32_bf16 v[136:139], a[224:227], a[24:27], v[136:139]
buffer_load_dwordx4 v[40:43], v12, s[24:27], 0 offen offset:2048 sc1
v_mfma_f32_16x16x32_bf16 v[140:143], a[224:227], a[28:31], v[140:143]
s_waitcnt lgkmcnt(1)
buffer_load_dwordx4 v[44:47], v12, s[24:27], 0 offen offset:3072 sc1
v_mfma_f32_16x16x32_bf16 v[144:147], a[228:231], a[16:19], v[144:147]
ds_read_b128 a[236:239], v4 offset:6144
v_lshl_add_u32 v12, s42, 5, v13
v_mfma_f32_16x16x32_bf16 v[148:151], a[228:231], a[20:23], v[148:151]
v_mfma_f32_16x16x32_bf16 v[152:155], a[228:231], a[24:27], v[152:155]
v_mfma_f32_16x16x32_bf16 v[156:159], a[228:231], a[28:31], v[156:159]
s_waitcnt lgkmcnt(1)
v_mfma_f32_16x16x32_bf16 v[160:163], a[232:235], a[16:19], v[160:163]
ds_read_b128 a[240:243], v4 offset:8192
v_mfma_f32_16x16x32_bf16 v[164:167], a[232:235], a[20:23], v[164:167]
v_mfma_f32_16x16x32_bf16 v[168:171], a[232:235], a[24:27], v[168:171]
v_mfma_f32_16x16x32_bf16 v[172:175], a[232:235], a[28:31], v[172:175]
s_waitcnt lgkmcnt(1)
v_mfma_f32_16x16x32_bf16 v[176:179], a[236:239], a[16:19], v[176:179]
ds_read_b128 a[244:247], v4 offset:10240
buffer_load_dwordx4 v[48:51], v12, s[24:27], 0 offen offset:0 sc1
v_mfma_f32_16x16x32_bf16 v[180:183], a[236:239], a[20:23], v[180:183]
buffer_load_dwordx4 v[52:55], v12, s[24:27], 0 offen offset:1024 sc1
v_mfma_f32_16x16x32_bf16 v[184:187], a[236:239], a[24:27], v[184:187]
s_add_u32 m0, s33, 98304
v_mfma_f32_16x16x32_bf16 v[188:191], a[236:239], a[28:31], v[188:191]
s_waitcnt lgkmcnt(1)
v_mfma_f32_16x16x32_bf16 v[192:195], a[240:243], a[16:19], v[192:195]
buffer_load_dwordx4 v8, s[20:23], s42 offen lds
v_mfma_f32_16x16x32_bf16 v[196:199], a[240:243], a[20:23], v[196:199]
v_mfma_f32_16x16x32_bf16 v[200:203], a[240:243], a[24:27], v[200:203]
s_add_u32 m0, s33, 102400
v_mfma_f32_16x16x32_bf16 v[204:207], a[240:243], a[28:31], v[204:207]
s_waitcnt lgkmcnt(0)
v_mfma_f32_16x16x32_bf16 v[208:211], a[244:247], a[16:19], v[208:211]
s_waitcnt vmcnt(8)
s_barrier
ds_read_b128 a[248:251], v4 offset:12288
buffer_load_dwordx4 v9, s[20:23], s42 offen lds
v_mfma_f32_16x16x32_bf16 v[212:215], a[244:247], a[20:23], v[212:215]
buffer_load_dwordx4 v[96:99], v12, s[24:27], 0 offen offset:2048 sc1
v_mfma_f32_16x16x32_bf16 v[216:219], a[244:247], a[24:27], v[216:219]
buffer_load_dwordx4 v[100:103], v12, s[24:27], 0 offen offset:3072 sc1
v_lshl_add_u32 v12, s43, 5, v13
v_mfma_f32_16x16x32_bf16 v[220:223], a[244:247], a[28:31], v[220:223]
s_add_u32 m0, s33, 106496
ds_read_b128 a[252:255], v4 offset:14336
buffer_load_dwordx4 v10, s[20:23], s42 offen lds
s_waitcnt vmcnt(10)
v_cmp_ne_u64 s[50:51], s[88:89], v[34:35]
v_cmp_ne_u64 s[44:45], s[88:89], v[38:39]
s_or_b64 s[50:51], s[44:45], s[50:51]
s_cbranch_scc1 L_SLOW2
L_BACK2:
v_perm_b32 v64, v32, v19, s52
v_perm_b32 v65, v32, v19, s53
v_perm_b32 v66, v36, v19, s52
v_perm_b32 v67, v36, v19, s53
v_perm_b32 v68, v32, v19, s54
v_perm_b32 v69, v32, v19, s55
v_perm_b32 v70, v36, v19, s54
v_perm_b32 v71, v36, v19, s55
ds_read_b32 a32, v64
ds_read_b32 a33, v65
ds_read_b32 a34, v66
ds_read_b32 a35, v67
ds_read_b32 a36, v68
ds_read_b32 a37, v69
ds_read_b32 a38, v70
ds_read_b32 a39, v71
v_perm_b32 v72, v33, v19, s52
v_perm_b32 v73, v33, v19, s53
v_perm_b32 v74, v37, v19, s52
v_perm_b32 v75, v37, v19, s53
v_perm_b32 v76, v33, v19, s54
v_perm_b32 v77, v33, v19, s55
v_perm_b32 v78, v37, v19, s54
v_perm_b32 v79, v37, v19, s55
ds_read_b32 a40, v72
ds_read_b32 a41, v73
ds_read_b32 a42, v74
ds_read_b32 a43, v75
ds_read_b32 a44, v76
ds_read_b32 a45, v77
ds_read_b32 a46, v78
ds_read_b32 a47, v79
s_waitcnt vmcnt(7)
s_add_u32 m0, s33, 110592
v_cmp_ne_u64 s[50:51], s[88:89], v[42:43]
v_cmp_ne_u64 s[44:45], s[88:89], v[46:47]
s_waitcnt lgkmcnt(15)
v_mfma_f32_16x16x32_bf16 v[224:227], a[248:251], a[16:19], v[224:227]
s_or_b64 s[50:51], s[44:45], s[50:51]
ds_read_b128 a[224:227], v14 offset:16384
buffer_load_dwordx4 v11, s[20:23], s42 offen lds
v_mfma_f32_16x16x32_bf16 v[228:231], a[248:251], a[20:23], v[228:231]
s_cbranch_scc1 L_SLOW3
L_BACK3:
v_mfma_f32_16x16x32_bf16 v[232:235], a[248:251], a[24:27], v[232:235]
s_add_u32 m0, s33, 114688
v_mfma_f32_16x16x32_bf16 v[236:239], a[248:251], a[28:31], v[236:239]
v_mfma_f32_16x16x32_bf16 v[240:243], a[252:255], a[16:19], v[240:243]
ds_read_b128 a[228:231], v14 offset:18432
buffer_load_dwordx4 v8, s[20:23], s43 offen lds
v_mfma_f32_16x16x32_bf16 v[244:247], a[252:255], a[20:23], v[244:247]
buffer_load_dwordx4 v[104:107], v30, s[16:19], 0 offen
v_mfma_f32_16x16x32_bf16 v[248:251], a[252:255], a[24:27], v[248:251]
s_add_u32 m0, s33, 118784
v_mfma_f32_16x16x32_bf16 v[252:255], a[252:255], a[28:31], v[252:255]
s_waitcnt lgkmcnt(1)
v_mfma_f32_16x16x32_bf16 v[128:131], a[224:227], a[32:35], v[128:131]
ds_read_b128 a[232:235], v14 offset:20480
buffer_load_dwordx4 v9, s[20:23], s43 offen lds
v_mfma_f32_16x16x32_bf16 v[132:135], a[224:227], a[36:39], v[132:135]
v_perm_b32 v63, v40, v19, s52
v_mfma_f32_16x16x32_bf16 v[136:139], a[224:227], a[40:43], v[136:139]
s_add_u32 m0, s33, 122880
ds_read_b32 a48, v63
v_perm_b32 v62, v40, v19, s53
v_mfma_f32_16x16x32_bf16 v[140:143], a[224:227], a[44:47], v[140:143]
s_waitcnt lgkmcnt(2)
ds_read_b32 a49, v62
v_perm_b32 v61, v44, v19, s52
v_mfma_f32_16x16x32_bf16 v[144:147], a[228:231], a[32:35], v[144:147]
ds_read_b128 a[236:239], v14 offset:22528
buffer_load_dwordx4 v10, s[20:23], s43 offen lds
v_mfma_f32_16x16x32_bf16 v[148:151], a[228:231], a[36:39], v[148:151]
buffer_load_dwordx4 v[108:111], v30, s[16:19], s92 offen
v_mfma_f32_16x16x32_bf16 v[152:155], a[228:231], a[40:43], v[152:155]
s_add_u32 m0, s33, 126976
ds_read_b32 a50, v61
v_perm_b32 v60, v44, v19, s53
v_mfma_f32_16x16x32_bf16 v[156:159], a[228:231], a[44:47], v[156:159]
s_waitcnt lgkmcnt(3)
ds_read_b32 a51, v60
v_perm_b32 v59, v40, v19, s54
v_mfma_f32_16x16x32_bf16 v[160:163], a[232:235], a[32:35], v[160:163]
ds_read_b128 a[240:243], v14 offset:24576
buffer_load_dwordx4 v11, s[20:23], s43 offen lds
v_mfma_f32_16x16x32_bf16 v[164:167], a[232:235], a[36:39], v[164:167]
ds_read_b32 a52, v59
v_perm_b32 v58, v40, v19, s55
v_mfma_f32_16x16x32_bf16 v[168:171], a[232:235], a[40:43], v[168:171]
ds_read_b32 a53, v58
v_perm_b32 v57, v44, v19, s54
v_mfma_f32_16x16x32_bf16 v[172:175], a[232:235], a[44:47], v[172:175]
s_waitcnt lgkmcnt(4)
ds_read_b32 a54, v57
buffer_load_dwordx4 v[80:83], v12, s[24:27], 0 offen offset:0 sc1
v_mfma_f32_16x16x32_bf16 v[176:179], a[236:239], a[32:35], v[176:179]
ds_read_b128 a[244:247], v14 offset:26624
v_perm_b32 v56, v44, v19, s55
v_mfma_f32_16x16x32_bf16 v[180:183], a[236:239], a[36:39], v[180:183]
buffer_load_dwordx4 v[112:115], v30, s[16:19], s93 offen
v_mfma_f32_16x16x32_bf16 v[184:187], a[236:239], a[40:43], v[184:187]
ds_read_b32 a55, v56
v_perm_b32 v63, v41, v19, s52
v_mfma_f32_16x16x32_bf16 v[188:191], a[236:239], a[44:47], v[188:191]
s_waitcnt lgkmcnt(3)
ds_read_b32 a56, v63
buffer_load_dwordx4 v[84:87], v12, s[24:27], 0 offen offset:1024 sc1
v_mfma_f32_16x16x32_bf16 v[192:195], a[240:243], a[32:35], v[192:195]
ds_read_b128 a[248:251], v14 offset:28672
v_perm_b32 v62, v41, v19, s53
v_mfma_f32_16x16x32_bf16 v[196:199], a[240:243], a[36:39], v[196:199]
ds_read_b32 a57, v62
v_perm_b32 v61, v45, v19, s52
v_mfma_f32_16x16x32_bf16 v[200:203], a[240:243], a[40:43], v[200:203]
s_add_u32 m0, s33, 130560
ds_read_b32 a58, v61
v_perm_b32 v60, v45, v19, s53
v_mfma_f32_16x16x32_bf16 v[204:207], a[240:243], a[44:47], v[204:207]
s_waitcnt lgkmcnt(4)
ds_read_b32 a59, v60
v_perm_b32 v59, v41, v19, s54
v_mfma_f32_16x16x32_bf16 v[208:211], a[244:247], a[32:35], v[208:211]
ds_read_b128 a[252:255], v14 offset:30720
buffer_load_dwordx4 v8, s[20:23], 0 offen offset:512 lds
v_mfma_f32_16x16x32_bf16 v[212:215], a[244:247], a[36:39], v[212:215]
buffer_load_dwordx4 v[116:119], v30, s[16:19], s94 offen
v_mfma_f32_16x16x32_bf16 v[216:219], a[244:247], a[40:43], v[216:219]
ds_read_b32 a60, v59
v_perm_b32 v58, v41, v19, s55
s_mov_b64 vcc, -1
s_cmp_eq_u32 s36, 0
s_cbranch_scc1 L_PAD1
s_cmp_eq_u32 s36, 1
s_cbranch_scc1 L_PAD3
s_cmp_eq_u32 s36, 2
s_cbranch_scc1 L_PAD5
s_cmp_eq_u32 s36, 3
s_cbranch_scc1 L_PADS
L_PADRET:
s_mov_b64 vcc, 0
v_mfma_f32_16x16x32_bf16 v[220:223], a[244:247], a[44:47], v[220:223]
s_waitcnt lgkmcnt(3)
ds_read_b32 a61, v58
v_mfma_f32_16x16x32_bf16 v[224:227], a[248:251], a[32:35], v[224:227]
ds_read_b128 a[224:227], v15 offset:16384
v_perm_b32 v57, v45, v19, s54
v_mfma_f32_16x16x32_bf16 v[228:231], a[248:251], a[36:39], v[228:231]
ds_read_b32 a62, v57
v_perm_b32 v56, v45, v19, s55
v_mfma_f32_16x16x32_bf16 v[232:235], a[248:251], a[40:43], v[232:235]
ds_read_b32 a63, v56
v_mfma_f32_16x16x32_bf16 v[236:239], a[248:251], a[44:47], v[236:239]
s_waitcnt lgkmcnt(4)
v_mfma_f32_16x16x32_bf16 v[240:243], a[252:255], a[32:35], v[240:243]
ds_read_b128 a[228:231], v15 offset:18432
v_lshlrev_b32 v24, 16, v20
v_mfma_f32_16x16x32_bf16 v[244:247], a[252:255], a[36:39], v[244:247]
v_and_b32 v25, 0xffff0000, v20
v_lshlrev_b32 v26, 16, v21
v_mfma_f32_16x16x32_bf16 v[248:251], a[252:255], a[40:43], v[248:251]
s_waitcnt vmcnt(17)
v_cmp_ne_u64 s[50:51], s[88:89], v[50:51]
v_cmp_ne_u64 s[44:45], s[88:89], v[54:55]
v_mfma_f32_16x16x32_bf16 v[252:255], a[252:255], a[44:47], v[252:255]
s_waitcnt lgkmcnt(1)
v_and_b32 v27, 0xffff0000, v21
v_mfma_f32_16x16x32_bf16 v[128:131], a[224:227], a[48:51], v[128:131]
s_or_b64 s[50:51], s[44:45], s[50:51]
ds_read_b128 a[232:235], v15 offset:20480
buffer_load_dwordx4 v[88:91], v12, s[24:27], 0 offen offset:2048 sc1
v_mfma_f32_16x16x32_bf16 v[132:135], a[224:227], a[52:55], v[132:135]
s_cbranch_scc1 L_SLOW4
L_BACK4:
v_mfma_f32_16x16x32_bf16 v[136:139], a[224:227], a[56:59], v[136:139]
buffer_load_dwordx4 v[92:95], v12, s[24:27], 0 offen offset:3072 sc1
v_perm_b32 v63, v48, v19, s52
v_mfma_f32_16x16x32_bf16 v[140:143], a[224:227], a[60:63], v[140:143]
s_waitcnt lgkmcnt(1)
ds_read_b32 a64, v63
v_add_u32 v12, 16384, v13
v_mfma_f32_16x16x32_bf16 v[144:147], a[228:231], a[48:51], v[144:147]
ds_read_b128 a[236:239], v15 offset:22528
v_perm_b32 v62, v48, v19, s53
v_mfma_f32_16x16x32_bf16 v[148:151], a[228:231], a[52:55], v[148:151]
ds_read_b32 a65, v62
v_perm_b32 v61, v52, v19, s52
v_mfma_f32_16x16x32_bf16 v[152:155], a[228:231], a[56:59], v[152:155]
ds_read_b32 a66, v61
v_perm_b32 v60, v52, v19, s53
v_mfma_f32_16x16x32_bf16 v[156:159], a[228:231], a[60:63], v[156:159]
s_waitcnt lgkmcnt(4)
ds_read_b32 a67, v60
v_mfma_f32_16x16x32_bf16 v[160:163], a[232:235], a[48:51], v[160:163]
ds_read_b128 a[240:243], v15 offset:24576
v_perm_b32 v59, v48, v19, s54
v_mfma_f32_16x16x32_bf16 v[164:167], a[232:235], a[52:55], v[164:167]
ds_read_b32 a68, v59
v_perm_b32 v58, v48, v19, s55
v_mfma_f32_16x16x32_bf16 v[168:171], a[232:235], a[56:59], v[168:171]
s_add_u32 m0, s33, 134656
ds_read_b32 a69, v58
v_perm_b32 v57, v52, v19, s54
v_mfma_f32_16x16x32_bf16 v[172:175], a[232:235], a[60:63], v[172:175]
s_waitcnt lgkmcnt(4)
ds_read_b32 a70, v57
v_perm_b32 v56, v52, v19, s55
v_mfma_f32_16x16x32_bf16 v[176:179], a[236:239], a[48:51], v[176:179]
ds_read_b128 a[244:247], v15 offset:26624
buffer_load_dwordx4 v9, s[20:23], 0 offen offset:512 lds
v_mfma_f32_16x16x32_bf16 v[180:183], a[236:239], a[52:55], v[180:183]
ds_read_b32 a71, v56
v_perm_b32 v63, v49, v19, s52
v_mfma_f32_16x16x32_bf16 v[184:187], a[236:239], a[56:59], v[184:187]
ds_read_b32 a72, v63
v_perm_b32 v62, v49, v19, s53
v_mfma_f32_16x16x32_bf16 v[188:191], a[236:239], a[60:63], v[188:191]
s_waitcnt lgkmcnt(4)
ds_read_b32 a73, v62
v_mfma_f32_16x16x32_bf16 v[192:195], a[240:243], a[48:51], v[192:195]
s_waitcnt vmcnt(13)
s_barrier
ds_read_b128 a[248:251], v15 offset:28672
v_perm_b32 v61, v53, v19, s52
v_mfma_f32_16x16x32_bf16 v[196:199], a[240:243], a[52:55], v[196:199]
ds_read_b32 a74, v61
v_perm_b32 v60, v53, v19, s53
v_mfma_f32_16x16x32_bf16 v[200:203], a[240:243], a[56:59], v[200:203]
ds_read_b32 a75, v60
v_perm_b32 v59, v49, v19, s54
v_mfma_f32_16x16x32_bf16 v[204:207], a[240:243], a[60:63], v[204:207]
s_waitcnt lgkmcnt(4)
ds_read_b32 a76, v59
v_mfma_f32_16x16x32_bf16 v[208:211], a[244:247], a[48:51], v[208:211]
ds_read_b128 a[252:255], v15 offset:30720
v_perm_b32 v58, v49, v19, s55
v_mfma_f32_16x16x32_bf16 v[212:215], a[244:247], a[52:55], v[212:215]
ds_read_b32 a77, v58
v_perm_b32 v57, v53, v19, s54
v_mfma_f32_16x16x32_bf16 v[216:219], a[244:247], a[56:59], v[216:219]
v_cmp_ne_u64 s[50:51], s[88:89], v[98:99]
v_cmp_ne_u64 s[44:45], s[88:89], v[102:103]
v_mfma_f32_16x16x32_bf16 v[220:223], a[244:247], a[60:63], v[220:223]
s_waitcnt lgkmcnt(3)
ds_read_b32 a78, v57
v_mfma_f32_16x16x32_bf16 v[224:227], a[248:251], a[48:51], v[224:227]
s_or_b64 s[50:51], s[44:45], s[50:51]
ds_read_b128 a[224:227], v14 offset:32768
v_perm_b32 v56, v53, v19, s55
v_mfma_f32_16x16x32_bf16 v[228:231], a[248:251], a[52:55], v[228:231]
s_cbranch_scc1 L_SLOW5
L_BACK5:
v_mfma_f32_16x16x32_bf16 v[232:235], a[248:251], a[56:59], v[232:235]
s_add_u32 m0, s33, 138752
ds_read_b32 a79, v56
v_mfma_f32_16x16x32_bf16 v[236:239], a[248:251], a[60:63], v[236:239]
s_waitcnt lgkmcnt(3)
v_perm_b32 v63, v96, v19, s52
v_mfma_f32_16x16x32_bf16 v[240:243], a[252:255], a[48:51], v[240:243]
ds_read_b128 a[228:231], v14 offset:34816
buffer_load_dwordx4 v10, s[20:23], 0 offen offset:512 lds
v_mfma_f32_16x16x32_bf16 v[244:247], a[252:255], a[52:55], v[244:247]
ds_read_b32 a80, v63
v_perm_b32 v62, v96, v19, s53
v_mfma_f32_16x16x32_bf16 v[248:251], a[252:255], a[56:59], v[248:251]
ds_read_b32 a81, v62
v_perm_b32 v61, v100, v19, s52
v_mfma_f32_16x16x32_bf16 v[252:255], a[252:255], a[60:63], v[252:255]
s_waitcnt lgkmcnt(3)
ds_read_b32 a82, v61
v_mfma_f32_16x16x32_bf16 v[128:131], a[224:227], a[64:67], v[128:131]
ds_read_b128 a[232:235], v14 offset:36864
v_perm_b32 v60, v100, v19, s53
v_mfma_f32_16x16x32_bf16 v[132:135], a[224:227], a[68:71], v[132:135]
ds_read_b32 a83, v60
v_perm_b32 v59, v96, v19, s54
v_mfma_f32_16x16x32_bf16 v[136:139], a[224:227], a[72:75], v[136:139]
ds_read_b32 a84, v59
v_perm_b32 v58, v96, v19, s55
v_mfma_f32_16x16x32_bf16 v[140:143], a[224:227], a[76:79], v[140:143]
s_waitcnt lgkmcnt(4)
ds_read_b32 a85, v58
buffer_load_dwordx4 v[32:35], v12, s[24:27], 0 offen offset:0 sc1
v_mfma_f32_16x16x32_bf16 v[144:147], a[228:231], a[64:67], v[144:147]
ds_read_b128 a[236:239], v14 offset:38912
v_perm_b32 v57, v100, v19, s54
v_mfma_f32_16x16x32_bf16 v[148:151], a[228:231], a[68:71], v[148:151]
ds_read_b32 a86, v57
v_perm_b32 v56, v100, v19, s55
v_mfma_f32_16x16x32_bf16 v[152:155], a[228:231], a[72:75], v[152:155]
s_add_u32 m0, s33, 142848
ds_read_b32 a87, v56
v_perm_b32 v63, v97, v19, s52
v_mfma_f32_16x16x32_bf16 v[156:159], a[228:231], a[76:79], v[156:159]
s_waitcnt lgkmcnt(4)
ds_read_b32 a88, v63
v_perm_b32 v62, v97, v19, s53
v_mfma_f32_16x16x32_bf16 v[160:163], a[232:235], a[64:67], v[160:163]
ds_read_b128 a[240:243], v14 offset:40960
buffer_load_dwordx4 v11, s[20:23], 0 offen offset:512 lds
v_mfma_f32_16x16x32_bf16 v[164:167], a[232:235], a[68:71], v[164:167]
ds_read_b32 a89, v62
v_perm_b32 v61, v101, v19, s52
v_mfma_f32_16x16x32_bf16 v[168:171], a[232:235], a[72:75], v[168:171]
ds_read_b32 a90, v61
v_perm_b32 v60, v101, v19, s53
v_mfma_f32_16x16x32_bf16 v[172:175], a[232:235], a[76:79], v[172:175]
s_waitcnt lgkmcnt(4)
ds_read_b32 a91, v60
buffer_load_dwordx4 v[36:39], v12, s[24:27], 0 offen offset:1024 sc1
v_mfma_f32_16x16x32_bf16 v[176:179], a[236:239], a[64:67], v[176:179]
ds_read_b128 a[244:247], v14 offset:43008
v_perm_b32 v59, v97, v19, s54
v_mfma_f32_16x16x32_bf16 v[180:183], a[236:239], a[68:71], v[180:183]
ds_read_b32 a92, v59
v_perm_b32 v58, v97, v19, s55
v_mfma_f32_16x16x32_bf16 v[184:187], a[236:239], a[72:75], v[184:187]
s_waitcnt vmcnt(9)
v_cmp_ne_u64 s[50:51], s[88:89], v[82:83]
v_cmp_ne_u64 s[44:45], s[88:89], v[86:87]
v_mfma_f32_16x16x32_bf16 v[188:191], a[236:239], a[76:79], v[188:191]
s_waitcnt lgkmcnt(3)
ds_read_b32 a93, v58
v_mfma_f32_16x16x32_bf16 v[192:195], a[240:243], a[64:67], v[192:195]
s_or_b64 s[50:51], s[44:45], s[50:51]
ds_read_b128 a[248:251], v14 offset:45056
v_perm_b32 v57, v101, v19, s54
v_mfma_f32_16x16x32_bf16 v[196:199], a[240:243], a[68:71], v[196:199]
s_cbranch_scc1 L_SLOW6
L_BACK6:
v_mfma_f32_16x16x32_bf16 v[200:203], a[240:243], a[72:75], v[200:203]
s_add_u32 m0, s33, 146816
ds_read_b32 a94, v57
v_perm_b32 v56, v101, v19, s55
v_mfma_f32_16x16x32_bf16 v[204:207], a[240:243], a[76:79], v[204:207]
s_waitcnt lgkmcnt(3)
ds_read_b32 a95, v56
v_perm_b32 v63, v80, v19, s52
v_mfma_f32_16x16x32_bf16 v[208:211], a[244:247], a[64:67], v[208:211]
ds_read_b128 a[252:255], v14 offset:47104
buffer_load_dwordx4 v8, s[20:23], 0 offen offset:640 lds
v_mfma_f32_16x16x32_bf16 v[212:215], a[244:247], a[68:71], v[212:215]
L_PAD1:
s_cbranch_vccnz L_PAD2
ds_read_b32 a96, v63
v_perm_b32 v62, v80, v19, s53
v_mfma_f32_16x16x32_bf16 v[216:219], a[244:247], a[72:75], v[216:219]
ds_read_b32 a97, v62
v_perm_b32 v61, v84, v19, s52
v_mfma_f32_16x16x32_bf16 v[220:223], a[244:247], a[76:79], v[220:223]
s_waitcnt lgkmcnt(4)
ds_read_b32 a98, v61
v_mfma_f32_16x16x32_bf16 v[224:227], a[248:251], a[64:67], v[224:227]
ds_read_b128 a[224:227], v15 offset:32768
v_perm_b32 v60, v84, v19, s53
v_mfma_f32_16x16x32_bf16 v[228:231], a[248:251], a[68:71], v[228:231]
ds_read_b32 a99, v60
v_perm_b32 v59, v80, v19, s54
v_mfma_f32_16x16x32_bf16 v[232:235], a[248:251], a[72:75], v[232:235]
ds_read_b32 a100, v59
v_perm_b32 v58, v80, v19, s55
v_mfma_f32_16x16x32_bf16 v[236:239], a[248:251], a[76:79], v[236:239]
s_waitcnt lgkmcnt(4)
ds_read_b32 a101, v58
v_mfma_f32_16x16x32_bf16 v[240:243], a[252:255], a[64:67], v[240:243]
ds_read_b128 a[228:231], v15 offset:36864
v_perm_b32 v57, v84, v19, s54
v_mfma_f32_16x16x32_bf16 v[244:247], a[252:255], a[68:71], v[244:247]
ds_read_b32 a102, v57
v_perm_b32 v56, v84, v19, s55
v_mfma_f32_16x16x32_bf16 v[248:251], a[252:255], a[72:75], v[248:251]
ds_read_b32 a103, v56
v_perm_b32 v63, v81, v19, s52
v_mfma_f32_16x16x32_bf16 v[252:255], a[252:255], a[76:79], v[252:255]
s_waitcnt lgkmcnt(4)
ds_read_b32 a104, v63
v_mfma_f32_16x16x32_bf16 v[128:131], a[224:227], a[80:83], v[128:131]
ds_read_b128 a[232:235], v15 offset:40960
v_perm_b32 v62, v81, v19, s53
v_mfma_f32_16x16x32_bf16 v[132:135], a[224:227], a[84:87], v[132:135]
ds_read_b32 a105, v62
v_perm_b32 v61, v85, v19, s52
v_mfma_f32_16x16x32_bf16 v[136:139], a[224:227], a[88:91], v[136:139]
ds_read_b32 a106, v61
v_perm_b32 v60, v85, v19, s53
v_mfma_f32_16x16x32_bf16 v[140:143], a[224:227], a[92:95], v[140:143]
s_waitcnt lgkmcnt(4)
ds_read_b32 a107, v60
buffer_load_dwordx4 v[40:43], v12, s[24:27], 0 offen offset:2048 sc1
v_mfma_f32_16x16x32_bf16 v[160:163], a[228:231], a[80:83], v[160:163]
ds_read_b128 a[236:239], v15 offset:45056
v_perm_b32 v59, v81, v19, s54
v_mfma_f32_16x16x32_bf16 v[164:167], a[228:231], a[84:87], v[164:167]
s_waitcnt vmcnt(9)
ds_read_b32 a108, v59
v_perm_b32 v58, v81, v19, s55
v_lshl_add_u64 v[104:105], v[108:109], 4, v[104:105]
v_lshl_add_u64 v[106:107], v[110:111], 4, v[106:107]
v_lshl_add_u64 v[112:113], v[116:117], 4, v[112:113]
v_lshl_add_u64 v[114:115], v[118:119], 4, v[114:115]
v_lshl_or_b32 v116, v112, 8, v104
v_lshl_or_b32 v117, v113, 8, v105
v_lshl_or_b32 v118, v114, 8, v106
v_lshl_or_b32 v119, v115, 8, v107
v_lshl_or_b32 v108, v117, 16, v116
v_lshl_or_b32 v109, v119, 16, v118
v_mov_b64 v[110:111], s[88:89]
v_mfma_f32_16x16x32_bf16 v[168:171], a[228:231], a[88:91], v[168:171]
s_add_u32 m0, s33, 150912
ds_read_b32 a109, v58
v_perm_b32 v57, v85, v19, s54
v_mfma_f32_16x16x32_bf16 v[172:175], a[228:231], a[92:95], v[172:175]
s_waitcnt lgkmcnt(4)
ds_read_b32 a110, v57
buffer_load_dwordx4 v[44:47], v12, s[24:27], 0 offen offset:3072 sc1
v_mfma_f32_16x16x32_bf16 v[192:195], a[232:235], a[80:83], v[192:195]
ds_read_b128 a[240:243], v15 offset:34816
buffer_load_dwordx4 v9, s[20:23], 0 offen offset:640 lds
v_mfma_f32_16x16x32_bf16 v[196:199], a[232:235], a[84:87], v[196:199]
buffer_store_dwordx4 v[108:111], v13, s[76:79], 0 offen sc1
v_mfma_f32_16x16x32_bf16 v[200:203], a[232:235], a[88:91], v[200:203]
ds_read_b128 a[244:247], v14 offset:51200
v_perm_b32 v56, v85, v19, s55
v_mfma_f32_16x16x32_bf16 v[204:207], a[232:235], a[92:95], v[204:207]
s_waitcnt lgkmcnt(3)
ds_read_b32 a111, v56
v_add_u32 v12, 20480, v13
v_mfma_f32_16x16x32_bf16 v[224:227], a[236:239], a[80:83], v[224:227]
s_waitcnt vmcnt(10)
v_cmp_ne_u64 s[50:51], s[88:89], v[90:91]
v_cmp_ne_u64 s[44:45], s[88:89], v[94:95]
v_mfma_f32_16x16x32_bf16 v[228:231], a[236:239], a[84:87], v[228:231]
v_mfma_f32_16x16x32_bf16 v[232:235], a[236:239], a[88:91], v[232:235]
s_or_b64 s[50:51], s[44:45], s[50:51]
v_mfma_f32_16x16x32_bf16 v[236:239], a[236:239], a[92:95], v[236:239]
s_waitcnt lgkmcnt(1)
v_mfma_f32_16x16x32_bf16 v[144:147], a[240:243], a[80:83], v[144:147]
s_barrier
ds_read_b128 a[248:251], v15 offset:38912
v_mfma_f32_16x16x32_bf16 v[144:147], a[244:247], a[96:99], v[144:147]
s_cbranch_scc1 L_SLOW7
L_BACK7:
v_mfma_f32_16x16x32_bf16 v[148:151], a[244:247], a[100:103], v[148:151]
ds_read_b128 a[252:255], v14 offset:55296
v_mfma_f32_16x16x32_bf16 v[148:151], a[240:243], a[84:87], v[148:151]
s_add_u32 m0, s33, 155008
v_mfma_f32_16x16x32_bf16 v[152:155], a[240:243], a[88:91], v[152:155]
buffer_load_dwordx4 v10, s[20:23], 0 offen offset:640 lds
v_mfma_f32_16x16x32_bf16 v[152:155], a[244:247], a[104:107], v[152:155]
s_waitcnt lgkmcnt(1)
v_perm_b32 v63, v88, v19, s52
v_mfma_f32_16x16x32_bf16 v[156:159], a[244:247], a[108:111], v[156:159]
ds_read_b32 a112, v63
v_perm_b32 v62, v88, v19, s53
v_mfma_f32_16x16x32_bf16 v[156:159], a[240:243], a[92:95], v[156:159]
s_waitcnt lgkmcnt(1)
ds_read_b32 a113, v62
v_mfma_f32_16x16x32_bf16 v[176:179], a[248:251], a[80:83], v[176:179]
ds_read_b128 a[224:227], v15 offset:43008
v_perm_b32 v61, v92, v19, s52
v_mfma_f32_16x16x32_bf16 v[176:179], a[252:255], a[96:99], v[176:179]
ds_read_b32 a114, v61
v_mfma_f32_16x16x32_bf16 v[180:183], a[252:255], a[100:103], v[180:183]
ds_read_b128 a[228:231], v14 offset:59392
v_perm_b32 v60, v92, v19, s53
v_mfma_f32_16x16x32_bf16 v[180:183], a[248:251], a[84:87], v[180:183]
ds_read_b32 a115, v60
v_perm_b32 v59, v88, v19, s54
v_mfma_f32_16x16x32_bf16 v[184:187], a[248:251], a[88:91], v[184:187]
ds_read_b32 a116, v59
v_perm_b32 v58, v88, v19, s55
v_mfma_f32_16x16x32_bf16 v[184:187], a[252:255], a[104:107], v[184:187]
ds_read_b32 a117, v58
v_perm_b32 v57, v92, v19, s54
v_mfma_f32_16x16x32_bf16 v[188:191], a[252:255], a[108:111], v[188:191]
s_add_u32 m0, s33, 159104
ds_read_b32 a118, v57
v_perm_b32 v56, v92, v19, s55
v_mfma_f32_16x16x32_bf16 v[188:191], a[248:251], a[92:95], v[188:191]
s_waitcnt lgkmcnt(4)
ds_read_b32 a119, v56
v_perm_b32 v63, v89, v19, s52
v_mfma_f32_16x16x32_bf16 v[208:211], a[224:227], a[80:83], v[208:211]
ds_read_b128 a[232:235], v15 offset:47104
buffer_load_dwordx4 v11, s[20:23], 0 offen offset:640 lds
v_mfma_f32_16x16x32_bf16 v[208:211], a[228:231], a[96:99], v[208:211]
ds_read_b32 a120, v63
v_mfma_f32_16x16x32_bf16 v[212:215], a[228:231], a[100:103], v[212:215]
ds_read_b128 a[236:239], v14 offset:63488
v_perm_b32 v62, v89, v19, s53
v_mfma_f32_16x16x32_bf16 v[212:215], a[224:227], a[84:87], v[212:215]
ds_read_b32 a121, v62
v_perm_b32 v61, v93, v19, s52
v_mfma_f32_16x16x32_bf16 v[216:219], a[224:227], a[88:91], v[216:219]
ds_read_b32 a122, v61
v_perm_b32 v60, v93, v19, s53
v_mfma_f32_16x16x32_bf16 v[216:219], a[228:231], a[104:107], v[216:219]
ds_read_b32 a123, v60
v_perm_b32 v59, v89, v19, s54
v_mfma_f32_16x16x32_bf16 v[220:223], a[228:231], a[108:111], v[220:223]
ds_read_b32 a124, v59
v_perm_b32 v58, v89, v19, s55
v_mfma_f32_16x16x32_bf16 v[220:223], a[224:227], a[92:95], v[220:223]
s_waitcnt lgkmcnt(4)
ds_read_b32 a125, v58
buffer_load_dwordx4 v[48:51], v12, s[24:27], 0 offen offset:0 sc1
v_mfma_f32_16x16x32_bf16 v[240:243], a[232:235], a[80:83], v[240:243]
ds_read_b128 a[240:243], v14 offset:49152
v_perm_b32 v57, v93, v19, s54
v_mfma_f32_16x16x32_bf16 v[240:243], a[236:239], a[96:99], v[240:243]
ds_read_b32 a126, v57
buffer_load_dwordx4 v[52:55], v12, s[24:27], 0 offen offset:1024 sc1
v_mfma_f32_16x16x32_bf16 v[244:247], a[236:239], a[100:103], v[244:247]
ds_read_b128 a[244:247], v15 offset:49152
v_perm_b32 v56, v93, v19, s55
v_mfma_f32_16x16x32_bf16 v[244:247], a[232:235], a[84:87], v[244:247]
s_add_u32 m0, s33, 64768
ds_read_b32 a127, v56
v_mfma_f32_16x16x32_bf16 v[248:251], a[232:235], a[88:91], v[248:251]
buffer_load_dwordx4 v8, s[20:23], 0 offen offset:768 lds
v_mfma_f32_16x16x32_bf16 v[248:251], a[236:239], a[104:107], v[248:251]
v_mfma_f32_16x16x32_bf16 v[252:255], a[236:239], a[108:111], v[252:255]
v_mfma_f32_16x16x32_bf16 v[252:255], a[232:235], a[92:95], v[252:255]
s_waitcnt vmcnt(10) lgkmcnt(1)
v_cmp_ne_u64 s[50:51], s[88:89], v[34:35]
v_mfma_f32_16x16x32_bf16 v[128:131], a[240:243], a[96:99], v[128:131]
ds_read_b128 a[248:251], v14 offset:53248
v_cmp_ne_u64 s[44:45], s[88:89], v[38:39]
v_mfma_f32_16x16x32_bf16 v[128:131], a[244:247], a[112:115], v[128:131]
v_mfma_f32_16x16x32_bf16 v[132:135], a[244:247], a[116:119], v[132:135]
s_or_b64 s[50:51], s[44:45], s[50:51]
ds_read_b128 a[252:255], v15 offset:53248
v_mfma_f32_16x16x32_bf16 v[132:135], a[240:243], a[100:103], v[132:135]
s_cbranch_scc1 L_SLOW8
L_BACK8:
v_mfma_f32_16x16x32_bf16 v[136:139], a[240:243], a[104:107], v[136:139]
v_perm_b32 v63, v32, v19, s52
v_mfma_f32_16x16x32_bf16 v[136:139], a[244:247], a[120:123], v[136:139]
s_waitcnt lgkmcnt(1)
ds_read_b32 a128, v63
v_perm_b32 v62, v32, v19, s53
v_mfma_f32_16x16x32_bf16 v[140:143], a[244:247], a[124:127], v[140:143]
s_add_u32 m0, s33, 68864
ds_read_b32 a129, v62
v_perm_b32 v61, v36, v19, s52
v_mfma_f32_16x16x32_bf16 v[140:143], a[240:243], a[108:111], v[140:143]
s_waitcnt lgkmcnt(2)
ds_read_b32 a130, v61
v_perm_b32 v60, v36, v19, s53
v_mfma_f32_16x16x32_bf16 v[160:163], a[248:251], a[96:99], v[160:163]
ds_read_b128 a[224:227], v14 offset:57344
buffer_load_dwordx4 v9, s[20:23], 0 offen offset:768 lds
v_mfma_f32_16x16x32_bf16 v[160:163], a[252:255], a[112:115], v[160:163]
ds_read_b32 a131, v60
v_mfma_f32_16x16x32_bf16 v[164:167], a[252:255], a[116:119], v[164:167]
ds_read_b128 a[228:231], v15 offset:57344
v_perm_b32 v59, v32, v19, s54
v_mfma_f32_16x16x32_bf16 v[164:167], a[248:251], a[100:103], v[164:167]
ds_read_b32 a132, v59
v_perm_b32 v58, v32, v19, s55
v_mfma_f32_16x16x32_bf16 v[168:171], a[248:251], a[104:107], v[168:171]
ds_read_b32 a133, v58
v_perm_b32 v57, v36, v19, s54
v_mfma_f32_16x16x32_bf16 v[168:171], a[252:255], a[120:123], v[168:171]
ds_read_b32 a134, v57
v_perm_b32 v56, v36, v19, s55
v_mfma_f32_16x16x32_bf16 v[172:175], a[252:255], a[124:127], v[172:175]
ds_read_b32 a135, v56
v_perm_b32 v63, v33, v19, s52
v_mfma_f32_16x16x32_bf16 v[172:175], a[248:251], a[108:111], v[172:175]
s_waitcnt lgkmcnt(4)
ds_read_b32 a136, v63
v_mfma_f32_16x16x32_bf16 v[192:195], a[224:227], a[96:99], v[192:195]
ds_read_b128 a[232:235], v14 offset:61440
v_perm_b32 v62, v33, v19, s53
v_mfma_f32_16x16x32_bf16 v[192:195], a[228:231], a[112:115], v[192:195]
ds_read_b32 a137, v62
v_mfma_f32_16x16x32_bf16 v[196:199], a[228:231], a[116:119], v[196:199]
ds_read_b128 a[236:239], v15 offset:61440
v_perm_b32 v61, v37, v19, s52
v_mfma_f32_16x16x32_bf16 v[196:199], a[224:227], a[100:103], v[196:199]
s_add_u32 m0, s33, 72960
ds_read_b32 a138, v61
buffer_load_dwordx4 v[96:99], v12, s[24:27], 0 offen offset:2048 sc1
v_mfma_f32_16x16x32_bf16 v[200:203], a[224:227], a[104:107], v[200:203]
buffer_load_dwordx4 v10, s[20:23], 0 offen offset:768 lds
v_perm_b32 v60, v37, v19, s53
v_mfma_f32_16x16x32_bf16 v[200:203], a[228:231], a[120:123], v[200:203]
ds_read_b32 a139, v60
v_perm_b32 v59, v33, v19, s54
v_mfma_f32_16x16x32_bf16 v[204:207], a[228:231], a[124:127], v[204:207]
ds_read_b32 a140, v59
v_perm_b32 v58, v33, v19, s55
v_mfma_f32_16x16x32_bf16 v[204:207], a[224:227], a[108:111], v[204:207]
s_waitcnt lgkmcnt(3)
ds_read_b32 a141, v58
buffer_load_dwordx4 v[100:103], v12, s[24:27], 0 offen offset:3072 sc1
v_mfma_f32_16x16x32_bf16 v[224:227], a[232:235], a[96:99], v[224:227]
ds_read_b128 a[240:243], v15 offset:51200
v_perm_b32 v57, v37, v19, s54
v_mfma_f32_16x16x32_bf16 v[224:227], a[236:239], a[112:115], v[224:227]
ds_read_b32 a142, v57
v_add_u32 v12, 24576, v13
v_mfma_f32_16x16x32_bf16 v[228:231], a[236:239], a[116:119], v[228:231]
ds_read_b128 a[244:247], v16 offset:2048
v_perm_b32 v56, v37, v19, s55
v_mfma_f32_16x16x32_bf16 v[228:231], a[232:235], a[100:103], v[228:231]
s_add_u32 m0, s33, 77056
ds_read_b32 a143, v56
v_mfma_f32_16x16x32_bf16 v[232:235], a[232:235], a[104:107], v[232:235]
buffer_load_dwordx4 v11, s[20:23], 0 offen offset:768 lds
v_mfma_f32_16x16x32_bf16 v[232:235], a[236:239], a[120:123], v[232:235]
v_mfma_f32_16x16x32_bf16 v[236:239], a[236:239], a[124:127], v[236:239]
v_mfma_f32_16x16x32_bf16 v[236:239], a[232:235], a[108:111], v[236:239]
s_waitcnt vmcnt(12) lgkmcnt(1)
v_cmp_ne_u64 s[50:51], s[88:89], v[42:43]
v_mfma_f32_16x16x32_bf16 v[144:147], a[240:243], a[112:115], v[144:147]
s_barrier
ds_read_b128 a[248:251], v15 offset:55296
v_cmp_ne_u64 s[44:45], s[88:89], v[46:47]
v_mfma_f32_16x16x32_bf16 v[144:147], a[244:247], a[128:131], v[144:147]
v_mfma_f32_16x16x32_bf16 v[148:151], a[244:247], a[132:135], v[148:151]
s_or_b64 s[50:51], s[44:45], s[50:51]
ds_read_b128 a[252:255], v16 offset:6144
v_mfma_f32_16x16x32_bf16 v[148:151], a[240:243], a[116:119], v[148:151]
s_cbranch_scc1 L_SLOW9
L_BACK9:
v_mfma_f32_16x16x32_bf16 v[152:155], a[240:243], a[120:123], v[152:155]
v_perm_b32 v63, v40, v19, s52
v_mfma_f32_16x16x32_bf16 v[152:155], a[244:247], a[136:139], v[152:155]
s_waitcnt lgkmcnt(1)
ds_read_b32 a144, v63
v_perm_b32 v62, v40, v19, s53
v_mfma_f32_16x16x32_bf16 v[156:159], a[244:247], a[140:143], v[156:159]
ds_read_b32 a145, v62
v_perm_b32 v61, v44, v19, s52
v_mfma_f32_16x16x32_bf16 v[156:159], a[240:243], a[124:127], v[156:159]
s_waitcnt lgkmcnt(2)
ds_read_b32 a146, v61
v_mfma_f32_16x16x32_bf16 v[176:179], a[248:251], a[112:115], v[176:179]
ds_read_b128 a[224:227], v15 offset:59392
v_perm_b32 v60, v44, v19, s53
v_mfma_f32_16x16x32_bf16 v[176:179], a[252:255], a[128:131], v[176:179]
ds_read_b32 a147, v60
v_mfma_f32_16x16x32_bf16 v[180:183], a[252:255], a[132:135], v[180:183]
ds_read_b128 a[228:231], v16 offset:10240
v_perm_b32 v59, v40, v19, s54
v_mfma_f32_16x16x32_bf16 v[180:183], a[248:251], a[116:119], v[180:183]
s_add_u32 m0, s33, 81024
ds_read_b32 a148, v59
v_mfma_f32_16x16x32_bf16 v[184:187], a[248:251], a[120:123], v[184:187]
buffer_load_dwordx4 v8, s[20:23], 0 offen offset:896 lds
v_perm_b32 v58, v40, v19, s55
v_mfma_f32_16x16x32_bf16 v[184:187], a[252:255], a[136:139], v[184:187]
ds_read_b32 a149, v58
v_perm_b32 v57, v44, v19, s54
v_mfma_f32_16x16x32_bf16 v[188:191], a[252:255], a[140:143], v[188:191]
ds_read_b32 a150, v57
v_perm_b32 v56, v44, v19, s55
v_mfma_f32_16x16x32_bf16 v[188:191], a[248:251], a[124:127], v[188:191]
s_waitcnt lgkmcnt(3)
ds_read_b32 a151, v56
v_mfma_f32_16x16x32_bf16 v[208:211], a[224:227], a[112:115], v[208:211]
ds_read_b128 a[232:235], v15 offset:63488
v_perm_b32 v63, v41, v19, s52
v_mfma_f32_16x16x32_bf16 v[208:211], a[228:231], a[128:131], v[208:211]
ds_read_b32 a152, v63
v_mfma_f32_16x16x32_bf16 v[212:215], a[228:231], a[132:135], v[212:215]
ds_read_b128 a[236:239], v16 offset:14336
v_perm_b32 v62, v41, v19, s53
v_mfma_f32_16x16x32_bf16 v[212:215], a[224:227], a[116:119], v[212:215]
ds_read_b32 a153, v62
v_perm_b32 v61, v45, v19, s52
v_mfma_f32_16x16x32_bf16 v[216:219], a[224:227], a[120:123], v[216:219]
ds_read_b32 a154, v61
v_perm_b32 v60, v45, v19, s53
v_mfma_f32_16x16x32_bf16 v[216:219], a[228:231], a[136:139], v[216:219]
ds_read_b32 a155, v60
v_perm_b32 v59, v41, v19, s54
v_mfma_f32_16x16x32_bf16 v[220:223], a[228:231], a[140:143], v[220:223]
s_add_u32 m0, s33, 85120
ds_read_b32 a156, v59
v_perm_b32 v58, v41, v19, s55
v_mfma_f32_16x16x32_bf16 v[220:223], a[224:227], a[124:127], v[220:223]
s_waitcnt lgkmcnt(4)
ds_read_b32 a157, v58
v_perm_b32 v57, v45, v19, s54
v_mfma_f32_16x16x32_bf16 v[240:243], a[232:235], a[112:115], v[240:243]
ds_read_b128 a[240:243], v16 offset:0
buffer_load_dwordx4 v9, s[20:23], 0 offen offset:896 lds
v_mfma_f32_16x16x32_bf16 v[240:243], a[236:239], a[128:131], v[240:243]
ds_read_b32 a158, v57
buffer_load_dwordx4 v[80:83], v12, s[24:27], 0 offen offset:0 sc1
v_mfma_f32_16x16x32_bf16 v[244:247], a[236:239], a[132:135], v[244:247]
ds_read_b128 a[244:247], v17 offset:0
v_perm_b32 v56, v45, v19, s55
v_mfma_f32_16x16x32_bf16 v[244:247], a[232:235], a[116:119], v[244:247]
ds_read_b32 a159, v56
buffer_load_dwordx4 v[84:87], v12, s[24:27], 0 offen offset:1024 sc1
v_mfma_f32_16x16x32_bf16 v[248:251], a[232:235], a[120:123], v[248:251]
v_mfma_f32_16x16x32_bf16 v[248:251], a[236:239], a[136:139], v[248:251]
v_mfma_f32_16x16x32_bf16 v[252:255], a[236:239], a[140:143], v[252:255]
s_waitcnt vmcnt(10)
v_cmp_ne_u64 s[50:51], s[88:89], v[50:51]
v_cmp_ne_u64 s[44:45], s[88:89], v[54:55]
v_mfma_f32_16x16x32_bf16 v[252:255], a[232:235], a[124:127], v[252:255]
s_waitcnt lgkmcnt(1)
v_mfma_f32_16x16x32_bf16 v[128:131], a[240:243], a[128:131], v[128:131]
s_or_b64 s[50:51], s[44:45], s[50:51]
ds_read_b128 a[248:251], v16 offset:4096
v_mfma_f32_16x16x32_bf16 v[128:131], a[244:247], a[144:147], v[128:131]
s_cbranch_scc1 L_SLOW10
L_BACK10:
v_mfma_f32_16x16x32_bf16 v[132:135], a[244:247], a[148:151], v[132:135]
ds_read_b128 a[252:255], v17 offset:4096
v_mfma_f32_16x16x32_bf16 v[132:135], a[240:243], a[132:135], v[132:135]
s_add_u32 m0, s33, 89216
v_mfma_f32_16x16x32_bf16 v[136:139], a[240:243], a[136:139], v[136:139]
buffer_load_dwordx4 v10, s[20:23], 0 offen offset:896 lds
v_mfma_f32_16x16x32_bf16 v[136:139], a[244:247], a[152:155], v[136:139]
s_waitcnt lgkmcnt(1)
v_perm_b32 v63, v48, v19, s52
v_mfma_f32_16x16x32_bf16 v[140:143], a[244:247], a[156:159], v[140:143]
ds_read_b32 a160, v63
v_perm_b32 v62, v48, v19, s53
v_mfma_f32_16x16x32_bf16 v[140:143], a[240:243], a[140:143], v[140:143]
s_waitcnt lgkmcnt(1)
ds_read_b32 a161, v62
v_mfma_f32_16x16x32_bf16 v[160:163], a[248:251], a[128:131], v[160:163]
ds_read_b128 a[224:227], v16 offset:8192
v_perm_b32 v61, v52, v19, s52
v_mfma_f32_16x16x32_bf16 v[160:163], a[252:255], a[144:147], v[160:163]
ds_read_b32 a162, v61
v_mfma_f32_16x16x32_bf16 v[164:167], a[252:255], a[148:151], v[164:167]
ds_read_b128 a[228:231], v17 offset:8192
v_perm_b32 v60, v52, v19, s53
v_mfma_f32_16x16x32_bf16 v[164:167], a[248:251], a[132:135], v[164:167]
ds_read_b32 a163, v60
v_perm_b32 v59, v48, v19, s54
v_mfma_f32_16x16x32_bf16 v[168:171], a[248:251], a[136:139], v[168:171]
ds_read_b32 a164, v59
v_perm_b32 v58, v48, v19, s55
v_mfma_f32_16x16x32_bf16 v[168:171], a[252:255], a[152:155], v[168:171]
ds_read_b32 a165, v58
v_perm_b32 v57, v52, v19, s54
v_mfma_f32_16x16x32_bf16 v[172:175], a[252:255], a[156:159], v[172:175]
ds_read_b32 a166, v57
v_perm_b32 v56, v52, v19, s55
v_mfma_f32_16x16x32_bf16 v[172:175], a[248:251], a[140:143], v[172:175]
s_waitcnt lgkmcnt(4)
ds_read_b32 a167, v56
v_mfma_f32_16x16x32_bf16 v[192:195], a[224:227], a[128:131], v[192:195]
ds_read_b128 a[232:235], v16 offset:12288
v_perm_b32 v63, v49, v19, s52
v_mfma_f32_16x16x32_bf16 v[192:195], a[228:231], a[144:147], v[192:195]
ds_read_b32 a168, v63
buffer_load_dwordx4 v[88:91], v12, s[24:27], 0 offen offset:2048 sc1
v_mfma_f32_16x16x32_bf16 v[196:199], a[228:231], a[148:151], v[196:199]
ds_read_b128 a[236:239], v17 offset:12288
v_perm_b32 v62, v49, v19, s53
v_mfma_f32_16x16x32_bf16 v[196:199], a[224:227], a[132:135], v[196:199]
ds_read_b32 a169, v62
v_perm_b32 v61, v53, v19, s52
v_mfma_f32_16x16x32_bf16 v[200:203], a[224:227], a[136:139], v[200:203]
ds_read_b32 a170, v61
v_perm_b32 v60, v53, v19, s53
v_mfma_f32_16x16x32_bf16 v[200:203], a[228:231], a[152:155], v[200:203]
ds_read_b32 a171, v60
v_perm_b32 v59, v49, v19, s54
v_mfma_f32_16x16x32_bf16 v[204:207], a[228:231], a[156:159], v[204:207]
ds_read_b32 a172, v59
v_perm_b32 v58, v49, v19, s55
v_mfma_f32_16x16x32_bf16 v[204:207], a[224:227], a[140:143], v[204:207]
s_waitcnt lgkmcnt(4)
ds_read_b32 a173, v58
buffer_load_dwordx4 v[92:95], v12, s[24:27], 0 offen offset:3072 sc1
v_mfma_f32_16x16x32_bf16 v[224:227], a[232:235], a[128:131], v[224:227]
ds_read_b128 a[240:243], v17 offset:2048
v_perm_b32 v57, v53, v19, s54
v_mfma_f32_16x16x32_bf16 v[224:227], a[236:239], a[144:147], v[224:227]
ds_read_b32 a174, v57
v_add_u32 v12, 28672, v13
v_mfma_f32_16x16x32_bf16 v[228:231], a[236:239], a[148:151], v[228:231]
ds_read_b128 a[244:247], v16 offset:18432
v_perm_b32 v56, v53, v19, s55
v_mfma_f32_16x16x32_bf16 v[228:231], a[232:235], a[132:135], v[228:231]
ds_read_b32 a175, v56
v_mfma_f32_16x16x32_bf16 v[232:235], a[232:235], a[136:139], v[232:235]
v_mfma_f32_16x16x32_bf16 v[232:235], a[236:239], a[152:155], v[232:235]
v_mfma_f32_16x16x32_bf16 v[236:239], a[236:239], a[156:159], v[236:239]
v_mfma_f32_16x16x32_bf16 v[236:239], a[232:235], a[140:143], v[236:239]
s_waitcnt vmcnt(8) lgkmcnt(1)
v_cmp_ne_u64 s[50:51], s[88:89], v[98:99]
v_mfma_f32_16x16x32_bf16 v[144:147], a[240:243], a[144:147], v[144:147]
s_barrier
ds_read_b128 a[248:251], v17 offset:6144
v_cmp_ne_u64 s[44:45], s[88:89], v[102:103]
v_mfma_f32_16x16x32_bf16 v[144:147], a[244:247], a[160:163], v[144:147]
v_mfma_f32_16x16x32_bf16 v[148:151], a[244:247], a[164:167], v[148:151]
s_or_b64 s[50:51], s[44:45], s[50:51]
ds_read_b128 a[252:255], v16 offset:22528
v_mfma_f32_16x16x32_bf16 v[148:151], a[240:243], a[148:151], v[148:151]
s_cbranch_scc1 L_SLOW11
L_BACK11:
v_mfma_f32_16x16x32_bf16 v[152:155], a[240:243], a[152:155], v[152:155]
v_perm_b32 v63, v96, v19, s52
v_mfma_f32_16x16x32_bf16 v[152:155], a[244:247], a[168:171], v[152:155]
s_waitcnt lgkmcnt(1)
ds_read_b32 a176, v63
v_perm_b32 v62, v96, v19, s53
v_mfma_f32_16x16x32_bf16 v[156:159], a[244:247], a[172:175], v[156:159]
s_add_u32 m0, s33, 93184
ds_read_b32 a177, v62
v_perm_b32 v61, v100, v19, s52
v_mfma_f32_16x16x32_bf16 v[156:159], a[240:243], a[156:159], v[156:159]
s_waitcnt lgkmcnt(2)
ds_read_b32 a178, v61
v_perm_b32 v60, v100, v19, s53
v_mfma_f32_16x16x32_bf16 v[176:179], a[248:251], a[144:147], v[176:179]
ds_read_b128 a[224:227], v17 offset:10240
buffer_load_dwordx4 v8, s[20:23], 0 offen offset:1024 lds
v_mfma_f32_16x16x32_bf16 v[176:179], a[252:255], a[160:163], v[176:179]
ds_read_b32 a179, v60
v_mfma_f32_16x16x32_bf16 v[180:183], a[252:255], a[164:167], v[180:183]
ds_read_b128 a[228:231], v16 offset:26624
v_perm_b32 v59, v96, v19, s54
v_mfma_f32_16x16x32_bf16 v[180:183], a[248:251], a[148:151], v[180:183]
ds_read_b32 a180, v59
v_perm_b32 v58, v96, v19, s55
v_mfma_f32_16x16x32_bf16 v[184:187], a[248:251], a[152:155], v[184:187]
ds_read_b32 a181, v58
v_perm_b32 v57, v100, v19, s54
v_mfma_f32_16x16x32_bf16 v[184:187], a[252:255], a[168:171], v[184:187]
ds_read_b32 a182, v57
v_perm_b32 v56, v100, v19, s55
v_mfma_f32_16x16x32_bf16 v[188:191], a[252:255], a[172:175], v[188:191]
ds_read_b32 a183, v56
v_perm_b32 v63, v97, v19, s52
v_mfma_f32_16x16x32_bf16 v[188:191], a[248:251], a[156:159], v[188:191]
s_waitcnt lgkmcnt(4)
ds_read_b32 a184, v63
buffer_load_dwordx4 v[32:35], v12, s[24:27], 0 offen offset:0 sc1
v_mfma_f32_16x16x32_bf16 v[208:211], a[224:227], a[144:147], v[208:211]
ds_read_b128 a[232:235], v17 offset:14336
v_perm_b32 v62, v97, v19, s53
v_mfma_f32_16x16x32_bf16 v[208:211], a[228:231], a[160:163], v[208:211]
ds_read_b32 a185, v62
buffer_load_dwordx4 v[36:39], v12, s[24:27], 0 offen offset:1024 sc1
v_mfma_f32_16x16x32_bf16 v[212:215], a[228:231], a[164:167], v[212:215]
ds_read_b128 a[236:239], v16 offset:30720
v_perm_b32 v61, v101, v19, s52
v_mfma_f32_16x16x32_bf16 v[212:215], a[224:227], a[148:151], v[212:215]
s_add_u32 m0, s33, 97280
ds_read_b32 a186, v61
v_mfma_f32_16x16x32_bf16 v[216:219], a[224:227], a[152:155], v[216:219]
buffer_load_dwordx4 v9, s[20:23], 0 offen offset:1024 lds
v_perm_b32 v60, v101, v19, s53
v_mfma_f32_16x16x32_bf16 v[216:219], a[228:231], a[168:171], v[216:219]
ds_read_b32 a187, v60
v_perm_b32 v59, v97, v19, s54
v_mfma_f32_16x16x32_bf16 v[220:223], a[228:231], a[172:175], v[220:223]
ds_read_b32 a188, v59
v_perm_b32 v58, v97, v19, s55
v_mfma_f32_16x16x32_bf16 v[220:223], a[224:227], a[156:159], v[220:223]
s_waitcnt lgkmcnt(3)
ds_read_b32 a189, v58
v_mfma_f32_16x16x32_bf16 v[240:243], a[232:235], a[144:147], v[240:243]
ds_read_b128 a[240:243], v16 offset:16384
v_perm_b32 v57, v101, v19, s54
v_mfma_f32_16x16x32_bf16 v[240:243], a[236:239], a[160:163], v[240:243]
ds_read_b32 a190, v57
v_mfma_f32_16x16x32_bf16 v[244:247], a[236:239], a[164:167], v[244:247]
ds_read_b128 a[244:247], v17 offset:16384
v_perm_b32 v56, v101, v19, s55
v_mfma_f32_16x16x32_bf16 v[244:247], a[232:235], a[148:151], v[244:247]
ds_read_b32 a191, v56
v_mfma_f32_16x16x32_bf16 v[248:251], a[232:235], a[152:155], v[248:251]
v_mfma_f32_16x16x32_bf16 v[248:251], a[236:239], a[168:171], v[248:251]
v_mfma_f32_16x16x32_bf16 v[252:255], a[236:239], a[172:175], v[252:255]
s_add_u32 m0, s33, 101504
v_mfma_f32_16x16x32_bf16 v[252:255], a[232:235], a[156:159], v[252:255]
s_waitcnt vmcnt(7) lgkmcnt(1)
v_cmp_ne_u64 s[50:51], s[88:89], v[82:83]
v_cmp_ne_u64 s[44:45], s[88:89], v[86:87]
v_mfma_f32_16x16x32_bf16 v[128:131], a[240:243], a[160:163], v[128:131]
L_PAD2:
s_cbranch_vccnz L_PADRET
ds_read_b128 a[248:251], v16 offset:20480
buffer_load_dwordx4 v11, s[20:23], 0 offen offset:896 lds
v_mfma_f32_16x16x32_bf16 v[128:131], a[244:247], a[176:179], v[128:131]
v_mfma_f32_16x16x32_bf16 v[132:135], a[244:247], a[180:183], v[132:135]
s_or_b64 s[50:51], s[44:45], s[50:51]
ds_read_b128 a[252:255], v17 offset:20480
v_mfma_f32_16x16x32_bf16 v[132:135], a[240:243], a[164:167], v[132:135]
s_cbranch_scc1 L_SLOW12
L_BACK12:
v_mfma_f32_16x16x32_bf16 v[136:139], a[240:243], a[168:171], v[136:139]
v_perm_b32 v63, v80, v19, s52
v_mfma_f32_16x16x32_bf16 v[136:139], a[244:247], a[184:187], v[136:139]
s_waitcnt lgkmcnt(1)
ds_read_b32 a192, v63
v_perm_b32 v62, v80, v19, s53
v_mfma_f32_16x16x32_bf16 v[140:143], a[244:247], a[188:191], v[140:143]
ds_read_b32 a193, v62
v_perm_b32 v61, v84, v19, s52
v_mfma_f32_16x16x32_bf16 v[140:143], a[240:243], a[172:175], v[140:143]
s_waitcnt lgkmcnt(2)
ds_read_b32 a194, v61
buffer_load_dwordx4 v[40:43], v12, s[24:27], 0 offen offset:2048 sc1
v_mfma_f32_16x16x32_bf16 v[160:163], a[248:251], a[160:163], v[160:163]
ds_read_b128 a[224:227], v16 offset:24576
v_perm_b32 v60, v84, v19, s53
v_mfma_f32_16x16x32_bf16 v[160:163], a[252:255], a[176:179], v[160:163]
ds_read_b32 a195, v60
buffer_load_dwordx4 v[44:47], v12, s[24:27], 0 offen offset:3072 sc1
v_mfma_f32_16x16x32_bf16 v[164:167], a[252:255], a[180:183], v[164:167]
ds_read_b128 a[228:231], v17 offset:24576
v_perm_b32 v59, v80, v19, s54
v_mfma_f32_16x16x32_bf16 v[164:167], a[248:251], a[164:167], v[164:167]
s_add_u32 m0, s33, 105472
ds_read_b32 a196, v59
v_add_u32 v12, 32768, v13
v_mfma_f32_16x16x32_bf16 v[168:171], a[248:251], a[168:171], v[168:171]
buffer_load_dwordx4 v10, s[20:23], 0 offen offset:1024 lds
v_perm_b32 v58, v80, v19, s55
v_mfma_f32_16x16x32_bf16 v[168:171], a[252:255], a[184:187], v[168:171]
ds_read_b32 a197, v58
v_perm_b32 v57, v84, v19, s54
v_mfma_f32_16x16x32_bf16 v[172:175], a[252:255], a[188:191], v[172:175]
ds_read_b32 a198, v57
v_perm_b32 v56, v84, v19, s55
v_mfma_f32_16x16x32_bf16 v[172:175], a[248:251], a[172:175], v[172:175]
s_waitcnt lgkmcnt(3)
ds_read_b32 a199, v56
v_mfma_f32_16x16x32_bf16 v[192:195], a[224:227], a[160:163], v[192:195]
ds_read_b128 a[232:235], v16 offset:28672
v_perm_b32 v63, v81, v19, s52
v_mfma_f32_16x16x32_bf16 v[192:195], a[228:231], a[176:179], v[192:195]
ds_read_b32 a200, v63
v_mfma_f32_16x16x32_bf16 v[196:199], a[228:231], a[180:183], v[196:199]
ds_read_b128 a[236:239], v17 offset:28672
v_perm_b32 v62, v81, v19, s53
v_mfma_f32_16x16x32_bf16 v[196:199], a[224:227], a[164:167], v[196:199]
ds_read_b32 a201, v62
v_perm_b32 v61, v85, v19, s52
v_mfma_f32_16x16x32_bf16 v[200:203], a[224:227], a[168:171], v[200:203]
ds_read_b32 a202, v61
v_perm_b32 v60, v85, v19, s53
v_mfma_f32_16x16x32_bf16 v[200:203], a[228:231], a[184:187], v[200:203]
ds_read_b32 a203, v60
v_perm_b32 v59, v81, v19, s54
v_mfma_f32_16x16x32_bf16 v[204:207], a[228:231], a[188:191], v[204:207]
s_add_u32 m0, s33, 109440
ds_read_b32 a204, v59
v_perm_b32 v58, v81, v19, s55
v_mfma_f32_16x16x32_bf16 v[204:207], a[224:227], a[172:175], v[204:207]
s_waitcnt lgkmcnt(4)
ds_read_b32 a205, v58
v_perm_b32 v57, v85, v19, s54
v_mfma_f32_16x16x32_bf16 v[224:227], a[232:235], a[160:163], v[224:227]
ds_read_b128 a[240:243], v17 offset:18432
buffer_load_dwordx4 v8, s[20:23], 0 offen offset:1152 lds
v_mfma_f32_16x16x32_bf16 v[224:227], a[236:239], a[176:179], v[224:227]
ds_read_b32 a206, v57
v_mfma_f32_16x16x32_bf16 v[228:231], a[236:239], a[180:183], v[228:231]
ds_read_b128 a[244:247], v14 offset:2048
v_perm_b32 v56, v85, v19, s55
v_mfma_f32_16x16x32_bf16 v[228:231], a[232:235], a[164:167], v[228:231]
ds_read_b32 a207, v56
v_mfma_f32_16x16x32_bf16 v[232:235], a[232:235], a[168:171], v[232:235]
s_waitcnt vmcnt(9)
v_cmp_ne_u64 s[50:51], s[88:89], v[90:91]
v_cmp_ne_u64 s[44:45], s[88:89], v[94:95]
v_mfma_f32_16x16x32_bf16 v[232:235], a[236:239], a[184:187], v[232:235]
v_mfma_f32_16x16x32_bf16 v[236:239], a[236:239], a[188:191], v[236:239]
s_or_b64 s[50:51], s[44:45], s[50:51]
v_mfma_f32_16x16x32_bf16 v[236:239], a[232:235], a[172:175], v[236:239]
s_waitcnt lgkmcnt(1)
v_mfma_f32_16x16x32_bf16 v[144:147], a[240:243], a[176:179], v[144:147]
s_barrier
ds_read_b128 a[248:251], v17 offset:22528
v_mfma_f32_16x16x32_bf16 v[144:147], a[244:247], a[192:195], v[144:147]
s_cbranch_scc1 L_SLOW13
L_BACK13:
v_mfma_f32_16x16x32_bf16 v[148:151], a[244:247], a[196:199], v[148:151]
ds_read_b128 a[252:255], v14 offset:6144
buffer_load_dwordx4 v[48:51], v12, s[24:27], 0 offen offset:0 sc1
v_mfma_f32_16x16x32_bf16 v[148:151], a[240:243], a[180:183], v[148:151]
s_add_u32 m0, s33, 113536
buffer_load_dwordx4 v[52:55], v12, s[24:27], 0 offen offset:1024 sc1
v_mfma_f32_16x16x32_bf16 v[152:155], a[240:243], a[184:187], v[152:155]
buffer_load_dwordx4 v9, s[20:23], 0 offen offset:1152 lds
v_perm_b32 v63, v88, v19, s52
v_mfma_f32_16x16x32_bf16 v[152:155], a[244:247], a[200:203], v[152:155]
s_waitcnt lgkmcnt(1)
ds_read_b32 a208, v63
v_perm_b32 v62, v88, v19, s53
v_mfma_f32_16x16x32_bf16 v[156:159], a[244:247], a[204:207], v[156:159]
ds_read_b32 a209, v62
v_perm_b32 v61, v92, v19, s52
v_mfma_f32_16x16x32_bf16 v[156:159], a[240:243], a[188:191], v[156:159]
s_waitcnt lgkmcnt(2)
ds_read_b32 a210, v61
v_mfma_f32_16x16x32_bf16 v[176:179], a[248:251], a[176:179], v[176:179]
ds_read_b128 a[224:227], v17 offset:26624
v_perm_b32 v60, v92, v19, s53
v_mfma_f32_16x16x32_bf16 v[176:179], a[252:255], a[192:195], v[176:179]
ds_read_b32 a211, v60
v_mfma_f32_16x16x32_bf16 v[180:183], a[252:255], a[196:199], v[180:183]
ds_read_b128 a[228:231], v14 offset:10240
v_perm_b32 v59, v88, v19, s54
v_mfma_f32_16x16x32_bf16 v[180:183], a[248:251], a[180:183], v[180:183]
ds_read_b32 a212, v59
v_perm_b32 v58, v88, v19, s55
v_mfma_f32_16x16x32_bf16 v[184:187], a[248:251], a[184:187], v[184:187]
ds_read_b32 a213, v58
v_perm_b32 v57, v92, v19, s54
v_mfma_f32_16x16x32_bf16 v[184:187], a[252:255], a[200:203], v[184:187]
ds_read_b32 a214, v57
v_perm_b32 v56, v92, v19, s55
v_mfma_f32_16x16x32_bf16 v[188:191], a[252:255], a[204:207], v[188:191]
ds_read_b32 a215, v56
v_perm_b32 v63, v89, v19, s52
v_mfma_f32_16x16x32_bf16 v[188:191], a[248:251], a[188:191], v[188:191]
s_waitcnt lgkmcnt(4)
ds_read_b32 a216, v63
v_mfma_f32_16x16x32_bf16 v[208:211], a[224:227], a[176:179], v[208:211]
ds_read_b128 a[232:235], v17 offset:30720
v_perm_b32 v62, v89, v19, s53
v_mfma_f32_16x16x32_bf16 v[208:211], a[228:231], a[192:195], v[208:211]
ds_read_b32 a217, v62
v_mfma_f32_16x16x32_bf16 v[212:215], a[228:231], a[196:199], v[212:215]
ds_read_b128 a[236:239], v14 offset:14336
v_perm_b32 v61, v93, v19, s52
v_mfma_f32_16x16x32_bf16 v[212:215], a[224:227], a[180:183], v[212:215]
ds_read_b32 a218, v61
v_perm_b32 v60, v93, v19, s53
v_mfma_f32_16x16x32_bf16 v[216:219], a[224:227], a[184:187], v[216:219]
ds_read_b32 a219, v60
v_perm_b32 v59, v89, v19, s54
v_mfma_f32_16x16x32_bf16 v[216:219], a[228:231], a[200:203], v[216:219]
ds_read_b32 a220, v59
v_perm_b32 v58, v89, v19, s55
v_mfma_f32_16x16x32_bf16 v[220:223], a[228:231], a[204:207], v[220:223]
ds_read_b32 a221, v58
v_perm_b32 v57, v93, v19, s54
v_mfma_f32_16x16x32_bf16 v[220:223], a[224:227], a[188:191], v[220:223]
s_waitcnt lgkmcnt(4)
ds_read_b32 a222, v57
v_mfma_f32_16x16x32_bf16 v[240:243], a[232:235], a[176:179], v[240:243]
ds_read_b128 a[240:243], v14 offset:0
v_mfma_f32_16x16x32_bf16 v[240:243], a[236:239], a[192:195], v[240:243]
s_waitcnt vmcnt(9)
v_perm_b32 v56, v93, v19, s55
v_cmp_ne_u64 s[50:51], s[88:89], v[34:35]
v_mfma_f32_16x16x32_bf16 v[244:247], a[236:239], a[196:199], v[244:247]
ds_read_b128 a[244:247], v15 offset:0
v_cmp_ne_u64 s[44:45], s[88:89], v[38:39]
v_mfma_f32_16x16x32_bf16 v[244:247], a[232:235], a[180:183], v[244:247]
s_add_u32 m0, s33, 117760
ds_read_b32 a223, v56
buffer_load_dwordx4 v[96:99], v12, s[24:27], 0 offen offset:2048 sc1
v_mfma_f32_16x16x32_bf16 v[248:251], a[232:235], a[184:187], v[248:251]
s_or_b64 s[50:51], s[44:45], s[50:51]
buffer_load_dwordx4 v11, s[20:23], 0 offen offset:1024 lds
v_mfma_f32_16x16x32_bf16 v[248:251], a[236:239], a[200:203], v[248:251]
s_cbranch_scc1 L_SLOW14
L_BACK14:
v_mfma_f32_16x16x32_bf16 v[252:255], a[236:239], a[204:207], v[252:255]
buffer_load_dwordx4 v[100:103], v12, s[24:27], 0 offen offset:3072 sc1
v_perm_b32 v63, v32, v19, s52
v_mfma_f32_16x16x32_bf16 v[252:255], a[232:235], a[188:191], v[252:255]
s_waitcnt lgkmcnt(1)
ds_read_b32 a0, v63
v_add_u32 v12, 36864, v13
v_mfma_f32_16x16x32_bf16 v[128:131], a[240:243], a[192:195], v[128:131]
ds_read_b128 a[248:251], v14 offset:4096
v_perm_b32 v62, v32, v19, s53
v_mfma_f32_16x16x32_bf16 v[128:131], a[244:247], a[208:211], v[128:131]
ds_read_b32 a1, v62
v_mfma_f32_16x16x32_bf16 v[132:135], a[244:247], a[212:215], v[132:135]
ds_read_b128 a[252:255], v15 offset:4096
v_perm_b32 v61, v36, v19, s52
v_mfma_f32_16x16x32_bf16 v[132:135], a[240:243], a[196:199], v[132:135]
ds_read_b32 a2, v61
v_perm_b32 v60, v36, v19, s53
v_mfma_f32_16x16x32_bf16 v[136:139], a[240:243], a[200:203], v[136:139]
ds_read_b32 a3, v60
v_perm_b32 v59, v32, v19, s54
v_mfma_f32_16x16x32_bf16 v[136:139], a[244:247], a[216:219], v[136:139]
s_waitcnt lgkmcnt(4)
ds_read_b32 a4, v59
v_perm_b32 v58, v32, v19, s55
v_mfma_f32_16x16x32_bf16 v[140:143], a[244:247], a[220:223], v[140:143]
s_add_u32 m0, s33, 121728
ds_read_b32 a5, v58
v_perm_b32 v57, v36, v19, s54
v_mfma_f32_16x16x32_bf16 v[140:143], a[240:243], a[204:207], v[140:143]
s_waitcnt lgkmcnt(4)
ds_read_b32 a6, v57
v_perm_b32 v56, v36, v19, s55
v_mfma_f32_16x16x32_bf16 v[160:163], a[248:251], a[192:195], v[160:163]
ds_read_b128 a[224:227], v14 offset:8192
buffer_load_dwordx4 v10, s[20:23], 0 offen offset:1152 lds
v_mfma_f32_16x16x32_bf16 v[160:163], a[252:255], a[208:211], v[160:163]
ds_read_b32 a7, v56
v_mfma_f32_16x16x32_bf16 v[164:167], a[252:255], a[212:215], v[164:167]
ds_read_b128 a[228:231], v15 offset:8192
v_perm_b32 v63, v33, v19, s52
v_mfma_f32_16x16x32_bf16 v[164:167], a[248:251], a[196:199], v[164:167]
ds_read_b32 a8, v63
v_perm_b32 v62, v33, v19, s53
v_mfma_f32_16x16x32_bf16 v[168:171], a[248:251], a[200:203], v[168:171]
ds_read_b32 a9, v62
v_perm_b32 v61, v37, v19, s52
v_mfma_f32_16x16x32_bf16 v[168:171], a[252:255], a[216:219], v[168:171]
ds_read_b32 a10, v61
v_perm_b32 v60, v37, v19, s53
v_mfma_f32_16x16x32_bf16 v[172:175], a[252:255], a[220:223], v[172:175]
ds_read_b32 a11, v60
v_perm_b32 v59, v33, v19, s54
v_mfma_f32_16x16x32_bf16 v[172:175], a[248:251], a[204:207], v[172:175]
s_waitcnt lgkmcnt(4)
ds_read_b32 a12, v59
v_mfma_f32_16x16x32_bf16 v[192:195], a[224:227], a[192:195], v[192:195]
ds_read_b128 a[232:235], v14 offset:12288
v_perm_b32 v58, v33, v19, s55
v_mfma_f32_16x16x32_bf16 v[192:195], a[228:231], a[208:211], v[192:195]
ds_read_b32 a13, v58
v_mfma_f32_16x16x32_bf16 v[196:199], a[228:231], a[212:215], v[196:199]
ds_read_b128 a[236:239], v15 offset:12288
v_mfma_f32_16x16x32_bf16 v[196:199], a[224:227], a[196:199], v[196:199]
s_waitcnt vmcnt(9)
s_add_u32 m0, s33, 125696
v_cmp_ne_u64 s[50:51], s[88:89], v[42:43]
v_cmp_ne_u64 s[44:45], s[88:89], v[46:47]
v_mfma_f32_16x16x32_bf16 v[200:203], a[224:227], a[200:203], v[200:203]
buffer_load_dwordx4 v8, s[20:23], 0 offen offset:1280 lds
v_perm_b32 v57, v37, v19, s54
v_mfma_f32_16x16x32_bf16 v[200:203], a[228:231], a[216:219], v[200:203]
s_or_b64 s[50:51], s[44:45], s[50:51]
ds_read_b32 a14, v57
v_perm_b32 v56, v37, v19, s55
v_mfma_f32_16x16x32_bf16 v[204:207], a[228:231], a[220:223], v[204:207]
s_cbranch_scc1 L_SLOW15
L_BACK15:
v_mfma_f32_16x16x32_bf16 v[204:207], a[224:227], a[204:207], v[204:207]
s_waitcnt lgkmcnt(1)
ds_read_b32 a15, v56
buffer_load_dwordx4 v[80:83], v12, s[24:27], 0 offen offset:0 sc1
v_mfma_f32_16x16x32_bf16 v[224:227], a[232:235], a[192:195], v[224:227]
ds_read_b128 a[240:243], v15 offset:2048
v_perm_b32 v63, v40, v19, s52
v_mfma_f32_16x16x32_bf16 v[224:227], a[236:239], a[208:211], v[224:227]
ds_read_b32 a16, v63
buffer_load_dwordx4 v[84:87], v12, s[24:27], 0 offen offset:1024 sc1
v_mfma_f32_16x16x32_bf16 v[228:231], a[236:239], a[212:215], v[228:231]
ds_read_b128 a[244:247], v14 offset:18432
v_perm_b32 v62, v40, v19, s53
v_mfma_f32_16x16x32_bf16 v[228:231], a[232:235], a[196:199], v[228:231]
ds_read_b32 a17, v62
v_perm_b32 v61, v44, v19, s52
v_mfma_f32_16x16x32_bf16 v[232:235], a[232:235], a[200:203], v[232:235]
ds_read_b32 a18, v61
v_perm_b32 v60, v44, v19, s53
v_mfma_f32_16x16x32_bf16 v[232:235], a[236:239], a[216:219], v[232:235]
ds_read_b32 a19, v60
v_perm_b32 v59, v40, v19, s54
v_mfma_f32_16x16x32_bf16 v[236:239], a[236:239], a[220:223], v[236:239]
s_add_u32 m0, s33, 129792
ds_read_b32 a20, v59
v_perm_b32 v58, v40, v19, s55
v_mfma_f32_16x16x32_bf16 v[236:239], a[232:235], a[204:207], v[236:239]
s_waitcnt lgkmcnt(4)
ds_read_b32 a21, v58
v_perm_b32 v57, v44, v19, s54
v_mfma_f32_16x16x32_bf16 v[144:147], a[240:243], a[208:211], v[144:147]
ds_read_b128 a[248:251], v15 offset:6144
buffer_load_dwordx4 v9, s[20:23], 0 offen offset:1280 lds
v_mfma_f32_16x16x32_bf16 v[144:147], a[244:247], a[0:3], v[144:147]
ds_read_b32 a22, v57
v_mfma_f32_16x16x32_bf16 v[148:151], a[244:247], a[4:7], v[148:151]
ds_read_b128 a[252:255], v14 offset:22528
v_perm_b32 v56, v44, v19, s55
v_mfma_f32_16x16x32_bf16 v[148:151], a[240:243], a[212:215], v[148:151]
ds_read_b32 a23, v56
v_perm_b32 v63, v41, v19, s52
v_mfma_f32_16x16x32_bf16 v[152:155], a[240:243], a[216:219], v[152:155]
ds_read_b32 a24, v63
v_perm_b32 v62, v41, v19, s53
v_mfma_f32_16x16x32_bf16 v[152:155], a[244:247], a[8:11], v[152:155]
ds_read_b32 a25, v62
v_perm_b32 v61, v45, v19, s52
v_mfma_f32_16x16x32_bf16 v[156:159], a[244:247], a[12:15], v[156:159]
ds_read_b32 a26, v61
v_perm_b32 v60, v45, v19, s53
v_mfma_f32_16x16x32_bf16 v[156:159], a[240:243], a[220:223], v[156:159]
s_waitcnt lgkmcnt(4)
ds_read_b32 a27, v60
v_mfma_f32_16x16x32_bf16 v[176:179], a[248:251], a[208:211], v[176:179]
ds_read_b128 a[224:227], v15 offset:10240
v_perm_b32 v59, v41, v19, s54
v_mfma_f32_16x16x32_bf16 v[176:179], a[252:255], a[0:3], v[176:179]
ds_read_b32 a28, v59
v_mfma_f32_16x16x32_bf16 v[180:183], a[252:255], a[4:7], v[180:183]
ds_read_b128 a[228:231], v14 offset:26624
v_perm_b32 v58, v41, v19, s55
v_mfma_f32_16x16x32_bf16 v[180:183], a[248:251], a[212:215], v[180:183]
s_add_u32 m0, s33, 133760
ds_read_b32 a29, v58
v_mfma_f32_16x16x32_bf16 v[184:187], a[248:251], a[216:219], v[184:187]
buffer_load_dwordx4 v8, s[20:23], 0 offen offset:1408 lds
v_perm_b32 v57, v45, v19, s54
v_mfma_f32_16x16x32_bf16 v[184:187], a[252:255], a[8:11], v[184:187]
ds_read_b32 a30, v57
v_perm_b32 v56, v45, v19, s55
v_mfma_f32_16x16x32_bf16 v[188:191], a[252:255], a[12:15], v[188:191]
s_waitcnt vmcnt(10)
v_cmp_ne_u64 s[50:51], s[88:89], v[50:51]
v_cmp_ne_u64 s[44:45], s[88:89], v[54:55]
v_mfma_f32_16x16x32_bf16 v[188:191], a[248:251], a[220:223], v[188:191]
s_waitcnt lgkmcnt(2)
ds_read_b32 a31, v56
buffer_load_dwordx4 v[88:91], v12, s[24:27], 0 offen offset:2048 sc1
v_mfma_f32_16x16x32_bf16 v[208:211], a[224:227], a[208:211], v[208:211]
s_or_b64 s[50:51], s[44:45], s[50:51]
ds_read_b128 a[232:235], v14 offset:16384
buffer_load_dwordx4 v[92:95], v12, s[24:27], 0 offen offset:3072 sc1
v_mfma_f32_16x16x32_bf16 v[208:211], a[228:231], a[0:3], v[208:211]
s_cbranch_scc1 L_SLOW16
L_BACK16:
v_mfma_f32_16x16x32_bf16 v[212:215], a[228:231], a[4:7], v[212:215]
ds_read_b128 a[236:239], v15 offset:16384
v_perm_b32 v63, v48, v19, s52
v_mfma_f32_16x16x32_bf16 v[212:215], a[224:227], a[212:215], v[212:215]
ds_read_b32 a32, v63
v_perm_b32 v62, v48, v19, s53
v_mfma_f32_16x16x32_bf16 v[216:219], a[224:227], a[216:219], v[216:219]
ds_read_b32 a33, v62
v_perm_b32 v61, v52, v19, s52
v_mfma_f32_16x16x32_bf16 v[216:219], a[228:231], a[8:11], v[216:219]
ds_read_b32 a34, v61
v_perm_b32 v60, v52, v19, s53
v_mfma_f32_16x16x32_bf16 v[220:223], a[228:231], a[12:15], v[220:223]
s_add_u32 m0, s33, 138112
ds_read_b32 a35, v60
v_perm_b32 v59, v48, v19, s54
v_mfma_f32_16x16x32_bf16 v[220:223], a[224:227], a[220:223], v[220:223]
s_waitcnt lgkmcnt(4)
ds_read_b32 a36, v59
v_perm_b32 v58, v48, v19, s55
v_mfma_f32_16x16x32_bf16 v[128:131], a[232:235], a[0:3], v[128:131]
ds_read_b128 a[240:243], v14 offset:20480
buffer_load_dwordx4 v11, s[20:23], 0 offen offset:1152 lds
v_mfma_f32_16x16x32_bf16 v[128:131], a[236:239], a[16:19], v[128:131]
ds_read_b32 a37, v58
v_add_u32 v12, 40960, v13
v_mfma_f32_16x16x32_bf16 v[132:135], a[236:239], a[20:23], v[132:135]
ds_read_b128 a[244:247], v15 offset:20480
v_perm_b32 v57, v52, v19, s54
v_mfma_f32_16x16x32_bf16 v[132:135], a[232:235], a[4:7], v[132:135]
ds_read_b32 a38, v57
v_perm_b32 v56, v52, v19, s55
v_mfma_f32_16x16x32_bf16 v[136:139], a[232:235], a[8:11], v[136:139]
ds_read_b32 a39, v56
v_perm_b32 v63, v49, v19, s52
v_mfma_f32_16x16x32_bf16 v[136:139], a[236:239], a[24:27], v[136:139]
ds_read_b32 a40, v63
v_perm_b32 v62, v49, v19, s53
v_mfma_f32_16x16x32_bf16 v[140:143], a[236:239], a[28:31], v[140:143]
ds_read_b32 a41, v62
v_perm_b32 v61, v53, v19, s52
v_mfma_f32_16x16x32_bf16 v[140:143], a[232:235], a[12:15], v[140:143]
s_waitcnt lgkmcnt(4)
ds_read_b32 a42, v61
v_mfma_f32_16x16x32_bf16 v[160:163], a[240:243], a[0:3], v[160:163]
s_waitcnt vmcnt(12)
s_barrier
ds_read_b128 a[248:251], v14 offset:24576
v_perm_b32 v60, v53, v19, s53
v_mfma_f32_16x16x32_bf16 v[160:163], a[244:247], a[16:19], v[160:163]
ds_read_b32 a43, v60
v_mfma_f32_16x16x32_bf16 v[164:167], a[244:247], a[20:23], v[164:167]
ds_read_b128 a[252:255], v15 offset:24576
v_perm_b32 v59, v49, v19, s54
v_mfma_f32_16x16x32_bf16 v[164:167], a[240:243], a[4:7], v[164:167]
s_add_u32 m0, s33, 142080
ds_read_b32 a44, v59
v_mfma_f32_16x16x32_bf16 v[168:171], a[240:243], a[8:11], v[168:171]
buffer_load_dwordx4 v10, s[20:23], 0 offen offset:1280 lds
v_perm_b32 v58, v49, v19, s55
v_mfma_f32_16x16x32_bf16 v[168:171], a[244:247], a[24:27], v[168:171]
ds_read_b32 a45, v58
v_perm_b32 v57, v53, v19, s54
v_mfma_f32_16x16x32_bf16 v[172:175], a[244:247], a[28:31], v[172:175]
s_waitcnt vmcnt(10)
v_cmp_ne_u64 s[50:51], s[88:89], v[98:99]
v_cmp_ne_u64 s[44:45], s[88:89], v[102:103]
v_mfma_f32_16x16x32_bf16 v[172:175], a[240:243], a[12:15], v[172:175]
s_waitcnt lgkmcnt(2)
ds_read_b32 a46, v57
buffer_load_dwordx4 v[32:35], v12, s[24:27], 0 offen offset:0 sc1
v_mfma_f32_16x16x32_bf16 v[192:195], a[248:251], a[0:3], v[192:195]
s_or_b64 s[50:51], s[44:45], s[50:51]
ds_read_b128 a[224:227], v15 offset:18432
buffer_load_dwordx4 v[36:39], v12, s[24:27], 0 offen offset:1024 sc1
v_mfma_f32_16x16x32_bf16 v[192:195], a[252:255], a[16:19], v[192:195]
s_cbranch_scc1 L_SLOW17
L_BACK17:
v_mfma_f32_16x16x32_bf16 v[196:199], a[252:255], a[20:23], v[196:199]
ds_read_b128 a[228:231], v14 offset:30720
v_perm_b32 v56, v53, v19, s55
v_mfma_f32_16x16x32_bf16 v[196:199], a[248:251], a[4:7], v[196:199]
ds_read_b32 a47, v56
v_perm_b32 v63, v96, v19, s52
v_mfma_f32_16x16x32_bf16 v[200:203], a[248:251], a[8:11], v[200:203]
ds_read_b32 a48, v63
v_perm_b32 v62, v96, v19, s53
v_mfma_f32_16x16x32_bf16 v[200:203], a[252:255], a[24:27], v[200:203]
ds_read_b32 a49, v62
v_perm_b32 v61, v100, v19, s52
v_mfma_f32_16x16x32_bf16 v[204:207], a[252:255], a[28:31], v[204:207]
ds_read_b32 a50, v61
v_perm_b32 v60, v100, v19, s53
v_mfma_f32_16x16x32_bf16 v[204:207], a[248:251], a[12:15], v[204:207]
s_waitcnt lgkmcnt(4)
ds_read_b32 a51, v60
v_mfma_f32_16x16x32_bf16 v[144:147], a[224:227], a[16:19], v[144:147]
ds_read_b128 a[232:235], v15 offset:22528
v_perm_b32 v59, v96, v19, s54
v_mfma_f32_16x16x32_bf16 v[144:147], a[228:231], a[32:35], v[144:147]
ds_read_b32 a52, v59
v_mfma_f32_16x16x32_bf16 v[148:151], a[228:231], a[36:39], v[148:151]
ds_read_b128 a[236:239], v14 offset:34816
v_perm_b32 v58, v96, v19, s55
v_mfma_f32_16x16x32_bf16 v[148:151], a[224:227], a[20:23], v[148:151]
ds_read_b32 a53, v58
v_perm_b32 v57, v100, v19, s54
v_mfma_f32_16x16x32_bf16 v[152:155], a[224:227], a[24:27], v[152:155]
ds_read_b32 a54, v57
v_perm_b32 v56, v100, v19, s55
v_mfma_f32_16x16x32_bf16 v[152:155], a[228:231], a[40:43], v[152:155]
s_waitcnt lgkmcnt(4)
ds_read_b32 a55, v56
v_perm_b32 v63, v97, v19, s52
v_mfma_f32_16x16x32_bf16 v[156:159], a[228:231], a[44:47], v[156:159]
ds_read_b32 a56, v63
v_perm_b32 v62, v97, v19, s53
v_mfma_f32_16x16x32_bf16 v[156:159], a[224:227], a[28:31], v[156:159]
s_waitcnt lgkmcnt(4)
ds_read_b32 a57, v62
v_mfma_f32_16x16x32_bf16 v[176:179], a[232:235], a[16:19], v[176:179]
ds_read_b128 a[240:243], v14 offset:36864
v_perm_b32 v61, v101, v19, s52
v_mfma_f32_16x16x32_bf16 v[176:179], a[236:239], a[32:35], v[176:179]
ds_read_b32 a58, v61
v_mfma_f32_16x16x32_bf16 v[180:183], a[236:239], a[36:39], v[180:183]
ds_read_b128 a[244:247], v15 offset:36864
v_perm_b32 v60, v101, v19, s53
v_mfma_f32_16x16x32_bf16 v[180:183], a[232:235], a[20:23], v[180:183]
ds_read_b32 a59, v60
v_perm_b32 v59, v97, v19, s54
v_mfma_f32_16x16x32_bf16 v[184:187], a[232:235], a[24:27], v[184:187]
ds_read_b32 a60, v59
v_perm_b32 v58, v97, v19, s55
v_mfma_f32_16x16x32_bf16 v[184:187], a[236:239], a[40:43], v[184:187]
ds_read_b32 a61, v58
v_perm_b32 v57, v101, v19, s54
v_mfma_f32_16x16x32_bf16 v[188:191], a[236:239], a[44:47], v[188:191]
ds_read_b32 a62, v57
v_mfma_f32_16x16x32_bf16 v[188:191], a[232:235], a[28:31], v[188:191]
s_waitcnt vmcnt(8) lgkmcnt(4)
v_perm_b32 v56, v101, v19, s55
v_cmp_ne_u64 s[50:51], s[88:89], v[82:83]
v_mfma_f32_16x16x32_bf16 v[224:227], a[240:243], a[0:3], v[224:227]
ds_read_b128 a[248:251], v14 offset:28672
v_cmp_ne_u64 s[44:45], s[88:89], v[86:87]
v_mfma_f32_16x16x32_bf16 v[224:227], a[244:247], a[16:19], v[224:227]
ds_read_b32 a63, v56
buffer_load_dwordx4 v[40:43], v12, s[24:27], 0 offen offset:2048 sc1
v_mfma_f32_16x16x32_bf16 v[228:231], a[244:247], a[20:23], v[228:231]
s_or_b64 s[50:51], s[44:45], s[50:51]
ds_read_b128 a[252:255], v15 offset:28672
buffer_load_dwordx4 v[44:47], v12, s[24:27], 0 offen offset:3072 sc1
v_mfma_f32_16x16x32_bf16 v[228:231], a[240:243], a[4:7], v[228:231]
s_cbranch_scc1 L_SLOW18
L_BACK18:
v_mfma_f32_16x16x32_bf16 v[232:235], a[240:243], a[8:11], v[232:235]
v_perm_b32 v63, v80, v19, s52
v_add_u32 v12, 45056, v13
v_mfma_f32_16x16x32_bf16 v[232:235], a[244:247], a[24:27], v[232:235]
ds_read_b32 a64, v63
v_perm_b32 v62, v80, v19, s53
v_mfma_f32_16x16x32_bf16 v[236:239], a[244:247], a[28:31], v[236:239]
s_add_u32 m0, s33, 146048
ds_read_b32 a65, v62
v_perm_b32 v61, v84, v19, s52
v_mfma_f32_16x16x32_bf16 v[236:239], a[240:243], a[12:15], v[236:239]
s_waitcnt lgkmcnt(2)
ds_read_b32 a66, v61
v_perm_b32 v60, v84, v19, s53
v_mfma_f32_16x16x32_bf16 v[128:131], a[248:251], a[32:35], v[128:131]
ds_read_b128 a[224:227], v15 offset:14336
buffer_load_dwordx4 v9, s[20:23], 0 offen offset:1408 lds
v_mfma_f32_16x16x32_bf16 v[128:131], a[252:255], a[48:51], v[128:131]
ds_read_b32 a67, v60
v_mfma_f32_16x16x32_bf16 v[132:135], a[252:255], a[52:55], v[132:135]
ds_read_b128 a[228:231], v14 offset:38912
v_perm_b32 v59, v80, v19, s54
v_mfma_f32_16x16x32_bf16 v[132:135], a[248:251], a[36:39], v[132:135]
ds_read_b32 a68, v59
v_perm_b32 v58, v80, v19, s55
v_mfma_f32_16x16x32_bf16 v[136:139], a[248:251], a[40:43], v[136:139]
ds_read_b32 a69, v58
v_perm_b32 v57, v84, v19, s54
v_mfma_f32_16x16x32_bf16 v[136:139], a[252:255], a[56:59], v[136:139]
ds_read_b32 a70, v57
v_perm_b32 v56, v84, v19, s55
v_mfma_f32_16x16x32_bf16 v[140:143], a[252:255], a[60:63], v[140:143]
ds_read_b32 a71, v56
v_perm_b32 v63, v81, v19, s52
v_mfma_f32_16x16x32_bf16 v[140:143], a[248:251], a[44:47], v[140:143]
s_waitcnt lgkmcnt(4)
ds_read_b32 a72, v63
v_mfma_f32_16x16x32_bf16 v[240:243], a[224:227], a[208:211], v[240:243]
ds_read_b128 a[232:235], v14 offset:32768
v_perm_b32 v62, v81, v19, s53
v_mfma_f32_16x16x32_bf16 v[240:243], a[228:231], a[0:3], v[240:243]
L_PAD3:
s_cbranch_vccnz L_PAD4
ds_read_b32 a73, v62
v_mfma_f32_16x16x32_bf16 v[244:247], a[228:231], a[4:7], v[244:247]
ds_read_b128 a[236:239], v15 offset:32768
v_perm_b32 v61, v85, v19, s52
v_mfma_f32_16x16x32_bf16 v[244:247], a[224:227], a[212:215], v[244:247]
s_add_u32 m0, s33, 150016
ds_read_b32 a74, v61
v_mfma_f32_16x16x32_bf16 v[248:251], a[224:227], a[216:219], v[248:251]
buffer_load_dwordx4 v8, s[20:23], 0 offen offset:1536 lds
v_perm_b32 v60, v85, v19, s53
v_mfma_f32_16x16x32_bf16 v[248:251], a[228:231], a[8:11], v[248:251]
ds_read_b32 a75, v60
v_perm_b32 v59, v81, v19, s54
v_mfma_f32_16x16x32_bf16 v[252:255], a[228:231], a[12:15], v[252:255]
ds_read_b32 a76, v59
v_perm_b32 v58, v81, v19, s55
v_mfma_f32_16x16x32_bf16 v[252:255], a[224:227], a[220:223], v[252:255]
s_waitcnt lgkmcnt(3)
ds_read_b32 a77, v58
v_mfma_f32_16x16x32_bf16 v[160:163], a[232:235], a[32:35], v[160:163]
ds_read_b128 a[240:243], v15 offset:26624
v_mfma_f32_16x16x32_bf16 v[160:163], a[236:239], a[48:51], v[160:163]
s_waitcnt vmcnt(8)
v_cmp_ne_u64 s[50:51], s[88:89], v[90:91]
v_cmp_ne_u64 s[44:45], s[88:89], v[94:95]
v_mfma_f32_16x16x32_bf16 v[164:167], a[236:239], a[52:55], v[164:167]
ds_read_b128 a[244:247], v14 offset:43008
v_perm_b32 v57, v85, v19, s54
v_mfma_f32_16x16x32_bf16 v[164:167], a[232:235], a[36:39], v[164:167]
s_or_b64 s[50:51], s[44:45], s[50:51]
ds_read_b32 a78, v57
v_perm_b32 v56, v85, v19, s55
v_mfma_f32_16x16x32_bf16 v[168:171], a[232:235], a[40:43], v[168:171]
s_cbranch_scc1 L_SLOW19
L_BACK19:
v_mfma_f32_16x16x32_bf16 v[168:171], a[236:239], a[56:59], v[168:171]
ds_read_b32 a79, v56
v_perm_b32 v63, v88, v19, s52
v_mfma_f32_16x16x32_bf16 v[172:175], a[236:239], a[60:63], v[172:175]
s_add_u32 m0, s33, 154240
ds_read_b32 a80, v63
v_perm_b32 v62, v88, v19, s53
v_mfma_f32_16x16x32_bf16 v[172:175], a[232:235], a[44:47], v[172:175]
s_waitcnt lgkmcnt(3)
ds_read_b32 a81, v62
v_perm_b32 v61, v92, v19, s52
v_mfma_f32_16x16x32_bf16 v[208:211], a[240:243], a[16:19], v[208:211]
ds_read_b128 a[248:251], v14 offset:40960
buffer_load_dwordx4 v10, s[20:23], 0 offen offset:1408 lds
v_mfma_f32_16x16x32_bf16 v[208:211], a[244:247], a[32:35], v[208:211]
ds_read_b32 a82, v61
buffer_load_dwordx4 v[48:51], v12, s[24:27], 0 offen offset:0 sc1
v_mfma_f32_16x16x32_bf16 v[212:215], a[244:247], a[36:39], v[212:215]
ds_read_b128 a[252:255], v15 offset:40960
v_perm_b32 v60, v92, v19, s53
v_mfma_f32_16x16x32_bf16 v[212:215], a[240:243], a[20:23], v[212:215]
ds_read_b32 a83, v60
v_perm_b32 v59, v88, v19, s54
v_mfma_f32_16x16x32_bf16 v[216:219], a[240:243], a[24:27], v[216:219]
ds_read_b32 a84, v59
v_perm_b32 v58, v88, v19, s55
v_mfma_f32_16x16x32_bf16 v[216:219], a[244:247], a[40:43], v[216:219]
ds_read_b32 a85, v58
v_perm_b32 v57, v92, v19, s54
v_mfma_f32_16x16x32_bf16 v[220:223], a[244:247], a[44:47], v[220:223]
ds_read_b32 a86, v57
v_perm_b32 v56, v92, v19, s55
v_mfma_f32_16x16x32_bf16 v[220:223], a[240:243], a[28:31], v[220:223]
s_waitcnt lgkmcnt(4)
ds_read_b32 a87, v56
buffer_load_dwordx4 v[52:55], v12, s[24:27], 0 offen offset:1024 sc1
v_mfma_f32_16x16x32_bf16 v[192:195], a[248:251], a[32:35], v[192:195]
ds_read_b128 a[224:227], v15 offset:30720
v_perm_b32 v63, v89, v19, s52
v_mfma_f32_16x16x32_bf16 v[192:195], a[252:255], a[48:51], v[192:195]
ds_read_b32 a88, v63
v_mfma_f32_16x16x32_bf16 v[196:199], a[252:255], a[52:55], v[196:199]
ds_read_b128 a[228:231], v14 offset:47104
v_perm_b32 v62, v89, v19, s53
v_mfma_f32_16x16x32_bf16 v[196:199], a[248:251], a[36:39], v[196:199]
s_add_u32 m0, s33, 158208
ds_read_b32 a89, v62
v_mfma_f32_16x16x32_bf16 v[200:203], a[248:251], a[40:43], v[200:203]
buffer_load_dwordx4 v9, s[20:23], 0 offen offset:1536 lds
v_perm_b32 v61, v93, v19, s52
v_mfma_f32_16x16x32_bf16 v[200:203], a[252:255], a[56:59], v[200:203]
ds_read_b32 a90, v61
v_perm_b32 v60, v93, v19, s53
v_mfma_f32_16x16x32_bf16 v[204:207], a[252:255], a[60:63], v[204:207]
ds_read_b32 a91, v60
v_perm_b32 v59, v89, v19, s54
v_mfma_f32_16x16x32_bf16 v[204:207], a[248:251], a[44:47], v[204:207]
s_waitcnt lgkmcnt(3)
ds_read_b32 a92, v59
v_mfma_f32_16x16x32_bf16 v[144:147], a[224:227], a[48:51], v[144:147]
ds_read_b128 a[232:235], v15 offset:34816
v_mfma_f32_16x16x32_bf16 v[144:147], a[228:231], a[64:67], v[144:147]
s_waitcnt vmcnt(8)
v_perm_b32 v58, v89, v19, s55
v_cmp_ne_u64 s[50:51], s[88:89], v[34:35]
v_mfma_f32_16x16x32_bf16 v[148:151], a[228:231], a[68:71], v[148:151]
ds_read_b128 a[236:239], v14 offset:51200
v_cmp_ne_u64 s[44:45], s[88:89], v[38:39]
v_mfma_f32_16x16x32_bf16 v[148:151], a[224:227], a[52:55], v[148:151]
ds_read_b32 a93, v58
v_perm_b32 v57, v93, v19, s54
v_mfma_f32_16x16x32_bf16 v[152:155], a[224:227], a[56:59], v[152:155]
s_or_b64 s[50:51], s[44:45], s[50:51]
ds_read_b32 a94, v57
v_perm_b32 v56, v93, v19, s55
v_mfma_f32_16x16x32_bf16 v[152:155], a[228:231], a[72:75], v[152:155]
s_cbranch_scc1 L_SLOW20
L_BACK20:
v_mfma_f32_16x16x32_bf16 v[156:159], a[228:231], a[76:79], v[156:159]
s_add_u32 m0, s33, 64256
ds_read_b32 a95, v56
v_perm_b32 v63, v32, v19, s52
v_mfma_f32_16x16x32_bf16 v[156:159], a[224:227], a[60:63], v[156:159]
s_waitcnt lgkmcnt(3)
ds_read_b32 a96, v63
v_perm_b32 v62, v32, v19, s53
v_mfma_f32_16x16x32_bf16 v[176:179], a[232:235], a[48:51], v[176:179]
ds_read_b128 a[240:243], v14 offset:45056
buffer_load_dwordx4 v11, s[20:23], 0 offen offset:1280 lds
v_mfma_f32_16x16x32_bf16 v[176:179], a[236:239], a[64:67], v[176:179]
ds_read_b32 a97, v62
buffer_load_dwordx4 v[96:99], v12, s[24:27], 0 offen offset:2048 sc1
v_mfma_f32_16x16x32_bf16 v[180:183], a[236:239], a[68:71], v[180:183]
ds_read_b128 a[244:247], v15 offset:45056
v_perm_b32 v61, v36, v19, s52
v_mfma_f32_16x16x32_bf16 v[180:183], a[232:235], a[52:55], v[180:183]
ds_read_b32 a98, v61
v_perm_b32 v60, v36, v19, s53
v_mfma_f32_16x16x32_bf16 v[184:187], a[232:235], a[56:59], v[184:187]
ds_read_b32 a99, v60
v_perm_b32 v59, v32, v19, s54
v_mfma_f32_16x16x32_bf16 v[184:187], a[236:239], a[72:75], v[184:187]
ds_read_b32 a100, v59
v_perm_b32 v58, v32, v19, s55
v_mfma_f32_16x16x32_bf16 v[188:191], a[236:239], a[76:79], v[188:191]
ds_read_b32 a101, v58
v_perm_b32 v57, v36, v19, s54
v_mfma_f32_16x16x32_bf16 v[188:191], a[232:235], a[60:63], v[188:191]
s_waitcnt lgkmcnt(4)
ds_read_b32 a102, v57
buffer_load_dwordx4 v[100:103], v12, s[24:27], 0 offen offset:3072 sc1
v_mfma_f32_16x16x32_bf16 v[128:131], a[240:243], a[64:67], v[128:131]
s_barrier
ds_read_b128 a[248:251], v14 offset:49152
v_perm_b32 v56, v36, v19, s55
v_mfma_f32_16x16x32_bf16 v[128:131], a[244:247], a[80:83], v[128:131]
ds_read_b32 a103, v56
v_add_u32 v12, 49152, v13
v_mfma_f32_16x16x32_bf16 v[132:135], a[244:247], a[84:87], v[132:135]
ds_read_b128 a[252:255], v15 offset:49152
v_perm_b32 v63, v33, v19, s52
v_mfma_f32_16x16x32_bf16 v[132:135], a[240:243], a[68:71], v[132:135]
s_add_u32 m0, s33, 67968
ds_read_b32 a104, v63
v_mfma_f32_16x16x32_bf16 v[136:139], a[240:243], a[72:75], v[136:139]
buffer_load_dwordx4 v8, s[20:23], 0 offen offset:1664 lds
v_perm_b32 v62, v33, v19, s53
v_mfma_f32_16x16x32_bf16 v[136:139], a[244:247], a[88:91], v[136:139]
ds_read_b32 a105, v62
v_perm_b32 v61, v37, v19, s52
v_mfma_f32_16x16x32_bf16 v[140:143], a[244:247], a[92:95], v[140:143]
ds_read_b32 a106, v61
v_perm_b32 v60, v37, v19, s53
v_mfma_f32_16x16x32_bf16 v[140:143], a[240:243], a[76:79], v[140:143]
s_waitcnt lgkmcnt(3)
ds_read_b32 a107, v60
v_mfma_f32_16x16x32_bf16 v[160:163], a[248:251], a[64:67], v[160:163]
ds_read_b128 a[224:227], v14 offset:53248
v_perm_b32 v59, v33, v19, s54
v_mfma_f32_16x16x32_bf16 v[160:163], a[252:255], a[80:83], v[160:163]
ds_read_b32 a108, v59
v_mfma_f32_16x16x32_bf16 v[164:167], a[252:255], a[84:87], v[164:167]
ds_read_b128 a[228:231], v15 offset:53248
v_perm_b32 v58, v33, v19, s55
v_mfma_f32_16x16x32_bf16 v[164:167], a[248:251], a[68:71], v[164:167]
s_waitcnt vmcnt(10)
v_cmp_ne_u64 s[50:51], s[88:89], v[42:43]
v_cmp_ne_u64 s[44:45], s[88:89], v[46:47]
v_mfma_f32_16x16x32_bf16 v[168:171], a[248:251], a[72:75], v[168:171]
ds_read_b32 a109, v58
v_perm_b32 v57, v37, v19, s54
v_mfma_f32_16x16x32_bf16 v[168:171], a[252:255], a[88:91], v[168:171]
s_or_b64 s[50:51], s[44:45], s[50:51]
ds_read_b32 a110, v57
v_perm_b32 v56, v37, v19, s55
v_mfma_f32_16x16x32_bf16 v[172:175], a[252:255], a[92:95], v[172:175]
s_cbranch_scc1 L_SLOW21
L_BACK21:
v_mfma_f32_16x16x32_bf16 v[172:175], a[248:251], a[76:79], v[172:175]
s_waitcnt lgkmcnt(2)
ds_read_b32 a111, v56
buffer_load_dwordx4 v[80:83], v12, s[24:27], 0 offen offset:0 sc1
v_mfma_f32_16x16x32_bf16 v[224:227], a[224:227], a[32:35], v[224:227]
ds_read_b128 a[232:235], v15 offset:43008
v_perm_b32 v63, v40, v19, s52
v_mfma_f32_16x16x32_bf16 v[224:227], a[228:231], a[48:51], v[224:227]
ds_read_b32 a112, v63
buffer_load_dwordx4 v[84:87], v12, s[24:27], 0 offen offset:1024 sc1
v_mfma_f32_16x16x32_bf16 v[228:231], a[228:231], a[52:55], v[228:231]
ds_read_b128 a[236:239], v14 offset:59392
v_perm_b32 v62, v40, v19, s53
v_mfma_f32_16x16x32_bf16 v[228:231], a[224:227], a[36:39], v[228:231]
ds_read_b32 a113, v62
v_perm_b32 v61, v44, v19, s52
v_mfma_f32_16x16x32_bf16 v[232:235], a[224:227], a[40:43], v[232:235]
ds_read_b32 a114, v61
v_perm_b32 v60, v44, v19, s53
v_mfma_f32_16x16x32_bf16 v[232:235], a[228:231], a[56:59], v[232:235]
ds_read_b32 a115, v60
v_perm_b32 v59, v40, v19, s54
v_mfma_f32_16x16x32_bf16 v[236:239], a[228:231], a[60:63], v[236:239]
ds_read_b32 a116, v59
v_perm_b32 v58, v40, v19, s55
v_mfma_f32_16x16x32_bf16 v[236:239], a[224:227], a[44:47], v[236:239]
s_waitcnt lgkmcnt(4)
ds_read_b32 a117, v58
v_mfma_f32_16x16x32_bf16 v[208:211], a[232:235], a[48:51], v[208:211]
ds_read_b128 a[240:243], v15 offset:47104
v_perm_b32 v57, v44, v19, s54
v_mfma_f32_16x16x32_bf16 v[208:211], a[236:239], a[64:67], v[208:211]
ds_read_b32 a118, v57
v_mfma_f32_16x16x32_bf16 v[212:215], a[236:239], a[68:71], v[212:215]
ds_read_b128 a[244:247], v14 offset:63488
v_perm_b32 v56, v44, v19, s55
v_mfma_f32_16x16x32_bf16 v[212:215], a[232:235], a[52:55], v[212:215]
s_add_u32 m0, s33, 72192
ds_read_b32 a119, v56
v_mfma_f32_16x16x32_bf16 v[216:219], a[232:235], a[56:59], v[216:219]
buffer_load_dwordx4 v10, s[20:23], 0 offen offset:1536 lds
v_perm_b32 v63, v41, v19, s52
v_mfma_f32_16x16x32_bf16 v[216:219], a[236:239], a[72:75], v[216:219]
ds_read_b32 a120, v63
v_perm_b32 v62, v41, v19, s53
v_mfma_f32_16x16x32_bf16 v[220:223], a[236:239], a[76:79], v[220:223]
ds_read_b32 a121, v62
v_perm_b32 v61, v45, v19, s52
v_mfma_f32_16x16x32_bf16 v[220:223], a[232:235], a[60:63], v[220:223]
s_waitcnt lgkmcnt(3)
ds_read_b32 a122, v61
v_mfma_f32_16x16x32_bf16 v[144:147], a[240:243], a[80:83], v[144:147]
ds_read_b128 a[248:251], v14 offset:57344
v_perm_b32 v60, v45, v19, s53
v_mfma_f32_16x16x32_bf16 v[144:147], a[244:247], a[96:99], v[144:147]
ds_read_b32 a123, v60
v_mfma_f32_16x16x32_bf16 v[148:151], a[244:247], a[100:103], v[148:151]
ds_read_b128 a[252:255], v15 offset:57344
v_perm_b32 v59, v41, v19, s54
v_mfma_f32_16x16x32_bf16 v[148:151], a[240:243], a[84:87], v[148:151]
ds_read_b32 a124, v59
v_perm_b32 v58, v41, v19, s55
v_mfma_f32_16x16x32_bf16 v[152:155], a[240:243], a[88:91], v[152:155]
ds_read_b32 a125, v58
v_perm_b32 v57, v45, v19, s54
v_mfma_f32_16x16x32_bf16 v[152:155], a[244:247], a[104:107], v[152:155]
ds_read_b32 a126, v57
v_perm_b32 v56, v45, v19, s55
v_mfma_f32_16x16x32_bf16 v[156:159], a[244:247], a[108:111], v[156:159]
s_waitcnt vmcnt(8)
s_add_u32 m0, s33, 80256
v_cmp_ne_u64 s[50:51], s[88:89], v[50:51]
v_cmp_ne_u64 s[44:45], s[88:89], v[54:55]
v_mfma_f32_16x16x32_bf16 v[156:159], a[240:243], a[92:95], v[156:159]
s_waitcnt lgkmcnt(3)
ds_read_b32 a127, v56
buffer_load_dwordx4 v[88:91], v12, s[24:27], 0 offen offset:2048 sc1
v_mfma_f32_16x16x32_bf16 v[192:195], a[248:251], a[64:67], v[192:195]
s_or_b64 s[50:51], s[44:45], s[50:51]
ds_read_b128 a[224:227], v14 offset:61440
buffer_load_dwordx4 v9, s[20:23], 0 offen offset:1664 lds
v_mfma_f32_16x16x32_bf16 v[192:195], a[252:255], a[80:83], v[192:195]
s_cbranch_scc1 L_SLOW22
L_BACK22:
v_mfma_f32_16x16x32_bf16 v[196:199], a[252:255], a[84:87], v[196:199]
ds_read_b128 a[228:231], v15 offset:61440
v_perm_b32 v63, v48, v19, s52
v_mfma_f32_16x16x32_bf16 v[196:199], a[248:251], a[68:71], v[196:199]
ds_read_b32 a128, v63
v_perm_b32 v62, v48, v19, s53
v_mfma_f32_16x16x32_bf16 v[200:203], a[248:251], a[72:75], v[200:203]
ds_read_b32 a129, v62
v_perm_b32 v61, v52, v19, s52
v_mfma_f32_16x16x32_bf16 v[200:203], a[252:255], a[88:91], v[200:203]
ds_read_b32 a130, v61
v_perm_b32 v60, v52, v19, s53
v_mfma_f32_16x16x32_bf16 v[204:207], a[252:255], a[92:95], v[204:207]
ds_read_b32 a131, v60
v_perm_b32 v59, v48, v19, s54
v_mfma_f32_16x16x32_bf16 v[204:207], a[248:251], a[76:79], v[204:207]
s_waitcnt lgkmcnt(4)
ds_read_b32 a132, v59
buffer_load_dwordx4 v[92:95], v12, s[24:27], 0 offen offset:3072 sc1
v_mfma_f32_16x16x32_bf16 v[128:131], a[224:227], a[96:99], v[128:131]
ds_read_b128 a[232:235], v15 offset:51200
v_perm_b32 v58, v48, v19, s55
v_mfma_f32_16x16x32_bf16 v[128:131], a[228:231], a[112:115], v[128:131]
ds_read_b32 a133, v58
v_add_u32 v12, 53248, v13
v_mfma_f32_16x16x32_bf16 v[132:135], a[228:231], a[116:119], v[132:135]
ds_read_b128 a[236:239], v16 offset:2048
v_perm_b32 v57, v52, v19, s54
v_mfma_f32_16x16x32_bf16 v[132:135], a[224:227], a[100:103], v[132:135]
s_add_u32 m0, s33, 84224
ds_read_b32 a134, v57
v_mfma_f32_16x16x32_bf16 v[136:139], a[224:227], a[104:107], v[136:139]
buffer_load_dwordx4 v8, s[20:23], 0 offen offset:1792 lds
v_perm_b32 v56, v52, v19, s55
v_mfma_f32_16x16x32_bf16 v[136:139], a[228:231], a[120:123], v[136:139]
ds_read_b32 a135, v56
v_perm_b32 v63, v49, v19, s52
v_mfma_f32_16x16x32_bf16 v[140:143], a[228:231], a[124:127], v[140:143]
ds_read_b32 a136, v63
v_perm_b32 v62, v49, v19, s53
v_mfma_f32_16x16x32_bf16 v[140:143], a[224:227], a[108:111], v[140:143]
s_waitcnt lgkmcnt(3)
ds_read_b32 a137, v62
v_mfma_f32_16x16x32_bf16 v[176:179], a[232:235], a[80:83], v[176:179]
ds_read_b128 a[240:243], v16 offset:0
v_perm_b32 v61, v53, v19, s52
v_mfma_f32_16x16x32_bf16 v[176:179], a[236:239], a[96:99], v[176:179]
ds_read_b32 a138, v61
v_mfma_f32_16x16x32_bf16 v[180:183], a[236:239], a[100:103], v[180:183]
ds_read_b128 a[244:247], v17 offset:0
v_perm_b32 v60, v53, v19, s53
v_mfma_f32_16x16x32_bf16 v[180:183], a[232:235], a[84:87], v[180:183]
ds_read_b32 a139, v60
v_perm_b32 v59, v49, v19, s54
v_mfma_f32_16x16x32_bf16 v[184:187], a[232:235], a[88:91], v[184:187]
ds_read_b32 a140, v59
v_perm_b32 v58, v49, v19, s55
v_mfma_f32_16x16x32_bf16 v[184:187], a[236:239], a[104:107], v[184:187]
ds_read_b32 a141, v58
v_perm_b32 v57, v53, v19, s54
v_mfma_f32_16x16x32_bf16 v[188:191], a[236:239], a[108:111], v[188:191]
s_waitcnt vmcnt(8)
s_add_u32 m0, s33, 76416
v_cmp_ne_u64 s[50:51], s[88:89], v[98:99]
v_cmp_ne_u64 s[44:45], s[88:89], v[102:103]
v_mfma_f32_16x16x32_bf16 v[188:191], a[232:235], a[92:95], v[188:191]
s_waitcnt lgkmcnt(3)
ds_read_b32 a142, v57
v_mfma_f32_16x16x32_bf16 v[160:163], a[240:243], a[96:99], v[160:163]
s_or_b64 s[50:51], s[44:45], s[50:51]
ds_read_b128 a[248:251], v15 offset:38912
buffer_load_dwordx4 v11, s[20:23], 0 offen offset:1408 lds
v_mfma_f32_16x16x32_bf16 v[160:163], a[244:247], a[112:115], v[160:163]
s_cbranch_scc1 L_SLOW23
L_BACK23:
v_mfma_f32_16x16x32_bf16 v[164:167], a[244:247], a[116:119], v[164:167]
ds_read_b128 a[252:255], v14 offset:55296
v_perm_b32 v56, v53, v19, s55
v_mfma_f32_16x16x32_bf16 v[164:167], a[240:243], a[100:103], v[164:167]
ds_read_b32 a143, v56
v_perm_b32 v63, v96, v19, s52
v_mfma_f32_16x16x32_bf16 v[168:171], a[240:243], a[104:107], v[168:171]
ds_read_b32 a144, v63
v_perm_b32 v62, v96, v19, s53
v_mfma_f32_16x16x32_bf16 v[168:171], a[244:247], a[120:123], v[168:171]
ds_read_b32 a145, v62
v_perm_b32 v61, v100, v19, s52
v_mfma_f32_16x16x32_bf16 v[172:175], a[244:247], a[124:127], v[172:175]
ds_read_b32 a146, v61
v_perm_b32 v60, v100, v19, s53
v_mfma_f32_16x16x32_bf16 v[172:175], a[240:243], a[108:111], v[172:175]
s_waitcnt lgkmcnt(4)
ds_read_b32 a147, v60
buffer_load_dwordx4 v[32:35], v12, s[24:27], 0 offen offset:0 sc1
v_mfma_f32_16x16x32_bf16 v[240:243], a[248:251], a[16:19], v[240:243]
ds_read_b128 a[224:227], v15 offset:63488
v_perm_b32 v59, v96, v19, s54
v_mfma_f32_16x16x32_bf16 v[240:243], a[252:255], a[32:35], v[240:243]
ds_read_b32 a148, v59
buffer_load_dwordx4 v[36:39], v12, s[24:27], 0 offen offset:1024 sc1
v_mfma_f32_16x16x32_bf16 v[244:247], a[252:255], a[36:39], v[244:247]
ds_read_b128 a[228:231], v16 offset:6144
v_perm_b32 v58, v96, v19, s55
v_mfma_f32_16x16x32_bf16 v[244:247], a[248:251], a[20:23], v[244:247]
s_add_u32 m0, s33, 88320
ds_read_b32 a149, v58
v_mfma_f32_16x16x32_bf16 v[248:251], a[248:251], a[24:27], v[248:251]
buffer_load_dwordx4 v9, s[20:23], 0 offen offset:1792 lds
v_perm_b32 v57, v100, v19, s54
v_mfma_f32_16x16x32_bf16 v[248:251], a[252:255], a[40:43], v[248:251]
ds_read_b32 a150, v57
v_perm_b32 v56, v100, v19, s55
v_mfma_f32_16x16x32_bf16 v[252:255], a[252:255], a[44:47], v[252:255]
ds_read_b32 a151, v56
v_perm_b32 v63, v97, v19, s52
v_mfma_f32_16x16x32_bf16 v[252:255], a[248:251], a[28:31], v[252:255]
s_waitcnt lgkmcnt(3)
ds_read_b32 a152, v63
v_mfma_f32_16x16x32_bf16 v[144:147], a[224:227], a[112:115], v[144:147]
ds_read_b128 a[232:235], v16 offset:8192
v_perm_b32 v62, v97, v19, s53
v_mfma_f32_16x16x32_bf16 v[144:147], a[228:231], a[128:131], v[144:147]
ds_read_b32 a153, v62
v_mfma_f32_16x16x32_bf16 v[148:151], a[228:231], a[132:135], v[148:151]
ds_read_b128 a[236:239], v17 offset:8192
v_perm_b32 v61, v101, v19, s52
v_mfma_f32_16x16x32_bf16 v[148:151], a[224:227], a[116:119], v[148:151]
ds_read_b32 a154, v61
v_perm_b32 v60, v101, v19, s53
v_mfma_f32_16x16x32_bf16 v[152:155], a[224:227], a[120:123], v[152:155]
ds_read_b32 a155, v60
v_perm_b32 v59, v97, v19, s54
v_mfma_f32_16x16x32_bf16 v[152:155], a[228:231], a[136:139], v[152:155]
ds_read_b32 a156, v59
v_perm_b32 v58, v97, v19, s55
v_mfma_f32_16x16x32_bf16 v[156:159], a[228:231], a[140:143], v[156:159]
s_add_u32 m0, s33, 92544
ds_read_b32 a157, v58
v_perm_b32 v57, v101, v19, s54
v_mfma_f32_16x16x32_bf16 v[156:159], a[224:227], a[124:127], v[156:159]
s_waitcnt vmcnt(9) lgkmcnt(4)
v_cmp_ne_u64 s[50:51], s[88:89], v[82:83]
v_cmp_ne_u64 s[44:45], s[88:89], v[86:87]
v_mfma_f32_16x16x32_bf16 v[224:227], a[232:235], a[64:67], v[224:227]
ds_read_b128 a[240:243], v15 offset:59392
buffer_load_dwordx4 v10, s[20:23], 0 offen offset:1664 lds
v_mfma_f32_16x16x32_bf16 v[224:227], a[236:239], a[80:83], v[224:227]
ds_read_b32 a158, v57
v_mfma_f32_16x16x32_bf16 v[228:231], a[236:239], a[84:87], v[228:231]
s_or_b64 s[50:51], s[44:45], s[50:51]
ds_read_b128 a[244:247], v16 offset:14336
v_perm_b32 v56, v101, v19, s55
v_mfma_f32_16x16x32_bf16 v[228:231], a[232:235], a[68:71], v[228:231]
s_cbranch_scc1 L_SLOW24
L_BACK24:
v_mfma_f32_16x16x32_bf16 v[232:235], a[232:235], a[72:75], v[232:235]
ds_read_b32 a159, v56
v_perm_b32 v63, v80, v19, s52
v_mfma_f32_16x16x32_bf16 v[232:235], a[236:239], a[88:91], v[232:235]
ds_read_b32 a160, v63
v_perm_b32 v62, v80, v19, s53
v_mfma_f32_16x16x32_bf16 v[236:239], a[236:239], a[92:95], v[236:239]
ds_read_b32 a161, v62
v_perm_b32 v61, v84, v19, s52
v_mfma_f32_16x16x32_bf16 v[236:239], a[232:235], a[76:79], v[236:239]
s_waitcnt lgkmcnt(3)
ds_read_b32 a162, v61
buffer_load_dwordx4 v[40:43], v12, s[24:27], 0 offen offset:2048 sc1
v_mfma_f32_16x16x32_bf16 v[208:211], a[240:243], a[80:83], v[208:211]
s_barrier
ds_read_b128 a[248:251], v16 offset:4096
v_perm_b32 v60, v84, v19, s53
v_mfma_f32_16x16x32_bf16 v[208:211], a[244:247], a[96:99], v[208:211]
ds_read_b32 a163, v60
buffer_load_dwordx4 v[44:47], v12, s[24:27], 0 offen offset:3072 sc1
v_mfma_f32_16x16x32_bf16 v[212:215], a[244:247], a[100:103], v[212:215]
ds_read_b128 a[252:255], v17 offset:4096
v_perm_b32 v59, v80, v19, s54
v_mfma_f32_16x16x32_bf16 v[212:215], a[240:243], a[84:87], v[212:215]
s_add_u32 m0, s33, 96384
ds_read_b32 a164, v59
v_add_u32 v12, 57344, v13
v_mfma_f32_16x16x32_bf16 v[216:219], a[240:243], a[88:91], v[216:219]
buffer_load_dwordx4 v8, s[20:23], 0 offen offset:1920 lds
v_perm_b32 v58, v80, v19, s55
v_mfma_f32_16x16x32_bf16 v[216:219], a[244:247], a[104:107], v[216:219]
ds_read_b32 a165, v58
v_perm_b32 v57, v84, v19, s54
v_mfma_f32_16x16x32_bf16 v[220:223], a[244:247], a[108:111], v[220:223]
ds_read_b32 a166, v57
v_perm_b32 v56, v84, v19, s55
v_mfma_f32_16x16x32_bf16 v[220:223], a[240:243], a[92:95], v[220:223]
s_waitcnt lgkmcnt(3)
ds_read_b32 a167, v56
v_mfma_f32_16x16x32_bf16 v[128:131], a[248:251], a[128:131], v[128:131]
ds_read_b128 a[224:227], v16 offset:12288
v_perm_b32 v63, v81, v19, s52
v_mfma_f32_16x16x32_bf16 v[128:131], a[252:255], a[144:147], v[128:131]
ds_read_b32 a168, v63
v_mfma_f32_16x16x32_bf16 v[132:135], a[252:255], a[148:151], v[132:135]
ds_read_b128 a[228:231], v17 offset:12288
v_perm_b32 v62, v81, v19, s53
v_mfma_f32_16x16x32_bf16 v[132:135], a[248:251], a[132:135], v[132:135]
ds_read_b32 a169, v62
v_perm_b32 v61, v85, v19, s52
v_mfma_f32_16x16x32_bf16 v[136:139], a[248:251], a[136:139], v[136:139]
ds_read_b32 a170, v61
v_perm_b32 v60, v85, v19, s53
v_mfma_f32_16x16x32_bf16 v[136:139], a[252:255], a[152:155], v[136:139]
ds_read_b32 a171, v60
v_perm_b32 v59, v81, v19, s54
v_mfma_f32_16x16x32_bf16 v[140:143], a[252:255], a[156:159], v[140:143]
ds_read_b32 a172, v59
v_perm_b32 v58, v81, v19, s55
v_mfma_f32_16x16x32_bf16 v[140:143], a[248:251], a[140:143], v[140:143]
s_waitcnt lgkmcnt(4)
ds_read_b32 a173, v58
v_mfma_f32_16x16x32_bf16 v[192:195], a[224:227], a[96:99], v[192:195]
ds_read_b128 a[232:235], v17 offset:2048
v_mfma_f32_16x16x32_bf16 v[192:195], a[228:231], a[112:115], v[192:195]
s_waitcnt vmcnt(9)
v_cmp_ne_u64 s[50:51], s[88:89], v[90:91]
v_cmp_ne_u64 s[44:45], s[88:89], v[94:95]
v_mfma_f32_16x16x32_bf16 v[196:199], a[228:231], a[116:119], v[196:199]
ds_read_b128 a[236:239], v16 offset:18432
v_perm_b32 v57, v85, v19, s54
v_mfma_f32_16x16x32_bf16 v[196:199], a[224:227], a[100:103], v[196:199]
s_or_b64 s[50:51], s[44:45], s[50:51]
ds_read_b32 a174, v57
v_perm_b32 v56, v85, v19, s55
v_mfma_f32_16x16x32_bf16 v[200:203], a[224:227], a[104:107], v[200:203]
s_cbranch_scc1 L_SLOW25
L_BACK25:
v_mfma_f32_16x16x32_bf16 v[200:203], a[228:231], a[120:123], v[200:203]
ds_read_b32 a175, v56
v_perm_b32 v63, v88, v19, s52
v_mfma_f32_16x16x32_bf16 v[204:207], a[228:231], a[124:127], v[204:207]
ds_read_b32 a176, v63
v_perm_b32 v62, v88, v19, s53
v_mfma_f32_16x16x32_bf16 v[204:207], a[224:227], a[108:111], v[204:207]
s_waitcnt lgkmcnt(3)
ds_read_b32 a177, v62
v_mfma_f32_16x16x32_bf16 v[176:179], a[232:235], a[112:115], v[176:179]
ds_read_b128 a[240:243], v16 offset:16384
v_perm_b32 v61, v92, v19, s52
v_mfma_f32_16x16x32_bf16 v[176:179], a[236:239], a[128:131], v[176:179]
ds_read_b32 a178, v61
v_mfma_f32_16x16x32_bf16 v[180:183], a[236:239], a[132:135], v[180:183]
ds_read_b128 a[244:247], v17 offset:16384
v_perm_b32 v60, v92, v19, s53
v_mfma_f32_16x16x32_bf16 v[180:183], a[232:235], a[116:119], v[180:183]
ds_read_b32 a179, v60
v_perm_b32 v59, v88, v19, s54
v_mfma_f32_16x16x32_bf16 v[184:187], a[232:235], a[120:123], v[184:187]
ds_read_b32 a180, v59
v_perm_b32 v58, v88, v19, s55
v_mfma_f32_16x16x32_bf16 v[184:187], a[236:239], a[136:139], v[184:187]
ds_read_b32 a181, v58
v_perm_b32 v57, v92, v19, s54
v_mfma_f32_16x16x32_bf16 v[188:191], a[236:239], a[140:143], v[188:191]
ds_read_b32 a182, v57
v_perm_b32 v56, v92, v19, s55
v_mfma_f32_16x16x32_bf16 v[188:191], a[232:235], a[124:127], v[188:191]
L_PAD4:
s_cbranch_vccnz L_PADRET
s_waitcnt lgkmcnt(4)
ds_read_b32 a183, v56
buffer_load_dwordx4 v[48:51], v12, s[24:27], 0 offen offset:0 sc1
v_mfma_f32_16x16x32_bf16 v[160:163], a[240:243], a[128:131], v[160:163]
ds_read_b128 a[248:251], v17 offset:6144
v_perm_b32 v63, v89, v19, s52
v_mfma_f32_16x16x32_bf16 v[160:163], a[244:247], a[144:147], v[160:163]
ds_read_b32 a184, v63
buffer_load_dwordx4 v[52:55], v12, s[24:27], 0 offen offset:1024 sc1
v_mfma_f32_16x16x32_bf16 v[164:167], a[244:247], a[148:151], v[164:167]
ds_read_b128 a[252:255], v16 offset:22528
v_perm_b32 v62, v89, v19, s53
v_mfma_f32_16x16x32_bf16 v[164:167], a[240:243], a[132:135], v[164:167]
ds_read_b32 a185, v62
v_perm_b32 v61, v93, v19, s52
v_mfma_f32_16x16x32_bf16 v[168:171], a[240:243], a[136:139], v[168:171]
ds_read_b32 a186, v61
v_perm_b32 v60, v93, v19, s53
v_mfma_f32_16x16x32_bf16 v[168:171], a[244:247], a[152:155], v[168:171]
ds_read_b32 a187, v60
v_perm_b32 v59, v89, v19, s54
v_mfma_f32_16x16x32_bf16 v[172:175], a[244:247], a[156:159], v[172:175]
ds_read_b32 a188, v59
v_perm_b32 v58, v89, v19, s55
v_mfma_f32_16x16x32_bf16 v[172:175], a[240:243], a[140:143], v[172:175]
s_waitcnt lgkmcnt(4)
ds_read_b32 a189, v58
v_mfma_f32_16x16x32_bf16 v[144:147], a[248:251], a[144:147], v[144:147]
ds_read_b128 a[224:227], v16 offset:20480
v_perm_b32 v57, v93, v19, s54
v_mfma_f32_16x16x32_bf16 v[144:147], a[252:255], a[160:163], v[144:147]
ds_read_b32 a190, v57
v_mfma_f32_16x16x32_bf16 v[148:151], a[252:255], a[164:167], v[148:151]
ds_read_b128 a[228:231], v17 offset:20480
v_perm_b32 v56, v93, v19, s55
v_mfma_f32_16x16x32_bf16 v[148:151], a[248:251], a[148:151], v[148:151]
ds_read_b32 a191, v56
v_mfma_f32_16x16x32_bf16 v[152:155], a[248:251], a[152:155], v[152:155]
v_mfma_f32_16x16x32_bf16 v[152:155], a[252:255], a[168:171], v[152:155]
v_mfma_f32_16x16x32_bf16 v[156:159], a[252:255], a[172:175], v[156:159]
s_waitcnt vmcnt(7)
v_cmp_ne_u64 s[50:51], s[88:89], v[34:35]
v_cmp_ne_u64 s[44:45], s[88:89], v[38:39]
v_mfma_f32_16x16x32_bf16 v[156:159], a[248:251], a[156:159], v[156:159]
s_waitcnt lgkmcnt(1)
v_mfma_f32_16x16x32_bf16 v[128:131], a[224:227], a[160:163], v[128:131]
s_or_b64 s[50:51], s[44:45], s[50:51]
ds_read_b128 a[232:235], v16 offset:24576
v_mfma_f32_16x16x32_bf16 v[128:131], a[228:231], a[176:179], v[128:131]
s_cbranch_scc1 L_SLOW26
L_BACK26:
v_mfma_f32_16x16x32_bf16 v[132:135], a[228:231], a[180:183], v[132:135]
ds_read_b128 a[236:239], v17 offset:24576
v_mfma_f32_16x16x32_bf16 v[132:135], a[224:227], a[164:167], v[132:135]
buffer_load_dwordx4 v[96:99], v12, s[24:27], 0 offen offset:2048 sc1
v_perm_b32 v63, v32, v19, s52
v_mfma_f32_16x16x32_bf16 v[136:139], a[224:227], a[168:171], v[136:139]
ds_read_b32 a192, v63
v_perm_b32 v62, v32, v19, s53
v_mfma_f32_16x16x32_bf16 v[136:139], a[228:231], a[184:187], v[136:139]
s_waitcnt lgkmcnt(2)
ds_read_b32 a193, v62
v_perm_b32 v61, v36, v19, s52
v_mfma_f32_16x16x32_bf16 v[140:143], a[228:231], a[188:191], v[140:143]
s_add_u32 m0, s33, 104960
ds_read_b32 a194, v61
v_perm_b32 v60, v36, v19, s53
v_mfma_f32_16x16x32_bf16 v[140:143], a[224:227], a[172:175], v[140:143]
s_waitcnt lgkmcnt(3)
ds_read_b32 a195, v60
v_perm_b32 v59, v32, v19, s54
v_mfma_f32_16x16x32_bf16 v[192:195], a[232:235], a[128:131], v[192:195]
ds_read_b128 a[240:243], v17 offset:14336
buffer_load_dwordx4 v11, s[20:23], 0 offen offset:1536 lds
v_mfma_f32_16x16x32_bf16 v[192:195], a[236:239], a[144:147], v[192:195]
ds_read_b32 a196, v59
buffer_load_dwordx4 v[100:103], v12, s[24:27], 0 offen offset:3072 sc1
v_mfma_f32_16x16x32_bf16 v[196:199], a[236:239], a[148:151], v[196:199]
ds_read_b128 a[244:247], v16 offset:26624
v_perm_b32 v58, v32, v19, s55
v_mfma_f32_16x16x32_bf16 v[196:199], a[232:235], a[132:135], v[196:199]
ds_read_b32 a197, v58
v_perm_b32 v57, v36, v19, s54
v_mfma_f32_16x16x32_bf16 v[200:203], a[232:235], a[136:139], v[200:203]
ds_read_b32 a198, v57
v_perm_b32 v56, v36, v19, s55
v_mfma_f32_16x16x32_bf16 v[200:203], a[236:239], a[152:155], v[200:203]
ds_read_b32 a199, v56
v_perm_b32 v63, v33, v19, s52
v_mfma_f32_16x16x32_bf16 v[204:207], a[236:239], a[156:159], v[204:207]
ds_read_b32 a200, v63
v_perm_b32 v62, v33, v19, s53
v_mfma_f32_16x16x32_bf16 v[204:207], a[232:235], a[140:143], v[204:207]
s_waitcnt lgkmcnt(4)
ds_read_b32 a201, v62
v_add_u32 v12, 61440, v13
v_mfma_f32_16x16x32_bf16 v[208:211], a[240:243], a[112:115], v[208:211]
ds_read_b128 a[248:251], v17 offset:18432
v_perm_b32 v61, v37, v19, s52
v_mfma_f32_16x16x32_bf16 v[208:211], a[244:247], a[128:131], v[208:211]
ds_read_b32 a202, v61
v_mfma_f32_16x16x32_bf16 v[212:215], a[244:247], a[132:135], v[212:215]
ds_read_b128 a[252:255], v16 offset:30720
v_perm_b32 v60, v37, v19, s53
v_mfma_f32_16x16x32_bf16 v[212:215], a[240:243], a[116:119], v[212:215]
s_add_u32 m0, s33, 108672
ds_read_b32 a203, v60
v_mfma_f32_16x16x32_bf16 v[216:219], a[240:243], a[120:123], v[216:219]
buffer_load_dwordx4 v9, s[20:23], 0 offen offset:1920 lds
v_perm_b32 v59, v33, v19, s54
v_mfma_f32_16x16x32_bf16 v[216:219], a[244:247], a[136:139], v[216:219]
ds_read_b32 a204, v59
v_perm_b32 v58, v33, v19, s55
v_mfma_f32_16x16x32_bf16 v[220:223], a[244:247], a[140:143], v[220:223]
ds_read_b32 a205, v58
v_mfma_f32_16x16x32_bf16 v[220:223], a[240:243], a[124:127], v[220:223]
s_waitcnt vmcnt(7) lgkmcnt(3)
v_perm_b32 v57, v37, v19, s54
v_cmp_ne_u64 s[50:51], s[88:89], v[42:43]
v_mfma_f32_16x16x32_bf16 v[176:179], a[248:251], a[144:147], v[176:179]
ds_read_b128 a[224:227], v14 offset:0
v_cmp_ne_u64 s[44:45], s[88:89], v[46:47]
v_mfma_f32_16x16x32_bf16 v[176:179], a[252:255], a[160:163], v[176:179]
ds_read_b32 a206, v57
v_mfma_f32_16x16x32_bf16 v[180:183], a[252:255], a[164:167], v[180:183]
s_or_b64 s[50:51], s[44:45], s[50:51]
ds_read_b128 a[228:231], v15 offset:0
v_perm_b32 v56, v37, v19, s55
v_mfma_f32_16x16x32_bf16 v[180:183], a[248:251], a[148:151], v[180:183]
s_cbranch_scc1 L_SLOW27
L_BACK27:
v_mfma_f32_16x16x32_bf16 v[184:187], a[248:251], a[152:155], v[184:187]
ds_read_b32 a207, v56
v_perm_b32 v63, v40, v19, s52
v_mfma_f32_16x16x32_bf16 v[184:187], a[252:255], a[168:171], v[184:187]
ds_read_b32 a208, v63
v_perm_b32 v62, v40, v19, s53
v_mfma_f32_16x16x32_bf16 v[188:191], a[252:255], a[172:175], v[188:191]
s_add_u32 m0, s33, 112896
ds_read_b32 a209, v62
v_perm_b32 v61, v44, v19, s52
v_mfma_f32_16x16x32_bf16 v[188:191], a[248:251], a[156:159], v[188:191]
s_waitcnt lgkmcnt(3)
ds_read_b32 a210, v61
v_perm_b32 v60, v44, v19, s53
v_mfma_f32_16x16x32_bf16 v[224:227], a[224:227], a[96:99], v[224:227]
ds_read_b128 a[232:235], v16 offset:28672
buffer_load_dwordx4 v10, s[20:23], 0 offen offset:1792 lds
v_mfma_f32_16x16x32_bf16 v[224:227], a[228:231], a[112:115], v[224:227]
ds_read_b32 a211, v60
buffer_load_dwordx4 v[80:83], v12, s[24:27], 0 offen offset:0 sc1
v_mfma_f32_16x16x32_bf16 v[228:231], a[228:231], a[116:119], v[228:231]
ds_read_b128 a[236:239], v17 offset:28672
v_perm_b32 v59, v40, v19, s54
v_mfma_f32_16x16x32_bf16 v[228:231], a[224:227], a[100:103], v[228:231]
ds_read_b32 a212, v59
v_perm_b32 v58, v40, v19, s55
v_mfma_f32_16x16x32_bf16 v[232:235], a[224:227], a[104:107], v[232:235]
ds_read_b32 a213, v58
v_perm_b32 v57, v44, v19, s54
v_mfma_f32_16x16x32_bf16 v[232:235], a[228:231], a[120:123], v[232:235]
ds_read_b32 a214, v57
v_perm_b32 v56, v44, v19, s55
v_mfma_f32_16x16x32_bf16 v[236:239], a[228:231], a[124:127], v[236:239]
ds_read_b32 a215, v56
v_perm_b32 v63, v41, v19, s52
v_mfma_f32_16x16x32_bf16 v[236:239], a[224:227], a[108:111], v[236:239]
s_waitcnt lgkmcnt(4)
ds_read_b32 a216, v63
buffer_load_dwordx4 v[84:87], v12, s[24:27], 0 offen offset:1024 sc1
v_mfma_f32_16x16x32_bf16 v[160:163], a[232:235], a[160:163], v[160:163]
ds_read_b128 a[240:243], v17 offset:22528
v_perm_b32 v62, v41, v19, s53
v_mfma_f32_16x16x32_bf16 v[160:163], a[236:239], a[176:179], v[160:163]
ds_read_b32 a217, v62
v_mfma_f32_16x16x32_bf16 v[164:167], a[236:239], a[180:183], v[164:167]
ds_read_b128 a[244:247], v14 offset:6144
v_perm_b32 v61, v45, v19, s52
v_mfma_f32_16x16x32_bf16 v[164:167], a[232:235], a[164:167], v[164:167]
s_add_u32 m0, s33, 100736
ds_read_b32 a218, v61
v_mfma_f32_16x16x32_bf16 v[168:171], a[232:235], a[168:171], v[168:171]
buffer_load_dwordx4 v11, s[20:23], 0 offen offset:1664 lds
v_perm_b32 v60, v45, v19, s53
v_mfma_f32_16x16x32_bf16 v[168:171], a[236:239], a[184:187], v[168:171]
ds_read_b32 a219, v60
v_perm_b32 v59, v41, v19, s54
v_mfma_f32_16x16x32_bf16 v[172:175], a[236:239], a[188:191], v[172:175]
ds_read_b32 a220, v59
v_perm_b32 v58, v41, v19, s55
v_mfma_f32_16x16x32_bf16 v[172:175], a[232:235], a[172:175], v[172:175]
s_waitcnt lgkmcnt(3)
ds_read_b32 a221, v58
v_mfma_f32_16x16x32_bf16 v[144:147], a[240:243], a[176:179], v[144:147]
s_waitcnt vmcnt(10)
s_barrier
ds_read_b128 a[248:251], v14 offset:4096
v_perm_b32 v57, v45, v19, s54
v_mfma_f32_16x16x32_bf16 v[144:147], a[244:247], a[192:195], v[144:147]
ds_read_b32 a222, v57
v_mfma_f32_16x16x32_bf16 v[148:151], a[244:247], a[196:199], v[148:151]
ds_read_b128 a[252:255], v15 offset:4096
v_perm_b32 v56, v45, v19, s55
v_mfma_f32_16x16x32_bf16 v[148:151], a[240:243], a[180:183], v[148:151]
ds_read_b32 a223, v56
v_mfma_f32_16x16x32_bf16 v[152:155], a[240:243], a[184:187], v[152:155]
v_mfma_f32_16x16x32_bf16 v[152:155], a[244:247], a[200:203], v[152:155]
buffer_load_dwordx4 v[88:91], v12, s[24:27], 0 offen offset:2048 sc1
v_mfma_f32_16x16x32_bf16 v[156:159], a[244:247], a[204:207], v[156:159]
s_waitcnt vmcnt(9)
s_add_u32 m0, s33, 125056
v_cmp_ne_u64 s[50:51], s[88:89], v[50:51]
v_cmp_ne_u64 s[44:45], s[88:89], v[54:55]
v_mfma_f32_16x16x32_bf16 v[156:159], a[240:243], a[188:191], v[156:159]
s_waitcnt lgkmcnt(1)
buffer_load_dwordx4 v[92:95], v12, s[24:27], 0 offen offset:3072 sc1
v_mfma_f32_16x16x32_bf16 v[128:131], a[248:251], a[192:195], v[128:131]
s_or_b64 s[50:51], s[44:45], s[50:51]
ds_read_b128 a[224:227], v15 offset:55296
buffer_load_dwordx4 v10, s[20:23], 0 offen offset:1920 lds
v_mfma_f32_16x16x32_bf16 v[128:131], a[252:255], a[208:211], v[128:131]
s_cbranch_scc1 L_SLOW28
L_BACK28:
v_mfma_f32_16x16x32_bf16 v[132:135], a[252:255], a[212:215], v[132:135]
ds_read_b128 a[228:231], v16 offset:10240
v_mfma_f32_16x16x32_bf16 v[132:135], a[248:251], a[196:199], v[132:135]
v_perm_b32 v63, v48, v19, s52
v_mfma_f32_16x16x32_bf16 v[136:139], a[248:251], a[200:203], v[136:139]
ds_read_b32 a0, v63
v_perm_b32 v62, v48, v19, s53
v_mfma_f32_16x16x32_bf16 v[136:139], a[252:255], a[216:219], v[136:139]
s_waitcnt lgkmcnt(2)
ds_read_b32 a1, v62
v_perm_b32 v61, v52, v19, s52
v_mfma_f32_16x16x32_bf16 v[140:143], a[252:255], a[220:223], v[140:143]
ds_read_b32 a2, v61
v_perm_b32 v60, v52, v19, s53
v_mfma_f32_16x16x32_bf16 v[140:143], a[248:251], a[204:207], v[140:143]
s_waitcnt lgkmcnt(3)
ds_read_b32 a3, v60
v_mfma_f32_16x16x32_bf16 v[240:243], a[224:227], a[48:51], v[240:243]
ds_read_b128 a[232:235], v14 offset:8192
v_perm_b32 v59, v48, v19, s54
v_mfma_f32_16x16x32_bf16 v[240:243], a[228:231], a[64:67], v[240:243]
ds_read_b32 a4, v59
v_mfma_f32_16x16x32_bf16 v[244:247], a[228:231], a[68:71], v[244:247]
ds_read_b128 a[236:239], v15 offset:8192
v_perm_b32 v58, v48, v19, s55
v_mfma_f32_16x16x32_bf16 v[244:247], a[224:227], a[52:55], v[244:247]
s_add_u32 m0, s33, 121088
ds_read_b32 a5, v58
v_mfma_f32_16x16x32_bf16 v[248:251], a[224:227], a[56:59], v[248:251]
buffer_load_dwordx4 v11, s[20:23], 0 offen offset:1792 lds
v_perm_b32 v57, v52, v19, s54
v_mfma_f32_16x16x32_bf16 v[248:251], a[228:231], a[72:75], v[248:251]
ds_read_b32 a6, v57
v_perm_b32 v56, v52, v19, s55
v_mfma_f32_16x16x32_bf16 v[252:255], a[228:231], a[76:79], v[252:255]
ds_read_b32 a7, v56
v_perm_b32 v63, v49, v19, s52
v_mfma_f32_16x16x32_bf16 v[252:255], a[224:227], a[60:63], v[252:255]
s_waitcnt lgkmcnt(3)
ds_read_b32 a8, v63
v_mfma_f32_16x16x32_bf16 v[192:195], a[232:235], a[160:163], v[192:195]
ds_read_b128 a[240:243], v17 offset:30720
v_perm_b32 v62, v49, v19, s53
v_mfma_f32_16x16x32_bf16 v[192:195], a[236:239], a[176:179], v[192:195]
ds_read_b32 a9, v62
v_mfma_f32_16x16x32_bf16 v[196:199], a[236:239], a[180:183], v[196:199]
ds_read_b128 a[244:247], v14 offset:18432
v_perm_b32 v61, v53, v19, s52
v_mfma_f32_16x16x32_bf16 v[196:199], a[232:235], a[164:167], v[196:199]
ds_read_b32 a10, v61
v_perm_b32 v60, v53, v19, s53
v_mfma_f32_16x16x32_bf16 v[200:203], a[232:235], a[168:171], v[200:203]
ds_read_b32 a11, v60
v_perm_b32 v59, v49, v19, s54
v_mfma_f32_16x16x32_bf16 v[200:203], a[236:239], a[184:187], v[200:203]
ds_read_b32 a12, v59
v_perm_b32 v58, v49, v19, s55
v_mfma_f32_16x16x32_bf16 v[204:207], a[236:239], a[188:191], v[204:207]
s_add_u32 m0, s33, 129152
ds_read_b32 a13, v58
v_perm_b32 v57, v53, v19, s54
v_mfma_f32_16x16x32_bf16 v[204:207], a[232:235], a[172:175], v[204:207]
s_waitcnt vmcnt(9) lgkmcnt(4)
v_cmp_ne_u64 s[50:51], s[88:89], v[98:99]
v_cmp_ne_u64 s[44:45], s[88:89], v[102:103]
v_mfma_f32_16x16x32_bf16 v[176:179], a[240:243], a[176:179], v[176:179]
ds_read_b128 a[248:251], v14 offset:16384
buffer_load_dwordx4 v11, s[20:23], 0 offen offset:1920 lds
v_mfma_f32_16x16x32_bf16 v[176:179], a[244:247], a[192:195], v[176:179]
ds_read_b32 a14, v57
v_mfma_f32_16x16x32_bf16 v[180:183], a[244:247], a[196:199], v[180:183]
s_or_b64 s[50:51], s[44:45], s[50:51]
ds_read_b128 a[252:255], v15 offset:16384
v_perm_b32 v56, v53, v19, s55
v_mfma_f32_16x16x32_bf16 v[180:183], a[240:243], a[180:183], v[180:183]
s_cbranch_scc1 L_SLOW29
L_BACK29:
v_mfma_f32_16x16x32_bf16 v[184:187], a[240:243], a[184:187], v[184:187]
ds_read_b32 a15, v56
v_perm_b32 v63, v96, v19, s52
v_mfma_f32_16x16x32_bf16 v[184:187], a[244:247], a[200:203], v[184:187]
ds_read_b32 a16, v63
v_perm_b32 v62, v96, v19, s53
v_mfma_f32_16x16x32_bf16 v[188:191], a[244:247], a[204:207], v[188:191]
ds_read_b32 a17, v62
v_perm_b32 v61, v100, v19, s52
v_mfma_f32_16x16x32_bf16 v[188:191], a[240:243], a[188:191], v[188:191]
s_waitcnt lgkmcnt(3)
ds_read_b32 a18, v61
v_mfma_f32_16x16x32_bf16 v[160:163], a[248:251], a[192:195], v[160:163]
ds_read_b128 a[224:227], v17 offset:26624
v_perm_b32 v60, v100, v19, s53
v_mfma_f32_16x16x32_bf16 v[160:163], a[252:255], a[208:211], v[160:163]
ds_read_b32 a19, v60
v_mfma_f32_16x16x32_bf16 v[164:167], a[252:255], a[212:215], v[164:167]
ds_read_b128 a[228:231], v14 offset:10240
v_perm_b32 v59, v96, v19, s54
v_mfma_f32_16x16x32_bf16 v[164:167], a[248:251], a[196:199], v[164:167]
ds_read_b32 a20, v59
v_perm_b32 v58, v96, v19, s55
v_mfma_f32_16x16x32_bf16 v[168:171], a[248:251], a[200:203], v[168:171]
ds_read_b32 a21, v58
v_perm_b32 v57, v100, v19, s54
v_mfma_f32_16x16x32_bf16 v[168:171], a[252:255], a[216:219], v[168:171]
ds_read_b32 a22, v57
v_perm_b32 v56, v100, v19, s55
v_mfma_f32_16x16x32_bf16 v[172:175], a[252:255], a[220:223], v[172:175]
ds_read_b32 a23, v56
v_perm_b32 v63, v97, v19, s52
v_mfma_f32_16x16x32_bf16 v[172:175], a[248:251], a[204:207], v[172:175]
s_waitcnt lgkmcnt(4)
ds_read_b32 a24, v63
v_mfma_f32_16x16x32_bf16 v[208:211], a[224:227], a[144:147], v[208:211]
ds_read_b128 a[232:235], v15 offset:6144
v_perm_b32 v62, v97, v19, s53
v_mfma_f32_16x16x32_bf16 v[208:211], a[228:231], a[160:163], v[208:211]
ds_read_b32 a25, v62
v_mfma_f32_16x16x32_bf16 v[212:215], a[228:231], a[164:167], v[212:215]
ds_read_b128 a[236:239], v14 offset:22528
v_perm_b32 v61, v101, v19, s52
v_mfma_f32_16x16x32_bf16 v[212:215], a[224:227], a[148:151], v[212:215]
ds_read_b32 a26, v61
v_perm_b32 v60, v101, v19, s53
v_mfma_f32_16x16x32_bf16 v[216:219], a[224:227], a[152:155], v[216:219]
ds_read_b32 a27, v60
v_perm_b32 v59, v97, v19, s54
v_mfma_f32_16x16x32_bf16 v[216:219], a[228:231], a[168:171], v[216:219]
ds_read_b32 a28, v59
v_perm_b32 v58, v97, v19, s55
v_mfma_f32_16x16x32_bf16 v[220:223], a[228:231], a[172:175], v[220:223]
ds_read_b32 a29, v58
v_perm_b32 v57, v101, v19, s54
v_mfma_f32_16x16x32_bf16 v[220:223], a[224:227], a[156:159], v[220:223]
s_waitcnt lgkmcnt(4)
ds_read_b32 a30, v57
v_mfma_f32_16x16x32_bf16 v[144:147], a[232:235], a[208:211], v[144:147]
ds_read_b128 a[240:243], v14 offset:20480
v_mfma_f32_16x16x32_bf16 v[144:147], a[236:239], a[0:3], v[144:147]
s_waitcnt vmcnt(6)
v_cmp_ne_u64 s[50:51], s[88:89], v[82:83]
v_cmp_ne_u64 s[44:45], s[88:89], v[86:87]
v_mfma_f32_16x16x32_bf16 v[148:151], a[236:239], a[4:7], v[148:151]
ds_read_b128 a[244:247], v15 offset:20480
v_perm_b32 v56, v101, v19, s55
v_mfma_f32_16x16x32_bf16 v[148:151], a[232:235], a[212:215], v[148:151]
s_or_b64 s[50:51], s[44:45], s[50:51]
ds_read_b32 a31, v56
v_mfma_f32_16x16x32_bf16 v[152:155], a[232:235], a[216:219], v[152:155]
s_cbranch_scc1 L_SLOW30
L_BACK30:
v_mfma_f32_16x16x32_bf16 v[152:155], a[236:239], a[8:11], v[152:155]
v_perm_b32 v63, v80, v19, s52
v_mfma_f32_16x16x32_bf16 v[156:159], a[236:239], a[12:15], v[156:159]
ds_read_b32 a32, v63
v_perm_b32 v62, v80, v19, s53
v_mfma_f32_16x16x32_bf16 v[156:159], a[232:235], a[220:223], v[156:159]
s_waitcnt lgkmcnt(2)
ds_read_b32 a33, v62
v_mfma_f32_16x16x32_bf16 v[128:131], a[240:243], a[0:3], v[128:131]
ds_read_b128 a[248:251], v14 offset:12288
v_perm_b32 v61, v84, v19, s52
v_mfma_f32_16x16x32_bf16 v[128:131], a[244:247], a[16:19], v[128:131]
ds_read_b32 a34, v61
v_mfma_f32_16x16x32_bf16 v[132:135], a[244:247], a[20:23], v[132:135]
ds_read_b128 a[252:255], v15 offset:12288
v_perm_b32 v60, v84, v19, s53
v_mfma_f32_16x16x32_bf16 v[132:135], a[240:243], a[4:7], v[132:135]
ds_read_b32 a35, v60
v_perm_b32 v59, v80, v19, s54
v_mfma_f32_16x16x32_bf16 v[136:139], a[240:243], a[8:11], v[136:139]
ds_read_b32 a36, v59
v_perm_b32 v58, v80, v19, s55
v_mfma_f32_16x16x32_bf16 v[136:139], a[244:247], a[24:27], v[136:139]
s_waitcnt lgkmcnt(4)
ds_read_b32 a37, v58
v_perm_b32 v57, v84, v19, s54
v_mfma_f32_16x16x32_bf16 v[140:143], a[244:247], a[28:31], v[140:143]
ds_read_b32 a38, v57
v_perm_b32 v56, v84, v19, s55
v_mfma_f32_16x16x32_bf16 v[140:143], a[240:243], a[12:15], v[140:143]
s_waitcnt lgkmcnt(4)
ds_read_b32 a39, v56
v_mfma_f32_16x16x32_bf16 v[224:227], a[248:251], a[128:131], v[224:227]
ds_read_b128 a[224:227], v15 offset:18432
v_perm_b32 v63, v81, v19, s52
v_mfma_f32_16x16x32_bf16 v[224:227], a[252:255], a[144:147], v[224:227]
ds_read_b32 a40, v63
v_mfma_f32_16x16x32_bf16 v[228:231], a[252:255], a[148:151], v[228:231]
ds_read_b128 a[228:231], v14 offset:26624
v_perm_b32 v62, v81, v19, s53
v_mfma_f32_16x16x32_bf16 v[228:231], a[248:251], a[132:135], v[228:231]
ds_read_b32 a41, v62
v_perm_b32 v61, v85, v19, s52
v_mfma_f32_16x16x32_bf16 v[232:235], a[248:251], a[136:139], v[232:235]
ds_read_b32 a42, v61
v_perm_b32 v60, v85, v19, s53
v_mfma_f32_16x16x32_bf16 v[232:235], a[252:255], a[152:155], v[232:235]
ds_read_b32 a43, v60
v_perm_b32 v59, v81, v19, s54
v_mfma_f32_16x16x32_bf16 v[236:239], a[252:255], a[156:159], v[236:239]
ds_read_b32 a44, v59
v_perm_b32 v58, v81, v19, s55
v_mfma_f32_16x16x32_bf16 v[236:239], a[248:251], a[140:143], v[236:239]
s_waitcnt lgkmcnt(4)
ds_read_b32 a45, v58
v_mfma_f32_16x16x32_bf16 v[176:179], a[224:227], a[208:211], v[176:179]
ds_read_b128 a[232:235], v14 offset:24576
v_mfma_f32_16x16x32_bf16 v[176:179], a[228:231], a[0:3], v[176:179]
s_waitcnt vmcnt(3)
v_cmp_ne_u64 s[50:51], s[88:89], v[90:91]
v_cmp_ne_u64 s[44:45], s[88:89], v[94:95]
v_mfma_f32_16x16x32_bf16 v[180:183], a[228:231], a[4:7], v[180:183]
ds_read_b128 a[236:239], v15 offset:24576
v_perm_b32 v57, v85, v19, s54
v_mfma_f32_16x16x32_bf16 v[180:183], a[224:227], a[212:215], v[180:183]
s_or_b64 s[50:51], s[44:45], s[50:51]
ds_read_b32 a46, v57
v_perm_b32 v56, v85, v19, s55
v_mfma_f32_16x16x32_bf16 v[184:187], a[224:227], a[216:219], v[184:187]
s_cbranch_scc1 L_SLOW31
L_BACK31:
v_mfma_f32_16x16x32_bf16 v[184:187], a[228:231], a[8:11], v[184:187]
ds_read_b32 a47, v56
v_perm_b32 v63, v88, v19, s52
v_mfma_f32_16x16x32_bf16 v[188:191], a[228:231], a[12:15], v[188:191]
ds_read_b32 a48, v63
v_perm_b32 v62, v88, v19, s53
v_mfma_f32_16x16x32_bf16 v[188:191], a[224:227], a[220:223], v[188:191]
s_waitcnt lgkmcnt(3)
ds_read_b32 a49, v62
v_mfma_f32_16x16x32_bf16 v[160:163], a[232:235], a[0:3], v[160:163]
ds_read_b128 a[240:243], v14 offset:28672
v_perm_b32 v61, v92, v19, s52
v_mfma_f32_16x16x32_bf16 v[160:163], a[236:239], a[16:19], v[160:163]
ds_read_b32 a50, v61
v_mfma_f32_16x16x32_bf16 v[164:167], a[236:239], a[20:23], v[164:167]
ds_read_b128 a[244:247], v15 offset:28672
v_perm_b32 v60, v92, v19, s53
v_mfma_f32_16x16x32_bf16 v[164:167], a[232:235], a[4:7], v[164:167]
ds_read_b32 a51, v60
v_perm_b32 v59, v88, v19, s54
v_mfma_f32_16x16x32_bf16 v[168:171], a[232:235], a[8:11], v[168:171]
ds_read_b32 a52, v59
v_perm_b32 v58, v88, v19, s55
v_mfma_f32_16x16x32_bf16 v[168:171], a[236:239], a[24:27], v[168:171]
ds_read_b32 a53, v58
v_perm_b32 v57, v92, v19, s54
v_mfma_f32_16x16x32_bf16 v[172:175], a[236:239], a[28:31], v[172:175]
ds_read_b32 a54, v57
v_perm_b32 v56, v92, v19, s55
v_mfma_f32_16x16x32_bf16 v[172:175], a[232:235], a[12:15], v[172:175]
s_waitcnt lgkmcnt(4)
ds_read_b32 a55, v56
v_mfma_f32_16x16x32_bf16 v[192:195], a[240:243], a[192:195], v[192:195]
ds_read_b128 a[248:251], v15 offset:22528
v_perm_b32 v63, v89, v19, s52
v_mfma_f32_16x16x32_bf16 v[192:195], a[244:247], a[208:211], v[192:195]
ds_read_b32 a56, v63
v_mfma_f32_16x16x32_bf16 v[196:199], a[244:247], a[212:215], v[196:199]
ds_read_b128 a[252:255], v14 offset:34816
v_perm_b32 v62, v89, v19, s53
v_mfma_f32_16x16x32_bf16 v[196:199], a[240:243], a[196:199], v[196:199]
ds_read_b32 a57, v62
v_perm_b32 v61, v93, v19, s52
v_mfma_f32_16x16x32_bf16 v[200:203], a[240:243], a[200:203], v[200:203]
ds_read_b32 a58, v61
v_perm_b32 v60, v93, v19, s53
v_mfma_f32_16x16x32_bf16 v[200:203], a[244:247], a[216:219], v[200:203]
ds_read_b32 a59, v60
v_perm_b32 v59, v89, v19, s54
v_mfma_f32_16x16x32_bf16 v[204:207], a[244:247], a[220:223], v[204:207]
ds_read_b32 a60, v59
v_perm_b32 v58, v89, v19, s55
v_mfma_f32_16x16x32_bf16 v[204:207], a[240:243], a[204:207], v[204:207]
s_waitcnt lgkmcnt(4)
ds_read_b32 a61, v58
v_mfma_f32_16x16x32_bf16 v[144:147], a[248:251], a[16:19], v[144:147]
ds_read_b128 a[224:227], v14 offset:32768
v_perm_b32 v57, v93, v19, s54
v_mfma_f32_16x16x32_bf16 v[144:147], a[252:255], a[32:35], v[144:147]
ds_read_b32 a62, v57
v_mfma_f32_16x16x32_bf16 v[148:151], a[252:255], a[36:39], v[148:151]
ds_read_b128 a[228:231], v15 offset:32768
v_perm_b32 v56, v93, v19, s55
v_mfma_f32_16x16x32_bf16 v[148:151], a[248:251], a[20:23], v[148:151]
ds_read_b32 a63, v56
v_mfma_f32_16x16x32_bf16 v[152:155], a[248:251], a[24:27], v[152:155]
v_mfma_f32_16x16x32_bf16 v[152:155], a[252:255], a[40:43], v[152:155]
v_mfma_f32_16x16x32_bf16 v[156:159], a[252:255], a[44:47], v[156:159]
v_mfma_f32_16x16x32_bf16 v[156:159], a[248:251], a[28:31], v[156:159]
s_waitcnt lgkmcnt(1)
v_mfma_f32_16x16x32_bf16 v[128:131], a[224:227], a[32:35], v[128:131]
ds_read_b128 a[232:235], v15 offset:10240
v_mfma_f32_16x16x32_bf16 v[128:131], a[228:231], a[48:51], v[128:131]
v_mfma_f32_16x16x32_bf16 v[132:135], a[228:231], a[52:55], v[132:135]
ds_read_b128 a[236:239], v14 offset:30720
v_mfma_f32_16x16x32_bf16 v[132:135], a[224:227], a[36:39], v[132:135]
v_mfma_f32_16x16x32_bf16 v[136:139], a[224:227], a[40:43], v[136:139]
v_mfma_f32_16x16x32_bf16 v[136:139], a[228:231], a[56:59], v[136:139]
s_waitcnt lgkmcnt(1)
v_mfma_f32_16x16x32_bf16 v[140:143], a[228:231], a[60:63], v[140:143]
v_mfma_f32_16x16x32_bf16 v[140:143], a[224:227], a[44:47], v[140:143]
s_waitcnt lgkmcnt(0)
v_mfma_f32_16x16x32_bf16 v[208:211], a[232:235], a[176:179], v[208:211]
ds_read_b128 a[240:243], v15 offset:34816
v_mfma_f32_16x16x32_bf16 v[208:211], a[236:239], a[192:195], v[208:211]
v_mfma_f32_16x16x32_bf16 v[212:215], a[236:239], a[196:199], v[212:215]
v_mfma_f32_16x16x32_bf16 v[212:215], a[232:235], a[180:183], v[212:215]
v_mfma_f32_16x16x32_bf16 v[216:219], a[232:235], a[184:187], v[216:219]
s_waitcnt vmcnt(0)
s_barrier
ds_read_b128 a[244:247], v14 offset:40960
v_mfma_f32_16x16x32_bf16 v[216:219], a[236:239], a[200:203], v[216:219]
v_mfma_f32_16x16x32_bf16 v[220:223], a[236:239], a[204:207], v[220:223]
ds_read_b128 a[248:251], v15 offset:40960
v_mfma_f32_16x16x32_bf16 v[220:223], a[232:235], a[188:191], v[220:223]
s_waitcnt lgkmcnt(2)
v_mul_f32 v128, v128, v24
v_mul_f32 v132, v132, v25
v_mfma_f32_16x16x32_bf16 v[144:147], a[240:243], a[48:51], v[144:147]
L_PAD5:
s_cbranch_vccnz L_PADRET
v_mul_f32 v136, v136, v26
v_mul_f32 v140, v140, v27
v_mfma_f32_16x16x32_bf16 v[148:151], a[240:243], a[52:55], v[148:151]
v_cvt_pk_bf16_f32 v120, v128, v132
v_cvt_pk_bf16_f32 v121, v136, v140
v_mfma_f32_16x16x32_bf16 v[152:155], a[240:243], a[56:59], v[152:155]
buffer_store_dwordx2 v[120:121], v18, s[28:31], 0 offen nt
v_mul_f32 v129, v129, v24
v_mfma_f32_16x16x32_bf16 v[156:159], a[240:243], a[60:63], v[156:159]
s_waitcnt lgkmcnt(0)
v_mul_f32 v133, v133, v25
v_mul_f32 v137, v137, v26
v_mfma_f32_16x16x32_bf16 v[224:227], a[244:247], a[160:163], v[224:227]
s_add_u32 s28, s28, 7168
ds_read_b128 a[252:255], v17 offset:10240
v_mul_f32 v141, v141, v27
v_mfma_f32_16x16x32_bf16 v[224:227], a[248:251], a[176:179], v[224:227]
s_addc_u32 s29, s29, 0
v_cvt_pk_bf16_f32 v122, v129, v133
v_cvt_pk_bf16_f32 v123, v137, v141
v_mfma_f32_16x16x32_bf16 v[228:231], a[248:251], a[180:183], v[228:231]
ds_read_b128 a[224:227], v14 offset:2048
v_mfma_f32_16x16x32_bf16 v[228:231], a[244:247], a[164:167], v[228:231]
buffer_store_dwordx2 v[122:123], v18, s[28:31], 0 offen nt
v_mul_f32 v130, v130, v24
v_mfma_f32_16x16x32_bf16 v[232:235], a[244:247], a[168:171], v[232:235]
s_add_u32 s28, s28, 7168
v_mul_f32 v134, v134, v25
v_mul_f32 v138, v138, v26
v_mfma_f32_16x16x32_bf16 v[232:235], a[248:251], a[184:187], v[232:235]
s_addc_u32 s29, s29, 0
v_mul_f32 v142, v142, v27
v_cvt_pk_bf16_f32 v124, v130, v134
v_mfma_f32_16x16x32_bf16 v[236:239], a[248:251], a[188:191], v[236:239]
v_cvt_pk_bf16_f32 v125, v138, v142
v_mfma_f32_16x16x32_bf16 v[236:239], a[244:247], a[172:175], v[236:239]
s_waitcnt lgkmcnt(0)
v_mfma_f32_16x16x32_bf16 v[240:243], a[252:255], a[80:83], v[240:243]
ds_read_b128 a[228:231], v14 offset:45056
v_mfma_f32_16x16x32_bf16 v[240:243], a[224:227], a[96:99], v[240:243]
buffer_store_dwordx2 v[124:125], v18, s[28:31], 0 offen nt
v_mul_f32 v131, v131, v24
v_mfma_f32_16x16x32_bf16 v[244:247], a[224:227], a[100:103], v[244:247]
s_add_u32 s28, s28, 7168
ds_read_b128 a[232:235], v15 offset:45056
v_mul_f32 v135, v135, v25
v_mfma_f32_16x16x32_bf16 v[244:247], a[252:255], a[84:87], v[244:247]
s_addc_u32 s29, s29, 0
v_mul_f32 v139, v139, v26
v_mul_f32 v143, v143, v27
v_mfma_f32_16x16x32_bf16 v[248:251], a[252:255], a[88:91], v[248:251]
v_cvt_pk_bf16_f32 v126, v131, v135
v_cvt_pk_bf16_f32 v127, v139, v143
v_mfma_f32_16x16x32_bf16 v[248:251], a[224:227], a[104:107], v[248:251]
buffer_store_dwordx2 v[126:127], v18, s[28:31], 0 offen nt
v_mul_f32 v144, v144, v24
v_mfma_f32_16x16x32_bf16 v[252:255], a[224:227], a[108:111], v[252:255]
s_add_u32 s28, s28, 93184
v_mul_f32 v148, v148, v25
v_mul_f32 v152, v152, v26
v_mfma_f32_16x16x32_bf16 v[252:255], a[252:255], a[92:95], v[252:255]
s_waitcnt lgkmcnt(0)
v_mul_f32 v156, v156, v27
v_cvt_pk_bf16_f32 v120, v144, v148
v_mfma_f32_16x16x32_bf16 v[160:163], a[228:231], a[32:35], v[160:163]
s_addc_u32 s29, s29, 0
ds_read_b128 a[236:239], v15 offset:26624
v_cvt_pk_bf16_f32 v121, v152, v156
v_mfma_f32_16x16x32_bf16 v[160:163], a[232:235], a[48:51], v[160:163]
buffer_store_dwordx2 v[120:121], v18, s[28:31], 0 offen nt
v_mul_f32 v145, v145, v24
v_mfma_f32_16x16x32_bf16 v[164:167], a[232:235], a[52:55], v[164:167]
s_add_u32 s28, s28, 7168
ds_read_b128 a[240:243], v14 offset:47104
v_mul_f32 v149, v149, v25
v_mfma_f32_16x16x32_bf16 v[164:167], a[228:231], a[36:39], v[164:167]
s_addc_u32 s29, s29, 0
v_mul_f32 v153, v153, v26
v_mul_f32 v157, v157, v27
v_mfma_f32_16x16x32_bf16 v[168:171], a[228:231], a[40:43], v[168:171]
v_cvt_pk_bf16_f32 v122, v145, v149
v_cvt_pk_bf16_f32 v123, v153, v157
v_mfma_f32_16x16x32_bf16 v[168:171], a[232:235], a[56:59], v[168:171]
buffer_store_dwordx2 v[122:123], v18, s[28:31], 0 offen nt
v_mul_f32 v146, v146, v24
v_mfma_f32_16x16x32_bf16 v[172:175], a[232:235], a[60:63], v[172:175]
s_add_u32 s28, s28, 7168
v_mul_f32 v150, v150, v25
v_mul_f32 v154, v154, v26
v_mfma_f32_16x16x32_bf16 v[172:175], a[228:231], a[44:47], v[172:175]
s_waitcnt lgkmcnt(0)
v_mul_f32 v158, v158, v27
v_cvt_pk_bf16_f32 v124, v146, v150
v_mfma_f32_16x16x32_bf16 v[176:179], a[236:239], a[16:19], v[176:179]
s_addc_u32 s29, s29, 0
ds_read_b128 a[244:247], v14 offset:49152
v_cvt_pk_bf16_f32 v125, v154, v158
v_mfma_f32_16x16x32_bf16 v[176:179], a[240:243], a[32:35], v[176:179]
buffer_store_dwordx2 v[124:125], v18, s[28:31], 0 offen nt
v_mul_f32 v147, v147, v24
v_mfma_f32_16x16x32_bf16 v[180:183], a[240:243], a[36:39], v[180:183]
s_add_u32 s28, s28, 7168
ds_read_b128 a[248:251], v15 offset:49152
v_mul_f32 v151, v151, v25
v_mfma_f32_16x16x32_bf16 v[180:183], a[236:239], a[20:23], v[180:183]
s_addc_u32 s29, s29, 0
v_mul_f32 v155, v155, v26
v_mul_f32 v159, v159, v27
v_mfma_f32_16x16x32_bf16 v[184:187], a[236:239], a[24:27], v[184:187]
v_cvt_pk_bf16_f32 v126, v147, v151
v_cvt_pk_bf16_f32 v127, v155, v159
v_mfma_f32_16x16x32_bf16 v[184:187], a[240:243], a[40:43], v[184:187]
buffer_store_dwordx2 v[126:127], v18, s[28:31], 0 offen nt
v_mfma_f32_16x16x32_bf16 v[188:191], a[240:243], a[44:47], v[188:191]
v_mfma_f32_16x16x32_bf16 v[188:191], a[236:239], a[28:31], v[188:191]
s_waitcnt lgkmcnt(0)
v_mul_f32 v160, v160, v24
v_mul_f32 v164, v164, v25
v_mfma_f32_16x16x32_bf16 v[192:195], a[244:247], a[0:3], v[192:195]
s_add_u32 s28, s28, 93184
ds_read_b128 a[252:255], v15 offset:30720
v_mul_f32 v168, v168, v26
v_mfma_f32_16x16x32_bf16 v[192:195], a[248:251], a[16:19], v[192:195]
s_addc_u32 s29, s29, 0
v_mul_f32 v172, v172, v27
v_cvt_pk_bf16_f32 v120, v160, v164
v_mfma_f32_16x16x32_bf16 v[196:199], a[248:251], a[20:23], v[196:199]
ds_read_b128 a[224:227], v14 offset:51200
v_cvt_pk_bf16_f32 v121, v168, v172
v_mfma_f32_16x16x32_bf16 v[196:199], a[244:247], a[4:7], v[196:199]
buffer_store_dwordx2 v[120:121], v18, s[28:31], 0 offen nt
v_mul_f32 v161, v161, v24
v_mfma_f32_16x16x32_bf16 v[200:203], a[244:247], a[8:11], v[200:203]
s_add_u32 s28, s28, 7168
v_mul_f32 v165, v165, v25
v_mul_f32 v169, v169, v26
v_mfma_f32_16x16x32_bf16 v[200:203], a[248:251], a[24:27], v[200:203]
s_addc_u32 s29, s29, 0
v_mul_f32 v173, v173, v27
v_cvt_pk_bf16_f32 v122, v161, v165
v_mfma_f32_16x16x32_bf16 v[204:207], a[248:251], a[28:31], v[204:207]
v_cvt_pk_bf16_f32 v123, v169, v173
v_mfma_f32_16x16x32_bf16 v[204:207], a[244:247], a[12:15], v[204:207]
s_waitcnt lgkmcnt(0)
v_mfma_f32_16x16x32_bf16 v[208:211], a[252:255], a[208:211], v[208:211]
ds_read_b128 a[228:231], v15 offset:47104
v_mfma_f32_16x16x32_bf16 v[208:211], a[224:227], a[0:3], v[208:211]
buffer_store_dwordx2 v[122:123], v18, s[28:31], 0 offen nt
v_mul_f32 v162, v162, v24
v_mfma_f32_16x16x32_bf16 v[212:215], a[224:227], a[4:7], v[212:215]
s_add_u32 s28, s28, 7168
v_mul_f32 v166, v166, v25
v_mul_f32 v170, v170, v26
v_mfma_f32_16x16x32_bf16 v[212:215], a[252:255], a[212:215], v[212:215]
s_addc_u32 s29, s29, 0
v_mul_f32 v174, v174, v27
v_cvt_pk_bf16_f32 v124, v162, v166
v_mfma_f32_16x16x32_bf16 v[216:219], a[252:255], a[216:219], v[216:219]
ds_read_b128 a[232:235], v14 offset:36864
v_cvt_pk_bf16_f32 v125, v170, v174
v_mfma_f32_16x16x32_bf16 v[216:219], a[224:227], a[8:11], v[216:219]
buffer_store_dwordx2 v[124:125], v18, s[28:31], 0 offen nt
v_mul_f32 v163, v163, v24
v_mfma_f32_16x16x32_bf16 v[220:223], a[224:227], a[12:15], v[220:223]
s_add_u32 s28, s28, 7168
ds_read_b128 a[236:239], v15 offset:36864
v_mul_f32 v167, v167, v25
v_mfma_f32_16x16x32_bf16 v[220:223], a[252:255], a[220:223], v[220:223]
s_waitcnt lgkmcnt(2)
v_mul_f32 v171, v171, v26
v_mul_f32 v175, v175, v27
v_mfma_f32_16x16x32_bf16 v[176:179], a[228:231], a[48:51], v[176:179]
s_addc_u32 s29, s29, 0
v_cvt_pk_bf16_f32 v126, v163, v167
v_cvt_pk_bf16_f32 v127, v171, v175
v_mfma_f32_16x16x32_bf16 v[180:183], a[228:231], a[52:55], v[180:183]
buffer_store_dwordx2 v[126:127], v18, s[28:31], 0 offen nt
v_mfma_f32_16x16x32_bf16 v[184:187], a[228:231], a[56:59], v[184:187]
v_mfma_f32_16x16x32_bf16 v[188:191], a[228:231], a[60:63], v[188:191]
s_waitcnt lgkmcnt(0)
v_mfma_f32_16x16x32_bf16 v[224:227], a[232:235], a[192:195], v[224:227]
ds_read_b128 a[240:243], v14 offset:61440
v_mfma_f32_16x16x32_bf16 v[224:227], a[236:239], a[208:211], v[224:227]
v_mfma_f32_16x16x32_bf16 v[228:231], a[236:239], a[212:215], v[228:231]
ds_read_b128 a[244:247], v15 offset:61440
v_mfma_f32_16x16x32_bf16 v[228:231], a[232:235], a[196:199], v[228:231]
v_mfma_f32_16x16x32_bf16 v[232:235], a[232:235], a[200:203], v[232:235]
v_mfma_f32_16x16x32_bf16 v[232:235], a[236:239], a[216:219], v[232:235]
v_mfma_f32_16x16x32_bf16 v[236:239], a[236:239], a[220:223], v[236:239]
v_mfma_f32_16x16x32_bf16 v[236:239], a[232:235], a[204:207], v[236:239]
s_waitcnt lgkmcnt(0)
v_mul_f32 v176, v176, v24
v_mul_f32 v180, v180, v25
v_mfma_f32_16x16x32_bf16 v[192:195], a[240:243], a[32:35], v[192:195]
s_add_u32 s28, s28, 93184
ds_read_b128 a[248:251], v15 offset:51200
v_mul_f32 v184, v184, v26
v_mfma_f32_16x16x32_bf16 v[192:195], a[244:247], a[48:51], v[192:195]
s_addc_u32 s29, s29, 0
v_mul_f32 v188, v188, v27
v_cvt_pk_bf16_f32 v120, v176, v180
v_mfma_f32_16x16x32_bf16 v[196:199], a[244:247], a[52:55], v[196:199]
ds_read_b128 a[252:255], v14 offset:63488
v_cvt_pk_bf16_f32 v121, v184, v188
v_mfma_f32_16x16x32_bf16 v[196:199], a[240:243], a[36:39], v[196:199]
buffer_store_dwordx2 v[120:121], v18, s[28:31], 0 offen nt
v_mul_f32 v177, v177, v24
v_mfma_f32_16x16x32_bf16 v[200:203], a[240:243], a[40:43], v[200:203]
s_add_u32 s28, s28, 7168
v_mul_f32 v181, v181, v25
v_mul_f32 v185, v185, v26
v_mfma_f32_16x16x32_bf16 v[200:203], a[244:247], a[56:59], v[200:203]
s_addc_u32 s29, s29, 0
v_mul_f32 v189, v189, v27
v_cvt_pk_bf16_f32 v122, v177, v181
v_mfma_f32_16x16x32_bf16 v[204:207], a[244:247], a[60:63], v[204:207]
v_cvt_pk_bf16_f32 v123, v185, v189
v_mfma_f32_16x16x32_bf16 v[204:207], a[240:243], a[44:47], v[204:207]
s_waitcnt lgkmcnt(0)
v_mfma_f32_16x16x32_bf16 v[208:211], a[248:251], a[16:19], v[208:211]
ds_read_b128 a[224:227], v15 offset:2048
v_mfma_f32_16x16x32_bf16 v[208:211], a[252:255], a[32:35], v[208:211]
buffer_store_dwordx2 v[122:123], v18, s[28:31], 0 offen nt
v_mul_f32 v178, v178, v24
v_mfma_f32_16x16x32_bf16 v[212:215], a[252:255], a[36:39], v[212:215]
s_add_u32 s28, s28, 7168
ds_read_b128 a[228:231], v14 offset:14336
v_mul_f32 v182, v182, v25
v_mfma_f32_16x16x32_bf16 v[212:215], a[248:251], a[20:23], v[212:215]
s_addc_u32 s29, s29, 0
v_mul_f32 v186, v186, v26
v_mul_f32 v190, v190, v27
v_mfma_f32_16x16x32_bf16 v[216:219], a[248:251], a[24:27], v[216:219]
v_cvt_pk_bf16_f32 v124, v178, v182
v_cvt_pk_bf16_f32 v125, v186, v190
v_mfma_f32_16x16x32_bf16 v[216:219], a[252:255], a[40:43], v[216:219]
buffer_store_dwordx2 v[124:125], v18, s[28:31], 0 offen nt
v_mul_f32 v179, v179, v24
v_mfma_f32_16x16x32_bf16 v[220:223], a[252:255], a[44:47], v[220:223]
s_add_u32 s28, s28, 7168
v_mul_f32 v183, v183, v25
v_mul_f32 v187, v187, v26
v_mfma_f32_16x16x32_bf16 v[220:223], a[248:251], a[28:31], v[220:223]
s_waitcnt lgkmcnt(0)
v_mul_f32 v191, v191, v27
v_cvt_pk_bf16_f32 v126, v179, v183
v_mfma_f32_16x16x32_bf16 v[240:243], a[224:227], a[112:115], v[240:243]
s_addc_u32 s29, s29, 0
ds_read_b128 a[232:235], v15 offset:63488
v_cvt_pk_bf16_f32 v127, v187, v191
v_mfma_f32_16x16x32_bf16 v[240:243], a[228:231], a[128:131], v[240:243]
buffer_store_dwordx2 v[126:127], v18, s[28:31], 0 offen nt
v_mul_f32 v192, v192, v24
v_mfma_f32_16x16x32_bf16 v[244:247], a[228:231], a[132:135], v[244:247]
s_add_u32 s28, s28, 93184
v_mul_f32 v196, v196, v25
v_mul_f32 v200, v200, v26
v_mfma_f32_16x16x32_bf16 v[244:247], a[224:227], a[116:119], v[244:247]
s_addc_u32 s29, s29, 0
v_mul_f32 v204, v204, v27
v_cvt_pk_bf16_f32 v120, v192, v196
v_mfma_f32_16x16x32_bf16 v[248:251], a[224:227], a[120:123], v[248:251]
ds_read_b128 a[236:239], v14 offset:57344
v_cvt_pk_bf16_f32 v121, v200, v204
v_mfma_f32_16x16x32_bf16 v[248:251], a[228:231], a[136:139], v[248:251]
buffer_store_dwordx2 v[120:121], v18, s[28:31], 0 offen nt
v_mul_f32 v193, v193, v24
v_mfma_f32_16x16x32_bf16 v[252:255], a[228:231], a[140:143], v[252:255]
s_add_u32 s28, s28, 7168
ds_read_b128 a[240:243], v15 offset:57344
v_mul_f32 v197, v197, v25
v_mfma_f32_16x16x32_bf16 v[252:255], a[224:227], a[124:127], v[252:255]
s_waitcnt lgkmcnt(2)
v_mul_f32 v201, v201, v26
v_mul_f32 v205, v205, v27
v_mfma_f32_16x16x32_bf16 v[208:211], a[232:235], a[48:51], v[208:211]
s_addc_u32 s29, s29, 0
v_cvt_pk_bf16_f32 v122, v193, v197
v_cvt_pk_bf16_f32 v123, v201, v205
v_mfma_f32_16x16x32_bf16 v[212:215], a[232:235], a[52:55], v[212:215]
buffer_store_dwordx2 v[122:123], v18, s[28:31], 0 offen nt
v_mul_f32 v194, v194, v24
v_mfma_f32_16x16x32_bf16 v[216:219], a[232:235], a[56:59], v[216:219]
s_add_u32 s28, s28, 7168
v_mul_f32 v198, v198, v25
v_mul_f32 v202, v202, v26
v_mfma_f32_16x16x32_bf16 v[220:223], a[232:235], a[60:63], v[220:223]
s_waitcnt lgkmcnt(0)
v_mul_f32 v206, v206, v27
v_cvt_pk_bf16_f32 v124, v194, v198
v_mfma_f32_16x16x32_bf16 v[224:227], a[236:239], a[0:3], v[224:227]
s_addc_u32 s29, s29, 0
ds_read_b128 a[244:247], v16 offset:0
v_cvt_pk_bf16_f32 v125, v202, v206
v_mfma_f32_16x16x32_bf16 v[224:227], a[240:243], a[16:19], v[224:227]
buffer_store_dwordx2 v[124:125], v18, s[28:31], 0 offen nt
v_mul_f32 v195, v195, v24
v_mfma_f32_16x16x32_bf16 v[228:231], a[240:243], a[20:23], v[228:231]
s_add_u32 s28, s28, 7168
ds_read_b128 a[248:251], v17 offset:0
v_mul_f32 v199, v199, v25
v_mfma_f32_16x16x32_bf16 v[228:231], a[236:239], a[4:7], v[228:231]
s_addc_u32 s29, s29, 0
v_mul_f32 v203, v203, v26
v_mul_f32 v207, v207, v27
v_mfma_f32_16x16x32_bf16 v[232:235], a[236:239], a[8:11], v[232:235]
v_cvt_pk_bf16_f32 v126, v195, v199
v_cvt_pk_bf16_f32 v127, v203, v207
v_mfma_f32_16x16x32_bf16 v[232:235], a[240:243], a[24:27], v[232:235]
buffer_store_dwordx2 v[126:127], v18, s[28:31], 0 offen nt
v_mfma_f32_16x16x32_bf16 v[236:239], a[240:243], a[28:31], v[236:239]
v_mfma_f32_16x16x32_bf16 v[236:239], a[236:239], a[12:15], v[236:239]
s_waitcnt lgkmcnt(0)
v_mul_f32 v208, v208, v24
v_mul_f32 v212, v212, v25
v_mfma_f32_16x16x32_bf16 v[224:227], a[244:247], a[32:35], v[224:227]
s_add_u32 s28, s28, 93184
ds_read_b128 a[252:255], v15 offset:14336
v_mul_f32 v216, v216, v26
v_mfma_f32_16x16x32_bf16 v[224:227], a[248:251], a[48:51], v[224:227]
s_addc_u32 s29, s29, 0
v_mul_f32 v220, v220, v27
v_cvt_pk_bf16_f32 v120, v208, v212
v_mfma_f32_16x16x32_bf16 v[228:231], a[248:251], a[52:55], v[228:231]
ds_read_b128 a[224:227], v14 offset:43008
v_cvt_pk_bf16_f32 v121, v216, v220
v_mfma_f32_16x16x32_bf16 v[228:231], a[244:247], a[36:39], v[228:231]
buffer_store_dwordx2 v[120:121], v18, s[28:31], 0 offen nt
v_mul_f32 v209, v209, v24
v_mfma_f32_16x16x32_bf16 v[232:235], a[244:247], a[40:43], v[232:235]
s_add_u32 s28, s28, 7168
v_mul_f32 v213, v213, v25
v_mul_f32 v217, v217, v26
v_mfma_f32_16x16x32_bf16 v[232:235], a[248:251], a[56:59], v[232:235]
s_addc_u32 s29, s29, 0
v_mul_f32 v221, v221, v27
v_cvt_pk_bf16_f32 v122, v209, v213
v_mfma_f32_16x16x32_bf16 v[236:239], a[248:251], a[60:63], v[236:239]
v_cvt_pk_bf16_f32 v123, v217, v221
v_mfma_f32_16x16x32_bf16 v[236:239], a[244:247], a[44:47], v[236:239]
s_waitcnt lgkmcnt(0)
v_mfma_f32_16x16x32_bf16 v[240:243], a[252:255], a[144:147], v[240:243]
ds_read_b128 a[228:231], v15 offset:43008
v_mfma_f32_16x16x32_bf16 v[240:243], a[224:227], a[160:163], v[240:243]
buffer_store_dwordx2 v[122:123], v18, s[28:31], 0 offen nt
v_mul_f32 v210, v210, v24
v_mfma_f32_16x16x32_bf16 v[244:247], a[224:227], a[164:167], v[244:247]
s_add_u32 s28, s28, 7168
ds_read_b128 a[232:235], v14 offset:38912
v_mul_f32 v214, v214, v25
v_mfma_f32_16x16x32_bf16 v[244:247], a[252:255], a[148:151], v[244:247]
s_addc_u32 s29, s29, 0
v_mul_f32 v218, v218, v26
v_mul_f32 v222, v222, v27
v_mfma_f32_16x16x32_bf16 v[248:251], a[252:255], a[152:155], v[248:251]
v_cvt_pk_bf16_f32 v124, v210, v214
v_cvt_pk_bf16_f32 v125, v218, v222
v_mfma_f32_16x16x32_bf16 v[248:251], a[224:227], a[168:171], v[248:251]
buffer_store_dwordx2 v[124:125], v18, s[28:31], 0 offen nt
v_mul_f32 v211, v211, v24
v_mfma_f32_16x16x32_bf16 v[252:255], a[224:227], a[172:175], v[252:255]
s_add_u32 s28, s28, 7168
v_mul_f32 v215, v215, v25
v_mul_f32 v219, v219, v26
v_mfma_f32_16x16x32_bf16 v[252:255], a[252:255], a[156:159], v[252:255]
s_waitcnt lgkmcnt(0)
v_mul_f32 v223, v223, v27
v_cvt_pk_bf16_f32 v126, v211, v215
v_mfma_f32_16x16x32_bf16 v[240:243], a[228:231], a[176:179], v[240:243]
s_addc_u32 s29, s29, 0
ds_read_b128 a[236:239], v15 offset:38912
v_cvt_pk_bf16_f32 v127, v219, v223
v_mfma_f32_16x16x32_bf16 v[240:243], a[232:235], a[192:195], v[240:243]
buffer_store_dwordx2 v[126:127], v18, s[28:31], 0 offen nt
v_mul_f32 v224, v224, v24
v_mfma_f32_16x16x32_bf16 v[244:247], a[232:235], a[196:199], v[244:247]
s_add_u32 s28, s28, 93184
ds_read_b128 a[240:243], v14 offset:59392
v_mul_f32 v228, v228, v25
v_mfma_f32_16x16x32_bf16 v[244:247], a[228:231], a[180:183], v[244:247]
s_addc_u32 s29, s29, 0
v_mul_f32 v232, v232, v26
v_mul_f32 v236, v236, v27
v_mfma_f32_16x16x32_bf16 v[248:251], a[228:231], a[184:187], v[248:251]
v_cvt_pk_bf16_f32 v120, v224, v228
v_cvt_pk_bf16_f32 v121, v232, v236
v_mfma_f32_16x16x32_bf16 v[248:251], a[232:235], a[200:203], v[248:251]
buffer_store_dwordx2 v[120:121], v18, s[28:31], 0 offen nt
v_mul_f32 v225, v225, v24
v_mfma_f32_16x16x32_bf16 v[252:255], a[232:235], a[204:207], v[252:255]
s_add_u32 s28, s28, 7168
v_mul_f32 v229, v229, v25
v_mul_f32 v233, v233, v26
v_mfma_f32_16x16x32_bf16 v[252:255], a[228:231], a[188:191], v[252:255]
s_waitcnt lgkmcnt(0)
v_mul_f32 v237, v237, v27
v_cvt_pk_bf16_f32 v122, v225, v229
v_mfma_f32_16x16x32_bf16 v[240:243], a[236:239], a[208:211], v[240:243]
s_addc_u32 s29, s29, 0
ds_read_b128 a[244:247], v15 offset:59392
v_cvt_pk_bf16_f32 v123, v233, v237
v_mfma_f32_16x16x32_bf16 v[240:243], a[240:243], a[0:3], v[240:243]
buffer_store_dwordx2 v[122:123], v18, s[28:31], 0 offen nt
v_mul_f32 v226, v226, v24
v_mfma_f32_16x16x32_bf16 v[244:247], a[240:243], a[4:7], v[244:247]
s_add_u32 s28, s28, 7168
ds_read_b128 a[248:251], v16 offset:2048
v_mul_f32 v230, v230, v25
v_mfma_f32_16x16x32_bf16 v[244:247], a[236:239], a[212:215], v[244:247]
s_addc_u32 s29, s29, 0
v_mul_f32 v234, v234, v26
v_mul_f32 v238, v238, v27
v_mfma_f32_16x16x32_bf16 v[248:251], a[236:239], a[216:219], v[248:251]
v_cvt_pk_bf16_f32 v124, v226, v230
v_cvt_pk_bf16_f32 v125, v234, v238
v_mfma_f32_16x16x32_bf16 v[248:251], a[240:243], a[8:11], v[248:251]
buffer_store_dwordx2 v[124:125], v18, s[28:31], 0 offen nt
v_mul_f32 v227, v227, v24
v_mfma_f32_16x16x32_bf16 v[252:255], a[240:243], a[12:15], v[252:255]
s_add_u32 s28, s28, 7168
v_mul_f32 v231, v231, v25
v_mul_f32 v235, v235, v26
v_mfma_f32_16x16x32_bf16 v[252:255], a[236:239], a[220:223], v[252:255]
s_waitcnt lgkmcnt(0)
v_mul_f32 v239, v239, v27
v_cvt_pk_bf16_f32 v126, v227, v231
v_mfma_f32_16x16x32_bf16 v[240:243], a[244:247], a[16:19], v[240:243]
s_addc_u32 s29, s29, 0
ds_read_b128 a[252:255], v17 offset:2048
v_cvt_pk_bf16_f32 v127, v235, v239
v_mfma_f32_16x16x32_bf16 v[240:243], a[248:251], a[32:35], v[240:243]
buffer_store_dwordx2 v[126:127], v18, s[28:31], 0 offen nt
v_mfma_f32_16x16x32_bf16 v[244:247], a[248:251], a[36:39], v[244:247]
v_mfma_f32_16x16x32_bf16 v[244:247], a[244:247], a[20:23], v[244:247]
v_mfma_f32_16x16x32_bf16 v[248:251], a[244:247], a[24:27], v[248:251]
v_mfma_f32_16x16x32_bf16 v[248:251], a[248:251], a[40:43], v[248:251]
v_mfma_f32_16x16x32_bf16 v[252:255], a[248:251], a[44:47], v[252:255]
v_mfma_f32_16x16x32_bf16 v[252:255], a[244:247], a[28:31], v[252:255]
s_waitcnt lgkmcnt(0)
v_mfma_f32_16x16x32_bf16 v[240:243], a[252:255], a[48:51], v[240:243]
v_mfma_f32_16x16x32_bf16 v[244:247], a[252:255], a[52:55], v[244:247]
v_mfma_f32_16x16x32_bf16 v[248:251], a[252:255], a[56:59], v[248:251]
v_mfma_f32_16x16x32_bf16 v[252:255], a[252:255], a[60:63], v[252:255]
s_nop 7
v_pk_mul_f32 v[240:241], v[240:241], v[24:25] op_sel:[0,0] op_sel_hi:[1,0]
v_pk_mul_f32 v[244:245], v[244:245], v[24:25] op_sel:[0,1] op_sel_hi:[1,1]
v_pk_mul_f32 v[248:249], v[248:249], v[26:27] op_sel:[0,0] op_sel_hi:[1,0]
v_pk_mul_f32 v[252:253], v[252:253], v[26:27] op_sel:[0,1] op_sel_hi:[1,1]
v_cvt_pk_bf16_f32 v120, v240, v244
v_cvt_pk_bf16_f32 v121, v248, v252
s_add_u32 s28, s28, 93184
s_addc_u32 s29, s29, 0
buffer_store_dwordx2 v[120:121], v18, s[28:31], 0 offen nt
v_cvt_pk_bf16_f32 v122, v241, v245
v_cvt_pk_bf16_f32 v123, v249, v253
s_add_u32 s28, s28, 7168
s_addc_u32 s29, s29, 0
buffer_store_dwordx2 v[122:123], v18, s[28:31], 0 offen nt
v_pk_mul_f32 v[242:243], v[242:243], v[24:25] op_sel:[0,0] op_sel_hi:[1,0]
v_pk_mul_f32 v[246:247], v[246:247], v[24:25] op_sel:[0,1] op_sel_hi:[1,1]
v_pk_mul_f32 v[250:251], v[250:251], v[26:27] op_sel:[0,0] op_sel_hi:[1,0]
v_pk_mul_f32 v[254:255], v[254:255], v[26:27] op_sel:[0,1] op_sel_hi:[1,1]
v_cvt_pk_bf16_f32 v124, v242, v246
v_cvt_pk_bf16_f32 v125, v250, v254
s_add_u32 s28, s28, 7168
s_addc_u32 s29, s29, 0
buffer_store_dwordx2 v[124:125], v18, s[28:31], 0 offen nt
v_cvt_pk_bf16_f32 v126, v243, v247
v_cvt_pk_bf16_f32 v127, v251, v255
s_add_u32 s28, s28, 7168
s_addc_u32 s29, s29, 0
buffer_store_dwordx2 v[126:127], v18, s[28:31], 0 offen nt
s_endpgm
L_NOTAG:
buffer_load_dwordx2 v[22:23], off, s[80:83], 0 sc1
s_waitcnt vmcnt(0)
v_readfirstlane_b32 s88, v22
v_readfirstlane_b32 s89, v23
s_sub_u32 s90, s90, 1
s_nop 0
s_cmp_eq_u64 s[88:89], 0
s_cbranch_scc0 L_TAGOK
s_cmp_gt_i32 s90, 0
s_cbranch_scc1 L_NOTAG
s_mov_b32 s26, 0
s_mov_b32 s78, 0
s_mov_b64 s[88:89], 1
s_branch L_TAGOK
.p2align 6
L_PADS:
s_cbranch_vccnz L_PADRET
L_TRY:
s_waitcnt vmcnt(0)
v_cmp_ne_u64 s[50:51], s[88:89], v[122:123]
v_cmp_ne_u64 s[44:45], s[88:89], v[126:127]
s_sub_u32 s90, s90, 1
s_nop 0
s_or_b64 s[50:51], s[44:45], s[50:51]
s_cbranch_scc0 L_WRET
s_cmp_gt_i32 s90, 0
s_cbranch_scc0 L_SELF
L_WRET:
s_setpc_b64 s[100:101]
L_SLOW2:
s_lshr_b32 s91, s41, 6
s_add_u32 s91, s91, 0
s_lshl_b32 s47, s91, 11
buffer_load_dwordx4 v[120:123], v13, s[24:27], s47 offen offset:0 sc1
buffer_load_dwordx4 v[124:127], v13, s[24:27], s47 offen offset:1024 sc1
s_lshr_b32 s47, s41, 6
s_add_u32 s47, s47, 1
s_lshl_b32 s47, s47, 11
buffer_load_dwordx4 v[40:43], v13, s[24:27], s47 offen offset:0 sc1
buffer_load_dwordx4 v[44:47], v13, s[24:27], s47 offen offset:1024 sc1
s_lshr_b32 s47, s42, 6
s_add_u32 s47, s47, 0
s_lshl_b32 s47, s47, 11
buffer_load_dwordx4 v[48:51], v13, s[24:27], s47 offen offset:0 sc1
buffer_load_dwordx4 v[52:55], v13, s[24:27], s47 offen offset:1024 sc1
s_call_b64 s[100:101], L_TRY
s_cbranch_scc1 L_SLOW2
v_mov_b64 v[32:33], v[120:121]
v_mov_b64 v[36:37], v[124:125]
s_branch L_BACK2
L_SLOW3:
s_lshr_b32 s91, s41, 6
s_add_u32 s91, s91, 1
s_lshl_b32 s47, s91, 11
buffer_load_dwordx4 v[120:123], v13, s[24:27], s47 offen offset:0 sc1
buffer_load_dwordx4 v[124:127], v13, s[24:27], s47 offen offset:1024 sc1
s_lshr_b32 s47, s42, 6
s_add_u32 s47, s47, 0
s_lshl_b32 s47, s47, 11
buffer_load_dwordx4 v[48:51], v13, s[24:27], s47 offen offset:0 sc1
buffer_load_dwordx4 v[52:55], v13, s[24:27], s47 offen offset:1024 sc1
s_lshr_b32 s47, s42, 6
s_add_u32 s47, s47, 1
s_lshl_b32 s47, s47, 11
buffer_load_dwordx4 v[96:99], v13, s[24:27], s47 offen offset:0 sc1
buffer_load_dwordx4 v[100:103], v13, s[24:27], s47 offen offset:1024 sc1
s_call_b64 s[100:101], L_TRY
s_cbranch_scc1 L_SLOW3
v_mov_b64 v[40:41], v[120:121]
v_mov_b64 v[44:45], v[124:125]
s_branch L_BACK3
L_SLOW4:
s_lshr_b32 s91, s42, 6
s_add_u32 s91, s91, 0
s_lshl_b32 s47, s91, 11
buffer_load_dwordx4 v[120:123], v13, s[24:27], s47 offen offset:0 sc1
buffer_load_dwordx4 v[124:127], v13, s[24:27], s47 offen offset:1024 sc1
s_lshr_b32 s47, s42, 6
s_add_u32 s47, s47, 1
s_lshl_b32 s47, s47, 11
buffer_load_dwordx4 v[96:99], v13, s[24:27], s47 offen offset:0 sc1
buffer_load_dwordx4 v[100:103], v13, s[24:27], s47 offen offset:1024 sc1
s_lshr_b32 s47, s43, 6
s_add_u32 s47, s47, 0
s_lshl_b32 s47, s47, 11
buffer_load_dwordx4 v[80:83], v13, s[24:27], s47 offen offset:0 sc1
buffer_load_dwordx4 v[84:87], v13, s[24:27], s47 offen offset:1024 sc1
s_call_b64 s[100:101], L_TRY
s_cbranch_scc1 L_SLOW4
v_mov_b64 v[48:49], v[120:121]
v_mov_b64 v[52:53], v[124:125]
s_branch L_BACK4
L_SLOW5:
s_lshr_b32 s91, s42, 6
s_add_u32 s91, s91, 1
s_lshl_b32 s47, s91, 11
buffer_load_dwordx4 v[120:123], v13, s[24:27], s47 offen offset:0 sc1
buffer_load_dwordx4 v[124:127], v13, s[24:27], s47 offen offset:1024 sc1
s_lshr_b32 s47, s43, 6
s_add_u32 s47, s47, 0
s_lshl_b32 s47, s47, 11
buffer_load_dwordx4 v[80:83], v13, s[24:27], s47 offen offset:0 sc1
buffer_load_dwordx4 v[84:87], v13, s[24:27], s47 offen offset:1024 sc1
s_lshr_b32 s47, s43, 6
s_add_u32 s47, s47, 1
s_lshl_b32 s47, s47, 11
buffer_load_dwordx4 v[88:91], v13, s[24:27], s47 offen offset:0 sc1
buffer_load_dwordx4 v[92:95], v13, s[24:27], s47 offen offset:1024 sc1
s_call_b64 s[100:101], L_TRY
s_cbranch_scc1 L_SLOW5
v_mov_b64 v[96:97], v[120:121]
v_mov_b64 v[100:101], v[124:125]
s_branch L_BACK5
L_SLOW6:
s_lshr_b32 s91, s43, 6
s_add_u32 s91, s91, 0
s_lshl_b32 s47, s91, 11
buffer_load_dwordx4 v[120:123], v13, s[24:27], s47 offen offset:0 sc1
buffer_load_dwordx4 v[124:127], v13, s[24:27], s47 offen offset:1024 sc1
s_lshr_b32 s47, s43, 6
s_add_u32 s47, s47, 1
s_lshl_b32 s47, s47, 11
buffer_load_dwordx4 v[88:91], v13, s[24:27], s47 offen offset:0 sc1
buffer_load_dwordx4 v[92:95], v13, s[24:27], s47 offen offset:1024 sc1
s_movk_i32 s47, 8
s_lshl_b32 s47, s47, 11
buffer_load_dwordx4 v[32:35], v13, s[24:27], s47 offen offset:0 sc1
buffer_load_dwordx4 v[36:39], v13, s[24:27], s47 offen offset:1024 sc1
s_call_b64 s[100:101], L_TRY
s_cbranch_scc1 L_SLOW6
v_mov_b64 v[80:81], v[120:121]
v_mov_b64 v[84:85], v[124:125]
s_branch L_BACK6
L_SLOW7:
s_lshr_b32 s91, s43, 6
s_add_u32 s91, s91, 1
s_lshl_b32 s47, s91, 11
buffer_load_dwordx4 v[120:123], v13, s[24:27], s47 offen offset:0 sc1
buffer_load_dwordx4 v[124:127], v13, s[24:27], s47 offen offset:1024 sc1
s_movk_i32 s47, 8
s_lshl_b32 s47, s47, 11
buffer_load_dwordx4 v[32:35], v13, s[24:27], s47 offen offset:0 sc1
buffer_load_dwordx4 v[36:39], v13, s[24:27], s47 offen offset:1024 sc1
s_movk_i32 s47, 9
s_lshl_b32 s47, s47, 11
buffer_load_dwordx4 v[40:43], v13, s[24:27], s47 offen offset:0 sc1
buffer_load_dwordx4 v[44:47], v13, s[24:27], s47 offen offset:1024 sc1
s_call_b64 s[100:101], L_TRY
s_cbranch_scc1 L_SLOW7
v_mov_b64 v[88:89], v[120:121]
v_mov_b64 v[92:93], v[124:125]
s_branch L_BACK7
L_SLOW8:
s_movk_i32 s91, 8
s_lshl_b32 s47, s91, 11
buffer_load_dwordx4 v[120:123], v13, s[24:27], s47 offen offset:0 sc1
buffer_load_dwordx4 v[124:127], v13, s[24:27], s47 offen offset:1024 sc1
s_movk_i32 s47, 9
s_lshl_b32 s47, s47, 11
buffer_load_dwordx4 v[40:43], v13, s[24:27], s47 offen offset:0 sc1
buffer_load_dwordx4 v[44:47], v13, s[24:27], s47 offen offset:1024 sc1
s_movk_i32 s47, 10
s_lshl_b32 s47, s47, 11
buffer_load_dwordx4 v[48:51], v13, s[24:27], s47 offen offset:0 sc1
buffer_load_dwordx4 v[52:55], v13, s[24:27], s47 offen offset:1024 sc1
s_call_b64 s[100:101], L_TRY
s_cbranch_scc1 L_SLOW8
v_mov_b64 v[32:33], v[120:121]
v_mov_b64 v[36:37], v[124:125]
s_branch L_BACK8
L_SLOW9:
s_movk_i32 s91, 9
s_lshl_b32 s47, s91, 11
buffer_load_dwordx4 v[120:123], v13, s[24:27], s47 offen offset:0 sc1
buffer_load_dwordx4 v[124:127], v13, s[24:27], s47 offen offset:1024 sc1
s_movk_i32 s47, 10
s_lshl_b32 s47, s47, 11
buffer_load_dwordx4 v[48:51], v13, s[24:27], s47 offen offset:0 sc1
buffer_load_dwordx4 v[52:55], v13, s[24:27], s47 offen offset:1024 sc1
s_movk_i32 s47, 11
s_lshl_b32 s47, s47, 11
buffer_load_dwordx4 v[96:99], v13, s[24:27], s47 offen offset:0 sc1
buffer_load_dwordx4 v[100:103], v13, s[24:27], s47 offen offset:1024 sc1
s_call_b64 s[100:101], L_TRY
s_cbranch_scc1 L_SLOW9
v_mov_b64 v[40:41], v[120:121]
v_mov_b64 v[44:45], v[124:125]
s_branch L_BACK9
L_SLOW10:
s_movk_i32 s91, 10
s_lshl_b32 s47, s91, 11
buffer_load_dwordx4 v[120:123], v13, s[24:27], s47 offen offset:0 sc1
buffer_load_dwordx4 v[124:127], v13, s[24:27], s47 offen offset:1024 sc1
s_movk_i32 s47, 11
s_lshl_b32 s47, s47, 11
buffer_load_dwordx4 v[96:99], v13, s[24:27], s47 offen offset:0 sc1
buffer_load_dwordx4 v[100:103], v13, s[24:27], s47 offen offset:1024 sc1
s_movk_i32 s47, 12
s_lshl_b32 s47, s47, 11
buffer_load_dwordx4 v[80:83], v13, s[24:27], s47 offen offset:0 sc1
buffer_load_dwordx4 v[84:87], v13, s[24:27], s47 offen offset:1024 sc1
s_call_b64 s[100:101], L_TRY
s_cbranch_scc1 L_SLOW10
v_mov_b64 v[48:49], v[120:121]
v_mov_b64 v[52:53], v[124:125]
s_branch L_BACK10
L_SLOW11:
s_movk_i32 s91, 11
s_lshl_b32 s47, s91, 11
buffer_load_dwordx4 v[120:123], v13, s[24:27], s47 offen offset:0 sc1
buffer_load_dwordx4 v[124:127], v13, s[24:27], s47 offen offset:1024 sc1
s_movk_i32 s47, 12
s_lshl_b32 s47, s47, 11
buffer_load_dwordx4 v[80:83], v13, s[24:27], s47 offen offset:0 sc1
buffer_load_dwordx4 v[84:87], v13, s[24:27], s47 offen offset:1024 sc1
s_movk_i32 s47, 13
s_lshl_b32 s47, s47, 11
buffer_load_dwordx4 v[88:91], v13, s[24:27], s47 offen offset:0 sc1
buffer_load_dwordx4 v[92:95], v13, s[24:27], s47 offen offset:1024 sc1
s_call_b64 s[100:101], L_TRY
s_cbranch_scc1 L_SLOW11
v_mov_b64 v[96:97], v[120:121]
v_mov_b64 v[100:101], v[124:125]
s_branch L_BACK11
L_SLOW12:
s_movk_i32 s91, 12
s_lshl_b32 s47, s91, 11
buffer_load_dwordx4 v[120:123], v13, s[24:27], s47 offen offset:0 sc1
buffer_load_dwordx4 v[124:127], v13, s[24:27], s47 offen offset:1024 sc1
s_movk_i32 s47, 13
s_lshl_b32 s47, s47, 11
buffer_load_dwordx4 v[88:91], v13, s[24:27], s47 offen offset:0 sc1
buffer_load_dwordx4 v[92:95], v13, s[24:27], s47 offen offset:1024 sc1
s_movk_i32 s47, 14
s_lshl_b32 s47, s47, 11
buffer_load_dwordx4 v[32:35], v13, s[24:27], s47 offen offset:0 sc1
buffer_load_dwordx4 v[36:39], v13, s[24:27], s47 offen offset:1024 sc1
s_call_b64 s[100:101], L_TRY
s_cbranch_scc1 L_SLOW12
v_mov_b64 v[80:81], v[120:121]
v_mov_b64 v[84:85], v[124:125]
s_branch L_BACK12
L_SLOW13:
s_movk_i32 s91, 13
s_lshl_b32 s47, s91, 11
buffer_load_dwordx4 v[120:123], v13, s[24:27], s47 offen offset:0 sc1
buffer_load_dwordx4 v[124:127], v13, s[24:27], s47 offen offset:1024 sc1
s_movk_i32 s47, 14
s_lshl_b32 s47, s47, 11
buffer_load_dwordx4 v[32:35], v13, s[24:27], s47 offen offset:0 sc1
buffer_load_dwordx4 v[36:39], v13, s[24:27], s47 offen offset:1024 sc1
s_movk_i32 s47, 15
s_lshl_b32 s47, s47, 11
buffer_load_dwordx4 v[40:43], v13, s[24:27], s47 offen offset:0 sc1
buffer_load_dwordx4 v[44:47], v13, s[24:27], s47 offen offset:1024 sc1
s_call_b64 s[100:101], L_TRY
s_cbranch_scc1 L_SLOW13
v_mov_b64 v[88:89], v[120:121]
v_mov_b64 v[92:93], v[124:125]
s_branch L_BACK13
L_SLOW14:
s_movk_i32 s91, 14
s_lshl_b32 s47, s91, 11
buffer_load_dwordx4 v[120:123], v13, s[24:27], s47 offen offset:0 sc1
buffer_load_dwordx4 v[124:127], v13, s[24:27], s47 offen offset:1024 sc1
s_movk_i32 s47, 15
s_lshl_b32 s47, s47, 11
buffer_load_dwordx4 v[40:43], v13, s[24:27], s47 offen offset:0 sc1
buffer_load_dwordx4 v[44:47], v13, s[24:27], s47 offen offset:1024 sc1
s_movk_i32 s47, 16
s_lshl_b32 s47, s47, 11
buffer_load_dwordx4 v[48:51], v13, s[24:27], s47 offen offset:0 sc1
buffer_load_dwordx4 v[52:55], v13, s[24:27], s47 offen offset:1024 sc1
s_call_b64 s[100:101], L_TRY
s_cbranch_scc1 L_SLOW14
v_mov_b64 v[32:33], v[120:121]
v_mov_b64 v[36:37], v[124:125]
s_branch L_BACK14
L_SLOW15:
s_movk_i32 s91, 15
s_lshl_b32 s47, s91, 11
buffer_load_dwordx4 v[120:123], v13, s[24:27], s47 offen offset:0 sc1
buffer_load_dwordx4 v[124:127], v13, s[24:27], s47 offen offset:1024 sc1
s_movk_i32 s47, 16
s_lshl_b32 s47, s47, 11
buffer_load_dwordx4 v[48:51], v13, s[24:27], s47 offen offset:0 sc1
buffer_load_dwordx4 v[52:55], v13, s[24:27], s47 offen offset:1024 sc1
s_movk_i32 s47, 17
s_lshl_b32 s47, s47, 11
buffer_load_dwordx4 v[96:99], v13, s[24:27], s47 offen offset:0 sc1
buffer_load_dwordx4 v[100:103], v13, s[24:27], s47 offen offset:1024 sc1
s_call_b64 s[100:101], L_TRY
s_cbranch_scc1 L_SLOW15
v_mov_b64 v[40:41], v[120:121]
v_mov_b64 v[44:45], v[124:125]
s_branch L_BACK15
L_SLOW16:
s_movk_i32 s91, 16
s_lshl_b32 s47, s91, 11
buffer_load_dwordx4 v[120:123], v13, s[24:27], s47 offen offset:0 sc1
buffer_load_dwordx4 v[124:127], v13, s[24:27], s47 offen offset:1024 sc1
s_movk_i32 s47, 17
s_lshl_b32 s47, s47, 11
buffer_load_dwordx4 v[96:99], v13, s[24:27], s47 offen offset:0 sc1
buffer_load_dwordx4 v[100:103], v13, s[24:27], s47 offen offset:1024 sc1
s_movk_i32 s47, 18
s_lshl_b32 s47, s47, 11
buffer_load_dwordx4 v[80:83], v13, s[24:27], s47 offen offset:0 sc1
buffer_load_dwordx4 v[84:87], v13, s[24:27], s47 offen offset:1024 sc1
s_call_b64 s[100:101], L_TRY
s_cbranch_scc1 L_SLOW16
v_mov_b64 v[48:49], v[120:121]
v_mov_b64 v[52:53], v[124:125]
s_branch L_BACK16
L_SLOW17:
s_movk_i32 s91, 17
s_lshl_b32 s47, s91, 11
buffer_load_dwordx4 v[120:123], v13, s[24:27], s47 offen offset:0 sc1
buffer_load_dwordx4 v[124:127], v13, s[24:27], s47 offen offset:1024 sc1
s_movk_i32 s47, 18
s_lshl_b32 s47, s47, 11
buffer_load_dwordx4 v[80:83], v13, s[24:27], s47 offen offset:0 sc1
buffer_load_dwordx4 v[84:87], v13, s[24:27], s47 offen offset:1024 sc1
s_movk_i32 s47, 19
s_lshl_b32 s47, s47, 11
buffer_load_dwordx4 v[88:91], v13, s[24:27], s47 offen offset:0 sc1
buffer_load_dwordx4 v[92:95], v13, s[24:27], s47 offen offset:1024 sc1
s_call_b64 s[100:101], L_TRY
s_cbranch_scc1 L_SLOW17
v_mov_b64 v[96:97], v[120:121]
v_mov_b64 v[100:101], v[124:125]
s_branch L_BACK17
L_SLOW18:
s_movk_i32 s91, 18
s_lshl_b32 s47, s91, 11
buffer_load_dwordx4 v[120:123], v13, s[24:27], s47 offen offset:0 sc1
buffer_load_dwordx4 v[124:127], v13, s[24:27], s47 offen offset:1024 sc1
s_movk_i32 s47, 19
s_lshl_b32 s47, s47, 11
buffer_load_dwordx4 v[88:91], v13, s[24:27], s47 offen offset:0 sc1
buffer_load_dwordx4 v[92:95], v13, s[24:27], s47 offen offset:1024 sc1
s_movk_i32 s47, 20
s_lshl_b32 s47, s47, 11
buffer_load_dwordx4 v[32:35], v13, s[24:27], s47 offen offset:0 sc1
buffer_load_dwordx4 v[36:39], v13, s[24:27], s47 offen offset:1024 sc1
s_call_b64 s[100:101], L_TRY
s_cbranch_scc1 L_SLOW18
v_mov_b64 v[80:81], v[120:121]
v_mov_b64 v[84:85], v[124:125]
s_branch L_BACK18
L_SLOW19:
s_movk_i32 s91, 19
s_lshl_b32 s47, s91, 11
buffer_load_dwordx4 v[120:123], v13, s[24:27], s47 offen offset:0 sc1
buffer_load_dwordx4 v[124:127], v13, s[24:27], s47 offen offset:1024 sc1
s_movk_i32 s47, 20
s_lshl_b32 s47, s47, 11
buffer_load_dwordx4 v[32:35], v13, s[24:27], s47 offen offset:0 sc1
buffer_load_dwordx4 v[36:39], v13, s[24:27], s47 offen offset:1024 sc1
s_movk_i32 s47, 21
s_lshl_b32 s47, s47, 11
buffer_load_dwordx4 v[40:43], v13, s[24:27], s47 offen offset:0 sc1
buffer_load_dwordx4 v[44:47], v13, s[24:27], s47 offen offset:1024 sc1
s_call_b64 s[100:101], L_TRY
s_cbranch_scc1 L_SLOW19
v_mov_b64 v[88:89], v[120:121]
v_mov_b64 v[92:93], v[124:125]
s_branch L_BACK19
L_SLOW20:
s_movk_i32 s91, 20
s_lshl_b32 s47, s91, 11
buffer_load_dwordx4 v[120:123], v13, s[24:27], s47 offen offset:0 sc1
buffer_load_dwordx4 v[124:127], v13, s[24:27], s47 offen offset:1024 sc1
s_movk_i32 s47, 21
s_lshl_b32 s47, s47, 11
buffer_load_dwordx4 v[40:43], v13, s[24:27], s47 offen offset:0 sc1
buffer_load_dwordx4 v[44:47], v13, s[24:27], s47 offen offset:1024 sc1
s_movk_i32 s47, 22
s_lshl_b32 s47, s47, 11
buffer_load_dwordx4 v[48:51], v13, s[24:27], s47 offen offset:0 sc1
buffer_load_dwordx4 v[52:55], v13, s[24:27], s47 offen offset:1024 sc1
s_call_b64 s[100:101], L_TRY
s_cbranch_scc1 L_SLOW20
v_mov_b64 v[32:33], v[120:121]
v_mov_b64 v[36:37], v[124:125]
s_branch L_BACK20
L_SLOW21:
s_movk_i32 s91, 21
s_lshl_b32 s47, s91, 11
buffer_load_dwordx4 v[120:123], v13, s[24:27], s47 offen offset:0 sc1
buffer_load_dwordx4 v[124:127], v13, s[24:27], s47 offen offset:1024 sc1
s_movk_i32 s47, 22
s_lshl_b32 s47, s47, 11
buffer_load_dwordx4 v[48:51], v13, s[24:27], s47 offen offset:0 sc1
buffer_load_dwordx4 v[52:55], v13, s[24:27], s47 offen offset:1024 sc1
s_movk_i32 s47, 23
s_lshl_b32 s47, s47, 11
buffer_load_dwordx4 v[96:99], v13, s[24:27], s47 offen offset:0 sc1
buffer_load_dwordx4 v[100:103], v13, s[24:27], s47 offen offset:1024 sc1
s_call_b64 s[100:101], L_TRY
s_cbranch_scc1 L_SLOW21
v_mov_b64 v[40:41], v[120:121]
v_mov_b64 v[44:45], v[124:125]
s_branch L_BACK21
L_SLOW22:
s_movk_i32 s91, 22
s_lshl_b32 s47, s91, 11
buffer_load_dwordx4 v[120:123], v13, s[24:27], s47 offen offset:0 sc1
buffer_load_dwordx4 v[124:127], v13, s[24:27], s47 offen offset:1024 sc1
s_movk_i32 s47, 23
s_lshl_b32 s47, s47, 11
buffer_load_dwordx4 v[96:99], v13, s[24:27], s47 offen offset:0 sc1
buffer_load_dwordx4 v[100:103], v13, s[24:27], s47 offen offset:1024 sc1
s_movk_i32 s47, 24
s_lshl_b32 s47, s47, 11
buffer_load_dwordx4 v[80:83], v13, s[24:27], s47 offen offset:0 sc1
buffer_load_dwordx4 v[84:87], v13, s[24:27], s47 offen offset:1024 sc1
s_call_b64 s[100:101], L_TRY
s_cbranch_scc1 L_SLOW22
v_mov_b64 v[48:49], v[120:121]
v_mov_b64 v[52:53], v[124:125]
s_branch L_BACK22
L_SLOW23:
s_movk_i32 s91, 23
s_lshl_b32 s47, s91, 11
buffer_load_dwordx4 v[120:123], v13, s[24:27], s47 offen offset:0 sc1
buffer_load_dwordx4 v[124:127], v13, s[24:27], s47 offen offset:1024 sc1
s_movk_i32 s47, 24
s_lshl_b32 s47, s47, 11
buffer_load_dwordx4 v[80:83], v13, s[24:27], s47 offen offset:0 sc1
buffer_load_dwordx4 v[84:87], v13, s[24:27], s47 offen offset:1024 sc1
s_movk_i32 s47, 25
s_lshl_b32 s47, s47, 11
buffer_load_dwordx4 v[88:91], v13, s[24:27], s47 offen offset:0 sc1
buffer_load_dwordx4 v[92:95], v13, s[24:27], s47 offen offset:1024 sc1
s_call_b64 s[100:101], L_TRY
s_cbranch_scc1 L_SLOW23
v_mov_b64 v[96:97], v[120:121]
v_mov_b64 v[100:101], v[124:125]
s_branch L_BACK23
L_SLOW24:
s_movk_i32 s91, 24
s_lshl_b32 s47, s91, 11
buffer_load_dwordx4 v[120:123], v13, s[24:27], s47 offen offset:0 sc1
buffer_load_dwordx4 v[124:127], v13, s[24:27], s47 offen offset:1024 sc1
s_movk_i32 s47, 25
s_lshl_b32 s47, s47, 11
buffer_load_dwordx4 v[88:91], v13, s[24:27], s47 offen offset:0 sc1
buffer_load_dwordx4 v[92:95], v13, s[24:27], s47 offen offset:1024 sc1
s_movk_i32 s47, 26
s_lshl_b32 s47, s47, 11
buffer_load_dwordx4 v[32:35], v13, s[24:27], s47 offen offset:0 sc1
buffer_load_dwordx4 v[36:39], v13, s[24:27], s47 offen offset:1024 sc1
s_call_b64 s[100:101], L_TRY
s_cbranch_scc1 L_SLOW24
v_mov_b64 v[80:81], v[120:121]
v_mov_b64 v[84:85], v[124:125]
s_branch L_BACK24
L_SLOW25:
s_movk_i32 s91, 25
s_lshl_b32 s47, s91, 11
buffer_load_dwordx4 v[120:123], v13, s[24:27], s47 offen offset:0 sc1
buffer_load_dwordx4 v[124:127], v13, s[24:27], s47 offen offset:1024 sc1
s_movk_i32 s47, 26
s_lshl_b32 s47, s47, 11
buffer_load_dwordx4 v[32:35], v13, s[24:27], s47 offen offset:0 sc1
buffer_load_dwordx4 v[36:39], v13, s[24:27], s47 offen offset:1024 sc1
s_movk_i32 s47, 27
s_lshl_b32 s47, s47, 11
buffer_load_dwordx4 v[40:43], v13, s[24:27], s47 offen offset:0 sc1
buffer_load_dwordx4 v[44:47], v13, s[24:27], s47 offen offset:1024 sc1
s_call_b64 s[100:101], L_TRY
s_cbranch_scc1 L_SLOW25
v_mov_b64 v[88:89], v[120:121]
v_mov_b64 v[92:93], v[124:125]
s_branch L_BACK25
L_SLOW26:
s_movk_i32 s91, 26
s_lshl_b32 s47, s91, 11
buffer_load_dwordx4 v[120:123], v13, s[24:27], s47 offen offset:0 sc1
buffer_load_dwordx4 v[124:127], v13, s[24:27], s47 offen offset:1024 sc1
s_movk_i32 s47, 27
s_lshl_b32 s47, s47, 11
buffer_load_dwordx4 v[40:43], v13, s[24:27], s47 offen offset:0 sc1
buffer_load_dwordx4 v[44:47], v13, s[24:27], s47 offen offset:1024 sc1
s_movk_i32 s47, 28
s_lshl_b32 s47, s47, 11
buffer_load_dwordx4 v[48:51], v13, s[24:27], s47 offen offset:0 sc1
buffer_load_dwordx4 v[52:55], v13, s[24:27], s47 offen offset:1024 sc1
s_call_b64 s[100:101], L_TRY
s_cbranch_scc1 L_SLOW26
v_mov_b64 v[32:33], v[120:121]
v_mov_b64 v[36:37], v[124:125]
s_branch L_BACK26
L_SLOW27:
s_movk_i32 s91, 27
s_lshl_b32 s47, s91, 11
buffer_load_dwordx4 v[120:123], v13, s[24:27], s47 offen offset:0 sc1
buffer_load_dwordx4 v[124:127], v13, s[24:27], s47 offen offset:1024 sc1
s_movk_i32 s47, 28
s_lshl_b32 s47, s47, 11
buffer_load_dwordx4 v[48:51], v13, s[24:27], s47 offen offset:0 sc1
buffer_load_dwordx4 v[52:55], v13, s[24:27], s47 offen offset:1024 sc1
s_movk_i32 s47, 29
s_lshl_b32 s47, s47, 11
buffer_load_dwordx4 v[96:99], v13, s[24:27], s47 offen offset:0 sc1
buffer_load_dwordx4 v[100:103], v13, s[24:27], s47 offen offset:1024 sc1
s_call_b64 s[100:101], L_TRY
s_cbranch_scc1 L_SLOW27
v_mov_b64 v[40:41], v[120:121]
v_mov_b64 v[44:45], v[124:125]
s_branch L_BACK27
L_SLOW28:
s_movk_i32 s91, 28
s_lshl_b32 s47, s91, 11
buffer_load_dwordx4 v[120:123], v13, s[24:27], s47 offen offset:0 sc1
buffer_load_dwordx4 v[124:127], v13, s[24:27], s47 offen offset:1024 sc1
s_movk_i32 s47, 29
s_lshl_b32 s47, s47, 11
buffer_load_dwordx4 v[96:99], v13, s[24:27], s47 offen offset:0 sc1
buffer_load_dwordx4 v[100:103], v13, s[24:27], s47 offen offset:1024 sc1
s_movk_i32 s47, 30
s_lshl_b32 s47, s47, 11
buffer_load_dwordx4 v[80:83], v13, s[24:27], s47 offen offset:0 sc1
buffer_load_dwordx4 v[84:87], v13, s[24:27], s47 offen offset:1024 sc1
s_call_b64 s[100:101], L_TRY
s_cbranch_scc1 L_SLOW28
v_mov_b64 v[48:49], v[120:121]
v_mov_b64 v[52:53], v[124:125]
s_branch L_BACK28
L_SLOW29:
s_movk_i32 s91, 29
s_lshl_b32 s47, s91, 11
buffer_load_dwordx4 v[120:123], v13, s[24:27], s47 offen offset:0 sc1
buffer_load_dwordx4 v[124:127], v13, s[24:27], s47 offen offset:1024 sc1
s_movk_i32 s47, 30
s_lshl_b32 s47, s47, 11
buffer_load_dwordx4 v[80:83], v13, s[24:27], s47 offen offset:0 sc1
buffer_load_dwordx4 v[84:87], v13, s[24:27], s47 offen offset:1024 sc1
s_movk_i32 s47, 31
s_lshl_b32 s47, s47, 11
buffer_load_dwordx4 v[88:91], v13, s[24:27], s47 offen offset:0 sc1
buffer_load_dwordx4 v[92:95], v13, s[24:27], s47 offen offset:1024 sc1
s_call_b64 s[100:101], L_TRY
s_cbranch_scc1 L_SLOW29
v_mov_b64 v[96:97], v[120:121]
v_mov_b64 v[100:101], v[124:125]
s_branch L_BACK29
L_SLOW30:
s_movk_i32 s91, 30
s_lshl_b32 s47, s91, 11
buffer_load_dwordx4 v[120:123], v13, s[24:27], s47 offen offset:0 sc1
buffer_load_dwordx4 v[124:127], v13, s[24:27], s47 offen offset:1024 sc1
s_movk_i32 s47, 31
s_lshl_b32 s47, s47, 11
buffer_load_dwordx4 v[88:91], v13, s[24:27], s47 offen offset:0 sc1
buffer_load_dwordx4 v[92:95], v13, s[24:27], s47 offen offset:1024 sc1
s_call_b64 s[100:101], L_TRY
s_cbranch_scc1 L_SLOW30
v_mov_b64 v[80:81], v[120:121]
v_mov_b64 v[84:85], v[124:125]
s_branch L_BACK30
L_SLOW31:
s_movk_i32 s91, 31
s_lshl_b32 s47, s91, 11
buffer_load_dwordx4 v[120:123], v13, s[24:27], s47 offen offset:0 sc1
buffer_load_dwordx4 v[124:127], v13, s[24:27], s47 offen offset:1024 sc1
s_call_b64 s[100:101], L_TRY
s_cbranch_scc1 L_SLOW31
v_mov_b64 v[88:89], v[120:121]
v_mov_b64 v[92:93], v[124:125]
s_branch L_BACK31
L_SELF:
s_mul_i32 s47, s91, 458752
s_lshl_b32 s46, s39, 8
s_add_u32 s47, s47, s46
s_add_u32 s84, s6, s47
s_addc_u32 s85, s7, 0
s_mov_b32 s86, 387328
s_mov_b32 s87, 0x20000
buffer_load_dwordx4 v[64:67], v30, s[84:87], 0 offen
buffer_load_dwordx4 v[68:71], v30, s[84:87], s92 offen
buffer_load_dwordx4 v[72:75], v30, s[84:87], s93 offen
buffer_load_dwordx4 v[76:79], v30, s[84:87], s94 offen
s_waitcnt vmcnt(0)
v_lshl_add_u64 v[64:65], v[68:69], 4, v[64:65]
v_lshl_add_u64 v[66:67], v[70:71], 4, v[66:67]
v_lshl_add_u64 v[72:73], v[76:77], 4, v[72:73]
v_lshl_add_u64 v[74:75], v[78:79], 4, v[74:75]
v_lshl_or_b32 v76, v72, 8, v64
v_lshl_or_b32 v77, v73, 8, v65
v_lshl_or_b32 v78, v74, 8, v66
v_lshl_or_b32 v79, v75, 8, v67
v_lshl_or_b32 v120, v77, 16, v76
v_lshl_or_b32 v121, v79, 16, v78
s_add_u32 s84, s84, 57344
s_addc_u32 s85, s85, 0
buffer_load_dwordx4 v[64:67], v30, s[84:87], 0 offen
buffer_load_dwordx4 v[68:71], v30, s[84:87], s92 offen
buffer_load_dwordx4 v[72:75], v30, s[84:87], s93 offen
buffer_load_dwordx4 v[76:79], v30, s[84:87], s94 offen
s_waitcnt vmcnt(0)
v_lshl_add_u64 v[64:65], v[68:69], 4, v[64:65]
v_lshl_add_u64 v[66:67], v[70:71], 4, v[66:67]
v_lshl_add_u64 v[72:73], v[76:77], 4, v[72:73]
v_lshl_add_u64 v[74:75], v[78:79], 4, v[74:75]
v_lshl_or_b32 v76, v72, 8, v64
v_lshl_or_b32 v77, v73, 8, v65
v_lshl_or_b32 v78, v74, 8, v66
v_lshl_or_b32 v79, v75, 8, v67
v_lshl_or_b32 v124, v77, 16, v76
v_lshl_or_b32 v125, v79, 16, v78
s_cmp_eq_u32 s39, -1
s_setpc_b64 s[100:101]
L_END:
s_endpgm
.section .rodata,"a"
.p2align 6
.amdhsa_kernel standalone__normalfloat_lut_af4__prompt_kernel
  .amdhsa_next_free_vgpr 512
  .amdhsa_next_free_sgpr 102
  .amdhsa_accum_offset 256
  .amdhsa_group_segment_fixed_size 0
  .amdhsa_kernarg_size 56
  .amdhsa_user_sgpr_count 2
  .amdhsa_user_sgpr_kernarg_segment_ptr 1
  .amdhsa_system_sgpr_workgroup_id_x 1
.end_amdhsa_kernel
```

```asm
; @launch grid=(256,1,1) block=(256,1,1) lds=163840
.amdgcn_target "amdgcn-amd-amdhsa--gfx950"
.text
.globl standalone__normalfloat_lut_af4__prompt_kernel
.p2align 12
.p2align 8
.type standalone__normalfloat_lut_af4__prompt_kernel,@function
standalone__normalfloat_lut_af4__prompt_kernel:
s_load_dwordx4 s[4:7], s[0:1], 0
s_load_dwordx4 s[12:15], s[0:1], 40
s_load_dwordx4 s[8:11], s[0:1], 24
s_load_dwordx2 s[50:51], s[0:1], 16
s_memrealtime s[56:57]
s_cmp_ge_u32 s2, 256
s_cbranch_scc1 L_END
s_getpc_b64 s[48:49]
L_PC0:
v_bfi_b32 v2, 7, v0, s2
v_lshlrev_b32 v2, 7, v2
v_min_u32 v2, L_END-L_PC0, v2
global_load_dword v7, v2, s[48:49]
v_lshrrev_b32 v1, 6, v0
s_cmp_lt_u32 s2, 32
v_readfirstlane_b32 s36, v1
s_cbranch_scc1 L_PACK
s_bfe_u32 s34, s2, 0x20001
s_bfe_u32 s37, s2, 0x20003
s_lshl2_add_u32 s37, s34, s37
s_and_b32 s43, s2, 1
s_mul_i32 s43, s43, 7
s_lshr_b32 s38, s2, 5
s_add_u32 s38, s38, s43
s_lshl2_add_u32 s39, s38, s36
s_sub_u32 s39, s39, 4
v_bfe_u32 v6, v0, 4, 2
v_and_b32 v3, 15, v0
v_mul_u32_u24 v2, 114688, v6
v_lshl_add_u32 v30, v3, 4, v2
s_lshr_b32 s46, s37, 1
s_and_b32 s45, s37, 1
s_lshl3_add_u32 s46, s46, s45
s_mul_i32 s46, s46, 57344
s_lshl_b32 s47, s39, 8
s_add_u32 s44, s46, s47
s_mov_b32 s18, 387328
s_mov_b32 s19, 0x20000
s_mov_b32 s92, 14336
s_mov_b32 s93, 28672
s_mov_b32 s94, 43008
s_waitcnt lgkmcnt(0)
s_load_dwordx8 s[64:71], s[50:51], 0
s_add_u32 s16, s6, s44
s_addc_u32 s17, s7, 0
buffer_load_dwordx4 v[104:107], v30, s[16:19], 0 offen
buffer_load_dwordx4 v[108:111], v30, s[16:19], s92 offen
buffer_load_dwordx4 v[112:115], v30, s[16:19], s93 offen
buffer_load_dwordx4 v[116:119], v30, s[16:19], s94 offen
s_branch L_MAIN
L_PACK:
v_lshrrev_b32 v2, 2, v0
v_and_b32 v3, 3, v0
s_lshl_b32 s45, s2, 17
v_lshl_add_u32 v2, v2, 11, s45
v_lshl_add_u32 v17, v3, 7, v2
s_mov_b32 s30, 4194304
s_mov_b32 s31, 0x20000
v_lshlrev_b32 v16, 3, v0
s_cmp_lt_u32 s2, 2
s_cselect_b32 s34, 8, 0
s_mov_b32 s35, 0x20000
v_mov_b64 v[22:23], 0
s_waitcnt lgkmcnt(0)
s_mov_b64 s[32:33], s[12:13]
v_mov_b64 v[20:21], s[56:57]
buffer_atomic_cmpswap_x2 v[20:23], v16, s[32:35], 0 offen sc1
s_mov_b64 s[28:29], s[4:5]
buffer_load_dword v19, v17, s[28:31], 0 offen offset:0
s_branch L_PACK1
L_MAIN:
s_mov_b64 s[20:21], s[4:5]
s_mov_b32 s22, 4194304
s_mov_b32 s23, 0x20000
s_lshl_b32 s46, s37, 18
v_lshrrev_b32 v5, 3, v0
v_lshl_add_u32 v2, v5, 11, s46
v_lshrrev_b32 v4, 4, v0
v_xor_b32 v4, v4, v0
v_and_b32 v4, 7, v4
v_lshl_add_u32 v8, v4, 4, v2
v_add_u32 v9, 65536, v8
v_add_u32 v10, 131072, v8
v_add_u32 v11, 196608, v8
s_lshl_b32 s33, s36, 10
s_mul_i32 s47, s45, 114688
s_sub_u32 s47, s44, s47
s_add_u32 s47, s47, 57344
s_add_u32 s84, s6, s47
s_addc_u32 s85, s7, 0
s_mov_b32 s86, 387328
s_mov_b32 s87, 0x20000
s_lshl_b32 s40, s34, 7
s_add_u32 m0, s33, 65536
s_nop 0
buffer_load_dwordx4 v8, s[20:23], s40 offen lds
s_add_u32 m0, s33, 69632
s_nop 0
buffer_load_dwordx4 v9, s[20:23], s40 offen lds
s_add_u32 m0, s33, 73728
s_nop 0
buffer_load_dwordx4 v10, s[20:23], s40 offen lds
s_add_u32 m0, s33, 77824
s_nop 0
buffer_load_dwordx4 v11, s[20:23], s40 offen lds
s_and_b32 s45, s36, 1
s_mul_i32 s45, s45, 0x0202
s_lshr_b32 s46, s36, 1
s_mul_i32 s46, s46, 0x02020000
s_add_u32 s45, s45, s46
s_add_u32 s45, s45, 0x05040100
v_mov_b32 v57, s45
v_lshlrev_b32 v5, 8, v5
v_and_b32 v58, 7, v0
v_lshl_add_u32 v58, v58, 4, v5
v_and_b32 v5, 31, v0
v_lshlrev_b32 v19, 2, v5
v_and_b32 v0, 63, v0
s_lshl_b32 s46, s39, 7
v_lshl_add_u32 v28, v3, 3, s46
s_mul_i32 s47, s37, 917504
s_add_u32 s47, s47, s46
s_add_u32 s28, s10, s47
s_addc_u32 s29, s11, 0
s_mov_b32 s30, 86144
s_mov_b32 s31, 0x20000
v_mul_u32_u24 v29, 28672, v6
v_lshl_add_u32 v18, v3, 3, v29
v_lshlrev_b32 v29, 7, v3
v_bfe_u32 v5, v0, 1, 3
v_xor_b32 v5, v5, v6
v_lshl_add_u32 v29, v5, 4, v29
v_add_u32 v14, 65536, v29
v_xor_b32 v15, 64, v14
v_add_u32 v16, 0x10000, v14
v_add_u32 v17, 0x10000, v15
s_mov_b32 s52, 0x0c0c0400
s_mov_b32 s53, 0x0c0c0500
s_mov_b32 s54, 0x0c0c0600
s_mov_b32 s55, 0x0c0c0700
v_lshlrev_b32 v13, 4, v0
s_lshl_b32 s47, s39, 16
s_add_u32 s24, s14, s47
s_addc_u32 s25, s15, 0
s_lshl_b32 s47, s37, 10
s_add_u32 s76, s24, s47
s_addc_u32 s77, s25, 0
s_movk_i32 s78, 1024
s_mov_b32 s79, 0x20000
s_lshl_b32 s47, s34, 3
s_lshr_b32 s47, 0x90d0b2d, s47
s_bfe_u32 s41, s47, 0x20000
s_lshl_b32 s41, s41, 7
s_bfe_u32 s42, s47, 0x20002
s_lshl_b32 s42, s42, 7
s_bfe_u32 s43, s47, 0x20004
s_lshl_b32 s43, s43, 7
s_lshl_b32 s47, s34, 1
s_lshr_b32 s47, 0x63, s47
s_and_b32 s47, s47, 3
s_sub_u32 s47, s47, s34
s_lshl1_add_u32 s3, s47, 12
s_mul_i32 s47, s3, 458752
s_add_u32 s16, s16, s47
s_addc_u32 s17, s17, 0
s_lshl_b32 s3, s3, 11
s_lshr_b32 s35, s37, 1
s_xor_b32 s35, s35, 1
v_lshl_add_u32 v12, s41, 5, v13
s_mul_i32 s47, s35, 458752
s_lshl_b32 s46, s39, 8
s_add_u32 s47, s47, s46
s_add_u32 s72, s6, s47
s_addc_u32 s73, s7, 0
s_mov_b32 s74, 444672
s_mov_b32 s75, 0x20000
v_add_u32 v31, 57344, v30
s_and_b32 s47, s37, 2
s_lshl_b32 s47, s47, 5
v_xor_b32 v2, s47, v14
v_xor_b32 v4, 64, v2
s_and_b32 s47, s37, 1
v_lshl_add_u32 v2, s47, 3, v2
v_xor_b32 v3, 8, v2
s_mov_b32 s26, 65536
s_mov_b32 s27, 0x20000
s_mov_b64 s[80:81], s[12:13]
s_movk_i32 s82, 128
s_mov_b32 s83, 0x20000
s_movk_i32 s90, 4096
s_waitcnt lgkmcnt(0)
s_pack_ll_b32_b16 s45, s64, s68
v_mov_b32 v56, s45
s_lshl_b64 exec, exec, 8
s_pack_hh_b32_b16 s45, s64, s68
v_mov_b32 v56, s45
s_lshl_b64 exec, exec, 8
s_pack_ll_b32_b16 s45, s65, s69
v_mov_b32 v56, s45
s_lshl_b64 exec, exec, 8
s_pack_hh_b32_b16 s45, s65, s69
v_mov_b32 v56, s45
s_lshl_b64 exec, exec, 8
s_pack_ll_b32_b16 s45, s66, s70
v_mov_b32 v56, s45
s_lshl_b64 exec, exec, 8
s_pack_hh_b32_b16 s45, s66, s70
v_mov_b32 v56, s45
s_lshl_b64 exec, exec, 8
s_pack_ll_b32_b16 s45, s67, s71
v_mov_b32 v56, s45
s_lshl_b64 exec, exec, 8
s_pack_hh_b32_b16 s45, s67, s71
v_mov_b32 v56, s45
s_mov_b64 exec, -1
v_perm_b32 v128, s64, v56, v57
v_mov_b32 v129, v128
v_mov_b64 v[130:131], v[128:129]
s_load_dwordx2 s[88:89], s[12:13], 0
ds_write_b128 v58, v[128:131] offset:0
v_perm_b32 v132, s65, v56, v57
v_mov_b32 v133, v132
v_mov_b64 v[134:135], v[132:133]
ds_write_b128 v58, v[132:135] offset:8192
v_perm_b32 v136, s66, v56, v57
v_mov_b32 v137, v136
v_mov_b64 v[138:139], v[136:137]
ds_write_b128 v58, v[136:139] offset:16384
v_perm_b32 v140, s67, v56, v57
v_mov_b32 v141, v140
v_mov_b64 v[142:143], v[140:141]
ds_write_b128 v58, v[140:143] offset:24576
v_perm_b32 v144, s68, v56, v57
v_mov_b32 v145, v144
v_mov_b64 v[146:147], v[144:145]
ds_write_b128 v58, v[144:147] offset:32768
v_perm_b32 v148, s69, v56, v57
v_mov_b32 v149, v148
v_mov_b64 v[150:151], v[148:149]
ds_write_b128 v58, v[148:151] offset:40960
v_perm_b32 v152, s70, v56, v57
v_mov_b32 v153, v152
v_mov_b64 v[154:155], v[152:153]
ds_write_b128 v58, v[152:155] offset:49152
v_perm_b32 v156, s71, v56, v57
v_mov_b32 v157, v156
v_mov_b64 v[158:159], v[156:157]
ds_write_b128 v58, v[156:159] offset:57344
buffer_load_dwordx4 v[64:67], v30, s[84:87], 0 offen
buffer_load_dwordx4 v[68:71], v30, s[84:87], s92 offen
buffer_load_dwordx4 v[72:75], v30, s[84:87], s93 offen
buffer_load_dwordx4 v[76:79], v30, s[84:87], s94 offen
s_mov_b64 vcc, -1
s_cmp_eq_u32 s36, 0
s_cbranch_scc1 L_PAD0
s_cmp_eq_u32 s36, 1
s_cbranch_scc1 L_PAD2
s_cmp_eq_u32 s36, 2
s_cbranch_scc1 L_PAD4
s_cmp_eq_u32 s36, 3
s_cbranch_scc1 L_PADS
L_PADRET:
s_mov_b64 vcc, 0
s_waitcnt vmcnt(8)
v_lshl_add_u64 v[104:105], v[108:109], 4, v[104:105]
v_lshl_add_u64 v[106:107], v[110:111], 4, v[106:107]
v_lshl_add_u64 v[112:113], v[116:117], 4, v[112:113]
v_lshl_add_u64 v[114:115], v[118:119], 4, v[114:115]
v_lshl_or_b32 v116, v112, 8, v104
v_lshl_or_b32 v117, v113, 8, v105
v_lshl_or_b32 v118, v114, 8, v106
v_lshl_or_b32 v119, v115, 8, v107
v_lshl_or_b32 v108, v117, 16, v116
v_lshl_or_b32 v109, v119, 16, v118
s_waitcnt lgkmcnt(0)
s_cmp_eq_u64 s[88:89], 0
s_cbranch_scc1 L_NOTAG
L_TAGOK:
v_mov_b64 v[110:111], s[88:89]
buffer_store_dwordx4 v[108:111], v13, s[76:79], 0 offen sc1
s_add_u32 s76, s76, s3
s_addc_u32 s77, s77, 0
s_branch L_STREAM
L_PACK1:
v_and_b32 v0, 63, v0
v_lshrrev_b32 v2, 4, v0
v_and_b32 v3, 15, v0
v_mul_u32_u24 v2, 114688, v2
v_lshl_add_u32 v8, v3, 4, v2
s_movk_i32 s47, 0x3800
v_add_u32 v9, s47, v8
v_add_u32 v10, s47, v9
v_add_u32 v11, s47, v10
v_add_u32 v12, s47, v11
v_add_u32 v13, s47, v12
v_add_u32 v14, s47, v13
v_add_u32 v15, s47, v14
s_sub_u32 s3, s2, 1
s_and_b32 s3, s3, 7
s_lshr_b32 s45, s2, 3
s_lshl2_add_u32 s3, s3, s45
s_mul_i32 s40, s3, 4682
s_lshr_b32 s40, s40, 16
s_mul_i32 s41, s40, 14
s_sub_u32 s41, s3, s41
s_add_u32 s40, s40, 8
s_mov_b32 s22, 14680064
s_mov_b32 s23, 0x20000
s_mov_b64 s[20:21], s[6:7]
s_cmp_ge_u32 s40, 12
s_cselect_b32 s45, 8, 0
s_add_u32 s45, s45, s40
s_lshl2_add_u32 s42, s41, s36
s_mul_i32 s43, s45, 458752
s_lshl_b32 s44, s42, 8
s_add_u32 s43, s43, s44
s_lshl_b32 s44, s42, 5
s_add_u32 s44, s44, s45
s_lshl_b32 s52, s44, 11
s_cmp_lt_u32 s45, 32
s_cselect_b32 s52, s52, 0x1000000
s_cselect_b32 s22, 14680064, 0
s_add_u32 s41, s41, 4
s_add_u32 s40, s40, 2
s_cmp_ge_u32 s41, 14
s_cselect_b32 s48, 14, 0
s_addc_u32 s40, s40, 0
s_sub_u32 s41, s41, s48
s_load_dwordx2 s[50:51], s[12:13], 0
buffer_load_dwordx4 v[32:35], v8, s[20:23], s43 offen
buffer_load_dwordx4 v[36:39], v9, s[20:23], s43 offen
buffer_load_dwordx4 v[40:43], v10, s[20:23], s43 offen
buffer_load_dwordx4 v[44:47], v11, s[20:23], s43 offen
buffer_load_dwordx4 v[48:51], v12, s[20:23], s43 offen
buffer_load_dwordx4 v[52:55], v13, s[20:23], s43 offen
buffer_load_dwordx4 v[56:59], v14, s[20:23], s43 offen
buffer_load_dwordx4 v[60:63], v15, s[20:23], s43 offen
s_mov_b64 s[24:25], s[14:15]
s_mov_b32 s26, 3670016
s_mov_b32 s27, 0x20000
s_movk_i32 s34, 128
v_mov_b32 v16, 0
v_lshlrev_b32 v18, 4, v0
s_movk_i32 s46, 4096
s_waitcnt vmcnt(4) lgkmcnt(0)
v_mov_b64 v[22:23], s[50:51]
s_nop 0
L_PKN:
v_cmp_ne_u64 vcc, 0, v[22:23]
s_sub_u32 s46, s46, 1
s_cmp_gt_i32 s46, 0
s_cbranch_vccnz L_PKGO
s_cbranch_scc0 L_END
buffer_load_dwordx2 v[22:23], v16, s[32:35], 0 offen sc1
s_waitcnt vmcnt(0)
s_branch L_PKN
L_PKGO:
s_call_b64 s[100:101], L_PK0
buffer_store_dwordx4 v[20:23], v18, s[24:27], s52 offen offset:0 sc1
s_waitcnt lgkmcnt(0)
s_call_b64 s[100:101], L_UNIT
s_mov_b32 s53, s49
buffer_load_dwordx4 v[64:67], v8, s[20:23], s43 offen
buffer_load_dwordx4 v[68:71], v9, s[20:23], s43 offen
buffer_load_dwordx4 v[72:75], v10, s[20:23], s43 offen
buffer_load_dwordx4 v[76:79], v11, s[20:23], s43 offen
s_waitcnt vmcnt(5)
s_call_b64 s[100:101], L_PK1
buffer_store_dwordx4 v[20:23], v18, s[24:27], s52 offen offset:1024 sc1
buffer_load_dwordx4 v[80:83], v12, s[20:23], s43 offen
buffer_load_dwordx4 v[84:87], v13, s[20:23], s43 offen
buffer_load_dwordx4 v[88:91], v14, s[20:23], s43 offen
buffer_load_dwordx4 v[92:95], v15, s[20:23], s43 offen
s_waitcnt vmcnt(5)
s_call_b64 s[100:101], L_PK2
buffer_store_dwordx4 v[20:23], v18, s[24:27], s53 offen offset:0 sc1
s_call_b64 s[100:101], L_UNIT
s_mov_b32 s54, s49
buffer_load_dwordx4 v[32:35], v8, s[20:23], s43 offen
buffer_load_dwordx4 v[36:39], v9, s[20:23], s43 offen
buffer_load_dwordx4 v[40:43], v10, s[20:23], s43 offen
buffer_load_dwordx4 v[44:47], v11, s[20:23], s43 offen
s_waitcnt vmcnt(5)
s_call_b64 s[100:101], L_PK3
buffer_store_dwordx4 v[20:23], v18, s[24:27], s53 offen offset:1024 sc1
buffer_load_dwordx4 v[48:51], v12, s[20:23], s43 offen
buffer_load_dwordx4 v[52:55], v13, s[20:23], s43 offen
buffer_load_dwordx4 v[56:59], v14, s[20:23], s43 offen
buffer_load_dwordx4 v[60:63], v15, s[20:23], s43 offen
s_waitcnt vmcnt(5)
s_call_b64 s[100:101], L_PK0
buffer_store_dwordx4 v[20:23], v18, s[24:27], s54 offen offset:0 sc1
s_call_b64 s[100:101], L_UNIT
s_mov_b32 s55, s49
buffer_load_dwordx4 v[64:67], v8, s[20:23], s43 offen
buffer_load_dwordx4 v[68:71], v9, s[20:23], s43 offen
buffer_load_dwordx4 v[72:75], v10, s[20:23], s43 offen
buffer_load_dwordx4 v[76:79], v11, s[20:23], s43 offen
s_waitcnt vmcnt(5)
s_call_b64 s[100:101], L_PK1
buffer_store_dwordx4 v[20:23], v18, s[24:27], s54 offen offset:1024 sc1
buffer_load_dwordx4 v[80:83], v12, s[20:23], s43 offen
buffer_load_dwordx4 v[84:87], v13, s[20:23], s43 offen
buffer_load_dwordx4 v[88:91], v14, s[20:23], s43 offen
buffer_load_dwordx4 v[92:95], v15, s[20:23], s43 offen
s_waitcnt vmcnt(5)
s_call_b64 s[100:101], L_PK2
buffer_store_dwordx4 v[20:23], v18, s[24:27], s55 offen offset:0 sc1
buffer_load_dword v19, v17, s[28:31], 0 offen offset:1152
s_waitcnt vmcnt(2)
s_call_b64 s[100:101], L_PK3
buffer_store_dwordx4 v[20:23], v18, s[24:27], s55 offen offset:1024 sc1
s_call_b64 s[100:101], L_UNIT
s_mov_b32 s52, s49
buffer_load_dwordx4 v[32:35], v8, s[20:23], s43 offen
buffer_load_dwordx4 v[36:39], v9, s[20:23], s43 offen
buffer_load_dwordx4 v[40:43], v10, s[20:23], s43 offen
buffer_load_dwordx4 v[44:47], v11, s[20:23], s43 offen
buffer_load_dwordx4 v[48:51], v12, s[20:23], s43 offen
buffer_load_dwordx4 v[52:55], v13, s[20:23], s43 offen
buffer_load_dwordx4 v[56:59], v14, s[20:23], s43 offen
buffer_load_dwordx4 v[60:63], v15, s[20:23], s43 offen
s_waitcnt vmcnt(4)
s_call_b64 s[100:101], L_PK0
buffer_store_dwordx4 v[20:23], v18, s[24:27], s52 offen offset:0 sc1
s_call_b64 s[100:101], L_UNIT
s_mov_b32 s53, s49
buffer_load_dwordx4 v[64:67], v8, s[20:23], s43 offen
buffer_load_dwordx4 v[68:71], v9, s[20:23], s43 offen
buffer_load_dwordx4 v[72:75], v10, s[20:23], s43 offen
buffer_load_dwordx4 v[76:79], v11, s[20:23], s43 offen
s_waitcnt vmcnt(5)
s_call_b64 s[100:101], L_PK1
buffer_store_dwordx4 v[20:23], v18, s[24:27], s52 offen offset:1024 sc1
buffer_load_dwordx4 v[80:83], v12, s[20:23], s43 offen
buffer_load_dwordx4 v[84:87], v13, s[20:23], s43 offen
buffer_load_dwordx4 v[88:91], v14, s[20:23], s43 offen
buffer_load_dwordx4 v[92:95], v15, s[20:23], s43 offen
s_waitcnt vmcnt(5)
s_call_b64 s[100:101], L_PK2
buffer_store_dwordx4 v[20:23], v18, s[24:27], s53 offen offset:0 sc1
s_call_b64 s[100:101], L_UNIT
s_mov_b32 s54, s49
buffer_load_dwordx4 v[32:35], v8, s[20:23], s43 offen
buffer_load_dwordx4 v[36:39], v9, s[20:23], s43 offen
buffer_load_dwordx4 v[40:43], v10, s[20:23], s43 offen
buffer_load_dwordx4 v[44:47], v11, s[20:23], s43 offen
s_waitcnt vmcnt(5)
s_call_b64 s[100:101], L_PK3
buffer_store_dwordx4 v[20:23], v18, s[24:27], s53 offen offset:1024 sc1
buffer_load_dwordx4 v[48:51], v12, s[20:23], s43 offen
buffer_load_dwordx4 v[52:55], v13, s[20:23], s43 offen
buffer_load_dwordx4 v[56:59], v14, s[20:23], s43 offen
buffer_load_dwordx4 v[60:63], v15, s[20:23], s43 offen
s_waitcnt vmcnt(5)
s_call_b64 s[100:101], L_PK0
buffer_store_dwordx4 v[20:23], v18, s[24:27], s54 offen offset:0 sc1
buffer_load_dword v19, v17, s[28:31], 0 offen offset:1536
s_waitcnt vmcnt(2)
s_call_b64 s[100:101], L_PK1
buffer_store_dwordx4 v[20:23], v18, s[24:27], s54 offen offset:1024 sc1
s_endpgm
L_UNIT:
s_cmp_ge_u32 s40, 12
s_cselect_b32 s45, 8, 0
s_add_u32 s45, s45, s40
s_lshl2_add_u32 s42, s41, s36
s_mul_i32 s43, s45, 458752
s_lshl_b32 s44, s42, 8
s_add_u32 s43, s43, s44
s_lshl_b32 s44, s42, 5
s_add_u32 s44, s44, s45
s_lshl_b32 s49, s44, 11
s_cmp_lt_u32 s45, 32
s_cselect_b32 s49, s49, 0x1000000
s_cselect_b32 s22, 14680064, 0
s_add_u32 s41, s41, 4
s_add_u32 s40, s40, 2
s_cmp_ge_u32 s41, 14
s_cselect_b32 s48, 14, 0
s_addc_u32 s40, s40, 0
s_sub_u32 s41, s41, s48
s_setpc_b64 s[100:101]
L_PK0:
v_lshl_add_u64 v[32:33], v[36:37], 4, v[32:33]
v_lshl_add_u64 v[34:35], v[38:39], 4, v[34:35]
v_lshl_add_u64 v[40:41], v[44:45], 4, v[40:41]
v_lshl_add_u64 v[42:43], v[46:47], 4, v[42:43]
v_lshl_or_b32 v44, v40, 8, v32
v_lshl_or_b32 v45, v41, 8, v33
v_lshl_or_b32 v46, v42, 8, v34
v_lshl_or_b32 v47, v43, 8, v35
v_lshl_or_b32 v20, v45, 16, v44
v_lshl_or_b32 v21, v47, 16, v46
s_setpc_b64 s[100:101]
L_PK1:
v_lshl_add_u64 v[48:49], v[52:53], 4, v[48:49]
v_lshl_add_u64 v[50:51], v[54:55], 4, v[50:51]
v_lshl_add_u64 v[56:57], v[60:61], 4, v[56:57]
v_lshl_add_u64 v[58:59], v[62:63], 4, v[58:59]
v_lshl_or_b32 v60, v56, 8, v48
v_lshl_or_b32 v61, v57, 8, v49
v_lshl_or_b32 v62, v58, 8, v50
v_lshl_or_b32 v63, v59, 8, v51
v_lshl_or_b32 v20, v61, 16, v60
v_lshl_or_b32 v21, v63, 16, v62
s_setpc_b64 s[100:101]
L_PK2:
v_lshl_add_u64 v[64:65], v[68:69], 4, v[64:65]
v_lshl_add_u64 v[66:67], v[70:71], 4, v[66:67]
v_lshl_add_u64 v[72:73], v[76:77], 4, v[72:73]
v_lshl_add_u64 v[74:75], v[78:79], 4, v[74:75]
v_lshl_or_b32 v76, v72, 8, v64
v_lshl_or_b32 v77, v73, 8, v65
v_lshl_or_b32 v78, v74, 8, v66
v_lshl_or_b32 v79, v75, 8, v67
v_lshl_or_b32 v20, v77, 16, v76
v_lshl_or_b32 v21, v79, 16, v78
s_setpc_b64 s[100:101]
L_PK3:
v_lshl_add_u64 v[80:81], v[84:85], 4, v[80:81]
v_lshl_add_u64 v[82:83], v[86:87], 4, v[82:83]
v_lshl_add_u64 v[88:89], v[92:93], 4, v[88:89]
v_lshl_add_u64 v[90:91], v[94:95], 4, v[90:91]
v_lshl_or_b32 v92, v88, 8, v80
v_lshl_or_b32 v93, v89, 8, v81
v_lshl_or_b32 v94, v90, 8, v82
v_lshl_or_b32 v95, v91, 8, v83
v_lshl_or_b32 v20, v93, 16, v92
v_lshl_or_b32 v21, v95, 16, v94
s_setpc_b64 s[100:101]
.p2align 12
L_STREAM:
L_PAD0:
s_cbranch_vccnz L_PAD1
buffer_load_dwordx4 v[80:83], v30, s[72:75], 0 offen
buffer_load_dwordx4 v[84:87], v30, s[72:75], s92 offen
buffer_load_dwordx4 v[88:91], v30, s[72:75], s93 offen
buffer_load_dwordx4 v[92:95], v30, s[72:75], s94 offen
v_lshl_add_u32 v104, v104, 8, v19
v_lshl_add_u32 v105, v105, 8, v19
v_lshl_add_u32 v106, v106, 8, v19
v_lshl_add_u32 v107, v107, 8, v19
v_lshl_add_u32 v112, v112, 8, v19
v_lshl_add_u32 v113, v113, 8, v19
v_lshl_add_u32 v114, v114, 8, v19
v_lshl_add_u32 v115, v115, 8, v19
s_waitcnt vmcnt(9)
s_barrier
ds_read_b64 a[224:225], v2 offset:0
ds_read_b64 a[228:229], v2 offset:2048
ds_read_b32 a0, v104
ds_read_b32 a1, v112
ds_read_b32 a4, v105
ds_read_b32 a5, v113
ds_read_b32 a8, v106
ds_read_b32 a9, v114
ds_read_b32 a12, v107
ds_read_b32 a13, v115
s_waitcnt lgkmcnt(6)
v_mfma_f32_16x16x16_bf16 v[128:131], a[224:225], a[0:1], 0
s_waitcnt lgkmcnt(4)
ds_read_b64 a[232:233], v2 offset:4096
buffer_load_dwordx4 v[40:43], v31, s[72:75], 0 offen
v_mfma_f32_16x16x16_bf16 v[132:135], a[224:225], a[4:5], 0
s_waitcnt lgkmcnt(3)
v_mfma_f32_16x16x16_bf16 v[136:139], a[224:225], a[8:9], 0
s_waitcnt lgkmcnt(1)
buffer_load_dwordx4 v[44:47], v31, s[72:75], s92 offen
v_mfma_f32_16x16x16_bf16 v[140:143], a[224:225], a[12:13], 0
v_mfma_f32_16x16x16_bf16 v[144:147], a[228:229], a[0:1], 0
ds_read_b64 a[236:237], v2 offset:6144
buffer_load_dwordx4 v[48:51], v31, s[72:75], s93 offen
v_mfma_f32_16x16x16_bf16 v[148:151], a[228:229], a[4:5], 0
v_mfma_f32_16x16x16_bf16 v[152:155], a[228:229], a[8:9], 0
buffer_load_dwordx4 v[52:55], v31, s[72:75], s94 offen
v_mfma_f32_16x16x16_bf16 v[156:159], a[228:229], a[12:13], 0
s_waitcnt lgkmcnt(1)
v_mfma_f32_16x16x16_bf16 v[160:163], a[232:233], a[0:1], 0
ds_read_b64 a[240:241], v2 offset:8192
v_mfma_f32_16x16x16_bf16 v[164:167], a[232:233], a[4:5], 0
v_mfma_f32_16x16x16_bf16 v[168:171], a[232:233], a[8:9], 0
s_add_u32 m0, s33, 81920
v_mfma_f32_16x16x16_bf16 v[172:175], a[232:233], a[12:13], 0
s_waitcnt lgkmcnt(1)
v_mfma_f32_16x16x16_bf16 v[176:179], a[236:237], a[0:1], 0
ds_read_b64 a[244:245], v2 offset:10240
buffer_load_dwordx4 v8, s[20:23], s41 offen lds
v_mfma_f32_16x16x16_bf16 v[180:183], a[236:237], a[4:5], 0
s_waitcnt vmcnt(12)
v_lshl_add_u64 v[64:65], v[68:69], 4, v[64:65]
v_mfma_f32_16x16x16_bf16 v[184:187], a[236:237], a[8:9], 0
s_add_u32 m0, s33, 86016
v_lshl_add_u64 v[66:67], v[70:71], 4, v[66:67]
v_lshl_add_u32 v64, v64, 8, v19
v_mfma_f32_16x16x16_bf16 v[188:191], a[236:237], a[12:13], 0
s_waitcnt lgkmcnt(1)
ds_read_b32 a2, v64
v_lshl_add_u32 v65, v65, 8, v19
v_mfma_f32_16x16x16_bf16 v[192:195], a[240:241], a[0:1], 0
ds_read_b64 a[248:249], v2 offset:12288
buffer_load_dwordx4 v9, s[20:23], s41 offen lds
v_mfma_f32_16x16x16_bf16 v[196:199], a[240:241], a[4:5], 0
ds_read_b32 a6, v65
v_lshl_add_u32 v66, v66, 8, v19
v_mfma_f32_16x16x16_bf16 v[200:203], a[240:241], a[8:9], 0
s_add_u32 m0, s33, 90112
ds_read_b32 a10, v66
v_lshl_add_u32 v67, v67, 8, v19
v_mfma_f32_16x16x16_bf16 v[204:207], a[240:241], a[12:13], 0
s_waitcnt vmcnt(11) lgkmcnt(4)
ds_read_b32 a14, v67
v_lshl_add_u64 v[72:73], v[76:77], 4, v[72:73]
v_mfma_f32_16x16x16_bf16 v[208:211], a[244:245], a[0:1], 0
ds_read_b64 a[252:253], v2 offset:14336
buffer_load_dwordx4 v10, s[20:23], s41 offen lds
v_mfma_f32_16x16x16_bf16 v[212:215], a[244:245], a[4:5], 0
v_lshl_add_u64 v[74:75], v[78:79], 4, v[74:75]
v_lshl_add_u32 v72, v72, 8, v19
v_mfma_f32_16x16x16_bf16 v[216:219], a[244:245], a[8:9], 0
s_add_u32 m0, s33, 94208
ds_read_b32 a3, v72
v_lshl_add_u32 v73, v73, 8, v19
v_mfma_f32_16x16x16_bf16 v[220:223], a[244:245], a[12:13], 0
s_waitcnt lgkmcnt(3)
ds_read_b32 a7, v73
v_lshl_add_u32 v74, v74, 8, v19
v_mfma_f32_16x16x16_bf16 v[224:227], a[248:249], a[0:1], 0
ds_read_b64 a[224:225], v3 offset:0
buffer_load_dwordx4 v11, s[20:23], s41 offen lds
v_mfma_f32_16x16x16_bf16 v[228:231], a[248:249], a[4:5], 0
ds_read_b32 a11, v74
v_lshl_add_u32 v75, v75, 8, v19
v_mfma_f32_16x16x16_bf16 v[232:235], a[248:249], a[8:9], 0
ds_read_b32 a15, v75
v_mfma_f32_16x16x16_bf16 v[236:239], a[248:249], a[12:13], 0
s_waitcnt lgkmcnt(4)
v_mfma_f32_16x16x16_bf16 v[240:243], a[252:253], a[0:1], 0
ds_read_b64 a[228:229], v3 offset:2048
v_mfma_f32_16x16x16_bf16 v[244:247], a[252:253], a[4:5], 0
v_mfma_f32_16x16x16_bf16 v[248:251], a[252:253], a[8:9], 0
global_load_dwordx2 v[20:21], v28, s[8:9]
v_mfma_f32_16x16x16_bf16 v[252:255], a[252:253], a[12:13], 0
s_waitcnt lgkmcnt(1)
v_mfma_f32_16x16x16_bf16 v[128:131], a[224:225], a[2:3], v[128:131]
s_waitcnt vmcnt(11)
ds_read_b64 a[232:233], v3 offset:4096
v_lshl_add_u64 v[80:81], v[84:85], 4, v[80:81]
v_mfma_f32_16x16x16_bf16 v[132:135], a[224:225], a[6:7], v[132:135]
v_lshl_add_u64 v[82:83], v[86:87], 4, v[82:83]
v_lshl_add_u32 v80, v80, 8, v19
v_mfma_f32_16x16x16_bf16 v[136:139], a[224:225], a[10:11], v[136:139]
ds_read_b32 a16, v80
v_lshl_add_u32 v81, v81, 8, v19
v_mfma_f32_16x16x16_bf16 v[140:143], a[224:225], a[14:15], v[140:143]
s_waitcnt lgkmcnt(2)
ds_read_b32 a20, v81
v_mfma_f32_16x16x16_bf16 v[144:147], a[228:229], a[2:3], v[144:147]
ds_read_b64 a[236:237], v3 offset:6144
v_lshl_add_u32 v82, v82, 8, v19
v_mfma_f32_16x16x16_bf16 v[148:151], a[228:229], a[6:7], v[148:151]
ds_read_b32 a24, v82
v_lshl_add_u32 v83, v83, 8, v19
v_mfma_f32_16x16x16_bf16 v[152:155], a[228:229], a[10:11], v[152:155]
ds_read_b32 a28, v83
v_mfma_f32_16x16x16_bf16 v[156:159], a[228:229], a[14:15], v[156:159]
s_waitcnt vmcnt(9) lgkmcnt(4)
v_lshl_add_u64 v[88:89], v[92:93], 4, v[88:89]
v_lshl_add_u64 v[90:91], v[94:95], 4, v[90:91]
v_mfma_f32_16x16x16_bf16 v[160:163], a[232:233], a[2:3], v[160:163]
ds_read_b64 a[240:241], v3 offset:8192
v_lshl_add_u32 v88, v88, 8, v19
v_mfma_f32_16x16x16_bf16 v[164:167], a[232:233], a[6:7], v[164:167]
ds_read_b32 a17, v88
v_lshl_add_u32 v89, v89, 8, v19
v_mfma_f32_16x16x16_bf16 v[168:171], a[232:233], a[10:11], v[168:171]
ds_read_b32 a21, v89
v_lshl_add_u32 v90, v90, 8, v19
v_mfma_f32_16x16x16_bf16 v[172:175], a[232:233], a[14:15], v[172:175]
s_waitcnt lgkmcnt(3)
ds_read_b32 a25, v90
v_mfma_f32_16x16x16_bf16 v[176:179], a[236:237], a[2:3], v[176:179]
ds_read_b64 a[244:245], v3 offset:10240
v_lshl_add_u32 v91, v91, 8, v19
v_mfma_f32_16x16x16_bf16 v[180:183], a[236:237], a[6:7], v[180:183]
s_waitcnt vmcnt(7)
ds_read_b32 a29, v91
v_lshl_add_u64 v[40:41], v[44:45], 4, v[40:41]
v_mfma_f32_16x16x16_bf16 v[184:187], a[236:237], a[10:11], v[184:187]
v_lshl_add_u64 v[42:43], v[46:47], 4, v[42:43]
v_lshl_add_u32 v40, v40, 8, v19
v_mfma_f32_16x16x16_bf16 v[188:191], a[236:237], a[14:15], v[188:191]
s_waitcnt lgkmcnt(3)
ds_read_b32 a18, v40
v_mfma_f32_16x16x16_bf16 v[192:195], a[240:241], a[2:3], v[192:195]
ds_read_b64 a[248:249], v3 offset:12288
v_lshl_add_u32 v41, v41, 8, v19
v_mfma_f32_16x16x16_bf16 v[196:199], a[240:241], a[6:7], v[196:199]
ds_read_b32 a22, v41
v_lshl_add_u32 v42, v42, 8, v19
v_mfma_f32_16x16x16_bf16 v[200:203], a[240:241], a[10:11], v[200:203]
ds_read_b32 a26, v42
v_lshl_add_u32 v43, v43, 8, v19
v_mfma_f32_16x16x16_bf16 v[204:207], a[240:241], a[14:15], v[204:207]
s_waitcnt lgkmcnt(4)
ds_read_b32 a30, v43
v_mfma_f32_16x16x16_bf16 v[208:211], a[244:245], a[2:3], v[208:211]
s_waitcnt vmcnt(5)
ds_read_b64 a[252:253], v3 offset:14336
v_lshl_add_u64 v[48:49], v[52:53], 4, v[48:49]
v_mfma_f32_16x16x16_bf16 v[212:215], a[244:245], a[6:7], v[212:215]
v_lshl_add_u64 v[50:51], v[54:55], 4, v[50:51]
v_lshl_add_u32 v48, v48, 8, v19
v_mfma_f32_16x16x16_bf16 v[216:219], a[244:245], a[10:11], v[216:219]
ds_read_b32 a19, v48
v_lshl_add_u32 v49, v49, 8, v19
v_mfma_f32_16x16x16_bf16 v[220:223], a[244:245], a[14:15], v[220:223]
s_waitcnt lgkmcnt(3)
ds_read_b32 a23, v49
buffer_load_dwordx4 v[32:35], v12, s[24:27], 0 offen offset:0 sc1
v_mfma_f32_16x16x16_bf16 v[224:227], a[248:249], a[2:3], v[224:227]
ds_read_b128 a[224:227], v4 offset:0
v_lshl_add_u32 v50, v50, 8, v19
v_mfma_f32_16x16x16_bf16 v[228:231], a[248:249], a[6:7], v[228:231]
ds_read_b32 a27, v50
v_lshl_add_u32 v51, v51, 8, v19
v_mfma_f32_16x16x16_bf16 v[232:235], a[248:249], a[10:11], v[232:235]
ds_read_b32 a31, v51
buffer_load_dwordx4 v[36:39], v12, s[24:27], 0 offen offset:1024 sc1
v_mfma_f32_16x16x16_bf16 v[236:239], a[248:249], a[14:15], v[236:239]
s_waitcnt lgkmcnt(4)
v_mfma_f32_16x16x16_bf16 v[240:243], a[252:253], a[2:3], v[240:243]
ds_read_b128 a[228:231], v4 offset:2048
v_mfma_f32_16x16x16_bf16 v[244:247], a[252:253], a[6:7], v[244:247]
v_mfma_f32_16x16x16_bf16 v[248:251], a[252:253], a[10:11], v[248:251]
v_mfma_f32_16x16x16_bf16 v[252:255], a[252:253], a[14:15], v[252:255]
s_waitcnt lgkmcnt(1)
v_mfma_f32_16x16x32_bf16 v[128:131], a[224:227], a[16:19], v[128:131]
ds_read_b128 a[232:235], v4 offset:4096
v_mfma_f32_16x16x32_bf16 v[132:135], a[224:227], a[20:23], v[132:135]
v_mfma_f32_16x16x32_bf16 v[136:139], a[224:227], a[24:27], v[136:139]
buffer_load_dwordx4 v[96:99], v12, s[24:27], 0 offen offset:2048 sc1
v_mfma_f32_16x16x32_bf16 v[140:143], a[224:227], a[28:31], v[140:143]
s_waitcnt lgkmcnt(1)
buffer_load_dwordx4 v[100:103], v12, s[24:27], 0 offen offset:3072 sc1
v_mfma_f32_16x16x32_bf16 v[144:147], a[228:231], a[16:19], v[144:147]
ds_read_b128 a[236:239], v4 offset:6144
v_lshl_add_u32 v12, s42, 5, v13
v_mfma_f32_16x16x32_bf16 v[148:151], a[228:231], a[20:23], v[148:151]
v_mfma_f32_16x16x32_bf16 v[152:155], a[228:231], a[24:27], v[152:155]
v_mfma_f32_16x16x32_bf16 v[156:159], a[228:231], a[28:31], v[156:159]
s_waitcnt lgkmcnt(1)
v_mfma_f32_16x16x32_bf16 v[160:163], a[232:235], a[16:19], v[160:163]
ds_read_b128 a[240:243], v4 offset:8192
v_mfma_f32_16x16x32_bf16 v[164:167], a[232:235], a[20:23], v[164:167]
v_mfma_f32_16x16x32_bf16 v[168:171], a[232:235], a[24:27], v[168:171]
v_mfma_f32_16x16x32_bf16 v[172:175], a[232:235], a[28:31], v[172:175]
s_waitcnt lgkmcnt(1)
v_mfma_f32_16x16x32_bf16 v[176:179], a[236:239], a[16:19], v[176:179]
ds_read_b128 a[244:247], v4 offset:10240
buffer_load_dwordx4 v[40:43], v12, s[24:27], 0 offen offset:0 sc1
v_mfma_f32_16x16x32_bf16 v[180:183], a[236:239], a[20:23], v[180:183]
buffer_load_dwordx4 v[44:47], v12, s[24:27], 0 offen offset:1024 sc1
v_mfma_f32_16x16x32_bf16 v[184:187], a[236:239], a[24:27], v[184:187]
s_add_u32 m0, s33, 98304
v_mfma_f32_16x16x32_bf16 v[188:191], a[236:239], a[28:31], v[188:191]
s_waitcnt lgkmcnt(1)
v_mfma_f32_16x16x32_bf16 v[192:195], a[240:243], a[16:19], v[192:195]
buffer_load_dwordx4 v8, s[20:23], s42 offen lds
v_mfma_f32_16x16x32_bf16 v[196:199], a[240:243], a[20:23], v[196:199]
v_mfma_f32_16x16x32_bf16 v[200:203], a[240:243], a[24:27], v[200:203]
s_add_u32 m0, s33, 102400
v_mfma_f32_16x16x32_bf16 v[204:207], a[240:243], a[28:31], v[204:207]
s_waitcnt lgkmcnt(0)
v_mfma_f32_16x16x32_bf16 v[208:211], a[244:247], a[16:19], v[208:211]
s_waitcnt vmcnt(8)
s_barrier
ds_read_b128 a[248:251], v4 offset:12288
buffer_load_dwordx4 v9, s[20:23], s42 offen lds
v_mfma_f32_16x16x32_bf16 v[212:215], a[244:247], a[20:23], v[212:215]
buffer_load_dwordx4 v[48:51], v12, s[24:27], 0 offen offset:2048 sc1
v_mfma_f32_16x16x32_bf16 v[216:219], a[244:247], a[24:27], v[216:219]
buffer_load_dwordx4 v[52:55], v12, s[24:27], 0 offen offset:3072 sc1
v_lshl_add_u32 v12, s43, 5, v13
v_mfma_f32_16x16x32_bf16 v[220:223], a[244:247], a[28:31], v[220:223]
s_add_u32 m0, s33, 106496
ds_read_b128 a[252:255], v4 offset:14336
buffer_load_dwordx4 v10, s[20:23], s42 offen lds
s_waitcnt vmcnt(9)
v_cmp_ne_u64 s[50:51], s[88:89], v[34:35]
v_cmp_ne_u64 s[44:45], s[88:89], v[38:39]
s_or_b64 s[50:51], s[44:45], s[50:51]
s_cbranch_scc1 L_SLOW2
L_BACK2:
v_perm_b32 v64, v32, v19, s52
v_perm_b32 v65, v32, v19, s53
v_perm_b32 v66, v36, v19, s52
v_perm_b32 v67, v36, v19, s53
v_perm_b32 v68, v32, v19, s54
v_perm_b32 v69, v32, v19, s55
v_perm_b32 v70, v36, v19, s54
v_perm_b32 v71, v36, v19, s55
ds_read_b32 a32, v64
ds_read_b32 a33, v65
ds_read_b32 a34, v66
ds_read_b32 a35, v67
ds_read_b32 a36, v68
ds_read_b32 a37, v69
ds_read_b32 a38, v70
ds_read_b32 a39, v71
v_perm_b32 v72, v33, v19, s52
v_perm_b32 v73, v33, v19, s53
v_perm_b32 v74, v37, v19, s52
v_perm_b32 v75, v37, v19, s53
v_perm_b32 v76, v33, v19, s54
v_perm_b32 v77, v33, v19, s55
v_perm_b32 v78, v37, v19, s54
v_perm_b32 v79, v37, v19, s55
ds_read_b32 a40, v72
ds_read_b32 a41, v73
ds_read_b32 a42, v74
ds_read_b32 a43, v75
ds_read_b32 a44, v76
ds_read_b32 a45, v77
ds_read_b32 a46, v78
ds_read_b32 a47, v79
s_waitcnt vmcnt(7)
s_add_u32 m0, s33, 110592
v_cmp_ne_u64 s[50:51], s[88:89], v[98:99]
v_cmp_ne_u64 s[44:45], s[88:89], v[102:103]
s_waitcnt lgkmcnt(15)
v_mfma_f32_16x16x32_bf16 v[224:227], a[248:251], a[16:19], v[224:227]
s_or_b64 s[50:51], s[44:45], s[50:51]
ds_read_b128 a[224:227], v14 offset:16384
buffer_load_dwordx4 v11, s[20:23], s42 offen lds
v_mfma_f32_16x16x32_bf16 v[228:231], a[248:251], a[20:23], v[228:231]
s_cbranch_scc1 L_SLOW3
L_BACK3:
v_mfma_f32_16x16x32_bf16 v[232:235], a[248:251], a[24:27], v[232:235]
s_add_u32 m0, s33, 114688
v_mfma_f32_16x16x32_bf16 v[236:239], a[248:251], a[28:31], v[236:239]
v_mfma_f32_16x16x32_bf16 v[240:243], a[252:255], a[16:19], v[240:243]
ds_read_b128 a[228:231], v14 offset:18432
buffer_load_dwordx4 v8, s[20:23], s43 offen lds
v_mfma_f32_16x16x32_bf16 v[244:247], a[252:255], a[20:23], v[244:247]
buffer_load_dwordx4 v[104:107], v30, s[16:19], 0 offen
v_mfma_f32_16x16x32_bf16 v[248:251], a[252:255], a[24:27], v[248:251]
s_add_u32 m0, s33, 118784
v_mfma_f32_16x16x32_bf16 v[252:255], a[252:255], a[28:31], v[252:255]
s_waitcnt lgkmcnt(1)
v_mfma_f32_16x16x32_bf16 v[128:131], a[224:227], a[32:35], v[128:131]
ds_read_b128 a[232:235], v14 offset:20480
buffer_load_dwordx4 v9, s[20:23], s43 offen lds
v_mfma_f32_16x16x32_bf16 v[132:135], a[224:227], a[36:39], v[132:135]
v_perm_b32 v63, v96, v19, s52
v_lshlrev_b32 v24, 16, v20
v_mfma_f32_16x16x32_bf16 v[136:139], a[224:227], a[40:43], v[136:139]
s_add_u32 m0, s33, 122880
ds_read_b32 a48, v63
v_perm_b32 v62, v96, v19, s53
v_mfma_f32_16x16x32_bf16 v[140:143], a[224:227], a[44:47], v[140:143]
s_waitcnt lgkmcnt(2)
ds_read_b32 a49, v62
v_perm_b32 v61, v100, v19, s52
v_mfma_f32_16x16x32_bf16 v[144:147], a[228:231], a[32:35], v[144:147]
ds_read_b128 a[236:239], v14 offset:22528
buffer_load_dwordx4 v10, s[20:23], s43 offen lds
v_mfma_f32_16x16x32_bf16 v[148:151], a[228:231], a[36:39], v[148:151]
buffer_load_dwordx4 v[108:111], v30, s[16:19], s92 offen
v_mfma_f32_16x16x32_bf16 v[152:155], a[228:231], a[40:43], v[152:155]
s_add_u32 m0, s33, 126976
ds_read_b32 a50, v61
v_perm_b32 v60, v100, v19, s53
v_mfma_f32_16x16x32_bf16 v[156:159], a[228:231], a[44:47], v[156:159]
s_waitcnt lgkmcnt(3)
ds_read_b32 a51, v60
v_perm_b32 v59, v96, v19, s54
v_mfma_f32_16x16x32_bf16 v[160:163], a[232:235], a[32:35], v[160:163]
ds_read_b128 a[240:243], v14 offset:24576
buffer_load_dwordx4 v11, s[20:23], s43 offen lds
v_mfma_f32_16x16x32_bf16 v[164:167], a[232:235], a[36:39], v[164:167]
ds_read_b32 a52, v59
v_perm_b32 v58, v96, v19, s55
v_mfma_f32_16x16x32_bf16 v[168:171], a[232:235], a[40:43], v[168:171]
ds_read_b32 a53, v58
v_perm_b32 v57, v100, v19, s54
v_mfma_f32_16x16x32_bf16 v[172:175], a[232:235], a[44:47], v[172:175]
s_waitcnt lgkmcnt(4)
ds_read_b32 a54, v57
buffer_load_dwordx4 v[80:83], v12, s[24:27], 0 offen offset:0 sc1
v_mfma_f32_16x16x32_bf16 v[176:179], a[236:239], a[32:35], v[176:179]
ds_read_b128 a[244:247], v14 offset:26624
v_perm_b32 v56, v100, v19, s55
v_mfma_f32_16x16x32_bf16 v[180:183], a[236:239], a[36:39], v[180:183]
buffer_load_dwordx4 v[112:115], v30, s[16:19], s93 offen
v_mfma_f32_16x16x32_bf16 v[184:187], a[236:239], a[40:43], v[184:187]
ds_read_b32 a55, v56
v_perm_b32 v63, v97, v19, s52
v_mfma_f32_16x16x32_bf16 v[188:191], a[236:239], a[44:47], v[188:191]
s_waitcnt lgkmcnt(3)
ds_read_b32 a56, v63
buffer_load_dwordx4 v[84:87], v12, s[24:27], 0 offen offset:1024 sc1
v_mfma_f32_16x16x32_bf16 v[192:195], a[240:243], a[32:35], v[192:195]
ds_read_b128 a[248:251], v14 offset:28672
v_perm_b32 v62, v97, v19, s53
v_mfma_f32_16x16x32_bf16 v[196:199], a[240:243], a[36:39], v[196:199]
ds_read_b32 a57, v62
v_perm_b32 v61, v101, v19, s52
v_mfma_f32_16x16x32_bf16 v[200:203], a[240:243], a[40:43], v[200:203]
s_add_u32 m0, s33, 130560
ds_read_b32 a58, v61
v_perm_b32 v60, v101, v19, s53
v_mfma_f32_16x16x32_bf16 v[204:207], a[240:243], a[44:47], v[204:207]
s_waitcnt lgkmcnt(4)
ds_read_b32 a59, v60
v_perm_b32 v59, v97, v19, s54
v_mfma_f32_16x16x32_bf16 v[208:211], a[244:247], a[32:35], v[208:211]
ds_read_b128 a[252:255], v14 offset:30720
buffer_load_dwordx4 v8, s[20:23], 0 offen offset:512 lds
v_mfma_f32_16x16x32_bf16 v[212:215], a[244:247], a[36:39], v[212:215]
buffer_load_dwordx4 v[116:119], v30, s[16:19], s94 offen
v_mfma_f32_16x16x32_bf16 v[216:219], a[244:247], a[40:43], v[216:219]
ds_read_b32 a60, v59
v_perm_b32 v58, v97, v19, s55
v_mfma_f32_16x16x32_bf16 v[220:223], a[244:247], a[44:47], v[220:223]
s_waitcnt lgkmcnt(3)
ds_read_b32 a61, v58
v_and_b32 v25, 0xffff0000, v20
v_mfma_f32_16x16x32_bf16 v[224:227], a[248:251], a[32:35], v[224:227]
ds_read_b128 a[224:227], v15 offset:16384
v_perm_b32 v57, v101, v19, s54
v_mfma_f32_16x16x32_bf16 v[228:231], a[248:251], a[36:39], v[228:231]
ds_read_b32 a62, v57
v_perm_b32 v56, v101, v19, s55
v_mfma_f32_16x16x32_bf16 v[232:235], a[248:251], a[40:43], v[232:235]
ds_read_b32 a63, v56
v_lshlrev_b32 v26, 16, v21
v_mfma_f32_16x16x32_bf16 v[236:239], a[248:251], a[44:47], v[236:239]
s_waitcnt lgkmcnt(4)
v_and_b32 v27, 0xffff0000, v21
v_mfma_f32_16x16x32_bf16 v[240:243], a[252:255], a[32:35], v[240:243]
ds_read_b128 a[228:231], v15 offset:18432
v_mfma_f32_16x16x32_bf16 v[244:247], a[252:255], a[36:39], v[244:247]
v_mfma_f32_16x16x32_bf16 v[248:251], a[252:255], a[40:43], v[248:251]
s_waitcnt vmcnt(17)
v_cmp_ne_u64 s[50:51], s[88:89], v[42:43]
v_cmp_ne_u64 s[44:45], s[88:89], v[46:47]
v_mfma_f32_16x16x32_bf16 v[252:255], a[252:255], a[44:47], v[252:255]
s_waitcnt lgkmcnt(1)
v_mfma_f32_16x16x32_bf16 v[128:131], a[224:227], a[48:51], v[128:131]
s_or_b64 s[50:51], s[44:45], s[50:51]
ds_read_b128 a[232:235], v15 offset:20480
buffer_load_dwordx4 v[88:91], v12, s[24:27], 0 offen offset:2048 sc1
v_mfma_f32_16x16x32_bf16 v[132:135], a[224:227], a[52:55], v[132:135]
s_cbranch_scc1 L_SLOW4
L_BACK4:
v_mfma_f32_16x16x32_bf16 v[136:139], a[224:227], a[56:59], v[136:139]
buffer_load_dwordx4 v[92:95], v12, s[24:27], 0 offen offset:3072 sc1
v_perm_b32 v63, v40, v19, s52
v_mfma_f32_16x16x32_bf16 v[140:143], a[224:227], a[60:63], v[140:143]
s_waitcnt lgkmcnt(1)
ds_read_b32 a64, v63
v_add_u32 v12, 16384, v13
v_mfma_f32_16x16x32_bf16 v[144:147], a[228:231], a[48:51], v[144:147]
ds_read_b128 a[236:239], v15 offset:22528
v_perm_b32 v62, v40, v19, s53
v_mfma_f32_16x16x32_bf16 v[148:151], a[228:231], a[52:55], v[148:151]
ds_read_b32 a65, v62
v_perm_b32 v61, v44, v19, s52
v_mfma_f32_16x16x32_bf16 v[152:155], a[228:231], a[56:59], v[152:155]
ds_read_b32 a66, v61
v_perm_b32 v60, v44, v19, s53
v_mfma_f32_16x16x32_bf16 v[156:159], a[228:231], a[60:63], v[156:159]
s_waitcnt lgkmcnt(4)
ds_read_b32 a67, v60
v_mfma_f32_16x16x32_bf16 v[160:163], a[232:235], a[48:51], v[160:163]
ds_read_b128 a[240:243], v15 offset:24576
v_perm_b32 v59, v40, v19, s54
v_mfma_f32_16x16x32_bf16 v[164:167], a[232:235], a[52:55], v[164:167]
ds_read_b32 a68, v59
v_perm_b32 v58, v40, v19, s55
v_mfma_f32_16x16x32_bf16 v[168:171], a[232:235], a[56:59], v[168:171]
s_add_u32 m0, s33, 134656
ds_read_b32 a69, v58
v_perm_b32 v57, v44, v19, s54
v_mfma_f32_16x16x32_bf16 v[172:175], a[232:235], a[60:63], v[172:175]
s_waitcnt lgkmcnt(4)
ds_read_b32 a70, v57
v_perm_b32 v56, v44, v19, s55
v_mfma_f32_16x16x32_bf16 v[176:179], a[236:239], a[48:51], v[176:179]
ds_read_b128 a[244:247], v15 offset:26624
buffer_load_dwordx4 v9, s[20:23], 0 offen offset:512 lds
v_mfma_f32_16x16x32_bf16 v[180:183], a[236:239], a[52:55], v[180:183]
ds_read_b32 a71, v56
v_perm_b32 v63, v41, v19, s52
v_mfma_f32_16x16x32_bf16 v[184:187], a[236:239], a[56:59], v[184:187]
ds_read_b32 a72, v63
v_perm_b32 v62, v41, v19, s53
v_mfma_f32_16x16x32_bf16 v[188:191], a[236:239], a[60:63], v[188:191]
s_waitcnt lgkmcnt(4)
ds_read_b32 a73, v62
v_mfma_f32_16x16x32_bf16 v[192:195], a[240:243], a[48:51], v[192:195]
s_waitcnt vmcnt(13)
s_barrier
ds_read_b128 a[248:251], v15 offset:28672
v_perm_b32 v61, v45, v19, s52
v_mfma_f32_16x16x32_bf16 v[196:199], a[240:243], a[52:55], v[196:199]
ds_read_b32 a74, v61
v_perm_b32 v60, v45, v19, s53
v_mfma_f32_16x16x32_bf16 v[200:203], a[240:243], a[56:59], v[200:203]
ds_read_b32 a75, v60
v_perm_b32 v59, v41, v19, s54
v_mfma_f32_16x16x32_bf16 v[204:207], a[240:243], a[60:63], v[204:207]
s_waitcnt lgkmcnt(4)
ds_read_b32 a76, v59
v_mfma_f32_16x16x32_bf16 v[208:211], a[244:247], a[48:51], v[208:211]
ds_read_b128 a[252:255], v15 offset:30720
v_perm_b32 v58, v41, v19, s55
v_mfma_f32_16x16x32_bf16 v[212:215], a[244:247], a[52:55], v[212:215]
ds_read_b32 a77, v58
v_perm_b32 v57, v45, v19, s54
v_mfma_f32_16x16x32_bf16 v[216:219], a[244:247], a[56:59], v[216:219]
v_cmp_ne_u64 s[50:51], s[88:89], v[50:51]
v_cmp_ne_u64 s[44:45], s[88:89], v[54:55]
v_mfma_f32_16x16x32_bf16 v[220:223], a[244:247], a[60:63], v[220:223]
s_waitcnt lgkmcnt(3)
ds_read_b32 a78, v57
v_mfma_f32_16x16x32_bf16 v[224:227], a[248:251], a[48:51], v[224:227]
s_or_b64 s[50:51], s[44:45], s[50:51]
ds_read_b128 a[224:227], v14 offset:32768
v_perm_b32 v56, v45, v19, s55
v_mfma_f32_16x16x32_bf16 v[228:231], a[248:251], a[52:55], v[228:231]
s_cbranch_scc1 L_SLOW5
L_BACK5:
v_mfma_f32_16x16x32_bf16 v[232:235], a[248:251], a[56:59], v[232:235]
s_add_u32 m0, s33, 138752
ds_read_b32 a79, v56
v_mfma_f32_16x16x32_bf16 v[236:239], a[248:251], a[60:63], v[236:239]
s_waitcnt lgkmcnt(3)
v_perm_b32 v63, v48, v19, s52
v_mfma_f32_16x16x32_bf16 v[240:243], a[252:255], a[48:51], v[240:243]
ds_read_b128 a[228:231], v14 offset:34816
buffer_load_dwordx4 v10, s[20:23], 0 offen offset:512 lds
v_mfma_f32_16x16x32_bf16 v[244:247], a[252:255], a[52:55], v[244:247]
ds_read_b32 a80, v63
v_perm_b32 v62, v48, v19, s53
v_mfma_f32_16x16x32_bf16 v[248:251], a[252:255], a[56:59], v[248:251]
ds_read_b32 a81, v62
v_perm_b32 v61, v52, v19, s52
v_mfma_f32_16x16x32_bf16 v[252:255], a[252:255], a[60:63], v[252:255]
s_waitcnt lgkmcnt(3)
ds_read_b32 a82, v61
v_mfma_f32_16x16x32_bf16 v[128:131], a[224:227], a[64:67], v[128:131]
ds_read_b128 a[232:235], v14 offset:36864
v_perm_b32 v60, v52, v19, s53
v_mfma_f32_16x16x32_bf16 v[132:135], a[224:227], a[68:71], v[132:135]
ds_read_b32 a83, v60
v_perm_b32 v59, v48, v19, s54
v_mfma_f32_16x16x32_bf16 v[136:139], a[224:227], a[72:75], v[136:139]
ds_read_b32 a84, v59
v_perm_b32 v58, v48, v19, s55
v_mfma_f32_16x16x32_bf16 v[140:143], a[224:227], a[76:79], v[140:143]
s_waitcnt lgkmcnt(4)
ds_read_b32 a85, v58
buffer_load_dwordx4 v[32:35], v12, s[24:27], 0 offen offset:0 sc1
v_mfma_f32_16x16x32_bf16 v[144:147], a[228:231], a[64:67], v[144:147]
ds_read_b128 a[236:239], v14 offset:38912
v_perm_b32 v57, v52, v19, s54
v_mfma_f32_16x16x32_bf16 v[148:151], a[228:231], a[68:71], v[148:151]
ds_read_b32 a86, v57
v_perm_b32 v56, v52, v19, s55
v_mfma_f32_16x16x32_bf16 v[152:155], a[228:231], a[72:75], v[152:155]
s_add_u32 m0, s33, 142848
ds_read_b32 a87, v56
v_perm_b32 v63, v49, v19, s52
v_mfma_f32_16x16x32_bf16 v[156:159], a[228:231], a[76:79], v[156:159]
s_waitcnt lgkmcnt(4)
ds_read_b32 a88, v63
v_perm_b32 v62, v49, v19, s53
v_mfma_f32_16x16x32_bf16 v[160:163], a[232:235], a[64:67], v[160:163]
ds_read_b128 a[240:243], v14 offset:40960
buffer_load_dwordx4 v11, s[20:23], 0 offen offset:512 lds
v_mfma_f32_16x16x32_bf16 v[164:167], a[232:235], a[68:71], v[164:167]
ds_read_b32 a89, v62
v_perm_b32 v61, v53, v19, s52
v_mfma_f32_16x16x32_bf16 v[168:171], a[232:235], a[72:75], v[168:171]
L_PAD1:
s_cbranch_vccnz L_PADRET
ds_read_b32 a90, v61
v_perm_b32 v60, v53, v19, s53
v_mfma_f32_16x16x32_bf16 v[172:175], a[232:235], a[76:79], v[172:175]
s_waitcnt lgkmcnt(4)
ds_read_b32 a91, v60
buffer_load_dwordx4 v[36:39], v12, s[24:27], 0 offen offset:1024 sc1
v_mfma_f32_16x16x32_bf16 v[176:179], a[236:239], a[64:67], v[176:179]
ds_read_b128 a[244:247], v14 offset:43008
v_perm_b32 v59, v49, v19, s54
v_mfma_f32_16x16x32_bf16 v[180:183], a[236:239], a[68:71], v[180:183]
ds_read_b32 a92, v59
v_perm_b32 v58, v49, v19, s55
v_mfma_f32_16x16x32_bf16 v[184:187], a[236:239], a[72:75], v[184:187]
s_waitcnt vmcnt(9)
v_cmp_ne_u64 s[50:51], s[88:89], v[82:83]
v_cmp_ne_u64 s[44:45], s[88:89], v[86:87]
v_mfma_f32_16x16x32_bf16 v[188:191], a[236:239], a[76:79], v[188:191]
s_waitcnt lgkmcnt(3)
ds_read_b32 a93, v58
v_mfma_f32_16x16x32_bf16 v[192:195], a[240:243], a[64:67], v[192:195]
s_or_b64 s[50:51], s[44:45], s[50:51]
ds_read_b128 a[248:251], v14 offset:45056
v_perm_b32 v57, v53, v19, s54
v_mfma_f32_16x16x32_bf16 v[196:199], a[240:243], a[68:71], v[196:199]
s_cbranch_scc1 L_SLOW6
L_BACK6:
v_mfma_f32_16x16x32_bf16 v[200:203], a[240:243], a[72:75], v[200:203]
s_add_u32 m0, s33, 146816
ds_read_b32 a94, v57
v_perm_b32 v56, v53, v19, s55
v_mfma_f32_16x16x32_bf16 v[204:207], a[240:243], a[76:79], v[204:207]
s_waitcnt lgkmcnt(3)
ds_read_b32 a95, v56
v_perm_b32 v63, v80, v19, s52
v_mfma_f32_16x16x32_bf16 v[208:211], a[244:247], a[64:67], v[208:211]
ds_read_b128 a[252:255], v14 offset:47104
buffer_load_dwordx4 v8, s[20:23], 0 offen offset:640 lds
v_mfma_f32_16x16x32_bf16 v[212:215], a[244:247], a[68:71], v[212:215]
ds_read_b32 a96, v63
v_perm_b32 v62, v80, v19, s53
v_mfma_f32_16x16x32_bf16 v[216:219], a[244:247], a[72:75], v[216:219]
ds_read_b32 a97, v62
v_perm_b32 v61, v84, v19, s52
v_mfma_f32_16x16x32_bf16 v[220:223], a[244:247], a[76:79], v[220:223]
s_waitcnt lgkmcnt(4)
ds_read_b32 a98, v61
v_mfma_f32_16x16x32_bf16 v[224:227], a[248:251], a[64:67], v[224:227]
ds_read_b128 a[224:227], v15 offset:32768
v_perm_b32 v60, v84, v19, s53
v_mfma_f32_16x16x32_bf16 v[228:231], a[248:251], a[68:71], v[228:231]
ds_read_b32 a99, v60
v_perm_b32 v59, v80, v19, s54
v_mfma_f32_16x16x32_bf16 v[232:235], a[248:251], a[72:75], v[232:235]
ds_read_b32 a100, v59
v_perm_b32 v58, v80, v19, s55
v_mfma_f32_16x16x32_bf16 v[236:239], a[248:251], a[76:79], v[236:239]
s_waitcnt lgkmcnt(4)
ds_read_b32 a101, v58
v_mfma_f32_16x16x32_bf16 v[240:243], a[252:255], a[64:67], v[240:243]
ds_read_b128 a[228:231], v15 offset:36864
v_perm_b32 v57, v84, v19, s54
v_mfma_f32_16x16x32_bf16 v[244:247], a[252:255], a[68:71], v[244:247]
ds_read_b32 a102, v57
v_perm_b32 v56, v84, v19, s55
v_mfma_f32_16x16x32_bf16 v[248:251], a[252:255], a[72:75], v[248:251]
ds_read_b32 a103, v56
v_perm_b32 v63, v81, v19, s52
v_mfma_f32_16x16x32_bf16 v[252:255], a[252:255], a[76:79], v[252:255]
s_waitcnt lgkmcnt(4)
ds_read_b32 a104, v63
v_mfma_f32_16x16x32_bf16 v[128:131], a[224:227], a[80:83], v[128:131]
ds_read_b128 a[232:235], v15 offset:40960
v_perm_b32 v62, v81, v19, s53
v_mfma_f32_16x16x32_bf16 v[132:135], a[224:227], a[84:87], v[132:135]
ds_read_b32 a105, v62
v_perm_b32 v61, v85, v19, s52
v_mfma_f32_16x16x32_bf16 v[136:139], a[224:227], a[88:91], v[136:139]
ds_read_b32 a106, v61
v_perm_b32 v60, v85, v19, s53
v_mfma_f32_16x16x32_bf16 v[140:143], a[224:227], a[92:95], v[140:143]
s_waitcnt lgkmcnt(4)
ds_read_b32 a107, v60
buffer_load_dwordx4 v[96:99], v12, s[24:27], 0 offen offset:2048 sc1
v_mfma_f32_16x16x32_bf16 v[160:163], a[228:231], a[80:83], v[160:163]
ds_read_b128 a[236:239], v15 offset:45056
v_perm_b32 v59, v81, v19, s54
v_mfma_f32_16x16x32_bf16 v[164:167], a[228:231], a[84:87], v[164:167]
s_waitcnt vmcnt(9)
ds_read_b32 a108, v59
v_perm_b32 v58, v81, v19, s55
v_lshl_add_u64 v[104:105], v[108:109], 4, v[104:105]
v_lshl_add_u64 v[106:107], v[110:111], 4, v[106:107]
v_lshl_add_u64 v[112:113], v[116:117], 4, v[112:113]
v_lshl_add_u64 v[114:115], v[118:119], 4, v[114:115]
v_lshl_or_b32 v116, v112, 8, v104
v_lshl_or_b32 v117, v113, 8, v105
v_lshl_or_b32 v118, v114, 8, v106
v_lshl_or_b32 v119, v115, 8, v107
v_lshl_or_b32 v108, v117, 16, v116
v_lshl_or_b32 v109, v119, 16, v118
v_mov_b64 v[110:111], s[88:89]
v_mfma_f32_16x16x32_bf16 v[168:171], a[228:231], a[88:91], v[168:171]
s_add_u32 m0, s33, 150912
ds_read_b32 a109, v58
v_perm_b32 v57, v85, v19, s54
v_mfma_f32_16x16x32_bf16 v[172:175], a[228:231], a[92:95], v[172:175]
s_waitcnt lgkmcnt(4)
ds_read_b32 a110, v57
buffer_load_dwordx4 v[100:103], v12, s[24:27], 0 offen offset:3072 sc1
v_mfma_f32_16x16x32_bf16 v[192:195], a[232:235], a[80:83], v[192:195]
ds_read_b128 a[240:243], v15 offset:34816
buffer_load_dwordx4 v9, s[20:23], 0 offen offset:640 lds
v_mfma_f32_16x16x32_bf16 v[196:199], a[232:235], a[84:87], v[196:199]
buffer_store_dwordx4 v[108:111], v13, s[76:79], 0 offen sc1
v_mfma_f32_16x16x32_bf16 v[200:203], a[232:235], a[88:91], v[200:203]
ds_read_b128 a[244:247], v14 offset:51200
v_perm_b32 v56, v85, v19, s55
v_mfma_f32_16x16x32_bf16 v[204:207], a[232:235], a[92:95], v[204:207]
s_waitcnt lgkmcnt(3)
ds_read_b32 a111, v56
v_add_u32 v12, 20480, v13
v_mfma_f32_16x16x32_bf16 v[224:227], a[236:239], a[80:83], v[224:227]
s_waitcnt vmcnt(10)
v_cmp_ne_u64 s[50:51], s[88:89], v[90:91]
v_cmp_ne_u64 s[44:45], s[88:89], v[94:95]
v_mfma_f32_16x16x32_bf16 v[228:231], a[236:239], a[84:87], v[228:231]
v_mfma_f32_16x16x32_bf16 v[232:235], a[236:239], a[88:91], v[232:235]
s_or_b64 s[50:51], s[44:45], s[50:51]
v_mfma_f32_16x16x32_bf16 v[236:239], a[236:239], a[92:95], v[236:239]
s_waitcnt lgkmcnt(1)
v_mfma_f32_16x16x32_bf16 v[144:147], a[240:243], a[80:83], v[144:147]
s_barrier
ds_read_b128 a[248:251], v15 offset:38912
v_mfma_f32_16x16x32_bf16 v[144:147], a[244:247], a[96:99], v[144:147]
s_cbranch_scc1 L_SLOW7
L_BACK7:
v_mfma_f32_16x16x32_bf16 v[148:151], a[244:247], a[100:103], v[148:151]
ds_read_b128 a[252:255], v14 offset:55296
v_mfma_f32_16x16x32_bf16 v[148:151], a[240:243], a[84:87], v[148:151]
s_add_u32 m0, s33, 155008
v_mfma_f32_16x16x32_bf16 v[152:155], a[240:243], a[88:91], v[152:155]
buffer_load_dwordx4 v10, s[20:23], 0 offen offset:640 lds
v_mfma_f32_16x16x32_bf16 v[152:155], a[244:247], a[104:107], v[152:155]
s_waitcnt lgkmcnt(1)
v_perm_b32 v63, v88, v19, s52
v_mfma_f32_16x16x32_bf16 v[156:159], a[244:247], a[108:111], v[156:159]
ds_read_b32 a112, v63
v_perm_b32 v62, v88, v19, s53
v_mfma_f32_16x16x32_bf16 v[156:159], a[240:243], a[92:95], v[156:159]
s_waitcnt lgkmcnt(1)
ds_read_b32 a113, v62
v_mfma_f32_16x16x32_bf16 v[176:179], a[248:251], a[80:83], v[176:179]
ds_read_b128 a[224:227], v15 offset:43008
v_perm_b32 v61, v92, v19, s52
v_mfma_f32_16x16x32_bf16 v[176:179], a[252:255], a[96:99], v[176:179]
ds_read_b32 a114, v61
v_mfma_f32_16x16x32_bf16 v[180:183], a[252:255], a[100:103], v[180:183]
ds_read_b128 a[228:231], v14 offset:59392
v_perm_b32 v60, v92, v19, s53
v_mfma_f32_16x16x32_bf16 v[180:183], a[248:251], a[84:87], v[180:183]
ds_read_b32 a115, v60
v_perm_b32 v59, v88, v19, s54
v_mfma_f32_16x16x32_bf16 v[184:187], a[248:251], a[88:91], v[184:187]
ds_read_b32 a116, v59
v_perm_b32 v58, v88, v19, s55
v_mfma_f32_16x16x32_bf16 v[184:187], a[252:255], a[104:107], v[184:187]
ds_read_b32 a117, v58
v_perm_b32 v57, v92, v19, s54
v_mfma_f32_16x16x32_bf16 v[188:191], a[252:255], a[108:111], v[188:191]
s_add_u32 m0, s33, 159104
ds_read_b32 a118, v57
v_perm_b32 v56, v92, v19, s55
v_mfma_f32_16x16x32_bf16 v[188:191], a[248:251], a[92:95], v[188:191]
s_waitcnt lgkmcnt(4)
ds_read_b32 a119, v56
v_perm_b32 v63, v89, v19, s52
v_mfma_f32_16x16x32_bf16 v[208:211], a[224:227], a[80:83], v[208:211]
ds_read_b128 a[232:235], v15 offset:47104
buffer_load_dwordx4 v11, s[20:23], 0 offen offset:640 lds
v_mfma_f32_16x16x32_bf16 v[208:211], a[228:231], a[96:99], v[208:211]
ds_read_b32 a120, v63
v_mfma_f32_16x16x32_bf16 v[212:215], a[228:231], a[100:103], v[212:215]
ds_read_b128 a[236:239], v14 offset:63488
v_perm_b32 v62, v89, v19, s53
v_mfma_f32_16x16x32_bf16 v[212:215], a[224:227], a[84:87], v[212:215]
ds_read_b32 a121, v62
v_perm_b32 v61, v93, v19, s52
v_mfma_f32_16x16x32_bf16 v[216:219], a[224:227], a[88:91], v[216:219]
ds_read_b32 a122, v61
v_perm_b32 v60, v93, v19, s53
v_mfma_f32_16x16x32_bf16 v[216:219], a[228:231], a[104:107], v[216:219]
ds_read_b32 a123, v60
v_perm_b32 v59, v89, v19, s54
v_mfma_f32_16x16x32_bf16 v[220:223], a[228:231], a[108:111], v[220:223]
ds_read_b32 a124, v59
v_perm_b32 v58, v89, v19, s55
v_mfma_f32_16x16x32_bf16 v[220:223], a[224:227], a[92:95], v[220:223]
s_waitcnt lgkmcnt(4)
ds_read_b32 a125, v58
buffer_load_dwordx4 v[40:43], v12, s[24:27], 0 offen offset:0 sc1
v_mfma_f32_16x16x32_bf16 v[240:243], a[232:235], a[80:83], v[240:243]
ds_read_b128 a[240:243], v14 offset:49152
v_perm_b32 v57, v93, v19, s54
v_mfma_f32_16x16x32_bf16 v[240:243], a[236:239], a[96:99], v[240:243]
ds_read_b32 a126, v57
buffer_load_dwordx4 v[44:47], v12, s[24:27], 0 offen offset:1024 sc1
v_mfma_f32_16x16x32_bf16 v[244:247], a[236:239], a[100:103], v[244:247]
ds_read_b128 a[244:247], v15 offset:49152
v_perm_b32 v56, v93, v19, s55
v_mfma_f32_16x16x32_bf16 v[244:247], a[232:235], a[84:87], v[244:247]
s_add_u32 m0, s33, 64768
ds_read_b32 a127, v56
v_mfma_f32_16x16x32_bf16 v[248:251], a[232:235], a[88:91], v[248:251]
buffer_load_dwordx4 v8, s[20:23], 0 offen offset:768 lds
v_mfma_f32_16x16x32_bf16 v[248:251], a[236:239], a[104:107], v[248:251]
v_mfma_f32_16x16x32_bf16 v[252:255], a[236:239], a[108:111], v[252:255]
v_mfma_f32_16x16x32_bf16 v[252:255], a[232:235], a[92:95], v[252:255]
s_waitcnt vmcnt(10) lgkmcnt(1)
v_cmp_ne_u64 s[50:51], s[88:89], v[34:35]
v_mfma_f32_16x16x32_bf16 v[128:131], a[240:243], a[96:99], v[128:131]
ds_read_b128 a[248:251], v14 offset:53248
v_cmp_ne_u64 s[44:45], s[88:89], v[38:39]
v_mfma_f32_16x16x32_bf16 v[128:131], a[244:247], a[112:115], v[128:131]
v_mfma_f32_16x16x32_bf16 v[132:135], a[244:247], a[116:119], v[132:135]
s_or_b64 s[50:51], s[44:45], s[50:51]
ds_read_b128 a[252:255], v15 offset:53248
v_mfma_f32_16x16x32_bf16 v[132:135], a[240:243], a[100:103], v[132:135]
s_cbranch_scc1 L_SLOW8
L_BACK8:
v_mfma_f32_16x16x32_bf16 v[136:139], a[240:243], a[104:107], v[136:139]
v_perm_b32 v63, v32, v19, s52
v_mfma_f32_16x16x32_bf16 v[136:139], a[244:247], a[120:123], v[136:139]
s_waitcnt lgkmcnt(1)
ds_read_b32 a128, v63
v_perm_b32 v62, v32, v19, s53
v_mfma_f32_16x16x32_bf16 v[140:143], a[244:247], a[124:127], v[140:143]
s_add_u32 m0, s33, 68864
ds_read_b32 a129, v62
v_perm_b32 v61, v36, v19, s52
v_mfma_f32_16x16x32_bf16 v[140:143], a[240:243], a[108:111], v[140:143]
s_waitcnt lgkmcnt(2)
ds_read_b32 a130, v61
v_perm_b32 v60, v36, v19, s53
v_mfma_f32_16x16x32_bf16 v[160:163], a[248:251], a[96:99], v[160:163]
ds_read_b128 a[224:227], v14 offset:57344
buffer_load_dwordx4 v9, s[20:23], 0 offen offset:768 lds
v_mfma_f32_16x16x32_bf16 v[160:163], a[252:255], a[112:115], v[160:163]
ds_read_b32 a131, v60
v_mfma_f32_16x16x32_bf16 v[164:167], a[252:255], a[116:119], v[164:167]
ds_read_b128 a[228:231], v15 offset:57344
v_perm_b32 v59, v32, v19, s54
v_mfma_f32_16x16x32_bf16 v[164:167], a[248:251], a[100:103], v[164:167]
ds_read_b32 a132, v59
v_perm_b32 v58, v32, v19, s55
v_mfma_f32_16x16x32_bf16 v[168:171], a[248:251], a[104:107], v[168:171]
ds_read_b32 a133, v58
v_perm_b32 v57, v36, v19, s54
v_mfma_f32_16x16x32_bf16 v[168:171], a[252:255], a[120:123], v[168:171]
ds_read_b32 a134, v57
v_perm_b32 v56, v36, v19, s55
v_mfma_f32_16x16x32_bf16 v[172:175], a[252:255], a[124:127], v[172:175]
ds_read_b32 a135, v56
v_perm_b32 v63, v33, v19, s52
v_mfma_f32_16x16x32_bf16 v[172:175], a[248:251], a[108:111], v[172:175]
s_waitcnt lgkmcnt(4)
ds_read_b32 a136, v63
v_mfma_f32_16x16x32_bf16 v[192:195], a[224:227], a[96:99], v[192:195]
ds_read_b128 a[232:235], v14 offset:61440
v_perm_b32 v62, v33, v19, s53
v_mfma_f32_16x16x32_bf16 v[192:195], a[228:231], a[112:115], v[192:195]
ds_read_b32 a137, v62
v_mfma_f32_16x16x32_bf16 v[196:199], a[228:231], a[116:119], v[196:199]
ds_read_b128 a[236:239], v15 offset:61440
v_perm_b32 v61, v37, v19, s52
v_mfma_f32_16x16x32_bf16 v[196:199], a[224:227], a[100:103], v[196:199]
s_add_u32 m0, s33, 72960
ds_read_b32 a138, v61
buffer_load_dwordx4 v[48:51], v12, s[24:27], 0 offen offset:2048 sc1
v_mfma_f32_16x16x32_bf16 v[200:203], a[224:227], a[104:107], v[200:203]
buffer_load_dwordx4 v10, s[20:23], 0 offen offset:768 lds
v_perm_b32 v60, v37, v19, s53
v_mfma_f32_16x16x32_bf16 v[200:203], a[228:231], a[120:123], v[200:203]
ds_read_b32 a139, v60
v_perm_b32 v59, v33, v19, s54
v_mfma_f32_16x16x32_bf16 v[204:207], a[228:231], a[124:127], v[204:207]
ds_read_b32 a140, v59
v_perm_b32 v58, v33, v19, s55
v_mfma_f32_16x16x32_bf16 v[204:207], a[224:227], a[108:111], v[204:207]
s_waitcnt lgkmcnt(3)
ds_read_b32 a141, v58
buffer_load_dwordx4 v[52:55], v12, s[24:27], 0 offen offset:3072 sc1
v_mfma_f32_16x16x32_bf16 v[224:227], a[232:235], a[96:99], v[224:227]
ds_read_b128 a[240:243], v15 offset:51200
v_perm_b32 v57, v37, v19, s54
v_mfma_f32_16x16x32_bf16 v[224:227], a[236:239], a[112:115], v[224:227]
ds_read_b32 a142, v57
v_add_u32 v12, 24576, v13
v_mfma_f32_16x16x32_bf16 v[228:231], a[236:239], a[116:119], v[228:231]
ds_read_b128 a[244:247], v16 offset:2048
v_perm_b32 v56, v37, v19, s55
v_mfma_f32_16x16x32_bf16 v[228:231], a[232:235], a[100:103], v[228:231]
s_add_u32 m0, s33, 77056
ds_read_b32 a143, v56
v_mfma_f32_16x16x32_bf16 v[232:235], a[232:235], a[104:107], v[232:235]
buffer_load_dwordx4 v11, s[20:23], 0 offen offset:768 lds
v_mfma_f32_16x16x32_bf16 v[232:235], a[236:239], a[120:123], v[232:235]
v_mfma_f32_16x16x32_bf16 v[236:239], a[236:239], a[124:127], v[236:239]
v_mfma_f32_16x16x32_bf16 v[236:239], a[232:235], a[108:111], v[236:239]
s_waitcnt vmcnt(12) lgkmcnt(1)
v_cmp_ne_u64 s[50:51], s[88:89], v[98:99]
v_mfma_f32_16x16x32_bf16 v[144:147], a[240:243], a[112:115], v[144:147]
s_barrier
ds_read_b128 a[248:251], v15 offset:55296
v_cmp_ne_u64 s[44:45], s[88:89], v[102:103]
v_mfma_f32_16x16x32_bf16 v[144:147], a[244:247], a[128:131], v[144:147]
v_mfma_f32_16x16x32_bf16 v[148:151], a[244:247], a[132:135], v[148:151]
s_or_b64 s[50:51], s[44:45], s[50:51]
ds_read_b128 a[252:255], v16 offset:6144
v_mfma_f32_16x16x32_bf16 v[148:151], a[240:243], a[116:119], v[148:151]
s_cbranch_scc1 L_SLOW9
L_BACK9:
v_mfma_f32_16x16x32_bf16 v[152:155], a[240:243], a[120:123], v[152:155]
v_perm_b32 v63, v96, v19, s52
v_mfma_f32_16x16x32_bf16 v[152:155], a[244:247], a[136:139], v[152:155]
s_waitcnt lgkmcnt(1)
ds_read_b32 a144, v63
v_perm_b32 v62, v96, v19, s53
v_mfma_f32_16x16x32_bf16 v[156:159], a[244:247], a[140:143], v[156:159]
ds_read_b32 a145, v62
v_perm_b32 v61, v100, v19, s52
v_mfma_f32_16x16x32_bf16 v[156:159], a[240:243], a[124:127], v[156:159]
s_waitcnt lgkmcnt(2)
ds_read_b32 a146, v61
v_mfma_f32_16x16x32_bf16 v[176:179], a[248:251], a[112:115], v[176:179]
ds_read_b128 a[224:227], v15 offset:59392
v_perm_b32 v60, v100, v19, s53
v_mfma_f32_16x16x32_bf16 v[176:179], a[252:255], a[128:131], v[176:179]
ds_read_b32 a147, v60
v_mfma_f32_16x16x32_bf16 v[180:183], a[252:255], a[132:135], v[180:183]
ds_read_b128 a[228:231], v16 offset:10240
v_perm_b32 v59, v96, v19, s54
v_mfma_f32_16x16x32_bf16 v[180:183], a[248:251], a[116:119], v[180:183]
s_add_u32 m0, s33, 81024
ds_read_b32 a148, v59
v_mfma_f32_16x16x32_bf16 v[184:187], a[248:251], a[120:123], v[184:187]
buffer_load_dwordx4 v8, s[20:23], 0 offen offset:896 lds
v_perm_b32 v58, v96, v19, s55
v_mfma_f32_16x16x32_bf16 v[184:187], a[252:255], a[136:139], v[184:187]
ds_read_b32 a149, v58
v_perm_b32 v57, v100, v19, s54
v_mfma_f32_16x16x32_bf16 v[188:191], a[252:255], a[140:143], v[188:191]
ds_read_b32 a150, v57
v_perm_b32 v56, v100, v19, s55
v_mfma_f32_16x16x32_bf16 v[188:191], a[248:251], a[124:127], v[188:191]
s_waitcnt lgkmcnt(3)
ds_read_b32 a151, v56
v_mfma_f32_16x16x32_bf16 v[208:211], a[224:227], a[112:115], v[208:211]
ds_read_b128 a[232:235], v15 offset:63488
v_perm_b32 v63, v97, v19, s52
v_mfma_f32_16x16x32_bf16 v[208:211], a[228:231], a[128:131], v[208:211]
ds_read_b32 a152, v63
v_mfma_f32_16x16x32_bf16 v[212:215], a[228:231], a[132:135], v[212:215]
ds_read_b128 a[236:239], v16 offset:14336
v_perm_b32 v62, v97, v19, s53
v_mfma_f32_16x16x32_bf16 v[212:215], a[224:227], a[116:119], v[212:215]
ds_read_b32 a153, v62
v_perm_b32 v61, v101, v19, s52
v_mfma_f32_16x16x32_bf16 v[216:219], a[224:227], a[120:123], v[216:219]
ds_read_b32 a154, v61
v_perm_b32 v60, v101, v19, s53
v_mfma_f32_16x16x32_bf16 v[216:219], a[228:231], a[136:139], v[216:219]
ds_read_b32 a155, v60
v_perm_b32 v59, v97, v19, s54
v_mfma_f32_16x16x32_bf16 v[220:223], a[228:231], a[140:143], v[220:223]
s_add_u32 m0, s33, 85120
ds_read_b32 a156, v59
v_perm_b32 v58, v97, v19, s55
v_mfma_f32_16x16x32_bf16 v[220:223], a[224:227], a[124:127], v[220:223]
s_waitcnt lgkmcnt(4)
ds_read_b32 a157, v58
v_perm_b32 v57, v101, v19, s54
v_mfma_f32_16x16x32_bf16 v[240:243], a[232:235], a[112:115], v[240:243]
ds_read_b128 a[240:243], v16 offset:0
buffer_load_dwordx4 v9, s[20:23], 0 offen offset:896 lds
v_mfma_f32_16x16x32_bf16 v[240:243], a[236:239], a[128:131], v[240:243]
ds_read_b32 a158, v57
buffer_load_dwordx4 v[80:83], v12, s[24:27], 0 offen offset:0 sc1
v_mfma_f32_16x16x32_bf16 v[244:247], a[236:239], a[132:135], v[244:247]
ds_read_b128 a[244:247], v17 offset:0
v_perm_b32 v56, v101, v19, s55
v_mfma_f32_16x16x32_bf16 v[244:247], a[232:235], a[116:119], v[244:247]
ds_read_b32 a159, v56
buffer_load_dwordx4 v[84:87], v12, s[24:27], 0 offen offset:1024 sc1
v_mfma_f32_16x16x32_bf16 v[248:251], a[232:235], a[120:123], v[248:251]
v_mfma_f32_16x16x32_bf16 v[248:251], a[236:239], a[136:139], v[248:251]
v_mfma_f32_16x16x32_bf16 v[252:255], a[236:239], a[140:143], v[252:255]
s_waitcnt vmcnt(10)
v_cmp_ne_u64 s[50:51], s[88:89], v[42:43]
v_cmp_ne_u64 s[44:45], s[88:89], v[46:47]
v_mfma_f32_16x16x32_bf16 v[252:255], a[232:235], a[124:127], v[252:255]
s_waitcnt lgkmcnt(1)
v_mfma_f32_16x16x32_bf16 v[128:131], a[240:243], a[128:131], v[128:131]
s_or_b64 s[50:51], s[44:45], s[50:51]
ds_read_b128 a[248:251], v16 offset:4096
v_mfma_f32_16x16x32_bf16 v[128:131], a[244:247], a[144:147], v[128:131]
s_cbranch_scc1 L_SLOW10
L_BACK10:
v_mfma_f32_16x16x32_bf16 v[132:135], a[244:247], a[148:151], v[132:135]
ds_read_b128 a[252:255], v17 offset:4096
v_mfma_f32_16x16x32_bf16 v[132:135], a[240:243], a[132:135], v[132:135]
s_add_u32 m0, s33, 89216
v_mfma_f32_16x16x32_bf16 v[136:139], a[240:243], a[136:139], v[136:139]
buffer_load_dwordx4 v10, s[20:23], 0 offen offset:896 lds
v_mfma_f32_16x16x32_bf16 v[136:139], a[244:247], a[152:155], v[136:139]
s_waitcnt lgkmcnt(1)
v_perm_b32 v63, v40, v19, s52
v_mfma_f32_16x16x32_bf16 v[140:143], a[244:247], a[156:159], v[140:143]
ds_read_b32 a160, v63
v_perm_b32 v62, v40, v19, s53
v_mfma_f32_16x16x32_bf16 v[140:143], a[240:243], a[140:143], v[140:143]
s_waitcnt lgkmcnt(1)
ds_read_b32 a161, v62
v_mfma_f32_16x16x32_bf16 v[160:163], a[248:251], a[128:131], v[160:163]
ds_read_b128 a[224:227], v16 offset:8192
v_perm_b32 v61, v44, v19, s52
v_mfma_f32_16x16x32_bf16 v[160:163], a[252:255], a[144:147], v[160:163]
ds_read_b32 a162, v61
v_mfma_f32_16x16x32_bf16 v[164:167], a[252:255], a[148:151], v[164:167]
ds_read_b128 a[228:231], v17 offset:8192
v_perm_b32 v60, v44, v19, s53
v_mfma_f32_16x16x32_bf16 v[164:167], a[248:251], a[132:135], v[164:167]
ds_read_b32 a163, v60
v_perm_b32 v59, v40, v19, s54
v_mfma_f32_16x16x32_bf16 v[168:171], a[248:251], a[136:139], v[168:171]
ds_read_b32 a164, v59
v_perm_b32 v58, v40, v19, s55
v_mfma_f32_16x16x32_bf16 v[168:171], a[252:255], a[152:155], v[168:171]
ds_read_b32 a165, v58
v_perm_b32 v57, v44, v19, s54
v_mfma_f32_16x16x32_bf16 v[172:175], a[252:255], a[156:159], v[172:175]
ds_read_b32 a166, v57
v_perm_b32 v56, v44, v19, s55
v_mfma_f32_16x16x32_bf16 v[172:175], a[248:251], a[140:143], v[172:175]
s_waitcnt lgkmcnt(4)
ds_read_b32 a167, v56
v_mfma_f32_16x16x32_bf16 v[192:195], a[224:227], a[128:131], v[192:195]
ds_read_b128 a[232:235], v16 offset:12288
v_perm_b32 v63, v41, v19, s52
v_mfma_f32_16x16x32_bf16 v[192:195], a[228:231], a[144:147], v[192:195]
ds_read_b32 a168, v63
buffer_load_dwordx4 v[88:91], v12, s[24:27], 0 offen offset:2048 sc1
v_mfma_f32_16x16x32_bf16 v[196:199], a[228:231], a[148:151], v[196:199]
ds_read_b128 a[236:239], v17 offset:12288
v_perm_b32 v62, v41, v19, s53
v_mfma_f32_16x16x32_bf16 v[196:199], a[224:227], a[132:135], v[196:199]
ds_read_b32 a169, v62
v_perm_b32 v61, v45, v19, s52
v_mfma_f32_16x16x32_bf16 v[200:203], a[224:227], a[136:139], v[200:203]
ds_read_b32 a170, v61
v_perm_b32 v60, v45, v19, s53
v_mfma_f32_16x16x32_bf16 v[200:203], a[228:231], a[152:155], v[200:203]
ds_read_b32 a171, v60
v_perm_b32 v59, v41, v19, s54
v_mfma_f32_16x16x32_bf16 v[204:207], a[228:231], a[156:159], v[204:207]
ds_read_b32 a172, v59
v_perm_b32 v58, v41, v19, s55
v_mfma_f32_16x16x32_bf16 v[204:207], a[224:227], a[140:143], v[204:207]
s_waitcnt lgkmcnt(4)
ds_read_b32 a173, v58
buffer_load_dwordx4 v[92:95], v12, s[24:27], 0 offen offset:3072 sc1
v_mfma_f32_16x16x32_bf16 v[224:227], a[232:235], a[128:131], v[224:227]
ds_read_b128 a[240:243], v17 offset:2048
v_perm_b32 v57, v45, v19, s54
v_mfma_f32_16x16x32_bf16 v[224:227], a[236:239], a[144:147], v[224:227]
ds_read_b32 a174, v57
v_add_u32 v12, 28672, v13
v_mfma_f32_16x16x32_bf16 v[228:231], a[236:239], a[148:151], v[228:231]
ds_read_b128 a[244:247], v16 offset:18432
v_perm_b32 v56, v45, v19, s55
v_mfma_f32_16x16x32_bf16 v[228:231], a[232:235], a[132:135], v[228:231]
ds_read_b32 a175, v56
v_mfma_f32_16x16x32_bf16 v[232:235], a[232:235], a[136:139], v[232:235]
v_mfma_f32_16x16x32_bf16 v[232:235], a[236:239], a[152:155], v[232:235]
v_mfma_f32_16x16x32_bf16 v[236:239], a[236:239], a[156:159], v[236:239]
v_mfma_f32_16x16x32_bf16 v[236:239], a[232:235], a[140:143], v[236:239]
s_waitcnt vmcnt(8) lgkmcnt(1)
v_cmp_ne_u64 s[50:51], s[88:89], v[50:51]
v_mfma_f32_16x16x32_bf16 v[144:147], a[240:243], a[144:147], v[144:147]
s_barrier
ds_read_b128 a[248:251], v17 offset:6144
v_cmp_ne_u64 s[44:45], s[88:89], v[54:55]
v_mfma_f32_16x16x32_bf16 v[144:147], a[244:247], a[160:163], v[144:147]
v_mfma_f32_16x16x32_bf16 v[148:151], a[244:247], a[164:167], v[148:151]
s_or_b64 s[50:51], s[44:45], s[50:51]
ds_read_b128 a[252:255], v16 offset:22528
v_mfma_f32_16x16x32_bf16 v[148:151], a[240:243], a[148:151], v[148:151]
s_cbranch_scc1 L_SLOW11
L_BACK11:
v_mfma_f32_16x16x32_bf16 v[152:155], a[240:243], a[152:155], v[152:155]
v_perm_b32 v63, v48, v19, s52
v_mfma_f32_16x16x32_bf16 v[152:155], a[244:247], a[168:171], v[152:155]
s_waitcnt lgkmcnt(1)
ds_read_b32 a176, v63
v_perm_b32 v62, v48, v19, s53
v_mfma_f32_16x16x32_bf16 v[156:159], a[244:247], a[172:175], v[156:159]
s_add_u32 m0, s33, 93184
ds_read_b32 a177, v62
v_perm_b32 v61, v52, v19, s52
v_mfma_f32_16x16x32_bf16 v[156:159], a[240:243], a[156:159], v[156:159]
s_waitcnt lgkmcnt(2)
ds_read_b32 a178, v61
v_perm_b32 v60, v52, v19, s53
v_mfma_f32_16x16x32_bf16 v[176:179], a[248:251], a[144:147], v[176:179]
ds_read_b128 a[224:227], v17 offset:10240
buffer_load_dwordx4 v8, s[20:23], 0 offen offset:1024 lds
v_mfma_f32_16x16x32_bf16 v[176:179], a[252:255], a[160:163], v[176:179]
ds_read_b32 a179, v60
v_mfma_f32_16x16x32_bf16 v[180:183], a[252:255], a[164:167], v[180:183]
ds_read_b128 a[228:231], v16 offset:26624
v_perm_b32 v59, v48, v19, s54
v_mfma_f32_16x16x32_bf16 v[180:183], a[248:251], a[148:151], v[180:183]
ds_read_b32 a180, v59
v_perm_b32 v58, v48, v19, s55
v_mfma_f32_16x16x32_bf16 v[184:187], a[248:251], a[152:155], v[184:187]
ds_read_b32 a181, v58
v_perm_b32 v57, v52, v19, s54
v_mfma_f32_16x16x32_bf16 v[184:187], a[252:255], a[168:171], v[184:187]
ds_read_b32 a182, v57
v_perm_b32 v56, v52, v19, s55
v_mfma_f32_16x16x32_bf16 v[188:191], a[252:255], a[172:175], v[188:191]
ds_read_b32 a183, v56
v_perm_b32 v63, v49, v19, s52
v_mfma_f32_16x16x32_bf16 v[188:191], a[248:251], a[156:159], v[188:191]
s_waitcnt lgkmcnt(4)
ds_read_b32 a184, v63
buffer_load_dwordx4 v[32:35], v12, s[24:27], 0 offen offset:0 sc1
v_mfma_f32_16x16x32_bf16 v[208:211], a[224:227], a[144:147], v[208:211]
ds_read_b128 a[232:235], v17 offset:14336
v_perm_b32 v62, v49, v19, s53
v_mfma_f32_16x16x32_bf16 v[208:211], a[228:231], a[160:163], v[208:211]
ds_read_b32 a185, v62
buffer_load_dwordx4 v[36:39], v12, s[24:27], 0 offen offset:1024 sc1
v_mfma_f32_16x16x32_bf16 v[212:215], a[228:231], a[164:167], v[212:215]
L_PAD2:
s_cbranch_vccnz L_PAD3
ds_read_b128 a[236:239], v16 offset:30720
v_perm_b32 v61, v53, v19, s52
v_mfma_f32_16x16x32_bf16 v[212:215], a[224:227], a[148:151], v[212:215]
s_add_u32 m0, s33, 97280
ds_read_b32 a186, v61
v_mfma_f32_16x16x32_bf16 v[216:219], a[224:227], a[152:155], v[216:219]
buffer_load_dwordx4 v9, s[20:23], 0 offen offset:1024 lds
v_perm_b32 v60, v53, v19, s53
v_mfma_f32_16x16x32_bf16 v[216:219], a[228:231], a[168:171], v[216:219]
ds_read_b32 a187, v60
v_perm_b32 v59, v49, v19, s54
v_mfma_f32_16x16x32_bf16 v[220:223], a[228:231], a[172:175], v[220:223]
ds_read_b32 a188, v59
v_perm_b32 v58, v49, v19, s55
v_mfma_f32_16x16x32_bf16 v[220:223], a[224:227], a[156:159], v[220:223]
s_waitcnt lgkmcnt(3)
ds_read_b32 a189, v58
v_mfma_f32_16x16x32_bf16 v[240:243], a[232:235], a[144:147], v[240:243]
ds_read_b128 a[240:243], v16 offset:16384
v_perm_b32 v57, v53, v19, s54
v_mfma_f32_16x16x32_bf16 v[240:243], a[236:239], a[160:163], v[240:243]
ds_read_b32 a190, v57
v_mfma_f32_16x16x32_bf16 v[244:247], a[236:239], a[164:167], v[244:247]
ds_read_b128 a[244:247], v17 offset:16384
v_perm_b32 v56, v53, v19, s55
v_mfma_f32_16x16x32_bf16 v[244:247], a[232:235], a[148:151], v[244:247]
ds_read_b32 a191, v56
v_mfma_f32_16x16x32_bf16 v[248:251], a[232:235], a[152:155], v[248:251]
v_mfma_f32_16x16x32_bf16 v[248:251], a[236:239], a[168:171], v[248:251]
v_mfma_f32_16x16x32_bf16 v[252:255], a[236:239], a[172:175], v[252:255]
s_add_u32 m0, s33, 101504
v_mfma_f32_16x16x32_bf16 v[252:255], a[232:235], a[156:159], v[252:255]
s_waitcnt vmcnt(7) lgkmcnt(1)
v_cmp_ne_u64 s[50:51], s[88:89], v[82:83]
v_cmp_ne_u64 s[44:45], s[88:89], v[86:87]
v_mfma_f32_16x16x32_bf16 v[128:131], a[240:243], a[160:163], v[128:131]
ds_read_b128 a[248:251], v16 offset:20480
buffer_load_dwordx4 v11, s[20:23], 0 offen offset:896 lds
v_mfma_f32_16x16x32_bf16 v[128:131], a[244:247], a[176:179], v[128:131]
v_mfma_f32_16x16x32_bf16 v[132:135], a[244:247], a[180:183], v[132:135]
s_or_b64 s[50:51], s[44:45], s[50:51]
ds_read_b128 a[252:255], v17 offset:20480
v_mfma_f32_16x16x32_bf16 v[132:135], a[240:243], a[164:167], v[132:135]
s_cbranch_scc1 L_SLOW12
L_BACK12:
v_mfma_f32_16x16x32_bf16 v[136:139], a[240:243], a[168:171], v[136:139]
v_perm_b32 v63, v80, v19, s52
v_mfma_f32_16x16x32_bf16 v[136:139], a[244:247], a[184:187], v[136:139]
s_waitcnt lgkmcnt(1)
ds_read_b32 a192, v63
v_perm_b32 v62, v80, v19, s53
v_mfma_f32_16x16x32_bf16 v[140:143], a[244:247], a[188:191], v[140:143]
ds_read_b32 a193, v62
v_perm_b32 v61, v84, v19, s52
v_mfma_f32_16x16x32_bf16 v[140:143], a[240:243], a[172:175], v[140:143]
s_waitcnt lgkmcnt(2)
ds_read_b32 a194, v61
buffer_load_dwordx4 v[96:99], v12, s[24:27], 0 offen offset:2048 sc1
v_mfma_f32_16x16x32_bf16 v[160:163], a[248:251], a[160:163], v[160:163]
ds_read_b128 a[224:227], v16 offset:24576
v_perm_b32 v60, v84, v19, s53
v_mfma_f32_16x16x32_bf16 v[160:163], a[252:255], a[176:179], v[160:163]
ds_read_b32 a195, v60
buffer_load_dwordx4 v[100:103], v12, s[24:27], 0 offen offset:3072 sc1
v_mfma_f32_16x16x32_bf16 v[164:167], a[252:255], a[180:183], v[164:167]
ds_read_b128 a[228:231], v17 offset:24576
v_perm_b32 v59, v80, v19, s54
v_mfma_f32_16x16x32_bf16 v[164:167], a[248:251], a[164:167], v[164:167]
s_add_u32 m0, s33, 105472
ds_read_b32 a196, v59
v_add_u32 v12, 32768, v13
v_mfma_f32_16x16x32_bf16 v[168:171], a[248:251], a[168:171], v[168:171]
buffer_load_dwordx4 v10, s[20:23], 0 offen offset:1024 lds
v_perm_b32 v58, v80, v19, s55
v_mfma_f32_16x16x32_bf16 v[168:171], a[252:255], a[184:187], v[168:171]
ds_read_b32 a197, v58
v_perm_b32 v57, v84, v19, s54
v_mfma_f32_16x16x32_bf16 v[172:175], a[252:255], a[188:191], v[172:175]
ds_read_b32 a198, v57
v_perm_b32 v56, v84, v19, s55
v_mfma_f32_16x16x32_bf16 v[172:175], a[248:251], a[172:175], v[172:175]
s_waitcnt lgkmcnt(3)
ds_read_b32 a199, v56
v_mfma_f32_16x16x32_bf16 v[192:195], a[224:227], a[160:163], v[192:195]
ds_read_b128 a[232:235], v16 offset:28672
v_perm_b32 v63, v81, v19, s52
v_mfma_f32_16x16x32_bf16 v[192:195], a[228:231], a[176:179], v[192:195]
ds_read_b32 a200, v63
v_mfma_f32_16x16x32_bf16 v[196:199], a[228:231], a[180:183], v[196:199]
ds_read_b128 a[236:239], v17 offset:28672
v_perm_b32 v62, v81, v19, s53
v_mfma_f32_16x16x32_bf16 v[196:199], a[224:227], a[164:167], v[196:199]
ds_read_b32 a201, v62
v_perm_b32 v61, v85, v19, s52
v_mfma_f32_16x16x32_bf16 v[200:203], a[224:227], a[168:171], v[200:203]
ds_read_b32 a202, v61
v_perm_b32 v60, v85, v19, s53
v_mfma_f32_16x16x32_bf16 v[200:203], a[228:231], a[184:187], v[200:203]
ds_read_b32 a203, v60
v_perm_b32 v59, v81, v19, s54
v_mfma_f32_16x16x32_bf16 v[204:207], a[228:231], a[188:191], v[204:207]
s_add_u32 m0, s33, 109440
ds_read_b32 a204, v59
v_perm_b32 v58, v81, v19, s55
v_mfma_f32_16x16x32_bf16 v[204:207], a[224:227], a[172:175], v[204:207]
s_waitcnt lgkmcnt(4)
ds_read_b32 a205, v58
v_perm_b32 v57, v85, v19, s54
v_mfma_f32_16x16x32_bf16 v[224:227], a[232:235], a[160:163], v[224:227]
ds_read_b128 a[240:243], v17 offset:18432
buffer_load_dwordx4 v8, s[20:23], 0 offen offset:1152 lds
v_mfma_f32_16x16x32_bf16 v[224:227], a[236:239], a[176:179], v[224:227]
ds_read_b32 a206, v57
v_mfma_f32_16x16x32_bf16 v[228:231], a[236:239], a[180:183], v[228:231]
ds_read_b128 a[244:247], v14 offset:2048
v_perm_b32 v56, v85, v19, s55
v_mfma_f32_16x16x32_bf16 v[228:231], a[232:235], a[164:167], v[228:231]
ds_read_b32 a207, v56
v_mfma_f32_16x16x32_bf16 v[232:235], a[232:235], a[168:171], v[232:235]
s_waitcnt vmcnt(9)
v_cmp_ne_u64 s[50:51], s[88:89], v[90:91]
v_cmp_ne_u64 s[44:45], s[88:89], v[94:95]
v_mfma_f32_16x16x32_bf16 v[232:235], a[236:239], a[184:187], v[232:235]
v_mfma_f32_16x16x32_bf16 v[236:239], a[236:239], a[188:191], v[236:239]
s_or_b64 s[50:51], s[44:45], s[50:51]
v_mfma_f32_16x16x32_bf16 v[236:239], a[232:235], a[172:175], v[236:239]
s_waitcnt lgkmcnt(1)
v_mfma_f32_16x16x32_bf16 v[144:147], a[240:243], a[176:179], v[144:147]
s_barrier
ds_read_b128 a[248:251], v17 offset:22528
v_mfma_f32_16x16x32_bf16 v[144:147], a[244:247], a[192:195], v[144:147]
s_cbranch_scc1 L_SLOW13
L_BACK13:
v_mfma_f32_16x16x32_bf16 v[148:151], a[244:247], a[196:199], v[148:151]
ds_read_b128 a[252:255], v14 offset:6144
buffer_load_dwordx4 v[40:43], v12, s[24:27], 0 offen offset:0 sc1
v_mfma_f32_16x16x32_bf16 v[148:151], a[240:243], a[180:183], v[148:151]
s_add_u32 m0, s33, 113536
buffer_load_dwordx4 v[44:47], v12, s[24:27], 0 offen offset:1024 sc1
v_mfma_f32_16x16x32_bf16 v[152:155], a[240:243], a[184:187], v[152:155]
buffer_load_dwordx4 v9, s[20:23], 0 offen offset:1152 lds
v_perm_b32 v63, v88, v19, s52
v_mfma_f32_16x16x32_bf16 v[152:155], a[244:247], a[200:203], v[152:155]
s_waitcnt lgkmcnt(1)
ds_read_b32 a208, v63
v_perm_b32 v62, v88, v19, s53
v_mfma_f32_16x16x32_bf16 v[156:159], a[244:247], a[204:207], v[156:159]
ds_read_b32 a209, v62
v_perm_b32 v61, v92, v19, s52
v_mfma_f32_16x16x32_bf16 v[156:159], a[240:243], a[188:191], v[156:159]
s_waitcnt lgkmcnt(2)
ds_read_b32 a210, v61
v_mfma_f32_16x16x32_bf16 v[176:179], a[248:251], a[176:179], v[176:179]
ds_read_b128 a[224:227], v17 offset:26624
v_perm_b32 v60, v92, v19, s53
v_mfma_f32_16x16x32_bf16 v[176:179], a[252:255], a[192:195], v[176:179]
ds_read_b32 a211, v60
v_mfma_f32_16x16x32_bf16 v[180:183], a[252:255], a[196:199], v[180:183]
ds_read_b128 a[228:231], v14 offset:10240
v_perm_b32 v59, v88, v19, s54
v_mfma_f32_16x16x32_bf16 v[180:183], a[248:251], a[180:183], v[180:183]
ds_read_b32 a212, v59
v_perm_b32 v58, v88, v19, s55
v_mfma_f32_16x16x32_bf16 v[184:187], a[248:251], a[184:187], v[184:187]
ds_read_b32 a213, v58
v_perm_b32 v57, v92, v19, s54
v_mfma_f32_16x16x32_bf16 v[184:187], a[252:255], a[200:203], v[184:187]
ds_read_b32 a214, v57
v_perm_b32 v56, v92, v19, s55
v_mfma_f32_16x16x32_bf16 v[188:191], a[252:255], a[204:207], v[188:191]
ds_read_b32 a215, v56
v_perm_b32 v63, v89, v19, s52
v_mfma_f32_16x16x32_bf16 v[188:191], a[248:251], a[188:191], v[188:191]
s_waitcnt lgkmcnt(4)
ds_read_b32 a216, v63
v_mfma_f32_16x16x32_bf16 v[208:211], a[224:227], a[176:179], v[208:211]
ds_read_b128 a[232:235], v17 offset:30720
v_perm_b32 v62, v89, v19, s53
v_mfma_f32_16x16x32_bf16 v[208:211], a[228:231], a[192:195], v[208:211]
ds_read_b32 a217, v62
v_mfma_f32_16x16x32_bf16 v[212:215], a[228:231], a[196:199], v[212:215]
ds_read_b128 a[236:239], v14 offset:14336
v_perm_b32 v61, v93, v19, s52
v_mfma_f32_16x16x32_bf16 v[212:215], a[224:227], a[180:183], v[212:215]
ds_read_b32 a218, v61
v_perm_b32 v60, v93, v19, s53
v_mfma_f32_16x16x32_bf16 v[216:219], a[224:227], a[184:187], v[216:219]
ds_read_b32 a219, v60
v_perm_b32 v59, v89, v19, s54
v_mfma_f32_16x16x32_bf16 v[216:219], a[228:231], a[200:203], v[216:219]
ds_read_b32 a220, v59
v_perm_b32 v58, v89, v19, s55
v_mfma_f32_16x16x32_bf16 v[220:223], a[228:231], a[204:207], v[220:223]
ds_read_b32 a221, v58
v_perm_b32 v57, v93, v19, s54
v_mfma_f32_16x16x32_bf16 v[220:223], a[224:227], a[188:191], v[220:223]
s_waitcnt lgkmcnt(4)
ds_read_b32 a222, v57
v_mfma_f32_16x16x32_bf16 v[240:243], a[232:235], a[176:179], v[240:243]
ds_read_b128 a[240:243], v14 offset:0
v_mfma_f32_16x16x32_bf16 v[240:243], a[236:239], a[192:195], v[240:243]
s_waitcnt vmcnt(9)
v_perm_b32 v56, v93, v19, s55
v_cmp_ne_u64 s[50:51], s[88:89], v[34:35]
v_mfma_f32_16x16x32_bf16 v[244:247], a[236:239], a[196:199], v[244:247]
ds_read_b128 a[244:247], v15 offset:0
v_cmp_ne_u64 s[44:45], s[88:89], v[38:39]
v_mfma_f32_16x16x32_bf16 v[244:247], a[232:235], a[180:183], v[244:247]
s_add_u32 m0, s33, 117760
ds_read_b32 a223, v56
buffer_load_dwordx4 v[48:51], v12, s[24:27], 0 offen offset:2048 sc1
v_mfma_f32_16x16x32_bf16 v[248:251], a[232:235], a[184:187], v[248:251]
s_or_b64 s[50:51], s[44:45], s[50:51]
buffer_load_dwordx4 v11, s[20:23], 0 offen offset:1024 lds
v_mfma_f32_16x16x32_bf16 v[248:251], a[236:239], a[200:203], v[248:251]
s_cbranch_scc1 L_SLOW14
L_BACK14:
v_mfma_f32_16x16x32_bf16 v[252:255], a[236:239], a[204:207], v[252:255]
buffer_load_dwordx4 v[52:55], v12, s[24:27], 0 offen offset:3072 sc1
v_perm_b32 v63, v32, v19, s52
v_mfma_f32_16x16x32_bf16 v[252:255], a[232:235], a[188:191], v[252:255]
s_waitcnt lgkmcnt(1)
ds_read_b32 a0, v63
v_add_u32 v12, 36864, v13
v_mfma_f32_16x16x32_bf16 v[128:131], a[240:243], a[192:195], v[128:131]
ds_read_b128 a[248:251], v14 offset:4096
v_perm_b32 v62, v32, v19, s53
v_mfma_f32_16x16x32_bf16 v[128:131], a[244:247], a[208:211], v[128:131]
ds_read_b32 a1, v62
v_mfma_f32_16x16x32_bf16 v[132:135], a[244:247], a[212:215], v[132:135]
ds_read_b128 a[252:255], v15 offset:4096
v_perm_b32 v61, v36, v19, s52
v_mfma_f32_16x16x32_bf16 v[132:135], a[240:243], a[196:199], v[132:135]
ds_read_b32 a2, v61
v_perm_b32 v60, v36, v19, s53
v_mfma_f32_16x16x32_bf16 v[136:139], a[240:243], a[200:203], v[136:139]
ds_read_b32 a3, v60
v_perm_b32 v59, v32, v19, s54
v_mfma_f32_16x16x32_bf16 v[136:139], a[244:247], a[216:219], v[136:139]
s_waitcnt lgkmcnt(4)
ds_read_b32 a4, v59
v_perm_b32 v58, v32, v19, s55
v_mfma_f32_16x16x32_bf16 v[140:143], a[244:247], a[220:223], v[140:143]
s_add_u32 m0, s33, 121728
ds_read_b32 a5, v58
v_perm_b32 v57, v36, v19, s54
v_mfma_f32_16x16x32_bf16 v[140:143], a[240:243], a[204:207], v[140:143]
s_waitcnt lgkmcnt(4)
ds_read_b32 a6, v57
v_perm_b32 v56, v36, v19, s55
v_mfma_f32_16x16x32_bf16 v[160:163], a[248:251], a[192:195], v[160:163]
ds_read_b128 a[224:227], v14 offset:8192
buffer_load_dwordx4 v10, s[20:23], 0 offen offset:1152 lds
v_mfma_f32_16x16x32_bf16 v[160:163], a[252:255], a[208:211], v[160:163]
ds_read_b32 a7, v56
v_mfma_f32_16x16x32_bf16 v[164:167], a[252:255], a[212:215], v[164:167]
ds_read_b128 a[228:231], v15 offset:8192
v_perm_b32 v63, v33, v19, s52
v_mfma_f32_16x16x32_bf16 v[164:167], a[248:251], a[196:199], v[164:167]
ds_read_b32 a8, v63
v_perm_b32 v62, v33, v19, s53
v_mfma_f32_16x16x32_bf16 v[168:171], a[248:251], a[200:203], v[168:171]
ds_read_b32 a9, v62
v_perm_b32 v61, v37, v19, s52
v_mfma_f32_16x16x32_bf16 v[168:171], a[252:255], a[216:219], v[168:171]
ds_read_b32 a10, v61
v_perm_b32 v60, v37, v19, s53
v_mfma_f32_16x16x32_bf16 v[172:175], a[252:255], a[220:223], v[172:175]
ds_read_b32 a11, v60
v_perm_b32 v59, v33, v19, s54
v_mfma_f32_16x16x32_bf16 v[172:175], a[248:251], a[204:207], v[172:175]
s_waitcnt lgkmcnt(4)
ds_read_b32 a12, v59
v_mfma_f32_16x16x32_bf16 v[192:195], a[224:227], a[192:195], v[192:195]
ds_read_b128 a[232:235], v14 offset:12288
v_perm_b32 v58, v33, v19, s55
v_mfma_f32_16x16x32_bf16 v[192:195], a[228:231], a[208:211], v[192:195]
ds_read_b32 a13, v58
v_mfma_f32_16x16x32_bf16 v[196:199], a[228:231], a[212:215], v[196:199]
ds_read_b128 a[236:239], v15 offset:12288
v_mfma_f32_16x16x32_bf16 v[196:199], a[224:227], a[196:199], v[196:199]
s_waitcnt vmcnt(9)
s_add_u32 m0, s33, 125696
v_cmp_ne_u64 s[50:51], s[88:89], v[98:99]
v_cmp_ne_u64 s[44:45], s[88:89], v[102:103]
v_mfma_f32_16x16x32_bf16 v[200:203], a[224:227], a[200:203], v[200:203]
buffer_load_dwordx4 v8, s[20:23], 0 offen offset:1280 lds
v_perm_b32 v57, v37, v19, s54
v_mfma_f32_16x16x32_bf16 v[200:203], a[228:231], a[216:219], v[200:203]
s_or_b64 s[50:51], s[44:45], s[50:51]
ds_read_b32 a14, v57
v_perm_b32 v56, v37, v19, s55
v_mfma_f32_16x16x32_bf16 v[204:207], a[228:231], a[220:223], v[204:207]
s_cbranch_scc1 L_SLOW15
L_BACK15:
v_mfma_f32_16x16x32_bf16 v[204:207], a[224:227], a[204:207], v[204:207]
s_waitcnt lgkmcnt(1)
ds_read_b32 a15, v56
buffer_load_dwordx4 v[80:83], v12, s[24:27], 0 offen offset:0 sc1
v_mfma_f32_16x16x32_bf16 v[224:227], a[232:235], a[192:195], v[224:227]
ds_read_b128 a[240:243], v15 offset:2048
v_perm_b32 v63, v96, v19, s52
v_mfma_f32_16x16x32_bf16 v[224:227], a[236:239], a[208:211], v[224:227]
ds_read_b32 a16, v63
buffer_load_dwordx4 v[84:87], v12, s[24:27], 0 offen offset:1024 sc1
v_mfma_f32_16x16x32_bf16 v[228:231], a[236:239], a[212:215], v[228:231]
ds_read_b128 a[244:247], v14 offset:18432
v_perm_b32 v62, v96, v19, s53
v_mfma_f32_16x16x32_bf16 v[228:231], a[232:235], a[196:199], v[228:231]
ds_read_b32 a17, v62
v_perm_b32 v61, v100, v19, s52
v_mfma_f32_16x16x32_bf16 v[232:235], a[232:235], a[200:203], v[232:235]
ds_read_b32 a18, v61
v_perm_b32 v60, v100, v19, s53
v_mfma_f32_16x16x32_bf16 v[232:235], a[236:239], a[216:219], v[232:235]
ds_read_b32 a19, v60
v_perm_b32 v59, v96, v19, s54
v_mfma_f32_16x16x32_bf16 v[236:239], a[236:239], a[220:223], v[236:239]
s_add_u32 m0, s33, 129792
ds_read_b32 a20, v59
v_perm_b32 v58, v96, v19, s55
v_mfma_f32_16x16x32_bf16 v[236:239], a[232:235], a[204:207], v[236:239]
s_waitcnt lgkmcnt(4)
ds_read_b32 a21, v58
v_perm_b32 v57, v100, v19, s54
v_mfma_f32_16x16x32_bf16 v[144:147], a[240:243], a[208:211], v[144:147]
ds_read_b128 a[248:251], v15 offset:6144
buffer_load_dwordx4 v9, s[20:23], 0 offen offset:1280 lds
v_mfma_f32_16x16x32_bf16 v[144:147], a[244:247], a[0:3], v[144:147]
ds_read_b32 a22, v57
v_mfma_f32_16x16x32_bf16 v[148:151], a[244:247], a[4:7], v[148:151]
ds_read_b128 a[252:255], v14 offset:22528
v_perm_b32 v56, v100, v19, s55
v_mfma_f32_16x16x32_bf16 v[148:151], a[240:243], a[212:215], v[148:151]
ds_read_b32 a23, v56
v_perm_b32 v63, v97, v19, s52
v_mfma_f32_16x16x32_bf16 v[152:155], a[240:243], a[216:219], v[152:155]
ds_read_b32 a24, v63
v_perm_b32 v62, v97, v19, s53
v_mfma_f32_16x16x32_bf16 v[152:155], a[244:247], a[8:11], v[152:155]
ds_read_b32 a25, v62
v_perm_b32 v61, v101, v19, s52
v_mfma_f32_16x16x32_bf16 v[156:159], a[244:247], a[12:15], v[156:159]
ds_read_b32 a26, v61
v_perm_b32 v60, v101, v19, s53
v_mfma_f32_16x16x32_bf16 v[156:159], a[240:243], a[220:223], v[156:159]
s_waitcnt lgkmcnt(4)
ds_read_b32 a27, v60
v_mfma_f32_16x16x32_bf16 v[176:179], a[248:251], a[208:211], v[176:179]
ds_read_b128 a[224:227], v15 offset:10240
v_perm_b32 v59, v97, v19, s54
v_mfma_f32_16x16x32_bf16 v[176:179], a[252:255], a[0:3], v[176:179]
ds_read_b32 a28, v59
v_mfma_f32_16x16x32_bf16 v[180:183], a[252:255], a[4:7], v[180:183]
ds_read_b128 a[228:231], v14 offset:26624
v_perm_b32 v58, v97, v19, s55
v_mfma_f32_16x16x32_bf16 v[180:183], a[248:251], a[212:215], v[180:183]
s_add_u32 m0, s33, 133760
ds_read_b32 a29, v58
v_mfma_f32_16x16x32_bf16 v[184:187], a[248:251], a[216:219], v[184:187]
buffer_load_dwordx4 v8, s[20:23], 0 offen offset:1408 lds
v_perm_b32 v57, v101, v19, s54
v_mfma_f32_16x16x32_bf16 v[184:187], a[252:255], a[8:11], v[184:187]
ds_read_b32 a30, v57
v_perm_b32 v56, v101, v19, s55
v_mfma_f32_16x16x32_bf16 v[188:191], a[252:255], a[12:15], v[188:191]
s_waitcnt vmcnt(10)
v_cmp_ne_u64 s[50:51], s[88:89], v[42:43]
v_cmp_ne_u64 s[44:45], s[88:89], v[46:47]
v_mfma_f32_16x16x32_bf16 v[188:191], a[248:251], a[220:223], v[188:191]
s_waitcnt lgkmcnt(2)
ds_read_b32 a31, v56
buffer_load_dwordx4 v[88:91], v12, s[24:27], 0 offen offset:2048 sc1
v_mfma_f32_16x16x32_bf16 v[208:211], a[224:227], a[208:211], v[208:211]
s_or_b64 s[50:51], s[44:45], s[50:51]
ds_read_b128 a[232:235], v14 offset:16384
buffer_load_dwordx4 v[92:95], v12, s[24:27], 0 offen offset:3072 sc1
v_mfma_f32_16x16x32_bf16 v[208:211], a[228:231], a[0:3], v[208:211]
s_cbranch_scc1 L_SLOW16
L_BACK16:
v_mfma_f32_16x16x32_bf16 v[212:215], a[228:231], a[4:7], v[212:215]
ds_read_b128 a[236:239], v15 offset:16384
v_perm_b32 v63, v40, v19, s52
v_mfma_f32_16x16x32_bf16 v[212:215], a[224:227], a[212:215], v[212:215]
ds_read_b32 a32, v63
v_perm_b32 v62, v40, v19, s53
v_mfma_f32_16x16x32_bf16 v[216:219], a[224:227], a[216:219], v[216:219]
ds_read_b32 a33, v62
v_perm_b32 v61, v44, v19, s52
v_mfma_f32_16x16x32_bf16 v[216:219], a[228:231], a[8:11], v[216:219]
ds_read_b32 a34, v61
v_perm_b32 v60, v44, v19, s53
v_mfma_f32_16x16x32_bf16 v[220:223], a[228:231], a[12:15], v[220:223]
s_add_u32 m0, s33, 138112
ds_read_b32 a35, v60
v_perm_b32 v59, v40, v19, s54
v_mfma_f32_16x16x32_bf16 v[220:223], a[224:227], a[220:223], v[220:223]
s_waitcnt lgkmcnt(4)
ds_read_b32 a36, v59
v_perm_b32 v58, v40, v19, s55
v_mfma_f32_16x16x32_bf16 v[128:131], a[232:235], a[0:3], v[128:131]
ds_read_b128 a[240:243], v14 offset:20480
buffer_load_dwordx4 v11, s[20:23], 0 offen offset:1152 lds
v_mfma_f32_16x16x32_bf16 v[128:131], a[236:239], a[16:19], v[128:131]
ds_read_b32 a37, v58
v_add_u32 v12, 40960, v13
v_mfma_f32_16x16x32_bf16 v[132:135], a[236:239], a[20:23], v[132:135]
ds_read_b128 a[244:247], v15 offset:20480
v_perm_b32 v57, v44, v19, s54
v_mfma_f32_16x16x32_bf16 v[132:135], a[232:235], a[4:7], v[132:135]
ds_read_b32 a38, v57
v_perm_b32 v56, v44, v19, s55
v_mfma_f32_16x16x32_bf16 v[136:139], a[232:235], a[8:11], v[136:139]
ds_read_b32 a39, v56
v_perm_b32 v63, v41, v19, s52
v_mfma_f32_16x16x32_bf16 v[136:139], a[236:239], a[24:27], v[136:139]
ds_read_b32 a40, v63
v_perm_b32 v62, v41, v19, s53
v_mfma_f32_16x16x32_bf16 v[140:143], a[236:239], a[28:31], v[140:143]
ds_read_b32 a41, v62
v_perm_b32 v61, v45, v19, s52
v_mfma_f32_16x16x32_bf16 v[140:143], a[232:235], a[12:15], v[140:143]
s_waitcnt lgkmcnt(4)
ds_read_b32 a42, v61
v_mfma_f32_16x16x32_bf16 v[160:163], a[240:243], a[0:3], v[160:163]
s_waitcnt vmcnt(12)
s_barrier
ds_read_b128 a[248:251], v14 offset:24576
v_perm_b32 v60, v45, v19, s53
v_mfma_f32_16x16x32_bf16 v[160:163], a[244:247], a[16:19], v[160:163]
ds_read_b32 a43, v60
v_mfma_f32_16x16x32_bf16 v[164:167], a[244:247], a[20:23], v[164:167]
ds_read_b128 a[252:255], v15 offset:24576
v_perm_b32 v59, v41, v19, s54
v_mfma_f32_16x16x32_bf16 v[164:167], a[240:243], a[4:7], v[164:167]
s_add_u32 m0, s33, 142080
ds_read_b32 a44, v59
v_mfma_f32_16x16x32_bf16 v[168:171], a[240:243], a[8:11], v[168:171]
buffer_load_dwordx4 v10, s[20:23], 0 offen offset:1280 lds
v_perm_b32 v58, v41, v19, s55
v_mfma_f32_16x16x32_bf16 v[168:171], a[244:247], a[24:27], v[168:171]
ds_read_b32 a45, v58
v_perm_b32 v57, v45, v19, s54
v_mfma_f32_16x16x32_bf16 v[172:175], a[244:247], a[28:31], v[172:175]
s_waitcnt vmcnt(10)
v_cmp_ne_u64 s[50:51], s[88:89], v[50:51]
v_cmp_ne_u64 s[44:45], s[88:89], v[54:55]
v_mfma_f32_16x16x32_bf16 v[172:175], a[240:243], a[12:15], v[172:175]
s_waitcnt lgkmcnt(2)
ds_read_b32 a46, v57
buffer_load_dwordx4 v[32:35], v12, s[24:27], 0 offen offset:0 sc1
v_mfma_f32_16x16x32_bf16 v[192:195], a[248:251], a[0:3], v[192:195]
s_or_b64 s[50:51], s[44:45], s[50:51]
ds_read_b128 a[224:227], v15 offset:18432
buffer_load_dwordx4 v[36:39], v12, s[24:27], 0 offen offset:1024 sc1
v_mfma_f32_16x16x32_bf16 v[192:195], a[252:255], a[16:19], v[192:195]
s_cbranch_scc1 L_SLOW17
L_BACK17:
v_mfma_f32_16x16x32_bf16 v[196:199], a[252:255], a[20:23], v[196:199]
ds_read_b128 a[228:231], v14 offset:30720
v_perm_b32 v56, v45, v19, s55
v_mfma_f32_16x16x32_bf16 v[196:199], a[248:251], a[4:7], v[196:199]
ds_read_b32 a47, v56
v_perm_b32 v63, v48, v19, s52
v_mfma_f32_16x16x32_bf16 v[200:203], a[248:251], a[8:11], v[200:203]
ds_read_b32 a48, v63
v_perm_b32 v62, v48, v19, s53
v_mfma_f32_16x16x32_bf16 v[200:203], a[252:255], a[24:27], v[200:203]
ds_read_b32 a49, v62
v_perm_b32 v61, v52, v19, s52
v_mfma_f32_16x16x32_bf16 v[204:207], a[252:255], a[28:31], v[204:207]
ds_read_b32 a50, v61
v_perm_b32 v60, v52, v19, s53
v_mfma_f32_16x16x32_bf16 v[204:207], a[248:251], a[12:15], v[204:207]
s_waitcnt lgkmcnt(4)
ds_read_b32 a51, v60
v_mfma_f32_16x16x32_bf16 v[144:147], a[224:227], a[16:19], v[144:147]
ds_read_b128 a[232:235], v15 offset:22528
v_perm_b32 v59, v48, v19, s54
v_mfma_f32_16x16x32_bf16 v[144:147], a[228:231], a[32:35], v[144:147]
ds_read_b32 a52, v59
v_mfma_f32_16x16x32_bf16 v[148:151], a[228:231], a[36:39], v[148:151]
ds_read_b128 a[236:239], v14 offset:34816
v_perm_b32 v58, v48, v19, s55
v_mfma_f32_16x16x32_bf16 v[148:151], a[224:227], a[20:23], v[148:151]
ds_read_b32 a53, v58
v_perm_b32 v57, v52, v19, s54
v_mfma_f32_16x16x32_bf16 v[152:155], a[224:227], a[24:27], v[152:155]
ds_read_b32 a54, v57
v_perm_b32 v56, v52, v19, s55
v_mfma_f32_16x16x32_bf16 v[152:155], a[228:231], a[40:43], v[152:155]
s_waitcnt lgkmcnt(4)
ds_read_b32 a55, v56
v_perm_b32 v63, v49, v19, s52
v_mfma_f32_16x16x32_bf16 v[156:159], a[228:231], a[44:47], v[156:159]
ds_read_b32 a56, v63
v_perm_b32 v62, v49, v19, s53
v_mfma_f32_16x16x32_bf16 v[156:159], a[224:227], a[28:31], v[156:159]
s_waitcnt lgkmcnt(4)
ds_read_b32 a57, v62
v_mfma_f32_16x16x32_bf16 v[176:179], a[232:235], a[16:19], v[176:179]
ds_read_b128 a[240:243], v14 offset:36864
v_perm_b32 v61, v53, v19, s52
v_mfma_f32_16x16x32_bf16 v[176:179], a[236:239], a[32:35], v[176:179]
ds_read_b32 a58, v61
v_mfma_f32_16x16x32_bf16 v[180:183], a[236:239], a[36:39], v[180:183]
ds_read_b128 a[244:247], v15 offset:36864
v_perm_b32 v60, v53, v19, s53
v_mfma_f32_16x16x32_bf16 v[180:183], a[232:235], a[20:23], v[180:183]
ds_read_b32 a59, v60
v_perm_b32 v59, v49, v19, s54
v_mfma_f32_16x16x32_bf16 v[184:187], a[232:235], a[24:27], v[184:187]
ds_read_b32 a60, v59
v_perm_b32 v58, v49, v19, s55
v_mfma_f32_16x16x32_bf16 v[184:187], a[236:239], a[40:43], v[184:187]
ds_read_b32 a61, v58
v_perm_b32 v57, v53, v19, s54
v_mfma_f32_16x16x32_bf16 v[188:191], a[236:239], a[44:47], v[188:191]
ds_read_b32 a62, v57
v_mfma_f32_16x16x32_bf16 v[188:191], a[232:235], a[28:31], v[188:191]
s_waitcnt vmcnt(8) lgkmcnt(4)
v_perm_b32 v56, v53, v19, s55
v_cmp_ne_u64 s[50:51], s[88:89], v[82:83]
v_mfma_f32_16x16x32_bf16 v[224:227], a[240:243], a[0:3], v[224:227]
ds_read_b128 a[248:251], v14 offset:28672
v_cmp_ne_u64 s[44:45], s[88:89], v[86:87]
v_mfma_f32_16x16x32_bf16 v[224:227], a[244:247], a[16:19], v[224:227]
ds_read_b32 a63, v56
buffer_load_dwordx4 v[96:99], v12, s[24:27], 0 offen offset:2048 sc1
v_mfma_f32_16x16x32_bf16 v[228:231], a[244:247], a[20:23], v[228:231]
s_or_b64 s[50:51], s[44:45], s[50:51]
ds_read_b128 a[252:255], v15 offset:28672
buffer_load_dwordx4 v[100:103], v12, s[24:27], 0 offen offset:3072 sc1
v_mfma_f32_16x16x32_bf16 v[228:231], a[240:243], a[4:7], v[228:231]
s_cbranch_scc1 L_SLOW18
L_BACK18:
v_mfma_f32_16x16x32_bf16 v[232:235], a[240:243], a[8:11], v[232:235]
v_perm_b32 v63, v80, v19, s52
v_add_u32 v12, 45056, v13
v_mfma_f32_16x16x32_bf16 v[232:235], a[244:247], a[24:27], v[232:235]
ds_read_b32 a64, v63
v_perm_b32 v62, v80, v19, s53
v_mfma_f32_16x16x32_bf16 v[236:239], a[244:247], a[28:31], v[236:239]
L_PAD3:
s_cbranch_vccnz L_PADRET
s_add_u32 m0, s33, 146048
ds_read_b32 a65, v62
v_perm_b32 v61, v84, v19, s52
v_mfma_f32_16x16x32_bf16 v[236:239], a[240:243], a[12:15], v[236:239]
s_waitcnt lgkmcnt(2)
ds_read_b32 a66, v61
v_perm_b32 v60, v84, v19, s53
v_mfma_f32_16x16x32_bf16 v[128:131], a[248:251], a[32:35], v[128:131]
ds_read_b128 a[224:227], v15 offset:14336
buffer_load_dwordx4 v9, s[20:23], 0 offen offset:1408 lds
v_mfma_f32_16x16x32_bf16 v[128:131], a[252:255], a[48:51], v[128:131]
ds_read_b32 a67, v60
v_mfma_f32_16x16x32_bf16 v[132:135], a[252:255], a[52:55], v[132:135]
ds_read_b128 a[228:231], v14 offset:38912
v_perm_b32 v59, v80, v19, s54
v_mfma_f32_16x16x32_bf16 v[132:135], a[248:251], a[36:39], v[132:135]
ds_read_b32 a68, v59
v_perm_b32 v58, v80, v19, s55
v_mfma_f32_16x16x32_bf16 v[136:139], a[248:251], a[40:43], v[136:139]
ds_read_b32 a69, v58
v_perm_b32 v57, v84, v19, s54
v_mfma_f32_16x16x32_bf16 v[136:139], a[252:255], a[56:59], v[136:139]
ds_read_b32 a70, v57
v_perm_b32 v56, v84, v19, s55
v_mfma_f32_16x16x32_bf16 v[140:143], a[252:255], a[60:63], v[140:143]
ds_read_b32 a71, v56
v_perm_b32 v63, v81, v19, s52
v_mfma_f32_16x16x32_bf16 v[140:143], a[248:251], a[44:47], v[140:143]
s_waitcnt lgkmcnt(4)
ds_read_b32 a72, v63
v_mfma_f32_16x16x32_bf16 v[240:243], a[224:227], a[208:211], v[240:243]
ds_read_b128 a[232:235], v14 offset:32768
v_perm_b32 v62, v81, v19, s53
v_mfma_f32_16x16x32_bf16 v[240:243], a[228:231], a[0:3], v[240:243]
ds_read_b32 a73, v62
v_mfma_f32_16x16x32_bf16 v[244:247], a[228:231], a[4:7], v[244:247]
ds_read_b128 a[236:239], v15 offset:32768
v_perm_b32 v61, v85, v19, s52
v_mfma_f32_16x16x32_bf16 v[244:247], a[224:227], a[212:215], v[244:247]
s_add_u32 m0, s33, 150016
ds_read_b32 a74, v61
v_mfma_f32_16x16x32_bf16 v[248:251], a[224:227], a[216:219], v[248:251]
buffer_load_dwordx4 v8, s[20:23], 0 offen offset:1536 lds
v_perm_b32 v60, v85, v19, s53
v_mfma_f32_16x16x32_bf16 v[248:251], a[228:231], a[8:11], v[248:251]
ds_read_b32 a75, v60
v_perm_b32 v59, v81, v19, s54
v_mfma_f32_16x16x32_bf16 v[252:255], a[228:231], a[12:15], v[252:255]
ds_read_b32 a76, v59
v_perm_b32 v58, v81, v19, s55
v_mfma_f32_16x16x32_bf16 v[252:255], a[224:227], a[220:223], v[252:255]
s_waitcnt lgkmcnt(3)
ds_read_b32 a77, v58
v_mfma_f32_16x16x32_bf16 v[160:163], a[232:235], a[32:35], v[160:163]
ds_read_b128 a[240:243], v15 offset:26624
v_mfma_f32_16x16x32_bf16 v[160:163], a[236:239], a[48:51], v[160:163]
s_waitcnt vmcnt(8)
v_cmp_ne_u64 s[50:51], s[88:89], v[90:91]
v_cmp_ne_u64 s[44:45], s[88:89], v[94:95]
v_mfma_f32_16x16x32_bf16 v[164:167], a[236:239], a[52:55], v[164:167]
ds_read_b128 a[244:247], v14 offset:43008
v_perm_b32 v57, v85, v19, s54
v_mfma_f32_16x16x32_bf16 v[164:167], a[232:235], a[36:39], v[164:167]
s_or_b64 s[50:51], s[44:45], s[50:51]
ds_read_b32 a78, v57
v_perm_b32 v56, v85, v19, s55
v_mfma_f32_16x16x32_bf16 v[168:171], a[232:235], a[40:43], v[168:171]
s_cbranch_scc1 L_SLOW19
L_BACK19:
v_mfma_f32_16x16x32_bf16 v[168:171], a[236:239], a[56:59], v[168:171]
ds_read_b32 a79, v56
v_perm_b32 v63, v88, v19, s52
v_mfma_f32_16x16x32_bf16 v[172:175], a[236:239], a[60:63], v[172:175]
s_add_u32 m0, s33, 154240
ds_read_b32 a80, v63
v_perm_b32 v62, v88, v19, s53
v_mfma_f32_16x16x32_bf16 v[172:175], a[232:235], a[44:47], v[172:175]
s_waitcnt lgkmcnt(3)
ds_read_b32 a81, v62
v_perm_b32 v61, v92, v19, s52
v_mfma_f32_16x16x32_bf16 v[208:211], a[240:243], a[16:19], v[208:211]
ds_read_b128 a[248:251], v14 offset:40960
buffer_load_dwordx4 v10, s[20:23], 0 offen offset:1408 lds
v_mfma_f32_16x16x32_bf16 v[208:211], a[244:247], a[32:35], v[208:211]
ds_read_b32 a82, v61
buffer_load_dwordx4 v[40:43], v12, s[24:27], 0 offen offset:0 sc1
v_mfma_f32_16x16x32_bf16 v[212:215], a[244:247], a[36:39], v[212:215]
ds_read_b128 a[252:255], v15 offset:40960
v_perm_b32 v60, v92, v19, s53
v_mfma_f32_16x16x32_bf16 v[212:215], a[240:243], a[20:23], v[212:215]
ds_read_b32 a83, v60
v_perm_b32 v59, v88, v19, s54
v_mfma_f32_16x16x32_bf16 v[216:219], a[240:243], a[24:27], v[216:219]
ds_read_b32 a84, v59
v_perm_b32 v58, v88, v19, s55
v_mfma_f32_16x16x32_bf16 v[216:219], a[244:247], a[40:43], v[216:219]
ds_read_b32 a85, v58
v_perm_b32 v57, v92, v19, s54
v_mfma_f32_16x16x32_bf16 v[220:223], a[244:247], a[44:47], v[220:223]
ds_read_b32 a86, v57
v_perm_b32 v56, v92, v19, s55
v_mfma_f32_16x16x32_bf16 v[220:223], a[240:243], a[28:31], v[220:223]
s_waitcnt lgkmcnt(4)
ds_read_b32 a87, v56
buffer_load_dwordx4 v[44:47], v12, s[24:27], 0 offen offset:1024 sc1
v_mfma_f32_16x16x32_bf16 v[192:195], a[248:251], a[32:35], v[192:195]
ds_read_b128 a[224:227], v15 offset:30720
v_perm_b32 v63, v89, v19, s52
v_mfma_f32_16x16x32_bf16 v[192:195], a[252:255], a[48:51], v[192:195]
ds_read_b32 a88, v63
v_mfma_f32_16x16x32_bf16 v[196:199], a[252:255], a[52:55], v[196:199]
ds_read_b128 a[228:231], v14 offset:47104
v_perm_b32 v62, v89, v19, s53
v_mfma_f32_16x16x32_bf16 v[196:199], a[248:251], a[36:39], v[196:199]
s_add_u32 m0, s33, 158208
ds_read_b32 a89, v62
v_mfma_f32_16x16x32_bf16 v[200:203], a[248:251], a[40:43], v[200:203]
buffer_load_dwordx4 v9, s[20:23], 0 offen offset:1536 lds
v_perm_b32 v61, v93, v19, s52
v_mfma_f32_16x16x32_bf16 v[200:203], a[252:255], a[56:59], v[200:203]
ds_read_b32 a90, v61
v_perm_b32 v60, v93, v19, s53
v_mfma_f32_16x16x32_bf16 v[204:207], a[252:255], a[60:63], v[204:207]
ds_read_b32 a91, v60
v_perm_b32 v59, v89, v19, s54
v_mfma_f32_16x16x32_bf16 v[204:207], a[248:251], a[44:47], v[204:207]
s_waitcnt lgkmcnt(3)
ds_read_b32 a92, v59
v_mfma_f32_16x16x32_bf16 v[144:147], a[224:227], a[48:51], v[144:147]
ds_read_b128 a[232:235], v15 offset:34816
v_mfma_f32_16x16x32_bf16 v[144:147], a[228:231], a[64:67], v[144:147]
s_waitcnt vmcnt(8)
v_perm_b32 v58, v89, v19, s55
v_cmp_ne_u64 s[50:51], s[88:89], v[34:35]
v_mfma_f32_16x16x32_bf16 v[148:151], a[228:231], a[68:71], v[148:151]
ds_read_b128 a[236:239], v14 offset:51200
v_cmp_ne_u64 s[44:45], s[88:89], v[38:39]
v_mfma_f32_16x16x32_bf16 v[148:151], a[224:227], a[52:55], v[148:151]
ds_read_b32 a93, v58
v_perm_b32 v57, v93, v19, s54
v_mfma_f32_16x16x32_bf16 v[152:155], a[224:227], a[56:59], v[152:155]
s_or_b64 s[50:51], s[44:45], s[50:51]
ds_read_b32 a94, v57
v_perm_b32 v56, v93, v19, s55
v_mfma_f32_16x16x32_bf16 v[152:155], a[228:231], a[72:75], v[152:155]
s_cbranch_scc1 L_SLOW20
L_BACK20:
v_mfma_f32_16x16x32_bf16 v[156:159], a[228:231], a[76:79], v[156:159]
s_add_u32 m0, s33, 64256
ds_read_b32 a95, v56
v_perm_b32 v63, v32, v19, s52
v_mfma_f32_16x16x32_bf16 v[156:159], a[224:227], a[60:63], v[156:159]
s_waitcnt lgkmcnt(3)
ds_read_b32 a96, v63
v_perm_b32 v62, v32, v19, s53
v_mfma_f32_16x16x32_bf16 v[176:179], a[232:235], a[48:51], v[176:179]
ds_read_b128 a[240:243], v14 offset:45056
buffer_load_dwordx4 v11, s[20:23], 0 offen offset:1280 lds
v_mfma_f32_16x16x32_bf16 v[176:179], a[236:239], a[64:67], v[176:179]
ds_read_b32 a97, v62
buffer_load_dwordx4 v[48:51], v12, s[24:27], 0 offen offset:2048 sc1
v_mfma_f32_16x16x32_bf16 v[180:183], a[236:239], a[68:71], v[180:183]
ds_read_b128 a[244:247], v15 offset:45056
v_perm_b32 v61, v36, v19, s52
v_mfma_f32_16x16x32_bf16 v[180:183], a[232:235], a[52:55], v[180:183]
ds_read_b32 a98, v61
v_perm_b32 v60, v36, v19, s53
v_mfma_f32_16x16x32_bf16 v[184:187], a[232:235], a[56:59], v[184:187]
ds_read_b32 a99, v60
v_perm_b32 v59, v32, v19, s54
v_mfma_f32_16x16x32_bf16 v[184:187], a[236:239], a[72:75], v[184:187]
ds_read_b32 a100, v59
v_perm_b32 v58, v32, v19, s55
v_mfma_f32_16x16x32_bf16 v[188:191], a[236:239], a[76:79], v[188:191]
ds_read_b32 a101, v58
v_perm_b32 v57, v36, v19, s54
v_mfma_f32_16x16x32_bf16 v[188:191], a[232:235], a[60:63], v[188:191]
s_waitcnt lgkmcnt(4)
ds_read_b32 a102, v57
buffer_load_dwordx4 v[52:55], v12, s[24:27], 0 offen offset:3072 sc1
v_mfma_f32_16x16x32_bf16 v[128:131], a[240:243], a[64:67], v[128:131]
s_barrier
ds_read_b128 a[248:251], v14 offset:49152
v_perm_b32 v56, v36, v19, s55
v_mfma_f32_16x16x32_bf16 v[128:131], a[244:247], a[80:83], v[128:131]
ds_read_b32 a103, v56
v_add_u32 v12, 49152, v13
v_mfma_f32_16x16x32_bf16 v[132:135], a[244:247], a[84:87], v[132:135]
ds_read_b128 a[252:255], v15 offset:49152
v_perm_b32 v63, v33, v19, s52
v_mfma_f32_16x16x32_bf16 v[132:135], a[240:243], a[68:71], v[132:135]
s_add_u32 m0, s33, 67968
ds_read_b32 a104, v63
v_mfma_f32_16x16x32_bf16 v[136:139], a[240:243], a[72:75], v[136:139]
buffer_load_dwordx4 v8, s[20:23], 0 offen offset:1664 lds
v_perm_b32 v62, v33, v19, s53
v_mfma_f32_16x16x32_bf16 v[136:139], a[244:247], a[88:91], v[136:139]
ds_read_b32 a105, v62
v_perm_b32 v61, v37, v19, s52
v_mfma_f32_16x16x32_bf16 v[140:143], a[244:247], a[92:95], v[140:143]
ds_read_b32 a106, v61
v_perm_b32 v60, v37, v19, s53
v_mfma_f32_16x16x32_bf16 v[140:143], a[240:243], a[76:79], v[140:143]
s_waitcnt lgkmcnt(3)
ds_read_b32 a107, v60
v_mfma_f32_16x16x32_bf16 v[160:163], a[248:251], a[64:67], v[160:163]
ds_read_b128 a[224:227], v14 offset:53248
v_perm_b32 v59, v33, v19, s54
v_mfma_f32_16x16x32_bf16 v[160:163], a[252:255], a[80:83], v[160:163]
ds_read_b32 a108, v59
v_mfma_f32_16x16x32_bf16 v[164:167], a[252:255], a[84:87], v[164:167]
ds_read_b128 a[228:231], v15 offset:53248
v_perm_b32 v58, v33, v19, s55
v_mfma_f32_16x16x32_bf16 v[164:167], a[248:251], a[68:71], v[164:167]
s_waitcnt vmcnt(10)
v_cmp_ne_u64 s[50:51], s[88:89], v[98:99]
v_cmp_ne_u64 s[44:45], s[88:89], v[102:103]
v_mfma_f32_16x16x32_bf16 v[168:171], a[248:251], a[72:75], v[168:171]
ds_read_b32 a109, v58
v_perm_b32 v57, v37, v19, s54
v_mfma_f32_16x16x32_bf16 v[168:171], a[252:255], a[88:91], v[168:171]
s_or_b64 s[50:51], s[44:45], s[50:51]
ds_read_b32 a110, v57
v_perm_b32 v56, v37, v19, s55
v_mfma_f32_16x16x32_bf16 v[172:175], a[252:255], a[92:95], v[172:175]
s_cbranch_scc1 L_SLOW21
L_BACK21:
v_mfma_f32_16x16x32_bf16 v[172:175], a[248:251], a[76:79], v[172:175]
s_waitcnt lgkmcnt(2)
ds_read_b32 a111, v56
buffer_load_dwordx4 v[80:83], v12, s[24:27], 0 offen offset:0 sc1
v_mfma_f32_16x16x32_bf16 v[224:227], a[224:227], a[32:35], v[224:227]
ds_read_b128 a[232:235], v15 offset:43008
v_perm_b32 v63, v96, v19, s52
v_mfma_f32_16x16x32_bf16 v[224:227], a[228:231], a[48:51], v[224:227]
ds_read_b32 a112, v63
buffer_load_dwordx4 v[84:87], v12, s[24:27], 0 offen offset:1024 sc1
v_mfma_f32_16x16x32_bf16 v[228:231], a[228:231], a[52:55], v[228:231]
ds_read_b128 a[236:239], v14 offset:59392
v_perm_b32 v62, v96, v19, s53
v_mfma_f32_16x16x32_bf16 v[228:231], a[224:227], a[36:39], v[228:231]
ds_read_b32 a113, v62
v_perm_b32 v61, v100, v19, s52
v_mfma_f32_16x16x32_bf16 v[232:235], a[224:227], a[40:43], v[232:235]
ds_read_b32 a114, v61
v_perm_b32 v60, v100, v19, s53
v_mfma_f32_16x16x32_bf16 v[232:235], a[228:231], a[56:59], v[232:235]
ds_read_b32 a115, v60
v_perm_b32 v59, v96, v19, s54
v_mfma_f32_16x16x32_bf16 v[236:239], a[228:231], a[60:63], v[236:239]
ds_read_b32 a116, v59
v_perm_b32 v58, v96, v19, s55
v_mfma_f32_16x16x32_bf16 v[236:239], a[224:227], a[44:47], v[236:239]
s_waitcnt lgkmcnt(4)
ds_read_b32 a117, v58
v_mfma_f32_16x16x32_bf16 v[208:211], a[232:235], a[48:51], v[208:211]
ds_read_b128 a[240:243], v15 offset:47104
v_perm_b32 v57, v100, v19, s54
v_mfma_f32_16x16x32_bf16 v[208:211], a[236:239], a[64:67], v[208:211]
ds_read_b32 a118, v57
v_mfma_f32_16x16x32_bf16 v[212:215], a[236:239], a[68:71], v[212:215]
ds_read_b128 a[244:247], v14 offset:63488
v_perm_b32 v56, v100, v19, s55
v_mfma_f32_16x16x32_bf16 v[212:215], a[232:235], a[52:55], v[212:215]
s_add_u32 m0, s33, 72192
ds_read_b32 a119, v56
v_mfma_f32_16x16x32_bf16 v[216:219], a[232:235], a[56:59], v[216:219]
buffer_load_dwordx4 v10, s[20:23], 0 offen offset:1536 lds
v_perm_b32 v63, v97, v19, s52
v_mfma_f32_16x16x32_bf16 v[216:219], a[236:239], a[72:75], v[216:219]
ds_read_b32 a120, v63
v_perm_b32 v62, v97, v19, s53
v_mfma_f32_16x16x32_bf16 v[220:223], a[236:239], a[76:79], v[220:223]
ds_read_b32 a121, v62
v_perm_b32 v61, v101, v19, s52
v_mfma_f32_16x16x32_bf16 v[220:223], a[232:235], a[60:63], v[220:223]
s_waitcnt lgkmcnt(3)
ds_read_b32 a122, v61
v_mfma_f32_16x16x32_bf16 v[144:147], a[240:243], a[80:83], v[144:147]
ds_read_b128 a[248:251], v14 offset:57344
v_perm_b32 v60, v101, v19, s53
v_mfma_f32_16x16x32_bf16 v[144:147], a[244:247], a[96:99], v[144:147]
ds_read_b32 a123, v60
v_mfma_f32_16x16x32_bf16 v[148:151], a[244:247], a[100:103], v[148:151]
ds_read_b128 a[252:255], v15 offset:57344
v_perm_b32 v59, v97, v19, s54
v_mfma_f32_16x16x32_bf16 v[148:151], a[240:243], a[84:87], v[148:151]
ds_read_b32 a124, v59
v_perm_b32 v58, v97, v19, s55
v_mfma_f32_16x16x32_bf16 v[152:155], a[240:243], a[88:91], v[152:155]
ds_read_b32 a125, v58
v_perm_b32 v57, v101, v19, s54
v_mfma_f32_16x16x32_bf16 v[152:155], a[244:247], a[104:107], v[152:155]
ds_read_b32 a126, v57
v_perm_b32 v56, v101, v19, s55
v_mfma_f32_16x16x32_bf16 v[156:159], a[244:247], a[108:111], v[156:159]
s_waitcnt vmcnt(8)
s_add_u32 m0, s33, 80256
v_cmp_ne_u64 s[50:51], s[88:89], v[42:43]
v_cmp_ne_u64 s[44:45], s[88:89], v[46:47]
v_mfma_f32_16x16x32_bf16 v[156:159], a[240:243], a[92:95], v[156:159]
s_waitcnt lgkmcnt(3)
ds_read_b32 a127, v56
buffer_load_dwordx4 v[88:91], v12, s[24:27], 0 offen offset:2048 sc1
v_mfma_f32_16x16x32_bf16 v[192:195], a[248:251], a[64:67], v[192:195]
s_or_b64 s[50:51], s[44:45], s[50:51]
ds_read_b128 a[224:227], v14 offset:61440
buffer_load_dwordx4 v9, s[20:23], 0 offen offset:1664 lds
v_mfma_f32_16x16x32_bf16 v[192:195], a[252:255], a[80:83], v[192:195]
s_cbranch_scc1 L_SLOW22
L_BACK22:
v_mfma_f32_16x16x32_bf16 v[196:199], a[252:255], a[84:87], v[196:199]
ds_read_b128 a[228:231], v15 offset:61440
v_perm_b32 v63, v40, v19, s52
v_mfma_f32_16x16x32_bf16 v[196:199], a[248:251], a[68:71], v[196:199]
ds_read_b32 a128, v63
v_perm_b32 v62, v40, v19, s53
v_mfma_f32_16x16x32_bf16 v[200:203], a[248:251], a[72:75], v[200:203]
ds_read_b32 a129, v62
v_perm_b32 v61, v44, v19, s52
v_mfma_f32_16x16x32_bf16 v[200:203], a[252:255], a[88:91], v[200:203]
ds_read_b32 a130, v61
v_perm_b32 v60, v44, v19, s53
v_mfma_f32_16x16x32_bf16 v[204:207], a[252:255], a[92:95], v[204:207]
ds_read_b32 a131, v60
v_perm_b32 v59, v40, v19, s54
v_mfma_f32_16x16x32_bf16 v[204:207], a[248:251], a[76:79], v[204:207]
s_waitcnt lgkmcnt(4)
ds_read_b32 a132, v59
buffer_load_dwordx4 v[92:95], v12, s[24:27], 0 offen offset:3072 sc1
v_mfma_f32_16x16x32_bf16 v[128:131], a[224:227], a[96:99], v[128:131]
ds_read_b128 a[232:235], v15 offset:51200
v_perm_b32 v58, v40, v19, s55
v_mfma_f32_16x16x32_bf16 v[128:131], a[228:231], a[112:115], v[128:131]
ds_read_b32 a133, v58
v_add_u32 v12, 53248, v13
v_mfma_f32_16x16x32_bf16 v[132:135], a[228:231], a[116:119], v[132:135]
ds_read_b128 a[236:239], v16 offset:2048
v_perm_b32 v57, v44, v19, s54
v_mfma_f32_16x16x32_bf16 v[132:135], a[224:227], a[100:103], v[132:135]
s_add_u32 m0, s33, 84224
ds_read_b32 a134, v57
v_mfma_f32_16x16x32_bf16 v[136:139], a[224:227], a[104:107], v[136:139]
buffer_load_dwordx4 v8, s[20:23], 0 offen offset:1792 lds
v_perm_b32 v56, v44, v19, s55
v_mfma_f32_16x16x32_bf16 v[136:139], a[228:231], a[120:123], v[136:139]
ds_read_b32 a135, v56
v_perm_b32 v63, v41, v19, s52
v_mfma_f32_16x16x32_bf16 v[140:143], a[228:231], a[124:127], v[140:143]
ds_read_b32 a136, v63
v_perm_b32 v62, v41, v19, s53
v_mfma_f32_16x16x32_bf16 v[140:143], a[224:227], a[108:111], v[140:143]
s_waitcnt lgkmcnt(3)
ds_read_b32 a137, v62
v_mfma_f32_16x16x32_bf16 v[176:179], a[232:235], a[80:83], v[176:179]
ds_read_b128 a[240:243], v16 offset:0
v_perm_b32 v61, v45, v19, s52
v_mfma_f32_16x16x32_bf16 v[176:179], a[236:239], a[96:99], v[176:179]
ds_read_b32 a138, v61
v_mfma_f32_16x16x32_bf16 v[180:183], a[236:239], a[100:103], v[180:183]
ds_read_b128 a[244:247], v17 offset:0
v_perm_b32 v60, v45, v19, s53
v_mfma_f32_16x16x32_bf16 v[180:183], a[232:235], a[84:87], v[180:183]
ds_read_b32 a139, v60
v_perm_b32 v59, v41, v19, s54
v_mfma_f32_16x16x32_bf16 v[184:187], a[232:235], a[88:91], v[184:187]
ds_read_b32 a140, v59
v_perm_b32 v58, v41, v19, s55
v_mfma_f32_16x16x32_bf16 v[184:187], a[236:239], a[104:107], v[184:187]
ds_read_b32 a141, v58
v_perm_b32 v57, v45, v19, s54
v_mfma_f32_16x16x32_bf16 v[188:191], a[236:239], a[108:111], v[188:191]
s_waitcnt vmcnt(8)
s_add_u32 m0, s33, 76416
v_cmp_ne_u64 s[50:51], s[88:89], v[50:51]
v_cmp_ne_u64 s[44:45], s[88:89], v[54:55]
v_mfma_f32_16x16x32_bf16 v[188:191], a[232:235], a[92:95], v[188:191]
s_waitcnt lgkmcnt(3)
ds_read_b32 a142, v57
v_mfma_f32_16x16x32_bf16 v[160:163], a[240:243], a[96:99], v[160:163]
s_or_b64 s[50:51], s[44:45], s[50:51]
ds_read_b128 a[248:251], v15 offset:38912
buffer_load_dwordx4 v11, s[20:23], 0 offen offset:1408 lds
v_mfma_f32_16x16x32_bf16 v[160:163], a[244:247], a[112:115], v[160:163]
s_cbranch_scc1 L_SLOW23
L_BACK23:
v_mfma_f32_16x16x32_bf16 v[164:167], a[244:247], a[116:119], v[164:167]
ds_read_b128 a[252:255], v14 offset:55296
v_perm_b32 v56, v45, v19, s55
v_mfma_f32_16x16x32_bf16 v[164:167], a[240:243], a[100:103], v[164:167]
ds_read_b32 a143, v56
v_perm_b32 v63, v48, v19, s52
v_mfma_f32_16x16x32_bf16 v[168:171], a[240:243], a[104:107], v[168:171]
ds_read_b32 a144, v63
v_perm_b32 v62, v48, v19, s53
v_mfma_f32_16x16x32_bf16 v[168:171], a[244:247], a[120:123], v[168:171]
ds_read_b32 a145, v62
v_perm_b32 v61, v52, v19, s52
v_mfma_f32_16x16x32_bf16 v[172:175], a[244:247], a[124:127], v[172:175]
ds_read_b32 a146, v61
v_perm_b32 v60, v52, v19, s53
v_mfma_f32_16x16x32_bf16 v[172:175], a[240:243], a[108:111], v[172:175]
s_waitcnt lgkmcnt(4)
ds_read_b32 a147, v60
buffer_load_dwordx4 v[32:35], v12, s[24:27], 0 offen offset:0 sc1
v_mfma_f32_16x16x32_bf16 v[240:243], a[248:251], a[16:19], v[240:243]
ds_read_b128 a[224:227], v15 offset:63488
v_perm_b32 v59, v48, v19, s54
v_mfma_f32_16x16x32_bf16 v[240:243], a[252:255], a[32:35], v[240:243]
ds_read_b32 a148, v59
buffer_load_dwordx4 v[36:39], v12, s[24:27], 0 offen offset:1024 sc1
v_mfma_f32_16x16x32_bf16 v[244:247], a[252:255], a[36:39], v[244:247]
ds_read_b128 a[228:231], v16 offset:6144
v_perm_b32 v58, v48, v19, s55
v_mfma_f32_16x16x32_bf16 v[244:247], a[248:251], a[20:23], v[244:247]
s_add_u32 m0, s33, 88320
ds_read_b32 a149, v58
v_mfma_f32_16x16x32_bf16 v[248:251], a[248:251], a[24:27], v[248:251]
buffer_load_dwordx4 v9, s[20:23], 0 offen offset:1792 lds
v_perm_b32 v57, v52, v19, s54
v_mfma_f32_16x16x32_bf16 v[248:251], a[252:255], a[40:43], v[248:251]
ds_read_b32 a150, v57
v_perm_b32 v56, v52, v19, s55
v_mfma_f32_16x16x32_bf16 v[252:255], a[252:255], a[44:47], v[252:255]
ds_read_b32 a151, v56
v_perm_b32 v63, v49, v19, s52
v_mfma_f32_16x16x32_bf16 v[252:255], a[248:251], a[28:31], v[252:255]
s_waitcnt lgkmcnt(3)
ds_read_b32 a152, v63
v_mfma_f32_16x16x32_bf16 v[144:147], a[224:227], a[112:115], v[144:147]
ds_read_b128 a[232:235], v16 offset:8192
v_perm_b32 v62, v49, v19, s53
v_mfma_f32_16x16x32_bf16 v[144:147], a[228:231], a[128:131], v[144:147]
ds_read_b32 a153, v62
v_mfma_f32_16x16x32_bf16 v[148:151], a[228:231], a[132:135], v[148:151]
ds_read_b128 a[236:239], v17 offset:8192
v_perm_b32 v61, v53, v19, s52
v_mfma_f32_16x16x32_bf16 v[148:151], a[224:227], a[116:119], v[148:151]
ds_read_b32 a154, v61
v_perm_b32 v60, v53, v19, s53
v_mfma_f32_16x16x32_bf16 v[152:155], a[224:227], a[120:123], v[152:155]
ds_read_b32 a155, v60
v_perm_b32 v59, v49, v19, s54
v_mfma_f32_16x16x32_bf16 v[152:155], a[228:231], a[136:139], v[152:155]
ds_read_b32 a156, v59
v_perm_b32 v58, v49, v19, s55
v_mfma_f32_16x16x32_bf16 v[156:159], a[228:231], a[140:143], v[156:159]
s_add_u32 m0, s33, 92544
ds_read_b32 a157, v58
v_perm_b32 v57, v53, v19, s54
v_mfma_f32_16x16x32_bf16 v[156:159], a[224:227], a[124:127], v[156:159]
s_waitcnt vmcnt(9) lgkmcnt(4)
v_cmp_ne_u64 s[50:51], s[88:89], v[82:83]
v_cmp_ne_u64 s[44:45], s[88:89], v[86:87]
v_mfma_f32_16x16x32_bf16 v[224:227], a[232:235], a[64:67], v[224:227]
ds_read_b128 a[240:243], v15 offset:59392
buffer_load_dwordx4 v10, s[20:23], 0 offen offset:1664 lds
v_mfma_f32_16x16x32_bf16 v[224:227], a[236:239], a[80:83], v[224:227]
ds_read_b32 a158, v57
v_mfma_f32_16x16x32_bf16 v[228:231], a[236:239], a[84:87], v[228:231]
s_or_b64 s[50:51], s[44:45], s[50:51]
ds_read_b128 a[244:247], v16 offset:14336
v_perm_b32 v56, v53, v19, s55
v_mfma_f32_16x16x32_bf16 v[228:231], a[232:235], a[68:71], v[228:231]
s_cbranch_scc1 L_SLOW24
L_BACK24:
v_mfma_f32_16x16x32_bf16 v[232:235], a[232:235], a[72:75], v[232:235]
ds_read_b32 a159, v56
v_perm_b32 v63, v80, v19, s52
v_mfma_f32_16x16x32_bf16 v[232:235], a[236:239], a[88:91], v[232:235]
ds_read_b32 a160, v63
v_perm_b32 v62, v80, v19, s53
v_mfma_f32_16x16x32_bf16 v[236:239], a[236:239], a[92:95], v[236:239]
ds_read_b32 a161, v62
v_perm_b32 v61, v84, v19, s52
v_mfma_f32_16x16x32_bf16 v[236:239], a[232:235], a[76:79], v[236:239]
s_waitcnt lgkmcnt(3)
ds_read_b32 a162, v61
buffer_load_dwordx4 v[96:99], v12, s[24:27], 0 offen offset:2048 sc1
v_mfma_f32_16x16x32_bf16 v[208:211], a[240:243], a[80:83], v[208:211]
s_barrier
ds_read_b128 a[248:251], v16 offset:4096
v_perm_b32 v60, v84, v19, s53
v_mfma_f32_16x16x32_bf16 v[208:211], a[244:247], a[96:99], v[208:211]
ds_read_b32 a163, v60
buffer_load_dwordx4 v[100:103], v12, s[24:27], 0 offen offset:3072 sc1
v_mfma_f32_16x16x32_bf16 v[212:215], a[244:247], a[100:103], v[212:215]
ds_read_b128 a[252:255], v17 offset:4096
v_perm_b32 v59, v80, v19, s54
v_mfma_f32_16x16x32_bf16 v[212:215], a[240:243], a[84:87], v[212:215]
s_add_u32 m0, s33, 96384
ds_read_b32 a164, v59
v_add_u32 v12, 57344, v13
v_mfma_f32_16x16x32_bf16 v[216:219], a[240:243], a[88:91], v[216:219]
buffer_load_dwordx4 v8, s[20:23], 0 offen offset:1920 lds
v_perm_b32 v58, v80, v19, s55
v_mfma_f32_16x16x32_bf16 v[216:219], a[244:247], a[104:107], v[216:219]
ds_read_b32 a165, v58
v_perm_b32 v57, v84, v19, s54
v_mfma_f32_16x16x32_bf16 v[220:223], a[244:247], a[108:111], v[220:223]
ds_read_b32 a166, v57
v_perm_b32 v56, v84, v19, s55
v_mfma_f32_16x16x32_bf16 v[220:223], a[240:243], a[92:95], v[220:223]
s_waitcnt lgkmcnt(3)
ds_read_b32 a167, v56
v_mfma_f32_16x16x32_bf16 v[128:131], a[248:251], a[128:131], v[128:131]
ds_read_b128 a[224:227], v16 offset:12288
v_perm_b32 v63, v81, v19, s52
v_mfma_f32_16x16x32_bf16 v[128:131], a[252:255], a[144:147], v[128:131]
ds_read_b32 a168, v63
v_mfma_f32_16x16x32_bf16 v[132:135], a[252:255], a[148:151], v[132:135]
ds_read_b128 a[228:231], v17 offset:12288
v_perm_b32 v62, v81, v19, s53
v_mfma_f32_16x16x32_bf16 v[132:135], a[248:251], a[132:135], v[132:135]
ds_read_b32 a169, v62
v_perm_b32 v61, v85, v19, s52
v_mfma_f32_16x16x32_bf16 v[136:139], a[248:251], a[136:139], v[136:139]
ds_read_b32 a170, v61
v_perm_b32 v60, v85, v19, s53
v_mfma_f32_16x16x32_bf16 v[136:139], a[252:255], a[152:155], v[136:139]
ds_read_b32 a171, v60
v_perm_b32 v59, v81, v19, s54
v_mfma_f32_16x16x32_bf16 v[140:143], a[252:255], a[156:159], v[140:143]
ds_read_b32 a172, v59
v_perm_b32 v58, v81, v19, s55
v_mfma_f32_16x16x32_bf16 v[140:143], a[248:251], a[140:143], v[140:143]
s_waitcnt lgkmcnt(4)
ds_read_b32 a173, v58
v_mfma_f32_16x16x32_bf16 v[192:195], a[224:227], a[96:99], v[192:195]
ds_read_b128 a[232:235], v17 offset:2048
v_mfma_f32_16x16x32_bf16 v[192:195], a[228:231], a[112:115], v[192:195]
s_waitcnt vmcnt(9)
v_cmp_ne_u64 s[50:51], s[88:89], v[90:91]
v_cmp_ne_u64 s[44:45], s[88:89], v[94:95]
v_mfma_f32_16x16x32_bf16 v[196:199], a[228:231], a[116:119], v[196:199]
ds_read_b128 a[236:239], v16 offset:18432
v_perm_b32 v57, v85, v19, s54
v_mfma_f32_16x16x32_bf16 v[196:199], a[224:227], a[100:103], v[196:199]
L_PAD4:
s_cbranch_vccnz L_PAD5
s_or_b64 s[50:51], s[44:45], s[50:51]
ds_read_b32 a174, v57
v_perm_b32 v56, v85, v19, s55
v_mfma_f32_16x16x32_bf16 v[200:203], a[224:227], a[104:107], v[200:203]
s_cbranch_scc1 L_SLOW25
L_BACK25:
v_mfma_f32_16x16x32_bf16 v[200:203], a[228:231], a[120:123], v[200:203]
ds_read_b32 a175, v56
v_perm_b32 v63, v88, v19, s52
v_mfma_f32_16x16x32_bf16 v[204:207], a[228:231], a[124:127], v[204:207]
ds_read_b32 a176, v63
v_perm_b32 v62, v88, v19, s53
v_mfma_f32_16x16x32_bf16 v[204:207], a[224:227], a[108:111], v[204:207]
s_waitcnt lgkmcnt(3)
ds_read_b32 a177, v62
v_mfma_f32_16x16x32_bf16 v[176:179], a[232:235], a[112:115], v[176:179]
ds_read_b128 a[240:243], v16 offset:16384
v_perm_b32 v61, v92, v19, s52
v_mfma_f32_16x16x32_bf16 v[176:179], a[236:239], a[128:131], v[176:179]
ds_read_b32 a178, v61
v_mfma_f32_16x16x32_bf16 v[180:183], a[236:239], a[132:135], v[180:183]
ds_read_b128 a[244:247], v17 offset:16384
v_perm_b32 v60, v92, v19, s53
v_mfma_f32_16x16x32_bf16 v[180:183], a[232:235], a[116:119], v[180:183]
ds_read_b32 a179, v60
v_perm_b32 v59, v88, v19, s54
v_mfma_f32_16x16x32_bf16 v[184:187], a[232:235], a[120:123], v[184:187]
ds_read_b32 a180, v59
v_perm_b32 v58, v88, v19, s55
v_mfma_f32_16x16x32_bf16 v[184:187], a[236:239], a[136:139], v[184:187]
ds_read_b32 a181, v58
v_perm_b32 v57, v92, v19, s54
v_mfma_f32_16x16x32_bf16 v[188:191], a[236:239], a[140:143], v[188:191]
ds_read_b32 a182, v57
v_perm_b32 v56, v92, v19, s55
v_mfma_f32_16x16x32_bf16 v[188:191], a[232:235], a[124:127], v[188:191]
s_waitcnt lgkmcnt(4)
ds_read_b32 a183, v56
buffer_load_dwordx4 v[40:43], v12, s[24:27], 0 offen offset:0 sc1
v_mfma_f32_16x16x32_bf16 v[160:163], a[240:243], a[128:131], v[160:163]
ds_read_b128 a[248:251], v17 offset:6144
v_perm_b32 v63, v89, v19, s52
v_mfma_f32_16x16x32_bf16 v[160:163], a[244:247], a[144:147], v[160:163]
ds_read_b32 a184, v63
buffer_load_dwordx4 v[44:47], v12, s[24:27], 0 offen offset:1024 sc1
v_mfma_f32_16x16x32_bf16 v[164:167], a[244:247], a[148:151], v[164:167]
ds_read_b128 a[252:255], v16 offset:22528
v_perm_b32 v62, v89, v19, s53
v_mfma_f32_16x16x32_bf16 v[164:167], a[240:243], a[132:135], v[164:167]
ds_read_b32 a185, v62
v_perm_b32 v61, v93, v19, s52
v_mfma_f32_16x16x32_bf16 v[168:171], a[240:243], a[136:139], v[168:171]
ds_read_b32 a186, v61
v_perm_b32 v60, v93, v19, s53
v_mfma_f32_16x16x32_bf16 v[168:171], a[244:247], a[152:155], v[168:171]
ds_read_b32 a187, v60
v_perm_b32 v59, v89, v19, s54
v_mfma_f32_16x16x32_bf16 v[172:175], a[244:247], a[156:159], v[172:175]
ds_read_b32 a188, v59
v_perm_b32 v58, v89, v19, s55
v_mfma_f32_16x16x32_bf16 v[172:175], a[240:243], a[140:143], v[172:175]
s_waitcnt lgkmcnt(4)
ds_read_b32 a189, v58
v_mfma_f32_16x16x32_bf16 v[144:147], a[248:251], a[144:147], v[144:147]
ds_read_b128 a[224:227], v16 offset:20480
v_perm_b32 v57, v93, v19, s54
v_mfma_f32_16x16x32_bf16 v[144:147], a[252:255], a[160:163], v[144:147]
ds_read_b32 a190, v57
v_mfma_f32_16x16x32_bf16 v[148:151], a[252:255], a[164:167], v[148:151]
ds_read_b128 a[228:231], v17 offset:20480
v_perm_b32 v56, v93, v19, s55
v_mfma_f32_16x16x32_bf16 v[148:151], a[248:251], a[148:151], v[148:151]
ds_read_b32 a191, v56
v_mfma_f32_16x16x32_bf16 v[152:155], a[248:251], a[152:155], v[152:155]
v_mfma_f32_16x16x32_bf16 v[152:155], a[252:255], a[168:171], v[152:155]
v_mfma_f32_16x16x32_bf16 v[156:159], a[252:255], a[172:175], v[156:159]
s_waitcnt vmcnt(7)
v_cmp_ne_u64 s[50:51], s[88:89], v[34:35]
v_cmp_ne_u64 s[44:45], s[88:89], v[38:39]
v_mfma_f32_16x16x32_bf16 v[156:159], a[248:251], a[156:159], v[156:159]
s_waitcnt lgkmcnt(1)
v_mfma_f32_16x16x32_bf16 v[128:131], a[224:227], a[160:163], v[128:131]
s_or_b64 s[50:51], s[44:45], s[50:51]
ds_read_b128 a[232:235], v16 offset:24576
v_mfma_f32_16x16x32_bf16 v[128:131], a[228:231], a[176:179], v[128:131]
s_cbranch_scc1 L_SLOW26
L_BACK26:
v_mfma_f32_16x16x32_bf16 v[132:135], a[228:231], a[180:183], v[132:135]
ds_read_b128 a[236:239], v17 offset:24576
v_mfma_f32_16x16x32_bf16 v[132:135], a[224:227], a[164:167], v[132:135]
buffer_load_dwordx4 v[48:51], v12, s[24:27], 0 offen offset:2048 sc1
v_perm_b32 v63, v32, v19, s52
v_mfma_f32_16x16x32_bf16 v[136:139], a[224:227], a[168:171], v[136:139]
ds_read_b32 a192, v63
v_perm_b32 v62, v32, v19, s53
v_mfma_f32_16x16x32_bf16 v[136:139], a[228:231], a[184:187], v[136:139]
s_waitcnt lgkmcnt(2)
ds_read_b32 a193, v62
v_perm_b32 v61, v36, v19, s52
v_mfma_f32_16x16x32_bf16 v[140:143], a[228:231], a[188:191], v[140:143]
s_add_u32 m0, s33, 104960
ds_read_b32 a194, v61
v_perm_b32 v60, v36, v19, s53
v_mfma_f32_16x16x32_bf16 v[140:143], a[224:227], a[172:175], v[140:143]
s_waitcnt lgkmcnt(3)
ds_read_b32 a195, v60
v_perm_b32 v59, v32, v19, s54
v_mfma_f32_16x16x32_bf16 v[192:195], a[232:235], a[128:131], v[192:195]
ds_read_b128 a[240:243], v17 offset:14336
buffer_load_dwordx4 v11, s[20:23], 0 offen offset:1536 lds
v_mfma_f32_16x16x32_bf16 v[192:195], a[236:239], a[144:147], v[192:195]
ds_read_b32 a196, v59
buffer_load_dwordx4 v[52:55], v12, s[24:27], 0 offen offset:3072 sc1
v_mfma_f32_16x16x32_bf16 v[196:199], a[236:239], a[148:151], v[196:199]
ds_read_b128 a[244:247], v16 offset:26624
v_perm_b32 v58, v32, v19, s55
v_mfma_f32_16x16x32_bf16 v[196:199], a[232:235], a[132:135], v[196:199]
ds_read_b32 a197, v58
v_perm_b32 v57, v36, v19, s54
v_mfma_f32_16x16x32_bf16 v[200:203], a[232:235], a[136:139], v[200:203]
ds_read_b32 a198, v57
v_perm_b32 v56, v36, v19, s55
v_mfma_f32_16x16x32_bf16 v[200:203], a[236:239], a[152:155], v[200:203]
ds_read_b32 a199, v56
v_perm_b32 v63, v33, v19, s52
v_mfma_f32_16x16x32_bf16 v[204:207], a[236:239], a[156:159], v[204:207]
ds_read_b32 a200, v63
v_perm_b32 v62, v33, v19, s53
v_mfma_f32_16x16x32_bf16 v[204:207], a[232:235], a[140:143], v[204:207]
s_waitcnt lgkmcnt(4)
ds_read_b32 a201, v62
v_add_u32 v12, 61440, v13
v_mfma_f32_16x16x32_bf16 v[208:211], a[240:243], a[112:115], v[208:211]
ds_read_b128 a[248:251], v17 offset:18432
v_perm_b32 v61, v37, v19, s52
v_mfma_f32_16x16x32_bf16 v[208:211], a[244:247], a[128:131], v[208:211]
ds_read_b32 a202, v61
v_mfma_f32_16x16x32_bf16 v[212:215], a[244:247], a[132:135], v[212:215]
ds_read_b128 a[252:255], v16 offset:30720
v_perm_b32 v60, v37, v19, s53
v_mfma_f32_16x16x32_bf16 v[212:215], a[240:243], a[116:119], v[212:215]
s_add_u32 m0, s33, 108672
ds_read_b32 a203, v60
v_mfma_f32_16x16x32_bf16 v[216:219], a[240:243], a[120:123], v[216:219]
buffer_load_dwordx4 v9, s[20:23], 0 offen offset:1920 lds
v_perm_b32 v59, v33, v19, s54
v_mfma_f32_16x16x32_bf16 v[216:219], a[244:247], a[136:139], v[216:219]
ds_read_b32 a204, v59
v_perm_b32 v58, v33, v19, s55
v_mfma_f32_16x16x32_bf16 v[220:223], a[244:247], a[140:143], v[220:223]
ds_read_b32 a205, v58
v_mfma_f32_16x16x32_bf16 v[220:223], a[240:243], a[124:127], v[220:223]
s_waitcnt vmcnt(7) lgkmcnt(3)
v_perm_b32 v57, v37, v19, s54
v_cmp_ne_u64 s[50:51], s[88:89], v[98:99]
v_mfma_f32_16x16x32_bf16 v[176:179], a[248:251], a[144:147], v[176:179]
ds_read_b128 a[224:227], v14 offset:0
v_cmp_ne_u64 s[44:45], s[88:89], v[102:103]
v_mfma_f32_16x16x32_bf16 v[176:179], a[252:255], a[160:163], v[176:179]
ds_read_b32 a206, v57
v_mfma_f32_16x16x32_bf16 v[180:183], a[252:255], a[164:167], v[180:183]
s_or_b64 s[50:51], s[44:45], s[50:51]
ds_read_b128 a[228:231], v15 offset:0
v_perm_b32 v56, v37, v19, s55
v_mfma_f32_16x16x32_bf16 v[180:183], a[248:251], a[148:151], v[180:183]
s_cbranch_scc1 L_SLOW27
L_BACK27:
v_mfma_f32_16x16x32_bf16 v[184:187], a[248:251], a[152:155], v[184:187]
ds_read_b32 a207, v56
v_perm_b32 v63, v96, v19, s52
v_mfma_f32_16x16x32_bf16 v[184:187], a[252:255], a[168:171], v[184:187]
ds_read_b32 a208, v63
v_perm_b32 v62, v96, v19, s53
v_mfma_f32_16x16x32_bf16 v[188:191], a[252:255], a[172:175], v[188:191]
s_add_u32 m0, s33, 112896
ds_read_b32 a209, v62
v_perm_b32 v61, v100, v19, s52
v_mfma_f32_16x16x32_bf16 v[188:191], a[248:251], a[156:159], v[188:191]
s_waitcnt lgkmcnt(3)
ds_read_b32 a210, v61
v_perm_b32 v60, v100, v19, s53
v_mfma_f32_16x16x32_bf16 v[224:227], a[224:227], a[96:99], v[224:227]
ds_read_b128 a[232:235], v16 offset:28672
buffer_load_dwordx4 v10, s[20:23], 0 offen offset:1792 lds
v_mfma_f32_16x16x32_bf16 v[224:227], a[228:231], a[112:115], v[224:227]
ds_read_b32 a211, v60
buffer_load_dwordx4 v[80:83], v12, s[24:27], 0 offen offset:0 sc1
v_mfma_f32_16x16x32_bf16 v[228:231], a[228:231], a[116:119], v[228:231]
ds_read_b128 a[236:239], v17 offset:28672
v_perm_b32 v59, v96, v19, s54
v_mfma_f32_16x16x32_bf16 v[228:231], a[224:227], a[100:103], v[228:231]
ds_read_b32 a212, v59
v_perm_b32 v58, v96, v19, s55
v_mfma_f32_16x16x32_bf16 v[232:235], a[224:227], a[104:107], v[232:235]
ds_read_b32 a213, v58
v_perm_b32 v57, v100, v19, s54
v_mfma_f32_16x16x32_bf16 v[232:235], a[228:231], a[120:123], v[232:235]
ds_read_b32 a214, v57
v_perm_b32 v56, v100, v19, s55
v_mfma_f32_16x16x32_bf16 v[236:239], a[228:231], a[124:127], v[236:239]
ds_read_b32 a215, v56
v_perm_b32 v63, v97, v19, s52
v_mfma_f32_16x16x32_bf16 v[236:239], a[224:227], a[108:111], v[236:239]
s_waitcnt lgkmcnt(4)
ds_read_b32 a216, v63
buffer_load_dwordx4 v[84:87], v12, s[24:27], 0 offen offset:1024 sc1
v_mfma_f32_16x16x32_bf16 v[160:163], a[232:235], a[160:163], v[160:163]
ds_read_b128 a[240:243], v17 offset:22528
v_perm_b32 v62, v97, v19, s53
v_mfma_f32_16x16x32_bf16 v[160:163], a[236:239], a[176:179], v[160:163]
ds_read_b32 a217, v62
v_mfma_f32_16x16x32_bf16 v[164:167], a[236:239], a[180:183], v[164:167]
ds_read_b128 a[244:247], v14 offset:6144
v_perm_b32 v61, v101, v19, s52
v_mfma_f32_16x16x32_bf16 v[164:167], a[232:235], a[164:167], v[164:167]
s_add_u32 m0, s33, 100736
ds_read_b32 a218, v61
v_mfma_f32_16x16x32_bf16 v[168:171], a[232:235], a[168:171], v[168:171]
buffer_load_dwordx4 v11, s[20:23], 0 offen offset:1664 lds
v_perm_b32 v60, v101, v19, s53
v_mfma_f32_16x16x32_bf16 v[168:171], a[236:239], a[184:187], v[168:171]
ds_read_b32 a219, v60
v_perm_b32 v59, v97, v19, s54
v_mfma_f32_16x16x32_bf16 v[172:175], a[236:239], a[188:191], v[172:175]
ds_read_b32 a220, v59
v_perm_b32 v58, v97, v19, s55
v_mfma_f32_16x16x32_bf16 v[172:175], a[232:235], a[172:175], v[172:175]
s_waitcnt lgkmcnt(3)
ds_read_b32 a221, v58
v_mfma_f32_16x16x32_bf16 v[144:147], a[240:243], a[176:179], v[144:147]
s_waitcnt vmcnt(10)
s_barrier
ds_read_b128 a[248:251], v14 offset:4096
v_perm_b32 v57, v101, v19, s54
v_mfma_f32_16x16x32_bf16 v[144:147], a[244:247], a[192:195], v[144:147]
ds_read_b32 a222, v57
v_mfma_f32_16x16x32_bf16 v[148:151], a[244:247], a[196:199], v[148:151]
ds_read_b128 a[252:255], v15 offset:4096
v_perm_b32 v56, v101, v19, s55
v_mfma_f32_16x16x32_bf16 v[148:151], a[240:243], a[180:183], v[148:151]
ds_read_b32 a223, v56
v_mfma_f32_16x16x32_bf16 v[152:155], a[240:243], a[184:187], v[152:155]
v_mfma_f32_16x16x32_bf16 v[152:155], a[244:247], a[200:203], v[152:155]
buffer_load_dwordx4 v[88:91], v12, s[24:27], 0 offen offset:2048 sc1
v_mfma_f32_16x16x32_bf16 v[156:159], a[244:247], a[204:207], v[156:159]
s_waitcnt vmcnt(9)
s_add_u32 m0, s33, 125056
v_cmp_ne_u64 s[50:51], s[88:89], v[42:43]
v_cmp_ne_u64 s[44:45], s[88:89], v[46:47]
v_mfma_f32_16x16x32_bf16 v[156:159], a[240:243], a[188:191], v[156:159]
s_waitcnt lgkmcnt(1)
buffer_load_dwordx4 v[92:95], v12, s[24:27], 0 offen offset:3072 sc1
v_mfma_f32_16x16x32_bf16 v[128:131], a[248:251], a[192:195], v[128:131]
s_or_b64 s[50:51], s[44:45], s[50:51]
ds_read_b128 a[224:227], v15 offset:55296
buffer_load_dwordx4 v10, s[20:23], 0 offen offset:1920 lds
v_mfma_f32_16x16x32_bf16 v[128:131], a[252:255], a[208:211], v[128:131]
s_cbranch_scc1 L_SLOW28
L_BACK28:
v_mfma_f32_16x16x32_bf16 v[132:135], a[252:255], a[212:215], v[132:135]
ds_read_b128 a[228:231], v16 offset:10240
v_mfma_f32_16x16x32_bf16 v[132:135], a[248:251], a[196:199], v[132:135]
v_perm_b32 v63, v40, v19, s52
v_mfma_f32_16x16x32_bf16 v[136:139], a[248:251], a[200:203], v[136:139]
ds_read_b32 a0, v63
v_perm_b32 v62, v40, v19, s53
v_mfma_f32_16x16x32_bf16 v[136:139], a[252:255], a[216:219], v[136:139]
s_waitcnt lgkmcnt(2)
ds_read_b32 a1, v62
v_perm_b32 v61, v44, v19, s52
v_mfma_f32_16x16x32_bf16 v[140:143], a[252:255], a[220:223], v[140:143]
ds_read_b32 a2, v61
v_perm_b32 v60, v44, v19, s53
v_mfma_f32_16x16x32_bf16 v[140:143], a[248:251], a[204:207], v[140:143]
s_waitcnt lgkmcnt(3)
ds_read_b32 a3, v60
v_mfma_f32_16x16x32_bf16 v[240:243], a[224:227], a[48:51], v[240:243]
ds_read_b128 a[232:235], v14 offset:8192
v_perm_b32 v59, v40, v19, s54
v_mfma_f32_16x16x32_bf16 v[240:243], a[228:231], a[64:67], v[240:243]
ds_read_b32 a4, v59
v_mfma_f32_16x16x32_bf16 v[244:247], a[228:231], a[68:71], v[244:247]
ds_read_b128 a[236:239], v15 offset:8192
v_perm_b32 v58, v40, v19, s55
v_mfma_f32_16x16x32_bf16 v[244:247], a[224:227], a[52:55], v[244:247]
s_add_u32 m0, s33, 121088
ds_read_b32 a5, v58
v_mfma_f32_16x16x32_bf16 v[248:251], a[224:227], a[56:59], v[248:251]
buffer_load_dwordx4 v11, s[20:23], 0 offen offset:1792 lds
v_perm_b32 v57, v44, v19, s54
v_mfma_f32_16x16x32_bf16 v[248:251], a[228:231], a[72:75], v[248:251]
ds_read_b32 a6, v57
v_perm_b32 v56, v44, v19, s55
v_mfma_f32_16x16x32_bf16 v[252:255], a[228:231], a[76:79], v[252:255]
ds_read_b32 a7, v56
v_perm_b32 v63, v41, v19, s52
v_mfma_f32_16x16x32_bf16 v[252:255], a[224:227], a[60:63], v[252:255]
s_waitcnt lgkmcnt(3)
ds_read_b32 a8, v63
v_mfma_f32_16x16x32_bf16 v[192:195], a[232:235], a[160:163], v[192:195]
ds_read_b128 a[240:243], v17 offset:30720
v_perm_b32 v62, v41, v19, s53
v_mfma_f32_16x16x32_bf16 v[192:195], a[236:239], a[176:179], v[192:195]
ds_read_b32 a9, v62
v_mfma_f32_16x16x32_bf16 v[196:199], a[236:239], a[180:183], v[196:199]
ds_read_b128 a[244:247], v14 offset:18432
v_perm_b32 v61, v45, v19, s52
v_mfma_f32_16x16x32_bf16 v[196:199], a[232:235], a[164:167], v[196:199]
ds_read_b32 a10, v61
v_perm_b32 v60, v45, v19, s53
v_mfma_f32_16x16x32_bf16 v[200:203], a[232:235], a[168:171], v[200:203]
ds_read_b32 a11, v60
v_perm_b32 v59, v41, v19, s54
v_mfma_f32_16x16x32_bf16 v[200:203], a[236:239], a[184:187], v[200:203]
ds_read_b32 a12, v59
v_perm_b32 v58, v41, v19, s55
v_mfma_f32_16x16x32_bf16 v[204:207], a[236:239], a[188:191], v[204:207]
s_add_u32 m0, s33, 129152
ds_read_b32 a13, v58
v_perm_b32 v57, v45, v19, s54
v_mfma_f32_16x16x32_bf16 v[204:207], a[232:235], a[172:175], v[204:207]
s_waitcnt vmcnt(9) lgkmcnt(4)
v_cmp_ne_u64 s[50:51], s[88:89], v[50:51]
v_cmp_ne_u64 s[44:45], s[88:89], v[54:55]
v_mfma_f32_16x16x32_bf16 v[176:179], a[240:243], a[176:179], v[176:179]
ds_read_b128 a[248:251], v14 offset:16384
buffer_load_dwordx4 v11, s[20:23], 0 offen offset:1920 lds
v_mfma_f32_16x16x32_bf16 v[176:179], a[244:247], a[192:195], v[176:179]
ds_read_b32 a14, v57
v_mfma_f32_16x16x32_bf16 v[180:183], a[244:247], a[196:199], v[180:183]
s_or_b64 s[50:51], s[44:45], s[50:51]
ds_read_b128 a[252:255], v15 offset:16384
v_perm_b32 v56, v45, v19, s55
v_mfma_f32_16x16x32_bf16 v[180:183], a[240:243], a[180:183], v[180:183]
s_cbranch_scc1 L_SLOW29
L_BACK29:
v_mfma_f32_16x16x32_bf16 v[184:187], a[240:243], a[184:187], v[184:187]
ds_read_b32 a15, v56
v_perm_b32 v63, v48, v19, s52
v_mfma_f32_16x16x32_bf16 v[184:187], a[244:247], a[200:203], v[184:187]
ds_read_b32 a16, v63
v_perm_b32 v62, v48, v19, s53
v_mfma_f32_16x16x32_bf16 v[188:191], a[244:247], a[204:207], v[188:191]
ds_read_b32 a17, v62
v_perm_b32 v61, v52, v19, s52
v_mfma_f32_16x16x32_bf16 v[188:191], a[240:243], a[188:191], v[188:191]
s_waitcnt lgkmcnt(3)
ds_read_b32 a18, v61
v_mfma_f32_16x16x32_bf16 v[160:163], a[248:251], a[192:195], v[160:163]
ds_read_b128 a[224:227], v17 offset:26624
v_perm_b32 v60, v52, v19, s53
v_mfma_f32_16x16x32_bf16 v[160:163], a[252:255], a[208:211], v[160:163]
ds_read_b32 a19, v60
v_mfma_f32_16x16x32_bf16 v[164:167], a[252:255], a[212:215], v[164:167]
ds_read_b128 a[228:231], v14 offset:10240
v_perm_b32 v59, v48, v19, s54
v_mfma_f32_16x16x32_bf16 v[164:167], a[248:251], a[196:199], v[164:167]
ds_read_b32 a20, v59
v_perm_b32 v58, v48, v19, s55
v_mfma_f32_16x16x32_bf16 v[168:171], a[248:251], a[200:203], v[168:171]
ds_read_b32 a21, v58
v_perm_b32 v57, v52, v19, s54
v_mfma_f32_16x16x32_bf16 v[168:171], a[252:255], a[216:219], v[168:171]
ds_read_b32 a22, v57
v_perm_b32 v56, v52, v19, s55
v_mfma_f32_16x16x32_bf16 v[172:175], a[252:255], a[220:223], v[172:175]
ds_read_b32 a23, v56
v_perm_b32 v63, v49, v19, s52
v_mfma_f32_16x16x32_bf16 v[172:175], a[248:251], a[204:207], v[172:175]
s_waitcnt lgkmcnt(4)
ds_read_b32 a24, v63
v_mfma_f32_16x16x32_bf16 v[208:211], a[224:227], a[144:147], v[208:211]
ds_read_b128 a[232:235], v15 offset:6144
v_perm_b32 v62, v49, v19, s53
v_mfma_f32_16x16x32_bf16 v[208:211], a[228:231], a[160:163], v[208:211]
ds_read_b32 a25, v62
v_mfma_f32_16x16x32_bf16 v[212:215], a[228:231], a[164:167], v[212:215]
ds_read_b128 a[236:239], v14 offset:22528
v_perm_b32 v61, v53, v19, s52
v_mfma_f32_16x16x32_bf16 v[212:215], a[224:227], a[148:151], v[212:215]
ds_read_b32 a26, v61
v_perm_b32 v60, v53, v19, s53
v_mfma_f32_16x16x32_bf16 v[216:219], a[224:227], a[152:155], v[216:219]
ds_read_b32 a27, v60
v_perm_b32 v59, v49, v19, s54
v_mfma_f32_16x16x32_bf16 v[216:219], a[228:231], a[168:171], v[216:219]
ds_read_b32 a28, v59
v_perm_b32 v58, v49, v19, s55
v_mfma_f32_16x16x32_bf16 v[220:223], a[228:231], a[172:175], v[220:223]
ds_read_b32 a29, v58
v_perm_b32 v57, v53, v19, s54
v_mfma_f32_16x16x32_bf16 v[220:223], a[224:227], a[156:159], v[220:223]
s_waitcnt lgkmcnt(4)
ds_read_b32 a30, v57
v_mfma_f32_16x16x32_bf16 v[144:147], a[232:235], a[208:211], v[144:147]
ds_read_b128 a[240:243], v14 offset:20480
v_mfma_f32_16x16x32_bf16 v[144:147], a[236:239], a[0:3], v[144:147]
s_waitcnt vmcnt(6)
v_cmp_ne_u64 s[50:51], s[88:89], v[82:83]
v_cmp_ne_u64 s[44:45], s[88:89], v[86:87]
v_mfma_f32_16x16x32_bf16 v[148:151], a[236:239], a[4:7], v[148:151]
ds_read_b128 a[244:247], v15 offset:20480
v_perm_b32 v56, v53, v19, s55
v_mfma_f32_16x16x32_bf16 v[148:151], a[232:235], a[212:215], v[148:151]
s_or_b64 s[50:51], s[44:45], s[50:51]
ds_read_b32 a31, v56
v_mfma_f32_16x16x32_bf16 v[152:155], a[232:235], a[216:219], v[152:155]
s_cbranch_scc1 L_SLOW30
L_BACK30:
v_mfma_f32_16x16x32_bf16 v[152:155], a[236:239], a[8:11], v[152:155]
v_perm_b32 v63, v80, v19, s52
v_mfma_f32_16x16x32_bf16 v[156:159], a[236:239], a[12:15], v[156:159]
ds_read_b32 a32, v63
v_perm_b32 v62, v80, v19, s53
v_mfma_f32_16x16x32_bf16 v[156:159], a[232:235], a[220:223], v[156:159]
s_waitcnt lgkmcnt(2)
ds_read_b32 a33, v62
v_mfma_f32_16x16x32_bf16 v[128:131], a[240:243], a[0:3], v[128:131]
ds_read_b128 a[248:251], v14 offset:12288
v_perm_b32 v61, v84, v19, s52
v_mfma_f32_16x16x32_bf16 v[128:131], a[244:247], a[16:19], v[128:131]
ds_read_b32 a34, v61
v_mfma_f32_16x16x32_bf16 v[132:135], a[244:247], a[20:23], v[132:135]
ds_read_b128 a[252:255], v15 offset:12288
v_perm_b32 v60, v84, v19, s53
v_mfma_f32_16x16x32_bf16 v[132:135], a[240:243], a[4:7], v[132:135]
ds_read_b32 a35, v60
v_perm_b32 v59, v80, v19, s54
v_mfma_f32_16x16x32_bf16 v[136:139], a[240:243], a[8:11], v[136:139]
ds_read_b32 a36, v59
v_perm_b32 v58, v80, v19, s55
v_mfma_f32_16x16x32_bf16 v[136:139], a[244:247], a[24:27], v[136:139]
s_waitcnt lgkmcnt(4)
ds_read_b32 a37, v58
v_perm_b32 v57, v84, v19, s54
v_mfma_f32_16x16x32_bf16 v[140:143], a[244:247], a[28:31], v[140:143]
ds_read_b32 a38, v57
v_perm_b32 v56, v84, v19, s55
v_mfma_f32_16x16x32_bf16 v[140:143], a[240:243], a[12:15], v[140:143]
s_waitcnt lgkmcnt(4)
ds_read_b32 a39, v56
v_mfma_f32_16x16x32_bf16 v[224:227], a[248:251], a[128:131], v[224:227]
ds_read_b128 a[224:227], v15 offset:18432
v_perm_b32 v63, v81, v19, s52
v_mfma_f32_16x16x32_bf16 v[224:227], a[252:255], a[144:147], v[224:227]
ds_read_b32 a40, v63
v_mfma_f32_16x16x32_bf16 v[228:231], a[252:255], a[148:151], v[228:231]
ds_read_b128 a[228:231], v14 offset:26624
v_perm_b32 v62, v81, v19, s53
v_mfma_f32_16x16x32_bf16 v[228:231], a[248:251], a[132:135], v[228:231]
ds_read_b32 a41, v62
v_perm_b32 v61, v85, v19, s52
v_mfma_f32_16x16x32_bf16 v[232:235], a[248:251], a[136:139], v[232:235]
ds_read_b32 a42, v61
v_perm_b32 v60, v85, v19, s53
v_mfma_f32_16x16x32_bf16 v[232:235], a[252:255], a[152:155], v[232:235]
ds_read_b32 a43, v60
v_perm_b32 v59, v81, v19, s54
v_mfma_f32_16x16x32_bf16 v[236:239], a[252:255], a[156:159], v[236:239]
ds_read_b32 a44, v59
v_perm_b32 v58, v81, v19, s55
v_mfma_f32_16x16x32_bf16 v[236:239], a[248:251], a[140:143], v[236:239]
s_waitcnt lgkmcnt(4)
ds_read_b32 a45, v58
v_mfma_f32_16x16x32_bf16 v[176:179], a[224:227], a[208:211], v[176:179]
ds_read_b128 a[232:235], v14 offset:24576
v_mfma_f32_16x16x32_bf16 v[176:179], a[228:231], a[0:3], v[176:179]
s_waitcnt vmcnt(3)
v_cmp_ne_u64 s[50:51], s[88:89], v[90:91]
v_cmp_ne_u64 s[44:45], s[88:89], v[94:95]
v_mfma_f32_16x16x32_bf16 v[180:183], a[228:231], a[4:7], v[180:183]
ds_read_b128 a[236:239], v15 offset:24576
v_perm_b32 v57, v85, v19, s54
v_mfma_f32_16x16x32_bf16 v[180:183], a[224:227], a[212:215], v[180:183]
s_or_b64 s[50:51], s[44:45], s[50:51]
ds_read_b32 a46, v57
v_perm_b32 v56, v85, v19, s55
v_mfma_f32_16x16x32_bf16 v[184:187], a[224:227], a[216:219], v[184:187]
s_cbranch_scc1 L_SLOW31
L_BACK31:
v_mfma_f32_16x16x32_bf16 v[184:187], a[228:231], a[8:11], v[184:187]
ds_read_b32 a47, v56
v_perm_b32 v63, v88, v19, s52
v_mfma_f32_16x16x32_bf16 v[188:191], a[228:231], a[12:15], v[188:191]
ds_read_b32 a48, v63
v_perm_b32 v62, v88, v19, s53
v_mfma_f32_16x16x32_bf16 v[188:191], a[224:227], a[220:223], v[188:191]
s_waitcnt lgkmcnt(3)
ds_read_b32 a49, v62
v_mfma_f32_16x16x32_bf16 v[160:163], a[232:235], a[0:3], v[160:163]
ds_read_b128 a[240:243], v14 offset:28672
v_perm_b32 v61, v92, v19, s52
v_mfma_f32_16x16x32_bf16 v[160:163], a[236:239], a[16:19], v[160:163]
ds_read_b32 a50, v61
v_mfma_f32_16x16x32_bf16 v[164:167], a[236:239], a[20:23], v[164:167]
ds_read_b128 a[244:247], v15 offset:28672
v_perm_b32 v60, v92, v19, s53
v_mfma_f32_16x16x32_bf16 v[164:167], a[232:235], a[4:7], v[164:167]
ds_read_b32 a51, v60
v_perm_b32 v59, v88, v19, s54
v_mfma_f32_16x16x32_bf16 v[168:171], a[232:235], a[8:11], v[168:171]
ds_read_b32 a52, v59
v_perm_b32 v58, v88, v19, s55
v_mfma_f32_16x16x32_bf16 v[168:171], a[236:239], a[24:27], v[168:171]
ds_read_b32 a53, v58
v_perm_b32 v57, v92, v19, s54
v_mfma_f32_16x16x32_bf16 v[172:175], a[236:239], a[28:31], v[172:175]
ds_read_b32 a54, v57
v_perm_b32 v56, v92, v19, s55
v_mfma_f32_16x16x32_bf16 v[172:175], a[232:235], a[12:15], v[172:175]
s_waitcnt lgkmcnt(4)
ds_read_b32 a55, v56
v_mfma_f32_16x16x32_bf16 v[192:195], a[240:243], a[192:195], v[192:195]
ds_read_b128 a[248:251], v15 offset:22528
v_perm_b32 v63, v89, v19, s52
v_mfma_f32_16x16x32_bf16 v[192:195], a[244:247], a[208:211], v[192:195]
ds_read_b32 a56, v63
v_mfma_f32_16x16x32_bf16 v[196:199], a[244:247], a[212:215], v[196:199]
ds_read_b128 a[252:255], v14 offset:34816
v_perm_b32 v62, v89, v19, s53
v_mfma_f32_16x16x32_bf16 v[196:199], a[240:243], a[196:199], v[196:199]
ds_read_b32 a57, v62
v_perm_b32 v61, v93, v19, s52
v_mfma_f32_16x16x32_bf16 v[200:203], a[240:243], a[200:203], v[200:203]
ds_read_b32 a58, v61
v_perm_b32 v60, v93, v19, s53
v_mfma_f32_16x16x32_bf16 v[200:203], a[244:247], a[216:219], v[200:203]
ds_read_b32 a59, v60
v_perm_b32 v59, v89, v19, s54
v_mfma_f32_16x16x32_bf16 v[204:207], a[244:247], a[220:223], v[204:207]
ds_read_b32 a60, v59
v_perm_b32 v58, v89, v19, s55
v_mfma_f32_16x16x32_bf16 v[204:207], a[240:243], a[204:207], v[204:207]
s_waitcnt lgkmcnt(4)
ds_read_b32 a61, v58
v_mfma_f32_16x16x32_bf16 v[144:147], a[248:251], a[16:19], v[144:147]
ds_read_b128 a[224:227], v14 offset:32768
v_perm_b32 v57, v93, v19, s54
v_mfma_f32_16x16x32_bf16 v[144:147], a[252:255], a[32:35], v[144:147]
ds_read_b32 a62, v57
v_mfma_f32_16x16x32_bf16 v[148:151], a[252:255], a[36:39], v[148:151]
L_PAD5:
s_cbranch_vccnz L_PADRET
ds_read_b128 a[228:231], v15 offset:32768
v_perm_b32 v56, v93, v19, s55
v_mfma_f32_16x16x32_bf16 v[148:151], a[248:251], a[20:23], v[148:151]
ds_read_b32 a63, v56
v_mfma_f32_16x16x32_bf16 v[152:155], a[248:251], a[24:27], v[152:155]
v_mfma_f32_16x16x32_bf16 v[152:155], a[252:255], a[40:43], v[152:155]
v_mfma_f32_16x16x32_bf16 v[156:159], a[252:255], a[44:47], v[156:159]
v_mfma_f32_16x16x32_bf16 v[156:159], a[248:251], a[28:31], v[156:159]
s_waitcnt lgkmcnt(1)
v_mfma_f32_16x16x32_bf16 v[128:131], a[224:227], a[32:35], v[128:131]
ds_read_b128 a[232:235], v15 offset:10240
v_mfma_f32_16x16x32_bf16 v[128:131], a[228:231], a[48:51], v[128:131]
v_mfma_f32_16x16x32_bf16 v[132:135], a[228:231], a[52:55], v[132:135]
ds_read_b128 a[236:239], v14 offset:30720
v_mfma_f32_16x16x32_bf16 v[132:135], a[224:227], a[36:39], v[132:135]
v_mfma_f32_16x16x32_bf16 v[136:139], a[224:227], a[40:43], v[136:139]
v_mfma_f32_16x16x32_bf16 v[136:139], a[228:231], a[56:59], v[136:139]
s_waitcnt lgkmcnt(1)
v_mfma_f32_16x16x32_bf16 v[140:143], a[228:231], a[60:63], v[140:143]
v_mfma_f32_16x16x32_bf16 v[140:143], a[224:227], a[44:47], v[140:143]
s_waitcnt lgkmcnt(0)
v_mfma_f32_16x16x32_bf16 v[208:211], a[232:235], a[176:179], v[208:211]
ds_read_b128 a[240:243], v15 offset:34816
v_mfma_f32_16x16x32_bf16 v[208:211], a[236:239], a[192:195], v[208:211]
v_mfma_f32_16x16x32_bf16 v[212:215], a[236:239], a[196:199], v[212:215]
v_mfma_f32_16x16x32_bf16 v[212:215], a[232:235], a[180:183], v[212:215]
v_mfma_f32_16x16x32_bf16 v[216:219], a[232:235], a[184:187], v[216:219]
s_waitcnt vmcnt(0)
s_barrier
ds_read_b128 a[244:247], v14 offset:40960
v_mfma_f32_16x16x32_bf16 v[216:219], a[236:239], a[200:203], v[216:219]
v_mfma_f32_16x16x32_bf16 v[220:223], a[236:239], a[204:207], v[220:223]
ds_read_b128 a[248:251], v15 offset:40960
v_mfma_f32_16x16x32_bf16 v[220:223], a[232:235], a[188:191], v[220:223]
s_waitcnt lgkmcnt(2)
v_mul_f32 v128, v128, v24
v_mul_f32 v132, v132, v25
v_mfma_f32_16x16x32_bf16 v[144:147], a[240:243], a[48:51], v[144:147]
v_mul_f32 v136, v136, v26
v_mul_f32 v140, v140, v27
v_mfma_f32_16x16x32_bf16 v[148:151], a[240:243], a[52:55], v[148:151]
v_cvt_pk_bf16_f32 v120, v128, v132
v_cvt_pk_bf16_f32 v121, v136, v140
v_mfma_f32_16x16x32_bf16 v[152:155], a[240:243], a[56:59], v[152:155]
buffer_store_dwordx2 v[120:121], v18, s[28:31], 0 offen nt
v_mul_f32 v129, v129, v24
v_mfma_f32_16x16x32_bf16 v[156:159], a[240:243], a[60:63], v[156:159]
s_waitcnt lgkmcnt(0)
v_mul_f32 v133, v133, v25
v_mul_f32 v137, v137, v26
v_mfma_f32_16x16x32_bf16 v[224:227], a[244:247], a[160:163], v[224:227]
s_add_u32 s28, s28, 7168
ds_read_b128 a[252:255], v17 offset:10240
v_mul_f32 v141, v141, v27
v_mfma_f32_16x16x32_bf16 v[224:227], a[248:251], a[176:179], v[224:227]
s_addc_u32 s29, s29, 0
v_cvt_pk_bf16_f32 v122, v129, v133
v_cvt_pk_bf16_f32 v123, v137, v141
v_mfma_f32_16x16x32_bf16 v[228:231], a[248:251], a[180:183], v[228:231]
ds_read_b128 a[224:227], v14 offset:2048
v_mfma_f32_16x16x32_bf16 v[228:231], a[244:247], a[164:167], v[228:231]
buffer_store_dwordx2 v[122:123], v18, s[28:31], 0 offen nt
v_mul_f32 v130, v130, v24
v_mfma_f32_16x16x32_bf16 v[232:235], a[244:247], a[168:171], v[232:235]
s_add_u32 s28, s28, 7168
v_mul_f32 v134, v134, v25
v_mul_f32 v138, v138, v26
v_mfma_f32_16x16x32_bf16 v[232:235], a[248:251], a[184:187], v[232:235]
s_addc_u32 s29, s29, 0
v_mul_f32 v142, v142, v27
v_cvt_pk_bf16_f32 v124, v130, v134
v_mfma_f32_16x16x32_bf16 v[236:239], a[248:251], a[188:191], v[236:239]
v_cvt_pk_bf16_f32 v125, v138, v142
v_mfma_f32_16x16x32_bf16 v[236:239], a[244:247], a[172:175], v[236:239]
s_waitcnt lgkmcnt(0)
v_mfma_f32_16x16x32_bf16 v[240:243], a[252:255], a[80:83], v[240:243]
ds_read_b128 a[228:231], v14 offset:45056
v_mfma_f32_16x16x32_bf16 v[240:243], a[224:227], a[96:99], v[240:243]
buffer_store_dwordx2 v[124:125], v18, s[28:31], 0 offen nt
v_mul_f32 v131, v131, v24
v_mfma_f32_16x16x32_bf16 v[244:247], a[224:227], a[100:103], v[244:247]
s_add_u32 s28, s28, 7168
ds_read_b128 a[232:235], v15 offset:45056
v_mul_f32 v135, v135, v25
v_mfma_f32_16x16x32_bf16 v[244:247], a[252:255], a[84:87], v[244:247]
s_addc_u32 s29, s29, 0
v_mul_f32 v139, v139, v26
v_mul_f32 v143, v143, v27
v_mfma_f32_16x16x32_bf16 v[248:251], a[252:255], a[88:91], v[248:251]
v_cvt_pk_bf16_f32 v126, v131, v135
v_cvt_pk_bf16_f32 v127, v139, v143
v_mfma_f32_16x16x32_bf16 v[248:251], a[224:227], a[104:107], v[248:251]
buffer_store_dwordx2 v[126:127], v18, s[28:31], 0 offen nt
v_mul_f32 v144, v144, v24
v_mfma_f32_16x16x32_bf16 v[252:255], a[224:227], a[108:111], v[252:255]
s_add_u32 s28, s28, 93184
v_mul_f32 v148, v148, v25
v_mul_f32 v152, v152, v26
v_mfma_f32_16x16x32_bf16 v[252:255], a[252:255], a[92:95], v[252:255]
s_waitcnt lgkmcnt(0)
v_mul_f32 v156, v156, v27
v_cvt_pk_bf16_f32 v120, v144, v148
v_mfma_f32_16x16x32_bf16 v[160:163], a[228:231], a[32:35], v[160:163]
s_addc_u32 s29, s29, 0
ds_read_b128 a[236:239], v15 offset:26624
v_cvt_pk_bf16_f32 v121, v152, v156
v_mfma_f32_16x16x32_bf16 v[160:163], a[232:235], a[48:51], v[160:163]
buffer_store_dwordx2 v[120:121], v18, s[28:31], 0 offen nt
v_mul_f32 v145, v145, v24
v_mfma_f32_16x16x32_bf16 v[164:167], a[232:235], a[52:55], v[164:167]
s_add_u32 s28, s28, 7168
ds_read_b128 a[240:243], v14 offset:47104
v_mul_f32 v149, v149, v25
v_mfma_f32_16x16x32_bf16 v[164:167], a[228:231], a[36:39], v[164:167]
s_addc_u32 s29, s29, 0
v_mul_f32 v153, v153, v26
v_mul_f32 v157, v157, v27
v_mfma_f32_16x16x32_bf16 v[168:171], a[228:231], a[40:43], v[168:171]
v_cvt_pk_bf16_f32 v122, v145, v149
v_cvt_pk_bf16_f32 v123, v153, v157
v_mfma_f32_16x16x32_bf16 v[168:171], a[232:235], a[56:59], v[168:171]
buffer_store_dwordx2 v[122:123], v18, s[28:31], 0 offen nt
v_mul_f32 v146, v146, v24
v_mfma_f32_16x16x32_bf16 v[172:175], a[232:235], a[60:63], v[172:175]
s_add_u32 s28, s28, 7168
v_mul_f32 v150, v150, v25
v_mul_f32 v154, v154, v26
v_mfma_f32_16x16x32_bf16 v[172:175], a[228:231], a[44:47], v[172:175]
s_waitcnt lgkmcnt(0)
v_mul_f32 v158, v158, v27
v_cvt_pk_bf16_f32 v124, v146, v150
v_mfma_f32_16x16x32_bf16 v[176:179], a[236:239], a[16:19], v[176:179]
s_addc_u32 s29, s29, 0
ds_read_b128 a[244:247], v14 offset:49152
v_cvt_pk_bf16_f32 v125, v154, v158
v_mfma_f32_16x16x32_bf16 v[176:179], a[240:243], a[32:35], v[176:179]
buffer_store_dwordx2 v[124:125], v18, s[28:31], 0 offen nt
v_mul_f32 v147, v147, v24
v_mfma_f32_16x16x32_bf16 v[180:183], a[240:243], a[36:39], v[180:183]
s_add_u32 s28, s28, 7168
ds_read_b128 a[248:251], v15 offset:49152
v_mul_f32 v151, v151, v25
v_mfma_f32_16x16x32_bf16 v[180:183], a[236:239], a[20:23], v[180:183]
s_addc_u32 s29, s29, 0
v_mul_f32 v155, v155, v26
v_mul_f32 v159, v159, v27
v_mfma_f32_16x16x32_bf16 v[184:187], a[236:239], a[24:27], v[184:187]
v_cvt_pk_bf16_f32 v126, v147, v151
v_cvt_pk_bf16_f32 v127, v155, v159
v_mfma_f32_16x16x32_bf16 v[184:187], a[240:243], a[40:43], v[184:187]
buffer_store_dwordx2 v[126:127], v18, s[28:31], 0 offen nt
v_mfma_f32_16x16x32_bf16 v[188:191], a[240:243], a[44:47], v[188:191]
v_mfma_f32_16x16x32_bf16 v[188:191], a[236:239], a[28:31], v[188:191]
s_waitcnt lgkmcnt(0)
v_mul_f32 v160, v160, v24
v_mul_f32 v164, v164, v25
v_mfma_f32_16x16x32_bf16 v[192:195], a[244:247], a[0:3], v[192:195]
s_add_u32 s28, s28, 93184
ds_read_b128 a[252:255], v15 offset:30720
v_mul_f32 v168, v168, v26
v_mfma_f32_16x16x32_bf16 v[192:195], a[248:251], a[16:19], v[192:195]
s_addc_u32 s29, s29, 0
v_mul_f32 v172, v172, v27
v_cvt_pk_bf16_f32 v120, v160, v164
v_mfma_f32_16x16x32_bf16 v[196:199], a[248:251], a[20:23], v[196:199]
ds_read_b128 a[224:227], v14 offset:51200
v_cvt_pk_bf16_f32 v121, v168, v172
v_mfma_f32_16x16x32_bf16 v[196:199], a[244:247], a[4:7], v[196:199]
buffer_store_dwordx2 v[120:121], v18, s[28:31], 0 offen nt
v_mul_f32 v161, v161, v24
v_mfma_f32_16x16x32_bf16 v[200:203], a[244:247], a[8:11], v[200:203]
s_add_u32 s28, s28, 7168
v_mul_f32 v165, v165, v25
v_mul_f32 v169, v169, v26
v_mfma_f32_16x16x32_bf16 v[200:203], a[248:251], a[24:27], v[200:203]
s_addc_u32 s29, s29, 0
v_mul_f32 v173, v173, v27
v_cvt_pk_bf16_f32 v122, v161, v165
v_mfma_f32_16x16x32_bf16 v[204:207], a[248:251], a[28:31], v[204:207]
v_cvt_pk_bf16_f32 v123, v169, v173
v_mfma_f32_16x16x32_bf16 v[204:207], a[244:247], a[12:15], v[204:207]
s_waitcnt lgkmcnt(0)
v_mfma_f32_16x16x32_bf16 v[208:211], a[252:255], a[208:211], v[208:211]
ds_read_b128 a[228:231], v15 offset:47104
v_mfma_f32_16x16x32_bf16 v[208:211], a[224:227], a[0:3], v[208:211]
buffer_store_dwordx2 v[122:123], v18, s[28:31], 0 offen nt
v_mul_f32 v162, v162, v24
v_mfma_f32_16x16x32_bf16 v[212:215], a[224:227], a[4:7], v[212:215]
s_add_u32 s28, s28, 7168
v_mul_f32 v166, v166, v25
v_mul_f32 v170, v170, v26
v_mfma_f32_16x16x32_bf16 v[212:215], a[252:255], a[212:215], v[212:215]
s_addc_u32 s29, s29, 0
v_mul_f32 v174, v174, v27
v_cvt_pk_bf16_f32 v124, v162, v166
v_mfma_f32_16x16x32_bf16 v[216:219], a[252:255], a[216:219], v[216:219]
ds_read_b128 a[232:235], v14 offset:36864
v_cvt_pk_bf16_f32 v125, v170, v174
v_mfma_f32_16x16x32_bf16 v[216:219], a[224:227], a[8:11], v[216:219]
buffer_store_dwordx2 v[124:125], v18, s[28:31], 0 offen nt
v_mul_f32 v163, v163, v24
v_mfma_f32_16x16x32_bf16 v[220:223], a[224:227], a[12:15], v[220:223]
s_add_u32 s28, s28, 7168
ds_read_b128 a[236:239], v15 offset:36864
v_mul_f32 v167, v167, v25
v_mfma_f32_16x16x32_bf16 v[220:223], a[252:255], a[220:223], v[220:223]
s_waitcnt lgkmcnt(2)
v_mul_f32 v171, v171, v26
v_mul_f32 v175, v175, v27
v_mfma_f32_16x16x32_bf16 v[176:179], a[228:231], a[48:51], v[176:179]
s_addc_u32 s29, s29, 0
v_cvt_pk_bf16_f32 v126, v163, v167
v_cvt_pk_bf16_f32 v127, v171, v175
v_mfma_f32_16x16x32_bf16 v[180:183], a[228:231], a[52:55], v[180:183]
buffer_store_dwordx2 v[126:127], v18, s[28:31], 0 offen nt
v_mfma_f32_16x16x32_bf16 v[184:187], a[228:231], a[56:59], v[184:187]
v_mfma_f32_16x16x32_bf16 v[188:191], a[228:231], a[60:63], v[188:191]
s_waitcnt lgkmcnt(0)
v_mfma_f32_16x16x32_bf16 v[224:227], a[232:235], a[192:195], v[224:227]
ds_read_b128 a[240:243], v14 offset:61440
v_mfma_f32_16x16x32_bf16 v[224:227], a[236:239], a[208:211], v[224:227]
v_mfma_f32_16x16x32_bf16 v[228:231], a[236:239], a[212:215], v[228:231]
ds_read_b128 a[244:247], v15 offset:61440
v_mfma_f32_16x16x32_bf16 v[228:231], a[232:235], a[196:199], v[228:231]
v_mfma_f32_16x16x32_bf16 v[232:235], a[232:235], a[200:203], v[232:235]
v_mfma_f32_16x16x32_bf16 v[232:235], a[236:239], a[216:219], v[232:235]
v_mfma_f32_16x16x32_bf16 v[236:239], a[236:239], a[220:223], v[236:239]
v_mfma_f32_16x16x32_bf16 v[236:239], a[232:235], a[204:207], v[236:239]
s_waitcnt lgkmcnt(0)
v_mul_f32 v176, v176, v24
v_mul_f32 v180, v180, v25
v_mfma_f32_16x16x32_bf16 v[192:195], a[240:243], a[32:35], v[192:195]
s_add_u32 s28, s28, 93184
ds_read_b128 a[248:251], v15 offset:51200
v_mul_f32 v184, v184, v26
v_mfma_f32_16x16x32_bf16 v[192:195], a[244:247], a[48:51], v[192:195]
s_addc_u32 s29, s29, 0
v_mul_f32 v188, v188, v27
v_cvt_pk_bf16_f32 v120, v176, v180
v_mfma_f32_16x16x32_bf16 v[196:199], a[244:247], a[52:55], v[196:199]
ds_read_b128 a[252:255], v14 offset:63488
v_cvt_pk_bf16_f32 v121, v184, v188
v_mfma_f32_16x16x32_bf16 v[196:199], a[240:243], a[36:39], v[196:199]
buffer_store_dwordx2 v[120:121], v18, s[28:31], 0 offen nt
v_mul_f32 v177, v177, v24
v_mfma_f32_16x16x32_bf16 v[200:203], a[240:243], a[40:43], v[200:203]
s_add_u32 s28, s28, 7168
v_mul_f32 v181, v181, v25
v_mul_f32 v185, v185, v26
v_mfma_f32_16x16x32_bf16 v[200:203], a[244:247], a[56:59], v[200:203]
s_addc_u32 s29, s29, 0
v_mul_f32 v189, v189, v27
v_cvt_pk_bf16_f32 v122, v177, v181
v_mfma_f32_16x16x32_bf16 v[204:207], a[244:247], a[60:63], v[204:207]
v_cvt_pk_bf16_f32 v123, v185, v189
v_mfma_f32_16x16x32_bf16 v[204:207], a[240:243], a[44:47], v[204:207]
s_waitcnt lgkmcnt(0)
v_mfma_f32_16x16x32_bf16 v[208:211], a[248:251], a[16:19], v[208:211]
ds_read_b128 a[224:227], v15 offset:2048
v_mfma_f32_16x16x32_bf16 v[208:211], a[252:255], a[32:35], v[208:211]
buffer_store_dwordx2 v[122:123], v18, s[28:31], 0 offen nt
v_mul_f32 v178, v178, v24
v_mfma_f32_16x16x32_bf16 v[212:215], a[252:255], a[36:39], v[212:215]
s_add_u32 s28, s28, 7168
ds_read_b128 a[228:231], v14 offset:14336
v_mul_f32 v182, v182, v25
v_mfma_f32_16x16x32_bf16 v[212:215], a[248:251], a[20:23], v[212:215]
s_addc_u32 s29, s29, 0
v_mul_f32 v186, v186, v26
v_mul_f32 v190, v190, v27
v_mfma_f32_16x16x32_bf16 v[216:219], a[248:251], a[24:27], v[216:219]
v_cvt_pk_bf16_f32 v124, v178, v182
v_cvt_pk_bf16_f32 v125, v186, v190
v_mfma_f32_16x16x32_bf16 v[216:219], a[252:255], a[40:43], v[216:219]
buffer_store_dwordx2 v[124:125], v18, s[28:31], 0 offen nt
v_mul_f32 v179, v179, v24
v_mfma_f32_16x16x32_bf16 v[220:223], a[252:255], a[44:47], v[220:223]
s_add_u32 s28, s28, 7168
v_mul_f32 v183, v183, v25
v_mul_f32 v187, v187, v26
v_mfma_f32_16x16x32_bf16 v[220:223], a[248:251], a[28:31], v[220:223]
s_waitcnt lgkmcnt(0)
v_mul_f32 v191, v191, v27
v_cvt_pk_bf16_f32 v126, v179, v183
v_mfma_f32_16x16x32_bf16 v[240:243], a[224:227], a[112:115], v[240:243]
s_addc_u32 s29, s29, 0
ds_read_b128 a[232:235], v15 offset:63488
v_cvt_pk_bf16_f32 v127, v187, v191
v_mfma_f32_16x16x32_bf16 v[240:243], a[228:231], a[128:131], v[240:243]
buffer_store_dwordx2 v[126:127], v18, s[28:31], 0 offen nt
v_mul_f32 v192, v192, v24
v_mfma_f32_16x16x32_bf16 v[244:247], a[228:231], a[132:135], v[244:247]
s_add_u32 s28, s28, 93184
v_mul_f32 v196, v196, v25
v_mul_f32 v200, v200, v26
v_mfma_f32_16x16x32_bf16 v[244:247], a[224:227], a[116:119], v[244:247]
s_addc_u32 s29, s29, 0
v_mul_f32 v204, v204, v27
v_cvt_pk_bf16_f32 v120, v192, v196
v_mfma_f32_16x16x32_bf16 v[248:251], a[224:227], a[120:123], v[248:251]
ds_read_b128 a[236:239], v14 offset:57344
v_cvt_pk_bf16_f32 v121, v200, v204
v_mfma_f32_16x16x32_bf16 v[248:251], a[228:231], a[136:139], v[248:251]
buffer_store_dwordx2 v[120:121], v18, s[28:31], 0 offen nt
v_mul_f32 v193, v193, v24
v_mfma_f32_16x16x32_bf16 v[252:255], a[228:231], a[140:143], v[252:255]
s_add_u32 s28, s28, 7168
ds_read_b128 a[240:243], v15 offset:57344
v_mul_f32 v197, v197, v25
v_mfma_f32_16x16x32_bf16 v[252:255], a[224:227], a[124:127], v[252:255]
s_waitcnt lgkmcnt(2)
v_mul_f32 v201, v201, v26
v_mul_f32 v205, v205, v27
v_mfma_f32_16x16x32_bf16 v[208:211], a[232:235], a[48:51], v[208:211]
s_addc_u32 s29, s29, 0
v_cvt_pk_bf16_f32 v122, v193, v197
v_cvt_pk_bf16_f32 v123, v201, v205
v_mfma_f32_16x16x32_bf16 v[212:215], a[232:235], a[52:55], v[212:215]
buffer_store_dwordx2 v[122:123], v18, s[28:31], 0 offen nt
v_mul_f32 v194, v194, v24
v_mfma_f32_16x16x32_bf16 v[216:219], a[232:235], a[56:59], v[216:219]
s_add_u32 s28, s28, 7168
v_mul_f32 v198, v198, v25
v_mul_f32 v202, v202, v26
v_mfma_f32_16x16x32_bf16 v[220:223], a[232:235], a[60:63], v[220:223]
s_waitcnt lgkmcnt(0)
v_mul_f32 v206, v206, v27
v_cvt_pk_bf16_f32 v124, v194, v198
v_mfma_f32_16x16x32_bf16 v[224:227], a[236:239], a[0:3], v[224:227]
s_addc_u32 s29, s29, 0
ds_read_b128 a[244:247], v16 offset:0
v_cvt_pk_bf16_f32 v125, v202, v206
v_mfma_f32_16x16x32_bf16 v[224:227], a[240:243], a[16:19], v[224:227]
buffer_store_dwordx2 v[124:125], v18, s[28:31], 0 offen nt
v_mul_f32 v195, v195, v24
v_mfma_f32_16x16x32_bf16 v[228:231], a[240:243], a[20:23], v[228:231]
s_add_u32 s28, s28, 7168
ds_read_b128 a[248:251], v17 offset:0
v_mul_f32 v199, v199, v25
v_mfma_f32_16x16x32_bf16 v[228:231], a[236:239], a[4:7], v[228:231]
s_addc_u32 s29, s29, 0
v_mul_f32 v203, v203, v26
v_mul_f32 v207, v207, v27
v_mfma_f32_16x16x32_bf16 v[232:235], a[236:239], a[8:11], v[232:235]
v_cvt_pk_bf16_f32 v126, v195, v199
v_cvt_pk_bf16_f32 v127, v203, v207
v_mfma_f32_16x16x32_bf16 v[232:235], a[240:243], a[24:27], v[232:235]
buffer_store_dwordx2 v[126:127], v18, s[28:31], 0 offen nt
v_mfma_f32_16x16x32_bf16 v[236:239], a[240:243], a[28:31], v[236:239]
v_mfma_f32_16x16x32_bf16 v[236:239], a[236:239], a[12:15], v[236:239]
s_waitcnt lgkmcnt(0)
v_mul_f32 v208, v208, v24
v_mul_f32 v212, v212, v25
v_mfma_f32_16x16x32_bf16 v[224:227], a[244:247], a[32:35], v[224:227]
s_add_u32 s28, s28, 93184
ds_read_b128 a[252:255], v15 offset:14336
v_mul_f32 v216, v216, v26
v_mfma_f32_16x16x32_bf16 v[224:227], a[248:251], a[48:51], v[224:227]
s_addc_u32 s29, s29, 0
v_mul_f32 v220, v220, v27
v_cvt_pk_bf16_f32 v120, v208, v212
v_mfma_f32_16x16x32_bf16 v[228:231], a[248:251], a[52:55], v[228:231]
ds_read_b128 a[224:227], v14 offset:43008
v_cvt_pk_bf16_f32 v121, v216, v220
v_mfma_f32_16x16x32_bf16 v[228:231], a[244:247], a[36:39], v[228:231]
buffer_store_dwordx2 v[120:121], v18, s[28:31], 0 offen nt
v_mul_f32 v209, v209, v24
v_mfma_f32_16x16x32_bf16 v[232:235], a[244:247], a[40:43], v[232:235]
s_add_u32 s28, s28, 7168
v_mul_f32 v213, v213, v25
v_mul_f32 v217, v217, v26
v_mfma_f32_16x16x32_bf16 v[232:235], a[248:251], a[56:59], v[232:235]
s_addc_u32 s29, s29, 0
v_mul_f32 v221, v221, v27
v_cvt_pk_bf16_f32 v122, v209, v213
v_mfma_f32_16x16x32_bf16 v[236:239], a[248:251], a[60:63], v[236:239]
v_cvt_pk_bf16_f32 v123, v217, v221
v_mfma_f32_16x16x32_bf16 v[236:239], a[244:247], a[44:47], v[236:239]
s_waitcnt lgkmcnt(0)
v_mfma_f32_16x16x32_bf16 v[240:243], a[252:255], a[144:147], v[240:243]
ds_read_b128 a[228:231], v15 offset:43008
v_mfma_f32_16x16x32_bf16 v[240:243], a[224:227], a[160:163], v[240:243]
buffer_store_dwordx2 v[122:123], v18, s[28:31], 0 offen nt
v_mul_f32 v210, v210, v24
v_mfma_f32_16x16x32_bf16 v[244:247], a[224:227], a[164:167], v[244:247]
s_add_u32 s28, s28, 7168
ds_read_b128 a[232:235], v14 offset:38912
v_mul_f32 v214, v214, v25
v_mfma_f32_16x16x32_bf16 v[244:247], a[252:255], a[148:151], v[244:247]
s_addc_u32 s29, s29, 0
v_mul_f32 v218, v218, v26
v_mul_f32 v222, v222, v27
v_mfma_f32_16x16x32_bf16 v[248:251], a[252:255], a[152:155], v[248:251]
v_cvt_pk_bf16_f32 v124, v210, v214
v_cvt_pk_bf16_f32 v125, v218, v222
v_mfma_f32_16x16x32_bf16 v[248:251], a[224:227], a[168:171], v[248:251]
buffer_store_dwordx2 v[124:125], v18, s[28:31], 0 offen nt
v_mul_f32 v211, v211, v24
v_mfma_f32_16x16x32_bf16 v[252:255], a[224:227], a[172:175], v[252:255]
s_add_u32 s28, s28, 7168
v_mul_f32 v215, v215, v25
v_mul_f32 v219, v219, v26
v_mfma_f32_16x16x32_bf16 v[252:255], a[252:255], a[156:159], v[252:255]
s_waitcnt lgkmcnt(0)
v_mul_f32 v223, v223, v27
v_cvt_pk_bf16_f32 v126, v211, v215
v_mfma_f32_16x16x32_bf16 v[240:243], a[228:231], a[176:179], v[240:243]
s_addc_u32 s29, s29, 0
ds_read_b128 a[236:239], v15 offset:38912
v_cvt_pk_bf16_f32 v127, v219, v223
v_mfma_f32_16x16x32_bf16 v[240:243], a[232:235], a[192:195], v[240:243]
buffer_store_dwordx2 v[126:127], v18, s[28:31], 0 offen nt
v_mul_f32 v224, v224, v24
v_mfma_f32_16x16x32_bf16 v[244:247], a[232:235], a[196:199], v[244:247]
s_add_u32 s28, s28, 93184
ds_read_b128 a[240:243], v14 offset:59392
v_mul_f32 v228, v228, v25
v_mfma_f32_16x16x32_bf16 v[244:247], a[228:231], a[180:183], v[244:247]
s_addc_u32 s29, s29, 0
v_mul_f32 v232, v232, v26
v_mul_f32 v236, v236, v27
v_mfma_f32_16x16x32_bf16 v[248:251], a[228:231], a[184:187], v[248:251]
v_cvt_pk_bf16_f32 v120, v224, v228
v_cvt_pk_bf16_f32 v121, v232, v236
v_mfma_f32_16x16x32_bf16 v[248:251], a[232:235], a[200:203], v[248:251]
buffer_store_dwordx2 v[120:121], v18, s[28:31], 0 offen nt
v_mul_f32 v225, v225, v24
v_mfma_f32_16x16x32_bf16 v[252:255], a[232:235], a[204:207], v[252:255]
s_add_u32 s28, s28, 7168
v_mul_f32 v229, v229, v25
v_mul_f32 v233, v233, v26
v_mfma_f32_16x16x32_bf16 v[252:255], a[228:231], a[188:191], v[252:255]
s_waitcnt lgkmcnt(0)
v_mul_f32 v237, v237, v27
v_cvt_pk_bf16_f32 v122, v225, v229
v_mfma_f32_16x16x32_bf16 v[240:243], a[236:239], a[208:211], v[240:243]
s_addc_u32 s29, s29, 0
ds_read_b128 a[244:247], v15 offset:59392
v_cvt_pk_bf16_f32 v123, v233, v237
v_mfma_f32_16x16x32_bf16 v[240:243], a[240:243], a[0:3], v[240:243]
buffer_store_dwordx2 v[122:123], v18, s[28:31], 0 offen nt
v_mul_f32 v226, v226, v24
v_mfma_f32_16x16x32_bf16 v[244:247], a[240:243], a[4:7], v[244:247]
s_add_u32 s28, s28, 7168
ds_read_b128 a[248:251], v16 offset:2048
v_mul_f32 v230, v230, v25
v_mfma_f32_16x16x32_bf16 v[244:247], a[236:239], a[212:215], v[244:247]
s_addc_u32 s29, s29, 0
v_mul_f32 v234, v234, v26
v_mul_f32 v238, v238, v27
v_mfma_f32_16x16x32_bf16 v[248:251], a[236:239], a[216:219], v[248:251]
v_cvt_pk_bf16_f32 v124, v226, v230
v_cvt_pk_bf16_f32 v125, v234, v238
v_mfma_f32_16x16x32_bf16 v[248:251], a[240:243], a[8:11], v[248:251]
buffer_store_dwordx2 v[124:125], v18, s[28:31], 0 offen nt
v_mul_f32 v227, v227, v24
v_mfma_f32_16x16x32_bf16 v[252:255], a[240:243], a[12:15], v[252:255]
s_add_u32 s28, s28, 7168
v_mul_f32 v231, v231, v25
v_mul_f32 v235, v235, v26
v_mfma_f32_16x16x32_bf16 v[252:255], a[236:239], a[220:223], v[252:255]
s_waitcnt lgkmcnt(0)
v_mul_f32 v239, v239, v27
v_cvt_pk_bf16_f32 v126, v227, v231
v_mfma_f32_16x16x32_bf16 v[240:243], a[244:247], a[16:19], v[240:243]
s_addc_u32 s29, s29, 0
ds_read_b128 a[252:255], v17 offset:2048
v_cvt_pk_bf16_f32 v127, v235, v239
v_mfma_f32_16x16x32_bf16 v[240:243], a[248:251], a[32:35], v[240:243]
buffer_store_dwordx2 v[126:127], v18, s[28:31], 0 offen nt
v_mfma_f32_16x16x32_bf16 v[244:247], a[248:251], a[36:39], v[244:247]
v_mfma_f32_16x16x32_bf16 v[244:247], a[244:247], a[20:23], v[244:247]
v_mfma_f32_16x16x32_bf16 v[248:251], a[244:247], a[24:27], v[248:251]
v_mfma_f32_16x16x32_bf16 v[248:251], a[248:251], a[40:43], v[248:251]
v_mfma_f32_16x16x32_bf16 v[252:255], a[248:251], a[44:47], v[252:255]
v_mfma_f32_16x16x32_bf16 v[252:255], a[244:247], a[28:31], v[252:255]
s_waitcnt lgkmcnt(0)
v_mfma_f32_16x16x32_bf16 v[240:243], a[252:255], a[48:51], v[240:243]
v_mfma_f32_16x16x32_bf16 v[244:247], a[252:255], a[52:55], v[244:247]
v_mfma_f32_16x16x32_bf16 v[248:251], a[252:255], a[56:59], v[248:251]
v_mfma_f32_16x16x32_bf16 v[252:255], a[252:255], a[60:63], v[252:255]
s_nop 7
v_pk_mul_f32 v[240:241], v[240:241], v[24:25] op_sel:[0,0] op_sel_hi:[1,0]
v_pk_mul_f32 v[244:245], v[244:245], v[24:25] op_sel:[0,1] op_sel_hi:[1,1]
v_pk_mul_f32 v[248:249], v[248:249], v[26:27] op_sel:[0,0] op_sel_hi:[1,0]
v_pk_mul_f32 v[252:253], v[252:253], v[26:27] op_sel:[0,1] op_sel_hi:[1,1]
v_cvt_pk_bf16_f32 v120, v240, v244
v_cvt_pk_bf16_f32 v121, v248, v252
s_add_u32 s28, s28, 93184
s_addc_u32 s29, s29, 0
buffer_store_dwordx2 v[120:121], v18, s[28:31], 0 offen nt
v_cvt_pk_bf16_f32 v122, v241, v245
v_cvt_pk_bf16_f32 v123, v249, v253
s_add_u32 s28, s28, 7168
s_addc_u32 s29, s29, 0
buffer_store_dwordx2 v[122:123], v18, s[28:31], 0 offen nt
v_pk_mul_f32 v[242:243], v[242:243], v[24:25] op_sel:[0,0] op_sel_hi:[1,0]
v_pk_mul_f32 v[246:247], v[246:247], v[24:25] op_sel:[0,1] op_sel_hi:[1,1]
v_pk_mul_f32 v[250:251], v[250:251], v[26:27] op_sel:[0,0] op_sel_hi:[1,0]
v_pk_mul_f32 v[254:255], v[254:255], v[26:27] op_sel:[0,1] op_sel_hi:[1,1]
v_cvt_pk_bf16_f32 v124, v242, v246
v_cvt_pk_bf16_f32 v125, v250, v254
s_add_u32 s28, s28, 7168
s_addc_u32 s29, s29, 0
buffer_store_dwordx2 v[124:125], v18, s[28:31], 0 offen nt
v_cvt_pk_bf16_f32 v126, v243, v247
v_cvt_pk_bf16_f32 v127, v251, v255
s_add_u32 s28, s28, 7168
s_addc_u32 s29, s29, 0
buffer_store_dwordx2 v[126:127], v18, s[28:31], 0 offen nt
s_endpgm
L_NOTAG:
buffer_load_dwordx2 v[22:23], off, s[80:83], 0 sc1
s_waitcnt vmcnt(0)
v_readfirstlane_b32 s88, v22
v_readfirstlane_b32 s89, v23
s_sub_u32 s90, s90, 1
s_nop 0
s_cmp_eq_u64 s[88:89], 0
s_cbranch_scc0 L_TAGOK
s_cmp_gt_i32 s90, 0
s_cbranch_scc1 L_NOTAG
s_mov_b32 s26, 0
s_mov_b32 s78, 0
s_mov_b64 s[88:89], 1
s_branch L_TAGOK
.p2align 6
L_PADS:
s_cbranch_vccnz L_PADRET
L_TRY:
s_waitcnt vmcnt(0)
v_cmp_ne_u64 s[50:51], s[88:89], v[122:123]
v_cmp_ne_u64 s[44:45], s[88:89], v[126:127]
s_sub_u32 s90, s90, 1
s_nop 0
s_or_b64 s[50:51], s[44:45], s[50:51]
s_cbranch_scc0 L_WRET
s_cmp_gt_i32 s90, 0
s_cbranch_scc0 L_SELF
L_WRET:
s_setpc_b64 s[100:101]
L_SLOW2:
s_lshr_b32 s91, s41, 6
s_add_u32 s91, s91, 0
s_lshl_b32 s47, s91, 11
buffer_load_dwordx4 v[120:123], v13, s[24:27], s47 offen offset:0 sc1
buffer_load_dwordx4 v[124:127], v13, s[24:27], s47 offen offset:1024 sc1
s_lshr_b32 s47, s41, 6
s_add_u32 s47, s47, 1
s_lshl_b32 s47, s47, 11
buffer_load_dwordx4 v[96:99], v13, s[24:27], s47 offen offset:0 sc1
buffer_load_dwordx4 v[100:103], v13, s[24:27], s47 offen offset:1024 sc1
s_lshr_b32 s47, s42, 6
s_add_u32 s47, s47, 0
s_lshl_b32 s47, s47, 11
buffer_load_dwordx4 v[40:43], v13, s[24:27], s47 offen offset:0 sc1
buffer_load_dwordx4 v[44:47], v13, s[24:27], s47 offen offset:1024 sc1
s_call_b64 s[100:101], L_TRY
s_cbranch_scc1 L_SLOW2
v_mov_b64 v[32:33], v[120:121]
v_mov_b64 v[36:37], v[124:125]
s_branch L_BACK2
L_SLOW3:
s_lshr_b32 s91, s41, 6
s_add_u32 s91, s91, 1
s_lshl_b32 s47, s91, 11
buffer_load_dwordx4 v[120:123], v13, s[24:27], s47 offen offset:0 sc1
buffer_load_dwordx4 v[124:127], v13, s[24:27], s47 offen offset:1024 sc1
s_lshr_b32 s47, s42, 6
s_add_u32 s47, s47, 0
s_lshl_b32 s47, s47, 11
buffer_load_dwordx4 v[40:43], v13, s[24:27], s47 offen offset:0 sc1
buffer_load_dwordx4 v[44:47], v13, s[24:27], s47 offen offset:1024 sc1
s_lshr_b32 s47, s42, 6
s_add_u32 s47, s47, 1
s_lshl_b32 s47, s47, 11
buffer_load_dwordx4 v[48:51], v13, s[24:27], s47 offen offset:0 sc1
buffer_load_dwordx4 v[52:55], v13, s[24:27], s47 offen offset:1024 sc1
s_call_b64 s[100:101], L_TRY
s_cbranch_scc1 L_SLOW3
v_mov_b64 v[96:97], v[120:121]
v_mov_b64 v[100:101], v[124:125]
s_branch L_BACK3
L_SLOW4:
s_lshr_b32 s91, s42, 6
s_add_u32 s91, s91, 0
s_lshl_b32 s47, s91, 11
buffer_load_dwordx4 v[120:123], v13, s[24:27], s47 offen offset:0 sc1
buffer_load_dwordx4 v[124:127], v13, s[24:27], s47 offen offset:1024 sc1
s_lshr_b32 s47, s42, 6
s_add_u32 s47, s47, 1
s_lshl_b32 s47, s47, 11
buffer_load_dwordx4 v[48:51], v13, s[24:27], s47 offen offset:0 sc1
buffer_load_dwordx4 v[52:55], v13, s[24:27], s47 offen offset:1024 sc1
s_lshr_b32 s47, s43, 6
s_add_u32 s47, s47, 0
s_lshl_b32 s47, s47, 11
buffer_load_dwordx4 v[80:83], v13, s[24:27], s47 offen offset:0 sc1
buffer_load_dwordx4 v[84:87], v13, s[24:27], s47 offen offset:1024 sc1
s_call_b64 s[100:101], L_TRY
s_cbranch_scc1 L_SLOW4
v_mov_b64 v[40:41], v[120:121]
v_mov_b64 v[44:45], v[124:125]
s_branch L_BACK4
L_SLOW5:
s_lshr_b32 s91, s42, 6
s_add_u32 s91, s91, 1
s_lshl_b32 s47, s91, 11
buffer_load_dwordx4 v[120:123], v13, s[24:27], s47 offen offset:0 sc1
buffer_load_dwordx4 v[124:127], v13, s[24:27], s47 offen offset:1024 sc1
s_lshr_b32 s47, s43, 6
s_add_u32 s47, s47, 0
s_lshl_b32 s47, s47, 11
buffer_load_dwordx4 v[80:83], v13, s[24:27], s47 offen offset:0 sc1
buffer_load_dwordx4 v[84:87], v13, s[24:27], s47 offen offset:1024 sc1
s_lshr_b32 s47, s43, 6
s_add_u32 s47, s47, 1
s_lshl_b32 s47, s47, 11
buffer_load_dwordx4 v[88:91], v13, s[24:27], s47 offen offset:0 sc1
buffer_load_dwordx4 v[92:95], v13, s[24:27], s47 offen offset:1024 sc1
s_call_b64 s[100:101], L_TRY
s_cbranch_scc1 L_SLOW5
v_mov_b64 v[48:49], v[120:121]
v_mov_b64 v[52:53], v[124:125]
s_branch L_BACK5
L_SLOW6:
s_lshr_b32 s91, s43, 6
s_add_u32 s91, s91, 0
s_lshl_b32 s47, s91, 11
buffer_load_dwordx4 v[120:123], v13, s[24:27], s47 offen offset:0 sc1
buffer_load_dwordx4 v[124:127], v13, s[24:27], s47 offen offset:1024 sc1
s_lshr_b32 s47, s43, 6
s_add_u32 s47, s47, 1
s_lshl_b32 s47, s47, 11
buffer_load_dwordx4 v[88:91], v13, s[24:27], s47 offen offset:0 sc1
buffer_load_dwordx4 v[92:95], v13, s[24:27], s47 offen offset:1024 sc1
s_movk_i32 s47, 8
s_lshl_b32 s47, s47, 11
buffer_load_dwordx4 v[32:35], v13, s[24:27], s47 offen offset:0 sc1
buffer_load_dwordx4 v[36:39], v13, s[24:27], s47 offen offset:1024 sc1
s_call_b64 s[100:101], L_TRY
s_cbranch_scc1 L_SLOW6
v_mov_b64 v[80:81], v[120:121]
v_mov_b64 v[84:85], v[124:125]
s_branch L_BACK6
L_SLOW7:
s_lshr_b32 s91, s43, 6
s_add_u32 s91, s91, 1
s_lshl_b32 s47, s91, 11
buffer_load_dwordx4 v[120:123], v13, s[24:27], s47 offen offset:0 sc1
buffer_load_dwordx4 v[124:127], v13, s[24:27], s47 offen offset:1024 sc1
s_movk_i32 s47, 8
s_lshl_b32 s47, s47, 11
buffer_load_dwordx4 v[32:35], v13, s[24:27], s47 offen offset:0 sc1
buffer_load_dwordx4 v[36:39], v13, s[24:27], s47 offen offset:1024 sc1
s_movk_i32 s47, 9
s_lshl_b32 s47, s47, 11
buffer_load_dwordx4 v[96:99], v13, s[24:27], s47 offen offset:0 sc1
buffer_load_dwordx4 v[100:103], v13, s[24:27], s47 offen offset:1024 sc1
s_call_b64 s[100:101], L_TRY
s_cbranch_scc1 L_SLOW7
v_mov_b64 v[88:89], v[120:121]
v_mov_b64 v[92:93], v[124:125]
s_branch L_BACK7
L_SLOW8:
s_movk_i32 s91, 8
s_lshl_b32 s47, s91, 11
buffer_load_dwordx4 v[120:123], v13, s[24:27], s47 offen offset:0 sc1
buffer_load_dwordx4 v[124:127], v13, s[24:27], s47 offen offset:1024 sc1
s_movk_i32 s47, 9
s_lshl_b32 s47, s47, 11
buffer_load_dwordx4 v[96:99], v13, s[24:27], s47 offen offset:0 sc1
buffer_load_dwordx4 v[100:103], v13, s[24:27], s47 offen offset:1024 sc1
s_movk_i32 s47, 10
s_lshl_b32 s47, s47, 11
buffer_load_dwordx4 v[40:43], v13, s[24:27], s47 offen offset:0 sc1
buffer_load_dwordx4 v[44:47], v13, s[24:27], s47 offen offset:1024 sc1
s_call_b64 s[100:101], L_TRY
s_cbranch_scc1 L_SLOW8
v_mov_b64 v[32:33], v[120:121]
v_mov_b64 v[36:37], v[124:125]
s_branch L_BACK8
L_SLOW9:
s_movk_i32 s91, 9
s_lshl_b32 s47, s91, 11
buffer_load_dwordx4 v[120:123], v13, s[24:27], s47 offen offset:0 sc1
buffer_load_dwordx4 v[124:127], v13, s[24:27], s47 offen offset:1024 sc1
s_movk_i32 s47, 10
s_lshl_b32 s47, s47, 11
buffer_load_dwordx4 v[40:43], v13, s[24:27], s47 offen offset:0 sc1
buffer_load_dwordx4 v[44:47], v13, s[24:27], s47 offen offset:1024 sc1
s_movk_i32 s47, 11
s_lshl_b32 s47, s47, 11
buffer_load_dwordx4 v[48:51], v13, s[24:27], s47 offen offset:0 sc1
buffer_load_dwordx4 v[52:55], v13, s[24:27], s47 offen offset:1024 sc1
s_call_b64 s[100:101], L_TRY
s_cbranch_scc1 L_SLOW9
v_mov_b64 v[96:97], v[120:121]
v_mov_b64 v[100:101], v[124:125]
s_branch L_BACK9
L_SLOW10:
s_movk_i32 s91, 10
s_lshl_b32 s47, s91, 11
buffer_load_dwordx4 v[120:123], v13, s[24:27], s47 offen offset:0 sc1
buffer_load_dwordx4 v[124:127], v13, s[24:27], s47 offen offset:1024 sc1
s_movk_i32 s47, 11
s_lshl_b32 s47, s47, 11
buffer_load_dwordx4 v[48:51], v13, s[24:27], s47 offen offset:0 sc1
buffer_load_dwordx4 v[52:55], v13, s[24:27], s47 offen offset:1024 sc1
s_movk_i32 s47, 12
s_lshl_b32 s47, s47, 11
buffer_load_dwordx4 v[80:83], v13, s[24:27], s47 offen offset:0 sc1
buffer_load_dwordx4 v[84:87], v13, s[24:27], s47 offen offset:1024 sc1
s_call_b64 s[100:101], L_TRY
s_cbranch_scc1 L_SLOW10
v_mov_b64 v[40:41], v[120:121]
v_mov_b64 v[44:45], v[124:125]
s_branch L_BACK10
L_SLOW11:
s_movk_i32 s91, 11
s_lshl_b32 s47, s91, 11
buffer_load_dwordx4 v[120:123], v13, s[24:27], s47 offen offset:0 sc1
buffer_load_dwordx4 v[124:127], v13, s[24:27], s47 offen offset:1024 sc1
s_movk_i32 s47, 12
s_lshl_b32 s47, s47, 11
buffer_load_dwordx4 v[80:83], v13, s[24:27], s47 offen offset:0 sc1
buffer_load_dwordx4 v[84:87], v13, s[24:27], s47 offen offset:1024 sc1
s_movk_i32 s47, 13
s_lshl_b32 s47, s47, 11
buffer_load_dwordx4 v[88:91], v13, s[24:27], s47 offen offset:0 sc1
buffer_load_dwordx4 v[92:95], v13, s[24:27], s47 offen offset:1024 sc1
s_call_b64 s[100:101], L_TRY
s_cbranch_scc1 L_SLOW11
v_mov_b64 v[48:49], v[120:121]
v_mov_b64 v[52:53], v[124:125]
s_branch L_BACK11
L_SLOW12:
s_movk_i32 s91, 12
s_lshl_b32 s47, s91, 11
buffer_load_dwordx4 v[120:123], v13, s[24:27], s47 offen offset:0 sc1
buffer_load_dwordx4 v[124:127], v13, s[24:27], s47 offen offset:1024 sc1
s_movk_i32 s47, 13
s_lshl_b32 s47, s47, 11
buffer_load_dwordx4 v[88:91], v13, s[24:27], s47 offen offset:0 sc1
buffer_load_dwordx4 v[92:95], v13, s[24:27], s47 offen offset:1024 sc1
s_movk_i32 s47, 14
s_lshl_b32 s47, s47, 11
buffer_load_dwordx4 v[32:35], v13, s[24:27], s47 offen offset:0 sc1
buffer_load_dwordx4 v[36:39], v13, s[24:27], s47 offen offset:1024 sc1
s_call_b64 s[100:101], L_TRY
s_cbranch_scc1 L_SLOW12
v_mov_b64 v[80:81], v[120:121]
v_mov_b64 v[84:85], v[124:125]
s_branch L_BACK12
L_SLOW13:
s_movk_i32 s91, 13
s_lshl_b32 s47, s91, 11
buffer_load_dwordx4 v[120:123], v13, s[24:27], s47 offen offset:0 sc1
buffer_load_dwordx4 v[124:127], v13, s[24:27], s47 offen offset:1024 sc1
s_movk_i32 s47, 14
s_lshl_b32 s47, s47, 11
buffer_load_dwordx4 v[32:35], v13, s[24:27], s47 offen offset:0 sc1
buffer_load_dwordx4 v[36:39], v13, s[24:27], s47 offen offset:1024 sc1
s_movk_i32 s47, 15
s_lshl_b32 s47, s47, 11
buffer_load_dwordx4 v[96:99], v13, s[24:27], s47 offen offset:0 sc1
buffer_load_dwordx4 v[100:103], v13, s[24:27], s47 offen offset:1024 sc1
s_call_b64 s[100:101], L_TRY
s_cbranch_scc1 L_SLOW13
v_mov_b64 v[88:89], v[120:121]
v_mov_b64 v[92:93], v[124:125]
s_branch L_BACK13
L_SLOW14:
s_movk_i32 s91, 14
s_lshl_b32 s47, s91, 11
buffer_load_dwordx4 v[120:123], v13, s[24:27], s47 offen offset:0 sc1
buffer_load_dwordx4 v[124:127], v13, s[24:27], s47 offen offset:1024 sc1
s_movk_i32 s47, 15
s_lshl_b32 s47, s47, 11
buffer_load_dwordx4 v[96:99], v13, s[24:27], s47 offen offset:0 sc1
buffer_load_dwordx4 v[100:103], v13, s[24:27], s47 offen offset:1024 sc1
s_movk_i32 s47, 16
s_lshl_b32 s47, s47, 11
buffer_load_dwordx4 v[40:43], v13, s[24:27], s47 offen offset:0 sc1
buffer_load_dwordx4 v[44:47], v13, s[24:27], s47 offen offset:1024 sc1
s_call_b64 s[100:101], L_TRY
s_cbranch_scc1 L_SLOW14
v_mov_b64 v[32:33], v[120:121]
v_mov_b64 v[36:37], v[124:125]
s_branch L_BACK14
L_SLOW15:
s_movk_i32 s91, 15
s_lshl_b32 s47, s91, 11
buffer_load_dwordx4 v[120:123], v13, s[24:27], s47 offen offset:0 sc1
buffer_load_dwordx4 v[124:127], v13, s[24:27], s47 offen offset:1024 sc1
s_movk_i32 s47, 16
s_lshl_b32 s47, s47, 11
buffer_load_dwordx4 v[40:43], v13, s[24:27], s47 offen offset:0 sc1
buffer_load_dwordx4 v[44:47], v13, s[24:27], s47 offen offset:1024 sc1
s_movk_i32 s47, 17
s_lshl_b32 s47, s47, 11
buffer_load_dwordx4 v[48:51], v13, s[24:27], s47 offen offset:0 sc1
buffer_load_dwordx4 v[52:55], v13, s[24:27], s47 offen offset:1024 sc1
s_call_b64 s[100:101], L_TRY
s_cbranch_scc1 L_SLOW15
v_mov_b64 v[96:97], v[120:121]
v_mov_b64 v[100:101], v[124:125]
s_branch L_BACK15
L_SLOW16:
s_movk_i32 s91, 16
s_lshl_b32 s47, s91, 11
buffer_load_dwordx4 v[120:123], v13, s[24:27], s47 offen offset:0 sc1
buffer_load_dwordx4 v[124:127], v13, s[24:27], s47 offen offset:1024 sc1
s_movk_i32 s47, 17
s_lshl_b32 s47, s47, 11
buffer_load_dwordx4 v[48:51], v13, s[24:27], s47 offen offset:0 sc1
buffer_load_dwordx4 v[52:55], v13, s[24:27], s47 offen offset:1024 sc1
s_movk_i32 s47, 18
s_lshl_b32 s47, s47, 11
buffer_load_dwordx4 v[80:83], v13, s[24:27], s47 offen offset:0 sc1
buffer_load_dwordx4 v[84:87], v13, s[24:27], s47 offen offset:1024 sc1
s_call_b64 s[100:101], L_TRY
s_cbranch_scc1 L_SLOW16
v_mov_b64 v[40:41], v[120:121]
v_mov_b64 v[44:45], v[124:125]
s_branch L_BACK16
L_SLOW17:
s_movk_i32 s91, 17
s_lshl_b32 s47, s91, 11
buffer_load_dwordx4 v[120:123], v13, s[24:27], s47 offen offset:0 sc1
buffer_load_dwordx4 v[124:127], v13, s[24:27], s47 offen offset:1024 sc1
s_movk_i32 s47, 18
s_lshl_b32 s47, s47, 11
buffer_load_dwordx4 v[80:83], v13, s[24:27], s47 offen offset:0 sc1
buffer_load_dwordx4 v[84:87], v13, s[24:27], s47 offen offset:1024 sc1
s_movk_i32 s47, 19
s_lshl_b32 s47, s47, 11
buffer_load_dwordx4 v[88:91], v13, s[24:27], s47 offen offset:0 sc1
buffer_load_dwordx4 v[92:95], v13, s[24:27], s47 offen offset:1024 sc1
s_call_b64 s[100:101], L_TRY
s_cbranch_scc1 L_SLOW17
v_mov_b64 v[48:49], v[120:121]
v_mov_b64 v[52:53], v[124:125]
s_branch L_BACK17
L_SLOW18:
s_movk_i32 s91, 18
s_lshl_b32 s47, s91, 11
buffer_load_dwordx4 v[120:123], v13, s[24:27], s47 offen offset:0 sc1
buffer_load_dwordx4 v[124:127], v13, s[24:27], s47 offen offset:1024 sc1
s_movk_i32 s47, 19
s_lshl_b32 s47, s47, 11
buffer_load_dwordx4 v[88:91], v13, s[24:27], s47 offen offset:0 sc1
buffer_load_dwordx4 v[92:95], v13, s[24:27], s47 offen offset:1024 sc1
s_movk_i32 s47, 20
s_lshl_b32 s47, s47, 11
buffer_load_dwordx4 v[32:35], v13, s[24:27], s47 offen offset:0 sc1
buffer_load_dwordx4 v[36:39], v13, s[24:27], s47 offen offset:1024 sc1
s_call_b64 s[100:101], L_TRY
s_cbranch_scc1 L_SLOW18
v_mov_b64 v[80:81], v[120:121]
v_mov_b64 v[84:85], v[124:125]
s_branch L_BACK18
L_SLOW19:
s_movk_i32 s91, 19
s_lshl_b32 s47, s91, 11
buffer_load_dwordx4 v[120:123], v13, s[24:27], s47 offen offset:0 sc1
buffer_load_dwordx4 v[124:127], v13, s[24:27], s47 offen offset:1024 sc1
s_movk_i32 s47, 20
s_lshl_b32 s47, s47, 11
buffer_load_dwordx4 v[32:35], v13, s[24:27], s47 offen offset:0 sc1
buffer_load_dwordx4 v[36:39], v13, s[24:27], s47 offen offset:1024 sc1
s_movk_i32 s47, 21
s_lshl_b32 s47, s47, 11
buffer_load_dwordx4 v[96:99], v13, s[24:27], s47 offen offset:0 sc1
buffer_load_dwordx4 v[100:103], v13, s[24:27], s47 offen offset:1024 sc1
s_call_b64 s[100:101], L_TRY
s_cbranch_scc1 L_SLOW19
v_mov_b64 v[88:89], v[120:121]
v_mov_b64 v[92:93], v[124:125]
s_branch L_BACK19
L_SLOW20:
s_movk_i32 s91, 20
s_lshl_b32 s47, s91, 11
buffer_load_dwordx4 v[120:123], v13, s[24:27], s47 offen offset:0 sc1
buffer_load_dwordx4 v[124:127], v13, s[24:27], s47 offen offset:1024 sc1
s_movk_i32 s47, 21
s_lshl_b32 s47, s47, 11
buffer_load_dwordx4 v[96:99], v13, s[24:27], s47 offen offset:0 sc1
buffer_load_dwordx4 v[100:103], v13, s[24:27], s47 offen offset:1024 sc1
s_movk_i32 s47, 22
s_lshl_b32 s47, s47, 11
buffer_load_dwordx4 v[40:43], v13, s[24:27], s47 offen offset:0 sc1
buffer_load_dwordx4 v[44:47], v13, s[24:27], s47 offen offset:1024 sc1
s_call_b64 s[100:101], L_TRY
s_cbranch_scc1 L_SLOW20
v_mov_b64 v[32:33], v[120:121]
v_mov_b64 v[36:37], v[124:125]
s_branch L_BACK20
L_SLOW21:
s_movk_i32 s91, 21
s_lshl_b32 s47, s91, 11
buffer_load_dwordx4 v[120:123], v13, s[24:27], s47 offen offset:0 sc1
buffer_load_dwordx4 v[124:127], v13, s[24:27], s47 offen offset:1024 sc1
s_movk_i32 s47, 22
s_lshl_b32 s47, s47, 11
buffer_load_dwordx4 v[40:43], v13, s[24:27], s47 offen offset:0 sc1
buffer_load_dwordx4 v[44:47], v13, s[24:27], s47 offen offset:1024 sc1
s_movk_i32 s47, 23
s_lshl_b32 s47, s47, 11
buffer_load_dwordx4 v[48:51], v13, s[24:27], s47 offen offset:0 sc1
buffer_load_dwordx4 v[52:55], v13, s[24:27], s47 offen offset:1024 sc1
s_call_b64 s[100:101], L_TRY
s_cbranch_scc1 L_SLOW21
v_mov_b64 v[96:97], v[120:121]
v_mov_b64 v[100:101], v[124:125]
s_branch L_BACK21
L_SLOW22:
s_movk_i32 s91, 22
s_lshl_b32 s47, s91, 11
buffer_load_dwordx4 v[120:123], v13, s[24:27], s47 offen offset:0 sc1
buffer_load_dwordx4 v[124:127], v13, s[24:27], s47 offen offset:1024 sc1
s_movk_i32 s47, 23
s_lshl_b32 s47, s47, 11
buffer_load_dwordx4 v[48:51], v13, s[24:27], s47 offen offset:0 sc1
buffer_load_dwordx4 v[52:55], v13, s[24:27], s47 offen offset:1024 sc1
s_movk_i32 s47, 24
s_lshl_b32 s47, s47, 11
buffer_load_dwordx4 v[80:83], v13, s[24:27], s47 offen offset:0 sc1
buffer_load_dwordx4 v[84:87], v13, s[24:27], s47 offen offset:1024 sc1
s_call_b64 s[100:101], L_TRY
s_cbranch_scc1 L_SLOW22
v_mov_b64 v[40:41], v[120:121]
v_mov_b64 v[44:45], v[124:125]
s_branch L_BACK22
L_SLOW23:
s_movk_i32 s91, 23
s_lshl_b32 s47, s91, 11
buffer_load_dwordx4 v[120:123], v13, s[24:27], s47 offen offset:0 sc1
buffer_load_dwordx4 v[124:127], v13, s[24:27], s47 offen offset:1024 sc1
s_movk_i32 s47, 24
s_lshl_b32 s47, s47, 11
buffer_load_dwordx4 v[80:83], v13, s[24:27], s47 offen offset:0 sc1
buffer_load_dwordx4 v[84:87], v13, s[24:27], s47 offen offset:1024 sc1
s_movk_i32 s47, 25
s_lshl_b32 s47, s47, 11
buffer_load_dwordx4 v[88:91], v13, s[24:27], s47 offen offset:0 sc1
buffer_load_dwordx4 v[92:95], v13, s[24:27], s47 offen offset:1024 sc1
s_call_b64 s[100:101], L_TRY
s_cbranch_scc1 L_SLOW23
v_mov_b64 v[48:49], v[120:121]
v_mov_b64 v[52:53], v[124:125]
s_branch L_BACK23
L_SLOW24:
s_movk_i32 s91, 24
s_lshl_b32 s47, s91, 11
buffer_load_dwordx4 v[120:123], v13, s[24:27], s47 offen offset:0 sc1
buffer_load_dwordx4 v[124:127], v13, s[24:27], s47 offen offset:1024 sc1
s_movk_i32 s47, 25
s_lshl_b32 s47, s47, 11
buffer_load_dwordx4 v[88:91], v13, s[24:27], s47 offen offset:0 sc1
buffer_load_dwordx4 v[92:95], v13, s[24:27], s47 offen offset:1024 sc1
s_movk_i32 s47, 26
s_lshl_b32 s47, s47, 11
buffer_load_dwordx4 v[32:35], v13, s[24:27], s47 offen offset:0 sc1
buffer_load_dwordx4 v[36:39], v13, s[24:27], s47 offen offset:1024 sc1
s_call_b64 s[100:101], L_TRY
s_cbranch_scc1 L_SLOW24
v_mov_b64 v[80:81], v[120:121]
v_mov_b64 v[84:85], v[124:125]
s_branch L_BACK24
L_SLOW25:
s_movk_i32 s91, 25
s_lshl_b32 s47, s91, 11
buffer_load_dwordx4 v[120:123], v13, s[24:27], s47 offen offset:0 sc1
buffer_load_dwordx4 v[124:127], v13, s[24:27], s47 offen offset:1024 sc1
s_movk_i32 s47, 26
s_lshl_b32 s47, s47, 11
buffer_load_dwordx4 v[32:35], v13, s[24:27], s47 offen offset:0 sc1
buffer_load_dwordx4 v[36:39], v13, s[24:27], s47 offen offset:1024 sc1
s_movk_i32 s47, 27
s_lshl_b32 s47, s47, 11
buffer_load_dwordx4 v[96:99], v13, s[24:27], s47 offen offset:0 sc1
buffer_load_dwordx4 v[100:103], v13, s[24:27], s47 offen offset:1024 sc1
s_call_b64 s[100:101], L_TRY
s_cbranch_scc1 L_SLOW25
v_mov_b64 v[88:89], v[120:121]
v_mov_b64 v[92:93], v[124:125]
s_branch L_BACK25
L_SLOW26:
s_movk_i32 s91, 26
s_lshl_b32 s47, s91, 11
buffer_load_dwordx4 v[120:123], v13, s[24:27], s47 offen offset:0 sc1
buffer_load_dwordx4 v[124:127], v13, s[24:27], s47 offen offset:1024 sc1
s_movk_i32 s47, 27
s_lshl_b32 s47, s47, 11
buffer_load_dwordx4 v[96:99], v13, s[24:27], s47 offen offset:0 sc1
buffer_load_dwordx4 v[100:103], v13, s[24:27], s47 offen offset:1024 sc1
s_movk_i32 s47, 28
s_lshl_b32 s47, s47, 11
buffer_load_dwordx4 v[40:43], v13, s[24:27], s47 offen offset:0 sc1
buffer_load_dwordx4 v[44:47], v13, s[24:27], s47 offen offset:1024 sc1
s_call_b64 s[100:101], L_TRY
s_cbranch_scc1 L_SLOW26
v_mov_b64 v[32:33], v[120:121]
v_mov_b64 v[36:37], v[124:125]
s_branch L_BACK26
L_SLOW27:
s_movk_i32 s91, 27
s_lshl_b32 s47, s91, 11
buffer_load_dwordx4 v[120:123], v13, s[24:27], s47 offen offset:0 sc1
buffer_load_dwordx4 v[124:127], v13, s[24:27], s47 offen offset:1024 sc1
s_movk_i32 s47, 28
s_lshl_b32 s47, s47, 11
buffer_load_dwordx4 v[40:43], v13, s[24:27], s47 offen offset:0 sc1
buffer_load_dwordx4 v[44:47], v13, s[24:27], s47 offen offset:1024 sc1
s_movk_i32 s47, 29
s_lshl_b32 s47, s47, 11
buffer_load_dwordx4 v[48:51], v13, s[24:27], s47 offen offset:0 sc1
buffer_load_dwordx4 v[52:55], v13, s[24:27], s47 offen offset:1024 sc1
s_call_b64 s[100:101], L_TRY
s_cbranch_scc1 L_SLOW27
v_mov_b64 v[96:97], v[120:121]
v_mov_b64 v[100:101], v[124:125]
s_branch L_BACK27
L_SLOW28:
s_movk_i32 s91, 28
s_lshl_b32 s47, s91, 11
buffer_load_dwordx4 v[120:123], v13, s[24:27], s47 offen offset:0 sc1
buffer_load_dwordx4 v[124:127], v13, s[24:27], s47 offen offset:1024 sc1
s_movk_i32 s47, 29
s_lshl_b32 s47, s47, 11
buffer_load_dwordx4 v[48:51], v13, s[24:27], s47 offen offset:0 sc1
buffer_load_dwordx4 v[52:55], v13, s[24:27], s47 offen offset:1024 sc1
s_movk_i32 s47, 30
s_lshl_b32 s47, s47, 11
buffer_load_dwordx4 v[80:83], v13, s[24:27], s47 offen offset:0 sc1
buffer_load_dwordx4 v[84:87], v13, s[24:27], s47 offen offset:1024 sc1
s_call_b64 s[100:101], L_TRY
s_cbranch_scc1 L_SLOW28
v_mov_b64 v[40:41], v[120:121]
v_mov_b64 v[44:45], v[124:125]
s_branch L_BACK28
L_SLOW29:
s_movk_i32 s91, 29
s_lshl_b32 s47, s91, 11
buffer_load_dwordx4 v[120:123], v13, s[24:27], s47 offen offset:0 sc1
buffer_load_dwordx4 v[124:127], v13, s[24:27], s47 offen offset:1024 sc1
s_movk_i32 s47, 30
s_lshl_b32 s47, s47, 11
buffer_load_dwordx4 v[80:83], v13, s[24:27], s47 offen offset:0 sc1
buffer_load_dwordx4 v[84:87], v13, s[24:27], s47 offen offset:1024 sc1
s_movk_i32 s47, 31
s_lshl_b32 s47, s47, 11
buffer_load_dwordx4 v[88:91], v13, s[24:27], s47 offen offset:0 sc1
buffer_load_dwordx4 v[92:95], v13, s[24:27], s47 offen offset:1024 sc1
s_call_b64 s[100:101], L_TRY
s_cbranch_scc1 L_SLOW29
v_mov_b64 v[48:49], v[120:121]
v_mov_b64 v[52:53], v[124:125]
s_branch L_BACK29
L_SLOW30:
s_movk_i32 s91, 30
s_lshl_b32 s47, s91, 11
buffer_load_dwordx4 v[120:123], v13, s[24:27], s47 offen offset:0 sc1
buffer_load_dwordx4 v[124:127], v13, s[24:27], s47 offen offset:1024 sc1
s_movk_i32 s47, 31
s_lshl_b32 s47, s47, 11
buffer_load_dwordx4 v[88:91], v13, s[24:27], s47 offen offset:0 sc1
buffer_load_dwordx4 v[92:95], v13, s[24:27], s47 offen offset:1024 sc1
s_call_b64 s[100:101], L_TRY
s_cbranch_scc1 L_SLOW30
v_mov_b64 v[80:81], v[120:121]
v_mov_b64 v[84:85], v[124:125]
s_branch L_BACK30
L_SLOW31:
s_movk_i32 s91, 31
s_lshl_b32 s47, s91, 11
buffer_load_dwordx4 v[120:123], v13, s[24:27], s47 offen offset:0 sc1
buffer_load_dwordx4 v[124:127], v13, s[24:27], s47 offen offset:1024 sc1
s_call_b64 s[100:101], L_TRY
s_cbranch_scc1 L_SLOW31
v_mov_b64 v[88:89], v[120:121]
v_mov_b64 v[92:93], v[124:125]
s_branch L_BACK31
L_SELF:
s_mul_i32 s47, s91, 458752
s_lshl_b32 s46, s39, 8
s_add_u32 s47, s47, s46
s_add_u32 s84, s6, s47
s_addc_u32 s85, s7, 0
s_mov_b32 s86, 387328
s_mov_b32 s87, 0x20000
buffer_load_dwordx4 v[64:67], v30, s[84:87], 0 offen
buffer_load_dwordx4 v[68:71], v30, s[84:87], s92 offen
buffer_load_dwordx4 v[72:75], v30, s[84:87], s93 offen
buffer_load_dwordx4 v[76:79], v30, s[84:87], s94 offen
s_waitcnt vmcnt(0)
v_lshl_add_u64 v[64:65], v[68:69], 4, v[64:65]
v_lshl_add_u64 v[66:67], v[70:71], 4, v[66:67]
v_lshl_add_u64 v[72:73], v[76:77], 4, v[72:73]
v_lshl_add_u64 v[74:75], v[78:79], 4, v[74:75]
v_lshl_or_b32 v76, v72, 8, v64
v_lshl_or_b32 v77, v73, 8, v65
v_lshl_or_b32 v78, v74, 8, v66
v_lshl_or_b32 v79, v75, 8, v67
v_lshl_or_b32 v120, v77, 16, v76
v_lshl_or_b32 v121, v79, 16, v78
s_add_u32 s84, s84, 57344
s_addc_u32 s85, s85, 0
buffer_load_dwordx4 v[64:67], v30, s[84:87], 0 offen
buffer_load_dwordx4 v[68:71], v30, s[84:87], s92 offen
buffer_load_dwordx4 v[72:75], v30, s[84:87], s93 offen
buffer_load_dwordx4 v[76:79], v30, s[84:87], s94 offen
s_waitcnt vmcnt(0)
v_lshl_add_u64 v[64:65], v[68:69], 4, v[64:65]
v_lshl_add_u64 v[66:67], v[70:71], 4, v[66:67]
v_lshl_add_u64 v[72:73], v[76:77], 4, v[72:73]
v_lshl_add_u64 v[74:75], v[78:79], 4, v[74:75]
v_lshl_or_b32 v76, v72, 8, v64
v_lshl_or_b32 v77, v73, 8, v65
v_lshl_or_b32 v78, v74, 8, v66
v_lshl_or_b32 v79, v75, 8, v67
v_lshl_or_b32 v124, v77, 16, v76
v_lshl_or_b32 v125, v79, 16, v78
s_cmp_eq_u32 s39, -1
s_setpc_b64 s[100:101]
L_END:
s_endpgm
.section .rodata,"a"
.p2align 6
.amdhsa_kernel standalone__normalfloat_lut_af4__prompt_kernel
  .amdhsa_next_free_vgpr 512
  .amdhsa_next_free_sgpr 102
  .amdhsa_accum_offset 256
  .amdhsa_group_segment_fixed_size 0
  .amdhsa_kernarg_size 56
  .amdhsa_user_sgpr_count 2
  .amdhsa_user_sgpr_kernarg_segment_ptr 1
  .amdhsa_system_sgpr_workgroup_id_x 1
.end_amdhsa_kernel
```
